```python
import torch

def _softmax(x, axis=-1):
    return torch.softmax(x, dim=axis)
def _gelu(x):
    return torch.nn.functional.gelu(x, approximate="tanh")
def _silu(x):
    return torch.nn.functional.silu(x)
def _sigmoid(x):
    return torch.sigmoid(x)
def _layernorm(x, axis=-1, eps=1e-5):
    m = x.mean(dim=axis, keepdim=True)
    v = x.var(dim=axis, keepdim=True, unbiased=False)
    return (x - m) / torch.sqrt(v + eps)
def _scatter_add(tgt, idx, src, axis=0):
    return tgt.clone().index_add_(axis, idx, src)
def _segment_sum(src, seg, n):
    out = torch.zeros((n,) + src.shape[1:], dtype=src.dtype)
    return out.index_add_(0, seg, src)
def _pad(x, pw):
    flat = tuple(v for pair in reversed(pw) for v in pair)
    return torch.nn.functional.pad(x, flat)

kernel_name = 'sequential_preLN__compressed_kv_cla__dense_activation_relu__prompt'

def setup_inputs():

    _w = (lambda a: (lambda t: t.to(torch.bfloat16) if t.is_floating_point() else t)(torch.as_tensor(a)))
    def _A_setup():
        B, H, Sq, Sk, D, M = 1, 32, 2048, 2048, 128, 576
        Dc = 4 * D
        return {
            "x": _w((lambda *s: torch.randn(*s, dtype=torch.bfloat16) * 0.05)(B, Sq, M)),
            "c_kv": _w((lambda *s: torch.randn(*s, dtype=torch.bfloat16) * 0.4)(B, Sk, Dc)),
            "w_q": _w((lambda *s: torch.randn(*s, dtype=torch.bfloat16) * 3.2)(M, H, D) * (M ** -0.5)),
            "w_uk": _w((lambda *s: torch.randn(*s, dtype=torch.bfloat16) * 3.2)(Dc, H, D) * (Dc ** -0.5)),
            "w_uv": _w((lambda *s: torch.randn(*s, dtype=torch.bfloat16) * 0.4)(Dc, H, D) * (Dc ** -0.5)),
            "w_o": _w((lambda *s: torch.randn(*s, dtype=torch.bfloat16) * 0.4)(H, D, M) * ((H * D) ** -0.5)),
        }
    _A_in = _A_setup()

    def _B_setup():
        B, S, D, Dff = 1, 2048, 576, 4608
        return {
            "x": _w((lambda *s: torch.randn(*s, dtype=torch.bfloat16) * 0.05)(B, S, D)),
            "w1": _w((lambda *s: torch.randn(*s, dtype=torch.bfloat16) * 0.05)(D, Dff)),
            "w2": _w((lambda *s: torch.randn(*s, dtype=torch.bfloat16) * 0.05)(Dff, D)),
        }
    _B_in = _B_setup()

    return {
        "A_x": _A_in["x"],
        "A_c_kv": _A_in["c_kv"],
        "A_w_q": _A_in["w_q"],
        "A_w_uk": _A_in["w_uk"],
        "A_w_uv": _A_in["w_uv"],
        "A_w_o": _A_in["w_o"],
        "B_x": _B_in["x"],
        "B_w1": _B_in["w1"],
        "B_w2": _B_in["w2"],
    }

def reference(A_x, A_c_kv, A_w_q, A_w_uk, A_w_uv, A_w_o, B_x, B_w1, B_w2):
    def _A_ref(x, c_kv, w_q, w_uk, w_uv, w_o):
        B, Sq, M = x.shape[0], x.shape[1], x.shape[2]
        Sk = c_kv.shape[1]
        H, D = w_q.shape[1], w_q.shape[2]
        q = torch.einsum("bqm,mhd->bhqd", x, w_q)
        k = torch.einsum("bkc,chd->bhkd", c_kv, w_uk)
        v = torch.einsum("bkc,chd->bhkd", c_kv, w_uv)
        scores = torch.einsum("bhqd,bhkd->bhqk", q, k) * (D ** -0.5)
        off = Sk - Sq
        qi = torch.arange(Sq)[:, None]
        kj = torch.arange(Sk)[None, :]
        cmask = kj <= (qi + off)
        scores = torch.where(cmask[None, None], scores, -1e9)
        p = _softmax(scores, axis=-1)
        ctx = torch.einsum("bhqk,bhkd->bhqd", p, v)
        return torch.einsum("bhqd,hdm->bqm", ctx, w_o)

    def _B_ref(x, w1, w2):
        h = torch.einsum("bsd,df->bsf", x, w1)
        zero = torch.zeros_like(h)
        h = torch.maximum(h, zero)
        return torch.einsum("bsf,fd->bsd", h, w2)

    x = A_x
    h = x + _A_ref(_layernorm(x, axis=-1), A_c_kv, A_w_q, A_w_uk, A_w_uv, A_w_o)
    h2 = h + _B_ref(_layernorm(h, axis=-1), B_w1, B_w2)
    return h2
```

```asm
; @launch kernel=attn_kernel grid=(256,1,1) block=(256,1,1) lds=163840
.amdgcn_target "amdgcn-amd-amdhsa--gfx950"
.text
.globl attn_kernel
.p2align 8
.type attn_kernel,@function
attn_kernel:
    s_cmp_ge_u32 s2, 256
    s_cbranch_scc1 K2_END
    s_load_dwordx4 s[28:31], s[0:1], 0
    s_load_dwordx4 s[32:35], s[0:1], 24
    s_load_dwordx4 s[92:95], s[0:1], 80
    s_load_dwordx2 s[64:65], s[0:1], 40
    s_load_dwordx2 s[66:67], s[0:1], 64
    v_lshrrev_b32 v1, 6, v0
    v_and_b32 v0, 63, v0
    v_readfirstlane_b32 s24, v1
    s_and_b32 s25, s2, 7
    s_lshr_b32 s39, s2, 3
    s_and_b32 s26, s39, 7
    s_lshr_b32 s27, s39, 3
    s_and_b32 s40, s27, 1
    s_lshl_b32 s40, s40, 1
    s_lshl_b32 s41, s25, 2
    s_add_u32 s40, s40, s41
    v_lshrrev_b32 v16, 3, v0
    v_and_b32 v17, 7, v0
    v_lshrrev_b32 v18, 4, v0
    v_xor_b32 v19, v17, v18
    v_xor_b32 v20, 4, v19
    s_lshl_b32 s44, s26, 8
    s_lshl_b32 s45, s24, 6
    s_add_u32 s44, s44, s45
    v_add_u32 v21, s44, v16
    v_lshlrev_b32 v21, 10, v21
    v_lshl_add_u32 v1, v19, 4, v21
    v_lshl_add_u32 v2, v20, 4, v21
    v_add_u32 v2, 8192, v2
    v_bfe_u32 v19, v0, 2, 2
    v_xor_b32 v19, v19, v18
    v_and_b32 v20, 3, v0
    v_lshl_add_u32 v19, v19, 2, v20
    s_lshl_b32 s45, s24, 4
    v_add_u32 v21, s45, v18
    v_lshlrev_b32 v21, 13, v21
    v_lshl_add_u32 v3, v19, 4, v21
    s_lshl_b32 s46, s40, 8
    v_add_u32 v3, s46, v3
    s_lshl_b32 s47, s24, 12
    s_lshl_b32 s48, s24, 13
    s_add_u32 s48, s48, 65536
    s_waitcnt lgkmcnt(0)
    s_mov_b32 s4, s30
    s_mov_b32 s5, s31
    s_mov_b32 s6, 0x200000
    s_mov_b32 s7, 0x00020000
    s_cmp_ge_u32 s27, 2
    s_cselect_b32 s8, s34, s32
    s_cselect_b32 s9, s35, s33
    s_mov_b32 s10, 0x400000
    s_mov_b32 s11, 0x00020000
    s_add_u32 s52, s25, 0
    s_and_b32 s52, s52, 7
    s_lshl_b32 s52, s52, 19
    s_add_u32 m0, s47, 16384
    s_nop 0
    buffer_load_dwordx4 v3, s[8:11], s52 offen lds
    s_add_u32 s52, s52, 32768
    s_add_u32 m0, s47, 17408
    s_nop 0
    buffer_load_dwordx4 v3, s[8:11], s52 offen lds
    s_add_u32 s52, s52, 32768
    s_add_u32 m0, s47, 18432
    s_nop 0
    buffer_load_dwordx4 v3, s[8:11], s52 offen lds
    s_add_u32 s52, s52, 32768
    s_add_u32 m0, s47, 19456
    s_nop 0
    buffer_load_dwordx4 v3, s[8:11], s52 offen lds
    s_add_u32 s50, s25, 0
    s_and_b32 s50, s50, 7
    s_lshl_b32 s50, s50, 7
    s_add_u32 m0, s48, 0
    s_nop 0
    buffer_load_dwordx4 v1, s[4:7], s50 offen lds
    s_add_u32 m0, s48, 1024
    s_nop 0
    buffer_load_dwordx4 v2, s[4:7], s50 offen lds
    s_add_u32 s50, s50, 16384
    s_add_u32 m0, s48, 2048
    s_nop 0
    buffer_load_dwordx4 v1, s[4:7], s50 offen lds
    s_add_u32 m0, s48, 3072
    s_nop 0
    buffer_load_dwordx4 v2, s[4:7], s50 offen lds
    s_add_u32 s50, s50, 16384
    s_add_u32 m0, s48, 4096
    s_nop 0
    buffer_load_dwordx4 v1, s[4:7], s50 offen lds
    s_add_u32 m0, s48, 5120
    s_nop 0
    buffer_load_dwordx4 v2, s[4:7], s50 offen lds
    s_add_u32 s50, s50, 16384
    s_add_u32 m0, s48, 6144
    s_nop 0
    buffer_load_dwordx4 v1, s[4:7], s50 offen lds
    s_add_u32 m0, s48, 7168
    s_nop 0
    buffer_load_dwordx4 v2, s[4:7], s50 offen lds
    v_bfe_u32 v19, v0, 2, 1
    v_bfe_u32 v21, v0, 4, 1
    v_xor_b32 v19, v19, v21
    v_lshl_add_u32 v19, v19, 2, v20
    s_and_b32 s45, s24, 1
    s_lshl_b32 s45, s45, 5
    v_add_u32 v21, s45, v16
    v_lshlrev_b32 v21, 13, v21
    v_lshl_add_u32 v4, v19, 4, v21
    s_add_u32 s46, s46, 256
    v_add_u32 v4, s46, v4
    s_lshr_b32 s49, s24, 1
    s_add_u32 s49, s49, s25
    s_mov_b32 s36, s94
    s_mov_b32 s37, s95
    s_mov_b32 s94, 256
    s_mov_b32 s95, 0x00020000
    s_mov_b32 s96, s36
    s_mov_b32 s97, s37
    s_mov_b32 s98, 0x2000000
    s_mov_b32 s99, 0x00020000
    s_mov_b32 s16, s28
    s_mov_b32 s17, s29
    s_mov_b32 s18, 0x240000
    s_mov_b32 s19, 0x00020000
    s_add_u32 s20, s36, 0x2000000
    s_addc_u32 s21, s37, 0
    s_mov_b32 s22, 0x2600000
    s_mov_b32 s23, 0x00020000
    s_lshl_b32 s35, s40, 3
    s_and_b32 s34, s27, 2
    s_lshl_b32 s34, s34, 2
    s_add_u32 s35, s35, s34
    s_add_u32 s35, s35, s26
    s_lshl_b32 s41, s35, 2
    s_add_u32 s41, s41, s24
    s_lshl_b32 s41, s41, 1
    s_cmp_eq_u32 s24, 0
    s_cselect_b32 s34, s35, 0x7f000000
    s_cselect_b32 s53, 0, 0x3f000000
    s_lshl_b32 s57, s26, 2
    s_add_u32 s57, s57, s24
    s_lshl_b32 s57, s57, 17
    s_lshl_b32 s60, s40, 8
    s_add_u32 s57, s57, s60
    v_lshrrev_b32 v62, 1, v0
    v_lshlrev_b32 v62, 13, v62
    v_and_b32 v63, 1, v0
    v_lshl_add_u32 v62, v63, 7, v62
    v_add_u32 v62, s57, v62
    v_mov_b32 v34, 0x7fffff00
    v_cmp_gt_u32 vcc, 32, v0
    s_nop 1
    v_cndmask_b32 v62, v34, v62, vcc
    s_lshl_b32 s57, s26, 2
    s_add_u32 s57, s57, s27
    s_lshl_b32 s57, s57, 2
    s_add_u32 s57, s57, s24
    s_lshl_b32 s57, s57, 14
    s_add_u32 s58, s57, 8192
    v_lshlrev_b32 v61, 7, v0
    v_mul_u32_u24 v32, 1152, v16
    v_lshl_add_u32 v32, v17, 4, v32
    v_lshlrev_b32 v33, 8, v16
    v_lshl_add_u32 v33, v17, 4, v33
    v_lshlrev_b32 v34, 5, v17
    v_lshl_add_u32 v34, v16, 2, v34
    v_lshl_add_u32 v35, v0, 2, s53
    s_mul_i32 s43, s35, 9216
    s_lshl_b32 s42, s24, 8
    s_add_u32 s42, s43, s42
    s_add_u32 s56, s43, 1152
    s_getpc_b64 s[62:63]
K1_PC:
    s_lshl_b32 s60, s39, 2
    s_add_u32 s60, s60, s24
    s_lshl_b32 s60, s60, 11
    v_and_b32 v192, 15, v0
    v_lshlrev_b32 v192, 7, v192
    v_add_u32 v192, s60, v192
    v_min_u32 v192, CODE_END-K1_PC-4, v192
    v_and_b32 v16, 31, v0
    v_lshrrev_b32 v17, 5, v0
    v_bfe_u32 v18, v0, 1, 3
    v_xor_b32 v17, v17, v18
    v_lshlrev_b32 v17, 4, v17
    v_lshl_add_u32 v17, v16, 7, v17
    v_add_u32 v5, s48, v17
    v_xor_b32 v6, 32, v5
    v_xor_b32 v7, 64, v5
    v_xor_b32 v8, 96, v5
    v_lshrrev_b32 v16, 5, v0
    v_bfe_u32 v17, v0, 2, 2
    v_lshl_add_u32 v16, v16, 3, v17
    v_bfe_u32 v18, v0, 4, 1
    v_and_b32 v19, 3, v0
    v_lshlrev_b32 v19, 3, v19
    v_lshl_add_u32 v19, v18, 5, v19
    v_lshl_add_u32 v20, v16, 8, v19
    v_lshl_add_u32 v9, v17, 6, v20
    v_xor_b32 v10, 64, v9
    v_xor_b32 v11, 128, v9
    v_xor_b32 v12, 192, v9
    v_lshl_add_u32 v20, v16, 7, v19
    v_lshrrev_b32 v17, 1, v17
    v_lshl_add_u32 v13, v17, 6, v20
    v_xor_b32 v14, 64, v13
    s_lshl_b32 s100, s26, 2
    s_add_u32 s100, s100, s24
    s_lshl_b32 s100, s100, 15
    s_lshl_b32 s101, s40, 20
    s_add_u32 s100, s100, s101
    s_cmp_ge_u32 s27, 2
    s_cselect_b32 s101, 16384, 0
    s_add_u32 s100, s100, s101
    v_lshrrev_b32 v16, 5, v0
    v_lshlrev_b32 v16, 8, v16
    v_and_b32 v17, 7, v0
    v_lshl_add_u32 v16, v17, 4, v16
    v_bfe_u32 v17, v0, 3, 1
    v_bfe_u32 v18, v0, 4, 1
    s_cmp_ge_u32 s27, 2
    s_cselect_b32 s44, 7, 12
    s_cselect_b32 s45, 10, 7
    v_lshl_add_u32 v16, v17, s44, v16
    v_lshl_add_u32 v15, v18, s45, v16
    s_barrier
    s_add_u32 s52, s25, 1
    s_and_b32 s52, s52, 7
    s_lshl_b32 s52, s52, 19
    s_add_u32 m0, s47, 32768
    s_nop 0
    buffer_load_dwordx4 v3, s[8:11], s52 offen lds
    s_add_u32 s52, s52, 32768
    s_add_u32 m0, s47, 33792
    s_nop 0
    buffer_load_dwordx4 v3, s[8:11], s52 offen lds
    s_add_u32 s52, s52, 32768
    s_add_u32 m0, s47, 34816
    s_nop 0
    buffer_load_dwordx4 v3, s[8:11], s52 offen lds
    s_add_u32 s52, s52, 32768
    s_add_u32 m0, s47, 35840
    s_nop 0
    buffer_load_dwordx4 v3, s[8:11], s52 offen lds
    s_add_u32 s50, s25, 1
    s_and_b32 s50, s50, 7
    s_lshl_b32 s50, s50, 7
    s_add_u32 m0, s48, 32768
    s_nop 0
    buffer_load_dwordx4 v1, s[4:7], s50 offen lds
    s_add_u32 m0, s48, 33792
    s_nop 0
    buffer_load_dwordx4 v2, s[4:7], s50 offen lds
    s_add_u32 s50, s50, 16384
    s_add_u32 m0, s48, 34816
    s_nop 0
    buffer_load_dwordx4 v1, s[4:7], s50 offen lds
    s_add_u32 m0, s48, 35840
    s_nop 0
    buffer_load_dwordx4 v2, s[4:7], s50 offen lds
    s_add_u32 s50, s50, 16384
    s_add_u32 m0, s48, 36864
    s_nop 0
    buffer_load_dwordx4 v1, s[4:7], s50 offen lds
    s_add_u32 m0, s48, 37888
    s_nop 0
    buffer_load_dwordx4 v2, s[4:7], s50 offen lds
    s_add_u32 s50, s50, 16384
    s_add_u32 m0, s48, 38912
    s_nop 0
    buffer_load_dwordx4 v1, s[4:7], s50 offen lds
    s_add_u32 m0, s48, 39936
    s_nop 0
    buffer_load_dwordx4 v2, s[4:7], s50 offen lds
    global_load_dword v192, v192, s[62:63]
    buffer_load_dword v63, v62, s[8:11], 0 offen offset:0
    buffer_load_dwordx4 v[196:199], v32, s[16:19], s42 offen offset:0
    buffer_load_dwordx4 v[200:203], v32, s[16:19], s42 offen offset:128
    buffer_load_dwordx4 v[204:207], v32, s[16:19], s42 offen offset:256
    s_add_u32 s42, s42, 384
    s_cmp_ge_u32 s42, s56
    s_cselect_b32 s42, s43, s42
    buffer_load_dwordx4 v[208:211], v32, s[16:19], s42 offen offset:0
    s_add_u32 s42, s42, 128
    s_cmp_ge_u32 s42, s56
    s_cselect_b32 s42, s43, s42
    buffer_load_dwordx4 v[212:215], v32, s[16:19], s42 offen offset:0
    s_add_u32 s42, s42, 128
    s_cmp_ge_u32 s42, s56
    s_cselect_b32 s42, s43, s42
    buffer_load_dwordx4 v[216:219], v32, s[16:19], s42 offen offset:0
    s_add_u32 s42, s42, 128
    s_cmp_ge_u32 s42, s56
    s_cselect_b32 s42, s43, s42
    buffer_load_dwordx4 v[220:223], v32, s[16:19], s42 offen offset:0
    s_add_u32 s42, s42, 128
    s_cmp_ge_u32 s42, s56
    s_cselect_b32 s42, s43, s42
    buffer_load_dwordx4 v[224:227], v32, s[16:19], s42 offen offset:0
    s_add_u32 s42, s42, 128
    s_cmp_ge_u32 s42, s56
    s_cselect_b32 s42, s43, s42
    buffer_load_dwordx4 v[228:231], v32, s[16:19], s42 offen offset:0
    s_cmp_ge_u32 s27, 2
    s_cbranch_scc1 K1_VPATH
    s_waitcnt vmcnt(23)
    s_barrier
    ds_read_b128 a[0:3], v5 offset:0
    ds_read_b128 a[4:7], v5 offset:4096
    ds_read_b64_tr_b16 v[16:17], v9 offset:16384
    ds_read_b64_tr_b16 v[18:19], v9 offset:17408
    ds_read_b64_tr_b16 v[20:21], v10 offset:16384
    ds_read_b64_tr_b16 v[22:23], v10 offset:17408
    ds_read_b64_tr_b16 v[24:25], v11 offset:16384
    ds_read_b64_tr_b16 v[26:27], v11 offset:17408
    s_waitcnt lgkmcnt(4)
    v_mfma_f32_32x32x16_bf16 v[64:79], v[16:19], a[0:3], 0
    ds_read_b64_tr_b16 v[28:29], v12 offset:16384
    ds_read_b64_tr_b16 v[30:31], v12 offset:17408
    s_add_u32 s52, s25, 2
    s_and_b32 s52, s52, 7
    s_lshl_b32 s52, s52, 19
    s_add_u32 m0, s47, 49152
    s_nop 0
    buffer_load_dwordx4 v3, s[8:11], s52 offen lds
    v_mfma_f32_32x32x16_bf16 v[80:95], v[16:19], a[4:7], 0
    s_waitcnt lgkmcnt(4)
    v_mfma_f32_32x32x16_bf16 v[96:111], v[20:23], a[0:3], 0
    ds_read_b128 a[8:11], v6 offset:0
    ds_read_b128 a[12:15], v6 offset:4096
    ds_read_b64_tr_b16 v[16:17], v9 offset:20480
    ds_read_b64_tr_b16 v[18:19], v9 offset:21504
    s_add_u32 s52, s52, 32768
    s_add_u32 m0, s47, 50176
    s_nop 0
    buffer_load_dwordx4 v3, s[8:11], s52 offen lds
    v_mfma_f32_32x32x16_bf16 v[112:127], v[20:23], a[4:7], 0
    s_waitcnt lgkmcnt(6)
    v_mfma_f32_32x32x16_bf16 v[128:143], v[24:27], a[0:3], 0
    ds_read_b64_tr_b16 v[20:21], v10 offset:20480
    ds_read_b64_tr_b16 v[22:23], v10 offset:21504
    s_add_u32 s52, s52, 32768
    s_add_u32 m0, s47, 51200
    s_nop 0
    buffer_load_dwordx4 v3, s[8:11], s52 offen lds
    v_mfma_f32_32x32x16_bf16 v[144:159], v[24:27], a[4:7], 0
    s_waitcnt lgkmcnt(6)
    v_mfma_f32_32x32x16_bf16 v[160:175], v[28:31], a[0:3], 0
    ds_read_b64_tr_b16 v[24:25], v11 offset:20480
    ds_read_b64_tr_b16 v[26:27], v11 offset:21504
    s_add_u32 s52, s52, 32768
    s_add_u32 m0, s47, 52224
    s_nop 0
    buffer_load_dwordx4 v3, s[8:11], s52 offen lds
    v_mfma_f32_32x32x16_bf16 v[176:191], v[28:31], a[4:7], 0
    s_waitcnt lgkmcnt(4)
    v_mfma_f32_32x32x16_bf16 v[64:79], v[16:19], a[8:11], v[64:79]
    ds_read_b64_tr_b16 v[28:29], v12 offset:20480
    ds_read_b64_tr_b16 v[30:31], v12 offset:21504
    s_add_u32 s50, s25, 2
    s_and_b32 s50, s50, 7
    s_lshl_b32 s50, s50, 7
    s_add_u32 m0, s48, 65536
    s_nop 0
    buffer_load_dwordx4 v1, s[4:7], s50 offen lds
    v_mfma_f32_32x32x16_bf16 v[80:95], v[16:19], a[12:15], v[80:95]
    s_waitcnt lgkmcnt(4)
    v_mfma_f32_32x32x16_bf16 v[96:111], v[20:23], a[8:11], v[96:111]
    ds_read_b128 a[16:19], v7 offset:0
    ds_read_b128 a[20:23], v7 offset:4096
    ds_read_b64_tr_b16 v[16:17], v9 offset:24576
    ds_read_b64_tr_b16 v[18:19], v9 offset:25600
    s_add_u32 m0, s48, 66560
    s_nop 0
    buffer_load_dwordx4 v2, s[4:7], s50 offen lds
    v_mfma_f32_32x32x16_bf16 v[112:127], v[20:23], a[12:15], v[112:127]
    s_waitcnt lgkmcnt(6)
    v_mfma_f32_32x32x16_bf16 v[128:143], v[24:27], a[8:11], v[128:143]
    ds_read_b64_tr_b16 v[20:21], v10 offset:24576
    ds_read_b64_tr_b16 v[22:23], v10 offset:25600
    s_add_u32 s50, s50, 16384
    s_add_u32 m0, s48, 67584
    s_nop 0
    buffer_load_dwordx4 v1, s[4:7], s50 offen lds
    v_mfma_f32_32x32x16_bf16 v[144:159], v[24:27], a[12:15], v[144:159]
    s_waitcnt lgkmcnt(6)
    v_mfma_f32_32x32x16_bf16 v[160:175], v[28:31], a[8:11], v[160:175]
    ds_read_b64_tr_b16 v[24:25], v11 offset:24576
    ds_read_b64_tr_b16 v[26:27], v11 offset:25600
    s_add_u32 m0, s48, 68608
    s_nop 0
    buffer_load_dwordx4 v2, s[4:7], s50 offen lds
    v_mfma_f32_32x32x16_bf16 v[176:191], v[28:31], a[12:15], v[176:191]
    s_waitcnt lgkmcnt(4)
    v_mfma_f32_32x32x16_bf16 v[64:79], v[16:19], a[16:19], v[64:79]
    ds_read_b64_tr_b16 v[28:29], v12 offset:24576
    ds_read_b64_tr_b16 v[30:31], v12 offset:25600
    s_add_u32 s50, s50, 16384
    s_add_u32 m0, s48, 69632
    s_nop 0
    buffer_load_dwordx4 v1, s[4:7], s50 offen lds
    v_mfma_f32_32x32x16_bf16 v[80:95], v[16:19], a[20:23], v[80:95]
    s_waitcnt lgkmcnt(4)
    v_mfma_f32_32x32x16_bf16 v[96:111], v[20:23], a[16:19], v[96:111]
    ds_read_b128 a[24:27], v8 offset:0
    ds_read_b128 a[28:31], v8 offset:4096
    ds_read_b64_tr_b16 v[16:17], v9 offset:28672
    ds_read_b64_tr_b16 v[18:19], v9 offset:29696
    s_add_u32 m0, s48, 70656
    s_nop 0
    buffer_load_dwordx4 v2, s[4:7], s50 offen lds
    v_mfma_f32_32x32x16_bf16 v[112:127], v[20:23], a[20:23], v[112:127]
    s_waitcnt lgkmcnt(6)
    v_mfma_f32_32x32x16_bf16 v[128:143], v[24:27], a[16:19], v[128:143]
    ds_read_b64_tr_b16 v[20:21], v10 offset:28672
    ds_read_b64_tr_b16 v[22:23], v10 offset:29696
    s_add_u32 s50, s50, 16384
    s_add_u32 m0, s48, 71680
    s_nop 0
    buffer_load_dwordx4 v1, s[4:7], s50 offen lds
    v_mfma_f32_32x32x16_bf16 v[144:159], v[24:27], a[20:23], v[144:159]
    s_waitcnt lgkmcnt(6)
    v_mfma_f32_32x32x16_bf16 v[160:175], v[28:31], a[16:19], v[160:175]
    ds_read_b64_tr_b16 v[24:25], v11 offset:28672
    ds_read_b64_tr_b16 v[26:27], v11 offset:29696
    s_add_u32 m0, s48, 72704
    s_nop 0
    buffer_load_dwordx4 v2, s[4:7], s50 offen lds
    v_mfma_f32_32x32x16_bf16 v[176:191], v[28:31], a[20:23], v[176:191]
    s_waitcnt lgkmcnt(4)
    v_mfma_f32_32x32x16_bf16 v[64:79], v[16:19], a[24:27], v[64:79]
    ds_read_b64_tr_b16 v[28:29], v12 offset:28672
    ds_read_b64_tr_b16 v[30:31], v12 offset:29696
    v_mfma_f32_32x32x16_bf16 v[80:95], v[16:19], a[28:31], v[80:95]
    s_waitcnt lgkmcnt(4)
    v_mfma_f32_32x32x16_bf16 v[96:111], v[20:23], a[24:27], v[96:111]
    s_waitcnt vmcnt(23)
    s_barrier
    v_add_u32 v5, 32768, v5
    ds_read_b128 a[32:35], v5 offset:0
    ds_read_b128 a[36:39], v5 offset:4096
    ds_read_b64_tr_b16 v[16:17], v9 offset:32768
    ds_read_b64_tr_b16 v[18:19], v9 offset:33792
    v_mfma_f32_32x32x16_bf16 v[112:127], v[20:23], a[28:31], v[112:127]
    s_waitcnt lgkmcnt(6)
    v_mfma_f32_32x32x16_bf16 v[128:143], v[24:27], a[24:27], v[128:143]
    ds_read_b64_tr_b16 v[20:21], v10 offset:32768
    ds_read_b64_tr_b16 v[22:23], v10 offset:33792
    v_mfma_f32_32x32x16_bf16 v[144:159], v[24:27], a[28:31], v[144:159]
    s_waitcnt lgkmcnt(6)
    v_mfma_f32_32x32x16_bf16 v[160:175], v[28:31], a[24:27], v[160:175]
    ds_read_b64_tr_b16 v[24:25], v11 offset:32768
    ds_read_b64_tr_b16 v[26:27], v11 offset:33792
    v_mov_b32 v60, 0
    v_mov_b32 v59, 0
    s_lshr_b32 s43, s35, 1
    v_mfma_f32_32x32x16_bf16 v[176:191], v[28:31], a[28:31], v[176:191]
    s_mul_i32 s43, s43, 18432
    s_and_b32 s42, s35, 1
    s_lshl_b32 s42, s42, 7
    s_waitcnt lgkmcnt(4)
    v_mfma_f32_32x32x16_bf16 v[64:79], v[16:19], a[32:35], v[64:79]
    ds_read_b64_tr_b16 v[28:29], v12 offset:32768
    ds_read_b64_tr_b16 v[30:31], v12 offset:33792
    s_add_u32 s52, s25, 3
    s_and_b32 s52, s52, 7
    s_lshl_b32 s52, s52, 19
    s_add_u32 m0, s47, 0
    s_nop 0
    buffer_load_dwordx4 v3, s[8:11], s52 offen lds
    s_add_u32 s43, s43, s42
    s_lshl_b32 s42, s24, 12
    v_mfma_f32_32x32x16_bf16 v[80:95], v[16:19], a[36:39], v[80:95]
    s_add_u32 s52, s52, 32768
    s_add_u32 m0, s47, 1024
    s_nop 0
    buffer_load_dwordx4 v3, s[8:11], s52 offen lds
    s_add_u32 s43, s43, s42
    s_add_u32 s42, s43, 4096
    s_lshl_b32 s57, s35, 8
    s_waitcnt lgkmcnt(4)
    v_mfma_f32_32x32x16_bf16 v[96:111], v[20:23], a[32:35], v[96:111]
    v_add_u32 v6, 32768, v6
    ds_read_b128 a[40:43], v6 offset:0
    ds_read_b128 a[44:47], v6 offset:4096
    ds_read_b64_tr_b16 v[16:17], v9 offset:36864
    ds_read_b64_tr_b16 v[18:19], v9 offset:37888
    s_add_u32 s58, s57, 36700160
    s_lshl_b32 s59, s57, 1
    v_mfma_f32_32x32x16_bf16 v[112:127], v[20:23], a[36:39], v[112:127]
    s_add_u32 s52, s52, 32768
    s_add_u32 m0, s47, 2048
    s_nop 0
    buffer_load_dwordx4 v3, s[8:11], s52 offen lds
    s_add_u32 s59, s59, 36831232
    s_add_u32 s57, s57, 35651584
    s_waitcnt vmcnt(15)
    s_waitcnt lgkmcnt(6)
    v_mfma_f32_32x32x16_bf16 v[128:143], v[24:27], a[32:35], v[128:143]
    ds_read_b64_tr_b16 v[20:21], v10 offset:36864
    ds_read_b64_tr_b16 v[22:23], v10 offset:37888
    v_dot2c_f32_bf16 v60, 0x3f803f80, v196
    v_dot2c_f32_bf16 v59, v196, v196
    v_mfma_f32_32x32x16_bf16 v[144:159], v[24:27], a[36:39], v[144:159]
    s_add_u32 s52, s52, 32768
    s_add_u32 m0, s47, 3072
    s_nop 0
    buffer_load_dwordx4 v3, s[8:11], s52 offen lds
    v_dot2c_f32_bf16 v60, 0x3f803f80, v197
    v_dot2c_f32_bf16 v59, v197, v197
    v_dot2c_f32_bf16 v60, 0x3f803f80, v198
    s_waitcnt lgkmcnt(6)
    v_mfma_f32_32x32x16_bf16 v[160:175], v[28:31], a[32:35], v[160:175]
    ds_read_b64_tr_b16 v[24:25], v11 offset:36864
    ds_read_b64_tr_b16 v[26:27], v11 offset:37888
    v_dot2c_f32_bf16 v59, v198, v198
    v_dot2c_f32_bf16 v60, 0x3f803f80, v199
    v_dot2c_f32_bf16 v59, v199, v199
    v_mfma_f32_32x32x16_bf16 v[176:191], v[28:31], a[36:39], v[176:191]
    s_add_u32 s50, s25, 3
    s_and_b32 s50, s50, 7
    s_lshl_b32 s50, s50, 7
    s_add_u32 m0, s48, 0
    s_nop 0
    buffer_load_dwordx4 v1, s[4:7], s50 offen lds
    v_dot2c_f32_bf16 v60, 0x3f803f80, v200
    v_dot2c_f32_bf16 v59, v200, v200
    s_waitcnt lgkmcnt(4)
    v_mfma_f32_32x32x16_bf16 v[64:79], v[16:19], a[40:43], v[64:79]
    ds_read_b64_tr_b16 v[28:29], v12 offset:36864
    ds_read_b64_tr_b16 v[30:31], v12 offset:37888
    v_dot2c_f32_bf16 v60, 0x3f803f80, v201
    v_dot2c_f32_bf16 v59, v201, v201
    v_dot2c_f32_bf16 v60, 0x3f803f80, v202
    v_mfma_f32_32x32x16_bf16 v[80:95], v[16:19], a[44:47], v[80:95]
    s_add_u32 m0, s48, 1024
    s_nop 0
    buffer_load_dwordx4 v2, s[4:7], s50 offen lds
    v_dot2c_f32_bf16 v59, v202, v202
    v_dot2c_f32_bf16 v60, 0x3f803f80, v203
    s_waitcnt lgkmcnt(4)
    v_mfma_f32_32x32x16_bf16 v[96:111], v[20:23], a[40:43], v[96:111]
    v_add_u32 v7, 32768, v7
    ds_read_b128 a[48:51], v7 offset:0
    ds_read_b128 a[52:55], v7 offset:4096
    ds_read_b64_tr_b16 v[16:17], v9 offset:40960
    ds_read_b64_tr_b16 v[18:19], v9 offset:41984
    v_dot2c_f32_bf16 v59, v203, v203
    v_dot2c_f32_bf16 v60, 0x3f803f80, v204
    v_dot2c_f32_bf16 v59, v204, v204
    v_mfma_f32_32x32x16_bf16 v[112:127], v[20:23], a[44:47], v[112:127]
    s_add_u32 s50, s50, 16384
    s_add_u32 m0, s48, 2048
    s_nop 0
    buffer_load_dwordx4 v1, s[4:7], s50 offen lds
    v_dot2c_f32_bf16 v60, 0x3f803f80, v205
    v_dot2c_f32_bf16 v59, v205, v205
    s_waitcnt lgkmcnt(6)
    v_mfma_f32_32x32x16_bf16 v[128:143], v[24:27], a[40:43], v[128:143]
    ds_read_b64_tr_b16 v[20:21], v10 offset:40960
    ds_read_b64_tr_b16 v[22:23], v10 offset:41984
    s_add_u32 m0, s48, 3072
    s_nop 0
    buffer_load_dwordx4 v2, s[4:7], s50 offen lds
    v_dot2c_f32_bf16 v60, 0x3f803f80, v206
    v_dot2c_f32_bf16 v59, v206, v206
    v_dot2c_f32_bf16 v60, 0x3f803f80, v207
    v_mfma_f32_32x32x16_bf16 v[144:159], v[24:27], a[44:47], v[144:159]
    v_dot2c_f32_bf16 v59, v207, v207
    v_dot2c_f32_bf16 v60, 0x3f803f80, v208
    s_waitcnt lgkmcnt(6)
    v_mfma_f32_32x32x16_bf16 v[160:175], v[28:31], a[40:43], v[160:175]
    ds_read_b64_tr_b16 v[24:25], v11 offset:40960
    ds_read_b64_tr_b16 v[26:27], v11 offset:41984
    s_add_u32 s50, s50, 16384
    s_add_u32 m0, s48, 4096
    s_nop 0
    buffer_load_dwordx4 v1, s[4:7], s50 offen lds
    v_dot2c_f32_bf16 v59, v208, v208
    v_dot2c_f32_bf16 v60, 0x3f803f80, v209
    v_dot2c_f32_bf16 v59, v209, v209
    v_mfma_f32_32x32x16_bf16 v[176:191], v[28:31], a[44:47], v[176:191]
    v_dot2c_f32_bf16 v60, 0x3f803f80, v210
    v_dot2c_f32_bf16 v59, v210, v210
    v_dot2c_f32_bf16 v60, 0x3f803f80, v211
    s_waitcnt lgkmcnt(4)
    v_mfma_f32_32x32x16_bf16 v[64:79], v[16:19], a[48:51], v[64:79]
    ds_read_b64_tr_b16 v[28:29], v12 offset:40960
    ds_read_b64_tr_b16 v[30:31], v12 offset:41984
    s_add_u32 m0, s48, 5120
    s_nop 0
    buffer_load_dwordx4 v2, s[4:7], s50 offen lds
    v_dot2c_f32_bf16 v59, v211, v211
    v_dot2c_f32_bf16 v60, 0x3f803f80, v212
    v_mfma_f32_32x32x16_bf16 v[80:95], v[16:19], a[52:55], v[80:95]
    v_dot2c_f32_bf16 v59, v212, v212
    v_dot2c_f32_bf16 v60, 0x3f803f80, v213
    v_dot2c_f32_bf16 v59, v213, v213
    s_waitcnt lgkmcnt(4)
    v_mfma_f32_32x32x16_bf16 v[96:111], v[20:23], a[48:51], v[96:111]
    v_add_u32 v8, 32768, v8
    ds_read_b128 a[56:59], v8 offset:0
    ds_read_b128 a[60:63], v8 offset:4096
    ds_read_b64_tr_b16 v[16:17], v9 offset:45056
    ds_read_b64_tr_b16 v[18:19], v9 offset:46080
    s_add_u32 s50, s50, 16384
    s_add_u32 m0, s48, 6144
    s_nop 0
    buffer_load_dwordx4 v1, s[4:7], s50 offen lds
    v_dot2c_f32_bf16 v60, 0x3f803f80, v214
    v_dot2c_f32_bf16 v59, v214, v214
    v_mfma_f32_32x32x16_bf16 v[112:127], v[20:23], a[52:55], v[112:127]
    v_dot2c_f32_bf16 v60, 0x3f803f80, v215
    v_dot2c_f32_bf16 v59, v215, v215
    v_dot2c_f32_bf16 v60, 0x3f803f80, v216
    s_waitcnt lgkmcnt(6)
    v_mfma_f32_32x32x16_bf16 v[128:143], v[24:27], a[48:51], v[128:143]
    ds_read_b64_tr_b16 v[20:21], v10 offset:45056
    ds_read_b64_tr_b16 v[22:23], v10 offset:46080
    s_add_u32 m0, s48, 7168
    s_nop 0
    buffer_load_dwordx4 v2, s[4:7], s50 offen lds
    v_dot2c_f32_bf16 v59, v216, v216
    v_dot2c_f32_bf16 v60, 0x3f803f80, v217
    v_mfma_f32_32x32x16_bf16 v[144:159], v[24:27], a[52:55], v[144:159]
    v_dot2c_f32_bf16 v59, v217, v217
    v_dot2c_f32_bf16 v60, 0x3f803f80, v218
    v_dot2c_f32_bf16 v59, v218, v218
    s_waitcnt lgkmcnt(6)
    v_mfma_f32_32x32x16_bf16 v[160:175], v[28:31], a[48:51], v[160:175]
    ds_read_b64_tr_b16 v[24:25], v11 offset:45056
    ds_read_b64_tr_b16 v[26:27], v11 offset:46080
    buffer_load_dword v63, v62, s[8:11], 0 offen offset:256
    v_dot2c_f32_bf16 v60, 0x3f803f80, v219
    v_dot2c_f32_bf16 v59, v219, v219
    v_mfma_f32_32x32x16_bf16 v[176:191], v[28:31], a[52:55], v[176:191]
    v_dot2c_f32_bf16 v60, 0x3f803f80, v220
    v_dot2c_f32_bf16 v59, v220, v220
    v_dot2c_f32_bf16 v60, 0x3f803f80, v221
    s_waitcnt lgkmcnt(4)
    v_mfma_f32_32x32x16_bf16 v[64:79], v[16:19], a[56:59], v[64:79]
    ds_read_b64_tr_b16 v[28:29], v12 offset:45056
    ds_read_b64_tr_b16 v[30:31], v12 offset:46080
    v_dot2c_f32_bf16 v59, v221, v221
    v_dot2c_f32_bf16 v60, 0x3f803f80, v222
    v_dot2c_f32_bf16 v59, v222, v222
    v_mfma_f32_32x32x16_bf16 v[80:95], v[16:19], a[60:63], v[80:95]
    v_dot2c_f32_bf16 v60, 0x3f803f80, v223
    v_dot2c_f32_bf16 v59, v223, v223
    s_waitcnt lgkmcnt(4)
    v_mfma_f32_32x32x16_bf16 v[96:111], v[20:23], a[56:59], v[96:111]
    s_waitcnt vmcnt(13)
    s_barrier
    v_add_u32 v5, 32768, v5
    ds_read_b128 a[64:67], v5 offset:0
    ds_read_b128 a[68:71], v5 offset:4096
    ds_read_b64_tr_b16 v[16:17], v9 offset:49152
    ds_read_b64_tr_b16 v[18:19], v9 offset:50176
    v_dot2c_f32_bf16 v60, 0x3f803f80, v224
    v_dot2c_f32_bf16 v59, v224, v224
    v_dot2c_f32_bf16 v60, 0x3f803f80, v225
    v_mfma_f32_32x32x16_bf16 v[112:127], v[20:23], a[60:63], v[112:127]
    v_dot2c_f32_bf16 v59, v225, v225
    v_dot2c_f32_bf16 v60, 0x3f803f80, v226
    s_waitcnt lgkmcnt(6)
    v_mfma_f32_32x32x16_bf16 v[128:143], v[24:27], a[56:59], v[128:143]
    ds_read_b64_tr_b16 v[20:21], v10 offset:49152
    ds_read_b64_tr_b16 v[22:23], v10 offset:50176
    v_dot2c_f32_bf16 v59, v226, v226
    v_dot2c_f32_bf16 v60, 0x3f803f80, v227
    v_dot2c_f32_bf16 v59, v227, v227
    v_mfma_f32_32x32x16_bf16 v[144:159], v[24:27], a[60:63], v[144:159]
    v_dot2c_f32_bf16 v60, 0x3f803f80, v228
    v_dot2c_f32_bf16 v59, v228, v228
    s_waitcnt lgkmcnt(6)
    v_mfma_f32_32x32x16_bf16 v[160:175], v[28:31], a[56:59], v[160:175]
    ds_read_b64_tr_b16 v[24:25], v11 offset:49152
    ds_read_b64_tr_b16 v[26:27], v11 offset:50176
    v_dot2c_f32_bf16 v60, 0x3f803f80, v229
    v_dot2c_f32_bf16 v59, v229, v229
    v_dot2c_f32_bf16 v60, 0x3f803f80, v230
    v_mfma_f32_32x32x16_bf16 v[176:191], v[28:31], a[60:63], v[176:191]
    v_dot2c_f32_bf16 v59, v230, v230
    v_dot2c_f32_bf16 v60, 0x3f803f80, v231
    v_dot2c_f32_bf16 v59, v231, v231
    s_waitcnt lgkmcnt(4)
    v_mfma_f32_32x32x16_bf16 v[64:79], v[16:19], a[64:67], v[64:79]
    ds_read_b64_tr_b16 v[28:29], v12 offset:49152
    ds_read_b64_tr_b16 v[30:31], v12 offset:50176
    s_add_u32 s52, s25, 4
    s_and_b32 s52, s52, 7
    s_lshl_b32 s52, s52, 19
    s_add_u32 m0, s47, 16384
    s_nop 0
    buffer_load_dwordx4 v3, s[8:11], s52 offen lds
    v_lshlrev_b32 v36, 16, v196
    v_and_b32 v37, 0xffff0000, v196
    v_mfma_f32_32x32x16_bf16 v[80:95], v[16:19], a[68:71], v[80:95]
    v_lshlrev_b32 v38, 16, v197
    v_and_b32 v39, 0xffff0000, v197
    v_lshlrev_b32 v40, 16, v198
    s_waitcnt lgkmcnt(4)
    v_mfma_f32_32x32x16_bf16 v[96:111], v[20:23], a[64:67], v[96:111]
    v_add_u32 v6, 32768, v6
    ds_read_b128 a[72:75], v6 offset:0
    ds_read_b128 a[76:79], v6 offset:4096
    ds_read_b64_tr_b16 v[16:17], v9 offset:53248
    ds_read_b64_tr_b16 v[18:19], v9 offset:54272
    s_add_u32 s52, s52, 32768
    s_add_u32 m0, s47, 17408
    s_nop 0
    buffer_load_dwordx4 v3, s[8:11], s52 offen lds
    v_and_b32 v41, 0xffff0000, v198
    v_add_f32_dpp v60, v60, v60 quad_perm:[1,0,3,2] row_mask:0xf bank_mask:0xf
    v_mfma_f32_32x32x16_bf16 v[112:127], v[20:23], a[68:71], v[112:127]
    v_add_f32_dpp v59, v59, v59 quad_perm:[1,0,3,2] row_mask:0xf bank_mask:0xf
    v_lshlrev_b32 v42, 16, v199
    v_and_b32 v43, 0xffff0000, v199
    s_waitcnt lgkmcnt(6)
    v_mfma_f32_32x32x16_bf16 v[128:143], v[24:27], a[64:67], v[128:143]
    ds_read_b64_tr_b16 v[20:21], v10 offset:53248
    ds_read_b64_tr_b16 v[22:23], v10 offset:54272
    s_add_u32 s52, s52, 32768
    s_add_u32 m0, s47, 18432
    s_nop 0
    buffer_load_dwordx4 v3, s[8:11], s52 offen lds
    v_lshlrev_b32 v44, 16, v200
    v_and_b32 v45, 0xffff0000, v200
    v_mfma_f32_32x32x16_bf16 v[144:159], v[24:27], a[68:71], v[144:159]
    v_add_f32_dpp v60, v60, v60 quad_perm:[2,3,0,1] row_mask:0xf bank_mask:0xf
    v_add_f32_dpp v59, v59, v59 quad_perm:[2,3,0,1] row_mask:0xf bank_mask:0xf
    v_lshlrev_b32 v46, 16, v201
    s_waitcnt lgkmcnt(6)
    v_mfma_f32_32x32x16_bf16 v[160:175], v[28:31], a[64:67], v[160:175]
    ds_read_b64_tr_b16 v[24:25], v11 offset:53248
    ds_read_b64_tr_b16 v[26:27], v11 offset:54272
    s_add_u32 s52, s52, 32768
    s_add_u32 m0, s47, 19456
    s_nop 0
    buffer_load_dwordx4 v3, s[8:11], s52 offen lds
    v_and_b32 v47, 0xffff0000, v201
    v_lshlrev_b32 v48, 16, v202
    v_mfma_f32_32x32x16_bf16 v[176:191], v[28:31], a[68:71], v[176:191]
    v_and_b32 v49, 0xffff0000, v202
    v_add_f32_dpp v60, v60, v60 row_half_mirror row_mask:0xf bank_mask:0xf
    v_add_f32_dpp v59, v59, v59 row_half_mirror row_mask:0xf bank_mask:0xf
    s_waitcnt lgkmcnt(4)
    v_mfma_f32_32x32x16_bf16 v[64:79], v[16:19], a[72:75], v[64:79]
    ds_read_b64_tr_b16 v[28:29], v12 offset:53248
    ds_read_b64_tr_b16 v[30:31], v12 offset:54272
    s_add_u32 s50, s25, 4
    s_and_b32 s50, s50, 7
    s_lshl_b32 s50, s50, 7
    s_add_u32 m0, s48, 32768
    s_nop 0
    buffer_load_dwordx4 v1, s[4:7], s50 offen lds
    v_lshlrev_b32 v50, 16, v203
    v_and_b32 v51, 0xffff0000, v203
    v_lshlrev_b32 v52, 16, v204
    v_mfma_f32_32x32x16_bf16 v[80:95], v[16:19], a[76:79], v[80:95]
    v_and_b32 v53, 0xffff0000, v204
    v_lshlrev_b32 v54, 16, v205
    s_waitcnt lgkmcnt(4)
    v_mfma_f32_32x32x16_bf16 v[96:111], v[20:23], a[72:75], v[96:111]
    v_add_u32 v7, 32768, v7
    ds_read_b128 a[80:83], v7 offset:0
    ds_read_b128 a[84:87], v7 offset:4096
    ds_read_b64_tr_b16 v[16:17], v9 offset:57344
    ds_read_b64_tr_b16 v[18:19], v9 offset:58368
    s_add_u32 m0, s48, 33792
    s_nop 0
    buffer_load_dwordx4 v2, s[4:7], s50 offen lds
    v_and_b32 v55, 0xffff0000, v205
    v_lshlrev_b32 v56, 16, v206
    v_and_b32 v57, 0xffff0000, v206
    v_mfma_f32_32x32x16_bf16 v[112:127], v[20:23], a[76:79], v[112:127]
    v_lshlrev_b32 v232, 16, v207
    v_and_b32 v233, 0xffff0000, v207
    s_waitcnt lgkmcnt(6)
    v_mfma_f32_32x32x16_bf16 v[128:143], v[24:27], a[72:75], v[128:143]
    ds_read_b64_tr_b16 v[20:21], v10 offset:57344
    ds_read_b64_tr_b16 v[22:23], v10 offset:58368
    s_add_u32 s50, s50, 16384
    s_add_u32 m0, s48, 34816
    s_nop 0
    buffer_load_dwordx4 v1, s[4:7], s50 offen lds
    v_mul_f32 v60, 0x3ae38e39, v60
    v_mul_f32 v59, 0x3ae38e39, v59
    buffer_store_dword v60, v35, s[20:23], s57 offen sc0 sc1
    v_mfma_f32_32x32x16_bf16 v[144:159], v[24:27], a[76:79], v[144:159]
    v_fma_f32 v59, -v60, v60, v59
    v_max_f32 v59, 0, v59
    s_waitcnt lgkmcnt(6)
    v_mfma_f32_32x32x16_bf16 v[160:175], v[28:31], a[72:75], v[160:175]
    ds_read_b64_tr_b16 v[24:25], v11 offset:57344
    ds_read_b64_tr_b16 v[26:27], v11 offset:58368
    s_add_u32 m0, s48, 35840
    s_nop 0
    buffer_load_dwordx4 v2, s[4:7], s50 offen lds
    v_cvt_pk_bf16_f32 v58, v60, v59
    v_and_b32 v59, 0xffff0000, v58
    v_lshlrev_b32 v58, 16, v58
    v_mfma_f32_32x32x16_bf16 v[176:191], v[28:31], a[76:79], v[176:191]
    v_add_f32 v59, 0x3727c5ac, v59
    v_cvt_pk_bf16_f32 v59, v59, v59
    s_waitcnt lgkmcnt(4)
    v_mfma_f32_32x32x16_bf16 v[64:79], v[16:19], a[80:83], v[64:79]
    ds_read_b64_tr_b16 v[28:29], v12 offset:57344
    ds_read_b64_tr_b16 v[30:31], v12 offset:58368
    s_add_u32 s50, s50, 16384
    s_add_u32 m0, s48, 36864
    s_nop 0
    buffer_load_dwordx4 v1, s[4:7], s50 offen lds
    v_and_b32 v59, 0xffff0000, v59
    v_sqrt_f32 v59, v59
    v_sub_f32 v36, v36, v58
    v_mfma_f32_32x32x16_bf16 v[80:95], v[16:19], a[84:87], v[80:95]
    v_sub_f32 v37, v37, v58
    v_sub_f32 v38, v38, v58
    v_sub_f32 v39, v39, v58
    s_waitcnt lgkmcnt(4)
    v_mfma_f32_32x32x16_bf16 v[96:111], v[20:23], a[80:83], v[96:111]
    v_add_u32 v8, 32768, v8
    ds_read_b128 a[88:91], v8 offset:0
    ds_read_b128 a[92:95], v8 offset:4096
    ds_read_b64_tr_b16 v[16:17], v9 offset:61440
    ds_read_b64_tr_b16 v[18:19], v9 offset:62464
    s_add_u32 m0, s48, 37888
    s_nop 0
    buffer_load_dwordx4 v2, s[4:7], s50 offen lds
    v_sub_f32 v40, v40, v58
    v_sub_f32 v41, v41, v58
    v_mfma_f32_32x32x16_bf16 v[112:127], v[20:23], a[84:87], v[112:127]
    v_sub_f32 v42, v42, v58
    v_sub_f32 v43, v43, v58
    v_sub_f32 v44, v44, v58
    s_waitcnt lgkmcnt(6)
    v_mfma_f32_32x32x16_bf16 v[128:143], v[24:27], a[80:83], v[128:143]
    ds_read_b64_tr_b16 v[20:21], v10 offset:61440
    ds_read_b64_tr_b16 v[22:23], v10 offset:62464
    s_add_u32 s50, s50, 16384
    s_add_u32 m0, s48, 38912
    s_nop 0
    buffer_load_dwordx4 v1, s[4:7], s50 offen lds
    v_sub_f32 v45, v45, v58
    v_sub_f32 v46, v46, v58
    v_mfma_f32_32x32x16_bf16 v[144:159], v[24:27], a[84:87], v[144:159]
    v_sub_f32 v47, v47, v58
    v_sub_f32 v48, v48, v58
    v_sub_f32 v49, v49, v58
    s_waitcnt lgkmcnt(6)
    v_mfma_f32_32x32x16_bf16 v[160:175], v[28:31], a[80:83], v[160:175]
    ds_read_b64_tr_b16 v[24:25], v11 offset:61440
    ds_read_b64_tr_b16 v[26:27], v11 offset:62464
    s_add_u32 m0, s48, 39936
    s_nop 0
    buffer_load_dwordx4 v2, s[4:7], s50 offen lds
    v_sub_f32 v50, v50, v58
    v_sub_f32 v51, v51, v58
    v_mfma_f32_32x32x16_bf16 v[176:191], v[28:31], a[84:87], v[176:191]
    v_sub_f32 v52, v52, v58
    v_sub_f32 v53, v53, v58
    v_sub_f32 v54, v54, v58
    s_waitcnt lgkmcnt(4)
    v_mfma_f32_32x32x16_bf16 v[64:79], v[16:19], a[88:91], v[64:79]
    ds_read_b64_tr_b16 v[28:29], v12 offset:61440
    ds_read_b64_tr_b16 v[30:31], v12 offset:62464
    v_sub_f32 v55, v55, v58
    v_sub_f32 v56, v56, v58
    v_sub_f32 v57, v57, v58
    v_mfma_f32_32x32x16_bf16 v[80:95], v[16:19], a[92:95], v[80:95]
    v_sub_f32 v232, v232, v58
    v_sub_f32 v233, v233, v58
    s_waitcnt lgkmcnt(4)
    v_mfma_f32_32x32x16_bf16 v[96:111], v[20:23], a[88:91], v[96:111]
    s_waitcnt vmcnt(14)
    s_barrier
    v_add_u32 v5, -65536, v5
    ds_read_b128 a[96:99], v5 offset:0
    ds_read_b128 a[100:103], v5 offset:4096
    ds_read_b64_tr_b16 v[16:17], v9 offset:0
    ds_read_b64_tr_b16 v[18:19], v9 offset:1024
    v_cvt_pk_bf16_f32 v59, v59, v59
    v_and_b32 v59, 0xffff0000, v59
    v_rcp_f32 v59, v59
    v_mfma_f32_32x32x16_bf16 v[112:127], v[20:23], a[92:95], v[112:127]
    v_cvt_pk_bf16_f32 v196, v36, v37
    v_cvt_pk_bf16_f32 v197, v38, v39
    s_waitcnt lgkmcnt(6)
    v_mfma_f32_32x32x16_bf16 v[128:143], v[24:27], a[88:91], v[128:143]
    ds_read_b64_tr_b16 v[20:21], v10 offset:0
    ds_read_b64_tr_b16 v[22:23], v10 offset:1024
    v_cvt_pk_bf16_f32 v198, v40, v41
    v_cvt_pk_bf16_f32 v199, v42, v43
    v_cvt_pk_bf16_f32 v200, v44, v45
    v_mfma_f32_32x32x16_bf16 v[144:159], v[24:27], a[92:95], v[144:159]
    v_cvt_pk_bf16_f32 v201, v46, v47
    v_cvt_pk_bf16_f32 v202, v48, v49
    s_waitcnt lgkmcnt(6)
    v_mfma_f32_32x32x16_bf16 v[160:175], v[28:31], a[88:91], v[160:175]
    ds_read_b64_tr_b16 v[24:25], v11 offset:0
    ds_read_b64_tr_b16 v[26:27], v11 offset:1024
    v_cvt_pk_bf16_f32 v203, v50, v51
    v_cvt_pk_bf16_f32 v204, v52, v53
    v_cvt_pk_bf16_f32 v205, v54, v55
    v_mfma_f32_32x32x16_bf16 v[176:191], v[28:31], a[92:95], v[176:191]
    v_cvt_pk_bf16_f32 v206, v56, v57
    v_cvt_pk_bf16_f32 v207, v232, v233
    s_waitcnt lgkmcnt(4)
    v_mfma_f32_32x32x16_bf16 v[64:79], v[16:19], a[96:99], v[64:79]
    ds_read_b64_tr_b16 v[28:29], v12 offset:0
    ds_read_b64_tr_b16 v[30:31], v12 offset:1024
    s_add_u32 s52, s25, 5
    s_and_b32 s52, s52, 7
    s_lshl_b32 s52, s52, 19
    s_add_u32 m0, s47, 32768
    s_nop 0
    buffer_load_dwordx4 v3, s[8:11], s52 offen lds
    v_lshlrev_b32 v36, 16, v196
    v_and_b32 v37, 0xffff0000, v196
    v_lshlrev_b32 v38, 16, v197
    v_mfma_f32_32x32x16_bf16 v[80:95], v[16:19], a[100:103], v[80:95]
    v_and_b32 v39, 0xffff0000, v197
    v_lshlrev_b32 v40, 16, v198
    v_and_b32 v41, 0xffff0000, v198
    s_waitcnt lgkmcnt(4)
    v_mfma_f32_32x32x16_bf16 v[96:111], v[20:23], a[96:99], v[96:111]
    v_add_u32 v6, -65536, v6
    ds_read_b128 a[104:107], v6 offset:0
    ds_read_b128 a[108:111], v6 offset:4096
    ds_read_b64_tr_b16 v[16:17], v9 offset:4096
    ds_read_b64_tr_b16 v[18:19], v9 offset:5120
    s_add_u32 s52, s52, 32768
    s_add_u32 m0, s47, 33792
    s_nop 0
    buffer_load_dwordx4 v3, s[8:11], s52 offen lds
    v_lshlrev_b32 v42, 16, v199
    v_and_b32 v43, 0xffff0000, v199
    v_mfma_f32_32x32x16_bf16 v[112:127], v[20:23], a[100:103], v[112:127]
    v_lshlrev_b32 v44, 16, v200
    v_and_b32 v45, 0xffff0000, v200
    v_lshlrev_b32 v46, 16, v201
    s_waitcnt lgkmcnt(6)
    v_mfma_f32_32x32x16_bf16 v[128:143], v[24:27], a[96:99], v[128:143]
    ds_read_b64_tr_b16 v[20:21], v10 offset:4096
    ds_read_b64_tr_b16 v[22:23], v10 offset:5120
    s_add_u32 s52, s52, 32768
    s_add_u32 m0, s47, 34816
    s_nop 0
    buffer_load_dwordx4 v3, s[8:11], s52 offen lds
    v_and_b32 v47, 0xffff0000, v201
    v_lshlrev_b32 v48, 16, v202
    v_mfma_f32_32x32x16_bf16 v[144:159], v[24:27], a[100:103], v[144:159]
    v_and_b32 v49, 0xffff0000, v202
    v_lshlrev_b32 v50, 16, v203
    v_and_b32 v51, 0xffff0000, v203
    s_waitcnt lgkmcnt(6)
    v_mfma_f32_32x32x16_bf16 v[160:175], v[28:31], a[96:99], v[160:175]
    ds_read_b64_tr_b16 v[24:25], v11 offset:4096
    ds_read_b64_tr_b16 v[26:27], v11 offset:5120
    s_add_u32 s52, s52, 32768
    s_add_u32 m0, s47, 35840
    s_nop 0
    buffer_load_dwordx4 v3, s[8:11], s52 offen lds
    v_lshlrev_b32 v52, 16, v204
    v_and_b32 v53, 0xffff0000, v204
    v_mfma_f32_32x32x16_bf16 v[176:191], v[28:31], a[100:103], v[176:191]
    v_lshlrev_b32 v54, 16, v205
    v_and_b32 v55, 0xffff0000, v205
    v_lshlrev_b32 v56, 16, v206
    s_waitcnt lgkmcnt(4)
    v_mfma_f32_32x32x16_bf16 v[64:79], v[16:19], a[104:107], v[64:79]
    ds_read_b64_tr_b16 v[28:29], v12 offset:4096
    ds_read_b64_tr_b16 v[30:31], v12 offset:5120
    s_add_u32 s50, s25, 5
    s_and_b32 s50, s50, 7
    s_lshl_b32 s50, s50, 7
    s_add_u32 m0, s48, 65536
    s_nop 0
    buffer_load_dwordx4 v1, s[4:7], s50 offen lds
    v_and_b32 v57, 0xffff0000, v206
    v_lshlrev_b32 v232, 16, v207
    v_mfma_f32_32x32x16_bf16 v[80:95], v[16:19], a[108:111], v[80:95]
    v_and_b32 v233, 0xffff0000, v207
    v_mul_f32 v36, v36, v59
    v_mul_f32 v37, v37, v59
    s_waitcnt lgkmcnt(4)
    v_mfma_f32_32x32x16_bf16 v[96:111], v[20:23], a[104:107], v[96:111]
    v_add_u32 v7, -65536, v7
    ds_read_b128 a[112:115], v7 offset:0
    ds_read_b128 a[116:119], v7 offset:4096
    ds_read_b64_tr_b16 v[16:17], v9 offset:8192
    ds_read_b64_tr_b16 v[18:19], v9 offset:9216
    s_add_u32 m0, s48, 66560
    s_nop 0
    buffer_load_dwordx4 v2, s[4:7], s50 offen lds
    v_mul_f32 v38, v38, v59
    v_mul_f32 v39, v39, v59
    v_cvt_pk_bf16_f32 v196, v36, v37
    v_mfma_f32_32x32x16_bf16 v[112:127], v[20:23], a[108:111], v[112:127]
    v_mul_f32 v40, v40, v59
    v_mul_f32 v41, v41, v59
    s_waitcnt lgkmcnt(6)
    v_mfma_f32_32x32x16_bf16 v[128:143], v[24:27], a[104:107], v[128:143]
    ds_read_b64_tr_b16 v[20:21], v10 offset:8192
    ds_read_b64_tr_b16 v[22:23], v10 offset:9216
    s_add_u32 s50, s50, 16384
    s_add_u32 m0, s48, 67584
    s_nop 0
    buffer_load_dwordx4 v1, s[4:7], s50 offen lds
    v_cvt_pk_bf16_f32 v197, v38, v39
    ds_bpermute_b32 v208, v34, v196
    v_mul_f32 v42, v42, v59
    v_mfma_f32_32x32x16_bf16 v[144:159], v[24:27], a[108:111], v[144:159]
    v_mul_f32 v43, v43, v59
    v_cvt_pk_bf16_f32 v198, v40, v41
    s_waitcnt lgkmcnt(7)
    v_mfma_f32_32x32x16_bf16 v[160:175], v[28:31], a[104:107], v[160:175]
    ds_read_b64_tr_b16 v[24:25], v11 offset:8192
    ds_read_b64_tr_b16 v[26:27], v11 offset:9216
    s_add_u32 m0, s48, 68608
    s_nop 0
    buffer_load_dwordx4 v2, s[4:7], s50 offen lds
    ds_bpermute_b32 v209, v34, v197
    v_mul_f32 v44, v44, v59
    v_mul_f32 v45, v45, v59
    v_mfma_f32_32x32x16_bf16 v[176:191], v[28:31], a[108:111], v[176:191]
    v_cvt_pk_bf16_f32 v199, v42, v43
    ds_bpermute_b32 v210, v34, v198
    s_waitcnt lgkmcnt(7)
    v_mfma_f32_32x32x16_bf16 v[64:79], v[16:19], a[112:115], v[64:79]
    ds_read_b64_tr_b16 v[28:29], v12 offset:8192
    ds_read_b64_tr_b16 v[30:31], v12 offset:9216
    s_add_u32 s50, s50, 16384
    s_add_u32 m0, s48, 69632
    s_nop 0
    buffer_load_dwordx4 v1, s[4:7], s50 offen lds
    v_mul_f32 v46, v46, v59
    v_mul_f32 v47, v47, v59
    v_cvt_pk_bf16_f32 v200, v44, v45
    v_mfma_f32_32x32x16_bf16 v[80:95], v[16:19], a[116:119], v[80:95]
    ds_bpermute_b32 v211, v34, v199
    v_mul_f32 v48, v48, v59
    v_mul_f32 v49, v49, v59
    s_waitcnt lgkmcnt(8)
    v_mfma_f32_32x32x16_bf16 v[96:111], v[20:23], a[112:115], v[96:111]
    v_add_u32 v8, -65536, v8
    ds_read_b128 a[120:123], v8 offset:0
    ds_read_b128 a[124:127], v8 offset:4096
    ds_read_b64_tr_b16 v[16:17], v9 offset:12288
    ds_read_b64_tr_b16 v[18:19], v9 offset:13312
    s_add_u32 m0, s48, 70656
    s_nop 0
    buffer_load_dwordx4 v2, s[4:7], s50 offen lds
    v_cvt_pk_bf16_f32 v201, v46, v47
    ds_bpermute_b32 v212, v34, v200
    v_mfma_f32_32x32x16_bf16 v[112:127], v[20:23], a[116:119], v[112:127]
    v_mul_f32 v50, v50, v59
    v_mul_f32 v51, v51, v59
    v_cvt_pk_bf16_f32 v202, v48, v49
    s_waitcnt lgkmcnt(10)
    v_mfma_f32_32x32x16_bf16 v[128:143], v[24:27], a[112:115], v[128:143]
    ds_read_b64_tr_b16 v[20:21], v10 offset:12288
    ds_read_b64_tr_b16 v[22:23], v10 offset:13312
    s_add_u32 s50, s50, 16384
    s_add_u32 m0, s48, 71680
    s_nop 0
    buffer_load_dwordx4 v1, s[4:7], s50 offen lds
    ds_bpermute_b32 v213, v34, v201
    v_mul_f32 v52, v52, v59
    v_mfma_f32_32x32x16_bf16 v[144:159], v[24:27], a[116:119], v[144:159]
    v_mul_f32 v53, v53, v59
    v_cvt_pk_bf16_f32 v203, v50, v51
    ds_bpermute_b32 v214, v34, v202
    s_waitcnt lgkmcnt(10)
    v_mfma_f32_32x32x16_bf16 v[160:175], v[28:31], a[112:115], v[160:175]
    ds_read_b64_tr_b16 v[24:25], v11 offset:12288
    ds_read_b64_tr_b16 v[26:27], v11 offset:13312
    s_add_u32 m0, s48, 72704
    s_nop 0
    buffer_load_dwordx4 v2, s[4:7], s50 offen lds
    v_mul_f32 v54, v54, v59
    v_mul_f32 v55, v55, v59
    v_mfma_f32_32x32x16_bf16 v[176:191], v[28:31], a[116:119], v[176:191]
    v_cvt_pk_bf16_f32 v204, v52, v53
    ds_bpermute_b32 v215, v34, v203
    v_mul_f32 v56, v56, v59
    s_waitcnt lgkmcnt(8)
    v_mfma_f32_32x32x16_bf16 v[64:79], v[16:19], a[120:123], v[64:79]
    ds_read_b64_tr_b16 v[28:29], v12 offset:12288
    ds_read_b64_tr_b16 v[30:31], v12 offset:13312
    v_mul_f32 v57, v57, v59
    v_cvt_pk_bf16_f32 v205, v54, v55
    v_mfma_f32_32x32x16_bf16 v[80:95], v[16:19], a[124:127], v[80:95]
    ds_bpermute_b32 v216, v34, v204
    v_mul_f32 v232, v232, v59
    v_mul_f32 v233, v233, v59
    s_waitcnt lgkmcnt(8)
    v_mfma_f32_32x32x16_bf16 v[96:111], v[20:23], a[120:123], v[96:111]
    s_waitcnt vmcnt(12)
    s_barrier
    v_add_u32 v5, 32768, v5
    ds_read_b128 a[128:131], v5 offset:0
    ds_read_b128 a[132:135], v5 offset:4096
    ds_read_b64_tr_b16 v[16:17], v9 offset:16384
    ds_read_b64_tr_b16 v[18:19], v9 offset:17408
    v_cvt_pk_bf16_f32 v206, v56, v57
    ds_bpermute_b32 v217, v34, v205
    v_cvt_pk_bf16_f32 v207, v232, v233
    v_mfma_f32_32x32x16_bf16 v[112:127], v[20:23], a[124:127], v[112:127]
    v_mov_b32 v36, 0
    v_mov_b32 v38, -1
    s_waitcnt lgkmcnt(9)
    v_mfma_f32_32x32x16_bf16 v[128:143], v[24:27], a[120:123], v[128:143]
    ds_read_b64_tr_b16 v[20:21], v10 offset:16384
    ds_read_b64_tr_b16 v[22:23], v10 offset:17408
    v_mov_b32 v39, -1
    v_lshlrev_b32 v37, 1, v35
    ds_bpermute_b32 v218, v34, v206
    v_mfma_f32_32x32x16_bf16 v[144:159], v[24:27], a[124:127], v[144:159]
    ds_bpermute_b32 v219, v34, v207
    s_waitcnt lgkmcnt(10)
    v_mfma_f32_32x32x16_bf16 v[160:175], v[28:31], a[120:123], v[160:175]
    ds_read_b64_tr_b16 v[24:25], v11 offset:16384
    ds_read_b64_tr_b16 v[26:27], v11 offset:17408
    v_mfma_f32_32x32x16_bf16 v[176:191], v[28:31], a[124:127], v[176:191]
    s_waitcnt lgkmcnt(7)
    v_mfma_f32_32x32x16_bf16 v[64:79], v[16:19], a[128:131], v[64:79]
    ds_read_b64_tr_b16 v[28:29], v12 offset:16384
    ds_read_b64_tr_b16 v[30:31], v12 offset:17408
    s_add_u32 s52, s25, 6
    s_and_b32 s52, s52, 7
    s_lshl_b32 s52, s52, 19
    s_add_u32 m0, s47, 49152
    s_nop 0
    buffer_load_dwordx4 v3, s[8:11], s52 offen lds
    s_waitcnt lgkmcnt(4)
    buffer_store_dwordx4 v[208:211], v33, s[20:23], s43 offen offset:0 sc0 sc1
    buffer_store_dwordx4 v[212:215], v33, s[20:23], s43 offen offset:2048 sc0 sc1
    buffer_store_dwordx4 v[216:219], v33, s[20:23], s42 offen offset:0 sc0 sc1
    v_mfma_f32_32x32x16_bf16 v[80:95], v[16:19], a[132:135], v[80:95]
    buffer_store_dword v36, v35, s[20:23], s58 offen sc0 sc1
    buffer_store_dwordx2 v[38:39], v37, s[20:23], s59 offen sc0 sc1
    v_mfma_f32_32x32x16_bf16 v[96:111], v[20:23], a[128:131], v[96:111]
    v_add_u32 v6, 32768, v6
    ds_read_b128 a[136:139], v6 offset:0
    ds_read_b128 a[140:143], v6 offset:4096
    ds_read_b64_tr_b16 v[16:17], v9 offset:20480
    ds_read_b64_tr_b16 v[18:19], v9 offset:21504
    s_add_u32 s52, s52, 32768
    s_add_u32 m0, s47, 50176
    s_nop 0
    buffer_load_dwordx4 v3, s[8:11], s52 offen lds
    v_lshl_add_u32 v54, v0, 20, s34
    v_mfma_f32_32x32x16_bf16 v[112:127], v[20:23], a[132:135], v[112:127]
    v_mov_b32 v55, 1
    s_waitcnt lgkmcnt(6)
    v_mfma_f32_32x32x16_bf16 v[128:143], v[24:27], a[128:131], v[128:143]
    ds_read_b64_tr_b16 v[20:21], v10 offset:20480
    ds_read_b64_tr_b16 v[22:23], v10 offset:21504
    s_add_u32 s52, s52, 32768
    s_add_u32 m0, s47, 51200
    s_nop 0
    buffer_load_dwordx4 v3, s[8:11], s52 offen lds
    s_add_u32 s42, s41, 0
    s_sub_u32 s60, s42, 512
    s_cmp_lt_u32 s42, 512
    s_cselect_b32 s68, s64, s66
    s_cselect_b32 s69, s65, s67
    s_cselect_b32 s60, s42, s60
    s_cselect_b32 s61, 0, 0x100000
    s_cselect_b32 s62, 8, 9
    v_mfma_f32_32x32x16_bf16 v[144:159], v[24:27], a[132:135], v[144:159]
    s_lshl_b32 s62, s62, 4
    s_mul_i32 s70, s62, 36864
    s_waitcnt lgkmcnt(6)
    v_mfma_f32_32x32x16_bf16 v[160:175], v[28:31], a[128:131], v[160:175]
    ds_read_b64_tr_b16 v[24:25], v11 offset:20480
    ds_read_b64_tr_b16 v[26:27], v11 offset:21504
    s_add_u32 s52, s52, 32768
    s_add_u32 m0, s47, 52224
    s_nop 0
    buffer_load_dwordx4 v3, s[8:11], s52 offen lds
    s_mov_b32 s71, 0x00020000
    s_lshl_b32 s63, s60, 8
    v_mfma_f32_32x32x16_bf16 v[176:191], v[28:31], a[132:135], v[176:191]
    s_add_u32 s61, s61, s63
    s_add_u32 s54, s61, 37748736
    s_waitcnt lgkmcnt(4)
    v_mfma_f32_32x32x16_bf16 v[64:79], v[16:19], a[136:139], v[64:79]
    ds_read_b64_tr_b16 v[28:29], v12 offset:20480
    ds_read_b64_tr_b16 v[30:31], v12 offset:21504
    s_add_u32 s50, s25, 6
    s_and_b32 s50, s50, 7
    s_lshl_b32 s50, s50, 7
    s_add_u32 m0, s48, 0
    s_nop 0
    buffer_load_dwordx4 v1, s[4:7], s50 offen lds
    s_mul_i32 s55, s60, 9216
    v_mfma_f32_32x32x16_bf16 v[80:95], v[16:19], a[140:143], v[80:95]
    s_lshl_b32 s62, s62, 10
    s_cmp_lt_u32 s42, 1088
    s_cselect_b32 s61, 0, 0x7f000000
    s_waitcnt lgkmcnt(4)
    v_mfma_f32_32x32x16_bf16 v[96:111], v[20:23], a[136:139], v[96:111]
    v_add_u32 v7, 32768, v7
    ds_read_b128 a[144:147], v7 offset:0
    ds_read_b128 a[148:151], v7 offset:4096
    ds_read_b64_tr_b16 v[16:17], v9 offset:24576
    ds_read_b64_tr_b16 v[18:19], v9 offset:25600
    s_add_u32 m0, s48, 1024
    s_nop 0
    buffer_load_dwordx4 v2, s[4:7], s50 offen lds
    v_lshrrev_b32 v50, 3, v0
    v_and_b32 v51, 7, v0
    v_mfma_f32_32x32x16_bf16 v[112:127], v[20:23], a[140:143], v[112:127]
    v_lshlrev_b32 v51, 4, v51
    v_mul_u32_u24 v40, 1152, v50
    s_waitcnt lgkmcnt(6)
    v_mfma_f32_32x32x16_bf16 v[128:143], v[24:27], a[136:139], v[128:143]
    ds_read_b64_tr_b16 v[20:21], v10 offset:24576
    ds_read_b64_tr_b16 v[22:23], v10 offset:25600
    s_add_u32 s50, s50, 16384
    s_add_u32 m0, s48, 2048
    s_nop 0
    buffer_load_dwordx4 v1, s[4:7], s50 offen lds
    v_add3_u32 v40, v40, v51, s61
    buffer_load_dwordx4 v[44:47], v40, s[68:71], s55 offen offset:1024
    v_mfma_f32_32x32x16_bf16 v[144:159], v[24:27], a[140:143], v[144:159]
    v_bfe_u32 v52, v0, 1, 2
    s_waitcnt lgkmcnt(6)
    v_mfma_f32_32x32x16_bf16 v[160:175], v[28:31], a[136:139], v[160:175]
    ds_read_b64_tr_b16 v[24:25], v11 offset:24576
    ds_read_b64_tr_b16 v[26:27], v11 offset:25600
    s_add_u32 m0, s48, 3072
    s_nop 0
    buffer_load_dwordx4 v2, s[4:7], s50 offen lds
    v_mul_lo_u32 v52, v52, s62
    v_lshl_add_u32 v52, v50, 5, v52
    v_mfma_f32_32x32x16_bf16 v[176:191], v[28:31], a[140:143], v[176:191]
    v_and_b32 v53, 16, v51
    v_add3_u32 v41, v52, v53, s61
    s_waitcnt lgkmcnt(4)
    v_mfma_f32_32x32x16_bf16 v[64:79], v[16:19], a[144:147], v[64:79]
    ds_read_b64_tr_b16 v[28:29], v12 offset:24576
    ds_read_b64_tr_b16 v[30:31], v12 offset:25600
    s_add_u32 s50, s50, 16384
    s_add_u32 m0, s48, 4096
    s_nop 0
    buffer_load_dwordx4 v1, s[4:7], s50 offen lds
    s_and_b32 s58, s42, 15
    s_lshl_b32 s58, s58, 8
    v_mfma_f32_32x32x16_bf16 v[80:95], v[16:19], a[148:151], v[80:95]
    s_bfe_u32 s56, s42, 0x30006
    s_lshl_b32 s56, s56, 12
    s_waitcnt lgkmcnt(4)
    v_mfma_f32_32x32x16_bf16 v[96:111], v[20:23], a[144:147], v[96:111]
    v_add_u32 v8, 32768, v8
    ds_read_b128 a[152:155], v8 offset:0
    ds_read_b128 a[156:159], v8 offset:4096
    ds_read_b64_tr_b16 v[16:17], v9 offset:28672
    ds_read_b64_tr_b16 v[18:19], v9 offset:29696
    s_add_u32 m0, s48, 5120
    s_nop 0
    buffer_load_dwordx4 v2, s[4:7], s50 offen lds
    s_add_u32 s58, s58, s56
    v_mfma_f32_32x32x16_bf16 v[112:127], v[20:23], a[148:151], v[112:127]
    s_bfe_u32 s56, s42, 0x20004
    s_lshl_b32 s56, s56, 3
    s_waitcnt lgkmcnt(6)
    v_mfma_f32_32x32x16_bf16 v[128:143], v[24:27], a[144:147], v[128:143]
    ds_read_b64_tr_b16 v[20:21], v10 offset:28672
    ds_read_b64_tr_b16 v[22:23], v10 offset:29696
    s_add_u32 s50, s50, 16384
    s_add_u32 m0, s48, 6144
    s_nop 0
    buffer_load_dwordx4 v1, s[4:7], s50 offen lds
    s_add_u32 s58, s58, s56
    s_add_u32 s58, s58, 36962304
    v_mfma_f32_32x32x16_bf16 v[144:159], v[24:27], a[148:151], v[144:159]
    s_cmp_lt_u32 s42, 512
    s_cselect_b32 s61, 0, 0x40000000
    v_lshlrev_b32 v42, 22, v51
    s_waitcnt lgkmcnt(6)
    v_mfma_f32_32x32x16_bf16 v[160:175], v[28:31], a[144:147], v[160:175]
    ds_read_b64_tr_b16 v[24:25], v11 offset:28672
    ds_read_b64_tr_b16 v[26:27], v11 offset:29696
    s_add_u32 m0, s48, 7168
    s_nop 0
    buffer_load_dwordx4 v2, s[4:7], s50 offen lds
    v_lshl_add_u32 v42, v50, 5, v42
    v_add_u32 v42, s61, v42
    v_mfma_f32_32x32x16_bf16 v[176:191], v[28:31], a[148:151], v[176:191]
    v_mov_b32 v48, 0
    s_waitcnt lgkmcnt(4)
    v_mfma_f32_32x32x16_bf16 v[64:79], v[16:19], a[152:155], v[64:79]
    ds_read_b64_tr_b16 v[28:29], v12 offset:28672
    ds_read_b64_tr_b16 v[30:31], v12 offset:29696
    v_mfma_f32_32x32x16_bf16 v[80:95], v[16:19], a[156:159], v[80:95]
    s_waitcnt lgkmcnt(4)
    v_mfma_f32_32x32x16_bf16 v[96:111], v[20:23], a[152:155], v[96:111]
    s_waitcnt vmcnt(18)
    s_barrier
    v_add_u32 v5, 32768, v5
    ds_read_b128 a[160:163], v5 offset:0
    ds_read_b128 a[164:167], v5 offset:4096
    ds_read_b64_tr_b16 v[16:17], v9 offset:32768
    ds_read_b64_tr_b16 v[18:19], v9 offset:33792
    v_mfma_f32_32x32x16_bf16 v[112:127], v[20:23], a[156:159], v[112:127]
    s_waitcnt lgkmcnt(6)
    v_mfma_f32_32x32x16_bf16 v[128:143], v[24:27], a[152:155], v[128:143]
    ds_read_b64_tr_b16 v[20:21], v10 offset:32768
    ds_read_b64_tr_b16 v[22:23], v10 offset:33792
    v_mfma_f32_32x32x16_bf16 v[144:159], v[24:27], a[156:159], v[144:159]
    s_waitcnt lgkmcnt(6)
    v_mfma_f32_32x32x16_bf16 v[160:175], v[28:31], a[152:155], v[160:175]
    ds_read_b64_tr_b16 v[24:25], v11 offset:32768
    ds_read_b64_tr_b16 v[26:27], v11 offset:33792
    v_mfma_f32_32x32x16_bf16 v[176:191], v[28:31], a[156:159], v[176:191]
    s_waitcnt lgkmcnt(4)
    v_mfma_f32_32x32x16_bf16 v[64:79], v[16:19], a[160:163], v[64:79]
    ds_read_b64_tr_b16 v[28:29], v12 offset:32768
    ds_read_b64_tr_b16 v[30:31], v12 offset:33792
    s_add_u32 s52, s25, 7
    s_and_b32 s52, s52, 7
    s_lshl_b32 s52, s52, 19
    s_add_u32 m0, s47, 0
    s_nop 0
    buffer_load_dwordx4 v3, s[8:11], s52 offen lds
    v_mfma_f32_32x32x16_bf16 v[80:95], v[16:19], a[164:167], v[80:95]
    s_waitcnt lgkmcnt(4)
    v_mfma_f32_32x32x16_bf16 v[96:111], v[20:23], a[160:163], v[96:111]
    v_add_u32 v6, 32768, v6
    ds_read_b128 a[168:171], v6 offset:0
    ds_read_b128 a[172:175], v6 offset:4096
    ds_read_b64_tr_b16 v[16:17], v9 offset:36864
    ds_read_b64_tr_b16 v[18:19], v9 offset:37888
    s_add_u32 s52, s52, 32768
    s_add_u32 m0, s47, 1024
    s_nop 0
    buffer_load_dwordx4 v3, s[8:11], s52 offen lds
    v_mfma_f32_32x32x16_bf16 v[112:127], v[20:23], a[164:167], v[112:127]
    s_waitcnt lgkmcnt(6)
    v_mfma_f32_32x32x16_bf16 v[128:143], v[24:27], a[160:163], v[128:143]
    ds_read_b64_tr_b16 v[20:21], v10 offset:36864
    ds_read_b64_tr_b16 v[22:23], v10 offset:37888
    s_add_u32 s52, s52, 32768
    s_add_u32 m0, s47, 2048
    s_nop 0
    buffer_load_dwordx4 v3, s[8:11], s52 offen lds
    v_mfma_f32_32x32x16_bf16 v[144:159], v[24:27], a[164:167], v[144:159]
    s_waitcnt lgkmcnt(6)
    v_mfma_f32_32x32x16_bf16 v[160:175], v[28:31], a[160:163], v[160:175]
    ds_read_b64_tr_b16 v[24:25], v11 offset:36864
    ds_read_b64_tr_b16 v[26:27], v11 offset:37888
    s_add_u32 s52, s52, 32768
    s_add_u32 m0, s47, 3072
    s_nop 0
    buffer_load_dwordx4 v3, s[8:11], s52 offen lds
    v_mfma_f32_32x32x16_bf16 v[176:191], v[28:31], a[164:167], v[176:191]
    s_waitcnt lgkmcnt(4)
    v_mfma_f32_32x32x16_bf16 v[64:79], v[16:19], a[168:171], v[64:79]
    ds_read_b64_tr_b16 v[28:29], v12 offset:36864
    ds_read_b64_tr_b16 v[30:31], v12 offset:37888
    s_add_u32 s50, s25, 7
    s_and_b32 s50, s50, 7
    s_lshl_b32 s50, s50, 7
    s_add_u32 m0, s48, 32768
    s_nop 0
    buffer_load_dwordx4 v1, s[4:7], s50 offen lds
    v_mfma_f32_32x32x16_bf16 v[80:95], v[16:19], a[172:175], v[80:95]
    s_waitcnt lgkmcnt(4)
    v_mfma_f32_32x32x16_bf16 v[96:111], v[20:23], a[168:171], v[96:111]
    v_add_u32 v7, 32768, v7
    ds_read_b128 a[176:179], v7 offset:0
    ds_read_b128 a[180:183], v7 offset:4096
    ds_read_b64_tr_b16 v[16:17], v9 offset:40960
    ds_read_b64_tr_b16 v[18:19], v9 offset:41984
    s_add_u32 m0, s48, 33792
    s_nop 0
    buffer_load_dwordx4 v2, s[4:7], s50 offen lds
    v_mfma_f32_32x32x16_bf16 v[112:127], v[20:23], a[172:175], v[112:127]
    s_waitcnt lgkmcnt(6)
    v_mfma_f32_32x32x16_bf16 v[128:143], v[24:27], a[168:171], v[128:143]
    ds_read_b64_tr_b16 v[20:21], v10 offset:40960
    ds_read_b64_tr_b16 v[22:23], v10 offset:41984
    s_add_u32 s50, s50, 16384
    s_add_u32 m0, s48, 34816
    s_nop 0
    buffer_load_dwordx4 v1, s[4:7], s50 offen lds
    v_mfma_f32_32x32x16_bf16 v[144:159], v[24:27], a[172:175], v[144:159]
    s_waitcnt lgkmcnt(6)
    v_mfma_f32_32x32x16_bf16 v[160:175], v[28:31], a[168:171], v[160:175]
    ds_read_b64_tr_b16 v[24:25], v11 offset:40960
    ds_read_b64_tr_b16 v[26:27], v11 offset:41984
    s_add_u32 m0, s48, 35840
    s_nop 0
    buffer_load_dwordx4 v2, s[4:7], s50 offen lds
    v_mfma_f32_32x32x16_bf16 v[176:191], v[28:31], a[172:175], v[176:191]
    s_waitcnt lgkmcnt(4)
    v_mfma_f32_32x32x16_bf16 v[64:79], v[16:19], a[176:179], v[64:79]
    ds_read_b64_tr_b16 v[28:29], v12 offset:40960
    ds_read_b64_tr_b16 v[30:31], v12 offset:41984
    s_add_u32 s50, s50, 16384
    s_add_u32 m0, s48, 36864
    s_nop 0
    buffer_load_dwordx4 v1, s[4:7], s50 offen lds
    v_mfma_f32_32x32x16_bf16 v[80:95], v[16:19], a[180:183], v[80:95]
    s_waitcnt lgkmcnt(4)
    v_mfma_f32_32x32x16_bf16 v[96:111], v[20:23], a[176:179], v[96:111]
    v_add_u32 v8, 32768, v8
    ds_read_b128 a[184:187], v8 offset:0
    ds_read_b128 a[188:191], v8 offset:4096
    ds_read_b64_tr_b16 v[16:17], v9 offset:45056
    ds_read_b64_tr_b16 v[18:19], v9 offset:46080
    s_add_u32 m0, s48, 37888
    s_nop 0
    buffer_load_dwordx4 v2, s[4:7], s50 offen lds
    v_mfma_f32_32x32x16_bf16 v[112:127], v[20:23], a[180:183], v[112:127]
    s_waitcnt lgkmcnt(6)
    v_mfma_f32_32x32x16_bf16 v[128:143], v[24:27], a[176:179], v[128:143]
    ds_read_b64_tr_b16 v[20:21], v10 offset:45056
    ds_read_b64_tr_b16 v[22:23], v10 offset:46080
    s_add_u32 s50, s50, 16384
    s_add_u32 m0, s48, 38912
    s_nop 0
    buffer_load_dwordx4 v1, s[4:7], s50 offen lds
    v_mfma_f32_32x32x16_bf16 v[144:159], v[24:27], a[180:183], v[144:159]
    s_waitcnt lgkmcnt(6)
    v_mfma_f32_32x32x16_bf16 v[160:175], v[28:31], a[176:179], v[160:175]
    ds_read_b64_tr_b16 v[24:25], v11 offset:45056
    ds_read_b64_tr_b16 v[26:27], v11 offset:46080
    s_add_u32 m0, s48, 39936
    s_nop 0
    buffer_load_dwordx4 v2, s[4:7], s50 offen lds
    v_mfma_f32_32x32x16_bf16 v[176:191], v[28:31], a[180:183], v[176:191]
    s_waitcnt lgkmcnt(4)
    v_mfma_f32_32x32x16_bf16 v[64:79], v[16:19], a[184:187], v[64:79]
    ds_read_b64_tr_b16 v[28:29], v12 offset:45056
    ds_read_b64_tr_b16 v[30:31], v12 offset:46080
    v_mfma_f32_32x32x16_bf16 v[80:95], v[16:19], a[188:191], v[80:95]
    s_waitcnt lgkmcnt(4)
    v_mfma_f32_32x32x16_bf16 v[96:111], v[20:23], a[184:187], v[96:111]
    s_waitcnt vmcnt(12)
    s_barrier
    buffer_store_byte v55, v54, s[92:95], 0 offen sc0 sc1
    v_add_u32 v5, -65536, v5
    ds_read_b128 a[192:195], v5 offset:0
    ds_read_b128 a[196:199], v5 offset:4096
    ds_read_b64_tr_b16 v[16:17], v9 offset:49152
    ds_read_b64_tr_b16 v[18:19], v9 offset:50176
    buffer_store_dwordx4 v[44:47], v41, s[20:23], s54 offen sc0 sc1
    v_mfma_f32_32x32x16_bf16 v[112:127], v[20:23], a[188:191], v[112:127]
    v_dot2c_f32_bf16 v48, 0x3f803f80, v44
    s_waitcnt lgkmcnt(6)
    v_mfma_f32_32x32x16_bf16 v[128:143], v[24:27], a[184:187], v[128:143]
    ds_read_b64_tr_b16 v[20:21], v10 offset:49152
    ds_read_b64_tr_b16 v[22:23], v10 offset:50176
    v_dot2c_f32_bf16 v48, 0x3f803f80, v45
    v_mfma_f32_32x32x16_bf16 v[144:159], v[24:27], a[188:191], v[144:159]
    v_dot2c_f32_bf16 v48, 0x3f803f80, v46
    s_waitcnt lgkmcnt(6)
    v_mfma_f32_32x32x16_bf16 v[160:175], v[28:31], a[184:187], v[160:175]
    ds_read_b64_tr_b16 v[24:25], v11 offset:49152
    ds_read_b64_tr_b16 v[26:27], v11 offset:50176
    v_dot2c_f32_bf16 v48, 0x3f803f80, v47
    s_load_dwordx2 s[32:33], s[0:1], 16
    v_mfma_f32_32x32x16_bf16 v[176:191], v[28:31], a[188:191], v[176:191]
    s_nop 0
    v_add_f32_dpp v48, v48, v48 quad_perm:[1,0,3,2] row_mask:0xf bank_mask:0xf
    s_waitcnt lgkmcnt(4)
    v_mfma_f32_32x32x16_bf16 v[64:79], v[16:19], a[192:195], v[64:79]
    ds_read_b64_tr_b16 v[28:29], v12 offset:49152
    ds_read_b64_tr_b16 v[30:31], v12 offset:50176
    s_add_u32 s52, s49, 0
    s_and_b32 s52, s52, 7
    s_lshl_b32 s52, s52, 19
    s_add_u32 m0, s47, 16384
    s_nop 0
    buffer_load_dwordx4 v4, s[8:11], s52 offen lds
    v_add_f32_dpp v48, v48, v48 quad_perm:[2,3,0,1] row_mask:0xf bank_mask:0xf
    v_mfma_f32_32x32x16_bf16 v[80:95], v[16:19], a[196:199], v[80:95]
    s_nop 0
    v_add_f32_dpp v48, v48, v48 row_half_mirror row_mask:0xf bank_mask:0xf
    s_waitcnt lgkmcnt(4)
    v_mfma_f32_32x32x16_bf16 v[96:111], v[20:23], a[192:195], v[96:111]
    v_add_u32 v6, -65536, v6
    ds_read_b128 a[200:203], v6 offset:0
    ds_read_b128 a[204:207], v6 offset:4096
    ds_read_b64_tr_b16 v[16:17], v9 offset:53248
    ds_read_b64_tr_b16 v[18:19], v9 offset:54272
    s_add_u32 s52, s52, 65536
    s_add_u32 m0, s47, 17408
    s_nop 0
    buffer_load_dwordx4 v4, s[8:11], s52 offen lds
    v_mul_f32 v48, 0x3ae38e39, v48
    v_mfma_f32_32x32x16_bf16 v[112:127], v[20:23], a[196:199], v[112:127]
    v_cvt_pk_bf16_f32 v49, v48, v48
    s_waitcnt lgkmcnt(6)
    v_mfma_f32_32x32x16_bf16 v[128:143], v[24:27], a[192:195], v[128:143]
    ds_read_b64_tr_b16 v[20:21], v10 offset:53248
    ds_read_b64_tr_b16 v[22:23], v10 offset:54272
    s_add_u32 s52, s52, 65536
    s_add_u32 m0, s47, 18432
    s_nop 0
    buffer_load_dwordx4 v4, s[8:11], s52 offen lds
    v_and_b32 v49, 0xffff0000, v49
    v_mfma_f32_32x32x16_bf16 v[144:159], v[24:27], a[196:199], v[144:159]
    v_sub_f32 v49, v48, v49
    s_waitcnt lgkmcnt(6)
    v_mfma_f32_32x32x16_bf16 v[160:175], v[28:31], a[192:195], v[160:175]
    ds_read_b64_tr_b16 v[24:25], v11 offset:53248
    ds_read_b64_tr_b16 v[26:27], v11 offset:54272
    s_add_u32 s52, s52, 65536
    s_add_u32 m0, s47, 19456
    s_nop 0
    buffer_load_dwordx4 v4, s[8:11], s52 offen lds
    v_cvt_pk_bf16_f32 v49, v48, v49
    s_waitcnt lgkmcnt(0)
    v_mfma_f32_32x32x16_bf16 v[176:191], v[28:31], a[196:199], v[176:191]
    buffer_store_dword v49, v42, s[20:23], s58 offen offset:4 sc0 sc1
    s_mov_b32 s4, s32
    s_mov_b32 s5, s33
    s_mov_b32 s6, 0x480000
    s_mov_b32 s7, 0x00020000
    v_mfma_f32_32x32x16_bf16 v[64:79], v[16:19], a[200:203], v[64:79]
    ds_read_b64_tr_b16 v[28:29], v12 offset:53248
    ds_read_b64_tr_b16 v[30:31], v12 offset:54272
    s_add_u32 s52, s49, 2
    s_and_b32 s52, s52, 7
    s_lshl_b32 s52, s52, 19
    s_add_u32 m0, s47, 131072
    s_nop 0
    buffer_load_dwordx4 v4, s[8:11], s52 offen lds
    s_add_u32 s42, s41, 1
    s_sub_u32 s60, s42, 512
    s_cmp_lt_u32 s42, 512
    s_cselect_b32 s68, s64, s66
    s_cselect_b32 s69, s65, s67
    s_cselect_b32 s60, s42, s60
    s_cselect_b32 s61, 0, 0x100000
    s_cselect_b32 s62, 8, 9
    s_lshr_b32 s44, s2, 3
    s_mul_i32 s44, s44, 18
    v_mfma_f32_32x32x16_bf16 v[80:95], v[16:19], a[204:207], v[80:95]
    s_lshl_b32 s62, s62, 4
    s_mul_i32 s70, s62, 36864
    s_lshl_b32 s45, s24, 3
    s_add_u32 s44, s44, s45
    s_lshl_b32 s44, s44, 13
    v_mfma_f32_32x32x16_bf16 v[96:111], v[20:23], a[200:203], v[96:111]
    v_add_u32 v7, -65536, v7
    ds_read_b128 a[208:211], v7 offset:0
    ds_read_b128 a[212:215], v7 offset:4096
    ds_read_b64_tr_b16 v[16:17], v9 offset:57344
    ds_read_b64_tr_b16 v[18:19], v9 offset:58368
    s_add_u32 s52, s52, 65536
    s_add_u32 m0, s47, 132096
    s_nop 0
    buffer_load_dwordx4 v4, s[8:11], s52 offen lds
    s_mov_b32 s71, 0x00020000
    s_lshl_b32 s63, s60, 8
    s_and_b32 s45, s2, 7
    s_lshl_b32 s45, s45, 10
    s_add_u32 s44, s44, s45
    v_mfma_f32_32x32x16_bf16 v[112:127], v[20:23], a[204:207], v[112:127]
    s_add_u32 s61, s61, s63
    s_add_u32 s54, s61, 37748736
    v_lshrrev_b32 v1, 3, v0
    v_mfma_f32_32x32x16_bf16 v[128:143], v[24:27], a[200:203], v[128:143]
    ds_read_b64_tr_b16 v[20:21], v10 offset:57344
    ds_read_b64_tr_b16 v[22:23], v10 offset:58368
    s_add_u32 s52, s52, 65536
    s_add_u32 m0, s47, 133120
    s_nop 0
    buffer_load_dwordx4 v4, s[8:11], s52 offen lds
    s_mul_i32 s55, s60, 9216
    v_lshlrev_b32 v1, 13, v1
    v_mfma_f32_32x32x16_bf16 v[144:159], v[24:27], a[204:207], v[144:159]
    s_lshl_b32 s62, s62, 10
    s_cmp_lt_u32 s42, 1088
    s_cselect_b32 s61, 0, 0x7f000000
    s_waitcnt lgkmcnt(6)
    v_mfma_f32_32x32x16_bf16 v[160:175], v[28:31], a[200:203], v[160:175]
    ds_read_b64_tr_b16 v[24:25], v11 offset:57344
    ds_read_b64_tr_b16 v[26:27], v11 offset:58368
    s_add_u32 s52, s52, 65536
    s_add_u32 m0, s47, 134144
    s_nop 0
    buffer_load_dwordx4 v4, s[8:11], s52 offen lds
    v_lshrrev_b32 v50, 3, v0
    v_and_b32 v51, 7, v0
    v_and_b32 v2, 7, v0
    v_mfma_f32_32x32x16_bf16 v[176:191], v[28:31], a[204:207], v[176:191]
    v_lshlrev_b32 v51, 4, v51
    v_mul_u32_u24 v40, 1152, v50
    v_lshl_add_u32 v1, v2, 7, v1
    s_waitcnt lgkmcnt(4)
    v_mfma_f32_32x32x16_bf16 v[64:79], v[16:19], a[208:211], v[64:79]
    ds_read_b64_tr_b16 v[28:29], v12 offset:57344
    ds_read_b64_tr_b16 v[30:31], v12 offset:58368
    s_add_u32 s52, s49, 4
    s_and_b32 s52, s52, 7
    s_lshl_b32 s52, s52, 19
    s_add_u32 m0, s47, 147456
    s_nop 0
    buffer_load_dwordx4 v4, s[8:11], s52 offen lds
    v_add3_u32 v40, v40, v51, s61
    buffer_load_dwordx4 v[44:47], v40, s[68:71], s55 offen offset:1024
    s_cmp_ge_u32 s24, 3
    s_cselect_b32 s44, 0x7f000000, s44
    v_mfma_f32_32x32x16_bf16 v[80:95], v[16:19], a[212:215], v[80:95]
    v_bfe_u32 v52, v0, 1, 2
    v_add_u32 v1, s44, v1
    s_waitcnt lgkmcnt(4)
    v_mfma_f32_32x32x16_bf16 v[96:111], v[20:23], a[208:211], v[96:111]
    v_add_u32 v8, -65536, v8
    ds_read_b128 a[216:219], v8 offset:0
    ds_read_b128 a[220:223], v8 offset:4096
    ds_read_b64_tr_b16 v[16:17], v9 offset:61440
    ds_read_b64_tr_b16 v[18:19], v9 offset:62464
    s_add_u32 s52, s52, 65536
    s_add_u32 m0, s47, 148480
    s_nop 0
    buffer_load_dwordx4 v4, s[8:11], s52 offen lds
    v_mul_lo_u32 v52, v52, s62
    v_lshl_add_u32 v52, v50, 5, v52
    buffer_load_dword v63, v1, s[4:7], 0 offen
    v_mfma_f32_32x32x16_bf16 v[112:127], v[20:23], a[212:215], v[112:127]
    v_and_b32 v53, 16, v51
    v_add3_u32 v41, v52, v53, s61
    s_and_b32 s38, s2, 7
    s_lshr_b32 s39, s2, 3
    s_waitcnt lgkmcnt(6)
    v_mfma_f32_32x32x16_bf16 v[128:143], v[24:27], a[208:211], v[128:143]
    ds_read_b64_tr_b16 v[20:21], v10 offset:61440
    ds_read_b64_tr_b16 v[22:23], v10 offset:62464
    s_add_u32 s52, s52, 65536
    s_add_u32 m0, s47, 149504
    s_nop 0
    buffer_load_dwordx4 v4, s[8:11], s52 offen lds
    s_and_b32 s58, s42, 15
    s_lshl_b32 s58, s58, 8
    s_and_b32 s26, s39, 7
    s_lshr_b32 s39, s39, 3
    s_lshl_b32 s38, s38, 2
    s_add_u32 s25, s38, s39
    v_mfma_f32_32x32x16_bf16 v[144:159], v[24:27], a[212:215], v[144:159]
    s_bfe_u32 s56, s42, 0x30006
    s_lshl_b32 s56, s56, 12
    s_waitcnt lgkmcnt(6)
    v_mfma_f32_32x32x16_bf16 v[160:175], v[28:31], a[208:211], v[160:175]
    ds_read_b64_tr_b16 v[24:25], v11 offset:61440
    ds_read_b64_tr_b16 v[26:27], v11 offset:62464
    s_add_u32 s52, s52, 65536
    s_add_u32 m0, s47, 150528
    s_nop 0
    buffer_load_dwordx4 v4, s[8:11], s52 offen lds
    s_add_u32 s58, s58, s56
    s_sub_u32 s38, 15, s26
    v_mfma_f32_32x32x16_bf16 v[176:191], v[28:31], a[212:215], v[176:191]
    s_bfe_u32 s56, s42, 0x20004
    s_lshl_b32 s56, s56, 3
    s_cmp_ge_u32 s24, 2
    s_cselect_b32 s39, s26, s38
    s_cselect_b32 s45, s38, s26
    s_waitcnt lgkmcnt(4)
    v_mfma_f32_32x32x16_bf16 v[64:79], v[16:19], a[216:219], v[64:79]
    ds_read_b64_tr_b16 v[28:29], v12 offset:61440
    ds_read_b64_tr_b16 v[30:31], v12 offset:62464
    s_add_u32 s58, s58, s56
    s_add_u32 s58, s58, 36962304
    s_and_b32 s44, s24, 1
    s_lshl_b32 s39, s39, 1
    s_add_u32 s39, s39, s44
    s_lshl_b32 s27, s39, 2
    v_mfma_f32_32x32x16_bf16 v[80:95], v[16:19], a[220:223], v[80:95]
    s_cmp_lt_u32 s42, 512
    s_cselect_b32 s61, 0, 0x40000000
    v_lshlrev_b32 v42, 22, v51
    s_lshl_b32 s45, s45, 1
    s_add_u32 s45, s45, 1
    s_sub_u32 s29, s45, s44
    s_waitcnt lgkmcnt(4)
    v_mfma_f32_32x32x16_bf16 v[96:111], v[20:23], a[216:219], v[96:111]
    s_waitcnt vmcnt(17)
    s_barrier
    v_add_u32 v5, 32768, v5
    ds_read_b128 a[224:227], v5 offset:0
    ds_read_b128 a[228:231], v5 offset:4096
    ds_read_b64_tr_b16 v[16:17], v9 offset:0
    ds_read_b64_tr_b16 v[18:19], v9 offset:1024
    v_lshl_add_u32 v42, v50, 5, v42
    v_add_u32 v42, s61, v42
    s_lshl_b32 s35, s29, 3
    v_mfma_f32_32x32x16_bf16 v[112:127], v[20:23], a[220:223], v[112:127]
    v_mov_b32 v48, 0
    s_mul_i32 s48, s29, 73728
    s_waitcnt lgkmcnt(6)
    v_mfma_f32_32x32x16_bf16 v[128:143], v[24:27], a[216:219], v[128:143]
    ds_read_b64_tr_b16 v[20:21], v10 offset:0
    ds_read_b64_tr_b16 v[22:23], v10 offset:1024
    s_and_b32 s46, s25, 3
    s_mul_i32 s46, s46, 144
    v_mfma_f32_32x32x16_bf16 v[144:159], v[24:27], a[220:223], v[144:159]
    s_waitcnt lgkmcnt(6)
    v_mfma_f32_32x32x16_bf16 v[160:175], v[28:31], a[216:219], v[160:175]
    ds_read_b64_tr_b16 v[24:25], v11 offset:0
    ds_read_b64_tr_b16 v[26:27], v11 offset:1024
    v_add_u32 v34, s46, v0
    v_mfma_f32_32x32x16_bf16 v[176:191], v[28:31], a[220:223], v[176:191]
    v_add_u32 v35, 64, v34
    s_waitcnt lgkmcnt(4)
    v_mfma_f32_32x32x16_bf16 v[64:79], v[16:19], a[224:227], v[64:79]
    ds_read_b64_tr_b16 v[28:29], v12 offset:0
    ds_read_b64_tr_b16 v[30:31], v12 offset:1024
    s_add_u32 s52, s49, 6
    s_and_b32 s52, s52, 7
    s_lshl_b32 s52, s52, 19
    s_add_u32 m0, s47, 32768
    s_nop 0
    buffer_load_dwordx4 v4, s[8:11], s52 offen lds
    v_add_u32 v36, 128, v34
    v_mfma_f32_32x32x16_bf16 v[80:95], v[16:19], a[228:231], v[80:95]
    v_min_u32 v36, 575, v36
    s_waitcnt lgkmcnt(4)
    v_mfma_f32_32x32x16_bf16 v[96:111], v[20:23], a[224:227], v[96:111]
    v_add_u32 v6, 32768, v6
    ds_read_b128 a[232:235], v6 offset:0
    ds_read_b128 a[236:239], v6 offset:4096
    ds_read_b64_tr_b16 v[16:17], v9 offset:4096
    ds_read_b64_tr_b16 v[18:19], v9 offset:5120
    s_add_u32 s52, s52, 65536
    s_add_u32 m0, s47, 33792
    s_nop 0
    buffer_load_dwordx4 v4, s[8:11], s52 offen lds
    v_lshlrev_b32 v34, 7, v34
    v_mfma_f32_32x32x16_bf16 v[112:127], v[20:23], a[228:231], v[112:127]
    v_lshlrev_b32 v35, 7, v35
    s_waitcnt lgkmcnt(6)
    v_mfma_f32_32x32x16_bf16 v[128:143], v[24:27], a[224:227], v[128:143]
    ds_read_b64_tr_b16 v[20:21], v10 offset:4096
    ds_read_b64_tr_b16 v[22:23], v10 offset:5120
    s_add_u32 s52, s52, 65536
    s_add_u32 m0, s47, 34816
    s_nop 0
    buffer_load_dwordx4 v4, s[8:11], s52 offen lds
    v_lshlrev_b32 v36, 7, v36
    v_mfma_f32_32x32x16_bf16 v[144:159], v[24:27], a[228:231], v[144:159]
    s_waitcnt lgkmcnt(6)
    v_mfma_f32_32x32x16_bf16 v[160:175], v[28:31], a[224:227], v[160:175]
    ds_read_b64_tr_b16 v[24:25], v11 offset:4096
    ds_read_b64_tr_b16 v[26:27], v11 offset:5120
    s_add_u32 s52, s52, 65536
    s_add_u32 m0, s47, 35840
    s_nop 0
    buffer_load_dwordx4 v4, s[8:11], s52 offen lds
    v_mfma_f32_32x32x16_bf16 v[176:191], v[28:31], a[228:231], v[176:191]
    s_waitcnt lgkmcnt(4)
    v_mfma_f32_32x32x16_bf16 v[64:79], v[16:19], a[232:235], v[64:79]
    ds_read_b64_tr_b16 v[28:29], v12 offset:4096
    ds_read_b64_tr_b16 v[30:31], v12 offset:5120
    s_add_u32 s52, s49, 0
    s_and_b32 s52, s52, 7
    s_lshl_b32 s52, s52, 19
    s_add_u32 s52, s52, 128
    s_add_u32 m0, s47, 81920
    s_nop 0
    buffer_load_dwordx4 v4, s[8:11], s52 offen lds
    v_mfma_f32_32x32x16_bf16 v[80:95], v[16:19], a[236:239], v[80:95]
    s_waitcnt lgkmcnt(4)
    v_mfma_f32_32x32x16_bf16 v[96:111], v[20:23], a[232:235], v[96:111]
    v_add_u32 v7, 32768, v7
    ds_read_b128 a[240:243], v7 offset:0
    ds_read_b128 a[244:247], v7 offset:4096
    ds_read_b64_tr_b16 v[16:17], v9 offset:8192
    ds_read_b64_tr_b16 v[18:19], v9 offset:9216
    s_add_u32 s52, s52, 65536
    s_add_u32 m0, s47, 82944
    s_nop 0
    buffer_load_dwordx4 v4, s[8:11], s52 offen lds
    v_mfma_f32_32x32x16_bf16 v[112:127], v[20:23], a[236:239], v[112:127]
    s_waitcnt lgkmcnt(6)
    v_mfma_f32_32x32x16_bf16 v[128:143], v[24:27], a[232:235], v[128:143]
    ds_read_b64_tr_b16 v[20:21], v10 offset:8192
    ds_read_b64_tr_b16 v[22:23], v10 offset:9216
    s_add_u32 s52, s52, 65536
    s_add_u32 m0, s47, 83968
    s_nop 0
    buffer_load_dwordx4 v4, s[8:11], s52 offen lds
    v_add_u32 v56, 0, v13
    v_mfma_f32_32x32x16_bf16 v[144:159], v[24:27], a[236:239], v[144:159]
    v_add_u32 v57, 0, v14
    s_waitcnt lgkmcnt(6)
    v_mfma_f32_32x32x16_bf16 v[160:175], v[28:31], a[232:235], v[160:175]
    ds_read_b64_tr_b16 v[24:25], v11 offset:8192
    ds_read_b64_tr_b16 v[26:27], v11 offset:9216
    s_add_u32 s52, s52, 65536
    s_add_u32 m0, s47, 84992
    s_nop 0
    buffer_load_dwordx4 v4, s[8:11], s52 offen lds
    v_add_u32 v58, 65536, v13
    v_mfma_f32_32x32x16_bf16 v[176:191], v[28:31], a[236:239], v[176:191]
    s_waitcnt lgkmcnt(4)
    v_mfma_f32_32x32x16_bf16 v[64:79], v[16:19], a[240:243], v[64:79]
    ds_read_b64_tr_b16 v[28:29], v12 offset:8192
    ds_read_b64_tr_b16 v[30:31], v12 offset:9216
    s_add_u32 s52, s49, 2
    s_and_b32 s52, s52, 7
    s_lshl_b32 s52, s52, 19
    s_add_u32 s52, s52, 128
    s_add_u32 m0, s47, 65536
    s_nop 0
    buffer_load_dwordx4 v4, s[8:11], s52 offen lds
    v_add_u32 v59, 65536, v14
    v_mfma_f32_32x32x16_bf16 v[80:95], v[16:19], a[244:247], v[80:95]
    v_add_u32 v60, 131072, v13
    s_waitcnt lgkmcnt(4)
    v_mfma_f32_32x32x16_bf16 v[96:111], v[20:23], a[240:243], v[96:111]
    v_add_u32 v8, 32768, v8
    ds_read_b128 a[248:251], v8 offset:0
    ds_read_b128 a[252:255], v8 offset:4096
    ds_read_b64_tr_b16 v[16:17], v9 offset:12288
    ds_read_b64_tr_b16 v[18:19], v9 offset:13312
    s_add_u32 s52, s52, 65536
    s_add_u32 m0, s47, 66560
    s_nop 0
    buffer_load_dwordx4 v4, s[8:11], s52 offen lds
    v_add_u32 v61, 131072, v14
    v_mfma_f32_32x32x16_bf16 v[112:127], v[20:23], a[244:247], v[112:127]
    s_waitcnt lgkmcnt(6)
    v_mfma_f32_32x32x16_bf16 v[128:143], v[24:27], a[240:243], v[128:143]
    ds_read_b64_tr_b16 v[20:21], v10 offset:12288
    ds_read_b64_tr_b16 v[22:23], v10 offset:13312
    s_add_u32 s52, s52, 65536
    s_add_u32 m0, s47, 67584
    s_nop 0
    buffer_load_dwordx4 v4, s[8:11], s52 offen lds
    v_mfma_f32_32x32x16_bf16 v[144:159], v[24:27], a[244:247], v[144:159]
    s_waitcnt lgkmcnt(6)
    v_mfma_f32_32x32x16_bf16 v[160:175], v[28:31], a[240:243], v[160:175]
    ds_read_b64_tr_b16 v[24:25], v11 offset:12288
    ds_read_b64_tr_b16 v[26:27], v11 offset:13312
    s_add_u32 s52, s52, 65536
    s_add_u32 m0, s47, 68608
    s_nop 0
    buffer_load_dwordx4 v4, s[8:11], s52 offen lds
    v_mfma_f32_32x32x16_bf16 v[176:191], v[28:31], a[244:247], v[176:191]
    s_waitcnt lgkmcnt(4)
    v_mfma_f32_32x32x16_bf16 v[64:79], v[16:19], a[248:251], v[64:79]
    ds_read_b64_tr_b16 v[28:29], v12 offset:12288
    ds_read_b64_tr_b16 v[30:31], v12 offset:13312
    v_mfma_f32_32x32x16_bf16 v[80:95], v[16:19], a[252:255], v[80:95]
    s_waitcnt lgkmcnt(4)
    v_mfma_f32_32x32x16_bf16 v[96:111], v[20:23], a[248:251], v[96:111]
    s_waitcnt vmcnt(23)
    s_barrier
    ds_read_b64_tr_b16 v[16:17], v56 offset:16384
    ds_read_b64_tr_b16 v[18:19], v56 offset:16896
    s_waitcnt vmcnt(16)
    buffer_store_dwordx4 v[44:47], v41, s[20:23], s54 offen sc0 sc1
    v_mfma_f32_32x32x16_bf16 v[112:127], v[20:23], a[252:255], v[112:127]
    v_dot2c_f32_bf16 v48, 0x3f803f80, v44
    s_waitcnt lgkmcnt(4)
    v_mfma_f32_32x32x16_bf16 v[128:143], v[24:27], a[248:251], v[128:143]
    ds_read_b64_tr_b16 v[20:21], v57 offset:16384
    ds_read_b64_tr_b16 v[22:23], v57 offset:16896
    v_dot2c_f32_bf16 v48, 0x3f803f80, v45
    v_mfma_f32_32x32x16_bf16 v[144:159], v[24:27], a[252:255], v[144:159]
    v_dot2c_f32_bf16 v48, 0x3f803f80, v46
    s_waitcnt lgkmcnt(4)
    v_mfma_f32_32x32x16_bf16 v[160:175], v[28:31], a[248:251], v[160:175]
    ds_read_b64_tr_b16 v[24:25], v56 offset:18432
    ds_read_b64_tr_b16 v[26:27], v56 offset:18944
    v_dot2c_f32_bf16 v48, 0x3f803f80, v47
    v_mfma_f32_32x32x16_bf16 v[176:191], v[28:31], a[252:255], v[176:191]
    s_nop 1
    v_add_f32_dpp v48, v48, v48 quad_perm:[1,0,3,2] row_mask:0xf bank_mask:0xf
    s_waitcnt lgkmcnt(4)
    v_mfma_f32_32x32x16_bf16 v[192:207], v[16:19], a[0:3], 0
    ds_read_b64_tr_b16 v[28:29], v57 offset:18432
    ds_read_b64_tr_b16 v[30:31], v57 offset:18944
    s_add_u32 s52, s49, 4
    s_and_b32 s52, s52, 7
    s_lshl_b32 s52, s52, 19
    s_add_u32 s52, s52, 128
    s_add_u32 m0, s47, 49152
    s_nop 0
    buffer_load_dwordx4 v4, s[8:11], s52 offen lds
    v_add_f32_dpp v48, v48, v48 quad_perm:[2,3,0,1] row_mask:0xf bank_mask:0xf
    v_mfma_f32_32x32x16_bf16 v[208:223], v[16:19], a[4:7], 0
    s_nop 0
    v_add_f32_dpp v48, v48, v48 row_half_mirror row_mask:0xf bank_mask:0xf
    s_waitcnt lgkmcnt(4)
    v_mfma_f32_32x32x16_bf16 v[224:239], v[20:23], a[0:3], 0
    ds_read_b64_tr_b16 v[16:17], v56 offset:20480
    ds_read_b64_tr_b16 v[18:19], v56 offset:20992
    v_mul_f32 v48, 0x3ae38e39, v48
    v_mfma_f32_32x32x16_bf16 v[240:255], v[20:23], a[4:7], 0
    s_add_u32 s52, s52, 65536
    s_add_u32 m0, s47, 50176
    s_nop 0
    buffer_load_dwordx4 v4, s[8:11], s52 offen lds
    v_cvt_pk_bf16_f32 v49, v48, v48
    s_waitcnt lgkmcnt(4)
    v_mfma_f32_32x32x16_bf16 v[192:207], v[24:27], a[8:11], v[192:207]
    ds_read_b64_tr_b16 v[20:21], v57 offset:20480
    ds_read_b64_tr_b16 v[22:23], v57 offset:20992
    v_and_b32 v49, 0xffff0000, v49
    v_mfma_f32_32x32x16_bf16 v[208:223], v[24:27], a[12:15], v[208:223]
    v_sub_f32 v49, v48, v49
    s_waitcnt lgkmcnt(4)
    v_mfma_f32_32x32x16_bf16 v[224:239], v[28:31], a[8:11], v[224:239]
    ds_read_b64_tr_b16 v[24:25], v56 offset:22528
    ds_read_b64_tr_b16 v[26:27], v56 offset:23040
    s_add_u32 s52, s52, 65536
    s_add_u32 m0, s47, 51200
    s_nop 0
    buffer_load_dwordx4 v4, s[8:11], s52 offen lds
    v_cvt_pk_bf16_f32 v49, v48, v49
    v_cvt_pk_bf16_f32 v64, v64, v65
    s_and_b32 s51, s34, 0x7f000000
    v_lshlrev_b32 v38, 20, v0
    v_mfma_f32_32x32x16_bf16 v[240:255], v[28:31], a[12:15], v[240:255]
    buffer_store_dword v49, v42, s[20:23], s58 offen offset:4 sc0 sc1
    s_lshl_b32 s35, s26, 4
    s_add_u32 s35, s35, s51
    v_writelane_b32 v38, s35, 0
    s_waitcnt lgkmcnt(4)
    v_mfma_f32_32x32x16_bf16 v[192:207], v[16:19], a[16:19], v[192:207]
    ds_read_b64_tr_b16 v[28:29], v57 offset:22528
    ds_read_b64_tr_b16 v[30:31], v57 offset:23040
    v_cvt_pk_bf16_f32 v65, v66, v67
    s_xor_b32 s35, s35, 0xf0
    v_writelane_b32 v38, s35, 1
    v_mfma_f32_32x32x16_bf16 v[208:223], v[16:19], a[20:23], v[208:223]
    s_add_u32 s52, s52, 65536
    s_add_u32 m0, s47, 52224
    s_nop 0
    buffer_load_dwordx4 v4, s[8:11], s52 offen lds
    s_lshl_b32 s35, s25, 3
    s_and_b32 s35, s35, 0xf0
    s_add_u32 s35, s35, s51
    v_writelane_b32 v38, s35, 2
    s_waitcnt lgkmcnt(4)
    v_mfma_f32_32x32x16_bf16 v[224:239], v[20:23], a[16:19], v[224:239]
    ds_read_b64_tr_b16 v[16:17], v56 offset:24576
    ds_read_b64_tr_b16 v[18:19], v56 offset:25088
    v_cvt_pk_bf16_f32 v66, v68, v69
    buffer_load_dwordx4 v[32:35], v38, s[92:95], 0 offen sc0 sc1
    v_mfma_f32_32x32x16_bf16 v[240:255], v[20:23], a[20:23], v[240:255]
    s_waitcnt lgkmcnt(4)
    v_mfma_f32_32x32x16_bf16 v[192:207], v[24:27], a[24:27], v[192:207]
    ds_read_b64_tr_b16 v[20:21], v57 offset:24576
    ds_read_b64_tr_b16 v[22:23], v57 offset:25088
    s_add_u32 s52, s49, 6
    s_and_b32 s52, s52, 7
    s_lshl_b32 s52, s52, 19
    s_add_u32 s52, s52, 128
    s_add_u32 m0, s47, 114688
    s_nop 0
    buffer_load_dwordx4 v4, s[8:11], s52 offen lds
    v_cvt_pk_bf16_f32 v67, v70, v71
    v_mfma_f32_32x32x16_bf16 v[208:223], v[24:27], a[28:31], v[208:223]
    s_waitcnt lgkmcnt(4)
    v_mfma_f32_32x32x16_bf16 v[224:239], v[28:31], a[24:27], v[224:239]
    ds_read_b64_tr_b16 v[24:25], v56 offset:26624
    ds_read_b64_tr_b16 v[26:27], v56 offset:27136
    s_add_u32 s101, s100, 0
    buffer_store_dwordx4 v[64:67], v15, s[96:99], s101 offen sc0 sc1
    v_mfma_f32_32x32x16_bf16 v[240:255], v[28:31], a[28:31], v[240:255]
    s_add_u32 s52, s52, 65536
    s_add_u32 m0, s47, 115712
    s_nop 0
    buffer_load_dwordx4 v4, s[8:11], s52 offen lds
    s_waitcnt lgkmcnt(4)
    v_mfma_f32_32x32x16_bf16 v[192:207], v[16:19], a[32:35], v[192:207]
    ds_read_b64_tr_b16 v[28:29], v57 offset:26624
    ds_read_b64_tr_b16 v[30:31], v57 offset:27136
    v_mfma_f32_32x32x16_bf16 v[208:223], v[16:19], a[36:39], v[208:223]
    v_cvt_pk_bf16_f32 v68, v72, v73
    s_waitcnt lgkmcnt(4)
    v_mfma_f32_32x32x16_bf16 v[224:239], v[20:23], a[32:35], v[224:239]
    ds_read_b64_tr_b16 v[16:17], v56 offset:28672
    ds_read_b64_tr_b16 v[18:19], v56 offset:29184
    s_add_u32 s52, s52, 65536
    s_add_u32 m0, s47, 116736
    s_nop 0
    buffer_load_dwordx4 v4, s[8:11], s52 offen lds
    v_mfma_f32_32x32x16_bf16 v[240:255], v[20:23], a[36:39], v[240:255]
    v_cvt_pk_bf16_f32 v69, v74, v75
    s_waitcnt lgkmcnt(4)
    v_mfma_f32_32x32x16_bf16 v[192:207], v[24:27], a[40:43], v[192:207]
    ds_read_b64_tr_b16 v[20:21], v57 offset:28672
    ds_read_b64_tr_b16 v[22:23], v57 offset:29184
    v_mfma_f32_32x32x16_bf16 v[208:223], v[24:27], a[44:47], v[208:223]
    s_add_u32 s52, s52, 65536
    s_add_u32 m0, s47, 117760
    s_nop 0
    buffer_load_dwordx4 v4, s[8:11], s52 offen lds
    v_cvt_pk_bf16_f32 v70, v76, v77
    s_waitcnt lgkmcnt(4)
    v_mfma_f32_32x32x16_bf16 v[224:239], v[28:31], a[40:43], v[224:239]
    ds_read_b64_tr_b16 v[24:25], v56 offset:30720
    ds_read_b64_tr_b16 v[26:27], v56 offset:31232
    v_mfma_f32_32x32x16_bf16 v[240:255], v[28:31], a[44:47], v[240:255]
    v_cvt_pk_bf16_f32 v71, v78, v79
    s_waitcnt lgkmcnt(4)
    v_mfma_f32_32x32x16_bf16 v[192:207], v[16:19], a[48:51], v[192:207]
    ds_read_b64_tr_b16 v[28:29], v57 offset:30720
    ds_read_b64_tr_b16 v[30:31], v57 offset:31232
    v_mfma_f32_32x32x16_bf16 v[208:223], v[16:19], a[52:55], v[208:223]
    s_add_u32 s101, s100, 512
    buffer_store_dwordx4 v[68:71], v15, s[96:99], s101 offen sc0 sc1
    s_waitcnt lgkmcnt(4)
    v_mfma_f32_32x32x16_bf16 v[224:239], v[20:23], a[48:51], v[224:239]
    s_barrier
    ds_read_b64_tr_b16 v[16:17], v60 offset:0
    ds_read_b64_tr_b16 v[18:19], v60 offset:512
    v_mfma_f32_32x32x16_bf16 v[240:255], v[20:23], a[52:55], v[240:255]
    s_waitcnt lgkmcnt(4)
    v_mfma_f32_32x32x16_bf16 v[192:207], v[24:27], a[56:59], v[192:207]
    ds_read_b64_tr_b16 v[20:21], v61 offset:0
    ds_read_b64_tr_b16 v[22:23], v61 offset:512
    v_cvt_pk_bf16_f32 v80, v80, v81
    v_mfma_f32_32x32x16_bf16 v[208:223], v[24:27], a[60:63], v[208:223]
    s_waitcnt lgkmcnt(4)
    v_mfma_f32_32x32x16_bf16 v[224:239], v[28:31], a[56:59], v[224:239]
    ds_read_b64_tr_b16 v[24:25], v60 offset:2048
    ds_read_b64_tr_b16 v[26:27], v60 offset:2560
    v_cvt_pk_bf16_f32 v81, v82, v83
    v_mfma_f32_32x32x16_bf16 v[240:255], v[28:31], a[60:63], v[240:255]
    s_waitcnt lgkmcnt(4)
    v_mfma_f32_32x32x16_bf16 v[192:207], v[16:19], a[64:67], v[192:207]
    ds_read_b64_tr_b16 v[28:29], v61 offset:2048
    ds_read_b64_tr_b16 v[30:31], v61 offset:2560
    v_cvt_pk_bf16_f32 v82, v84, v85
    v_mfma_f32_32x32x16_bf16 v[208:223], v[16:19], a[68:71], v[208:223]
    s_waitcnt lgkmcnt(4)
    v_mfma_f32_32x32x16_bf16 v[224:239], v[20:23], a[64:67], v[224:239]
    ds_read_b64_tr_b16 v[16:17], v60 offset:4096
    ds_read_b64_tr_b16 v[18:19], v60 offset:4608
    v_cvt_pk_bf16_f32 v83, v86, v87
    s_mov_b32 s58, 0
    s_waitcnt vmcnt(6)
    v_mfma_f32_32x32x16_bf16 v[240:255], v[20:23], a[68:71], v[240:255]
    v_and_b32 v32, v32, v33
    s_waitcnt lgkmcnt(4)
    v_mfma_f32_32x32x16_bf16 v[192:207], v[24:27], a[72:75], v[192:207]
    ds_read_b64_tr_b16 v[20:21], v61 offset:4096
    ds_read_b64_tr_b16 v[22:23], v61 offset:4608
    s_add_u32 s101, s100, 8192
    buffer_store_dwordx4 v[80:83], v15, s[96:99], s101 offen sc0 sc1
    s_load_dwordx2 s[54:55], s[0:1], 40
    s_load_dwordx4 s[60:63], s[0:1], 56
    v_and_b32 v32, v32, v34
    v_mfma_f32_32x32x16_bf16 v[208:223], v[24:27], a[76:79], v[208:223]
    v_and_b32 v32, v32, v35
    s_waitcnt lgkmcnt(4)
    v_mfma_f32_32x32x16_bf16 v[224:239], v[28:31], a[72:75], v[224:239]
    ds_read_b64_tr_b16 v[24:25], v60 offset:6144
    ds_read_b64_tr_b16 v[26:27], v60 offset:6656
    v_lshlrev_b32 v1, 4, v0
    v_and_b32 v32, 0x01010101, v32
    v_mfma_f32_32x32x16_bf16 v[240:255], v[28:31], a[76:79], v[240:255]
    v_cvt_pk_bf16_f32 v84, v88, v89
    v_cmp_eq_u32 vcc, 0x01010101, v32
    s_cmp_eq_u32 s24, 0
    s_cselect_b32 s51, vcc_lo, -1
    s_and_b32 s51, s51, 7
    s_cmp_eq_u32 s51, 7
    s_cbranch_scc0 KM_SPX0
KM_RTX0:
    s_waitcnt lgkmcnt(4)
    v_mfma_f32_32x32x16_bf16 v[192:207], v[16:19], a[80:83], v[192:207]
    ds_read_b64_tr_b16 v[28:29], v61 offset:6144
    ds_read_b64_tr_b16 v[30:31], v61 offset:6656
    v_lshrrev_b32 v48, 4, v0
    v_lshl_or_b32 v49, v48, 2, s44
    v_and_b32 v50, 15, v0
    v_xor_b32 v49, v49, v50
    v_mfma_f32_32x32x16_bf16 v[208:223], v[16:19], a[84:87], v[208:223]
    v_cvt_pk_bf16_f32 v85, v90, v91
    s_waitcnt lgkmcnt(4)
    v_mfma_f32_32x32x16_bf16 v[224:239], v[20:23], a[80:83], v[224:239]
    ds_read_b64_tr_b16 v[16:17], v60 offset:8192
    ds_read_b64_tr_b16 v[18:19], v60 offset:8704
    v_mfma_f32_32x32x16_bf16 v[240:255], v[20:23], a[84:87], v[240:255]
    v_cvt_pk_bf16_f32 v86, v92, v93
    s_lshr_b32 s45, s24, 1
    s_lshl_b32 s45, s45, 2
    s_add_u32 s45, s45, s44
    s_waitcnt lgkmcnt(4)
    v_mfma_f32_32x32x16_bf16 v[192:207], v[24:27], a[88:91], v[192:207]
    ds_read_b64_tr_b16 v[20:21], v61 offset:8192
    ds_read_b64_tr_b16 v[22:23], v61 offset:8704
    v_mfma_f32_32x32x16_bf16 v[208:223], v[24:27], a[92:95], v[208:223]
    v_cvt_pk_bf16_f32 v87, v94, v95
    s_lshl_b32 s45, s45, 16
    s_lshl_b32 s46, s25, 8
    s_add_u32 s45, s45, s46
    s_waitcnt lgkmcnt(4)
    v_mfma_f32_32x32x16_bf16 v[224:239], v[28:31], a[88:91], v[224:239]
    ds_read_b64_tr_b16 v[24:25], v60 offset:10240
    ds_read_b64_tr_b16 v[26:27], v60 offset:10752
    v_mfma_f32_32x32x16_bf16 v[240:255], v[28:31], a[92:95], v[240:255]
    s_add_u32 s101, s100, 8704
    buffer_store_dwordx4 v[84:87], v15, s[96:99], s101 offen sc0 sc1
    v_lshlrev_b32 v48, 13, v48
    v_lshl_add_u32 v48, v49, 4, v48
    v_add_u32 v11, s45, v48
    s_waitcnt lgkmcnt(4)
    v_mfma_f32_32x32x16_bf16 v[192:207], v[16:19], a[96:99], v[192:207]
    ds_read_b64_tr_b16 v[28:29], v61 offset:10240
    ds_read_b64_tr_b16 v[30:31], v61 offset:10752
    v_mfma_f32_32x32x16_bf16 v[208:223], v[16:19], a[100:103], v[208:223]
    v_add_u32 v12, 31744, v11
    s_waitcnt lgkmcnt(4)
    v_mfma_f32_32x32x16_bf16 v[224:239], v[20:23], a[96:99], v[224:239]
    ds_read_b64_tr_b16 v[16:17], v60 offset:12288
    ds_read_b64_tr_b16 v[18:19], v60 offset:12800
    v_cvt_pk_bf16_f32 v96, v96, v97
    v_mfma_f32_32x32x16_bf16 v[240:255], v[20:23], a[100:103], v[240:255]
    s_waitcnt lgkmcnt(4)
    v_mfma_f32_32x32x16_bf16 v[192:207], v[24:27], a[104:107], v[192:207]
    ds_read_b64_tr_b16 v[20:21], v61 offset:12288
    ds_read_b64_tr_b16 v[22:23], v61 offset:12800
    v_cvt_pk_bf16_f32 v97, v98, v99
    v_add_u32 v13, 129024, v11
    v_mfma_f32_32x32x16_bf16 v[208:223], v[24:27], a[108:111], v[208:223]
    s_waitcnt lgkmcnt(4)
    v_mfma_f32_32x32x16_bf16 v[224:239], v[28:31], a[104:107], v[224:239]
    ds_read_b64_tr_b16 v[24:25], v60 offset:14336
    ds_read_b64_tr_b16 v[26:27], v60 offset:14848
    v_cvt_pk_bf16_f32 v98, v100, v101
    v_add_u32 v14, 160768, v11
    v_mfma_f32_32x32x16_bf16 v[240:255], v[28:31], a[108:111], v[240:255]
    s_waitcnt lgkmcnt(4)
    v_mfma_f32_32x32x16_bf16 v[192:207], v[16:19], a[112:115], v[192:207]
    ds_read_b64_tr_b16 v[28:29], v61 offset:14336
    ds_read_b64_tr_b16 v[30:31], v61 offset:14848
    v_cvt_pk_bf16_f32 v99, v102, v103
    v_mov_b32 v7, v1
    v_mfma_f32_32x32x16_bf16 v[208:223], v[16:19], a[116:119], v[208:223]
    s_waitcnt lgkmcnt(4)
    v_mfma_f32_32x32x16_bf16 v[224:239], v[20:23], a[112:115], v[224:239]
    s_barrier
    ds_read_b64_tr_b16 v[16:17], v60 offset:16384
    ds_read_b64_tr_b16 v[18:19], v60 offset:16896
    s_add_u32 s101, s100, 1024
    buffer_store_dwordx4 v[96:99], v15, s[96:99], s101 offen sc0 sc1
    v_mfma_f32_32x32x16_bf16 v[240:255], v[20:23], a[116:119], v[240:255]
    v_add_u32 v8, 18432, v1
    s_waitcnt lgkmcnt(4)
    v_mfma_f32_32x32x16_bf16 v[192:207], v[24:27], a[120:123], v[192:207]
    ds_read_b64_tr_b16 v[20:21], v61 offset:16384
    ds_read_b64_tr_b16 v[22:23], v61 offset:16896
    v_mfma_f32_32x32x16_bf16 v[208:223], v[24:27], a[124:127], v[208:223]
    v_cvt_pk_bf16_f32 v100, v104, v105
    v_add_u32 v9, 36864, v1
    s_waitcnt lgkmcnt(4)
    v_mfma_f32_32x32x16_bf16 v[224:239], v[28:31], a[120:123], v[224:239]
    ds_read_b64_tr_b16 v[24:25], v60 offset:18432
    ds_read_b64_tr_b16 v[26:27], v60 offset:18944
    v_mfma_f32_32x32x16_bf16 v[240:255], v[28:31], a[124:127], v[240:255]
    v_cvt_pk_bf16_f32 v101, v106, v107
    v_add_u32 v10, 55296, v1
    s_waitcnt lgkmcnt(4)
    v_mfma_f32_32x32x16_bf16 v[192:207], v[16:19], a[128:131], v[192:207]
    ds_read_b64_tr_b16 v[28:29], v61 offset:18432
    ds_read_b64_tr_b16 v[30:31], v61 offset:18944
    v_mfma_f32_32x32x16_bf16 v[208:223], v[16:19], a[132:135], v[208:223]
    v_cvt_pk_bf16_f32 v102, v108, v109
    s_lshl_b32 s47, s24, 12
    s_waitcnt lgkmcnt(4)
    v_mfma_f32_32x32x16_bf16 v[224:239], v[20:23], a[128:131], v[224:239]
    ds_read_b64_tr_b16 v[16:17], v60 offset:20480
    ds_read_b64_tr_b16 v[18:19], v60 offset:20992
    v_mfma_f32_32x32x16_bf16 v[240:255], v[20:23], a[132:135], v[240:255]
    v_cvt_pk_bf16_f32 v103, v110, v111
    s_waitcnt lgkmcnt(4)
    v_mfma_f32_32x32x16_bf16 v[192:207], v[24:27], a[136:139], v[192:207]
    ds_read_b64_tr_b16 v[20:21], v61 offset:20480
    ds_read_b64_tr_b16 v[22:23], v61 offset:20992
    s_add_u32 s8, s36, 0x2000000
    s_addc_u32 s9, s37, 0
    s_mov_b32 s10, 0x240000
    s_mov_b32 s11, 0x00020000
    v_mfma_f32_32x32x16_bf16 v[208:223], v[24:27], a[140:143], v[208:223]
    s_add_u32 s101, s100, 1536
    buffer_store_dwordx4 v[100:103], v15, s[96:99], s101 offen sc0 sc1
    s_waitcnt lgkmcnt(4)
    v_mfma_f32_32x32x16_bf16 v[224:239], v[28:31], a[136:139], v[224:239]
    ds_read_b64_tr_b16 v[24:25], v60 offset:22528
    ds_read_b64_tr_b16 v[26:27], v60 offset:23040
    s_mov_b32 s49, 0
    v_mfma_f32_32x32x16_bf16 v[240:255], v[28:31], a[140:143], v[240:255]
    s_waitcnt lgkmcnt(4)
    v_mfma_f32_32x32x16_bf16 v[192:207], v[16:19], a[144:147], v[192:207]
    ds_read_b64_tr_b16 v[28:29], v61 offset:22528
    ds_read_b64_tr_b16 v[30:31], v61 offset:23040
    v_cvt_pk_bf16_f32 v112, v112, v113
    s_add_u32 m0, s47, 16384
    v_mfma_f32_32x32x16_bf16 v[208:223], v[16:19], a[148:151], v[208:223]
    s_waitcnt lgkmcnt(4)
    v_mfma_f32_32x32x16_bf16 v[224:239], v[20:23], a[144:147], v[224:239]
    ds_read_b64_tr_b16 v[16:17], v60 offset:24576
    ds_read_b64_tr_b16 v[18:19], v60 offset:25088
    v_cvt_pk_bf16_f32 v113, v114, v115
    buffer_load_dwordx4 v11, s[4:7], s49 offen offset:0 lds
    v_mfma_f32_32x32x16_bf16 v[240:255], v[20:23], a[148:151], v[240:255]
    s_waitcnt lgkmcnt(4)
    v_mfma_f32_32x32x16_bf16 v[192:207], v[24:27], a[152:155], v[192:207]
    ds_read_b64_tr_b16 v[20:21], v61 offset:24576
    ds_read_b64_tr_b16 v[22:23], v61 offset:25088
    v_cvt_pk_bf16_f32 v114, v116, v117
    v_mfma_f32_32x32x16_bf16 v[208:223], v[24:27], a[156:159], v[208:223]
    buffer_load_dwordx4 v12, s[4:7], s49 offen offset:1024 lds
    s_waitcnt lgkmcnt(4)
    v_mfma_f32_32x32x16_bf16 v[224:239], v[28:31], a[152:155], v[224:239]
    ds_read_b64_tr_b16 v[24:25], v60 offset:26624
    ds_read_b64_tr_b16 v[26:27], v60 offset:27136
    v_cvt_pk_bf16_f32 v115, v118, v119
    v_mfma_f32_32x32x16_bf16 v[240:255], v[28:31], a[156:159], v[240:255]
    buffer_load_dwordx4 v13, s[4:7], s49 offen offset:2048 lds
    s_waitcnt lgkmcnt(4)
    v_mfma_f32_32x32x16_bf16 v[192:207], v[16:19], a[160:163], v[192:207]
    ds_read_b64_tr_b16 v[28:29], v61 offset:26624
    ds_read_b64_tr_b16 v[30:31], v61 offset:27136
    s_add_u32 s101, s100, 9216
    buffer_store_dwordx4 v[112:115], v15, s[96:99], s101 offen sc0 sc1
    v_mfma_f32_32x32x16_bf16 v[208:223], v[16:19], a[164:167], v[208:223]
    buffer_load_dwordx4 v14, s[4:7], s49 offen offset:3072 lds
    s_waitcnt lgkmcnt(4)
    v_mfma_f32_32x32x16_bf16 v[224:239], v[20:23], a[160:163], v[224:239]
    ds_read_b64_tr_b16 v[16:17], v60 offset:28672
    ds_read_b64_tr_b16 v[18:19], v60 offset:29184
    v_mfma_f32_32x32x16_bf16 v[240:255], v[20:23], a[164:167], v[240:255]
    v_cvt_pk_bf16_f32 v116, v120, v121
    s_waitcnt lgkmcnt(4)
    v_mfma_f32_32x32x16_bf16 v[192:207], v[24:27], a[168:171], v[192:207]
    ds_read_b64_tr_b16 v[20:21], v61 offset:28672
    ds_read_b64_tr_b16 v[22:23], v61 offset:29184
    s_lshl_b32 s39, s25, 20
    s_add_u32 s12, s36, s39
    s_addc_u32 s13, s37, 0
    v_mfma_f32_32x32x16_bf16 v[208:223], v[24:27], a[172:175], v[208:223]
    v_cvt_pk_bf16_f32 v117, v122, v123
    s_add_u32 s14, s38, 1
    s_lshl_b32 s14, s14, 16
    s_mov_b32 s15, 0x00020000
    s_waitcnt lgkmcnt(4)
    v_mfma_f32_32x32x16_bf16 v[224:239], v[28:31], a[168:171], v[224:239]
    ds_read_b64_tr_b16 v[24:25], v60 offset:30720
    ds_read_b64_tr_b16 v[26:27], v60 offset:31232
    v_mfma_f32_32x32x16_bf16 v[240:255], v[28:31], a[172:175], v[240:255]
    v_cvt_pk_bf16_f32 v118, v124, v125
    s_add_u32 s16, s36, 0x2400000
    s_addc_u32 s17, s37, 0
    s_mov_b32 s18, 0x1000000
    s_mov_b32 s19, 0x00020000
    s_waitcnt lgkmcnt(4)
    v_mfma_f32_32x32x16_bf16 v[192:207], v[16:19], a[176:179], v[192:207]
    ds_read_b64_tr_b16 v[28:29], v61 offset:30720
    ds_read_b64_tr_b16 v[30:31], v61 offset:31232
    v_mfma_f32_32x32x16_bf16 v[208:223], v[16:19], a[180:183], v[208:223]
    v_cvt_pk_bf16_f32 v119, v126, v127
    v_add_u32 v2, 4096, v1
    s_waitcnt lgkmcnt(4)
    v_mfma_f32_32x32x16_bf16 v[224:239], v[20:23], a[176:179], v[224:239]
    s_barrier
    ds_read_b64_tr_b16 v[16:17], v56 offset:32768
    ds_read_b64_tr_b16 v[18:19], v56 offset:33280
    v_mfma_f32_32x32x16_bf16 v[240:255], v[20:23], a[180:183], v[240:255]
    s_add_u32 s101, s100, 9728
    buffer_store_dwordx4 v[116:119], v15, s[96:99], s101 offen sc0 sc1
    s_lshl_b32 s39, s26, 1
    s_add_u32 s39, s39, s44
    s_sub_u32 s28, 16, s39
    s_waitcnt lgkmcnt(4)
    v_mfma_f32_32x32x16_bf16 v[192:207], v[24:27], a[184:187], v[192:207]
    ds_read_b64_tr_b16 v[20:21], v57 offset:32768
    ds_read_b64_tr_b16 v[22:23], v57 offset:33280
    v_mfma_f32_32x32x16_bf16 v[208:223], v[24:27], a[188:191], v[208:223]
    s_mov_b32 s40, 491520
    s_mov_b32 s43, 65536
    s_mov_b32 s42, 16384
    s_mov_b32 s41, 4294926336
    s_waitcnt lgkmcnt(4)
    v_mfma_f32_32x32x16_bf16 v[224:239], v[28:31], a[184:187], v[224:239]
    ds_read_b64_tr_b16 v[24:25], v56 offset:34816
    ds_read_b64_tr_b16 v[26:27], v56 offset:35328
    v_cvt_pk_bf16_f32 v144, v144, v145
    v_mfma_f32_32x32x16_bf16 v[240:255], v[28:31], a[188:191], v[240:255]
    v_cvt_pk_bf16_f32 v145, v146, v147
    s_cmp_eq_u32 s24, 1
    s_cselect_b32 s40, 540672, s40
    s_cselect_b32 s43, 98304, s43
    s_cselect_b32 s42, 0, s42
    s_waitcnt lgkmcnt(4)
    v_mfma_f32_32x32x16_bf16 v[192:207], v[16:19], a[192:195], v[192:207]
    ds_read_b64_tr_b16 v[28:29], v57 offset:34816
    ds_read_b64_tr_b16 v[30:31], v57 offset:35328
    v_mfma_f32_32x32x16_bf16 v[208:223], v[16:19], a[196:199], v[208:223]
    v_cvt_pk_bf16_f32 v146, v148, v149
    s_cmp_eq_u32 s24, 2
    s_cselect_b32 s40, 540672, s40
    s_cselect_b32 s43, 32768, s43
    s_cselect_b32 s42, 0, s42
    s_waitcnt lgkmcnt(4)
    v_mfma_f32_32x32x16_bf16 v[224:239], v[20:23], a[192:195], v[224:239]
    ds_read_b64_tr_b16 v[16:17], v56 offset:36864
    ds_read_b64_tr_b16 v[18:19], v56 offset:37376
    v_mfma_f32_32x32x16_bf16 v[240:255], v[20:23], a[196:199], v[240:255]
    v_cvt_pk_bf16_f32 v147, v150, v151
    s_cmp_eq_u32 s24, 3
    s_cselect_b32 s40, 557056, s40
    s_cselect_b32 s43, 0, s43
    s_waitcnt lgkmcnt(4)
    v_mfma_f32_32x32x16_bf16 v[192:207], v[24:27], a[200:203], v[192:207]
    ds_read_b64_tr_b16 v[20:21], v57 offset:36864
    ds_read_b64_tr_b16 v[22:23], v57 offset:37376
    s_cmp_ge_u32 s24, 2
    s_cselect_b32 s41, 24576, s41
    v_mfma_f32_32x32x16_bf16 v[208:223], v[24:27], a[204:207], v[208:223]
    s_add_u32 s101, s100, 10240
    buffer_store_dwordx4 v[144:147], v15, s[96:99], s101 offen sc0 sc1
    s_waitcnt lgkmcnt(4)
    v_mfma_f32_32x32x16_bf16 v[224:239], v[28:31], a[200:203], v[224:239]
    ds_read_b64_tr_b16 v[24:25], v56 offset:38912
    ds_read_b64_tr_b16 v[26:27], v56 offset:39424
    v_bfe_u32 v48, v0, 4, 1
    v_bfe_u32 v49, v0, 2, 2
    v_lshrrev_b32 v50, 5, v0
    v_mfma_f32_32x32x16_bf16 v[240:255], v[28:31], a[204:207], v[240:255]
    v_cvt_pk_bf16_f32 v148, v152, v153
    s_waitcnt lgkmcnt(4)
    v_mfma_f32_32x32x16_bf16 v[192:207], v[16:19], a[208:211], v[192:207]
    ds_read_b64_tr_b16 v[28:29], v57 offset:38912
    ds_read_b64_tr_b16 v[30:31], v57 offset:39424
    v_lshlrev_b32 v51, 12, v48
    v_lshl_add_u32 v51, v50, 11, v51
    v_lshl_add_u32 v51, v49, 8, v51
    v_mfma_f32_32x32x16_bf16 v[208:223], v[16:19], a[212:215], v[208:223]
    v_cvt_pk_bf16_f32 v149, v154, v155
    s_waitcnt lgkmcnt(4)
    v_mfma_f32_32x32x16_bf16 v[224:239], v[20:23], a[208:211], v[224:239]
    ds_read_b64_tr_b16 v[16:17], v56 offset:40960
    ds_read_b64_tr_b16 v[18:19], v56 offset:41472
    v_lshl_add_u32 v51, v49, 6, v51
    v_lshl_add_u32 v51, v48, 4, v51
    v_mfma_f32_32x32x16_bf16 v[240:255], v[20:23], a[212:215], v[240:255]
    v_cvt_pk_bf16_f32 v150, v156, v157
    s_waitcnt lgkmcnt(4)
    v_mfma_f32_32x32x16_bf16 v[192:207], v[24:27], a[216:219], v[192:207]
    ds_read_b64_tr_b16 v[20:21], v57 offset:40960
    ds_read_b64_tr_b16 v[22:23], v57 offset:41472
    v_bfe_u32 v52, v0, 1, 1
    v_lshl_add_u32 v51, v52, 5, v51
    v_and_b32 v52, 1, v0
    v_lshl_add_u32 v51, v52, 3, v51
    v_mfma_f32_32x32x16_bf16 v[208:223], v[24:27], a[220:223], v[208:223]
    v_cvt_pk_bf16_f32 v151, v158, v159
    s_waitcnt lgkmcnt(4)
    v_mfma_f32_32x32x16_bf16 v[224:239], v[28:31], a[216:219], v[224:239]
    ds_read_b64_tr_b16 v[24:25], v56 offset:43008
    ds_read_b64_tr_b16 v[26:27], v56 offset:43520
    v_and_b32 v52, 15, v0
    v_lshlrev_b32 v50, 4, v50
    v_lshl_add_u32 v50, v48, 2, v50
    v_sub_u32 v5, v52, v50
    v_mfma_f32_32x32x16_bf16 v[240:255], v[28:31], a[220:223], v[240:255]
    s_add_u32 s101, s100, 10752
    buffer_store_dwordx4 v[148:151], v15, s[96:99], s101 offen sc0 sc1
    s_waitcnt lgkmcnt(4)
    v_mfma_f32_32x32x16_bf16 v[192:207], v[16:19], a[224:227], v[192:207]
    ds_read_b64_tr_b16 v[28:29], v57 offset:43008
    ds_read_b64_tr_b16 v[30:31], v57 offset:43520
    v_mov_b32 v6, 0xff800000
    v_mfma_f32_32x32x16_bf16 v[208:223], v[16:19], a[228:231], v[208:223]
    v_cvt_pk_bf16_f32 v176, v176, v177
    s_waitcnt lgkmcnt(4)
    v_mfma_f32_32x32x16_bf16 v[224:239], v[20:23], a[224:227], v[224:239]
    ds_read_b64_tr_b16 v[16:17], v56 offset:45056
    ds_read_b64_tr_b16 v[18:19], v56 offset:45568
    v_cvt_pk_bf16_f32 v177, v178, v179
    v_add_u32 v3, 0, v1
    v_add_u32 v4, 32768, v1
    v_mfma_f32_32x32x16_bf16 v[240:255], v[20:23], a[228:231], v[240:255]
    s_mov_b32 s52, 0x3e0293ee
    s_mov_b32 s53, 0x3e0293ee
    s_waitcnt lgkmcnt(4)
    v_mfma_f32_32x32x16_bf16 v[192:207], v[24:27], a[232:235], v[192:207]
    ds_read_b64_tr_b16 v[20:21], v57 offset:45056
    ds_read_b64_tr_b16 v[22:23], v57 offset:45568
    v_cvt_pk_bf16_f32 v178, v180, v181
    v_mfma_f32_32x32x16_bf16 v[208:223], v[24:27], a[236:239], v[208:223]
    s_add_u32 s56, s24, 1
    s_bfe_u32 s56, s56, 0x10001
    s_lshl_b32 s57, s56, 15
    s_waitcnt lgkmcnt(4)
    v_mfma_f32_32x32x16_bf16 v[224:239], v[28:31], a[232:235], v[224:239]
    ds_read_b64_tr_b16 v[24:25], v56 offset:47104
    ds_read_b64_tr_b16 v[26:27], v56 offset:47616
    v_cvt_pk_bf16_f32 v179, v182, v183
    v_mfma_f32_32x32x16_bf16 v[240:255], v[28:31], a[236:239], v[240:255]
    s_lshl_b32 s56, s56, 14
    s_add_u32 s56, s56, 131072
    s_waitcnt lgkmcnt(4)
    v_mfma_f32_32x32x16_bf16 v[192:207], v[16:19], a[240:243], v[192:207]
    ds_read_b64_tr_b16 v[28:29], v57 offset:47104
    ds_read_b64_tr_b16 v[30:31], v57 offset:47616
    s_add_u32 s101, s100, 11264
    buffer_store_dwordx4 v[176:179], v15, s[96:99], s101 offen sc0 sc1
    v_mfma_f32_32x32x16_bf16 v[208:223], v[16:19], a[244:247], v[208:223]
    s_mul_i32 s59, s2, 22528
    s_waitcnt lgkmcnt(4)
    v_mfma_f32_32x32x16_bf16 v[224:239], v[20:23], a[240:243], v[224:239]
    s_barrier
    ds_read_b64_tr_b16 v[16:17], v58 offset:16384
    ds_read_b64_tr_b16 v[18:19], v58 offset:16896
    v_cvt_pk_bf16_f32 v180, v184, v185
    v_mfma_f32_32x32x16_bf16 v[240:255], v[20:23], a[244:247], v[240:255]
    s_waitcnt lgkmcnt(0)
    v_mfma_f32_32x32x16_bf16 v[192:207], v[24:27], a[248:251], v[192:207]
    ds_read_b64_tr_b16 v[20:21], v59 offset:16384
    ds_read_b64_tr_b16 v[22:23], v59 offset:16896
    v_cvt_pk_bf16_f32 v181, v186, v187
    v_mfma_f32_32x32x16_bf16 v[208:223], v[24:27], a[252:255], v[208:223]
    s_mov_b32 s22, 4718592
    s_mov_b32 s23, 0x00020000
    s_mov_b32 s20, s54
    s_mov_b32 s21, s55
    v_mfma_f32_32x32x16_bf16 v[224:239], v[28:31], a[248:251], v[224:239]
    ds_read_b64_tr_b16 v[24:25], v58 offset:18432
    ds_read_b64_tr_b16 v[26:27], v58 offset:18944
    v_cvt_pk_bf16_f32 v182, v188, v189
    v_mfma_f32_32x32x16_bf16 v[240:255], v[28:31], a[252:255], v[240:255]
    s_cmp_eq_u32 s24, 0
    s_cselect_b32 s20, s60, s20
    s_cselect_b32 s21, s61, s21
    s_cselect_b32 s22, 5308416, s22
    v_mfma_f32_32x32x16_bf16 v[64:79], v[16:19], a[0:3], 0
    ds_read_b64_tr_b16 v[28:29], v59 offset:18432
    ds_read_b64_tr_b16 v[30:31], v59 offset:18944
    v_cvt_pk_bf16_f32 v183, v190, v191
    v_mfma_f32_32x32x16_bf16 v[80:95], v[16:19], a[4:7], 0
    s_cmp_eq_u32 s24, 1
    s_cselect_b32 s20, s62, s20
    s_cselect_b32 s21, s63, s21
    s_cselect_b32 s22, 5308416, s22
    s_waitcnt lgkmcnt(4)
    v_mfma_f32_32x32x16_bf16 v[96:111], v[20:23], a[0:3], 0
    ds_read_b64_tr_b16 v[16:17], v58 offset:20480
    ds_read_b64_tr_b16 v[18:19], v58 offset:20992
    s_add_u32 s101, s100, 11776
    buffer_store_dwordx4 v[180:183], v15, s[96:99], s101 offen sc0 sc1
    s_lshl_b32 s51, s25, 3
    s_add_u32 s51, s51, s26
    v_mfma_f32_32x32x16_bf16 v[112:127], v[20:23], a[4:7], 0
    s_waitcnt lgkmcnt(4)
    v_mfma_f32_32x32x16_bf16 v[64:79], v[24:27], a[8:11], v[64:79]
    ds_read_b64_tr_b16 v[20:21], v59 offset:20480
    ds_read_b64_tr_b16 v[22:23], v59 offset:20992
    v_cvt_pk_bf16_f32 v192, v192, v193
    v_cvt_pk_bf16_f32 v193, v194, v195
    s_lshl_b32 s70, s51, 1
    s_add_u32 s70, s70, s44
    s_mul_i32 s71, s70, 9216
    v_mfma_f32_32x32x16_bf16 v[80:95], v[24:27], a[12:15], v[80:95]
    v_cvt_pk_bf16_f32 v194, v196, v197
    s_waitcnt lgkmcnt(4)
    v_mfma_f32_32x32x16_bf16 v[96:111], v[28:31], a[8:11], v[96:111]
    ds_read_b64_tr_b16 v[24:25], v58 offset:22528
    ds_read_b64_tr_b16 v[26:27], v58 offset:23040
    v_cvt_pk_bf16_f32 v195, v198, v199
    s_cmp_ge_u32 s24, 2
    s_cselect_b32 s59, s71, s59
    s_cselect_b32 s69, 64, 1408
    v_mfma_f32_32x32x16_bf16 v[112:127], v[28:31], a[12:15], v[112:127]
    s_add_u32 s101, s100, 1048576
    buffer_store_dwordx4 v[192:195], v15, s[96:99], s101 offen sc0 sc1
    s_waitcnt lgkmcnt(4)
    v_mfma_f32_32x32x16_bf16 v[64:79], v[16:19], a[16:19], v[64:79]
    ds_read_b64_tr_b16 v[28:29], v59 offset:22528
    ds_read_b64_tr_b16 v[30:31], v59 offset:23040
    v_cvt_pk_bf16_f32 v196, v200, v201
    s_and_b32 s70, s70, 15
    s_lshl_b32 s70, s70, 8
    s_lshr_b32 s71, s51, 5
    s_lshl_b32 s71, s71, 12
    v_add_u32 v144, 16384, v51
    v_mfma_f32_32x32x16_bf16 v[80:95], v[16:19], a[20:23], v[80:95]
    v_cvt_pk_bf16_f32 v197, v202, v203
    s_waitcnt lgkmcnt(4)
    v_mfma_f32_32x32x16_bf16 v[96:111], v[20:23], a[16:19], v[96:111]
    ds_read_b64_tr_b16 v[16:17], v58 offset:24576
    ds_read_b64_tr_b16 v[18:19], v58 offset:25088
    v_cvt_pk_bf16_f32 v198, v204, v205
    s_add_u32 s70, s70, s71
    s_and_b32 s71, s51, 24
    s_add_u32 s70, s70, s71
    v_mfma_f32_32x32x16_bf16 v[112:127], v[20:23], a[20:23], v[112:127]
    v_cvt_pk_bf16_f32 v199, v206, v207
    v_xor_b32 v145, 16, v144
    s_waitcnt lgkmcnt(4)
    v_mfma_f32_32x32x16_bf16 v[64:79], v[24:27], a[24:27], v[64:79]
    ds_read_b64_tr_b16 v[20:21], v59 offset:24576
    ds_read_b64_tr_b16 v[22:23], v59 offset:25088
    s_add_u32 s101, s100, 1049088
    buffer_store_dwordx4 v[196:199], v15, s[96:99], s101 offen sc0 sc1
    s_add_u32 s70, s70, 262144
    v_mfma_f32_32x32x16_bf16 v[80:95], v[24:27], a[28:31], v[80:95]
    v_cvt_pk_bf16_f32 v208, v208, v209
    v_cvt_pk_bf16_f32 v209, v210, v211
    s_waitcnt lgkmcnt(4)
    v_mfma_f32_32x32x16_bf16 v[96:111], v[28:31], a[24:27], v[96:111]
    ds_read_b64_tr_b16 v[24:25], v58 offset:26624
    ds_read_b64_tr_b16 v[26:27], v58 offset:27136
    v_cvt_pk_bf16_f32 v210, v212, v213
    s_add_u32 s64, s36, 0x4300000
    s_addc_u32 s65, s37, 0
    s_mov_b32 s66, 0x1500000
    s_mov_b32 s67, 0x00020000
    v_xor_b32 v146, 64, v144
    v_mfma_f32_32x32x16_bf16 v[112:127], v[28:31], a[28:31], v[112:127]
    v_cvt_pk_bf16_f32 v211, v214, v215
    s_waitcnt lgkmcnt(4)
    v_mfma_f32_32x32x16_bf16 v[64:79], v[16:19], a[32:35], v[64:79]
    ds_read_b64_tr_b16 v[28:29], v59 offset:26624
    ds_read_b64_tr_b16 v[30:31], v59 offset:27136
    s_add_u32 s101, s100, 1056768
    buffer_store_dwordx4 v[208:211], v15, s[96:99], s101 offen sc0 sc1
    v_mfma_f32_32x32x16_bf16 v[80:95], v[16:19], a[36:39], v[80:95]
    v_cvt_pk_bf16_f32 v212, v216, v217
    v_xor_b32 v147, 80, v144
    s_waitcnt lgkmcnt(4)
    v_mfma_f32_32x32x16_bf16 v[96:111], v[20:23], a[32:35], v[96:111]
    ds_read_b64_tr_b16 v[16:17], v58 offset:28672
    ds_read_b64_tr_b16 v[18:19], v58 offset:29184
    v_cvt_pk_bf16_f32 v213, v218, v219
    v_mfma_f32_32x32x16_bf16 v[112:127], v[20:23], a[36:39], v[112:127]
    v_cvt_pk_bf16_f32 v214, v220, v221
    s_waitcnt lgkmcnt(4)
    v_mfma_f32_32x32x16_bf16 v[64:79], v[24:27], a[40:43], v[64:79]
    ds_read_b64_tr_b16 v[20:21], v59 offset:28672
    ds_read_b64_tr_b16 v[22:23], v59 offset:29184
    v_cvt_pk_bf16_f32 v215, v222, v223
    v_xor_b32 v148, 128, v144
    v_mfma_f32_32x32x16_bf16 v[80:95], v[24:27], a[44:47], v[80:95]
    s_add_u32 s101, s100, 1057280
    buffer_store_dwordx4 v[212:215], v15, s[96:99], s101 offen sc0 sc1
    s_waitcnt lgkmcnt(4)
    v_mfma_f32_32x32x16_bf16 v[96:111], v[28:31], a[40:43], v[96:111]
    ds_read_b64_tr_b16 v[24:25], v58 offset:30720
    ds_read_b64_tr_b16 v[26:27], v58 offset:31232
    v_cvt_pk_bf16_f32 v128, v128, v129
    v_mfma_f32_32x32x16_bf16 v[112:127], v[28:31], a[44:47], v[112:127]
    v_xor_b32 v149, 144, v144
    s_waitcnt lgkmcnt(4)
    v_mfma_f32_32x32x16_bf16 v[64:79], v[16:19], a[48:51], v[64:79]
    ds_read_b64_tr_b16 v[28:29], v59 offset:30720
    ds_read_b64_tr_b16 v[30:31], v59 offset:31232
    v_cvt_pk_bf16_f32 v129, v130, v131
    s_add_u32 s50, s48, 0
    v_mfma_f32_32x32x16_bf16 v[80:95], v[16:19], a[52:55], v[80:95]
    buffer_load_dwordx4 v[192:195], v7, s[8:11], s50 offen offset:0
    s_waitcnt lgkmcnt(4)
    v_mfma_f32_32x32x16_bf16 v[96:111], v[20:23], a[48:51], v[96:111]
    s_barrier
    ds_read_b64_tr_b16 v[16:17], v58 offset:0
    ds_read_b64_tr_b16 v[18:19], v58 offset:512
    v_xor_b32 v150, 192, v144
    v_mfma_f32_32x32x16_bf16 v[112:127], v[20:23], a[52:55], v[112:127]
    v_cvt_pk_bf16_f32 v130, v132, v133
    buffer_load_dwordx4 v[196:199], v8, s[8:11], s50 offen offset:0
    s_waitcnt lgkmcnt(4)
    v_mfma_f32_32x32x16_bf16 v[64:79], v[24:27], a[56:59], v[64:79]
    ds_read_b64_tr_b16 v[20:21], v59 offset:0
    ds_read_b64_tr_b16 v[22:23], v59 offset:512
    v_mfma_f32_32x32x16_bf16 v[80:95], v[24:27], a[60:63], v[80:95]
    v_cvt_pk_bf16_f32 v131, v134, v135
    v_xor_b32 v151, 208, v144
    buffer_load_dwordx4 v[200:203], v9, s[8:11], s50 offen offset:0
    s_waitcnt lgkmcnt(4)
    v_mfma_f32_32x32x16_bf16 v[96:111], v[28:31], a[56:59], v[96:111]
    ds_read_b64_tr_b16 v[24:25], v58 offset:2048
    ds_read_b64_tr_b16 v[26:27], v58 offset:2560
    buffer_load_dwordx4 v[204:207], v10, s[8:11], s50 offen offset:0
    v_mfma_f32_32x32x16_bf16 v[112:127], v[28:31], a[60:63], v[112:127]
    s_waitcnt lgkmcnt(4)
    v_mfma_f32_32x32x16_bf16 v[64:79], v[16:19], a[64:67], v[64:79]
    ds_read_b64_tr_b16 v[28:29], v59 offset:2048
    ds_read_b64_tr_b16 v[30:31], v59 offset:2560
    s_add_u32 s101, s100, 2048
    buffer_store_dwordx4 v[128:131], v15, s[96:99], s101 offen sc0 sc1
    v_add_u32 v184, 65536, v144
    buffer_load_dwordx4 v[208:211], v7, s[8:11], s50 offen offset:1024
    v_mfma_f32_32x32x16_bf16 v[80:95], v[16:19], a[68:71], v[80:95]
    s_waitcnt lgkmcnt(4)
    v_mfma_f32_32x32x16_bf16 v[96:111], v[20:23], a[64:67], v[96:111]
    ds_read_b64_tr_b16 v[16:17], v58 offset:4096
    ds_read_b64_tr_b16 v[18:19], v58 offset:4608
    v_cvt_pk_bf16_f32 v132, v136, v137
    buffer_load_dwordx4 v[212:215], v8, s[8:11], s50 offen offset:1024
    v_mfma_f32_32x32x16_bf16 v[112:127], v[20:23], a[68:71], v[112:127]
    v_add_u32 v185, 65536, v145
    buffer_load_dwordx4 v[216:219], v9, s[8:11], s50 offen offset:1024
    s_waitcnt lgkmcnt(4)
    v_mfma_f32_32x32x16_bf16 v[64:79], v[24:27], a[72:75], v[64:79]
    ds_read_b64_tr_b16 v[20:21], v59 offset:4096
    ds_read_b64_tr_b16 v[22:23], v59 offset:4608
    v_mfma_f32_32x32x16_bf16 v[80:95], v[24:27], a[76:79], v[80:95]
    v_cvt_pk_bf16_f32 v133, v138, v139
    buffer_load_dwordx4 v[220:223], v10, s[8:11], s50 offen offset:1024
    s_waitcnt lgkmcnt(4)
    v_mfma_f32_32x32x16_bf16 v[96:111], v[28:31], a[72:75], v[96:111]
    ds_read_b64_tr_b16 v[24:25], v58 offset:6144
    ds_read_b64_tr_b16 v[26:27], v58 offset:6656
    v_add_u32 v186, 65536, v146
    v_mfma_f32_32x32x16_bf16 v[112:127], v[28:31], a[76:79], v[112:127]
    v_cvt_pk_bf16_f32 v134, v140, v141
    s_mov_b32 s49, 524288
    s_waitcnt lgkmcnt(4)
    v_mfma_f32_32x32x16_bf16 v[64:79], v[16:19], a[80:83], v[64:79]
    ds_read_b64_tr_b16 v[28:29], v59 offset:6144
    ds_read_b64_tr_b16 v[30:31], v59 offset:6656
    v_mfma_f32_32x32x16_bf16 v[80:95], v[16:19], a[84:87], v[80:95]
    v_add_u32 v187, 65536, v147
    s_add_u32 m0, s47, 32768
    s_waitcnt lgkmcnt(4)
    v_mfma_f32_32x32x16_bf16 v[96:111], v[20:23], a[80:83], v[96:111]
    ds_read_b64_tr_b16 v[16:17], v58 offset:8192
    ds_read_b64_tr_b16 v[18:19], v58 offset:8704
    v_cvt_pk_bf16_f32 v135, v142, v143
    buffer_load_dwordx4 v11, s[4:7], s49 offen offset:0 lds
    v_mfma_f32_32x32x16_bf16 v[112:127], v[20:23], a[84:87], v[112:127]
    s_waitcnt lgkmcnt(4)
    v_mfma_f32_32x32x16_bf16 v[64:79], v[24:27], a[88:91], v[64:79]
    ds_read_b64_tr_b16 v[20:21], v59 offset:8192
    ds_read_b64_tr_b16 v[22:23], v59 offset:8704
    s_add_u32 s101, s100, 2560
    buffer_store_dwordx4 v[132:135], v15, s[96:99], s101 offen sc0 sc1
    v_add_u32 v188, 65536, v148
    buffer_load_dwordx4 v12, s[4:7], s49 offen offset:1024 lds
    v_mfma_f32_32x32x16_bf16 v[80:95], v[24:27], a[92:95], v[80:95]
    s_waitcnt lgkmcnt(4)
    v_mfma_f32_32x32x16_bf16 v[96:111], v[28:31], a[88:91], v[96:111]
    ds_read_b64_tr_b16 v[24:25], v58 offset:10240
    ds_read_b64_tr_b16 v[26:27], v58 offset:10752
    buffer_load_dwordx4 v13, s[4:7], s49 offen offset:2048 lds
    v_mfma_f32_32x32x16_bf16 v[112:127], v[28:31], a[92:95], v[112:127]
    v_cvt_pk_bf16_f32 v160, v160, v161
    v_add_u32 v189, 65536, v149
    buffer_load_dwordx4 v14, s[4:7], s49 offen offset:3072 lds
    s_waitcnt lgkmcnt(4)
    v_mfma_f32_32x32x16_bf16 v[64:79], v[16:19], a[96:99], v[64:79]
    ds_read_b64_tr_b16 v[28:29], v59 offset:10240
    ds_read_b64_tr_b16 v[30:31], v59 offset:10752
    v_mfma_f32_32x32x16_bf16 v[80:95], v[16:19], a[100:103], v[80:95]
    s_add_u32 s50, s48, 2048
    s_waitcnt lgkmcnt(4)
    v_mfma_f32_32x32x16_bf16 v[96:111], v[20:23], a[96:99], v[96:111]
    ds_read_b64_tr_b16 v[16:17], v58 offset:12288
    ds_read_b64_tr_b16 v[18:19], v58 offset:12800
    v_cvt_pk_bf16_f32 v161, v162, v163
    v_add_u32 v190, 65536, v150
    v_mfma_f32_32x32x16_bf16 v[112:127], v[20:23], a[100:103], v[112:127]
    buffer_load_dwordx4 a[0:3], v7, s[8:11], s50 offen offset:0
    s_waitcnt lgkmcnt(4)
    v_mfma_f32_32x32x16_bf16 v[64:79], v[24:27], a[104:107], v[64:79]
    ds_read_b64_tr_b16 v[20:21], v59 offset:12288
    ds_read_b64_tr_b16 v[22:23], v59 offset:12800
    v_cvt_pk_bf16_f32 v162, v164, v165
    buffer_load_dwordx4 a[4:7], v8, s[8:11], s50 offen offset:0
    v_mfma_f32_32x32x16_bf16 v[80:95], v[24:27], a[108:111], v[80:95]
    v_add_u32 v191, 65536, v151
    s_waitcnt lgkmcnt(4)
    v_mfma_f32_32x32x16_bf16 v[96:111], v[28:31], a[104:107], v[96:111]
    ds_read_b64_tr_b16 v[24:25], v58 offset:14336
    ds_read_b64_tr_b16 v[26:27], v58 offset:14848
    buffer_load_dwordx4 a[8:11], v9, s[8:11], s50 offen offset:0
    v_mfma_f32_32x32x16_bf16 v[112:127], v[28:31], a[108:111], v[112:127]
    v_cvt_pk_bf16_f32 v163, v166, v167
    s_waitcnt lgkmcnt(4)
    v_mfma_f32_32x32x16_bf16 v[64:79], v[16:19], a[112:115], v[64:79]
    ds_read_b64_tr_b16 v[28:29], v59 offset:14336
    ds_read_b64_tr_b16 v[30:31], v59 offset:14848
    buffer_load_dwordx4 a[12:15], v10, s[8:11], s50 offen offset:0
    v_mfma_f32_32x32x16_bf16 v[80:95], v[16:19], a[116:119], v[80:95]
    s_add_u32 s101, s100, 3072
    buffer_store_dwordx4 v[160:163], v15, s[96:99], s101 offen sc0 sc1
    s_waitcnt lgkmcnt(4)
    v_mfma_f32_32x32x16_bf16 v[96:111], v[20:23], a[112:115], v[96:111]
    s_barrier
    ds_read_b64_tr_b16 v[16:17], v56 offset:49152
    ds_read_b64_tr_b16 v[18:19], v56 offset:49664
    buffer_load_dwordx4 a[16:19], v7, s[8:11], s50 offen offset:1024
    v_mfma_f32_32x32x16_bf16 v[112:127], v[20:23], a[116:119], v[112:127]
    buffer_load_dwordx4 a[20:23], v8, s[8:11], s50 offen offset:1024
    s_waitcnt lgkmcnt(4)
    v_mfma_f32_32x32x16_bf16 v[64:79], v[24:27], a[120:123], v[64:79]
    ds_read_b64_tr_b16 v[20:21], v57 offset:49152
    ds_read_b64_tr_b16 v[22:23], v57 offset:49664
    v_cvt_pk_bf16_f32 v164, v168, v169
    v_mfma_f32_32x32x16_bf16 v[80:95], v[24:27], a[124:127], v[80:95]
    buffer_load_dwordx4 a[24:27], v9, s[8:11], s50 offen offset:1024
    s_waitcnt lgkmcnt(4)
    v_mfma_f32_32x32x16_bf16 v[96:111], v[28:31], a[120:123], v[96:111]
    ds_read_b64_tr_b16 v[24:25], v56 offset:51200
    ds_read_b64_tr_b16 v[26:27], v56 offset:51712
    v_cvt_pk_bf16_f32 v165, v170, v171
    v_mfma_f32_32x32x16_bf16 v[112:127], v[28:31], a[124:127], v[112:127]
    buffer_load_dwordx4 a[28:31], v10, s[8:11], s50 offen offset:1024
    s_waitcnt lgkmcnt(4)
    v_mfma_f32_32x32x16_bf16 v[64:79], v[16:19], a[128:131], v[64:79]
    ds_read_b64_tr_b16 v[28:29], v57 offset:51200
    ds_read_b64_tr_b16 v[30:31], v57 offset:51712
    s_mov_b32 s49, 1048576
    v_mfma_f32_32x32x16_bf16 v[80:95], v[16:19], a[132:135], v[80:95]
    v_cvt_pk_bf16_f32 v166, v172, v173
    s_waitcnt lgkmcnt(4)
    v_mfma_f32_32x32x16_bf16 v[96:111], v[20:23], a[128:131], v[96:111]
    ds_read_b64_tr_b16 v[16:17], v56 offset:53248
    ds_read_b64_tr_b16 v[18:19], v56 offset:53760
    s_add_u32 m0, s47, 81920
    v_mfma_f32_32x32x16_bf16 v[112:127], v[20:23], a[132:135], v[112:127]
    v_cvt_pk_bf16_f32 v167, v174, v175
    s_waitcnt lgkmcnt(4)
    v_mfma_f32_32x32x16_bf16 v[64:79], v[24:27], a[136:139], v[64:79]
    ds_read_b64_tr_b16 v[20:21], v57 offset:53248
    ds_read_b64_tr_b16 v[22:23], v57 offset:53760
    buffer_load_dwordx4 v11, s[4:7], s49 offen offset:0 lds
    v_mfma_f32_32x32x16_bf16 v[80:95], v[24:27], a[140:143], v[80:95]
    s_waitcnt lgkmcnt(4)
    v_mfma_f32_32x32x16_bf16 v[96:111], v[28:31], a[136:139], v[96:111]
    ds_read_b64_tr_b16 v[24:25], v56 offset:55296
    ds_read_b64_tr_b16 v[26:27], v56 offset:55808
    s_add_u32 s101, s100, 3584
    buffer_store_dwordx4 v[164:167], v15, s[96:99], s101 offen sc0 sc1
    buffer_load_dwordx4 v12, s[4:7], s49 offen offset:1024 lds
    v_mfma_f32_32x32x16_bf16 v[112:127], v[28:31], a[140:143], v[112:127]
    buffer_load_dwordx4 v13, s[4:7], s49 offen offset:2048 lds
    s_waitcnt lgkmcnt(4)
    v_mfma_f32_32x32x16_bf16 v[64:79], v[16:19], a[144:147], v[64:79]
    ds_read_b64_tr_b16 v[28:29], v57 offset:55296
    ds_read_b64_tr_b16 v[30:31], v57 offset:55808
    v_mfma_f32_32x32x16_bf16 v[80:95], v[16:19], a[148:151], v[80:95]
    v_cvt_pk_bf16_f32 v224, v224, v225
    buffer_load_dwordx4 v14, s[4:7], s49 offen offset:3072 lds
    s_waitcnt lgkmcnt(4)
    v_mfma_f32_32x32x16_bf16 v[96:111], v[20:23], a[144:147], v[96:111]
    ds_read_b64_tr_b16 v[16:17], v56 offset:57344
    ds_read_b64_tr_b16 v[18:19], v56 offset:57856
    v_mfma_f32_32x32x16_bf16 v[112:127], v[20:23], a[148:151], v[112:127]
    v_cvt_pk_bf16_f32 v225, v226, v227
    s_add_u32 s50, s48, 4096
    s_waitcnt lgkmcnt(4)
    v_mfma_f32_32x32x16_bf16 v[64:79], v[24:27], a[152:155], v[64:79]
    ds_read_b64_tr_b16 v[20:21], v57 offset:57344
    ds_read_b64_tr_b16 v[22:23], v57 offset:57856
    buffer_load_dwordx4 a[32:35], v7, s[8:11], s50 offen offset:0
    v_mfma_f32_32x32x16_bf16 v[80:95], v[24:27], a[156:159], v[80:95]
    s_waitcnt lgkmcnt(4)
    v_mfma_f32_32x32x16_bf16 v[96:111], v[28:31], a[152:155], v[96:111]
    ds_read_b64_tr_b16 v[24:25], v56 offset:59392
    ds_read_b64_tr_b16 v[26:27], v56 offset:59904
    v_cvt_pk_bf16_f32 v226, v228, v229
    buffer_load_dwordx4 a[36:39], v8, s[8:11], s50 offen offset:0
    v_mfma_f32_32x32x16_bf16 v[112:127], v[28:31], a[156:159], v[112:127]
    s_waitcnt lgkmcnt(4)
    v_mfma_f32_32x32x16_bf16 v[64:79], v[16:19], a[160:163], v[64:79]
    ds_read_b64_tr_b16 v[28:29], v57 offset:59392
    ds_read_b64_tr_b16 v[30:31], v57 offset:59904
    v_cvt_pk_bf16_f32 v227, v230, v231
    buffer_load_dwordx4 a[40:43], v9, s[8:11], s50 offen offset:0
    v_mfma_f32_32x32x16_bf16 v[80:95], v[16:19], a[164:167], v[80:95]
    buffer_load_dwordx4 a[44:47], v10, s[8:11], s50 offen offset:0
    s_waitcnt lgkmcnt(4)
    v_mfma_f32_32x32x16_bf16 v[96:111], v[20:23], a[160:163], v[96:111]
    ds_read_b64_tr_b16 v[16:17], v56 offset:61440
    ds_read_b64_tr_b16 v[18:19], v56 offset:61952
    v_mfma_f32_32x32x16_bf16 v[112:127], v[20:23], a[164:167], v[112:127]
    s_add_u32 s101, s100, 1049600
    buffer_store_dwordx4 v[224:227], v15, s[96:99], s101 offen sc0 sc1
    buffer_load_dwordx4 a[48:51], v7, s[8:11], s50 offen offset:1024
    s_waitcnt lgkmcnt(4)
    v_mfma_f32_32x32x16_bf16 v[64:79], v[24:27], a[168:171], v[64:79]
    ds_read_b64_tr_b16 v[20:21], v57 offset:61440
    ds_read_b64_tr_b16 v[22:23], v57 offset:61952
    v_mfma_f32_32x32x16_bf16 v[80:95], v[24:27], a[172:175], v[80:95]
    v_cvt_pk_bf16_f32 v228, v232, v233
    buffer_load_dwordx4 a[52:55], v8, s[8:11], s50 offen offset:1024
    s_waitcnt lgkmcnt(4)
    v_mfma_f32_32x32x16_bf16 v[96:111], v[28:31], a[168:171], v[96:111]
    ds_read_b64_tr_b16 v[24:25], v56 offset:63488
    ds_read_b64_tr_b16 v[26:27], v56 offset:64000
    v_mfma_f32_32x32x16_bf16 v[112:127], v[28:31], a[172:175], v[112:127]
    buffer_load_dwordx4 a[56:59], v9, s[8:11], s50 offen offset:1024
    s_waitcnt lgkmcnt(4)
    v_mfma_f32_32x32x16_bf16 v[64:79], v[16:19], a[176:179], v[64:79]
    ds_read_b64_tr_b16 v[28:29], v57 offset:63488
    ds_read_b64_tr_b16 v[30:31], v57 offset:64000
    v_cvt_pk_bf16_f32 v229, v234, v235
    buffer_load_dwordx4 a[60:63], v10, s[8:11], s50 offen offset:1024
    v_mfma_f32_32x32x16_bf16 v[80:95], v[16:19], a[180:183], v[80:95]
    s_waitcnt lgkmcnt(4)
    v_mfma_f32_32x32x16_bf16 v[96:111], v[20:23], a[176:179], v[96:111]
    s_waitcnt vmcnt(56)
    s_barrier
    ds_read_b64_tr_b16 v[16:17], v58 offset:49152
    ds_read_b64_tr_b16 v[18:19], v58 offset:49664
    v_cvt_pk_bf16_f32 v230, v236, v237
    s_mov_b32 s49, 1572864
    v_mfma_f32_32x32x16_bf16 v[112:127], v[20:23], a[180:183], v[112:127]
    s_waitcnt lgkmcnt(4)
    v_mfma_f32_32x32x16_bf16 v[64:79], v[24:27], a[184:187], v[64:79]
    ds_read_b64_tr_b16 v[20:21], v59 offset:49152
    ds_read_b64_tr_b16 v[22:23], v59 offset:49664
    s_add_u32 m0, s47, 98304
    v_mfma_f32_32x32x16_bf16 v[80:95], v[24:27], a[188:191], v[80:95]
    v_cvt_pk_bf16_f32 v231, v238, v239
    buffer_load_dwordx4 v11, s[4:7], s49 offen offset:0 lds
    s_waitcnt lgkmcnt(4)
    v_mfma_f32_32x32x16_bf16 v[96:111], v[28:31], a[184:187], v[96:111]
    ds_read_b64_tr_b16 v[24:25], v58 offset:51200
    ds_read_b64_tr_b16 v[26:27], v58 offset:51712
    v_mfma_f32_32x32x16_bf16 v[112:127], v[28:31], a[188:191], v[112:127]
    s_add_u32 s101, s100, 1050112
    buffer_store_dwordx4 v[228:231], v15, s[96:99], s101 offen sc0 sc1
    buffer_load_dwordx4 v12, s[4:7], s49 offen offset:1024 lds
    s_waitcnt lgkmcnt(4)
    v_mfma_f32_32x32x16_bf16 v[64:79], v[16:19], a[192:195], v[64:79]
    ds_read_b64_tr_b16 v[28:29], v59 offset:51200
    ds_read_b64_tr_b16 v[30:31], v59 offset:51712
    v_mfma_f32_32x32x16_bf16 v[80:95], v[16:19], a[196:199], v[80:95]
    buffer_load_dwordx4 v13, s[4:7], s49 offen offset:2048 lds
    s_waitcnt lgkmcnt(4)
    v_mfma_f32_32x32x16_bf16 v[96:111], v[20:23], a[192:195], v[96:111]
    ds_read_b64_tr_b16 v[16:17], v58 offset:53248
    ds_read_b64_tr_b16 v[18:19], v58 offset:53760
    v_cvt_pk_bf16_f32 v240, v240, v241
    buffer_load_dwordx4 v14, s[4:7], s49 offen offset:3072 lds
    v_mfma_f32_32x32x16_bf16 v[112:127], v[20:23], a[196:199], v[112:127]
    s_waitcnt lgkmcnt(4)
    v_mfma_f32_32x32x16_bf16 v[64:79], v[24:27], a[200:203], v[64:79]
    ds_read_b64_tr_b16 v[20:21], v59 offset:53248
    ds_read_b64_tr_b16 v[22:23], v59 offset:53760
    s_add_u32 s50, s48, 6144
    v_mfma_f32_32x32x16_bf16 v[80:95], v[24:27], a[204:207], v[80:95]
    v_cvt_pk_bf16_f32 v241, v242, v243
    s_waitcnt lgkmcnt(4)
    v_mfma_f32_32x32x16_bf16 v[96:111], v[28:31], a[200:203], v[96:111]
    ds_read_b64_tr_b16 v[24:25], v58 offset:55296
    ds_read_b64_tr_b16 v[26:27], v58 offset:55808
    buffer_load_dwordx4 a[64:67], v7, s[8:11], s50 offen offset:0
    v_mfma_f32_32x32x16_bf16 v[112:127], v[28:31], a[204:207], v[112:127]
    v_cvt_pk_bf16_f32 v242, v244, v245
    s_waitcnt lgkmcnt(4)
    v_mfma_f32_32x32x16_bf16 v[64:79], v[16:19], a[208:211], v[64:79]
    ds_read_b64_tr_b16 v[28:29], v59 offset:55296
    ds_read_b64_tr_b16 v[30:31], v59 offset:55808
    buffer_load_dwordx4 a[68:71], v8, s[8:11], s50 offen offset:0
    v_mfma_f32_32x32x16_bf16 v[80:95], v[16:19], a[212:215], v[80:95]
    buffer_load_dwordx4 a[72:75], v9, s[8:11], s50 offen offset:0
    s_waitcnt lgkmcnt(4)
    v_mfma_f32_32x32x16_bf16 v[96:111], v[20:23], a[208:211], v[96:111]
    ds_read_b64_tr_b16 v[16:17], v58 offset:57344
    ds_read_b64_tr_b16 v[18:19], v58 offset:57856
    v_cvt_pk_bf16_f32 v243, v246, v247
    v_mfma_f32_32x32x16_bf16 v[112:127], v[20:23], a[212:215], v[112:127]
    buffer_load_dwordx4 a[76:79], v10, s[8:11], s50 offen offset:0
    s_waitcnt lgkmcnt(4)
    v_mfma_f32_32x32x16_bf16 v[64:79], v[24:27], a[216:219], v[64:79]
    ds_read_b64_tr_b16 v[20:21], v59 offset:57344
    ds_read_b64_tr_b16 v[22:23], v59 offset:57856
    s_add_u32 s101, s100, 1057792
    buffer_store_dwordx4 v[240:243], v15, s[96:99], s101 offen sc0 sc1
    v_mfma_f32_32x32x16_bf16 v[80:95], v[24:27], a[220:223], v[80:95]
    buffer_load_dwordx4 a[80:83], v7, s[8:11], s50 offen offset:1024
    s_waitcnt lgkmcnt(4)
    v_mfma_f32_32x32x16_bf16 v[96:111], v[28:31], a[216:219], v[96:111]
    ds_read_b64_tr_b16 v[24:25], v58 offset:59392
    ds_read_b64_tr_b16 v[26:27], v58 offset:59904
    buffer_load_dwordx4 a[84:87], v8, s[8:11], s50 offen offset:1024
    v_mfma_f32_32x32x16_bf16 v[112:127], v[28:31], a[220:223], v[112:127]
    v_cvt_pk_bf16_f32 v244, v248, v249
    s_waitcnt lgkmcnt(4)
    v_mfma_f32_32x32x16_bf16 v[64:79], v[16:19], a[224:227], v[64:79]
    ds_read_b64_tr_b16 v[28:29], v59 offset:59392
    ds_read_b64_tr_b16 v[30:31], v59 offset:59904
    buffer_load_dwordx4 a[88:91], v9, s[8:11], s50 offen offset:1024
    v_mfma_f32_32x32x16_bf16 v[80:95], v[16:19], a[228:231], v[80:95]
    v_cvt_pk_bf16_f32 v245, v250, v251
    s_waitcnt lgkmcnt(4)
    v_mfma_f32_32x32x16_bf16 v[96:111], v[20:23], a[224:227], v[96:111]
    ds_read_b64_tr_b16 v[16:17], v58 offset:61440
    ds_read_b64_tr_b16 v[18:19], v58 offset:61952
    buffer_load_dwordx4 a[92:95], v10, s[8:11], s50 offen offset:1024
    v_mfma_f32_32x32x16_bf16 v[112:127], v[20:23], a[228:231], v[112:127]
    s_waitcnt lgkmcnt(4)
    v_mfma_f32_32x32x16_bf16 v[64:79], v[24:27], a[232:235], v[64:79]
    ds_read_b64_tr_b16 v[20:21], v59 offset:61440
    ds_read_b64_tr_b16 v[22:23], v59 offset:61952
    v_cvt_pk_bf16_f32 v246, v252, v253
    v_mfma_f32_32x32x16_bf16 v[80:95], v[24:27], a[236:239], v[80:95]
    s_waitcnt lgkmcnt(4)
    v_mfma_f32_32x32x16_bf16 v[96:111], v[28:31], a[232:235], v[96:111]
    ds_read_b64_tr_b16 v[24:25], v58 offset:63488
    ds_read_b64_tr_b16 v[26:27], v58 offset:64000
    v_cvt_pk_bf16_f32 v247, v254, v255
    v_mfma_f32_32x32x16_bf16 v[112:127], v[28:31], a[236:239], v[112:127]
    s_waitcnt lgkmcnt(4)
    v_mfma_f32_32x32x16_bf16 v[64:79], v[16:19], a[240:243], v[64:79]
    ds_read_b64_tr_b16 v[28:29], v59 offset:63488
    ds_read_b64_tr_b16 v[30:31], v59 offset:64000
    v_mfma_f32_32x32x16_bf16 v[80:95], v[16:19], a[244:247], v[80:95]
    s_add_u32 s101, s100, 1058304
    buffer_store_dwordx4 v[244:247], v15, s[96:99], s101 offen sc0 sc1
    s_waitcnt lgkmcnt(4)
    v_mfma_f32_32x32x16_bf16 v[96:111], v[20:23], a[240:243], v[96:111]
    v_mfma_f32_32x32x16_bf16 v[112:127], v[20:23], a[244:247], v[112:127]
    s_waitcnt lgkmcnt(2)
    v_mfma_f32_32x32x16_bf16 v[64:79], v[24:27], a[248:251], v[64:79]
    v_mfma_f32_32x32x16_bf16 v[80:95], v[24:27], a[252:255], v[80:95]
    s_waitcnt lgkmcnt(0)
    v_mfma_f32_32x32x16_bf16 v[96:111], v[28:31], a[248:251], v[96:111]
    v_mfma_f32_32x32x16_bf16 v[112:127], v[28:31], a[252:255], v[112:127]
    s_waitcnt vmcnt(48)
    s_barrier
    ds_read_b64_tr_b16 v[152:153], v144 offset:0
    ds_read_b64_tr_b16 v[154:155], v144 offset:1024
    ds_read_b64_tr_b16 v[156:157], v145 offset:0
    ds_read_b64_tr_b16 v[158:159], v145 offset:1024
    ds_read_b64_tr_b16 v[160:161], v146 offset:0
    ds_read_b64_tr_b16 v[162:163], v146 offset:1024
    ds_read_b64_tr_b16 v[164:165], v147 offset:0
    ds_read_b64_tr_b16 v[166:167], v147 offset:1024
    v_cvt_pk_bf16_f32 v64, v64, v65
    v_cvt_pk_bf16_f32 v65, v66, v67
    v_cvt_pk_bf16_f32 v66, v68, v69
    v_cvt_pk_bf16_f32 v67, v70, v71
    s_add_u32 s101, s100, 1050624
    buffer_store_dwordx4 v[64:67], v15, s[96:99], s101 offen sc0 sc1
    v_cvt_pk_bf16_f32 v68, v72, v73
    v_cvt_pk_bf16_f32 v69, v74, v75
    v_cvt_pk_bf16_f32 v70, v76, v77
    v_cvt_pk_bf16_f32 v71, v78, v79
    s_add_u32 s101, s100, 1051136
    buffer_store_dwordx4 v[68:71], v15, s[96:99], s101 offen sc0 sc1
    v_cvt_pk_bf16_f32 v80, v80, v81
    v_cvt_pk_bf16_f32 v81, v82, v83
    v_cvt_pk_bf16_f32 v82, v84, v85
    v_cvt_pk_bf16_f32 v83, v86, v87
    s_add_u32 s101, s100, 1058816
    buffer_store_dwordx4 v[80:83], v15, s[96:99], s101 offen sc0 sc1
    v_cvt_pk_bf16_f32 v84, v88, v89
    v_cvt_pk_bf16_f32 v85, v90, v91
    v_cvt_pk_bf16_f32 v86, v92, v93
    v_cvt_pk_bf16_f32 v87, v94, v95
    s_add_u32 s101, s100, 1059328
    buffer_store_dwordx4 v[84:87], v15, s[96:99], s101 offen sc0 sc1
    v_cvt_pk_bf16_f32 v96, v96, v97
    v_cvt_pk_bf16_f32 v97, v98, v99
    v_cvt_pk_bf16_f32 v98, v100, v101
    v_cvt_pk_bf16_f32 v99, v102, v103
    s_add_u32 s101, s100, 1051648
    buffer_store_dwordx4 v[96:99], v15, s[96:99], s101 offen sc0 sc1
    v_cvt_pk_bf16_f32 v100, v104, v105
    v_cvt_pk_bf16_f32 v101, v106, v107
    v_cvt_pk_bf16_f32 v102, v108, v109
    v_cvt_pk_bf16_f32 v103, v110, v111
    s_add_u32 s101, s100, 1052160
    buffer_store_dwordx4 v[100:103], v15, s[96:99], s101 offen sc0 sc1
    v_cvt_pk_bf16_f32 v112, v112, v113
    v_cvt_pk_bf16_f32 v113, v114, v115
    v_cvt_pk_bf16_f32 v114, v116, v117
    v_cvt_pk_bf16_f32 v115, v118, v119
    s_add_u32 s101, s100, 1059840
    buffer_store_dwordx4 v[112:115], v15, s[96:99], s101 offen sc0 sc1
    v_cvt_pk_bf16_f32 v116, v120, v121
    v_cvt_pk_bf16_f32 v117, v122, v123
    v_cvt_pk_bf16_f32 v118, v124, v125
    v_cvt_pk_bf16_f32 v119, v126, v127
    s_add_u32 s101, s100, 1060352
    buffer_store_dwordx4 v[116:119], v15, s[96:99], s101 offen sc0 sc1
    s_branch K2_JOIN
K1_VPATH:
    s_waitcnt vmcnt(23)
    s_barrier
    ds_read_b128 a[0:3], v5 offset:0
    ds_read_b128 a[4:7], v5 offset:4096
    ds_read_b64_tr_b16 v[16:17], v9 offset:16384
    ds_read_b64_tr_b16 v[18:19], v9 offset:17408
    ds_read_b64_tr_b16 v[20:21], v10 offset:16384
    ds_read_b64_tr_b16 v[22:23], v10 offset:17408
    ds_read_b64_tr_b16 v[24:25], v11 offset:16384
    ds_read_b64_tr_b16 v[26:27], v11 offset:17408
    s_waitcnt lgkmcnt(4)
    v_mfma_f32_32x32x16_bf16 v[64:79], a[0:3], v[16:19], 0
    ds_read_b64_tr_b16 v[28:29], v12 offset:16384
    ds_read_b64_tr_b16 v[30:31], v12 offset:17408
    s_add_u32 s52, s25, 2
    s_and_b32 s52, s52, 7
    s_lshl_b32 s52, s52, 19
    s_add_u32 m0, s47, 49152
    s_nop 0
    buffer_load_dwordx4 v3, s[8:11], s52 offen lds
    v_mfma_f32_32x32x16_bf16 v[80:95], a[4:7], v[16:19], 0
    s_waitcnt lgkmcnt(4)
    v_mfma_f32_32x32x16_bf16 v[96:111], a[0:3], v[20:23], 0
    ds_read_b128 a[8:11], v6 offset:0
    ds_read_b128 a[12:15], v6 offset:4096
    ds_read_b64_tr_b16 v[16:17], v9 offset:20480
    ds_read_b64_tr_b16 v[18:19], v9 offset:21504
    s_add_u32 s52, s52, 32768
    s_add_u32 m0, s47, 50176
    s_nop 0
    buffer_load_dwordx4 v3, s[8:11], s52 offen lds
    v_mfma_f32_32x32x16_bf16 v[112:127], a[4:7], v[20:23], 0
    s_waitcnt lgkmcnt(6)
    v_mfma_f32_32x32x16_bf16 v[128:143], a[0:3], v[24:27], 0
    ds_read_b64_tr_b16 v[20:21], v10 offset:20480
    ds_read_b64_tr_b16 v[22:23], v10 offset:21504
    s_add_u32 s52, s52, 32768
    s_add_u32 m0, s47, 51200
    s_nop 0
    buffer_load_dwordx4 v3, s[8:11], s52 offen lds
    v_mfma_f32_32x32x16_bf16 v[144:159], a[4:7], v[24:27], 0
    s_waitcnt lgkmcnt(6)
    v_mfma_f32_32x32x16_bf16 v[160:175], a[0:3], v[28:31], 0
    ds_read_b64_tr_b16 v[24:25], v11 offset:20480
    ds_read_b64_tr_b16 v[26:27], v11 offset:21504
    s_add_u32 s52, s52, 32768
    s_add_u32 m0, s47, 52224
    s_nop 0
    buffer_load_dwordx4 v3, s[8:11], s52 offen lds
    v_mfma_f32_32x32x16_bf16 v[176:191], a[4:7], v[28:31], 0
    s_waitcnt lgkmcnt(4)
    v_mfma_f32_32x32x16_bf16 v[64:79], a[8:11], v[16:19], v[64:79]
    ds_read_b64_tr_b16 v[28:29], v12 offset:20480
    ds_read_b64_tr_b16 v[30:31], v12 offset:21504
    s_add_u32 s50, s25, 2
    s_and_b32 s50, s50, 7
    s_lshl_b32 s50, s50, 7
    s_add_u32 m0, s48, 65536
    s_nop 0
    buffer_load_dwordx4 v1, s[4:7], s50 offen lds
    v_mfma_f32_32x32x16_bf16 v[80:95], a[12:15], v[16:19], v[80:95]
    s_waitcnt lgkmcnt(4)
    v_mfma_f32_32x32x16_bf16 v[96:111], a[8:11], v[20:23], v[96:111]
    ds_read_b128 a[16:19], v7 offset:0
    ds_read_b128 a[20:23], v7 offset:4096
    ds_read_b64_tr_b16 v[16:17], v9 offset:24576
    ds_read_b64_tr_b16 v[18:19], v9 offset:25600
    s_add_u32 m0, s48, 66560
    s_nop 0
    buffer_load_dwordx4 v2, s[4:7], s50 offen lds
    v_mfma_f32_32x32x16_bf16 v[112:127], a[12:15], v[20:23], v[112:127]
    s_waitcnt lgkmcnt(6)
    v_mfma_f32_32x32x16_bf16 v[128:143], a[8:11], v[24:27], v[128:143]
    ds_read_b64_tr_b16 v[20:21], v10 offset:24576
    ds_read_b64_tr_b16 v[22:23], v10 offset:25600
    s_add_u32 s50, s50, 16384
    s_add_u32 m0, s48, 67584
    s_nop 0
    buffer_load_dwordx4 v1, s[4:7], s50 offen lds
    v_mfma_f32_32x32x16_bf16 v[144:159], a[12:15], v[24:27], v[144:159]
    s_waitcnt lgkmcnt(6)
    v_mfma_f32_32x32x16_bf16 v[160:175], a[8:11], v[28:31], v[160:175]
    ds_read_b64_tr_b16 v[24:25], v11 offset:24576
    ds_read_b64_tr_b16 v[26:27], v11 offset:25600
    s_add_u32 m0, s48, 68608
    s_nop 0
    buffer_load_dwordx4 v2, s[4:7], s50 offen lds
    v_mfma_f32_32x32x16_bf16 v[176:191], a[12:15], v[28:31], v[176:191]
    s_waitcnt lgkmcnt(4)
    v_mfma_f32_32x32x16_bf16 v[64:79], a[16:19], v[16:19], v[64:79]
    ds_read_b64_tr_b16 v[28:29], v12 offset:24576
    ds_read_b64_tr_b16 v[30:31], v12 offset:25600
    s_add_u32 s50, s50, 16384
    s_add_u32 m0, s48, 69632
    s_nop 0
    buffer_load_dwordx4 v1, s[4:7], s50 offen lds
    v_mfma_f32_32x32x16_bf16 v[80:95], a[20:23], v[16:19], v[80:95]
    s_waitcnt lgkmcnt(4)
    v_mfma_f32_32x32x16_bf16 v[96:111], a[16:19], v[20:23], v[96:111]
    ds_read_b128 a[24:27], v8 offset:0
    ds_read_b128 a[28:31], v8 offset:4096
    ds_read_b64_tr_b16 v[16:17], v9 offset:28672
    ds_read_b64_tr_b16 v[18:19], v9 offset:29696
    s_add_u32 m0, s48, 70656
    s_nop 0
    buffer_load_dwordx4 v2, s[4:7], s50 offen lds
    v_mfma_f32_32x32x16_bf16 v[112:127], a[20:23], v[20:23], v[112:127]
    s_waitcnt lgkmcnt(6)
    v_mfma_f32_32x32x16_bf16 v[128:143], a[16:19], v[24:27], v[128:143]
    ds_read_b64_tr_b16 v[20:21], v10 offset:28672
    ds_read_b64_tr_b16 v[22:23], v10 offset:29696
    s_add_u32 s50, s50, 16384
    s_add_u32 m0, s48, 71680
    s_nop 0
    buffer_load_dwordx4 v1, s[4:7], s50 offen lds
    v_mfma_f32_32x32x16_bf16 v[144:159], a[20:23], v[24:27], v[144:159]
    s_waitcnt lgkmcnt(6)
    v_mfma_f32_32x32x16_bf16 v[160:175], a[16:19], v[28:31], v[160:175]
    ds_read_b64_tr_b16 v[24:25], v11 offset:28672
    ds_read_b64_tr_b16 v[26:27], v11 offset:29696
    s_add_u32 m0, s48, 72704
    s_nop 0
    buffer_load_dwordx4 v2, s[4:7], s50 offen lds
    v_mfma_f32_32x32x16_bf16 v[176:191], a[20:23], v[28:31], v[176:191]
    s_waitcnt lgkmcnt(4)
    v_mfma_f32_32x32x16_bf16 v[64:79], a[24:27], v[16:19], v[64:79]
    ds_read_b64_tr_b16 v[28:29], v12 offset:28672
    ds_read_b64_tr_b16 v[30:31], v12 offset:29696
    v_mfma_f32_32x32x16_bf16 v[80:95], a[28:31], v[16:19], v[80:95]
    s_waitcnt lgkmcnt(4)
    v_mfma_f32_32x32x16_bf16 v[96:111], a[24:27], v[20:23], v[96:111]
    s_waitcnt vmcnt(23)
    s_barrier
    v_add_u32 v5, 32768, v5
    ds_read_b128 a[32:35], v5 offset:0
    ds_read_b128 a[36:39], v5 offset:4096
    ds_read_b64_tr_b16 v[16:17], v9 offset:32768
    ds_read_b64_tr_b16 v[18:19], v9 offset:33792
    v_mfma_f32_32x32x16_bf16 v[112:127], a[28:31], v[20:23], v[112:127]
    s_waitcnt lgkmcnt(6)
    v_mfma_f32_32x32x16_bf16 v[128:143], a[24:27], v[24:27], v[128:143]
    ds_read_b64_tr_b16 v[20:21], v10 offset:32768
    ds_read_b64_tr_b16 v[22:23], v10 offset:33792
    v_mfma_f32_32x32x16_bf16 v[144:159], a[28:31], v[24:27], v[144:159]
    s_waitcnt lgkmcnt(6)
    v_mfma_f32_32x32x16_bf16 v[160:175], a[24:27], v[28:31], v[160:175]
    ds_read_b64_tr_b16 v[24:25], v11 offset:32768
    ds_read_b64_tr_b16 v[26:27], v11 offset:33792
    v_mov_b32 v60, 0
    v_mov_b32 v59, 0
    s_lshr_b32 s43, s35, 1
    v_mfma_f32_32x32x16_bf16 v[176:191], a[28:31], v[28:31], v[176:191]
    s_mul_i32 s43, s43, 18432
    s_and_b32 s42, s35, 1
    s_lshl_b32 s42, s42, 7
    s_waitcnt lgkmcnt(4)
    v_mfma_f32_32x32x16_bf16 v[64:79], a[32:35], v[16:19], v[64:79]
    ds_read_b64_tr_b16 v[28:29], v12 offset:32768
    ds_read_b64_tr_b16 v[30:31], v12 offset:33792
    s_add_u32 s52, s25, 3
    s_and_b32 s52, s52, 7
    s_lshl_b32 s52, s52, 19
    s_add_u32 m0, s47, 0
    s_nop 0
    buffer_load_dwordx4 v3, s[8:11], s52 offen lds
    s_add_u32 s43, s43, s42
    s_lshl_b32 s42, s24, 12
    v_mfma_f32_32x32x16_bf16 v[80:95], a[36:39], v[16:19], v[80:95]
    s_add_u32 s52, s52, 32768
    s_add_u32 m0, s47, 1024
    s_nop 0
    buffer_load_dwordx4 v3, s[8:11], s52 offen lds
    s_add_u32 s43, s43, s42
    s_add_u32 s42, s43, 4096
    s_lshl_b32 s57, s35, 8
    s_waitcnt lgkmcnt(4)
    v_mfma_f32_32x32x16_bf16 v[96:111], a[32:35], v[20:23], v[96:111]
    v_add_u32 v6, 32768, v6
    ds_read_b128 a[40:43], v6 offset:0
    ds_read_b128 a[44:47], v6 offset:4096
    ds_read_b64_tr_b16 v[16:17], v9 offset:36864
    ds_read_b64_tr_b16 v[18:19], v9 offset:37888
    s_add_u32 s58, s57, 36700160
    s_lshl_b32 s59, s57, 1
    v_mfma_f32_32x32x16_bf16 v[112:127], a[36:39], v[20:23], v[112:127]
    s_add_u32 s52, s52, 32768
    s_add_u32 m0, s47, 2048
    s_nop 0
    buffer_load_dwordx4 v3, s[8:11], s52 offen lds
    s_add_u32 s59, s59, 36831232
    s_add_u32 s57, s57, 35651584
    s_waitcnt vmcnt(15)
    s_waitcnt lgkmcnt(6)
    v_mfma_f32_32x32x16_bf16 v[128:143], a[32:35], v[24:27], v[128:143]
    ds_read_b64_tr_b16 v[20:21], v10 offset:36864
    ds_read_b64_tr_b16 v[22:23], v10 offset:37888
    v_dot2c_f32_bf16 v60, 0x3f803f80, v196
    v_dot2c_f32_bf16 v59, v196, v196
    v_mfma_f32_32x32x16_bf16 v[144:159], a[36:39], v[24:27], v[144:159]
    s_add_u32 s52, s52, 32768
    s_add_u32 m0, s47, 3072
    s_nop 0
    buffer_load_dwordx4 v3, s[8:11], s52 offen lds
    v_dot2c_f32_bf16 v60, 0x3f803f80, v197
    v_dot2c_f32_bf16 v59, v197, v197
    v_dot2c_f32_bf16 v60, 0x3f803f80, v198
    s_waitcnt lgkmcnt(6)
    v_mfma_f32_32x32x16_bf16 v[160:175], a[32:35], v[28:31], v[160:175]
    ds_read_b64_tr_b16 v[24:25], v11 offset:36864
    ds_read_b64_tr_b16 v[26:27], v11 offset:37888
    v_dot2c_f32_bf16 v59, v198, v198
    v_dot2c_f32_bf16 v60, 0x3f803f80, v199
    v_dot2c_f32_bf16 v59, v199, v199
    v_mfma_f32_32x32x16_bf16 v[176:191], a[36:39], v[28:31], v[176:191]
    s_add_u32 s50, s25, 3
    s_and_b32 s50, s50, 7
    s_lshl_b32 s50, s50, 7
    s_add_u32 m0, s48, 0
    s_nop 0
    buffer_load_dwordx4 v1, s[4:7], s50 offen lds
    v_dot2c_f32_bf16 v60, 0x3f803f80, v200
    v_dot2c_f32_bf16 v59, v200, v200
    s_waitcnt lgkmcnt(4)
    v_mfma_f32_32x32x16_bf16 v[64:79], a[40:43], v[16:19], v[64:79]
    ds_read_b64_tr_b16 v[28:29], v12 offset:36864
    ds_read_b64_tr_b16 v[30:31], v12 offset:37888
    v_dot2c_f32_bf16 v60, 0x3f803f80, v201
    v_dot2c_f32_bf16 v59, v201, v201
    v_dot2c_f32_bf16 v60, 0x3f803f80, v202
    v_mfma_f32_32x32x16_bf16 v[80:95], a[44:47], v[16:19], v[80:95]
    s_add_u32 m0, s48, 1024
    s_nop 0
    buffer_load_dwordx4 v2, s[4:7], s50 offen lds
    v_dot2c_f32_bf16 v59, v202, v202
    v_dot2c_f32_bf16 v60, 0x3f803f80, v203
    s_waitcnt lgkmcnt(4)
    v_mfma_f32_32x32x16_bf16 v[96:111], a[40:43], v[20:23], v[96:111]
    v_add_u32 v7, 32768, v7
    ds_read_b128 a[48:51], v7 offset:0
    ds_read_b128 a[52:55], v7 offset:4096
    ds_read_b64_tr_b16 v[16:17], v9 offset:40960
    ds_read_b64_tr_b16 v[18:19], v9 offset:41984
    v_dot2c_f32_bf16 v59, v203, v203
    v_dot2c_f32_bf16 v60, 0x3f803f80, v204
    v_dot2c_f32_bf16 v59, v204, v204
    v_mfma_f32_32x32x16_bf16 v[112:127], a[44:47], v[20:23], v[112:127]
    s_add_u32 s50, s50, 16384
    s_add_u32 m0, s48, 2048
    s_nop 0
    buffer_load_dwordx4 v1, s[4:7], s50 offen lds
    v_dot2c_f32_bf16 v60, 0x3f803f80, v205
    v_dot2c_f32_bf16 v59, v205, v205
    s_waitcnt lgkmcnt(6)
    v_mfma_f32_32x32x16_bf16 v[128:143], a[40:43], v[24:27], v[128:143]
    ds_read_b64_tr_b16 v[20:21], v10 offset:40960
    ds_read_b64_tr_b16 v[22:23], v10 offset:41984
    s_add_u32 m0, s48, 3072
    s_nop 0
    buffer_load_dwordx4 v2, s[4:7], s50 offen lds
    v_dot2c_f32_bf16 v60, 0x3f803f80, v206
    v_dot2c_f32_bf16 v59, v206, v206
    v_dot2c_f32_bf16 v60, 0x3f803f80, v207
    v_mfma_f32_32x32x16_bf16 v[144:159], a[44:47], v[24:27], v[144:159]
    v_dot2c_f32_bf16 v59, v207, v207
    v_dot2c_f32_bf16 v60, 0x3f803f80, v208
    s_waitcnt lgkmcnt(6)
    v_mfma_f32_32x32x16_bf16 v[160:175], a[40:43], v[28:31], v[160:175]
    ds_read_b64_tr_b16 v[24:25], v11 offset:40960
    ds_read_b64_tr_b16 v[26:27], v11 offset:41984
    s_add_u32 s50, s50, 16384
    s_add_u32 m0, s48, 4096
    s_nop 0
    buffer_load_dwordx4 v1, s[4:7], s50 offen lds
    v_dot2c_f32_bf16 v59, v208, v208
    v_dot2c_f32_bf16 v60, 0x3f803f80, v209
    v_dot2c_f32_bf16 v59, v209, v209
    v_mfma_f32_32x32x16_bf16 v[176:191], a[44:47], v[28:31], v[176:191]
    v_dot2c_f32_bf16 v60, 0x3f803f80, v210
    v_dot2c_f32_bf16 v59, v210, v210
    v_dot2c_f32_bf16 v60, 0x3f803f80, v211
    s_waitcnt lgkmcnt(4)
    v_mfma_f32_32x32x16_bf16 v[64:79], a[48:51], v[16:19], v[64:79]
    ds_read_b64_tr_b16 v[28:29], v12 offset:40960
    ds_read_b64_tr_b16 v[30:31], v12 offset:41984
    s_add_u32 m0, s48, 5120
    s_nop 0
    buffer_load_dwordx4 v2, s[4:7], s50 offen lds
    v_dot2c_f32_bf16 v59, v211, v211
    v_dot2c_f32_bf16 v60, 0x3f803f80, v212
    v_mfma_f32_32x32x16_bf16 v[80:95], a[52:55], v[16:19], v[80:95]
    v_dot2c_f32_bf16 v59, v212, v212
    v_dot2c_f32_bf16 v60, 0x3f803f80, v213
    v_dot2c_f32_bf16 v59, v213, v213
    s_waitcnt lgkmcnt(4)
    v_mfma_f32_32x32x16_bf16 v[96:111], a[48:51], v[20:23], v[96:111]
    v_add_u32 v8, 32768, v8
    ds_read_b128 a[56:59], v8 offset:0
    ds_read_b128 a[60:63], v8 offset:4096
    ds_read_b64_tr_b16 v[16:17], v9 offset:45056
    ds_read_b64_tr_b16 v[18:19], v9 offset:46080
    s_add_u32 s50, s50, 16384
    s_add_u32 m0, s48, 6144
    s_nop 0
    buffer_load_dwordx4 v1, s[4:7], s50 offen lds
    v_dot2c_f32_bf16 v60, 0x3f803f80, v214
    v_dot2c_f32_bf16 v59, v214, v214
    v_mfma_f32_32x32x16_bf16 v[112:127], a[52:55], v[20:23], v[112:127]
    v_dot2c_f32_bf16 v60, 0x3f803f80, v215
    v_dot2c_f32_bf16 v59, v215, v215
    v_dot2c_f32_bf16 v60, 0x3f803f80, v216
    s_waitcnt lgkmcnt(6)
    v_mfma_f32_32x32x16_bf16 v[128:143], a[48:51], v[24:27], v[128:143]
    ds_read_b64_tr_b16 v[20:21], v10 offset:45056
    ds_read_b64_tr_b16 v[22:23], v10 offset:46080
    s_add_u32 m0, s48, 7168
    s_nop 0
    buffer_load_dwordx4 v2, s[4:7], s50 offen lds
    v_dot2c_f32_bf16 v59, v216, v216
    v_dot2c_f32_bf16 v60, 0x3f803f80, v217
    v_mfma_f32_32x32x16_bf16 v[144:159], a[52:55], v[24:27], v[144:159]
    v_dot2c_f32_bf16 v59, v217, v217
    v_dot2c_f32_bf16 v60, 0x3f803f80, v218
    v_dot2c_f32_bf16 v59, v218, v218
    s_waitcnt lgkmcnt(6)
    v_mfma_f32_32x32x16_bf16 v[160:175], a[48:51], v[28:31], v[160:175]
    ds_read_b64_tr_b16 v[24:25], v11 offset:45056
    ds_read_b64_tr_b16 v[26:27], v11 offset:46080
    buffer_load_dword v63, v62, s[8:11], 0 offen offset:256
    v_dot2c_f32_bf16 v60, 0x3f803f80, v219
    v_dot2c_f32_bf16 v59, v219, v219
    v_mfma_f32_32x32x16_bf16 v[176:191], a[52:55], v[28:31], v[176:191]
    v_dot2c_f32_bf16 v60, 0x3f803f80, v220
    v_dot2c_f32_bf16 v59, v220, v220
    v_dot2c_f32_bf16 v60, 0x3f803f80, v221
    s_waitcnt lgkmcnt(4)
    v_mfma_f32_32x32x16_bf16 v[64:79], a[56:59], v[16:19], v[64:79]
    ds_read_b64_tr_b16 v[28:29], v12 offset:45056
    ds_read_b64_tr_b16 v[30:31], v12 offset:46080
    v_dot2c_f32_bf16 v59, v221, v221
    v_dot2c_f32_bf16 v60, 0x3f803f80, v222
    v_dot2c_f32_bf16 v59, v222, v222
    v_mfma_f32_32x32x16_bf16 v[80:95], a[60:63], v[16:19], v[80:95]
    v_dot2c_f32_bf16 v60, 0x3f803f80, v223
    v_dot2c_f32_bf16 v59, v223, v223
    s_waitcnt lgkmcnt(4)
    v_mfma_f32_32x32x16_bf16 v[96:111], a[56:59], v[20:23], v[96:111]
    s_waitcnt vmcnt(13)
    s_barrier
    v_add_u32 v5, 32768, v5
    ds_read_b128 a[64:67], v5 offset:0
    ds_read_b128 a[68:71], v5 offset:4096
    ds_read_b64_tr_b16 v[16:17], v9 offset:49152
    ds_read_b64_tr_b16 v[18:19], v9 offset:50176
    v_dot2c_f32_bf16 v60, 0x3f803f80, v224
    v_dot2c_f32_bf16 v59, v224, v224
    v_dot2c_f32_bf16 v60, 0x3f803f80, v225
    v_mfma_f32_32x32x16_bf16 v[112:127], a[60:63], v[20:23], v[112:127]
    v_dot2c_f32_bf16 v59, v225, v225
    v_dot2c_f32_bf16 v60, 0x3f803f80, v226
    s_waitcnt lgkmcnt(6)
    v_mfma_f32_32x32x16_bf16 v[128:143], a[56:59], v[24:27], v[128:143]
    ds_read_b64_tr_b16 v[20:21], v10 offset:49152
    ds_read_b64_tr_b16 v[22:23], v10 offset:50176
    v_dot2c_f32_bf16 v59, v226, v226
    v_dot2c_f32_bf16 v60, 0x3f803f80, v227
    v_dot2c_f32_bf16 v59, v227, v227
    v_mfma_f32_32x32x16_bf16 v[144:159], a[60:63], v[24:27], v[144:159]
    v_dot2c_f32_bf16 v60, 0x3f803f80, v228
    v_dot2c_f32_bf16 v59, v228, v228
    s_waitcnt lgkmcnt(6)
    v_mfma_f32_32x32x16_bf16 v[160:175], a[56:59], v[28:31], v[160:175]
    ds_read_b64_tr_b16 v[24:25], v11 offset:49152
    ds_read_b64_tr_b16 v[26:27], v11 offset:50176
    v_dot2c_f32_bf16 v60, 0x3f803f80, v229
    v_dot2c_f32_bf16 v59, v229, v229
    v_dot2c_f32_bf16 v60, 0x3f803f80, v230
    v_mfma_f32_32x32x16_bf16 v[176:191], a[60:63], v[28:31], v[176:191]
    v_dot2c_f32_bf16 v59, v230, v230
    v_dot2c_f32_bf16 v60, 0x3f803f80, v231
    v_dot2c_f32_bf16 v59, v231, v231
    s_waitcnt lgkmcnt(4)
    v_mfma_f32_32x32x16_bf16 v[64:79], a[64:67], v[16:19], v[64:79]
    ds_read_b64_tr_b16 v[28:29], v12 offset:49152
    ds_read_b64_tr_b16 v[30:31], v12 offset:50176
    s_add_u32 s52, s25, 4
    s_and_b32 s52, s52, 7
    s_lshl_b32 s52, s52, 19
    s_add_u32 m0, s47, 16384
    s_nop 0
    buffer_load_dwordx4 v3, s[8:11], s52 offen lds
    v_lshlrev_b32 v36, 16, v196
    v_and_b32 v37, 0xffff0000, v196
    v_mfma_f32_32x32x16_bf16 v[80:95], a[68:71], v[16:19], v[80:95]
    v_lshlrev_b32 v38, 16, v197
    v_and_b32 v39, 0xffff0000, v197
    v_lshlrev_b32 v40, 16, v198
    s_waitcnt lgkmcnt(4)
    v_mfma_f32_32x32x16_bf16 v[96:111], a[64:67], v[20:23], v[96:111]
    v_add_u32 v6, 32768, v6
    ds_read_b128 a[72:75], v6 offset:0
    ds_read_b128 a[76:79], v6 offset:4096
    ds_read_b64_tr_b16 v[16:17], v9 offset:53248
    ds_read_b64_tr_b16 v[18:19], v9 offset:54272
    s_add_u32 s52, s52, 32768
    s_add_u32 m0, s47, 17408
    s_nop 0
    buffer_load_dwordx4 v3, s[8:11], s52 offen lds
    v_and_b32 v41, 0xffff0000, v198
    v_add_f32_dpp v60, v60, v60 quad_perm:[1,0,3,2] row_mask:0xf bank_mask:0xf
    v_mfma_f32_32x32x16_bf16 v[112:127], a[68:71], v[20:23], v[112:127]
    v_add_f32_dpp v59, v59, v59 quad_perm:[1,0,3,2] row_mask:0xf bank_mask:0xf
    v_lshlrev_b32 v42, 16, v199
    v_and_b32 v43, 0xffff0000, v199
    s_waitcnt lgkmcnt(6)
    v_mfma_f32_32x32x16_bf16 v[128:143], a[64:67], v[24:27], v[128:143]
    ds_read_b64_tr_b16 v[20:21], v10 offset:53248
    ds_read_b64_tr_b16 v[22:23], v10 offset:54272
    s_add_u32 s52, s52, 32768
    s_add_u32 m0, s47, 18432
    s_nop 0
    buffer_load_dwordx4 v3, s[8:11], s52 offen lds
    v_lshlrev_b32 v44, 16, v200
    v_and_b32 v45, 0xffff0000, v200
    v_mfma_f32_32x32x16_bf16 v[144:159], a[68:71], v[24:27], v[144:159]
    v_add_f32_dpp v60, v60, v60 quad_perm:[2,3,0,1] row_mask:0xf bank_mask:0xf
    v_add_f32_dpp v59, v59, v59 quad_perm:[2,3,0,1] row_mask:0xf bank_mask:0xf
    v_lshlrev_b32 v46, 16, v201
    s_waitcnt lgkmcnt(6)
    v_mfma_f32_32x32x16_bf16 v[160:175], a[64:67], v[28:31], v[160:175]
    ds_read_b64_tr_b16 v[24:25], v11 offset:53248
    ds_read_b64_tr_b16 v[26:27], v11 offset:54272
    s_add_u32 s52, s52, 32768
    s_add_u32 m0, s47, 19456
    s_nop 0
    buffer_load_dwordx4 v3, s[8:11], s52 offen lds
    v_and_b32 v47, 0xffff0000, v201
    v_lshlrev_b32 v48, 16, v202
    v_mfma_f32_32x32x16_bf16 v[176:191], a[68:71], v[28:31], v[176:191]
    v_and_b32 v49, 0xffff0000, v202
    v_add_f32_dpp v60, v60, v60 row_half_mirror row_mask:0xf bank_mask:0xf
    v_add_f32_dpp v59, v59, v59 row_half_mirror row_mask:0xf bank_mask:0xf
    s_waitcnt lgkmcnt(4)
    v_mfma_f32_32x32x16_bf16 v[64:79], a[72:75], v[16:19], v[64:79]
    ds_read_b64_tr_b16 v[28:29], v12 offset:53248
    ds_read_b64_tr_b16 v[30:31], v12 offset:54272
    s_add_u32 s50, s25, 4
    s_and_b32 s50, s50, 7
    s_lshl_b32 s50, s50, 7
    s_add_u32 m0, s48, 32768
    s_nop 0
    buffer_load_dwordx4 v1, s[4:7], s50 offen lds
    v_lshlrev_b32 v50, 16, v203
    v_and_b32 v51, 0xffff0000, v203
    v_lshlrev_b32 v52, 16, v204
    v_mfma_f32_32x32x16_bf16 v[80:95], a[76:79], v[16:19], v[80:95]
    v_and_b32 v53, 0xffff0000, v204
    v_lshlrev_b32 v54, 16, v205
    s_waitcnt lgkmcnt(4)
    v_mfma_f32_32x32x16_bf16 v[96:111], a[72:75], v[20:23], v[96:111]
    v_add_u32 v7, 32768, v7
    ds_read_b128 a[80:83], v7 offset:0
    ds_read_b128 a[84:87], v7 offset:4096
    ds_read_b64_tr_b16 v[16:17], v9 offset:57344
    ds_read_b64_tr_b16 v[18:19], v9 offset:58368
    s_add_u32 m0, s48, 33792
    s_nop 0
    buffer_load_dwordx4 v2, s[4:7], s50 offen lds
    v_and_b32 v55, 0xffff0000, v205
    v_lshlrev_b32 v56, 16, v206
    v_and_b32 v57, 0xffff0000, v206
    v_mfma_f32_32x32x16_bf16 v[112:127], a[76:79], v[20:23], v[112:127]
    v_lshlrev_b32 v232, 16, v207
    v_and_b32 v233, 0xffff0000, v207
    s_waitcnt lgkmcnt(6)
    v_mfma_f32_32x32x16_bf16 v[128:143], a[72:75], v[24:27], v[128:143]
    ds_read_b64_tr_b16 v[20:21], v10 offset:57344
    ds_read_b64_tr_b16 v[22:23], v10 offset:58368
    s_add_u32 s50, s50, 16384
    s_add_u32 m0, s48, 34816
    s_nop 0
    buffer_load_dwordx4 v1, s[4:7], s50 offen lds
    v_mul_f32 v60, 0x3ae38e39, v60
    v_mul_f32 v59, 0x3ae38e39, v59
    buffer_store_dword v60, v35, s[20:23], s57 offen sc0 sc1
    v_mfma_f32_32x32x16_bf16 v[144:159], a[76:79], v[24:27], v[144:159]
    v_fma_f32 v59, -v60, v60, v59
    v_max_f32 v59, 0, v59
    s_waitcnt lgkmcnt(6)
    v_mfma_f32_32x32x16_bf16 v[160:175], a[72:75], v[28:31], v[160:175]
    ds_read_b64_tr_b16 v[24:25], v11 offset:57344
    ds_read_b64_tr_b16 v[26:27], v11 offset:58368
    s_add_u32 m0, s48, 35840
    s_nop 0
    buffer_load_dwordx4 v2, s[4:7], s50 offen lds
    v_cvt_pk_bf16_f32 v58, v60, v59
    v_and_b32 v59, 0xffff0000, v58
    v_lshlrev_b32 v58, 16, v58
    v_mfma_f32_32x32x16_bf16 v[176:191], a[76:79], v[28:31], v[176:191]
    v_add_f32 v59, 0x3727c5ac, v59
    v_cvt_pk_bf16_f32 v59, v59, v59
    s_waitcnt lgkmcnt(4)
    v_mfma_f32_32x32x16_bf16 v[64:79], a[80:83], v[16:19], v[64:79]
    ds_read_b64_tr_b16 v[28:29], v12 offset:57344
    ds_read_b64_tr_b16 v[30:31], v12 offset:58368
    s_add_u32 s50, s50, 16384
    s_add_u32 m0, s48, 36864
    s_nop 0
    buffer_load_dwordx4 v1, s[4:7], s50 offen lds
    v_and_b32 v59, 0xffff0000, v59
    v_sqrt_f32 v59, v59
    v_sub_f32 v36, v36, v58
    v_mfma_f32_32x32x16_bf16 v[80:95], a[84:87], v[16:19], v[80:95]
    v_sub_f32 v37, v37, v58
    v_sub_f32 v38, v38, v58
    v_sub_f32 v39, v39, v58
    s_waitcnt lgkmcnt(4)
    v_mfma_f32_32x32x16_bf16 v[96:111], a[80:83], v[20:23], v[96:111]
    v_add_u32 v8, 32768, v8
    ds_read_b128 a[88:91], v8 offset:0
    ds_read_b128 a[92:95], v8 offset:4096
    ds_read_b64_tr_b16 v[16:17], v9 offset:61440
    ds_read_b64_tr_b16 v[18:19], v9 offset:62464
    s_add_u32 m0, s48, 37888
    s_nop 0
    buffer_load_dwordx4 v2, s[4:7], s50 offen lds
    v_sub_f32 v40, v40, v58
    v_sub_f32 v41, v41, v58
    v_mfma_f32_32x32x16_bf16 v[112:127], a[84:87], v[20:23], v[112:127]
    v_sub_f32 v42, v42, v58
    v_sub_f32 v43, v43, v58
    v_sub_f32 v44, v44, v58
    s_waitcnt lgkmcnt(6)
    v_mfma_f32_32x32x16_bf16 v[128:143], a[80:83], v[24:27], v[128:143]
    ds_read_b64_tr_b16 v[20:21], v10 offset:61440
    ds_read_b64_tr_b16 v[22:23], v10 offset:62464
    s_add_u32 s50, s50, 16384
    s_add_u32 m0, s48, 38912
    s_nop 0
    buffer_load_dwordx4 v1, s[4:7], s50 offen lds
    v_sub_f32 v45, v45, v58
    v_sub_f32 v46, v46, v58
    v_mfma_f32_32x32x16_bf16 v[144:159], a[84:87], v[24:27], v[144:159]
    v_sub_f32 v47, v47, v58
    v_sub_f32 v48, v48, v58
    v_sub_f32 v49, v49, v58
    s_waitcnt lgkmcnt(6)
    v_mfma_f32_32x32x16_bf16 v[160:175], a[80:83], v[28:31], v[160:175]
    ds_read_b64_tr_b16 v[24:25], v11 offset:61440
    ds_read_b64_tr_b16 v[26:27], v11 offset:62464
    s_add_u32 m0, s48, 39936
    s_nop 0
    buffer_load_dwordx4 v2, s[4:7], s50 offen lds
    v_sub_f32 v50, v50, v58
    v_sub_f32 v51, v51, v58
    v_mfma_f32_32x32x16_bf16 v[176:191], a[84:87], v[28:31], v[176:191]
    v_sub_f32 v52, v52, v58
    v_sub_f32 v53, v53, v58
    v_sub_f32 v54, v54, v58
    s_waitcnt lgkmcnt(4)
    v_mfma_f32_32x32x16_bf16 v[64:79], a[88:91], v[16:19], v[64:79]
    ds_read_b64_tr_b16 v[28:29], v12 offset:61440
    ds_read_b64_tr_b16 v[30:31], v12 offset:62464
    v_sub_f32 v55, v55, v58
    v_sub_f32 v56, v56, v58
    v_sub_f32 v57, v57, v58
    v_mfma_f32_32x32x16_bf16 v[80:95], a[92:95], v[16:19], v[80:95]
    v_sub_f32 v232, v232, v58
    v_sub_f32 v233, v233, v58
    s_waitcnt lgkmcnt(4)
    v_mfma_f32_32x32x16_bf16 v[96:111], a[88:91], v[20:23], v[96:111]
    s_waitcnt vmcnt(14)
    s_barrier
    v_add_u32 v5, -65536, v5
    ds_read_b128 a[96:99], v5 offset:0
    ds_read_b128 a[100:103], v5 offset:4096
    ds_read_b64_tr_b16 v[16:17], v9 offset:0
    ds_read_b64_tr_b16 v[18:19], v9 offset:1024
    v_cvt_pk_bf16_f32 v59, v59, v59
    v_and_b32 v59, 0xffff0000, v59
    v_rcp_f32 v59, v59
    v_mfma_f32_32x32x16_bf16 v[112:127], a[92:95], v[20:23], v[112:127]
    v_cvt_pk_bf16_f32 v196, v36, v37
    v_cvt_pk_bf16_f32 v197, v38, v39
    s_waitcnt lgkmcnt(6)
    v_mfma_f32_32x32x16_bf16 v[128:143], a[88:91], v[24:27], v[128:143]
    ds_read_b64_tr_b16 v[20:21], v10 offset:0
    ds_read_b64_tr_b16 v[22:23], v10 offset:1024
    v_cvt_pk_bf16_f32 v198, v40, v41
    v_cvt_pk_bf16_f32 v199, v42, v43
    v_cvt_pk_bf16_f32 v200, v44, v45
    v_mfma_f32_32x32x16_bf16 v[144:159], a[92:95], v[24:27], v[144:159]
    v_cvt_pk_bf16_f32 v201, v46, v47
    v_cvt_pk_bf16_f32 v202, v48, v49
    s_waitcnt lgkmcnt(6)
    v_mfma_f32_32x32x16_bf16 v[160:175], a[88:91], v[28:31], v[160:175]
    ds_read_b64_tr_b16 v[24:25], v11 offset:0
    ds_read_b64_tr_b16 v[26:27], v11 offset:1024
    v_cvt_pk_bf16_f32 v203, v50, v51
    v_cvt_pk_bf16_f32 v204, v52, v53
    v_cvt_pk_bf16_f32 v205, v54, v55
    v_mfma_f32_32x32x16_bf16 v[176:191], a[92:95], v[28:31], v[176:191]
    v_cvt_pk_bf16_f32 v206, v56, v57
    v_cvt_pk_bf16_f32 v207, v232, v233
    s_waitcnt lgkmcnt(4)
    v_mfma_f32_32x32x16_bf16 v[64:79], a[96:99], v[16:19], v[64:79]
    ds_read_b64_tr_b16 v[28:29], v12 offset:0
    ds_read_b64_tr_b16 v[30:31], v12 offset:1024
    s_add_u32 s52, s25, 5
    s_and_b32 s52, s52, 7
    s_lshl_b32 s52, s52, 19
    s_add_u32 m0, s47, 32768
    s_nop 0
    buffer_load_dwordx4 v3, s[8:11], s52 offen lds
    v_lshlrev_b32 v36, 16, v196
    v_and_b32 v37, 0xffff0000, v196
    v_lshlrev_b32 v38, 16, v197
    v_mfma_f32_32x32x16_bf16 v[80:95], a[100:103], v[16:19], v[80:95]
    v_and_b32 v39, 0xffff0000, v197
    v_lshlrev_b32 v40, 16, v198
    v_and_b32 v41, 0xffff0000, v198
    s_waitcnt lgkmcnt(4)
    v_mfma_f32_32x32x16_bf16 v[96:111], a[96:99], v[20:23], v[96:111]
    v_add_u32 v6, -65536, v6
    ds_read_b128 a[104:107], v6 offset:0
    ds_read_b128 a[108:111], v6 offset:4096
    ds_read_b64_tr_b16 v[16:17], v9 offset:4096
    ds_read_b64_tr_b16 v[18:19], v9 offset:5120
    s_add_u32 s52, s52, 32768
    s_add_u32 m0, s47, 33792
    s_nop 0
    buffer_load_dwordx4 v3, s[8:11], s52 offen lds
    v_lshlrev_b32 v42, 16, v199
    v_and_b32 v43, 0xffff0000, v199
    v_mfma_f32_32x32x16_bf16 v[112:127], a[100:103], v[20:23], v[112:127]
    v_lshlrev_b32 v44, 16, v200
    v_and_b32 v45, 0xffff0000, v200
    v_lshlrev_b32 v46, 16, v201
    s_waitcnt lgkmcnt(6)
    v_mfma_f32_32x32x16_bf16 v[128:143], a[96:99], v[24:27], v[128:143]
    ds_read_b64_tr_b16 v[20:21], v10 offset:4096
    ds_read_b64_tr_b16 v[22:23], v10 offset:5120
    s_add_u32 s52, s52, 32768
    s_add_u32 m0, s47, 34816
    s_nop 0
    buffer_load_dwordx4 v3, s[8:11], s52 offen lds
    v_and_b32 v47, 0xffff0000, v201
    v_lshlrev_b32 v48, 16, v202
    v_mfma_f32_32x32x16_bf16 v[144:159], a[100:103], v[24:27], v[144:159]
    v_and_b32 v49, 0xffff0000, v202
    v_lshlrev_b32 v50, 16, v203
    v_and_b32 v51, 0xffff0000, v203
    s_waitcnt lgkmcnt(6)
    v_mfma_f32_32x32x16_bf16 v[160:175], a[96:99], v[28:31], v[160:175]
    ds_read_b64_tr_b16 v[24:25], v11 offset:4096
    ds_read_b64_tr_b16 v[26:27], v11 offset:5120
    s_add_u32 s52, s52, 32768
    s_add_u32 m0, s47, 35840
    s_nop 0
    buffer_load_dwordx4 v3, s[8:11], s52 offen lds
    v_lshlrev_b32 v52, 16, v204
    v_and_b32 v53, 0xffff0000, v204
    v_mfma_f32_32x32x16_bf16 v[176:191], a[100:103], v[28:31], v[176:191]
    v_lshlrev_b32 v54, 16, v205
    v_and_b32 v55, 0xffff0000, v205
    v_lshlrev_b32 v56, 16, v206
    s_waitcnt lgkmcnt(4)
    v_mfma_f32_32x32x16_bf16 v[64:79], a[104:107], v[16:19], v[64:79]
    ds_read_b64_tr_b16 v[28:29], v12 offset:4096
    ds_read_b64_tr_b16 v[30:31], v12 offset:5120
    s_add_u32 s50, s25, 5
    s_and_b32 s50, s50, 7
    s_lshl_b32 s50, s50, 7
    s_add_u32 m0, s48, 65536
    s_nop 0
    buffer_load_dwordx4 v1, s[4:7], s50 offen lds
    v_and_b32 v57, 0xffff0000, v206
    v_lshlrev_b32 v232, 16, v207
    v_mfma_f32_32x32x16_bf16 v[80:95], a[108:111], v[16:19], v[80:95]
    v_and_b32 v233, 0xffff0000, v207
    v_mul_f32 v36, v36, v59
    v_mul_f32 v37, v37, v59
    s_waitcnt lgkmcnt(4)
    v_mfma_f32_32x32x16_bf16 v[96:111], a[104:107], v[20:23], v[96:111]
    v_add_u32 v7, -65536, v7
    ds_read_b128 a[112:115], v7 offset:0
    ds_read_b128 a[116:119], v7 offset:4096
    ds_read_b64_tr_b16 v[16:17], v9 offset:8192
    ds_read_b64_tr_b16 v[18:19], v9 offset:9216
    s_add_u32 m0, s48, 66560
    s_nop 0
    buffer_load_dwordx4 v2, s[4:7], s50 offen lds
    v_mul_f32 v38, v38, v59
    v_mul_f32 v39, v39, v59
    v_cvt_pk_bf16_f32 v196, v36, v37
    v_mfma_f32_32x32x16_bf16 v[112:127], a[108:111], v[20:23], v[112:127]
    v_mul_f32 v40, v40, v59
    v_mul_f32 v41, v41, v59
    s_waitcnt lgkmcnt(6)
    v_mfma_f32_32x32x16_bf16 v[128:143], a[104:107], v[24:27], v[128:143]
    ds_read_b64_tr_b16 v[20:21], v10 offset:8192
    ds_read_b64_tr_b16 v[22:23], v10 offset:9216
    s_add_u32 s50, s50, 16384
    s_add_u32 m0, s48, 67584
    s_nop 0
    buffer_load_dwordx4 v1, s[4:7], s50 offen lds
    v_cvt_pk_bf16_f32 v197, v38, v39
    ds_bpermute_b32 v208, v34, v196
    v_mul_f32 v42, v42, v59
    v_mfma_f32_32x32x16_bf16 v[144:159], a[108:111], v[24:27], v[144:159]
    v_mul_f32 v43, v43, v59
    v_cvt_pk_bf16_f32 v198, v40, v41
    s_waitcnt lgkmcnt(7)
    v_mfma_f32_32x32x16_bf16 v[160:175], a[104:107], v[28:31], v[160:175]
    ds_read_b64_tr_b16 v[24:25], v11 offset:8192
    ds_read_b64_tr_b16 v[26:27], v11 offset:9216
    s_add_u32 m0, s48, 68608
    s_nop 0
    buffer_load_dwordx4 v2, s[4:7], s50 offen lds
    ds_bpermute_b32 v209, v34, v197
    v_mul_f32 v44, v44, v59
    v_mul_f32 v45, v45, v59
    v_mfma_f32_32x32x16_bf16 v[176:191], a[108:111], v[28:31], v[176:191]
    v_cvt_pk_bf16_f32 v199, v42, v43
    ds_bpermute_b32 v210, v34, v198
    s_waitcnt lgkmcnt(7)
    v_mfma_f32_32x32x16_bf16 v[64:79], a[112:115], v[16:19], v[64:79]
    ds_read_b64_tr_b16 v[28:29], v12 offset:8192
    ds_read_b64_tr_b16 v[30:31], v12 offset:9216
    s_add_u32 s50, s50, 16384
    s_add_u32 m0, s48, 69632
    s_nop 0
    buffer_load_dwordx4 v1, s[4:7], s50 offen lds
    v_mul_f32 v46, v46, v59
    v_mul_f32 v47, v47, v59
    v_cvt_pk_bf16_f32 v200, v44, v45
    v_mfma_f32_32x32x16_bf16 v[80:95], a[116:119], v[16:19], v[80:95]
    ds_bpermute_b32 v211, v34, v199
    v_mul_f32 v48, v48, v59
    v_mul_f32 v49, v49, v59
    s_waitcnt lgkmcnt(8)
    v_mfma_f32_32x32x16_bf16 v[96:111], a[112:115], v[20:23], v[96:111]
    v_add_u32 v8, -65536, v8
    ds_read_b128 a[120:123], v8 offset:0
    ds_read_b128 a[124:127], v8 offset:4096
    ds_read_b64_tr_b16 v[16:17], v9 offset:12288
    ds_read_b64_tr_b16 v[18:19], v9 offset:13312
    s_add_u32 m0, s48, 70656
    s_nop 0
    buffer_load_dwordx4 v2, s[4:7], s50 offen lds
    v_cvt_pk_bf16_f32 v201, v46, v47
    ds_bpermute_b32 v212, v34, v200
    v_mfma_f32_32x32x16_bf16 v[112:127], a[116:119], v[20:23], v[112:127]
    v_mul_f32 v50, v50, v59
    v_mul_f32 v51, v51, v59
    v_cvt_pk_bf16_f32 v202, v48, v49
    s_waitcnt lgkmcnt(10)
    v_mfma_f32_32x32x16_bf16 v[128:143], a[112:115], v[24:27], v[128:143]
    ds_read_b64_tr_b16 v[20:21], v10 offset:12288
    ds_read_b64_tr_b16 v[22:23], v10 offset:13312
    s_add_u32 s50, s50, 16384
    s_add_u32 m0, s48, 71680
    s_nop 0
    buffer_load_dwordx4 v1, s[4:7], s50 offen lds
    ds_bpermute_b32 v213, v34, v201
    v_mul_f32 v52, v52, v59
    v_mfma_f32_32x32x16_bf16 v[144:159], a[116:119], v[24:27], v[144:159]
    v_mul_f32 v53, v53, v59
    v_cvt_pk_bf16_f32 v203, v50, v51
    ds_bpermute_b32 v214, v34, v202
    s_waitcnt lgkmcnt(10)
    v_mfma_f32_32x32x16_bf16 v[160:175], a[112:115], v[28:31], v[160:175]
    ds_read_b64_tr_b16 v[24:25], v11 offset:12288
    ds_read_b64_tr_b16 v[26:27], v11 offset:13312
    s_add_u32 m0, s48, 72704
    s_nop 0
    buffer_load_dwordx4 v2, s[4:7], s50 offen lds
    v_mul_f32 v54, v54, v59
    v_mul_f32 v55, v55, v59
    v_mfma_f32_32x32x16_bf16 v[176:191], a[116:119], v[28:31], v[176:191]
    v_cvt_pk_bf16_f32 v204, v52, v53
    ds_bpermute_b32 v215, v34, v203
    v_mul_f32 v56, v56, v59
    s_waitcnt lgkmcnt(8)
    v_mfma_f32_32x32x16_bf16 v[64:79], a[120:123], v[16:19], v[64:79]
    ds_read_b64_tr_b16 v[28:29], v12 offset:12288
    ds_read_b64_tr_b16 v[30:31], v12 offset:13312
    v_mul_f32 v57, v57, v59
    v_cvt_pk_bf16_f32 v205, v54, v55
    v_mfma_f32_32x32x16_bf16 v[80:95], a[124:127], v[16:19], v[80:95]
    ds_bpermute_b32 v216, v34, v204
    v_mul_f32 v232, v232, v59
    v_mul_f32 v233, v233, v59
    s_waitcnt lgkmcnt(8)
    v_mfma_f32_32x32x16_bf16 v[96:111], a[120:123], v[20:23], v[96:111]
    s_waitcnt vmcnt(12)
    s_barrier
    v_add_u32 v5, 32768, v5
    ds_read_b128 a[128:131], v5 offset:0
    ds_read_b128 a[132:135], v5 offset:4096
    ds_read_b64_tr_b16 v[16:17], v9 offset:16384
    ds_read_b64_tr_b16 v[18:19], v9 offset:17408
    v_cvt_pk_bf16_f32 v206, v56, v57
    ds_bpermute_b32 v217, v34, v205
    v_cvt_pk_bf16_f32 v207, v232, v233
    v_mfma_f32_32x32x16_bf16 v[112:127], a[124:127], v[20:23], v[112:127]
    v_mov_b32 v36, 0
    v_mov_b32 v38, -1
    s_waitcnt lgkmcnt(9)
    v_mfma_f32_32x32x16_bf16 v[128:143], a[120:123], v[24:27], v[128:143]
    ds_read_b64_tr_b16 v[20:21], v10 offset:16384
    ds_read_b64_tr_b16 v[22:23], v10 offset:17408
    v_mov_b32 v39, -1
    v_lshlrev_b32 v37, 1, v35
    ds_bpermute_b32 v218, v34, v206
    v_mfma_f32_32x32x16_bf16 v[144:159], a[124:127], v[24:27], v[144:159]
    ds_bpermute_b32 v219, v34, v207
    s_waitcnt lgkmcnt(10)
    v_mfma_f32_32x32x16_bf16 v[160:175], a[120:123], v[28:31], v[160:175]
    ds_read_b64_tr_b16 v[24:25], v11 offset:16384
    ds_read_b64_tr_b16 v[26:27], v11 offset:17408
    v_mfma_f32_32x32x16_bf16 v[176:191], a[124:127], v[28:31], v[176:191]
    s_waitcnt lgkmcnt(7)
    v_mfma_f32_32x32x16_bf16 v[64:79], a[128:131], v[16:19], v[64:79]
    ds_read_b64_tr_b16 v[28:29], v12 offset:16384
    ds_read_b64_tr_b16 v[30:31], v12 offset:17408
    s_add_u32 s52, s25, 6
    s_and_b32 s52, s52, 7
    s_lshl_b32 s52, s52, 19
    s_add_u32 m0, s47, 49152
    s_nop 0
    buffer_load_dwordx4 v3, s[8:11], s52 offen lds
    s_waitcnt lgkmcnt(4)
    buffer_store_dwordx4 v[208:211], v33, s[20:23], s43 offen offset:0 sc0 sc1
    buffer_store_dwordx4 v[212:215], v33, s[20:23], s43 offen offset:2048 sc0 sc1
    buffer_store_dwordx4 v[216:219], v33, s[20:23], s42 offen offset:0 sc0 sc1
    v_mfma_f32_32x32x16_bf16 v[80:95], a[132:135], v[16:19], v[80:95]
    buffer_store_dword v36, v35, s[20:23], s58 offen sc0 sc1
    buffer_store_dwordx2 v[38:39], v37, s[20:23], s59 offen sc0 sc1
    v_mfma_f32_32x32x16_bf16 v[96:111], a[128:131], v[20:23], v[96:111]
    v_add_u32 v6, 32768, v6
    ds_read_b128 a[136:139], v6 offset:0
    ds_read_b128 a[140:143], v6 offset:4096
    ds_read_b64_tr_b16 v[16:17], v9 offset:20480
    ds_read_b64_tr_b16 v[18:19], v9 offset:21504
    s_add_u32 s52, s52, 32768
    s_add_u32 m0, s47, 50176
    s_nop 0
    buffer_load_dwordx4 v3, s[8:11], s52 offen lds
    v_lshl_add_u32 v54, v0, 20, s34
    v_mfma_f32_32x32x16_bf16 v[112:127], a[132:135], v[20:23], v[112:127]
    v_mov_b32 v55, 1
    s_waitcnt lgkmcnt(6)
    v_mfma_f32_32x32x16_bf16 v[128:143], a[128:131], v[24:27], v[128:143]
    ds_read_b64_tr_b16 v[20:21], v10 offset:20480
    ds_read_b64_tr_b16 v[22:23], v10 offset:21504
    s_add_u32 s52, s52, 32768
    s_add_u32 m0, s47, 51200
    s_nop 0
    buffer_load_dwordx4 v3, s[8:11], s52 offen lds
    s_add_u32 s42, s41, 0
    s_sub_u32 s60, s42, 512
    s_cmp_lt_u32 s42, 512
    s_cselect_b32 s68, s64, s66
    s_cselect_b32 s69, s65, s67
    s_cselect_b32 s60, s42, s60
    s_cselect_b32 s61, 0, 0x100000
    s_cselect_b32 s62, 8, 9
    v_mfma_f32_32x32x16_bf16 v[144:159], a[132:135], v[24:27], v[144:159]
    s_lshl_b32 s62, s62, 4
    s_mul_i32 s70, s62, 36864
    s_waitcnt lgkmcnt(6)
    v_mfma_f32_32x32x16_bf16 v[160:175], a[128:131], v[28:31], v[160:175]
    ds_read_b64_tr_b16 v[24:25], v11 offset:20480
    ds_read_b64_tr_b16 v[26:27], v11 offset:21504
    s_add_u32 s52, s52, 32768
    s_add_u32 m0, s47, 52224
    s_nop 0
    buffer_load_dwordx4 v3, s[8:11], s52 offen lds
    s_mov_b32 s71, 0x00020000
    s_lshl_b32 s63, s60, 8
    v_mfma_f32_32x32x16_bf16 v[176:191], a[132:135], v[28:31], v[176:191]
    s_add_u32 s61, s61, s63
    s_add_u32 s54, s61, 37748736
    s_waitcnt lgkmcnt(4)
    v_mfma_f32_32x32x16_bf16 v[64:79], a[136:139], v[16:19], v[64:79]
    ds_read_b64_tr_b16 v[28:29], v12 offset:20480
    ds_read_b64_tr_b16 v[30:31], v12 offset:21504
    s_add_u32 s50, s25, 6
    s_and_b32 s50, s50, 7
    s_lshl_b32 s50, s50, 7
    s_add_u32 m0, s48, 0
    s_nop 0
    buffer_load_dwordx4 v1, s[4:7], s50 offen lds
    s_mul_i32 s55, s60, 9216
    v_mfma_f32_32x32x16_bf16 v[80:95], a[140:143], v[16:19], v[80:95]
    s_lshl_b32 s62, s62, 10
    s_cmp_lt_u32 s42, 1088
    s_cselect_b32 s61, 0, 0x7f000000
    s_waitcnt lgkmcnt(4)
    v_mfma_f32_32x32x16_bf16 v[96:111], a[136:139], v[20:23], v[96:111]
    v_add_u32 v7, 32768, v7
    ds_read_b128 a[144:147], v7 offset:0
    ds_read_b128 a[148:151], v7 offset:4096
    ds_read_b64_tr_b16 v[16:17], v9 offset:24576
    ds_read_b64_tr_b16 v[18:19], v9 offset:25600
    s_add_u32 m0, s48, 1024
    s_nop 0
    buffer_load_dwordx4 v2, s[4:7], s50 offen lds
    v_lshrrev_b32 v50, 3, v0
    v_and_b32 v51, 7, v0
    v_mfma_f32_32x32x16_bf16 v[112:127], a[140:143], v[20:23], v[112:127]
    v_lshlrev_b32 v51, 4, v51
    v_mul_u32_u24 v40, 1152, v50
    s_waitcnt lgkmcnt(6)
    v_mfma_f32_32x32x16_bf16 v[128:143], a[136:139], v[24:27], v[128:143]
    ds_read_b64_tr_b16 v[20:21], v10 offset:24576
    ds_read_b64_tr_b16 v[22:23], v10 offset:25600
    s_add_u32 s50, s50, 16384
    s_add_u32 m0, s48, 2048
    s_nop 0
    buffer_load_dwordx4 v1, s[4:7], s50 offen lds
    v_add3_u32 v40, v40, v51, s61
    buffer_load_dwordx4 v[44:47], v40, s[68:71], s55 offen offset:1024
    v_mfma_f32_32x32x16_bf16 v[144:159], a[140:143], v[24:27], v[144:159]
    v_bfe_u32 v52, v0, 1, 2
    s_waitcnt lgkmcnt(6)
    v_mfma_f32_32x32x16_bf16 v[160:175], a[136:139], v[28:31], v[160:175]
    ds_read_b64_tr_b16 v[24:25], v11 offset:24576
    ds_read_b64_tr_b16 v[26:27], v11 offset:25600
    s_add_u32 m0, s48, 3072
    s_nop 0
    buffer_load_dwordx4 v2, s[4:7], s50 offen lds
    v_mul_lo_u32 v52, v52, s62
    v_lshl_add_u32 v52, v50, 5, v52
    v_mfma_f32_32x32x16_bf16 v[176:191], a[140:143], v[28:31], v[176:191]
    v_and_b32 v53, 16, v51
    v_add3_u32 v41, v52, v53, s61
    s_waitcnt lgkmcnt(4)
    v_mfma_f32_32x32x16_bf16 v[64:79], a[144:147], v[16:19], v[64:79]
    ds_read_b64_tr_b16 v[28:29], v12 offset:24576
    ds_read_b64_tr_b16 v[30:31], v12 offset:25600
    s_add_u32 s50, s50, 16384
    s_add_u32 m0, s48, 4096
    s_nop 0
    buffer_load_dwordx4 v1, s[4:7], s50 offen lds
    s_and_b32 s58, s42, 15
    s_lshl_b32 s58, s58, 8
    v_mfma_f32_32x32x16_bf16 v[80:95], a[148:151], v[16:19], v[80:95]
    s_bfe_u32 s56, s42, 0x30006
    s_lshl_b32 s56, s56, 12
    s_waitcnt lgkmcnt(4)
    v_mfma_f32_32x32x16_bf16 v[96:111], a[144:147], v[20:23], v[96:111]
    v_add_u32 v8, 32768, v8
    ds_read_b128 a[152:155], v8 offset:0
    ds_read_b128 a[156:159], v8 offset:4096
    ds_read_b64_tr_b16 v[16:17], v9 offset:28672
    ds_read_b64_tr_b16 v[18:19], v9 offset:29696
    s_add_u32 m0, s48, 5120
    s_nop 0
    buffer_load_dwordx4 v2, s[4:7], s50 offen lds
    s_add_u32 s58, s58, s56
    v_mfma_f32_32x32x16_bf16 v[112:127], a[148:151], v[20:23], v[112:127]
    s_bfe_u32 s56, s42, 0x20004
    s_lshl_b32 s56, s56, 3
    s_waitcnt lgkmcnt(6)
    v_mfma_f32_32x32x16_bf16 v[128:143], a[144:147], v[24:27], v[128:143]
    ds_read_b64_tr_b16 v[20:21], v10 offset:28672
    ds_read_b64_tr_b16 v[22:23], v10 offset:29696
    s_add_u32 s50, s50, 16384
    s_add_u32 m0, s48, 6144
    s_nop 0
    buffer_load_dwordx4 v1, s[4:7], s50 offen lds
    s_add_u32 s58, s58, s56
    s_add_u32 s58, s58, 36962304
    v_mfma_f32_32x32x16_bf16 v[144:159], a[148:151], v[24:27], v[144:159]
    s_cmp_lt_u32 s42, 512
    s_cselect_b32 s61, 0, 0x40000000
    v_lshlrev_b32 v42, 22, v51
    s_waitcnt lgkmcnt(6)
    v_mfma_f32_32x32x16_bf16 v[160:175], a[144:147], v[28:31], v[160:175]
    ds_read_b64_tr_b16 v[24:25], v11 offset:28672
    ds_read_b64_tr_b16 v[26:27], v11 offset:29696
    s_add_u32 m0, s48, 7168
    s_nop 0
    buffer_load_dwordx4 v2, s[4:7], s50 offen lds
    v_lshl_add_u32 v42, v50, 5, v42
    v_add_u32 v42, s61, v42
    v_mfma_f32_32x32x16_bf16 v[176:191], a[148:151], v[28:31], v[176:191]
    v_mov_b32 v48, 0
    s_waitcnt lgkmcnt(4)
    v_mfma_f32_32x32x16_bf16 v[64:79], a[152:155], v[16:19], v[64:79]
    ds_read_b64_tr_b16 v[28:29], v12 offset:28672
    ds_read_b64_tr_b16 v[30:31], v12 offset:29696
    v_mfma_f32_32x32x16_bf16 v[80:95], a[156:159], v[16:19], v[80:95]
    s_waitcnt lgkmcnt(4)
    v_mfma_f32_32x32x16_bf16 v[96:111], a[152:155], v[20:23], v[96:111]
    s_waitcnt vmcnt(18)
    s_barrier
    v_add_u32 v5, 32768, v5
    ds_read_b128 a[160:163], v5 offset:0
    ds_read_b128 a[164:167], v5 offset:4096
    ds_read_b64_tr_b16 v[16:17], v9 offset:32768
    ds_read_b64_tr_b16 v[18:19], v9 offset:33792
    v_mfma_f32_32x32x16_bf16 v[112:127], a[156:159], v[20:23], v[112:127]
    s_waitcnt lgkmcnt(6)
    v_mfma_f32_32x32x16_bf16 v[128:143], a[152:155], v[24:27], v[128:143]
    ds_read_b64_tr_b16 v[20:21], v10 offset:32768
    ds_read_b64_tr_b16 v[22:23], v10 offset:33792
    v_mfma_f32_32x32x16_bf16 v[144:159], a[156:159], v[24:27], v[144:159]
    s_waitcnt lgkmcnt(6)
    v_mfma_f32_32x32x16_bf16 v[160:175], a[152:155], v[28:31], v[160:175]
    ds_read_b64_tr_b16 v[24:25], v11 offset:32768
    ds_read_b64_tr_b16 v[26:27], v11 offset:33792
    v_mfma_f32_32x32x16_bf16 v[176:191], a[156:159], v[28:31], v[176:191]
    s_waitcnt lgkmcnt(4)
    v_mfma_f32_32x32x16_bf16 v[64:79], a[160:163], v[16:19], v[64:79]
    ds_read_b64_tr_b16 v[28:29], v12 offset:32768
    ds_read_b64_tr_b16 v[30:31], v12 offset:33792
    s_add_u32 s52, s25, 7
    s_and_b32 s52, s52, 7
    s_lshl_b32 s52, s52, 19
    s_add_u32 m0, s47, 0
    s_nop 0
    buffer_load_dwordx4 v3, s[8:11], s52 offen lds
    v_mfma_f32_32x32x16_bf16 v[80:95], a[164:167], v[16:19], v[80:95]
    s_waitcnt lgkmcnt(4)
    v_mfma_f32_32x32x16_bf16 v[96:111], a[160:163], v[20:23], v[96:111]
    v_add_u32 v6, 32768, v6
    ds_read_b128 a[168:171], v6 offset:0
    ds_read_b128 a[172:175], v6 offset:4096
    ds_read_b64_tr_b16 v[16:17], v9 offset:36864
    ds_read_b64_tr_b16 v[18:19], v9 offset:37888
    s_add_u32 s52, s52, 32768
    s_add_u32 m0, s47, 1024
    s_nop 0
    buffer_load_dwordx4 v3, s[8:11], s52 offen lds
    v_mfma_f32_32x32x16_bf16 v[112:127], a[164:167], v[20:23], v[112:127]
    s_waitcnt lgkmcnt(6)
    v_mfma_f32_32x32x16_bf16 v[128:143], a[160:163], v[24:27], v[128:143]
    ds_read_b64_tr_b16 v[20:21], v10 offset:36864
    ds_read_b64_tr_b16 v[22:23], v10 offset:37888
    s_add_u32 s52, s52, 32768
    s_add_u32 m0, s47, 2048
    s_nop 0
    buffer_load_dwordx4 v3, s[8:11], s52 offen lds
    v_mfma_f32_32x32x16_bf16 v[144:159], a[164:167], v[24:27], v[144:159]
    s_waitcnt lgkmcnt(6)
    v_mfma_f32_32x32x16_bf16 v[160:175], a[160:163], v[28:31], v[160:175]
    ds_read_b64_tr_b16 v[24:25], v11 offset:36864
    ds_read_b64_tr_b16 v[26:27], v11 offset:37888
    s_add_u32 s52, s52, 32768
    s_add_u32 m0, s47, 3072
    s_nop 0
    buffer_load_dwordx4 v3, s[8:11], s52 offen lds
    v_mfma_f32_32x32x16_bf16 v[176:191], a[164:167], v[28:31], v[176:191]
    s_waitcnt lgkmcnt(4)
    v_mfma_f32_32x32x16_bf16 v[64:79], a[168:171], v[16:19], v[64:79]
    ds_read_b64_tr_b16 v[28:29], v12 offset:36864
    ds_read_b64_tr_b16 v[30:31], v12 offset:37888
    s_add_u32 s50, s25, 7
    s_and_b32 s50, s50, 7
    s_lshl_b32 s50, s50, 7
    s_add_u32 m0, s48, 32768
    s_nop 0
    buffer_load_dwordx4 v1, s[4:7], s50 offen lds
    v_mfma_f32_32x32x16_bf16 v[80:95], a[172:175], v[16:19], v[80:95]
    s_waitcnt lgkmcnt(4)
    v_mfma_f32_32x32x16_bf16 v[96:111], a[168:171], v[20:23], v[96:111]
    v_add_u32 v7, 32768, v7
    ds_read_b128 a[176:179], v7 offset:0
    ds_read_b128 a[180:183], v7 offset:4096
    ds_read_b64_tr_b16 v[16:17], v9 offset:40960
    ds_read_b64_tr_b16 v[18:19], v9 offset:41984
    s_add_u32 m0, s48, 33792
    s_nop 0
    buffer_load_dwordx4 v2, s[4:7], s50 offen lds
    v_mfma_f32_32x32x16_bf16 v[112:127], a[172:175], v[20:23], v[112:127]
    s_waitcnt lgkmcnt(6)
    v_mfma_f32_32x32x16_bf16 v[128:143], a[168:171], v[24:27], v[128:143]
    ds_read_b64_tr_b16 v[20:21], v10 offset:40960
    ds_read_b64_tr_b16 v[22:23], v10 offset:41984
    s_add_u32 s50, s50, 16384
    s_add_u32 m0, s48, 34816
    s_nop 0
    buffer_load_dwordx4 v1, s[4:7], s50 offen lds
    v_mfma_f32_32x32x16_bf16 v[144:159], a[172:175], v[24:27], v[144:159]
    s_waitcnt lgkmcnt(6)
    v_mfma_f32_32x32x16_bf16 v[160:175], a[168:171], v[28:31], v[160:175]
    ds_read_b64_tr_b16 v[24:25], v11 offset:40960
    ds_read_b64_tr_b16 v[26:27], v11 offset:41984
    s_add_u32 m0, s48, 35840
    s_nop 0
    buffer_load_dwordx4 v2, s[4:7], s50 offen lds
    v_mfma_f32_32x32x16_bf16 v[176:191], a[172:175], v[28:31], v[176:191]
    s_waitcnt lgkmcnt(4)
    v_mfma_f32_32x32x16_bf16 v[64:79], a[176:179], v[16:19], v[64:79]
    ds_read_b64_tr_b16 v[28:29], v12 offset:40960
    ds_read_b64_tr_b16 v[30:31], v12 offset:41984
    s_add_u32 s50, s50, 16384
    s_add_u32 m0, s48, 36864
    s_nop 0
    buffer_load_dwordx4 v1, s[4:7], s50 offen lds
    v_mfma_f32_32x32x16_bf16 v[80:95], a[180:183], v[16:19], v[80:95]
    s_waitcnt lgkmcnt(4)
    v_mfma_f32_32x32x16_bf16 v[96:111], a[176:179], v[20:23], v[96:111]
    v_add_u32 v8, 32768, v8
    ds_read_b128 a[184:187], v8 offset:0
    ds_read_b128 a[188:191], v8 offset:4096
    ds_read_b64_tr_b16 v[16:17], v9 offset:45056
    ds_read_b64_tr_b16 v[18:19], v9 offset:46080
    s_add_u32 m0, s48, 37888
    s_nop 0
    buffer_load_dwordx4 v2, s[4:7], s50 offen lds
    v_mfma_f32_32x32x16_bf16 v[112:127], a[180:183], v[20:23], v[112:127]
    s_waitcnt lgkmcnt(6)
    v_mfma_f32_32x32x16_bf16 v[128:143], a[176:179], v[24:27], v[128:143]
    ds_read_b64_tr_b16 v[20:21], v10 offset:45056
    ds_read_b64_tr_b16 v[22:23], v10 offset:46080
    s_add_u32 s50, s50, 16384
    s_add_u32 m0, s48, 38912
    s_nop 0
    buffer_load_dwordx4 v1, s[4:7], s50 offen lds
    v_mfma_f32_32x32x16_bf16 v[144:159], a[180:183], v[24:27], v[144:159]
    s_waitcnt lgkmcnt(6)
    v_mfma_f32_32x32x16_bf16 v[160:175], a[176:179], v[28:31], v[160:175]
    ds_read_b64_tr_b16 v[24:25], v11 offset:45056
    ds_read_b64_tr_b16 v[26:27], v11 offset:46080
    s_add_u32 m0, s48, 39936
    s_nop 0
    buffer_load_dwordx4 v2, s[4:7], s50 offen lds
    v_mfma_f32_32x32x16_bf16 v[176:191], a[180:183], v[28:31], v[176:191]
    s_waitcnt lgkmcnt(4)
    v_mfma_f32_32x32x16_bf16 v[64:79], a[184:187], v[16:19], v[64:79]
    ds_read_b64_tr_b16 v[28:29], v12 offset:45056
    ds_read_b64_tr_b16 v[30:31], v12 offset:46080
    v_mfma_f32_32x32x16_bf16 v[80:95], a[188:191], v[16:19], v[80:95]
    s_waitcnt lgkmcnt(4)
    v_mfma_f32_32x32x16_bf16 v[96:111], a[184:187], v[20:23], v[96:111]
    s_waitcnt vmcnt(12)
    s_barrier
    buffer_store_byte v55, v54, s[92:95], 0 offen sc0 sc1
    v_add_u32 v5, -65536, v5
    ds_read_b128 a[192:195], v5 offset:0
    ds_read_b128 a[196:199], v5 offset:4096
    ds_read_b64_tr_b16 v[16:17], v9 offset:49152
    ds_read_b64_tr_b16 v[18:19], v9 offset:50176
    buffer_store_dwordx4 v[44:47], v41, s[20:23], s54 offen sc0 sc1
    v_mfma_f32_32x32x16_bf16 v[112:127], a[188:191], v[20:23], v[112:127]
    v_dot2c_f32_bf16 v48, 0x3f803f80, v44
    s_waitcnt lgkmcnt(6)
    v_mfma_f32_32x32x16_bf16 v[128:143], a[184:187], v[24:27], v[128:143]
    ds_read_b64_tr_b16 v[20:21], v10 offset:49152
    ds_read_b64_tr_b16 v[22:23], v10 offset:50176
    v_dot2c_f32_bf16 v48, 0x3f803f80, v45
    v_mfma_f32_32x32x16_bf16 v[144:159], a[188:191], v[24:27], v[144:159]
    v_dot2c_f32_bf16 v48, 0x3f803f80, v46
    s_waitcnt lgkmcnt(6)
    v_mfma_f32_32x32x16_bf16 v[160:175], a[184:187], v[28:31], v[160:175]
    ds_read_b64_tr_b16 v[24:25], v11 offset:49152
    ds_read_b64_tr_b16 v[26:27], v11 offset:50176
    v_dot2c_f32_bf16 v48, 0x3f803f80, v47
    s_load_dwordx2 s[32:33], s[0:1], 16
    v_mfma_f32_32x32x16_bf16 v[176:191], a[188:191], v[28:31], v[176:191]
    s_nop 0
    v_add_f32_dpp v48, v48, v48 quad_perm:[1,0,3,2] row_mask:0xf bank_mask:0xf
    s_waitcnt lgkmcnt(4)
    v_mfma_f32_32x32x16_bf16 v[64:79], a[192:195], v[16:19], v[64:79]
    ds_read_b64_tr_b16 v[28:29], v12 offset:49152
    ds_read_b64_tr_b16 v[30:31], v12 offset:50176
    s_add_u32 s52, s49, 0
    s_and_b32 s52, s52, 7
    s_lshl_b32 s52, s52, 19
    s_add_u32 m0, s47, 16384
    s_nop 0
    buffer_load_dwordx4 v4, s[8:11], s52 offen lds
    v_add_f32_dpp v48, v48, v48 quad_perm:[2,3,0,1] row_mask:0xf bank_mask:0xf
    v_mfma_f32_32x32x16_bf16 v[80:95], a[196:199], v[16:19], v[80:95]
    s_nop 0
    v_add_f32_dpp v48, v48, v48 row_half_mirror row_mask:0xf bank_mask:0xf
    s_waitcnt lgkmcnt(4)
    v_mfma_f32_32x32x16_bf16 v[96:111], a[192:195], v[20:23], v[96:111]
    v_add_u32 v6, -65536, v6
    ds_read_b128 a[200:203], v6 offset:0
    ds_read_b128 a[204:207], v6 offset:4096
    ds_read_b64_tr_b16 v[16:17], v9 offset:53248
    ds_read_b64_tr_b16 v[18:19], v9 offset:54272
    s_add_u32 s52, s52, 65536
    s_add_u32 m0, s47, 17408
    s_nop 0
    buffer_load_dwordx4 v4, s[8:11], s52 offen lds
    v_mul_f32 v48, 0x3ae38e39, v48
    v_mfma_f32_32x32x16_bf16 v[112:127], a[196:199], v[20:23], v[112:127]
    v_cvt_pk_bf16_f32 v49, v48, v48
    s_waitcnt lgkmcnt(6)
    v_mfma_f32_32x32x16_bf16 v[128:143], a[192:195], v[24:27], v[128:143]
    ds_read_b64_tr_b16 v[20:21], v10 offset:53248
    ds_read_b64_tr_b16 v[22:23], v10 offset:54272
    s_add_u32 s52, s52, 65536
    s_add_u32 m0, s47, 18432
    s_nop 0
    buffer_load_dwordx4 v4, s[8:11], s52 offen lds
    v_and_b32 v49, 0xffff0000, v49
    v_mfma_f32_32x32x16_bf16 v[144:159], a[196:199], v[24:27], v[144:159]
    v_sub_f32 v49, v48, v49
    s_waitcnt lgkmcnt(6)
    v_mfma_f32_32x32x16_bf16 v[160:175], a[192:195], v[28:31], v[160:175]
    ds_read_b64_tr_b16 v[24:25], v11 offset:53248
    ds_read_b64_tr_b16 v[26:27], v11 offset:54272
    s_add_u32 s52, s52, 65536
    s_add_u32 m0, s47, 19456
    s_nop 0
    buffer_load_dwordx4 v4, s[8:11], s52 offen lds
    v_cvt_pk_bf16_f32 v49, v48, v49
    s_waitcnt lgkmcnt(0)
    v_mfma_f32_32x32x16_bf16 v[176:191], a[196:199], v[28:31], v[176:191]
    buffer_store_dword v49, v42, s[20:23], s58 offen offset:4 sc0 sc1
    s_mov_b32 s4, s32
    s_mov_b32 s5, s33
    s_mov_b32 s6, 0x480000
    s_mov_b32 s7, 0x00020000
    v_mfma_f32_32x32x16_bf16 v[64:79], a[200:203], v[16:19], v[64:79]
    ds_read_b64_tr_b16 v[28:29], v12 offset:53248
    ds_read_b64_tr_b16 v[30:31], v12 offset:54272
    s_add_u32 s52, s49, 2
    s_and_b32 s52, s52, 7
    s_lshl_b32 s52, s52, 19
    s_add_u32 m0, s47, 131072
    s_nop 0
    buffer_load_dwordx4 v4, s[8:11], s52 offen lds
    s_add_u32 s42, s41, 1
    s_sub_u32 s60, s42, 512
    s_cmp_lt_u32 s42, 512
    s_cselect_b32 s68, s64, s66
    s_cselect_b32 s69, s65, s67
    s_cselect_b32 s60, s42, s60
    s_cselect_b32 s61, 0, 0x100000
    s_cselect_b32 s62, 8, 9
    s_lshr_b32 s44, s2, 3
    s_mul_i32 s44, s44, 18
    v_mfma_f32_32x32x16_bf16 v[80:95], a[204:207], v[16:19], v[80:95]
    s_lshl_b32 s62, s62, 4
    s_mul_i32 s70, s62, 36864
    s_lshl_b32 s45, s24, 3
    s_add_u32 s44, s44, s45
    s_lshl_b32 s44, s44, 13
    v_mfma_f32_32x32x16_bf16 v[96:111], a[200:203], v[20:23], v[96:111]
    v_add_u32 v7, -65536, v7
    ds_read_b128 a[208:211], v7 offset:0
    ds_read_b128 a[212:215], v7 offset:4096
    ds_read_b64_tr_b16 v[16:17], v9 offset:57344
    ds_read_b64_tr_b16 v[18:19], v9 offset:58368
    s_add_u32 s52, s52, 65536
    s_add_u32 m0, s47, 132096
    s_nop 0
    buffer_load_dwordx4 v4, s[8:11], s52 offen lds
    s_mov_b32 s71, 0x00020000
    s_lshl_b32 s63, s60, 8
    s_and_b32 s45, s2, 7
    s_lshl_b32 s45, s45, 10
    s_add_u32 s44, s44, s45
    v_mfma_f32_32x32x16_bf16 v[112:127], a[204:207], v[20:23], v[112:127]
    s_add_u32 s61, s61, s63
    s_add_u32 s54, s61, 37748736
    v_lshrrev_b32 v1, 3, v0
    v_mfma_f32_32x32x16_bf16 v[128:143], a[200:203], v[24:27], v[128:143]
    ds_read_b64_tr_b16 v[20:21], v10 offset:57344
    ds_read_b64_tr_b16 v[22:23], v10 offset:58368
    s_add_u32 s52, s52, 65536
    s_add_u32 m0, s47, 133120
    s_nop 0
    buffer_load_dwordx4 v4, s[8:11], s52 offen lds
    s_mul_i32 s55, s60, 9216
    v_lshlrev_b32 v1, 13, v1
    v_mfma_f32_32x32x16_bf16 v[144:159], a[204:207], v[24:27], v[144:159]
    s_lshl_b32 s62, s62, 10
    s_cmp_lt_u32 s42, 1088
    s_cselect_b32 s61, 0, 0x7f000000
    s_waitcnt lgkmcnt(6)
    v_mfma_f32_32x32x16_bf16 v[160:175], a[200:203], v[28:31], v[160:175]
    ds_read_b64_tr_b16 v[24:25], v11 offset:57344
    ds_read_b64_tr_b16 v[26:27], v11 offset:58368
    s_add_u32 s52, s52, 65536
    s_add_u32 m0, s47, 134144
    s_nop 0
    buffer_load_dwordx4 v4, s[8:11], s52 offen lds
    v_lshrrev_b32 v50, 3, v0
    v_and_b32 v51, 7, v0
    v_and_b32 v2, 7, v0
    v_mfma_f32_32x32x16_bf16 v[176:191], a[204:207], v[28:31], v[176:191]
    v_lshlrev_b32 v51, 4, v51
    v_mul_u32_u24 v40, 1152, v50
    v_lshl_add_u32 v1, v2, 7, v1
    s_waitcnt lgkmcnt(4)
    v_mfma_f32_32x32x16_bf16 v[64:79], a[208:211], v[16:19], v[64:79]
    ds_read_b64_tr_b16 v[28:29], v12 offset:57344
    ds_read_b64_tr_b16 v[30:31], v12 offset:58368
    s_add_u32 s52, s49, 4
    s_and_b32 s52, s52, 7
    s_lshl_b32 s52, s52, 19
    s_add_u32 m0, s47, 147456
    s_nop 0
    buffer_load_dwordx4 v4, s[8:11], s52 offen lds
    v_add3_u32 v40, v40, v51, s61
    buffer_load_dwordx4 v[44:47], v40, s[68:71], s55 offen offset:1024
    s_cmp_ge_u32 s24, 3
    s_cselect_b32 s44, 0x7f000000, s44
    v_mfma_f32_32x32x16_bf16 v[80:95], a[212:215], v[16:19], v[80:95]
    v_bfe_u32 v52, v0, 1, 2
    v_add_u32 v1, s44, v1
    s_waitcnt lgkmcnt(4)
    v_mfma_f32_32x32x16_bf16 v[96:111], a[208:211], v[20:23], v[96:111]
    v_add_u32 v8, -65536, v8
    ds_read_b128 a[216:219], v8 offset:0
    ds_read_b128 a[220:223], v8 offset:4096
    ds_read_b64_tr_b16 v[16:17], v9 offset:61440
    ds_read_b64_tr_b16 v[18:19], v9 offset:62464
    s_add_u32 s52, s52, 65536
    s_add_u32 m0, s47, 148480
    s_nop 0
    buffer_load_dwordx4 v4, s[8:11], s52 offen lds
    v_mul_lo_u32 v52, v52, s62
    v_lshl_add_u32 v52, v50, 5, v52
    buffer_load_dword v63, v1, s[4:7], 0 offen
    v_mfma_f32_32x32x16_bf16 v[112:127], a[212:215], v[20:23], v[112:127]
    v_and_b32 v53, 16, v51
    v_add3_u32 v41, v52, v53, s61
    s_and_b32 s38, s2, 7
    s_lshr_b32 s39, s2, 3
    s_waitcnt lgkmcnt(6)
    v_mfma_f32_32x32x16_bf16 v[128:143], a[208:211], v[24:27], v[128:143]
    ds_read_b64_tr_b16 v[20:21], v10 offset:61440
    ds_read_b64_tr_b16 v[22:23], v10 offset:62464
    s_add_u32 s52, s52, 65536
    s_add_u32 m0, s47, 149504
    s_nop 0
    buffer_load_dwordx4 v4, s[8:11], s52 offen lds
    s_and_b32 s58, s42, 15
    s_lshl_b32 s58, s58, 8
    s_and_b32 s26, s39, 7
    s_lshr_b32 s39, s39, 3
    s_lshl_b32 s38, s38, 2
    s_add_u32 s25, s38, s39
    v_mfma_f32_32x32x16_bf16 v[144:159], a[212:215], v[24:27], v[144:159]
    s_bfe_u32 s56, s42, 0x30006
    s_lshl_b32 s56, s56, 12
    s_waitcnt lgkmcnt(6)
    v_mfma_f32_32x32x16_bf16 v[160:175], a[208:211], v[28:31], v[160:175]
    ds_read_b64_tr_b16 v[24:25], v11 offset:61440
    ds_read_b64_tr_b16 v[26:27], v11 offset:62464
    s_add_u32 s52, s52, 65536
    s_add_u32 m0, s47, 150528
    s_nop 0
    buffer_load_dwordx4 v4, s[8:11], s52 offen lds
    s_add_u32 s58, s58, s56
    s_sub_u32 s38, 15, s26
    v_mfma_f32_32x32x16_bf16 v[176:191], a[212:215], v[28:31], v[176:191]
    s_bfe_u32 s56, s42, 0x20004
    s_lshl_b32 s56, s56, 3
    s_cmp_ge_u32 s24, 2
    s_cselect_b32 s39, s26, s38
    s_cselect_b32 s45, s38, s26
    s_waitcnt lgkmcnt(4)
    v_mfma_f32_32x32x16_bf16 v[64:79], a[216:219], v[16:19], v[64:79]
    ds_read_b64_tr_b16 v[28:29], v12 offset:61440
    ds_read_b64_tr_b16 v[30:31], v12 offset:62464
    s_add_u32 s58, s58, s56
    s_add_u32 s58, s58, 36962304
    s_and_b32 s44, s24, 1
    s_lshl_b32 s39, s39, 1
    s_add_u32 s39, s39, s44
    s_lshl_b32 s27, s39, 2
    v_mfma_f32_32x32x16_bf16 v[80:95], a[220:223], v[16:19], v[80:95]
    s_cmp_lt_u32 s42, 512
    s_cselect_b32 s61, 0, 0x40000000
    v_lshlrev_b32 v42, 22, v51
    s_lshl_b32 s45, s45, 1
    s_add_u32 s45, s45, 1
    s_sub_u32 s29, s45, s44
    s_waitcnt lgkmcnt(4)
    v_mfma_f32_32x32x16_bf16 v[96:111], a[216:219], v[20:23], v[96:111]
    s_waitcnt vmcnt(17)
    s_barrier
    v_add_u32 v5, 32768, v5
    ds_read_b128 a[224:227], v5 offset:0
    ds_read_b128 a[228:231], v5 offset:4096
    ds_read_b64_tr_b16 v[16:17], v9 offset:0
    ds_read_b64_tr_b16 v[18:19], v9 offset:1024
    v_lshl_add_u32 v42, v50, 5, v42
    v_add_u32 v42, s61, v42
    s_lshl_b32 s35, s29, 3
    v_mfma_f32_32x32x16_bf16 v[112:127], a[220:223], v[20:23], v[112:127]
    v_mov_b32 v48, 0
    s_mul_i32 s48, s29, 73728
    s_waitcnt lgkmcnt(6)
    v_mfma_f32_32x32x16_bf16 v[128:143], a[216:219], v[24:27], v[128:143]
    ds_read_b64_tr_b16 v[20:21], v10 offset:0
    ds_read_b64_tr_b16 v[22:23], v10 offset:1024
    s_and_b32 s46, s25, 3
    s_mul_i32 s46, s46, 144
    v_mfma_f32_32x32x16_bf16 v[144:159], a[220:223], v[24:27], v[144:159]
    s_waitcnt lgkmcnt(6)
    v_mfma_f32_32x32x16_bf16 v[160:175], a[216:219], v[28:31], v[160:175]
    ds_read_b64_tr_b16 v[24:25], v11 offset:0
    ds_read_b64_tr_b16 v[26:27], v11 offset:1024
    v_add_u32 v34, s46, v0
    v_mfma_f32_32x32x16_bf16 v[176:191], a[220:223], v[28:31], v[176:191]
    v_add_u32 v35, 64, v34
    s_waitcnt lgkmcnt(4)
    v_mfma_f32_32x32x16_bf16 v[64:79], a[224:227], v[16:19], v[64:79]
    ds_read_b64_tr_b16 v[28:29], v12 offset:0
    ds_read_b64_tr_b16 v[30:31], v12 offset:1024
    s_add_u32 s52, s49, 6
    s_and_b32 s52, s52, 7
    s_lshl_b32 s52, s52, 19
    s_add_u32 m0, s47, 32768
    s_nop 0
    buffer_load_dwordx4 v4, s[8:11], s52 offen lds
    v_add_u32 v36, 128, v34
    v_mfma_f32_32x32x16_bf16 v[80:95], a[228:231], v[16:19], v[80:95]
    v_min_u32 v36, 575, v36
    s_waitcnt lgkmcnt(4)
    v_mfma_f32_32x32x16_bf16 v[96:111], a[224:227], v[20:23], v[96:111]
    v_add_u32 v6, 32768, v6
    ds_read_b128 a[232:235], v6 offset:0
    ds_read_b128 a[236:239], v6 offset:4096
    ds_read_b64_tr_b16 v[16:17], v9 offset:4096
    ds_read_b64_tr_b16 v[18:19], v9 offset:5120
    s_add_u32 s52, s52, 65536
    s_add_u32 m0, s47, 33792
    s_nop 0
    buffer_load_dwordx4 v4, s[8:11], s52 offen lds
    v_lshlrev_b32 v34, 7, v34
    v_mfma_f32_32x32x16_bf16 v[112:127], a[228:231], v[20:23], v[112:127]
    v_lshlrev_b32 v35, 7, v35
    s_waitcnt lgkmcnt(6)
    v_mfma_f32_32x32x16_bf16 v[128:143], a[224:227], v[24:27], v[128:143]
    ds_read_b64_tr_b16 v[20:21], v10 offset:4096
    ds_read_b64_tr_b16 v[22:23], v10 offset:5120
    s_add_u32 s52, s52, 65536
    s_add_u32 m0, s47, 34816
    s_nop 0
    buffer_load_dwordx4 v4, s[8:11], s52 offen lds
    v_lshlrev_b32 v36, 7, v36
    v_mfma_f32_32x32x16_bf16 v[144:159], a[228:231], v[24:27], v[144:159]
    s_waitcnt lgkmcnt(6)
    v_mfma_f32_32x32x16_bf16 v[160:175], a[224:227], v[28:31], v[160:175]
    ds_read_b64_tr_b16 v[24:25], v11 offset:4096
    ds_read_b64_tr_b16 v[26:27], v11 offset:5120
    s_add_u32 s52, s52, 65536
    s_add_u32 m0, s47, 35840
    s_nop 0
    buffer_load_dwordx4 v4, s[8:11], s52 offen lds
    v_mfma_f32_32x32x16_bf16 v[176:191], a[228:231], v[28:31], v[176:191]
    s_waitcnt lgkmcnt(4)
    v_mfma_f32_32x32x16_bf16 v[64:79], a[232:235], v[16:19], v[64:79]
    ds_read_b64_tr_b16 v[28:29], v12 offset:4096
    ds_read_b64_tr_b16 v[30:31], v12 offset:5120
    s_add_u32 s52, s49, 0
    s_and_b32 s52, s52, 7
    s_lshl_b32 s52, s52, 19
    s_add_u32 s52, s52, 128
    s_add_u32 m0, s47, 81920
    s_nop 0
    buffer_load_dwordx4 v4, s[8:11], s52 offen lds
    v_mfma_f32_32x32x16_bf16 v[80:95], a[236:239], v[16:19], v[80:95]
    s_waitcnt lgkmcnt(4)
    v_mfma_f32_32x32x16_bf16 v[96:111], a[232:235], v[20:23], v[96:111]
    v_add_u32 v7, 32768, v7
    ds_read_b128 a[240:243], v7 offset:0
    ds_read_b128 a[244:247], v7 offset:4096
    ds_read_b64_tr_b16 v[16:17], v9 offset:8192
    ds_read_b64_tr_b16 v[18:19], v9 offset:9216
    s_add_u32 s52, s52, 65536
    s_add_u32 m0, s47, 82944
    s_nop 0
    buffer_load_dwordx4 v4, s[8:11], s52 offen lds
    v_mfma_f32_32x32x16_bf16 v[112:127], a[236:239], v[20:23], v[112:127]
    s_waitcnt lgkmcnt(6)
    v_mfma_f32_32x32x16_bf16 v[128:143], a[232:235], v[24:27], v[128:143]
    ds_read_b64_tr_b16 v[20:21], v10 offset:8192
    ds_read_b64_tr_b16 v[22:23], v10 offset:9216
    s_add_u32 s52, s52, 65536
    s_add_u32 m0, s47, 83968
    s_nop 0
    buffer_load_dwordx4 v4, s[8:11], s52 offen lds
    v_add_u32 v56, 0, v13
    v_mfma_f32_32x32x16_bf16 v[144:159], a[236:239], v[24:27], v[144:159]
    v_add_u32 v57, 0, v14
    s_waitcnt lgkmcnt(6)
    v_mfma_f32_32x32x16_bf16 v[160:175], a[232:235], v[28:31], v[160:175]
    ds_read_b64_tr_b16 v[24:25], v11 offset:8192
    ds_read_b64_tr_b16 v[26:27], v11 offset:9216
    s_add_u32 s52, s52, 65536
    s_add_u32 m0, s47, 84992
    s_nop 0
    buffer_load_dwordx4 v4, s[8:11], s52 offen lds
    v_add_u32 v58, 65536, v13
    v_mfma_f32_32x32x16_bf16 v[176:191], a[236:239], v[28:31], v[176:191]
    s_waitcnt lgkmcnt(4)
    v_mfma_f32_32x32x16_bf16 v[64:79], a[240:243], v[16:19], v[64:79]
    ds_read_b64_tr_b16 v[28:29], v12 offset:8192
    ds_read_b64_tr_b16 v[30:31], v12 offset:9216
    s_add_u32 s52, s49, 2
    s_and_b32 s52, s52, 7
    s_lshl_b32 s52, s52, 19
    s_add_u32 s52, s52, 128
    s_add_u32 m0, s47, 65536
    s_nop 0
    buffer_load_dwordx4 v4, s[8:11], s52 offen lds
    v_add_u32 v59, 65536, v14
    v_mfma_f32_32x32x16_bf16 v[80:95], a[244:247], v[16:19], v[80:95]
    v_add_u32 v60, 131072, v13
    s_waitcnt lgkmcnt(4)
    v_mfma_f32_32x32x16_bf16 v[96:111], a[240:243], v[20:23], v[96:111]
    v_add_u32 v8, 32768, v8
    ds_read_b128 a[248:251], v8 offset:0
    ds_read_b128 a[252:255], v8 offset:4096
    ds_read_b64_tr_b16 v[16:17], v9 offset:12288
    ds_read_b64_tr_b16 v[18:19], v9 offset:13312
    s_add_u32 s52, s52, 65536
    s_add_u32 m0, s47, 66560
    s_nop 0
    buffer_load_dwordx4 v4, s[8:11], s52 offen lds
    v_add_u32 v61, 131072, v14
    v_mfma_f32_32x32x16_bf16 v[112:127], a[244:247], v[20:23], v[112:127]
    s_waitcnt lgkmcnt(6)
    v_mfma_f32_32x32x16_bf16 v[128:143], a[240:243], v[24:27], v[128:143]
    ds_read_b64_tr_b16 v[20:21], v10 offset:12288
    ds_read_b64_tr_b16 v[22:23], v10 offset:13312
    s_add_u32 s52, s52, 65536
    s_add_u32 m0, s47, 67584
    s_nop 0
    buffer_load_dwordx4 v4, s[8:11], s52 offen lds
    v_mfma_f32_32x32x16_bf16 v[144:159], a[244:247], v[24:27], v[144:159]
    s_waitcnt lgkmcnt(6)
    v_mfma_f32_32x32x16_bf16 v[160:175], a[240:243], v[28:31], v[160:175]
    ds_read_b64_tr_b16 v[24:25], v11 offset:12288
    ds_read_b64_tr_b16 v[26:27], v11 offset:13312
    s_add_u32 s52, s52, 65536
    s_add_u32 m0, s47, 68608
    s_nop 0
    buffer_load_dwordx4 v4, s[8:11], s52 offen lds
    v_mfma_f32_32x32x16_bf16 v[176:191], a[244:247], v[28:31], v[176:191]
    s_waitcnt lgkmcnt(4)
    v_mfma_f32_32x32x16_bf16 v[64:79], a[248:251], v[16:19], v[64:79]
    ds_read_b64_tr_b16 v[28:29], v12 offset:12288
    ds_read_b64_tr_b16 v[30:31], v12 offset:13312
    v_mfma_f32_32x32x16_bf16 v[80:95], a[252:255], v[16:19], v[80:95]
    s_waitcnt lgkmcnt(4)
    v_mfma_f32_32x32x16_bf16 v[96:111], a[248:251], v[20:23], v[96:111]
    s_waitcnt vmcnt(23)
    s_barrier
    ds_read_b64_tr_b16 v[16:17], v56 offset:16384
    ds_read_b64_tr_b16 v[18:19], v56 offset:16896
    s_waitcnt vmcnt(16)
    buffer_store_dwordx4 v[44:47], v41, s[20:23], s54 offen sc0 sc1
    v_mfma_f32_32x32x16_bf16 v[112:127], a[252:255], v[20:23], v[112:127]
    v_dot2c_f32_bf16 v48, 0x3f803f80, v44
    s_waitcnt lgkmcnt(4)
    v_mfma_f32_32x32x16_bf16 v[128:143], a[248:251], v[24:27], v[128:143]
    ds_read_b64_tr_b16 v[20:21], v57 offset:16384
    ds_read_b64_tr_b16 v[22:23], v57 offset:16896
    v_dot2c_f32_bf16 v48, 0x3f803f80, v45
    v_mfma_f32_32x32x16_bf16 v[144:159], a[252:255], v[24:27], v[144:159]
    v_dot2c_f32_bf16 v48, 0x3f803f80, v46
    s_waitcnt lgkmcnt(4)
    v_mfma_f32_32x32x16_bf16 v[160:175], a[248:251], v[28:31], v[160:175]
    ds_read_b64_tr_b16 v[24:25], v56 offset:18432
    ds_read_b64_tr_b16 v[26:27], v56 offset:18944
    v_dot2c_f32_bf16 v48, 0x3f803f80, v47
    v_mfma_f32_32x32x16_bf16 v[176:191], a[252:255], v[28:31], v[176:191]
    s_nop 1
    v_add_f32_dpp v48, v48, v48 quad_perm:[1,0,3,2] row_mask:0xf bank_mask:0xf
    s_waitcnt lgkmcnt(4)
    v_mfma_f32_32x32x16_bf16 v[192:207], a[0:3], v[16:19], 0
    ds_read_b64_tr_b16 v[28:29], v57 offset:18432
    ds_read_b64_tr_b16 v[30:31], v57 offset:18944
    s_add_u32 s52, s49, 4
    s_and_b32 s52, s52, 7
    s_lshl_b32 s52, s52, 19
    s_add_u32 s52, s52, 128
    s_add_u32 m0, s47, 49152
    s_nop 0
    buffer_load_dwordx4 v4, s[8:11], s52 offen lds
    v_add_f32_dpp v48, v48, v48 quad_perm:[2,3,0,1] row_mask:0xf bank_mask:0xf
    v_mfma_f32_32x32x16_bf16 v[208:223], a[4:7], v[16:19], 0
    s_nop 0
    v_add_f32_dpp v48, v48, v48 row_half_mirror row_mask:0xf bank_mask:0xf
    s_waitcnt lgkmcnt(4)
    v_mfma_f32_32x32x16_bf16 v[224:239], a[0:3], v[20:23], 0
    ds_read_b64_tr_b16 v[16:17], v56 offset:20480
    ds_read_b64_tr_b16 v[18:19], v56 offset:20992
    v_mul_f32 v48, 0x3ae38e39, v48
    v_mfma_f32_32x32x16_bf16 v[240:255], a[4:7], v[20:23], 0
    s_add_u32 s52, s52, 65536
    s_add_u32 m0, s47, 50176
    s_nop 0
    buffer_load_dwordx4 v4, s[8:11], s52 offen lds
    v_cvt_pk_bf16_f32 v49, v48, v48
    s_waitcnt lgkmcnt(4)
    v_mfma_f32_32x32x16_bf16 v[192:207], a[8:11], v[24:27], v[192:207]
    ds_read_b64_tr_b16 v[20:21], v57 offset:20480
    ds_read_b64_tr_b16 v[22:23], v57 offset:20992
    v_and_b32 v49, 0xffff0000, v49
    v_mfma_f32_32x32x16_bf16 v[208:223], a[12:15], v[24:27], v[208:223]
    v_sub_f32 v49, v48, v49
    s_waitcnt lgkmcnt(4)
    v_mfma_f32_32x32x16_bf16 v[224:239], a[8:11], v[28:31], v[224:239]
    ds_read_b64_tr_b16 v[24:25], v56 offset:22528
    ds_read_b64_tr_b16 v[26:27], v56 offset:23040
    s_add_u32 s52, s52, 65536
    s_add_u32 m0, s47, 51200
    s_nop 0
    buffer_load_dwordx4 v4, s[8:11], s52 offen lds
    v_cvt_pk_bf16_f32 v49, v48, v49
    v_cvt_pk_bf16_f32 v64, v64, v65
    s_and_b32 s51, s34, 0x7f000000
    v_lshlrev_b32 v38, 20, v0
    v_mfma_f32_32x32x16_bf16 v[240:255], a[12:15], v[28:31], v[240:255]
    buffer_store_dword v49, v42, s[20:23], s58 offen offset:4 sc0 sc1
    s_lshl_b32 s35, s26, 4
    s_add_u32 s35, s35, s51
    v_writelane_b32 v38, s35, 0
    s_waitcnt lgkmcnt(4)
    v_mfma_f32_32x32x16_bf16 v[192:207], a[16:19], v[16:19], v[192:207]
    ds_read_b64_tr_b16 v[28:29], v57 offset:22528
    ds_read_b64_tr_b16 v[30:31], v57 offset:23040
    v_cvt_pk_bf16_f32 v65, v66, v67
    s_xor_b32 s35, s35, 0xf0
    v_writelane_b32 v38, s35, 1
    v_mfma_f32_32x32x16_bf16 v[208:223], a[20:23], v[16:19], v[208:223]
    s_add_u32 s52, s52, 65536
    s_add_u32 m0, s47, 52224
    s_nop 0
    buffer_load_dwordx4 v4, s[8:11], s52 offen lds
    s_lshl_b32 s35, s25, 3
    s_and_b32 s35, s35, 0xf0
    s_add_u32 s35, s35, s51
    v_writelane_b32 v38, s35, 2
    s_waitcnt lgkmcnt(4)
    v_mfma_f32_32x32x16_bf16 v[224:239], a[16:19], v[20:23], v[224:239]
    ds_read_b64_tr_b16 v[16:17], v56 offset:24576
    ds_read_b64_tr_b16 v[18:19], v56 offset:25088
    v_cvt_pk_bf16_f32 v66, v68, v69
    buffer_load_dwordx4 v[32:35], v38, s[92:95], 0 offen sc0 sc1
    v_mfma_f32_32x32x16_bf16 v[240:255], a[20:23], v[20:23], v[240:255]
    s_waitcnt lgkmcnt(4)
    v_mfma_f32_32x32x16_bf16 v[192:207], a[24:27], v[24:27], v[192:207]
    ds_read_b64_tr_b16 v[20:21], v57 offset:24576
    ds_read_b64_tr_b16 v[22:23], v57 offset:25088
    s_add_u32 s52, s49, 6
    s_and_b32 s52, s52, 7
    s_lshl_b32 s52, s52, 19
    s_add_u32 s52, s52, 128
    s_add_u32 m0, s47, 114688
    s_nop 0
    buffer_load_dwordx4 v4, s[8:11], s52 offen lds
    v_cvt_pk_bf16_f32 v67, v70, v71
    v_mfma_f32_32x32x16_bf16 v[208:223], a[28:31], v[24:27], v[208:223]
    s_waitcnt lgkmcnt(4)
    v_mfma_f32_32x32x16_bf16 v[224:239], a[24:27], v[28:31], v[224:239]
    ds_read_b64_tr_b16 v[24:25], v56 offset:26624
    ds_read_b64_tr_b16 v[26:27], v56 offset:27136
    s_add_u32 s101, s100, 0
    buffer_store_dwordx4 v[64:67], v15, s[96:99], s101 offen sc0 sc1
    v_mfma_f32_32x32x16_bf16 v[240:255], a[28:31], v[28:31], v[240:255]
    s_add_u32 s52, s52, 65536
    s_add_u32 m0, s47, 115712
    s_nop 0
    buffer_load_dwordx4 v4, s[8:11], s52 offen lds
    s_waitcnt lgkmcnt(4)
    v_mfma_f32_32x32x16_bf16 v[192:207], a[32:35], v[16:19], v[192:207]
    ds_read_b64_tr_b16 v[28:29], v57 offset:26624
    ds_read_b64_tr_b16 v[30:31], v57 offset:27136
    v_mfma_f32_32x32x16_bf16 v[208:223], a[36:39], v[16:19], v[208:223]
    v_cvt_pk_bf16_f32 v68, v72, v73
    s_waitcnt lgkmcnt(4)
    v_mfma_f32_32x32x16_bf16 v[224:239], a[32:35], v[20:23], v[224:239]
    ds_read_b64_tr_b16 v[16:17], v56 offset:28672
    ds_read_b64_tr_b16 v[18:19], v56 offset:29184
    s_add_u32 s52, s52, 65536
    s_add_u32 m0, s47, 116736
    s_nop 0
    buffer_load_dwordx4 v4, s[8:11], s52 offen lds
    v_mfma_f32_32x32x16_bf16 v[240:255], a[36:39], v[20:23], v[240:255]
    v_cvt_pk_bf16_f32 v69, v74, v75
    s_waitcnt lgkmcnt(4)
    v_mfma_f32_32x32x16_bf16 v[192:207], a[40:43], v[24:27], v[192:207]
    ds_read_b64_tr_b16 v[20:21], v57 offset:28672
    ds_read_b64_tr_b16 v[22:23], v57 offset:29184
    v_mfma_f32_32x32x16_bf16 v[208:223], a[44:47], v[24:27], v[208:223]
    s_add_u32 s52, s52, 65536
    s_add_u32 m0, s47, 117760
    s_nop 0
    buffer_load_dwordx4 v4, s[8:11], s52 offen lds
    v_cvt_pk_bf16_f32 v70, v76, v77
    s_waitcnt lgkmcnt(4)
    v_mfma_f32_32x32x16_bf16 v[224:239], a[40:43], v[28:31], v[224:239]
    ds_read_b64_tr_b16 v[24:25], v56 offset:30720
    ds_read_b64_tr_b16 v[26:27], v56 offset:31232
    v_mfma_f32_32x32x16_bf16 v[240:255], a[44:47], v[28:31], v[240:255]
    v_cvt_pk_bf16_f32 v71, v78, v79
    s_waitcnt lgkmcnt(4)
    v_mfma_f32_32x32x16_bf16 v[192:207], a[48:51], v[16:19], v[192:207]
    ds_read_b64_tr_b16 v[28:29], v57 offset:30720
    ds_read_b64_tr_b16 v[30:31], v57 offset:31232
    v_mfma_f32_32x32x16_bf16 v[208:223], a[52:55], v[16:19], v[208:223]
    s_add_u32 s101, s100, 512
    buffer_store_dwordx4 v[68:71], v15, s[96:99], s101 offen sc0 sc1
    s_waitcnt lgkmcnt(4)
    v_mfma_f32_32x32x16_bf16 v[224:239], a[48:51], v[20:23], v[224:239]
    s_barrier
    ds_read_b64_tr_b16 v[16:17], v60 offset:0
    ds_read_b64_tr_b16 v[18:19], v60 offset:512
    v_mfma_f32_32x32x16_bf16 v[240:255], a[52:55], v[20:23], v[240:255]
    s_waitcnt lgkmcnt(4)
    v_mfma_f32_32x32x16_bf16 v[192:207], a[56:59], v[24:27], v[192:207]
    ds_read_b64_tr_b16 v[20:21], v61 offset:0
    ds_read_b64_tr_b16 v[22:23], v61 offset:512
    v_cvt_pk_bf16_f32 v80, v80, v81
    v_mfma_f32_32x32x16_bf16 v[208:223], a[60:63], v[24:27], v[208:223]
    s_waitcnt lgkmcnt(4)
    v_mfma_f32_32x32x16_bf16 v[224:239], a[56:59], v[28:31], v[224:239]
    ds_read_b64_tr_b16 v[24:25], v60 offset:2048
    ds_read_b64_tr_b16 v[26:27], v60 offset:2560
    v_cvt_pk_bf16_f32 v81, v82, v83
    v_mfma_f32_32x32x16_bf16 v[240:255], a[60:63], v[28:31], v[240:255]
    s_waitcnt lgkmcnt(4)
    v_mfma_f32_32x32x16_bf16 v[192:207], a[64:67], v[16:19], v[192:207]
    ds_read_b64_tr_b16 v[28:29], v61 offset:2048
    ds_read_b64_tr_b16 v[30:31], v61 offset:2560
    v_cvt_pk_bf16_f32 v82, v84, v85
    v_mfma_f32_32x32x16_bf16 v[208:223], a[68:71], v[16:19], v[208:223]
    s_waitcnt lgkmcnt(4)
    v_mfma_f32_32x32x16_bf16 v[224:239], a[64:67], v[20:23], v[224:239]
    ds_read_b64_tr_b16 v[16:17], v60 offset:4096
    ds_read_b64_tr_b16 v[18:19], v60 offset:4608
    v_cvt_pk_bf16_f32 v83, v86, v87
    s_mov_b32 s58, 0
    s_waitcnt vmcnt(6)
    v_mfma_f32_32x32x16_bf16 v[240:255], a[68:71], v[20:23], v[240:255]
    v_and_b32 v32, v32, v33
    s_waitcnt lgkmcnt(4)
    v_mfma_f32_32x32x16_bf16 v[192:207], a[72:75], v[24:27], v[192:207]
    ds_read_b64_tr_b16 v[20:21], v61 offset:4096
    ds_read_b64_tr_b16 v[22:23], v61 offset:4608
    s_add_u32 s101, s100, 8192
    buffer_store_dwordx4 v[80:83], v15, s[96:99], s101 offen sc0 sc1
    s_load_dwordx2 s[54:55], s[0:1], 40
    s_load_dwordx4 s[60:63], s[0:1], 56
    v_and_b32 v32, v32, v34
    v_mfma_f32_32x32x16_bf16 v[208:223], a[76:79], v[24:27], v[208:223]
    v_and_b32 v32, v32, v35
    s_waitcnt lgkmcnt(4)
    v_mfma_f32_32x32x16_bf16 v[224:239], a[72:75], v[28:31], v[224:239]
    ds_read_b64_tr_b16 v[24:25], v60 offset:6144
    ds_read_b64_tr_b16 v[26:27], v60 offset:6656
    v_lshlrev_b32 v1, 4, v0
    v_and_b32 v32, 0x01010101, v32
    v_mfma_f32_32x32x16_bf16 v[240:255], a[76:79], v[28:31], v[240:255]
    v_cvt_pk_bf16_f32 v84, v88, v89
    v_cmp_eq_u32 vcc, 0x01010101, v32
    s_cmp_eq_u32 s24, 0
    s_cselect_b32 s51, vcc_lo, -1
    s_and_b32 s51, s51, 7
    s_cmp_eq_u32 s51, 7
    s_cbranch_scc0 KM_SPX1
KM_RTX1:
    s_waitcnt lgkmcnt(4)
    v_mfma_f32_32x32x16_bf16 v[192:207], a[80:83], v[16:19], v[192:207]
    ds_read_b64_tr_b16 v[28:29], v61 offset:6144
    ds_read_b64_tr_b16 v[30:31], v61 offset:6656
    v_lshrrev_b32 v48, 4, v0
    v_lshl_or_b32 v49, v48, 2, s44
    v_and_b32 v50, 15, v0
    v_xor_b32 v49, v49, v50
    v_mfma_f32_32x32x16_bf16 v[208:223], a[84:87], v[16:19], v[208:223]
    v_cvt_pk_bf16_f32 v85, v90, v91
    s_waitcnt lgkmcnt(4)
    v_mfma_f32_32x32x16_bf16 v[224:239], a[80:83], v[20:23], v[224:239]
    ds_read_b64_tr_b16 v[16:17], v60 offset:8192
    ds_read_b64_tr_b16 v[18:19], v60 offset:8704
    v_mfma_f32_32x32x16_bf16 v[240:255], a[84:87], v[20:23], v[240:255]
    v_cvt_pk_bf16_f32 v86, v92, v93
    s_lshr_b32 s45, s24, 1
    s_lshl_b32 s45, s45, 2
    s_add_u32 s45, s45, s44
    s_waitcnt lgkmcnt(4)
    v_mfma_f32_32x32x16_bf16 v[192:207], a[88:91], v[24:27], v[192:207]
    ds_read_b64_tr_b16 v[20:21], v61 offset:8192
    ds_read_b64_tr_b16 v[22:23], v61 offset:8704
    v_mfma_f32_32x32x16_bf16 v[208:223], a[92:95], v[24:27], v[208:223]
    v_cvt_pk_bf16_f32 v87, v94, v95
    s_lshl_b32 s45, s45, 16
    s_lshl_b32 s46, s25, 8
    s_add_u32 s45, s45, s46
    s_waitcnt lgkmcnt(4)
    v_mfma_f32_32x32x16_bf16 v[224:239], a[88:91], v[28:31], v[224:239]
    ds_read_b64_tr_b16 v[24:25], v60 offset:10240
    ds_read_b64_tr_b16 v[26:27], v60 offset:10752
    v_mfma_f32_32x32x16_bf16 v[240:255], a[92:95], v[28:31], v[240:255]
    s_add_u32 s101, s100, 8704
    buffer_store_dwordx4 v[84:87], v15, s[96:99], s101 offen sc0 sc1
    v_lshlrev_b32 v48, 13, v48
    v_lshl_add_u32 v48, v49, 4, v48
    v_add_u32 v11, s45, v48
    s_waitcnt lgkmcnt(4)
    v_mfma_f32_32x32x16_bf16 v[192:207], a[96:99], v[16:19], v[192:207]
    ds_read_b64_tr_b16 v[28:29], v61 offset:10240
    ds_read_b64_tr_b16 v[30:31], v61 offset:10752
    v_mfma_f32_32x32x16_bf16 v[208:223], a[100:103], v[16:19], v[208:223]
    v_add_u32 v12, 31744, v11
    s_waitcnt lgkmcnt(4)
    v_mfma_f32_32x32x16_bf16 v[224:239], a[96:99], v[20:23], v[224:239]
    ds_read_b64_tr_b16 v[16:17], v60 offset:12288
    ds_read_b64_tr_b16 v[18:19], v60 offset:12800
    v_cvt_pk_bf16_f32 v96, v96, v97
    v_mfma_f32_32x32x16_bf16 v[240:255], a[100:103], v[20:23], v[240:255]
    s_waitcnt lgkmcnt(4)
    v_mfma_f32_32x32x16_bf16 v[192:207], a[104:107], v[24:27], v[192:207]
    ds_read_b64_tr_b16 v[20:21], v61 offset:12288
    ds_read_b64_tr_b16 v[22:23], v61 offset:12800
    v_cvt_pk_bf16_f32 v97, v98, v99
    v_add_u32 v13, 129024, v11
    v_mfma_f32_32x32x16_bf16 v[208:223], a[108:111], v[24:27], v[208:223]
    s_waitcnt lgkmcnt(4)
    v_mfma_f32_32x32x16_bf16 v[224:239], a[104:107], v[28:31], v[224:239]
    ds_read_b64_tr_b16 v[24:25], v60 offset:14336
    ds_read_b64_tr_b16 v[26:27], v60 offset:14848
    v_cvt_pk_bf16_f32 v98, v100, v101
    v_add_u32 v14, 160768, v11
    v_mfma_f32_32x32x16_bf16 v[240:255], a[108:111], v[28:31], v[240:255]
    s_waitcnt lgkmcnt(4)
    v_mfma_f32_32x32x16_bf16 v[192:207], a[112:115], v[16:19], v[192:207]
    ds_read_b64_tr_b16 v[28:29], v61 offset:14336
    ds_read_b64_tr_b16 v[30:31], v61 offset:14848
    v_cvt_pk_bf16_f32 v99, v102, v103
    v_mov_b32 v7, v1
    v_mfma_f32_32x32x16_bf16 v[208:223], a[116:119], v[16:19], v[208:223]
    s_waitcnt lgkmcnt(4)
    v_mfma_f32_32x32x16_bf16 v[224:239], a[112:115], v[20:23], v[224:239]
    s_barrier
    ds_read_b64_tr_b16 v[16:17], v60 offset:16384
    ds_read_b64_tr_b16 v[18:19], v60 offset:16896
    s_add_u32 s101, s100, 2048
    buffer_store_dwordx4 v[96:99], v15, s[96:99], s101 offen sc0 sc1
    v_mfma_f32_32x32x16_bf16 v[240:255], a[116:119], v[20:23], v[240:255]
    v_add_u32 v8, 18432, v1
    s_waitcnt lgkmcnt(4)
    v_mfma_f32_32x32x16_bf16 v[192:207], a[120:123], v[24:27], v[192:207]
    ds_read_b64_tr_b16 v[20:21], v61 offset:16384
    ds_read_b64_tr_b16 v[22:23], v61 offset:16896
    v_mfma_f32_32x32x16_bf16 v[208:223], a[124:127], v[24:27], v[208:223]
    v_cvt_pk_bf16_f32 v100, v104, v105
    v_add_u32 v9, 36864, v1
    s_waitcnt lgkmcnt(4)
    v_mfma_f32_32x32x16_bf16 v[224:239], a[120:123], v[28:31], v[224:239]
    ds_read_b64_tr_b16 v[24:25], v60 offset:18432
    ds_read_b64_tr_b16 v[26:27], v60 offset:18944
    v_mfma_f32_32x32x16_bf16 v[240:255], a[124:127], v[28:31], v[240:255]
    v_cvt_pk_bf16_f32 v101, v106, v107
    v_add_u32 v10, 55296, v1
    s_waitcnt lgkmcnt(4)
    v_mfma_f32_32x32x16_bf16 v[192:207], a[128:131], v[16:19], v[192:207]
    ds_read_b64_tr_b16 v[28:29], v61 offset:18432
    ds_read_b64_tr_b16 v[30:31], v61 offset:18944
    v_mfma_f32_32x32x16_bf16 v[208:223], a[132:135], v[16:19], v[208:223]
    v_cvt_pk_bf16_f32 v102, v108, v109
    s_lshl_b32 s47, s24, 12
    s_waitcnt lgkmcnt(4)
    v_mfma_f32_32x32x16_bf16 v[224:239], a[128:131], v[20:23], v[224:239]
    ds_read_b64_tr_b16 v[16:17], v60 offset:20480
    ds_read_b64_tr_b16 v[18:19], v60 offset:20992
    v_mfma_f32_32x32x16_bf16 v[240:255], a[132:135], v[20:23], v[240:255]
    v_cvt_pk_bf16_f32 v103, v110, v111
    s_waitcnt lgkmcnt(4)
    v_mfma_f32_32x32x16_bf16 v[192:207], a[136:139], v[24:27], v[192:207]
    ds_read_b64_tr_b16 v[20:21], v61 offset:20480
    ds_read_b64_tr_b16 v[22:23], v61 offset:20992
    s_add_u32 s8, s36, 0x2000000
    s_addc_u32 s9, s37, 0
    s_mov_b32 s10, 0x240000
    s_mov_b32 s11, 0x00020000
    v_mfma_f32_32x32x16_bf16 v[208:223], a[140:143], v[24:27], v[208:223]
    s_add_u32 s101, s100, 2560
    buffer_store_dwordx4 v[100:103], v15, s[96:99], s101 offen sc0 sc1
    s_waitcnt lgkmcnt(4)
    v_mfma_f32_32x32x16_bf16 v[224:239], a[136:139], v[28:31], v[224:239]
    ds_read_b64_tr_b16 v[24:25], v60 offset:22528
    ds_read_b64_tr_b16 v[26:27], v60 offset:23040
    s_mov_b32 s49, 0
    v_mfma_f32_32x32x16_bf16 v[240:255], a[140:143], v[28:31], v[240:255]
    s_waitcnt lgkmcnt(4)
    v_mfma_f32_32x32x16_bf16 v[192:207], a[144:147], v[16:19], v[192:207]
    ds_read_b64_tr_b16 v[28:29], v61 offset:22528
    ds_read_b64_tr_b16 v[30:31], v61 offset:23040
    v_cvt_pk_bf16_f32 v112, v112, v113
    s_add_u32 m0, s47, 16384
    v_mfma_f32_32x32x16_bf16 v[208:223], a[148:151], v[16:19], v[208:223]
    s_waitcnt lgkmcnt(4)
    v_mfma_f32_32x32x16_bf16 v[224:239], a[144:147], v[20:23], v[224:239]
    ds_read_b64_tr_b16 v[16:17], v60 offset:24576
    ds_read_b64_tr_b16 v[18:19], v60 offset:25088
    v_cvt_pk_bf16_f32 v113, v114, v115
    buffer_load_dwordx4 v11, s[4:7], s49 offen offset:0 lds
    v_mfma_f32_32x32x16_bf16 v[240:255], a[148:151], v[20:23], v[240:255]
    s_waitcnt lgkmcnt(4)
    v_mfma_f32_32x32x16_bf16 v[192:207], a[152:155], v[24:27], v[192:207]
    ds_read_b64_tr_b16 v[20:21], v61 offset:24576
    ds_read_b64_tr_b16 v[22:23], v61 offset:25088
    v_cvt_pk_bf16_f32 v114, v116, v117
    v_mfma_f32_32x32x16_bf16 v[208:223], a[156:159], v[24:27], v[208:223]
    buffer_load_dwordx4 v12, s[4:7], s49 offen offset:1024 lds
    s_waitcnt lgkmcnt(4)
    v_mfma_f32_32x32x16_bf16 v[224:239], a[152:155], v[28:31], v[224:239]
    ds_read_b64_tr_b16 v[24:25], v60 offset:26624
    ds_read_b64_tr_b16 v[26:27], v60 offset:27136
    v_cvt_pk_bf16_f32 v115, v118, v119
    v_mfma_f32_32x32x16_bf16 v[240:255], a[156:159], v[28:31], v[240:255]
    buffer_load_dwordx4 v13, s[4:7], s49 offen offset:2048 lds
    s_waitcnt lgkmcnt(4)
    v_mfma_f32_32x32x16_bf16 v[192:207], a[160:163], v[16:19], v[192:207]
    ds_read_b64_tr_b16 v[28:29], v61 offset:26624
    ds_read_b64_tr_b16 v[30:31], v61 offset:27136
    s_add_u32 s101, s100, 10240
    buffer_store_dwordx4 v[112:115], v15, s[96:99], s101 offen sc0 sc1
    v_mfma_f32_32x32x16_bf16 v[208:223], a[164:167], v[16:19], v[208:223]
    buffer_load_dwordx4 v14, s[4:7], s49 offen offset:3072 lds
    s_waitcnt lgkmcnt(4)
    v_mfma_f32_32x32x16_bf16 v[224:239], a[160:163], v[20:23], v[224:239]
    ds_read_b64_tr_b16 v[16:17], v60 offset:28672
    ds_read_b64_tr_b16 v[18:19], v60 offset:29184
    v_mfma_f32_32x32x16_bf16 v[240:255], a[164:167], v[20:23], v[240:255]
    v_cvt_pk_bf16_f32 v116, v120, v121
    s_waitcnt lgkmcnt(4)
    v_mfma_f32_32x32x16_bf16 v[192:207], a[168:171], v[24:27], v[192:207]
    ds_read_b64_tr_b16 v[20:21], v61 offset:28672
    ds_read_b64_tr_b16 v[22:23], v61 offset:29184
    s_lshl_b32 s39, s25, 20
    s_add_u32 s12, s36, s39
    s_addc_u32 s13, s37, 0
    v_mfma_f32_32x32x16_bf16 v[208:223], a[172:175], v[24:27], v[208:223]
    v_cvt_pk_bf16_f32 v117, v122, v123
    s_add_u32 s14, s38, 1
    s_lshl_b32 s14, s14, 16
    s_mov_b32 s15, 0x00020000
    s_waitcnt lgkmcnt(4)
    v_mfma_f32_32x32x16_bf16 v[224:239], a[168:171], v[28:31], v[224:239]
    ds_read_b64_tr_b16 v[24:25], v60 offset:30720
    ds_read_b64_tr_b16 v[26:27], v60 offset:31232
    v_mfma_f32_32x32x16_bf16 v[240:255], a[172:175], v[28:31], v[240:255]
    v_cvt_pk_bf16_f32 v118, v124, v125
    s_add_u32 s16, s36, 0x2400000
    s_addc_u32 s17, s37, 0
    s_mov_b32 s18, 0x1000000
    s_mov_b32 s19, 0x00020000
    s_waitcnt lgkmcnt(4)
    v_mfma_f32_32x32x16_bf16 v[192:207], a[176:179], v[16:19], v[192:207]
    ds_read_b64_tr_b16 v[28:29], v61 offset:30720
    ds_read_b64_tr_b16 v[30:31], v61 offset:31232
    v_mfma_f32_32x32x16_bf16 v[208:223], a[180:183], v[16:19], v[208:223]
    v_cvt_pk_bf16_f32 v119, v126, v127
    v_add_u32 v2, 4096, v1
    s_waitcnt lgkmcnt(4)
    v_mfma_f32_32x32x16_bf16 v[224:239], a[176:179], v[20:23], v[224:239]
    s_barrier
    ds_read_b64_tr_b16 v[16:17], v56 offset:32768
    ds_read_b64_tr_b16 v[18:19], v56 offset:33280
    v_mfma_f32_32x32x16_bf16 v[240:255], a[180:183], v[20:23], v[240:255]
    s_add_u32 s101, s100, 10752
    buffer_store_dwordx4 v[116:119], v15, s[96:99], s101 offen sc0 sc1
    s_lshl_b32 s39, s26, 1
    s_add_u32 s39, s39, s44
    s_sub_u32 s28, 16, s39
    s_waitcnt lgkmcnt(4)
    v_mfma_f32_32x32x16_bf16 v[192:207], a[184:187], v[24:27], v[192:207]
    ds_read_b64_tr_b16 v[20:21], v57 offset:32768
    ds_read_b64_tr_b16 v[22:23], v57 offset:33280
    v_mfma_f32_32x32x16_bf16 v[208:223], a[188:191], v[24:27], v[208:223]
    s_mov_b32 s40, 491520
    s_mov_b32 s43, 65536
    s_mov_b32 s42, 16384
    s_mov_b32 s41, 4294926336
    s_waitcnt lgkmcnt(4)
    v_mfma_f32_32x32x16_bf16 v[224:239], a[184:187], v[28:31], v[224:239]
    ds_read_b64_tr_b16 v[24:25], v56 offset:34816
    ds_read_b64_tr_b16 v[26:27], v56 offset:35328
    v_cvt_pk_bf16_f32 v144, v144, v145
    v_mfma_f32_32x32x16_bf16 v[240:255], a[188:191], v[28:31], v[240:255]
    v_cvt_pk_bf16_f32 v145, v146, v147
    s_cmp_eq_u32 s24, 1
    s_cselect_b32 s40, 540672, s40
    s_cselect_b32 s43, 98304, s43
    s_cselect_b32 s42, 0, s42
    s_waitcnt lgkmcnt(4)
    v_mfma_f32_32x32x16_bf16 v[192:207], a[192:195], v[16:19], v[192:207]
    ds_read_b64_tr_b16 v[28:29], v57 offset:34816
    ds_read_b64_tr_b16 v[30:31], v57 offset:35328
    v_mfma_f32_32x32x16_bf16 v[208:223], a[196:199], v[16:19], v[208:223]
    v_cvt_pk_bf16_f32 v146, v148, v149
    s_cmp_eq_u32 s24, 2
    s_cselect_b32 s40, 540672, s40
    s_cselect_b32 s43, 32768, s43
    s_cselect_b32 s42, 0, s42
    s_waitcnt lgkmcnt(4)
    v_mfma_f32_32x32x16_bf16 v[224:239], a[192:195], v[20:23], v[224:239]
    ds_read_b64_tr_b16 v[16:17], v56 offset:36864
    ds_read_b64_tr_b16 v[18:19], v56 offset:37376
    v_mfma_f32_32x32x16_bf16 v[240:255], a[196:199], v[20:23], v[240:255]
    v_cvt_pk_bf16_f32 v147, v150, v151
    s_cmp_eq_u32 s24, 3
    s_cselect_b32 s40, 557056, s40
    s_cselect_b32 s43, 0, s43
    s_waitcnt lgkmcnt(4)
    v_mfma_f32_32x32x16_bf16 v[192:207], a[200:203], v[24:27], v[192:207]
    ds_read_b64_tr_b16 v[20:21], v57 offset:36864
    ds_read_b64_tr_b16 v[22:23], v57 offset:37376
    s_cmp_ge_u32 s24, 2
    s_cselect_b32 s41, 24576, s41
    v_mfma_f32_32x32x16_bf16 v[208:223], a[204:207], v[24:27], v[208:223]
    s_add_u32 s101, s100, 12288
    buffer_store_dwordx4 v[144:147], v15, s[96:99], s101 offen sc0 sc1
    s_waitcnt lgkmcnt(4)
    v_mfma_f32_32x32x16_bf16 v[224:239], a[200:203], v[28:31], v[224:239]
    ds_read_b64_tr_b16 v[24:25], v56 offset:38912
    ds_read_b64_tr_b16 v[26:27], v56 offset:39424
    v_bfe_u32 v48, v0, 4, 1
    v_bfe_u32 v49, v0, 2, 2
    v_lshrrev_b32 v50, 5, v0
    v_mfma_f32_32x32x16_bf16 v[240:255], a[204:207], v[28:31], v[240:255]
    v_cvt_pk_bf16_f32 v148, v152, v153
    s_waitcnt lgkmcnt(4)
    v_mfma_f32_32x32x16_bf16 v[192:207], a[208:211], v[16:19], v[192:207]
    ds_read_b64_tr_b16 v[28:29], v57 offset:38912
    ds_read_b64_tr_b16 v[30:31], v57 offset:39424
    v_lshlrev_b32 v51, 12, v48
    v_lshl_add_u32 v51, v50, 11, v51
    v_lshl_add_u32 v51, v49, 8, v51
    v_mfma_f32_32x32x16_bf16 v[208:223], a[212:215], v[16:19], v[208:223]
    v_cvt_pk_bf16_f32 v149, v154, v155
    s_waitcnt lgkmcnt(4)
    v_mfma_f32_32x32x16_bf16 v[224:239], a[208:211], v[20:23], v[224:239]
    ds_read_b64_tr_b16 v[16:17], v56 offset:40960
    ds_read_b64_tr_b16 v[18:19], v56 offset:41472
    v_lshl_add_u32 v51, v49, 6, v51
    v_lshl_add_u32 v51, v48, 4, v51
    v_mfma_f32_32x32x16_bf16 v[240:255], a[212:215], v[20:23], v[240:255]
    v_cvt_pk_bf16_f32 v150, v156, v157
    s_waitcnt lgkmcnt(4)
    v_mfma_f32_32x32x16_bf16 v[192:207], a[216:219], v[24:27], v[192:207]
    ds_read_b64_tr_b16 v[20:21], v57 offset:40960
    ds_read_b64_tr_b16 v[22:23], v57 offset:41472
    v_bfe_u32 v52, v0, 1, 1
    v_lshl_add_u32 v51, v52, 5, v51
    v_and_b32 v52, 1, v0
    v_lshl_add_u32 v51, v52, 3, v51
    v_mfma_f32_32x32x16_bf16 v[208:223], a[220:223], v[24:27], v[208:223]
    v_cvt_pk_bf16_f32 v151, v158, v159
    s_waitcnt lgkmcnt(4)
    v_mfma_f32_32x32x16_bf16 v[224:239], a[216:219], v[28:31], v[224:239]
    ds_read_b64_tr_b16 v[24:25], v56 offset:43008
    ds_read_b64_tr_b16 v[26:27], v56 offset:43520
    v_and_b32 v52, 15, v0
    v_lshlrev_b32 v50, 4, v50
    v_lshl_add_u32 v50, v48, 2, v50
    v_sub_u32 v5, v52, v50
    v_mfma_f32_32x32x16_bf16 v[240:255], a[220:223], v[28:31], v[240:255]
    s_add_u32 s101, s100, 12800
    buffer_store_dwordx4 v[148:151], v15, s[96:99], s101 offen sc0 sc1
    s_waitcnt lgkmcnt(4)
    v_mfma_f32_32x32x16_bf16 v[192:207], a[224:227], v[16:19], v[192:207]
    ds_read_b64_tr_b16 v[28:29], v57 offset:43008
    ds_read_b64_tr_b16 v[30:31], v57 offset:43520
    v_mov_b32 v6, 0xff800000
    v_mfma_f32_32x32x16_bf16 v[208:223], a[228:231], v[16:19], v[208:223]
    v_cvt_pk_bf16_f32 v176, v176, v177
    s_waitcnt lgkmcnt(4)
    v_mfma_f32_32x32x16_bf16 v[224:239], a[224:227], v[20:23], v[224:239]
    ds_read_b64_tr_b16 v[16:17], v56 offset:45056
    ds_read_b64_tr_b16 v[18:19], v56 offset:45568
    v_cvt_pk_bf16_f32 v177, v178, v179
    v_add_u32 v3, 0, v1
    v_add_u32 v4, 32768, v1
    v_mfma_f32_32x32x16_bf16 v[240:255], a[228:231], v[20:23], v[240:255]
    s_mov_b32 s52, 0x3e0293ee
    s_mov_b32 s53, 0x3e0293ee
    s_waitcnt lgkmcnt(4)
    v_mfma_f32_32x32x16_bf16 v[192:207], a[232:235], v[24:27], v[192:207]
    ds_read_b64_tr_b16 v[20:21], v57 offset:45056
    ds_read_b64_tr_b16 v[22:23], v57 offset:45568
    v_cvt_pk_bf16_f32 v178, v180, v181
    v_mfma_f32_32x32x16_bf16 v[208:223], a[236:239], v[24:27], v[208:223]
    s_add_u32 s56, s24, 1
    s_bfe_u32 s56, s56, 0x10001
    s_lshl_b32 s57, s56, 15
    s_waitcnt lgkmcnt(4)
    v_mfma_f32_32x32x16_bf16 v[224:239], a[232:235], v[28:31], v[224:239]
    ds_read_b64_tr_b16 v[24:25], v56 offset:47104
    ds_read_b64_tr_b16 v[26:27], v56 offset:47616
    v_cvt_pk_bf16_f32 v179, v182, v183
    v_mfma_f32_32x32x16_bf16 v[240:255], a[236:239], v[28:31], v[240:255]
    s_lshl_b32 s56, s56, 14
    s_add_u32 s56, s56, 131072
    s_waitcnt lgkmcnt(4)
    v_mfma_f32_32x32x16_bf16 v[192:207], a[240:243], v[16:19], v[192:207]
    ds_read_b64_tr_b16 v[28:29], v57 offset:47104
    ds_read_b64_tr_b16 v[30:31], v57 offset:47616
    s_add_u32 s101, s100, 14336
    buffer_store_dwordx4 v[176:179], v15, s[96:99], s101 offen sc0 sc1
    v_mfma_f32_32x32x16_bf16 v[208:223], a[244:247], v[16:19], v[208:223]
    s_mul_i32 s59, s2, 22528
    s_waitcnt lgkmcnt(4)
    v_mfma_f32_32x32x16_bf16 v[224:239], a[240:243], v[20:23], v[224:239]
    s_barrier
    ds_read_b64_tr_b16 v[16:17], v58 offset:16384
    ds_read_b64_tr_b16 v[18:19], v58 offset:16896
    v_cvt_pk_bf16_f32 v180, v184, v185
    v_mfma_f32_32x32x16_bf16 v[240:255], a[244:247], v[20:23], v[240:255]
    s_waitcnt lgkmcnt(0)
    v_mfma_f32_32x32x16_bf16 v[192:207], a[248:251], v[24:27], v[192:207]
    ds_read_b64_tr_b16 v[20:21], v59 offset:16384
    ds_read_b64_tr_b16 v[22:23], v59 offset:16896
    v_cvt_pk_bf16_f32 v181, v186, v187
    v_mfma_f32_32x32x16_bf16 v[208:223], a[252:255], v[24:27], v[208:223]
    s_mov_b32 s22, 4718592
    s_mov_b32 s23, 0x00020000
    s_mov_b32 s20, s54
    s_mov_b32 s21, s55
    v_mfma_f32_32x32x16_bf16 v[224:239], a[248:251], v[28:31], v[224:239]
    ds_read_b64_tr_b16 v[24:25], v58 offset:18432
    ds_read_b64_tr_b16 v[26:27], v58 offset:18944
    v_cvt_pk_bf16_f32 v182, v188, v189
    v_mfma_f32_32x32x16_bf16 v[240:255], a[252:255], v[28:31], v[240:255]
    s_cmp_eq_u32 s24, 0
    s_cselect_b32 s20, s60, s20
    s_cselect_b32 s21, s61, s21
    s_cselect_b32 s22, 5308416, s22
    v_mfma_f32_32x32x16_bf16 v[64:79], a[0:3], v[16:19], 0
    ds_read_b64_tr_b16 v[28:29], v59 offset:18432
    ds_read_b64_tr_b16 v[30:31], v59 offset:18944
    v_cvt_pk_bf16_f32 v183, v190, v191
    v_mfma_f32_32x32x16_bf16 v[80:95], a[4:7], v[16:19], 0
    s_cmp_eq_u32 s24, 1
    s_cselect_b32 s20, s62, s20
    s_cselect_b32 s21, s63, s21
    s_cselect_b32 s22, 5308416, s22
    s_waitcnt lgkmcnt(4)
    v_mfma_f32_32x32x16_bf16 v[96:111], a[0:3], v[20:23], 0
    ds_read_b64_tr_b16 v[16:17], v58 offset:20480
    ds_read_b64_tr_b16 v[18:19], v58 offset:20992
    s_add_u32 s101, s100, 14848
    buffer_store_dwordx4 v[180:183], v15, s[96:99], s101 offen sc0 sc1
    s_lshl_b32 s51, s25, 3
    s_add_u32 s51, s51, s26
    v_mfma_f32_32x32x16_bf16 v[112:127], a[4:7], v[20:23], 0
    s_waitcnt lgkmcnt(4)
    v_mfma_f32_32x32x16_bf16 v[64:79], a[8:11], v[24:27], v[64:79]
    ds_read_b64_tr_b16 v[20:21], v59 offset:20480
    ds_read_b64_tr_b16 v[22:23], v59 offset:20992
    v_cvt_pk_bf16_f32 v192, v192, v193
    v_cvt_pk_bf16_f32 v193, v194, v195
    s_lshl_b32 s70, s51, 1
    s_add_u32 s70, s70, s44
    s_mul_i32 s71, s70, 9216
    v_mfma_f32_32x32x16_bf16 v[80:95], a[12:15], v[24:27], v[80:95]
    v_cvt_pk_bf16_f32 v194, v196, v197
    s_waitcnt lgkmcnt(4)
    v_mfma_f32_32x32x16_bf16 v[96:111], a[8:11], v[28:31], v[96:111]
    ds_read_b64_tr_b16 v[24:25], v58 offset:22528
    ds_read_b64_tr_b16 v[26:27], v58 offset:23040
    v_cvt_pk_bf16_f32 v195, v198, v199
    s_cmp_ge_u32 s24, 2
    s_cselect_b32 s59, s71, s59
    s_cselect_b32 s69, 64, 1408
    v_mfma_f32_32x32x16_bf16 v[112:127], a[12:15], v[28:31], v[112:127]
    s_add_u32 s101, s100, 1048576
    buffer_store_dwordx4 v[192:195], v15, s[96:99], s101 offen sc0 sc1
    s_waitcnt lgkmcnt(4)
    v_mfma_f32_32x32x16_bf16 v[64:79], a[16:19], v[16:19], v[64:79]
    ds_read_b64_tr_b16 v[28:29], v59 offset:22528
    ds_read_b64_tr_b16 v[30:31], v59 offset:23040
    v_cvt_pk_bf16_f32 v196, v200, v201
    s_and_b32 s70, s70, 15
    s_lshl_b32 s70, s70, 8
    s_lshr_b32 s71, s51, 5
    s_lshl_b32 s71, s71, 12
    v_add_u32 v144, 16384, v51
    v_mfma_f32_32x32x16_bf16 v[80:95], a[20:23], v[16:19], v[80:95]
    v_cvt_pk_bf16_f32 v197, v202, v203
    s_waitcnt lgkmcnt(4)
    v_mfma_f32_32x32x16_bf16 v[96:111], a[16:19], v[20:23], v[96:111]
    ds_read_b64_tr_b16 v[16:17], v58 offset:24576
    ds_read_b64_tr_b16 v[18:19], v58 offset:25088
    v_cvt_pk_bf16_f32 v198, v204, v205
    s_add_u32 s70, s70, s71
    s_and_b32 s71, s51, 24
    s_add_u32 s70, s70, s71
    v_mfma_f32_32x32x16_bf16 v[112:127], a[20:23], v[20:23], v[112:127]
    v_cvt_pk_bf16_f32 v199, v206, v207
    v_xor_b32 v145, 16, v144
    s_waitcnt lgkmcnt(4)
    v_mfma_f32_32x32x16_bf16 v[64:79], a[24:27], v[24:27], v[64:79]
    ds_read_b64_tr_b16 v[20:21], v59 offset:24576
    ds_read_b64_tr_b16 v[22:23], v59 offset:25088
    s_add_u32 s101, s100, 1049088
    buffer_store_dwordx4 v[196:199], v15, s[96:99], s101 offen sc0 sc1
    s_add_u32 s70, s70, 262144
    v_mfma_f32_32x32x16_bf16 v[80:95], a[28:31], v[24:27], v[80:95]
    v_cvt_pk_bf16_f32 v208, v208, v209
    v_cvt_pk_bf16_f32 v209, v210, v211
    s_waitcnt lgkmcnt(4)
    v_mfma_f32_32x32x16_bf16 v[96:111], a[24:27], v[28:31], v[96:111]
    ds_read_b64_tr_b16 v[24:25], v58 offset:26624
    ds_read_b64_tr_b16 v[26:27], v58 offset:27136
    v_cvt_pk_bf16_f32 v210, v212, v213
    s_add_u32 s64, s36, 0x4300000
    s_addc_u32 s65, s37, 0
    s_mov_b32 s66, 0x1500000
    s_mov_b32 s67, 0x00020000
    v_xor_b32 v146, 64, v144
    v_mfma_f32_32x32x16_bf16 v[112:127], a[28:31], v[28:31], v[112:127]
    v_cvt_pk_bf16_f32 v211, v214, v215
    s_waitcnt lgkmcnt(4)
    v_mfma_f32_32x32x16_bf16 v[64:79], a[32:35], v[16:19], v[64:79]
    ds_read_b64_tr_b16 v[28:29], v59 offset:26624
    ds_read_b64_tr_b16 v[30:31], v59 offset:27136
    s_add_u32 s101, s100, 1056768
    buffer_store_dwordx4 v[208:211], v15, s[96:99], s101 offen sc0 sc1
    v_mfma_f32_32x32x16_bf16 v[80:95], a[36:39], v[16:19], v[80:95]
    v_cvt_pk_bf16_f32 v212, v216, v217
    v_xor_b32 v147, 80, v144
    s_waitcnt lgkmcnt(4)
    v_mfma_f32_32x32x16_bf16 v[96:111], a[32:35], v[20:23], v[96:111]
    ds_read_b64_tr_b16 v[16:17], v58 offset:28672
    ds_read_b64_tr_b16 v[18:19], v58 offset:29184
    v_cvt_pk_bf16_f32 v213, v218, v219
    v_mfma_f32_32x32x16_bf16 v[112:127], a[36:39], v[20:23], v[112:127]
    v_cvt_pk_bf16_f32 v214, v220, v221
    s_waitcnt lgkmcnt(4)
    v_mfma_f32_32x32x16_bf16 v[64:79], a[40:43], v[24:27], v[64:79]
    ds_read_b64_tr_b16 v[20:21], v59 offset:28672
    ds_read_b64_tr_b16 v[22:23], v59 offset:29184
    v_cvt_pk_bf16_f32 v215, v222, v223
    v_xor_b32 v148, 128, v144
    v_mfma_f32_32x32x16_bf16 v[80:95], a[44:47], v[24:27], v[80:95]
    s_add_u32 s101, s100, 1057280
    buffer_store_dwordx4 v[212:215], v15, s[96:99], s101 offen sc0 sc1
    s_waitcnt lgkmcnt(4)
    v_mfma_f32_32x32x16_bf16 v[96:111], a[40:43], v[28:31], v[96:111]
    ds_read_b64_tr_b16 v[24:25], v58 offset:30720
    ds_read_b64_tr_b16 v[26:27], v58 offset:31232
    v_cvt_pk_bf16_f32 v128, v128, v129
    v_mfma_f32_32x32x16_bf16 v[112:127], a[44:47], v[28:31], v[112:127]
    v_xor_b32 v149, 144, v144
    s_waitcnt lgkmcnt(4)
    v_mfma_f32_32x32x16_bf16 v[64:79], a[48:51], v[16:19], v[64:79]
    ds_read_b64_tr_b16 v[28:29], v59 offset:30720
    ds_read_b64_tr_b16 v[30:31], v59 offset:31232
    v_cvt_pk_bf16_f32 v129, v130, v131
    s_add_u32 s50, s48, 0
    v_mfma_f32_32x32x16_bf16 v[80:95], a[52:55], v[16:19], v[80:95]
    buffer_load_dwordx4 v[192:195], v7, s[8:11], s50 offen offset:0
    s_waitcnt lgkmcnt(4)
    v_mfma_f32_32x32x16_bf16 v[96:111], a[48:51], v[20:23], v[96:111]
    s_barrier
    ds_read_b64_tr_b16 v[16:17], v58 offset:0
    ds_read_b64_tr_b16 v[18:19], v58 offset:512
    v_xor_b32 v150, 192, v144
    v_mfma_f32_32x32x16_bf16 v[112:127], a[52:55], v[20:23], v[112:127]
    v_cvt_pk_bf16_f32 v130, v132, v133
    buffer_load_dwordx4 v[196:199], v8, s[8:11], s50 offen offset:0
    s_waitcnt lgkmcnt(4)
    v_mfma_f32_32x32x16_bf16 v[64:79], a[56:59], v[24:27], v[64:79]
    ds_read_b64_tr_b16 v[20:21], v59 offset:0
    ds_read_b64_tr_b16 v[22:23], v59 offset:512
    v_mfma_f32_32x32x16_bf16 v[80:95], a[60:63], v[24:27], v[80:95]
    v_cvt_pk_bf16_f32 v131, v134, v135
    v_xor_b32 v151, 208, v144
    buffer_load_dwordx4 v[200:203], v9, s[8:11], s50 offen offset:0
    s_waitcnt lgkmcnt(4)
    v_mfma_f32_32x32x16_bf16 v[96:111], a[56:59], v[28:31], v[96:111]
    ds_read_b64_tr_b16 v[24:25], v58 offset:2048
    ds_read_b64_tr_b16 v[26:27], v58 offset:2560
    buffer_load_dwordx4 v[204:207], v10, s[8:11], s50 offen offset:0
    v_mfma_f32_32x32x16_bf16 v[112:127], a[60:63], v[28:31], v[112:127]
    s_waitcnt lgkmcnt(4)
    v_mfma_f32_32x32x16_bf16 v[64:79], a[64:67], v[16:19], v[64:79]
    ds_read_b64_tr_b16 v[28:29], v59 offset:2048
    ds_read_b64_tr_b16 v[30:31], v59 offset:2560
    s_add_u32 s101, s100, 4096
    buffer_store_dwordx4 v[128:131], v15, s[96:99], s101 offen sc0 sc1
    v_add_u32 v184, 65536, v144
    buffer_load_dwordx4 v[208:211], v7, s[8:11], s50 offen offset:1024
    v_mfma_f32_32x32x16_bf16 v[80:95], a[68:71], v[16:19], v[80:95]
    s_waitcnt lgkmcnt(4)
    v_mfma_f32_32x32x16_bf16 v[96:111], a[64:67], v[20:23], v[96:111]
    ds_read_b64_tr_b16 v[16:17], v58 offset:4096
    ds_read_b64_tr_b16 v[18:19], v58 offset:4608
    v_cvt_pk_bf16_f32 v132, v136, v137
    buffer_load_dwordx4 v[212:215], v8, s[8:11], s50 offen offset:1024
    v_mfma_f32_32x32x16_bf16 v[112:127], a[68:71], v[20:23], v[112:127]
    v_add_u32 v185, 65536, v145
    buffer_load_dwordx4 v[216:219], v9, s[8:11], s50 offen offset:1024
    s_waitcnt lgkmcnt(4)
    v_mfma_f32_32x32x16_bf16 v[64:79], a[72:75], v[24:27], v[64:79]
    ds_read_b64_tr_b16 v[20:21], v59 offset:4096
    ds_read_b64_tr_b16 v[22:23], v59 offset:4608
    v_mfma_f32_32x32x16_bf16 v[80:95], a[76:79], v[24:27], v[80:95]
    v_cvt_pk_bf16_f32 v133, v138, v139
    buffer_load_dwordx4 v[220:223], v10, s[8:11], s50 offen offset:1024
    s_waitcnt lgkmcnt(4)
    v_mfma_f32_32x32x16_bf16 v[96:111], a[72:75], v[28:31], v[96:111]
    ds_read_b64_tr_b16 v[24:25], v58 offset:6144
    ds_read_b64_tr_b16 v[26:27], v58 offset:6656
    v_add_u32 v186, 65536, v146
    v_mfma_f32_32x32x16_bf16 v[112:127], a[76:79], v[28:31], v[112:127]
    v_cvt_pk_bf16_f32 v134, v140, v141
    s_mov_b32 s49, 524288
    s_waitcnt lgkmcnt(4)
    v_mfma_f32_32x32x16_bf16 v[64:79], a[80:83], v[16:19], v[64:79]
    ds_read_b64_tr_b16 v[28:29], v59 offset:6144
    ds_read_b64_tr_b16 v[30:31], v59 offset:6656
    v_mfma_f32_32x32x16_bf16 v[80:95], a[84:87], v[16:19], v[80:95]
    v_add_u32 v187, 65536, v147
    s_add_u32 m0, s47, 32768
    s_waitcnt lgkmcnt(4)
    v_mfma_f32_32x32x16_bf16 v[96:111], a[80:83], v[20:23], v[96:111]
    ds_read_b64_tr_b16 v[16:17], v58 offset:8192
    ds_read_b64_tr_b16 v[18:19], v58 offset:8704
    v_cvt_pk_bf16_f32 v135, v142, v143
    buffer_load_dwordx4 v11, s[4:7], s49 offen offset:0 lds
    v_mfma_f32_32x32x16_bf16 v[112:127], a[84:87], v[20:23], v[112:127]
    s_waitcnt lgkmcnt(4)
    v_mfma_f32_32x32x16_bf16 v[64:79], a[88:91], v[24:27], v[64:79]
    ds_read_b64_tr_b16 v[20:21], v59 offset:8192
    ds_read_b64_tr_b16 v[22:23], v59 offset:8704
    s_add_u32 s101, s100, 4608
    buffer_store_dwordx4 v[132:135], v15, s[96:99], s101 offen sc0 sc1
    v_add_u32 v188, 65536, v148
    buffer_load_dwordx4 v12, s[4:7], s49 offen offset:1024 lds
    v_mfma_f32_32x32x16_bf16 v[80:95], a[92:95], v[24:27], v[80:95]
    s_waitcnt lgkmcnt(4)
    v_mfma_f32_32x32x16_bf16 v[96:111], a[88:91], v[28:31], v[96:111]
    ds_read_b64_tr_b16 v[24:25], v58 offset:10240
    ds_read_b64_tr_b16 v[26:27], v58 offset:10752
    buffer_load_dwordx4 v13, s[4:7], s49 offen offset:2048 lds
    v_mfma_f32_32x32x16_bf16 v[112:127], a[92:95], v[28:31], v[112:127]
    v_cvt_pk_bf16_f32 v160, v160, v161
    v_add_u32 v189, 65536, v149
    buffer_load_dwordx4 v14, s[4:7], s49 offen offset:3072 lds
    s_waitcnt lgkmcnt(4)
    v_mfma_f32_32x32x16_bf16 v[64:79], a[96:99], v[16:19], v[64:79]
    ds_read_b64_tr_b16 v[28:29], v59 offset:10240
    ds_read_b64_tr_b16 v[30:31], v59 offset:10752
    v_mfma_f32_32x32x16_bf16 v[80:95], a[100:103], v[16:19], v[80:95]
    s_add_u32 s50, s48, 2048
    s_waitcnt lgkmcnt(4)
    v_mfma_f32_32x32x16_bf16 v[96:111], a[96:99], v[20:23], v[96:111]
    ds_read_b64_tr_b16 v[16:17], v58 offset:12288
    ds_read_b64_tr_b16 v[18:19], v58 offset:12800
    v_cvt_pk_bf16_f32 v161, v162, v163
    v_add_u32 v190, 65536, v150
    v_mfma_f32_32x32x16_bf16 v[112:127], a[100:103], v[20:23], v[112:127]
    buffer_load_dwordx4 a[0:3], v7, s[8:11], s50 offen offset:0
    s_waitcnt lgkmcnt(4)
    v_mfma_f32_32x32x16_bf16 v[64:79], a[104:107], v[24:27], v[64:79]
    ds_read_b64_tr_b16 v[20:21], v59 offset:12288
    ds_read_b64_tr_b16 v[22:23], v59 offset:12800
    v_cvt_pk_bf16_f32 v162, v164, v165
    buffer_load_dwordx4 a[4:7], v8, s[8:11], s50 offen offset:0
    v_mfma_f32_32x32x16_bf16 v[80:95], a[108:111], v[24:27], v[80:95]
    v_add_u32 v191, 65536, v151
    s_waitcnt lgkmcnt(4)
    v_mfma_f32_32x32x16_bf16 v[96:111], a[104:107], v[28:31], v[96:111]
    ds_read_b64_tr_b16 v[24:25], v58 offset:14336
    ds_read_b64_tr_b16 v[26:27], v58 offset:14848
    buffer_load_dwordx4 a[8:11], v9, s[8:11], s50 offen offset:0
    v_mfma_f32_32x32x16_bf16 v[112:127], a[108:111], v[28:31], v[112:127]
    v_cvt_pk_bf16_f32 v163, v166, v167
    s_waitcnt lgkmcnt(4)
    v_mfma_f32_32x32x16_bf16 v[64:79], a[112:115], v[16:19], v[64:79]
    ds_read_b64_tr_b16 v[28:29], v59 offset:14336
    ds_read_b64_tr_b16 v[30:31], v59 offset:14848
    buffer_load_dwordx4 a[12:15], v10, s[8:11], s50 offen offset:0
    v_mfma_f32_32x32x16_bf16 v[80:95], a[116:119], v[16:19], v[80:95]
    s_add_u32 s101, s100, 6144
    buffer_store_dwordx4 v[160:163], v15, s[96:99], s101 offen sc0 sc1
    s_waitcnt lgkmcnt(4)
    v_mfma_f32_32x32x16_bf16 v[96:111], a[112:115], v[20:23], v[96:111]
    s_barrier
    ds_read_b64_tr_b16 v[16:17], v56 offset:49152
    ds_read_b64_tr_b16 v[18:19], v56 offset:49664
    buffer_load_dwordx4 a[16:19], v7, s[8:11], s50 offen offset:1024
    v_mfma_f32_32x32x16_bf16 v[112:127], a[116:119], v[20:23], v[112:127]
    buffer_load_dwordx4 a[20:23], v8, s[8:11], s50 offen offset:1024
    s_waitcnt lgkmcnt(4)
    v_mfma_f32_32x32x16_bf16 v[64:79], a[120:123], v[24:27], v[64:79]
    ds_read_b64_tr_b16 v[20:21], v57 offset:49152
    ds_read_b64_tr_b16 v[22:23], v57 offset:49664
    v_cvt_pk_bf16_f32 v164, v168, v169
    v_mfma_f32_32x32x16_bf16 v[80:95], a[124:127], v[24:27], v[80:95]
    buffer_load_dwordx4 a[24:27], v9, s[8:11], s50 offen offset:1024
    s_waitcnt lgkmcnt(4)
    v_mfma_f32_32x32x16_bf16 v[96:111], a[120:123], v[28:31], v[96:111]
    ds_read_b64_tr_b16 v[24:25], v56 offset:51200
    ds_read_b64_tr_b16 v[26:27], v56 offset:51712
    v_cvt_pk_bf16_f32 v165, v170, v171
    v_mfma_f32_32x32x16_bf16 v[112:127], a[124:127], v[28:31], v[112:127]
    buffer_load_dwordx4 a[28:31], v10, s[8:11], s50 offen offset:1024
    s_waitcnt lgkmcnt(4)
    v_mfma_f32_32x32x16_bf16 v[64:79], a[128:131], v[16:19], v[64:79]
    ds_read_b64_tr_b16 v[28:29], v57 offset:51200
    ds_read_b64_tr_b16 v[30:31], v57 offset:51712
    s_mov_b32 s49, 1048576
    v_mfma_f32_32x32x16_bf16 v[80:95], a[132:135], v[16:19], v[80:95]
    v_cvt_pk_bf16_f32 v166, v172, v173
    s_waitcnt lgkmcnt(4)
    v_mfma_f32_32x32x16_bf16 v[96:111], a[128:131], v[20:23], v[96:111]
    ds_read_b64_tr_b16 v[16:17], v56 offset:53248
    ds_read_b64_tr_b16 v[18:19], v56 offset:53760
    s_add_u32 m0, s47, 81920
    v_mfma_f32_32x32x16_bf16 v[112:127], a[132:135], v[20:23], v[112:127]
    v_cvt_pk_bf16_f32 v167, v174, v175
    s_waitcnt lgkmcnt(4)
    v_mfma_f32_32x32x16_bf16 v[64:79], a[136:139], v[24:27], v[64:79]
    ds_read_b64_tr_b16 v[20:21], v57 offset:53248
    ds_read_b64_tr_b16 v[22:23], v57 offset:53760
    buffer_load_dwordx4 v11, s[4:7], s49 offen offset:0 lds
    v_mfma_f32_32x32x16_bf16 v[80:95], a[140:143], v[24:27], v[80:95]
    s_waitcnt lgkmcnt(4)
    v_mfma_f32_32x32x16_bf16 v[96:111], a[136:139], v[28:31], v[96:111]
    ds_read_b64_tr_b16 v[24:25], v56 offset:55296
    ds_read_b64_tr_b16 v[26:27], v56 offset:55808
    s_add_u32 s101, s100, 6656
    buffer_store_dwordx4 v[164:167], v15, s[96:99], s101 offen sc0 sc1
    buffer_load_dwordx4 v12, s[4:7], s49 offen offset:1024 lds
    v_mfma_f32_32x32x16_bf16 v[112:127], a[140:143], v[28:31], v[112:127]
    buffer_load_dwordx4 v13, s[4:7], s49 offen offset:2048 lds
    s_waitcnt lgkmcnt(4)
    v_mfma_f32_32x32x16_bf16 v[64:79], a[144:147], v[16:19], v[64:79]
    ds_read_b64_tr_b16 v[28:29], v57 offset:55296
    ds_read_b64_tr_b16 v[30:31], v57 offset:55808
    v_mfma_f32_32x32x16_bf16 v[80:95], a[148:151], v[16:19], v[80:95]
    v_cvt_pk_bf16_f32 v224, v224, v225
    buffer_load_dwordx4 v14, s[4:7], s49 offen offset:3072 lds
    s_waitcnt lgkmcnt(4)
    v_mfma_f32_32x32x16_bf16 v[96:111], a[144:147], v[20:23], v[96:111]
    ds_read_b64_tr_b16 v[16:17], v56 offset:57344
    ds_read_b64_tr_b16 v[18:19], v56 offset:57856
    v_mfma_f32_32x32x16_bf16 v[112:127], a[148:151], v[20:23], v[112:127]
    v_cvt_pk_bf16_f32 v225, v226, v227
    s_add_u32 s50, s48, 4096
    s_waitcnt lgkmcnt(4)
    v_mfma_f32_32x32x16_bf16 v[64:79], a[152:155], v[24:27], v[64:79]
    ds_read_b64_tr_b16 v[20:21], v57 offset:57344
    ds_read_b64_tr_b16 v[22:23], v57 offset:57856
    buffer_load_dwordx4 a[32:35], v7, s[8:11], s50 offen offset:0
    v_mfma_f32_32x32x16_bf16 v[80:95], a[156:159], v[24:27], v[80:95]
    s_waitcnt lgkmcnt(4)
    v_mfma_f32_32x32x16_bf16 v[96:111], a[152:155], v[28:31], v[96:111]
    ds_read_b64_tr_b16 v[24:25], v56 offset:59392
    ds_read_b64_tr_b16 v[26:27], v56 offset:59904
    v_cvt_pk_bf16_f32 v226, v228, v229
    buffer_load_dwordx4 a[36:39], v8, s[8:11], s50 offen offset:0
    v_mfma_f32_32x32x16_bf16 v[112:127], a[156:159], v[28:31], v[112:127]
    s_waitcnt lgkmcnt(4)
    v_mfma_f32_32x32x16_bf16 v[64:79], a[160:163], v[16:19], v[64:79]
    ds_read_b64_tr_b16 v[28:29], v57 offset:59392
    ds_read_b64_tr_b16 v[30:31], v57 offset:59904
    v_cvt_pk_bf16_f32 v227, v230, v231
    buffer_load_dwordx4 a[40:43], v9, s[8:11], s50 offen offset:0
    v_mfma_f32_32x32x16_bf16 v[80:95], a[164:167], v[16:19], v[80:95]
    buffer_load_dwordx4 a[44:47], v10, s[8:11], s50 offen offset:0
    s_waitcnt lgkmcnt(4)
    v_mfma_f32_32x32x16_bf16 v[96:111], a[160:163], v[20:23], v[96:111]
    ds_read_b64_tr_b16 v[16:17], v56 offset:61440
    ds_read_b64_tr_b16 v[18:19], v56 offset:61952
    v_mfma_f32_32x32x16_bf16 v[112:127], a[164:167], v[20:23], v[112:127]
    s_add_u32 s101, s100, 1050624
    buffer_store_dwordx4 v[224:227], v15, s[96:99], s101 offen sc0 sc1
    buffer_load_dwordx4 a[48:51], v7, s[8:11], s50 offen offset:1024
    s_waitcnt lgkmcnt(4)
    v_mfma_f32_32x32x16_bf16 v[64:79], a[168:171], v[24:27], v[64:79]
    ds_read_b64_tr_b16 v[20:21], v57 offset:61440
    ds_read_b64_tr_b16 v[22:23], v57 offset:61952
    v_mfma_f32_32x32x16_bf16 v[80:95], a[172:175], v[24:27], v[80:95]
    v_cvt_pk_bf16_f32 v228, v232, v233
    buffer_load_dwordx4 a[52:55], v8, s[8:11], s50 offen offset:1024
    s_waitcnt lgkmcnt(4)
    v_mfma_f32_32x32x16_bf16 v[96:111], a[168:171], v[28:31], v[96:111]
    ds_read_b64_tr_b16 v[24:25], v56 offset:63488
    ds_read_b64_tr_b16 v[26:27], v56 offset:64000
    v_mfma_f32_32x32x16_bf16 v[112:127], a[172:175], v[28:31], v[112:127]
    buffer_load_dwordx4 a[56:59], v9, s[8:11], s50 offen offset:1024
    s_waitcnt lgkmcnt(4)
    v_mfma_f32_32x32x16_bf16 v[64:79], a[176:179], v[16:19], v[64:79]
    ds_read_b64_tr_b16 v[28:29], v57 offset:63488
    ds_read_b64_tr_b16 v[30:31], v57 offset:64000
    v_cvt_pk_bf16_f32 v229, v234, v235
    buffer_load_dwordx4 a[60:63], v10, s[8:11], s50 offen offset:1024
    v_mfma_f32_32x32x16_bf16 v[80:95], a[180:183], v[16:19], v[80:95]
    s_waitcnt lgkmcnt(4)
    v_mfma_f32_32x32x16_bf16 v[96:111], a[176:179], v[20:23], v[96:111]
    s_waitcnt vmcnt(56)
    s_barrier
    ds_read_b64_tr_b16 v[16:17], v58 offset:49152
    ds_read_b64_tr_b16 v[18:19], v58 offset:49664
    v_cvt_pk_bf16_f32 v230, v236, v237
    s_mov_b32 s49, 1572864
    v_mfma_f32_32x32x16_bf16 v[112:127], a[180:183], v[20:23], v[112:127]
    s_waitcnt lgkmcnt(4)
    v_mfma_f32_32x32x16_bf16 v[64:79], a[184:187], v[24:27], v[64:79]
    ds_read_b64_tr_b16 v[20:21], v59 offset:49152
    ds_read_b64_tr_b16 v[22:23], v59 offset:49664
    s_add_u32 m0, s47, 98304
    v_mfma_f32_32x32x16_bf16 v[80:95], a[188:191], v[24:27], v[80:95]
    v_cvt_pk_bf16_f32 v231, v238, v239
    buffer_load_dwordx4 v11, s[4:7], s49 offen offset:0 lds
    s_waitcnt lgkmcnt(4)
    v_mfma_f32_32x32x16_bf16 v[96:111], a[184:187], v[28:31], v[96:111]
    ds_read_b64_tr_b16 v[24:25], v58 offset:51200
    ds_read_b64_tr_b16 v[26:27], v58 offset:51712
    v_mfma_f32_32x32x16_bf16 v[112:127], a[188:191], v[28:31], v[112:127]
    s_add_u32 s101, s100, 1051136
    buffer_store_dwordx4 v[228:231], v15, s[96:99], s101 offen sc0 sc1
    buffer_load_dwordx4 v12, s[4:7], s49 offen offset:1024 lds
    s_waitcnt lgkmcnt(4)
    v_mfma_f32_32x32x16_bf16 v[64:79], a[192:195], v[16:19], v[64:79]
    ds_read_b64_tr_b16 v[28:29], v59 offset:51200
    ds_read_b64_tr_b16 v[30:31], v59 offset:51712
    v_mfma_f32_32x32x16_bf16 v[80:95], a[196:199], v[16:19], v[80:95]
    buffer_load_dwordx4 v13, s[4:7], s49 offen offset:2048 lds
    s_waitcnt lgkmcnt(4)
    v_mfma_f32_32x32x16_bf16 v[96:111], a[192:195], v[20:23], v[96:111]
    ds_read_b64_tr_b16 v[16:17], v58 offset:53248
    ds_read_b64_tr_b16 v[18:19], v58 offset:53760
    v_cvt_pk_bf16_f32 v240, v240, v241
    buffer_load_dwordx4 v14, s[4:7], s49 offen offset:3072 lds
    v_mfma_f32_32x32x16_bf16 v[112:127], a[196:199], v[20:23], v[112:127]
    s_waitcnt lgkmcnt(4)
    v_mfma_f32_32x32x16_bf16 v[64:79], a[200:203], v[24:27], v[64:79]
    ds_read_b64_tr_b16 v[20:21], v59 offset:53248
    ds_read_b64_tr_b16 v[22:23], v59 offset:53760
    s_add_u32 s50, s48, 6144
    v_mfma_f32_32x32x16_bf16 v[80:95], a[204:207], v[24:27], v[80:95]
    v_cvt_pk_bf16_f32 v241, v242, v243
    s_waitcnt lgkmcnt(4)
    v_mfma_f32_32x32x16_bf16 v[96:111], a[200:203], v[28:31], v[96:111]
    ds_read_b64_tr_b16 v[24:25], v58 offset:55296
    ds_read_b64_tr_b16 v[26:27], v58 offset:55808
    buffer_load_dwordx4 a[64:67], v7, s[8:11], s50 offen offset:0
    v_mfma_f32_32x32x16_bf16 v[112:127], a[204:207], v[28:31], v[112:127]
    v_cvt_pk_bf16_f32 v242, v244, v245
    s_waitcnt lgkmcnt(4)
    v_mfma_f32_32x32x16_bf16 v[64:79], a[208:211], v[16:19], v[64:79]
    ds_read_b64_tr_b16 v[28:29], v59 offset:55296
    ds_read_b64_tr_b16 v[30:31], v59 offset:55808
    buffer_load_dwordx4 a[68:71], v8, s[8:11], s50 offen offset:0
    v_mfma_f32_32x32x16_bf16 v[80:95], a[212:215], v[16:19], v[80:95]
    buffer_load_dwordx4 a[72:75], v9, s[8:11], s50 offen offset:0
    s_waitcnt lgkmcnt(4)
    v_mfma_f32_32x32x16_bf16 v[96:111], a[208:211], v[20:23], v[96:111]
    ds_read_b64_tr_b16 v[16:17], v58 offset:57344
    ds_read_b64_tr_b16 v[18:19], v58 offset:57856
    v_cvt_pk_bf16_f32 v243, v246, v247
    v_mfma_f32_32x32x16_bf16 v[112:127], a[212:215], v[20:23], v[112:127]
    buffer_load_dwordx4 a[76:79], v10, s[8:11], s50 offen offset:0
    s_waitcnt lgkmcnt(4)
    v_mfma_f32_32x32x16_bf16 v[64:79], a[216:219], v[24:27], v[64:79]
    ds_read_b64_tr_b16 v[20:21], v59 offset:57344
    ds_read_b64_tr_b16 v[22:23], v59 offset:57856
    s_add_u32 s101, s100, 1058816
    buffer_store_dwordx4 v[240:243], v15, s[96:99], s101 offen sc0 sc1
    v_mfma_f32_32x32x16_bf16 v[80:95], a[220:223], v[24:27], v[80:95]
    buffer_load_dwordx4 a[80:83], v7, s[8:11], s50 offen offset:1024
    s_waitcnt lgkmcnt(4)
    v_mfma_f32_32x32x16_bf16 v[96:111], a[216:219], v[28:31], v[96:111]
    ds_read_b64_tr_b16 v[24:25], v58 offset:59392
    ds_read_b64_tr_b16 v[26:27], v58 offset:59904
    buffer_load_dwordx4 a[84:87], v8, s[8:11], s50 offen offset:1024
    v_mfma_f32_32x32x16_bf16 v[112:127], a[220:223], v[28:31], v[112:127]
    v_cvt_pk_bf16_f32 v244, v248, v249
    s_waitcnt lgkmcnt(4)
    v_mfma_f32_32x32x16_bf16 v[64:79], a[224:227], v[16:19], v[64:79]
    ds_read_b64_tr_b16 v[28:29], v59 offset:59392
    ds_read_b64_tr_b16 v[30:31], v59 offset:59904
    buffer_load_dwordx4 a[88:91], v9, s[8:11], s50 offen offset:1024
    v_mfma_f32_32x32x16_bf16 v[80:95], a[228:231], v[16:19], v[80:95]
    v_cvt_pk_bf16_f32 v245, v250, v251
    s_waitcnt lgkmcnt(4)
    v_mfma_f32_32x32x16_bf16 v[96:111], a[224:227], v[20:23], v[96:111]
    ds_read_b64_tr_b16 v[16:17], v58 offset:61440
    ds_read_b64_tr_b16 v[18:19], v58 offset:61952
    buffer_load_dwordx4 a[92:95], v10, s[8:11], s50 offen offset:1024
    v_mfma_f32_32x32x16_bf16 v[112:127], a[228:231], v[20:23], v[112:127]
    s_waitcnt lgkmcnt(4)
    v_mfma_f32_32x32x16_bf16 v[64:79], a[232:235], v[24:27], v[64:79]
    ds_read_b64_tr_b16 v[20:21], v59 offset:61440
    ds_read_b64_tr_b16 v[22:23], v59 offset:61952
    v_cvt_pk_bf16_f32 v246, v252, v253
    v_mfma_f32_32x32x16_bf16 v[80:95], a[236:239], v[24:27], v[80:95]
    s_waitcnt lgkmcnt(4)
    v_mfma_f32_32x32x16_bf16 v[96:111], a[232:235], v[28:31], v[96:111]
    ds_read_b64_tr_b16 v[24:25], v58 offset:63488
    ds_read_b64_tr_b16 v[26:27], v58 offset:64000
    v_cvt_pk_bf16_f32 v247, v254, v255
    v_mfma_f32_32x32x16_bf16 v[112:127], a[236:239], v[28:31], v[112:127]
    s_waitcnt lgkmcnt(4)
    v_mfma_f32_32x32x16_bf16 v[64:79], a[240:243], v[16:19], v[64:79]
    ds_read_b64_tr_b16 v[28:29], v59 offset:63488
    ds_read_b64_tr_b16 v[30:31], v59 offset:64000
    v_mfma_f32_32x32x16_bf16 v[80:95], a[244:247], v[16:19], v[80:95]
    s_add_u32 s101, s100, 1059328
    buffer_store_dwordx4 v[244:247], v15, s[96:99], s101 offen sc0 sc1
    s_waitcnt lgkmcnt(4)
    v_mfma_f32_32x32x16_bf16 v[96:111], a[240:243], v[20:23], v[96:111]
    v_mfma_f32_32x32x16_bf16 v[112:127], a[244:247], v[20:23], v[112:127]
    s_waitcnt lgkmcnt(2)
    v_mfma_f32_32x32x16_bf16 v[64:79], a[248:251], v[24:27], v[64:79]
    v_mfma_f32_32x32x16_bf16 v[80:95], a[252:255], v[24:27], v[80:95]
    s_waitcnt lgkmcnt(0)
    v_mfma_f32_32x32x16_bf16 v[96:111], a[248:251], v[28:31], v[96:111]
    v_mfma_f32_32x32x16_bf16 v[112:127], a[252:255], v[28:31], v[112:127]
    s_waitcnt vmcnt(48)
    s_barrier
    ds_read_b64_tr_b16 v[152:153], v144 offset:0
    ds_read_b64_tr_b16 v[154:155], v144 offset:1024
    ds_read_b64_tr_b16 v[156:157], v145 offset:0
    ds_read_b64_tr_b16 v[158:159], v145 offset:1024
    ds_read_b64_tr_b16 v[160:161], v146 offset:0
    ds_read_b64_tr_b16 v[162:163], v146 offset:1024
    ds_read_b64_tr_b16 v[164:165], v147 offset:0
    ds_read_b64_tr_b16 v[166:167], v147 offset:1024
    v_cvt_pk_bf16_f32 v64, v64, v65
    v_cvt_pk_bf16_f32 v65, v66, v67
    v_cvt_pk_bf16_f32 v66, v68, v69
    v_cvt_pk_bf16_f32 v67, v70, v71
    s_add_u32 s101, s100, 1052672
    buffer_store_dwordx4 v[64:67], v15, s[96:99], s101 offen sc0 sc1
    v_cvt_pk_bf16_f32 v68, v72, v73
    v_cvt_pk_bf16_f32 v69, v74, v75
    v_cvt_pk_bf16_f32 v70, v76, v77
    v_cvt_pk_bf16_f32 v71, v78, v79
    s_add_u32 s101, s100, 1053184
    buffer_store_dwordx4 v[68:71], v15, s[96:99], s101 offen sc0 sc1
    v_cvt_pk_bf16_f32 v80, v80, v81
    v_cvt_pk_bf16_f32 v81, v82, v83
    v_cvt_pk_bf16_f32 v82, v84, v85
    v_cvt_pk_bf16_f32 v83, v86, v87
    s_add_u32 s101, s100, 1060864
    buffer_store_dwordx4 v[80:83], v15, s[96:99], s101 offen sc0 sc1
    v_cvt_pk_bf16_f32 v84, v88, v89
    v_cvt_pk_bf16_f32 v85, v90, v91
    v_cvt_pk_bf16_f32 v86, v92, v93
    v_cvt_pk_bf16_f32 v87, v94, v95
    s_add_u32 s101, s100, 1061376
    buffer_store_dwordx4 v[84:87], v15, s[96:99], s101 offen sc0 sc1
    v_cvt_pk_bf16_f32 v96, v96, v97
    v_cvt_pk_bf16_f32 v97, v98, v99
    v_cvt_pk_bf16_f32 v98, v100, v101
    v_cvt_pk_bf16_f32 v99, v102, v103
    s_add_u32 s101, s100, 1054720
    buffer_store_dwordx4 v[96:99], v15, s[96:99], s101 offen sc0 sc1
    v_cvt_pk_bf16_f32 v100, v104, v105
    v_cvt_pk_bf16_f32 v101, v106, v107
    v_cvt_pk_bf16_f32 v102, v108, v109
    v_cvt_pk_bf16_f32 v103, v110, v111
    s_add_u32 s101, s100, 1055232
    buffer_store_dwordx4 v[100:103], v15, s[96:99], s101 offen sc0 sc1
    v_cvt_pk_bf16_f32 v112, v112, v113
    v_cvt_pk_bf16_f32 v113, v114, v115
    v_cvt_pk_bf16_f32 v114, v116, v117
    v_cvt_pk_bf16_f32 v115, v118, v119
    s_add_u32 s101, s100, 1062912
    buffer_store_dwordx4 v[112:115], v15, s[96:99], s101 offen sc0 sc1
    v_cvt_pk_bf16_f32 v116, v120, v121
    v_cvt_pk_bf16_f32 v117, v122, v123
    v_cvt_pk_bf16_f32 v118, v124, v125
    v_cvt_pk_bf16_f32 v119, v126, v127
    s_add_u32 s101, s100, 1063424
    buffer_store_dwordx4 v[116:119], v15, s[96:99], s101 offen sc0 sc1
K2_JOIN:
    s_waitcnt lgkmcnt(6)
    v_mfma_f32_16x16x32_bf16 v[112:115], v[152:155], v[192:195], 0
    ds_read_b64_tr_b16 v[168:169], v148 offset:0
    v_lshl_add_u32 v228, v0, 20, s34
    v_mfma_f32_16x16x32_bf16 v[116:119], v[152:155], v[196:199], 0
    ds_read_b64_tr_b16 v[170:171], v148 offset:1024
    v_mov_b32 v229, 3
    v_mfma_f32_16x16x32_bf16 v[120:123], v[152:155], v[200:203], 0
    v_mfma_f32_16x16x32_bf16 v[124:127], v[152:155], v[204:207], 0
    s_waitcnt lgkmcnt(6)
    v_mfma_f32_16x16x32_bf16 v[16:19], v[156:159], v[192:195], 0
    ds_read_b64_tr_b16 v[172:173], v149 offset:0
    v_mfma_f32_16x16x32_bf16 v[20:23], v[156:159], v[196:199], 0
    ds_read_b64_tr_b16 v[174:175], v149 offset:1024
    v_mfma_f32_16x16x32_bf16 v[24:27], v[156:159], v[200:203], 0
    v_mfma_f32_16x16x32_bf16 v[28:31], v[156:159], v[204:207], 0
    s_waitcnt lgkmcnt(6)
    v_mfma_f32_16x16x32_bf16 v[32:35], v[160:163], v[192:195], 0
    ds_read_b64_tr_b16 v[176:177], v150 offset:0
    s_lshr_b32 s35, s25, 1
    v_mfma_f32_16x16x32_bf16 v[36:39], v[160:163], v[196:199], 0
    ds_read_b64_tr_b16 v[178:179], v150 offset:1024
    v_mfma_f32_16x16x32_bf16 v[40:43], v[160:163], v[200:203], 0
    v_mfma_f32_16x16x32_bf16 v[44:47], v[160:163], v[204:207], 0
    s_waitcnt lgkmcnt(6)
    v_mfma_f32_16x16x32_bf16 v[48:51], v[164:167], v[192:195], 0
    ds_read_b64_tr_b16 v[180:181], v151 offset:0
    s_lshl_b32 s35, s35, 4
    v_mfma_f32_16x16x32_bf16 v[52:55], v[164:167], v[196:199], 0
    ds_read_b64_tr_b16 v[182:183], v151 offset:1024
    v_mfma_f32_16x16x32_bf16 v[56:59], v[164:167], v[200:203], 0
    v_mfma_f32_16x16x32_bf16 v[60:63], v[164:167], v[204:207], 0
    s_waitcnt lgkmcnt(6)
    v_mfma_f32_16x16x32_bf16 v[64:67], v[168:171], v[192:195], 0
    ds_read_b64_tr_b16 v[152:153], v144 offset:8192
    v_mfma_f32_16x16x32_bf16 v[68:71], v[168:171], v[196:199], 0
    ds_read_b64_tr_b16 v[154:155], v144 offset:9216
    v_mfma_f32_16x16x32_bf16 v[72:75], v[168:171], v[200:203], 0
    v_mfma_f32_16x16x32_bf16 v[76:79], v[168:171], v[204:207], 0
    s_waitcnt lgkmcnt(6)
    v_mfma_f32_16x16x32_bf16 v[80:83], v[172:175], v[192:195], 0
    ds_read_b64_tr_b16 v[156:157], v145 offset:8192
    v_lshrrev_b32 v231, 20, v228
    v_mfma_f32_16x16x32_bf16 v[84:87], v[172:175], v[196:199], 0
    ds_read_b64_tr_b16 v[158:159], v145 offset:9216
    v_min_u32 v231, 1, v231
    v_mfma_f32_16x16x32_bf16 v[88:91], v[172:175], v[200:203], 0
    v_mfma_f32_16x16x32_bf16 v[92:95], v[172:175], v[204:207], 0
    s_waitcnt lgkmcnt(6)
    v_mfma_f32_16x16x32_bf16 v[96:99], v[176:179], v[192:195], 0
    ds_read_b64_tr_b16 v[160:161], v146 offset:8192
    v_and_b32 v227, 0xff, v228
    v_mfma_f32_16x16x32_bf16 v[100:103], v[176:179], v[196:199], 0
    ds_read_b64_tr_b16 v[162:163], v146 offset:9216
    v_mfma_f32_16x16x32_bf16 v[104:107], v[176:179], v[200:203], 0
    v_mfma_f32_16x16x32_bf16 v[108:111], v[176:179], v[204:207], 0
    s_waitcnt lgkmcnt(6)
    v_mfma_f32_16x16x32_bf16 v[128:131], v[180:183], v[192:195], 0
    ds_read_b64_tr_b16 v[164:165], v147 offset:8192
    v_lshl_add_u32 v231, v231, 17, v227
    v_mfma_f32_16x16x32_bf16 v[132:135], v[180:183], v[196:199], 0
    ds_read_b64_tr_b16 v[166:167], v147 offset:9216
    v_mfma_f32_16x16x32_bf16 v[136:139], v[180:183], v[200:203], 0
    v_mfma_f32_16x16x32_bf16 v[140:143], v[180:183], v[204:207], 0
    s_waitcnt vmcnt(51) lgkmcnt(6)
    v_mfma_f32_16x16x32_bf16 v[112:115], v[152:155], v[208:211], v[112:115]
    ds_read_b64_tr_b16 v[168:169], v148 offset:8192
    v_lshlrev_b32 v231, 8, v231
    v_mfma_f32_16x16x32_bf16 v[116:119], v[152:155], v[212:215], v[116:119]
    ds_read_b64_tr_b16 v[170:171], v148 offset:9216
    v_mfma_f32_16x16x32_bf16 v[120:123], v[152:155], v[216:219], v[120:123]
    v_mfma_f32_16x16x32_bf16 v[124:127], v[152:155], v[220:223], v[124:127]
    s_waitcnt lgkmcnt(6)
    v_mfma_f32_16x16x32_bf16 v[16:19], v[156:159], v[208:211], v[16:19]
    ds_read_b64_tr_b16 v[172:173], v149 offset:8192
    v_mfma_f32_16x16x32_bf16 v[20:23], v[156:159], v[212:215], v[20:23]
    ds_read_b64_tr_b16 v[174:175], v149 offset:9216
    v_mfma_f32_16x16x32_bf16 v[24:27], v[156:159], v[216:219], v[24:27]
    v_mfma_f32_16x16x32_bf16 v[28:31], v[156:159], v[220:223], v[28:31]
    s_waitcnt lgkmcnt(6)
    v_mfma_f32_16x16x32_bf16 v[32:35], v[160:163], v[208:211], v[32:35]
    ds_read_b64_tr_b16 v[176:177], v150 offset:8192
    v_lshrrev_b32 v224, 4, v0
    v_mfma_f32_16x16x32_bf16 v[36:39], v[160:163], v[212:215], v[36:39]
    ds_read_b64_tr_b16 v[178:179], v150 offset:9216
    v_add_u32 v224, s24, v224
    v_mfma_f32_16x16x32_bf16 v[40:43], v[160:163], v[216:219], v[40:43]
    v_mfma_f32_16x16x32_bf16 v[44:47], v[160:163], v[220:223], v[44:47]
    s_waitcnt lgkmcnt(6)
    v_mfma_f32_16x16x32_bf16 v[48:51], v[164:167], v[208:211], v[48:51]
    ds_read_b64_tr_b16 v[180:181], v151 offset:8192
    v_min_u32 v224, 1, v224
    v_mfma_f32_16x16x32_bf16 v[52:55], v[164:167], v[212:215], v[52:55]
    ds_read_b64_tr_b16 v[182:183], v151 offset:9216
    v_mfma_f32_16x16x32_bf16 v[56:59], v[164:167], v[216:219], v[56:59]
    v_mfma_f32_16x16x32_bf16 v[60:63], v[164:167], v[220:223], v[60:63]
    s_waitcnt lgkmcnt(6)
    v_mfma_f32_16x16x32_bf16 v[64:67], v[168:171], v[208:211], v[64:67]
    s_waitcnt vmcnt(42)
    s_barrier
    ds_read_b64_tr_b16 v[152:153], v144 offset:16384
    v_add_u32 v230, s35, v0
    v_mfma_f32_16x16x32_bf16 v[68:71], v[168:171], v[212:215], v[68:71]
    ds_read_b64_tr_b16 v[154:155], v144 offset:17408
    v_lshl_add_u32 v230, v224, 17, v230
    v_mfma_f32_16x16x32_bf16 v[72:75], v[168:171], v[216:219], v[72:75]
    v_mfma_f32_16x16x32_bf16 v[76:79], v[168:171], v[220:223], v[76:79]
    s_waitcnt lgkmcnt(6)
    v_mfma_f32_16x16x32_bf16 v[80:83], v[172:175], v[208:211], v[80:83]
    ds_read_b64_tr_b16 v[156:157], v145 offset:16384
    v_lshlrev_b32 v230, 8, v230
    v_mfma_f32_16x16x32_bf16 v[84:87], v[172:175], v[212:215], v[84:87]
    ds_read_b64_tr_b16 v[158:159], v145 offset:17408
    v_mfma_f32_16x16x32_bf16 v[88:91], v[172:175], v[216:219], v[88:91]
    v_mfma_f32_16x16x32_bf16 v[92:95], v[172:175], v[220:223], v[92:95]
    s_waitcnt lgkmcnt(6)
    v_mfma_f32_16x16x32_bf16 v[96:99], v[176:179], v[208:211], v[96:99]
    ds_read_b64_tr_b16 v[160:161], v146 offset:16384
    v_mfma_f32_16x16x32_bf16 v[100:103], v[176:179], v[212:215], v[100:103]
    ds_read_b64_tr_b16 v[162:163], v146 offset:17408
    v_mfma_f32_16x16x32_bf16 v[104:107], v[176:179], v[216:219], v[104:107]
    v_mfma_f32_16x16x32_bf16 v[108:111], v[176:179], v[220:223], v[108:111]
    s_waitcnt lgkmcnt(6)
    v_mfma_f32_16x16x32_bf16 v[128:131], v[180:183], v[208:211], v[128:131]
    ds_read_b64_tr_b16 v[164:165], v147 offset:16384
    v_mfma_f32_16x16x32_bf16 v[132:135], v[180:183], v[212:215], v[132:135]
    ds_read_b64_tr_b16 v[166:167], v147 offset:17408
    v_mfma_f32_16x16x32_bf16 v[136:139], v[180:183], v[216:219], v[136:139]
    v_mfma_f32_16x16x32_bf16 v[140:143], v[180:183], v[220:223], v[140:143]
    s_waitcnt lgkmcnt(6)
    v_mfma_f32_16x16x32_bf16 v[112:115], v[152:155], a[0:3], v[112:115]
    ds_read_b64_tr_b16 v[168:169], v148 offset:16384
    s_mov_b32 s49, 2097152
    v_mfma_f32_16x16x32_bf16 v[116:119], v[152:155], a[4:7], v[116:119]
    ds_read_b64_tr_b16 v[170:171], v148 offset:17408
    s_add_u32 m0, s47, 131072
    v_mfma_f32_16x16x32_bf16 v[120:123], v[152:155], a[8:11], v[120:123]
    buffer_load_dwordx4 v11, s[4:7], s49 offen offset:0 lds
    v_mfma_f32_16x16x32_bf16 v[124:127], v[152:155], a[12:15], v[124:127]
    s_waitcnt lgkmcnt(6)
    v_mfma_f32_16x16x32_bf16 v[16:19], v[156:159], a[0:3], v[16:19]
    ds_read_b64_tr_b16 v[172:173], v149 offset:16384
    v_mfma_f32_16x16x32_bf16 v[20:23], v[156:159], a[4:7], v[20:23]
    ds_read_b64_tr_b16 v[174:175], v149 offset:17408
    v_mfma_f32_16x16x32_bf16 v[24:27], v[156:159], a[8:11], v[24:27]
    buffer_load_dwordx4 v12, s[4:7], s49 offen offset:1024 lds
    v_mfma_f32_16x16x32_bf16 v[28:31], v[156:159], a[12:15], v[28:31]
    s_waitcnt lgkmcnt(6)
    v_mfma_f32_16x16x32_bf16 v[32:35], v[160:163], a[0:3], v[32:35]
    ds_read_b64_tr_b16 v[176:177], v150 offset:16384
    v_mfma_f32_16x16x32_bf16 v[36:39], v[160:163], a[4:7], v[36:39]
    ds_read_b64_tr_b16 v[178:179], v150 offset:17408
    v_mfma_f32_16x16x32_bf16 v[40:43], v[160:163], a[8:11], v[40:43]
    buffer_load_dwordx4 v13, s[4:7], s49 offen offset:2048 lds
    v_mfma_f32_16x16x32_bf16 v[44:47], v[160:163], a[12:15], v[44:47]
    s_waitcnt lgkmcnt(6)
    v_mfma_f32_16x16x32_bf16 v[48:51], v[164:167], a[0:3], v[48:51]
    ds_read_b64_tr_b16 v[180:181], v151 offset:16384
    v_mfma_f32_16x16x32_bf16 v[52:55], v[164:167], a[4:7], v[52:55]
    ds_read_b64_tr_b16 v[182:183], v151 offset:17408
    v_mfma_f32_16x16x32_bf16 v[56:59], v[164:167], a[8:11], v[56:59]
    buffer_load_dwordx4 v14, s[4:7], s49 offen offset:3072 lds
    v_mfma_f32_16x16x32_bf16 v[60:63], v[164:167], a[12:15], v[60:63]
    s_add_u32 s50, s48, 8192
    s_waitcnt lgkmcnt(6)
    v_mfma_f32_16x16x32_bf16 v[64:67], v[168:171], a[0:3], v[64:67]
    ds_read_b64_tr_b16 v[152:153], v144 offset:24576
    v_mfma_f32_16x16x32_bf16 v[68:71], v[168:171], a[4:7], v[68:71]
    ds_read_b64_tr_b16 v[154:155], v144 offset:25600
    v_mfma_f32_16x16x32_bf16 v[72:75], v[168:171], a[8:11], v[72:75]
    buffer_load_dwordx4 a[96:99], v7, s[8:11], s50 offen offset:0
    v_mfma_f32_16x16x32_bf16 v[76:79], v[168:171], a[12:15], v[76:79]
    s_waitcnt lgkmcnt(6)
    v_mfma_f32_16x16x32_bf16 v[80:83], v[172:175], a[0:3], v[80:83]
    ds_read_b64_tr_b16 v[156:157], v145 offset:24576
    v_mfma_f32_16x16x32_bf16 v[84:87], v[172:175], a[4:7], v[84:87]
    ds_read_b64_tr_b16 v[158:159], v145 offset:25600
    v_mfma_f32_16x16x32_bf16 v[88:91], v[172:175], a[8:11], v[88:91]
    buffer_load_dwordx4 a[100:103], v8, s[8:11], s50 offen offset:0
    v_mfma_f32_16x16x32_bf16 v[92:95], v[172:175], a[12:15], v[92:95]
    buffer_load_dwordx4 a[104:107], v9, s[8:11], s50 offen offset:0
    s_waitcnt lgkmcnt(6)
    v_mfma_f32_16x16x32_bf16 v[96:99], v[176:179], a[0:3], v[96:99]
    ds_read_b64_tr_b16 v[160:161], v146 offset:24576
    v_mfma_f32_16x16x32_bf16 v[100:103], v[176:179], a[4:7], v[100:103]
    ds_read_b64_tr_b16 v[162:163], v146 offset:25600
    v_mfma_f32_16x16x32_bf16 v[104:107], v[176:179], a[8:11], v[104:107]
    v_mfma_f32_16x16x32_bf16 v[108:111], v[176:179], a[12:15], v[108:111]
    buffer_load_dwordx4 a[108:111], v10, s[8:11], s50 offen offset:0
    s_waitcnt lgkmcnt(6)
    v_mfma_f32_16x16x32_bf16 v[128:131], v[180:183], a[0:3], v[128:131]
    ds_read_b64_tr_b16 v[164:165], v147 offset:24576
    v_mfma_f32_16x16x32_bf16 v[132:135], v[180:183], a[4:7], v[132:135]
    ds_read_b64_tr_b16 v[166:167], v147 offset:25600
    v_mfma_f32_16x16x32_bf16 v[136:139], v[180:183], a[8:11], v[136:139]
    buffer_load_dwordx4 a[112:115], v7, s[8:11], s50 offen offset:1024
    v_mfma_f32_16x16x32_bf16 v[140:143], v[180:183], a[12:15], v[140:143]
    s_waitcnt vmcnt(46) lgkmcnt(6)
    v_mfma_f32_16x16x32_bf16 v[112:115], v[152:155], a[16:19], v[112:115]
    ds_read_b64_tr_b16 v[168:169], v148 offset:24576
    v_mfma_f32_16x16x32_bf16 v[116:119], v[152:155], a[20:23], v[116:119]
    ds_read_b64_tr_b16 v[170:171], v148 offset:25600
    v_mfma_f32_16x16x32_bf16 v[120:123], v[152:155], a[24:27], v[120:123]
    buffer_load_dwordx4 a[116:119], v8, s[8:11], s50 offen offset:1024
    v_mfma_f32_16x16x32_bf16 v[124:127], v[152:155], a[28:31], v[124:127]
    s_waitcnt lgkmcnt(6)
    v_mfma_f32_16x16x32_bf16 v[16:19], v[156:159], a[16:19], v[16:19]
    ds_read_b64_tr_b16 v[172:173], v149 offset:24576
    v_mfma_f32_16x16x32_bf16 v[20:23], v[156:159], a[20:23], v[20:23]
    ds_read_b64_tr_b16 v[174:175], v149 offset:25600
    v_mfma_f32_16x16x32_bf16 v[24:27], v[156:159], a[24:27], v[24:27]
    buffer_load_dwordx4 a[120:123], v9, s[8:11], s50 offen offset:1024
    v_mfma_f32_16x16x32_bf16 v[28:31], v[156:159], a[28:31], v[28:31]
    s_waitcnt lgkmcnt(6)
    v_mfma_f32_16x16x32_bf16 v[32:35], v[160:163], a[16:19], v[32:35]
    ds_read_b64_tr_b16 v[176:177], v150 offset:24576
    v_mfma_f32_16x16x32_bf16 v[36:39], v[160:163], a[20:23], v[36:39]
    ds_read_b64_tr_b16 v[178:179], v150 offset:25600
    v_mfma_f32_16x16x32_bf16 v[40:43], v[160:163], a[24:27], v[40:43]
    buffer_load_dwordx4 a[124:127], v10, s[8:11], s50 offen offset:1024
    v_mfma_f32_16x16x32_bf16 v[44:47], v[160:163], a[28:31], v[44:47]
    s_waitcnt lgkmcnt(6)
    v_mfma_f32_16x16x32_bf16 v[48:51], v[164:167], a[16:19], v[48:51]
    ds_read_b64_tr_b16 v[180:181], v151 offset:24576
    v_mfma_f32_16x16x32_bf16 v[52:55], v[164:167], a[20:23], v[52:55]
    ds_read_b64_tr_b16 v[182:183], v151 offset:25600
    v_mfma_f32_16x16x32_bf16 v[56:59], v[164:167], a[24:27], v[56:59]
    v_mfma_f32_16x16x32_bf16 v[60:63], v[164:167], a[28:31], v[60:63]
    s_waitcnt lgkmcnt(6)
    v_mfma_f32_16x16x32_bf16 v[64:67], v[168:171], a[16:19], v[64:67]
    s_waitcnt vmcnt(12)
    s_barrier
    buffer_store_dword v229, v231, s[64:67], 0 offen offset:48 sc0 sc1
    buffer_store_byte v229, v228, s[92:95], 0 offen sc0 sc1
    ds_read_b64_tr_b16 v[152:153], v184 offset:0
    v_mfma_f32_16x16x32_bf16 v[68:71], v[168:171], a[20:23], v[68:71]
    ds_read_b64_tr_b16 v[154:155], v184 offset:1024
    v_mfma_f32_16x16x32_bf16 v[72:75], v[168:171], a[24:27], v[72:75]
    v_mfma_f32_16x16x32_bf16 v[76:79], v[168:171], a[28:31], v[76:79]
    s_waitcnt lgkmcnt(6)
    v_mfma_f32_16x16x32_bf16 v[80:83], v[172:175], a[16:19], v[80:83]
    ds_read_b64_tr_b16 v[156:157], v185 offset:0
    v_mfma_f32_16x16x32_bf16 v[84:87], v[172:175], a[20:23], v[84:87]
    ds_read_b64_tr_b16 v[158:159], v185 offset:1024
    v_mfma_f32_16x16x32_bf16 v[88:91], v[172:175], a[24:27], v[88:91]
    v_mfma_f32_16x16x32_bf16 v[92:95], v[172:175], a[28:31], v[92:95]
    s_waitcnt lgkmcnt(6)
    v_mfma_f32_16x16x32_bf16 v[96:99], v[176:179], a[16:19], v[96:99]
    ds_read_b64_tr_b16 v[160:161], v186 offset:0
    v_mfma_f32_16x16x32_bf16 v[100:103], v[176:179], a[20:23], v[100:103]
    ds_read_b64_tr_b16 v[162:163], v186 offset:1024
    v_mfma_f32_16x16x32_bf16 v[104:107], v[176:179], a[24:27], v[104:107]
    v_mfma_f32_16x16x32_bf16 v[108:111], v[176:179], a[28:31], v[108:111]
    s_waitcnt lgkmcnt(6)
    v_mfma_f32_16x16x32_bf16 v[128:131], v[180:183], a[16:19], v[128:131]
    ds_read_b64_tr_b16 v[164:165], v187 offset:0
    v_mfma_f32_16x16x32_bf16 v[132:135], v[180:183], a[20:23], v[132:135]
    ds_read_b64_tr_b16 v[166:167], v187 offset:1024
    v_mfma_f32_16x16x32_bf16 v[136:139], v[180:183], a[24:27], v[136:139]
    v_mfma_f32_16x16x32_bf16 v[140:143], v[180:183], a[28:31], v[140:143]
    s_waitcnt lgkmcnt(6)
    v_mfma_f32_16x16x32_bf16 v[112:115], v[152:155], a[32:35], v[112:115]
    ds_read_b64_tr_b16 v[168:169], v188 offset:0
    s_mov_b32 s49, 2621440
    v_mfma_f32_16x16x32_bf16 v[116:119], v[152:155], a[36:39], v[116:119]
    ds_read_b64_tr_b16 v[170:171], v188 offset:1024
    s_add_u32 m0, s47, 147456
    v_mfma_f32_16x16x32_bf16 v[120:123], v[152:155], a[40:43], v[120:123]
    buffer_load_dwordx4 v11, s[4:7], s49 offen offset:0 lds
    v_mfma_f32_16x16x32_bf16 v[124:127], v[152:155], a[44:47], v[124:127]
    v_add_u32 v144, 81920, v144
    s_waitcnt lgkmcnt(6)
    v_mfma_f32_16x16x32_bf16 v[16:19], v[156:159], a[32:35], v[16:19]
    ds_read_b64_tr_b16 v[172:173], v189 offset:0
    v_add_u32 v145, 81920, v145
    v_mfma_f32_16x16x32_bf16 v[20:23], v[156:159], a[36:39], v[20:23]
    ds_read_b64_tr_b16 v[174:175], v189 offset:1024
    v_mfma_f32_16x16x32_bf16 v[24:27], v[156:159], a[40:43], v[24:27]
    buffer_load_dwordx4 v12, s[4:7], s49 offen offset:1024 lds
    v_mfma_f32_16x16x32_bf16 v[28:31], v[156:159], a[44:47], v[28:31]
    s_waitcnt lgkmcnt(6)
    v_mfma_f32_16x16x32_bf16 v[32:35], v[160:163], a[32:35], v[32:35]
    ds_read_b64_tr_b16 v[176:177], v190 offset:0
    v_mfma_f32_16x16x32_bf16 v[36:39], v[160:163], a[36:39], v[36:39]
    ds_read_b64_tr_b16 v[178:179], v190 offset:1024
    v_mfma_f32_16x16x32_bf16 v[40:43], v[160:163], a[40:43], v[40:43]
    buffer_load_dwordx4 v13, s[4:7], s49 offen offset:2048 lds
    v_mfma_f32_16x16x32_bf16 v[44:47], v[160:163], a[44:47], v[44:47]
    s_waitcnt lgkmcnt(6)
    v_mfma_f32_16x16x32_bf16 v[48:51], v[164:167], a[32:35], v[48:51]
    ds_read_b64_tr_b16 v[180:181], v191 offset:0
    v_add_u32 v146, 81920, v146
    v_mfma_f32_16x16x32_bf16 v[52:55], v[164:167], a[36:39], v[52:55]
    ds_read_b64_tr_b16 v[182:183], v191 offset:1024
    v_mfma_f32_16x16x32_bf16 v[56:59], v[164:167], a[40:43], v[56:59]
    buffer_load_dwordx4 v14, s[4:7], s49 offen offset:3072 lds
    v_mfma_f32_16x16x32_bf16 v[60:63], v[164:167], a[44:47], v[60:63]
    s_add_u32 s50, s48, 10240
    s_waitcnt lgkmcnt(6)
    v_mfma_f32_16x16x32_bf16 v[64:67], v[168:171], a[32:35], v[64:67]
    ds_read_b64_tr_b16 v[152:153], v184 offset:8192
    v_mfma_f32_16x16x32_bf16 v[68:71], v[168:171], a[36:39], v[68:71]
    ds_read_b64_tr_b16 v[154:155], v184 offset:9216
    v_mfma_f32_16x16x32_bf16 v[72:75], v[168:171], a[40:43], v[72:75]
    buffer_load_dwordx4 a[128:131], v7, s[8:11], s50 offen offset:0
    v_mfma_f32_16x16x32_bf16 v[76:79], v[168:171], a[44:47], v[76:79]
    s_waitcnt lgkmcnt(6)
    v_mfma_f32_16x16x32_bf16 v[80:83], v[172:175], a[32:35], v[80:83]
    ds_read_b64_tr_b16 v[156:157], v185 offset:8192
    v_add_u32 v147, 81920, v147
    v_mfma_f32_16x16x32_bf16 v[84:87], v[172:175], a[36:39], v[84:87]
    ds_read_b64_tr_b16 v[158:159], v185 offset:9216
    v_mfma_f32_16x16x32_bf16 v[88:91], v[172:175], a[40:43], v[88:91]
    buffer_load_dwordx4 a[132:135], v8, s[8:11], s50 offen offset:0
    v_mfma_f32_16x16x32_bf16 v[92:95], v[172:175], a[44:47], v[92:95]
    buffer_load_dwordx4 a[136:139], v9, s[8:11], s50 offen offset:0
    s_waitcnt lgkmcnt(6)
    v_mfma_f32_16x16x32_bf16 v[96:99], v[176:179], a[32:35], v[96:99]
    ds_read_b64_tr_b16 v[160:161], v186 offset:8192
    v_mfma_f32_16x16x32_bf16 v[100:103], v[176:179], a[36:39], v[100:103]
    ds_read_b64_tr_b16 v[162:163], v186 offset:9216
    v_mfma_f32_16x16x32_bf16 v[104:107], v[176:179], a[40:43], v[104:107]
    v_mfma_f32_16x16x32_bf16 v[108:111], v[176:179], a[44:47], v[108:111]
    buffer_load_dwordx4 a[140:143], v10, s[8:11], s50 offen offset:0
    s_waitcnt lgkmcnt(6)
    v_mfma_f32_16x16x32_bf16 v[128:131], v[180:183], a[32:35], v[128:131]
    ds_read_b64_tr_b16 v[164:165], v187 offset:8192
    v_add_u32 v148, 81920, v148
    v_mfma_f32_16x16x32_bf16 v[132:135], v[180:183], a[36:39], v[132:135]
    ds_read_b64_tr_b16 v[166:167], v187 offset:9216
    v_mfma_f32_16x16x32_bf16 v[136:139], v[180:183], a[40:43], v[136:139]
    buffer_load_dwordx4 a[144:147], v7, s[8:11], s50 offen offset:1024
    v_mfma_f32_16x16x32_bf16 v[140:143], v[180:183], a[44:47], v[140:143]
    s_waitcnt lgkmcnt(6)
    v_mfma_f32_16x16x32_bf16 v[112:115], v[152:155], a[48:51], v[112:115]
    ds_read_b64_tr_b16 v[168:169], v188 offset:8192
    v_mfma_f32_16x16x32_bf16 v[116:119], v[152:155], a[52:55], v[116:119]
    ds_read_b64_tr_b16 v[170:171], v188 offset:9216
    v_mfma_f32_16x16x32_bf16 v[120:123], v[152:155], a[56:59], v[120:123]
    buffer_load_dwordx4 a[148:151], v8, s[8:11], s50 offen offset:1024
    v_mfma_f32_16x16x32_bf16 v[124:127], v[152:155], a[60:63], v[124:127]
    s_waitcnt lgkmcnt(6)
    v_mfma_f32_16x16x32_bf16 v[16:19], v[156:159], a[48:51], v[16:19]
    ds_read_b64_tr_b16 v[172:173], v189 offset:8192
    v_add_u32 v149, 81920, v149
    v_mfma_f32_16x16x32_bf16 v[20:23], v[156:159], a[52:55], v[20:23]
    ds_read_b64_tr_b16 v[174:175], v189 offset:9216
    v_mfma_f32_16x16x32_bf16 v[24:27], v[156:159], a[56:59], v[24:27]
    buffer_load_dwordx4 a[152:155], v9, s[8:11], s50 offen offset:1024
    v_mfma_f32_16x16x32_bf16 v[28:31], v[156:159], a[60:63], v[28:31]
    s_waitcnt lgkmcnt(6)
    v_mfma_f32_16x16x32_bf16 v[32:35], v[160:163], a[48:51], v[32:35]
    ds_read_b64_tr_b16 v[176:177], v190 offset:8192
    v_mfma_f32_16x16x32_bf16 v[36:39], v[160:163], a[52:55], v[36:39]
    ds_read_b64_tr_b16 v[178:179], v190 offset:9216
    v_mfma_f32_16x16x32_bf16 v[40:43], v[160:163], a[56:59], v[40:43]
    buffer_load_dwordx4 a[156:159], v10, s[8:11], s50 offen offset:1024
    v_mfma_f32_16x16x32_bf16 v[44:47], v[160:163], a[60:63], v[44:47]
    s_waitcnt lgkmcnt(6)
    v_mfma_f32_16x16x32_bf16 v[48:51], v[164:167], a[48:51], v[48:51]
    ds_read_b64_tr_b16 v[180:181], v191 offset:8192
    v_add_u32 v150, 81920, v150
    v_mfma_f32_16x16x32_bf16 v[52:55], v[164:167], a[52:55], v[52:55]
    ds_read_b64_tr_b16 v[182:183], v191 offset:9216
    v_mfma_f32_16x16x32_bf16 v[56:59], v[164:167], a[56:59], v[56:59]
    v_mfma_f32_16x16x32_bf16 v[60:63], v[164:167], a[60:63], v[60:63]
    s_waitcnt lgkmcnt(6)
    v_mfma_f32_16x16x32_bf16 v[64:67], v[168:171], a[48:51], v[64:67]
    s_barrier
    ds_read_b64_tr_b16 v[152:153], v184 offset:16384
    v_mfma_f32_16x16x32_bf16 v[68:71], v[168:171], a[52:55], v[68:71]
    ds_read_b64_tr_b16 v[154:155], v184 offset:17408
    v_mfma_f32_16x16x32_bf16 v[72:75], v[168:171], a[56:59], v[72:75]
    v_mfma_f32_16x16x32_bf16 v[76:79], v[168:171], a[60:63], v[76:79]
    s_waitcnt lgkmcnt(6)
    v_mfma_f32_16x16x32_bf16 v[80:83], v[172:175], a[48:51], v[80:83]
    ds_read_b64_tr_b16 v[156:157], v185 offset:16384
    v_add_u32 v151, 81920, v151
    v_mfma_f32_16x16x32_bf16 v[84:87], v[172:175], a[52:55], v[84:87]
    ds_read_b64_tr_b16 v[158:159], v185 offset:17408
    v_mfma_f32_16x16x32_bf16 v[88:91], v[172:175], a[56:59], v[88:91]
    v_mfma_f32_16x16x32_bf16 v[92:95], v[172:175], a[60:63], v[92:95]
    s_waitcnt lgkmcnt(6)
    v_mfma_f32_16x16x32_bf16 v[96:99], v[176:179], a[48:51], v[96:99]
    ds_read_b64_tr_b16 v[160:161], v186 offset:16384
    v_mfma_f32_16x16x32_bf16 v[100:103], v[176:179], a[52:55], v[100:103]
    ds_read_b64_tr_b16 v[162:163], v186 offset:17408
    v_mfma_f32_16x16x32_bf16 v[104:107], v[176:179], a[56:59], v[104:107]
    v_mfma_f32_16x16x32_bf16 v[108:111], v[176:179], a[60:63], v[108:111]
    s_waitcnt lgkmcnt(6)
    v_mfma_f32_16x16x32_bf16 v[128:131], v[180:183], a[48:51], v[128:131]
    ds_read_b64_tr_b16 v[164:165], v187 offset:16384
    v_mfma_f32_16x16x32_bf16 v[132:135], v[180:183], a[52:55], v[132:135]
    ds_read_b64_tr_b16 v[166:167], v187 offset:17408
    v_mfma_f32_16x16x32_bf16 v[136:139], v[180:183], a[56:59], v[136:139]
    v_mfma_f32_16x16x32_bf16 v[140:143], v[180:183], a[60:63], v[140:143]
    s_waitcnt lgkmcnt(6)
    v_mfma_f32_16x16x32_bf16 v[112:115], v[152:155], a[64:67], v[112:115]
    ds_read_b64_tr_b16 v[168:169], v188 offset:16384
    s_mov_b32 s49, 3145728
    v_mfma_f32_16x16x32_bf16 v[116:119], v[152:155], a[68:71], v[116:119]
    ds_read_b64_tr_b16 v[170:171], v188 offset:17408
    s_add_u32 m0, s47, 114688
    v_mfma_f32_16x16x32_bf16 v[120:123], v[152:155], a[72:75], v[120:123]
    buffer_load_dwordx4 v11, s[4:7], s49 offen offset:0 lds
    v_mfma_f32_16x16x32_bf16 v[124:127], v[152:155], a[76:79], v[124:127]
    s_waitcnt lgkmcnt(6)
    v_mfma_f32_16x16x32_bf16 v[16:19], v[156:159], a[64:67], v[16:19]
    ds_read_b64_tr_b16 v[172:173], v189 offset:16384
    v_mfma_f32_16x16x32_bf16 v[20:23], v[156:159], a[68:71], v[20:23]
    ds_read_b64_tr_b16 v[174:175], v189 offset:17408
    v_mfma_f32_16x16x32_bf16 v[24:27], v[156:159], a[72:75], v[24:27]
    buffer_load_dwordx4 v12, s[4:7], s49 offen offset:1024 lds
    v_mfma_f32_16x16x32_bf16 v[28:31], v[156:159], a[76:79], v[28:31]
    s_waitcnt lgkmcnt(6)
    v_mfma_f32_16x16x32_bf16 v[32:35], v[160:163], a[64:67], v[32:35]
    ds_read_b64_tr_b16 v[176:177], v190 offset:16384
    v_mfma_f32_16x16x32_bf16 v[36:39], v[160:163], a[68:71], v[36:39]
    ds_read_b64_tr_b16 v[178:179], v190 offset:17408
    v_mfma_f32_16x16x32_bf16 v[40:43], v[160:163], a[72:75], v[40:43]
    buffer_load_dwordx4 v13, s[4:7], s49 offen offset:2048 lds
    v_mfma_f32_16x16x32_bf16 v[44:47], v[160:163], a[76:79], v[44:47]
    s_waitcnt lgkmcnt(6)
    v_mfma_f32_16x16x32_bf16 v[48:51], v[164:167], a[64:67], v[48:51]
    ds_read_b64_tr_b16 v[180:181], v191 offset:16384
    v_mfma_f32_16x16x32_bf16 v[52:55], v[164:167], a[68:71], v[52:55]
    ds_read_b64_tr_b16 v[182:183], v191 offset:17408
    v_mfma_f32_16x16x32_bf16 v[56:59], v[164:167], a[72:75], v[56:59]
    buffer_load_dwordx4 v14, s[4:7], s49 offen offset:3072 lds
    v_mfma_f32_16x16x32_bf16 v[60:63], v[164:167], a[76:79], v[60:63]
    s_add_u32 s50, s48, 12288
    s_waitcnt lgkmcnt(6)
    v_mfma_f32_16x16x32_bf16 v[64:67], v[168:171], a[64:67], v[64:67]
    ds_read_b64_tr_b16 v[152:153], v184 offset:24576
    v_mfma_f32_16x16x32_bf16 v[68:71], v[168:171], a[68:71], v[68:71]
    ds_read_b64_tr_b16 v[154:155], v184 offset:25600
    v_mfma_f32_16x16x32_bf16 v[72:75], v[168:171], a[72:75], v[72:75]
    buffer_load_dwordx4 a[160:163], v7, s[8:11], s50 offen offset:0
    v_mfma_f32_16x16x32_bf16 v[76:79], v[168:171], a[76:79], v[76:79]
    s_waitcnt lgkmcnt(6)
    v_mfma_f32_16x16x32_bf16 v[80:83], v[172:175], a[64:67], v[80:83]
    ds_read_b64_tr_b16 v[156:157], v185 offset:24576
    v_mfma_f32_16x16x32_bf16 v[84:87], v[172:175], a[68:71], v[84:87]
    ds_read_b64_tr_b16 v[158:159], v185 offset:25600
    v_mfma_f32_16x16x32_bf16 v[88:91], v[172:175], a[72:75], v[88:91]
    buffer_load_dwordx4 a[164:167], v8, s[8:11], s50 offen offset:0
    v_mfma_f32_16x16x32_bf16 v[92:95], v[172:175], a[76:79], v[92:95]
    buffer_load_dwordx4 a[168:171], v9, s[8:11], s50 offen offset:0
    s_waitcnt lgkmcnt(6)
    v_mfma_f32_16x16x32_bf16 v[96:99], v[176:179], a[64:67], v[96:99]
    ds_read_b64_tr_b16 v[160:161], v186 offset:24576
    v_mfma_f32_16x16x32_bf16 v[100:103], v[176:179], a[68:71], v[100:103]
    ds_read_b64_tr_b16 v[162:163], v186 offset:25600
    v_mfma_f32_16x16x32_bf16 v[104:107], v[176:179], a[72:75], v[104:107]
    v_mfma_f32_16x16x32_bf16 v[108:111], v[176:179], a[76:79], v[108:111]
    buffer_load_dwordx4 a[172:175], v10, s[8:11], s50 offen offset:0
    s_waitcnt lgkmcnt(6)
    v_mfma_f32_16x16x32_bf16 v[128:131], v[180:183], a[64:67], v[128:131]
    ds_read_b64_tr_b16 v[164:165], v187 offset:24576
    v_mfma_f32_16x16x32_bf16 v[132:135], v[180:183], a[68:71], v[132:135]
    ds_read_b64_tr_b16 v[166:167], v187 offset:25600
    v_mfma_f32_16x16x32_bf16 v[136:139], v[180:183], a[72:75], v[136:139]
    buffer_load_dwordx4 a[176:179], v7, s[8:11], s50 offen offset:1024
    v_mfma_f32_16x16x32_bf16 v[140:143], v[180:183], a[76:79], v[140:143]
    s_waitcnt lgkmcnt(6)
    v_mfma_f32_16x16x32_bf16 v[112:115], v[152:155], a[80:83], v[112:115]
    ds_read_b64_tr_b16 v[168:169], v188 offset:24576
    v_mfma_f32_16x16x32_bf16 v[116:119], v[152:155], a[84:87], v[116:119]
    ds_read_b64_tr_b16 v[170:171], v188 offset:25600
    v_mfma_f32_16x16x32_bf16 v[120:123], v[152:155], a[88:91], v[120:123]
    buffer_load_dwordx4 a[180:183], v8, s[8:11], s50 offen offset:1024
    v_mfma_f32_16x16x32_bf16 v[124:127], v[152:155], a[92:95], v[124:127]
    s_waitcnt lgkmcnt(6)
    v_mfma_f32_16x16x32_bf16 v[16:19], v[156:159], a[80:83], v[16:19]
    ds_read_b64_tr_b16 v[172:173], v189 offset:24576
    v_mfma_f32_16x16x32_bf16 v[20:23], v[156:159], a[84:87], v[20:23]
    ds_read_b64_tr_b16 v[174:175], v189 offset:25600
    v_mfma_f32_16x16x32_bf16 v[24:27], v[156:159], a[88:91], v[24:27]
    buffer_load_dwordx4 a[184:187], v9, s[8:11], s50 offen offset:1024
    v_mfma_f32_16x16x32_bf16 v[28:31], v[156:159], a[92:95], v[28:31]
    s_waitcnt lgkmcnt(6)
    v_mfma_f32_16x16x32_bf16 v[32:35], v[160:163], a[80:83], v[32:35]
    ds_read_b64_tr_b16 v[176:177], v190 offset:24576
    v_mfma_f32_16x16x32_bf16 v[36:39], v[160:163], a[84:87], v[36:39]
    ds_read_b64_tr_b16 v[178:179], v190 offset:25600
    v_mfma_f32_16x16x32_bf16 v[40:43], v[160:163], a[88:91], v[40:43]
    buffer_load_dwordx4 a[188:191], v10, s[8:11], s50 offen offset:1024
    v_mfma_f32_16x16x32_bf16 v[44:47], v[160:163], a[92:95], v[44:47]
    s_waitcnt lgkmcnt(6)
    v_mfma_f32_16x16x32_bf16 v[48:51], v[164:167], a[80:83], v[48:51]
    ds_read_b64_tr_b16 v[180:181], v191 offset:24576
    v_mfma_f32_16x16x32_bf16 v[52:55], v[164:167], a[84:87], v[52:55]
    ds_read_b64_tr_b16 v[182:183], v191 offset:25600
    v_mfma_f32_16x16x32_bf16 v[56:59], v[164:167], a[88:91], v[56:59]
    v_mfma_f32_16x16x32_bf16 v[60:63], v[164:167], a[92:95], v[60:63]
    s_waitcnt lgkmcnt(6)
    v_mfma_f32_16x16x32_bf16 v[64:67], v[168:171], a[80:83], v[64:67]
    s_waitcnt vmcnt(30)
    s_barrier
    ds_read_b64_tr_b16 v[152:153], v184 offset:49152
    v_mfma_f32_16x16x32_bf16 v[68:71], v[168:171], a[84:87], v[68:71]
    ds_read_b64_tr_b16 v[154:155], v184 offset:50176
    v_mfma_f32_16x16x32_bf16 v[72:75], v[168:171], a[88:91], v[72:75]
    v_mfma_f32_16x16x32_bf16 v[76:79], v[168:171], a[92:95], v[76:79]
    s_waitcnt lgkmcnt(6)
    v_mfma_f32_16x16x32_bf16 v[80:83], v[172:175], a[80:83], v[80:83]
    ds_read_b64_tr_b16 v[156:157], v185 offset:49152
    v_mfma_f32_16x16x32_bf16 v[84:87], v[172:175], a[84:87], v[84:87]
    ds_read_b64_tr_b16 v[158:159], v185 offset:50176
    v_mfma_f32_16x16x32_bf16 v[88:91], v[172:175], a[88:91], v[88:91]
    v_mfma_f32_16x16x32_bf16 v[92:95], v[172:175], a[92:95], v[92:95]
    s_waitcnt lgkmcnt(6)
    v_mfma_f32_16x16x32_bf16 v[96:99], v[176:179], a[80:83], v[96:99]
    ds_read_b64_tr_b16 v[160:161], v186 offset:49152
    v_mfma_f32_16x16x32_bf16 v[100:103], v[176:179], a[84:87], v[100:103]
    ds_read_b64_tr_b16 v[162:163], v186 offset:50176
    v_mfma_f32_16x16x32_bf16 v[104:107], v[176:179], a[88:91], v[104:107]
    v_mfma_f32_16x16x32_bf16 v[108:111], v[176:179], a[92:95], v[108:111]
    s_waitcnt lgkmcnt(6)
    v_mfma_f32_16x16x32_bf16 v[128:131], v[180:183], a[80:83], v[128:131]
    ds_read_b64_tr_b16 v[164:165], v187 offset:49152
    v_mfma_f32_16x16x32_bf16 v[132:135], v[180:183], a[84:87], v[132:135]
    ds_read_b64_tr_b16 v[166:167], v187 offset:50176
    v_mfma_f32_16x16x32_bf16 v[136:139], v[180:183], a[88:91], v[136:139]
    v_mfma_f32_16x16x32_bf16 v[140:143], v[180:183], a[92:95], v[140:143]
    s_waitcnt lgkmcnt(6)
    v_mfma_f32_16x16x32_bf16 v[112:115], v[152:155], a[96:99], v[112:115]
    ds_read_b64_tr_b16 v[168:169], v188 offset:49152
    s_mov_b32 s49, 3670016
    v_mfma_f32_16x16x32_bf16 v[116:119], v[152:155], a[100:103], v[116:119]
    ds_read_b64_tr_b16 v[170:171], v188 offset:50176
    s_add_u32 m0, s47, 49152
    v_mfma_f32_16x16x32_bf16 v[120:123], v[152:155], a[104:107], v[120:123]
    buffer_load_dwordx4 v11, s[4:7], s49 offen offset:0 lds
    v_mfma_f32_16x16x32_bf16 v[124:127], v[152:155], a[108:111], v[124:127]
    s_waitcnt lgkmcnt(6)
    v_mfma_f32_16x16x32_bf16 v[16:19], v[156:159], a[96:99], v[16:19]
    ds_read_b64_tr_b16 v[172:173], v189 offset:49152
    v_mfma_f32_16x16x32_bf16 v[20:23], v[156:159], a[100:103], v[20:23]
    ds_read_b64_tr_b16 v[174:175], v189 offset:50176
    v_mfma_f32_16x16x32_bf16 v[24:27], v[156:159], a[104:107], v[24:27]
    buffer_load_dwordx4 v12, s[4:7], s49 offen offset:1024 lds
    v_mfma_f32_16x16x32_bf16 v[28:31], v[156:159], a[108:111], v[28:31]
    s_waitcnt lgkmcnt(6)
    v_mfma_f32_16x16x32_bf16 v[32:35], v[160:163], a[96:99], v[32:35]
    ds_read_b64_tr_b16 v[176:177], v190 offset:49152
    v_mfma_f32_16x16x32_bf16 v[36:39], v[160:163], a[100:103], v[36:39]
    ds_read_b64_tr_b16 v[178:179], v190 offset:50176
    v_mfma_f32_16x16x32_bf16 v[40:43], v[160:163], a[104:107], v[40:43]
    buffer_load_dwordx4 v13, s[4:7], s49 offen offset:2048 lds
    v_mfma_f32_16x16x32_bf16 v[44:47], v[160:163], a[108:111], v[44:47]
    s_waitcnt lgkmcnt(6)
    v_mfma_f32_16x16x32_bf16 v[48:51], v[164:167], a[96:99], v[48:51]
    ds_read_b64_tr_b16 v[180:181], v191 offset:49152
    v_mfma_f32_16x16x32_bf16 v[52:55], v[164:167], a[100:103], v[52:55]
    ds_read_b64_tr_b16 v[182:183], v191 offset:50176
    v_mfma_f32_16x16x32_bf16 v[56:59], v[164:167], a[104:107], v[56:59]
    buffer_load_dwordx4 v14, s[4:7], s49 offen offset:3072 lds
    v_mfma_f32_16x16x32_bf16 v[60:63], v[164:167], a[108:111], v[60:63]
    s_add_u32 s50, s48, 14336
    s_waitcnt lgkmcnt(6)
    v_mfma_f32_16x16x32_bf16 v[64:67], v[168:171], a[96:99], v[64:67]
    ds_read_b64_tr_b16 v[152:153], v184 offset:57344
    v_mfma_f32_16x16x32_bf16 v[68:71], v[168:171], a[100:103], v[68:71]
    ds_read_b64_tr_b16 v[154:155], v184 offset:58368
    v_mfma_f32_16x16x32_bf16 v[72:75], v[168:171], a[104:107], v[72:75]
    buffer_load_dwordx4 a[192:195], v7, s[8:11], s50 offen offset:0
    v_mfma_f32_16x16x32_bf16 v[76:79], v[168:171], a[108:111], v[76:79]
    s_waitcnt lgkmcnt(6)
    v_mfma_f32_16x16x32_bf16 v[80:83], v[172:175], a[96:99], v[80:83]
    ds_read_b64_tr_b16 v[156:157], v185 offset:57344
    v_mfma_f32_16x16x32_bf16 v[84:87], v[172:175], a[100:103], v[84:87]
    ds_read_b64_tr_b16 v[158:159], v185 offset:58368
    v_mfma_f32_16x16x32_bf16 v[88:91], v[172:175], a[104:107], v[88:91]
    buffer_load_dwordx4 a[196:199], v8, s[8:11], s50 offen offset:0
    v_mfma_f32_16x16x32_bf16 v[92:95], v[172:175], a[108:111], v[92:95]
    buffer_load_dwordx4 a[200:203], v9, s[8:11], s50 offen offset:0
    s_waitcnt lgkmcnt(6)
    v_mfma_f32_16x16x32_bf16 v[96:99], v[176:179], a[96:99], v[96:99]
    ds_read_b64_tr_b16 v[160:161], v186 offset:57344
    v_mfma_f32_16x16x32_bf16 v[100:103], v[176:179], a[100:103], v[100:103]
    ds_read_b64_tr_b16 v[162:163], v186 offset:58368
    v_mfma_f32_16x16x32_bf16 v[104:107], v[176:179], a[104:107], v[104:107]
    v_mfma_f32_16x16x32_bf16 v[108:111], v[176:179], a[108:111], v[108:111]
    buffer_load_dwordx4 a[204:207], v10, s[8:11], s50 offen offset:0
    s_waitcnt lgkmcnt(6)
    v_mfma_f32_16x16x32_bf16 v[128:131], v[180:183], a[96:99], v[128:131]
    ds_read_b64_tr_b16 v[164:165], v187 offset:57344
    v_mfma_f32_16x16x32_bf16 v[132:135], v[180:183], a[100:103], v[132:135]
    ds_read_b64_tr_b16 v[166:167], v187 offset:58368
    v_mfma_f32_16x16x32_bf16 v[136:139], v[180:183], a[104:107], v[136:139]
    buffer_load_dwordx4 a[208:211], v7, s[8:11], s50 offen offset:1024
    v_mfma_f32_16x16x32_bf16 v[140:143], v[180:183], a[108:111], v[140:143]
    s_waitcnt vmcnt(35) lgkmcnt(6)
    v_mfma_f32_16x16x32_bf16 v[112:115], v[152:155], a[112:115], v[112:115]
    ds_read_b64_tr_b16 v[168:169], v188 offset:57344
    v_mfma_f32_16x16x32_bf16 v[116:119], v[152:155], a[116:119], v[116:119]
    ds_read_b64_tr_b16 v[170:171], v188 offset:58368
    v_mfma_f32_16x16x32_bf16 v[120:123], v[152:155], a[120:123], v[120:123]
    buffer_load_dwordx4 a[212:215], v8, s[8:11], s50 offen offset:1024
    v_mfma_f32_16x16x32_bf16 v[124:127], v[152:155], a[124:127], v[124:127]
    s_waitcnt lgkmcnt(6)
    v_mfma_f32_16x16x32_bf16 v[16:19], v[156:159], a[112:115], v[16:19]
    ds_read_b64_tr_b16 v[172:173], v189 offset:57344
    v_mfma_f32_16x16x32_bf16 v[20:23], v[156:159], a[116:119], v[20:23]
    ds_read_b64_tr_b16 v[174:175], v189 offset:58368
    v_mfma_f32_16x16x32_bf16 v[24:27], v[156:159], a[120:123], v[24:27]
    buffer_load_dwordx4 a[216:219], v9, s[8:11], s50 offen offset:1024
    v_mfma_f32_16x16x32_bf16 v[28:31], v[156:159], a[124:127], v[28:31]
    s_waitcnt lgkmcnt(6)
    v_mfma_f32_16x16x32_bf16 v[32:35], v[160:163], a[112:115], v[32:35]
    ds_read_b64_tr_b16 v[176:177], v190 offset:57344
    v_mfma_f32_16x16x32_bf16 v[36:39], v[160:163], a[116:119], v[36:39]
    ds_read_b64_tr_b16 v[178:179], v190 offset:58368
    v_mfma_f32_16x16x32_bf16 v[40:43], v[160:163], a[120:123], v[40:43]
    buffer_load_dwordx4 a[220:223], v10, s[8:11], s50 offen offset:1024
    v_mfma_f32_16x16x32_bf16 v[44:47], v[160:163], a[124:127], v[44:47]
    s_waitcnt lgkmcnt(6)
    v_mfma_f32_16x16x32_bf16 v[48:51], v[164:167], a[112:115], v[48:51]
    ds_read_b64_tr_b16 v[180:181], v191 offset:57344
    v_mfma_f32_16x16x32_bf16 v[52:55], v[164:167], a[116:119], v[52:55]
    ds_read_b64_tr_b16 v[182:183], v191 offset:58368
    buffer_load_dword v224, v230, s[64:67], 0 offen offset:48 sc0 sc1
    v_mfma_f32_16x16x32_bf16 v[56:59], v[164:167], a[120:123], v[56:59]
    v_mfma_f32_16x16x32_bf16 v[60:63], v[164:167], a[124:127], v[60:63]
    s_waitcnt lgkmcnt(6)
    v_mfma_f32_16x16x32_bf16 v[64:67], v[168:171], a[112:115], v[64:67]
    s_waitcnt vmcnt(29)
    s_barrier
    ds_read_b64_tr_b16 v[152:153], v144 offset:49152
    v_mfma_f32_16x16x32_bf16 v[68:71], v[168:171], a[116:119], v[68:71]
    ds_read_b64_tr_b16 v[154:155], v144 offset:50176
    v_mfma_f32_16x16x32_bf16 v[72:75], v[168:171], a[120:123], v[72:75]
    v_mfma_f32_16x16x32_bf16 v[76:79], v[168:171], a[124:127], v[76:79]
    s_waitcnt lgkmcnt(6)
    v_mfma_f32_16x16x32_bf16 v[80:83], v[172:175], a[112:115], v[80:83]
    ds_read_b64_tr_b16 v[156:157], v145 offset:49152
    v_mfma_f32_16x16x32_bf16 v[84:87], v[172:175], a[116:119], v[84:87]
    ds_read_b64_tr_b16 v[158:159], v145 offset:50176
    v_mfma_f32_16x16x32_bf16 v[88:91], v[172:175], a[120:123], v[88:91]
    v_mfma_f32_16x16x32_bf16 v[92:95], v[172:175], a[124:127], v[92:95]
    s_waitcnt lgkmcnt(6)
    v_mfma_f32_16x16x32_bf16 v[96:99], v[176:179], a[112:115], v[96:99]
    ds_read_b64_tr_b16 v[160:161], v146 offset:49152
    v_mfma_f32_16x16x32_bf16 v[100:103], v[176:179], a[116:119], v[100:103]
    ds_read_b64_tr_b16 v[162:163], v146 offset:50176
    v_mfma_f32_16x16x32_bf16 v[104:107], v[176:179], a[120:123], v[104:107]
    v_mfma_f32_16x16x32_bf16 v[108:111], v[176:179], a[124:127], v[108:111]
    s_waitcnt lgkmcnt(6)
    v_mfma_f32_16x16x32_bf16 v[128:131], v[180:183], a[112:115], v[128:131]
    ds_read_b64_tr_b16 v[164:165], v147 offset:49152
    v_mfma_f32_16x16x32_bf16 v[132:135], v[180:183], a[116:119], v[132:135]
    ds_read_b64_tr_b16 v[166:167], v147 offset:50176
    v_mfma_f32_16x16x32_bf16 v[136:139], v[180:183], a[120:123], v[136:139]
    v_mfma_f32_16x16x32_bf16 v[140:143], v[180:183], a[124:127], v[140:143]
    s_waitcnt lgkmcnt(6)
    v_mfma_f32_16x16x32_bf16 v[112:115], v[152:155], a[128:131], v[112:115]
    ds_read_b64_tr_b16 v[168:169], v148 offset:49152
    s_mov_b32 s49, 4194304
    v_mfma_f32_16x16x32_bf16 v[116:119], v[152:155], a[132:135], v[116:119]
    ds_read_b64_tr_b16 v[170:171], v148 offset:50176
    s_add_u32 m0, s47, 65536
    v_mfma_f32_16x16x32_bf16 v[120:123], v[152:155], a[136:139], v[120:123]
    buffer_load_dwordx4 v11, s[4:7], s49 offen offset:0 lds
    v_mfma_f32_16x16x32_bf16 v[124:127], v[152:155], a[140:143], v[124:127]
    v_subrev_u32 v184, 65536, v184
    s_waitcnt lgkmcnt(6)
    v_mfma_f32_16x16x32_bf16 v[16:19], v[156:159], a[128:131], v[16:19]
    ds_read_b64_tr_b16 v[172:173], v149 offset:49152
    v_accvgpr_write_b32 a0, 0
    v_mfma_f32_16x16x32_bf16 v[20:23], v[156:159], a[132:135], v[20:23]
    ds_read_b64_tr_b16 v[174:175], v149 offset:50176
    v_accvgpr_write_b32 a1, 0
    v_mfma_f32_16x16x32_bf16 v[24:27], v[156:159], a[136:139], v[24:27]
    buffer_load_dwordx4 v12, s[4:7], s49 offen offset:1024 lds
    v_mfma_f32_16x16x32_bf16 v[28:31], v[156:159], a[140:143], v[28:31]
    v_accvgpr_write_b32 a2, 0
    v_accvgpr_write_b32 a3, 0
    s_waitcnt lgkmcnt(6)
    v_mfma_f32_16x16x32_bf16 v[32:35], v[160:163], a[128:131], v[32:35]
    ds_read_b64_tr_b16 v[176:177], v150 offset:49152
    v_subrev_u32 v185, 65536, v185
    v_mfma_f32_16x16x32_bf16 v[36:39], v[160:163], a[132:135], v[36:39]
    ds_read_b64_tr_b16 v[178:179], v150 offset:50176
    v_accvgpr_write_b32 a4, 0
    v_mfma_f32_16x16x32_bf16 v[40:43], v[160:163], a[136:139], v[40:43]
    buffer_load_dwordx4 v13, s[4:7], s49 offen offset:2048 lds
    v_mfma_f32_16x16x32_bf16 v[44:47], v[160:163], a[140:143], v[44:47]
    v_accvgpr_write_b32 a5, 0
    v_accvgpr_write_b32 a6, 0
    s_waitcnt lgkmcnt(6)
    v_mfma_f32_16x16x32_bf16 v[48:51], v[164:167], a[128:131], v[48:51]
    ds_read_b64_tr_b16 v[180:181], v151 offset:49152
    v_accvgpr_write_b32 a7, 0
    v_mfma_f32_16x16x32_bf16 v[52:55], v[164:167], a[132:135], v[52:55]
    ds_read_b64_tr_b16 v[182:183], v151 offset:50176
    v_accvgpr_write_b32 a8, 0
    v_mfma_f32_16x16x32_bf16 v[56:59], v[164:167], a[136:139], v[56:59]
    buffer_load_dwordx4 v14, s[4:7], s49 offen offset:3072 lds
    v_mfma_f32_16x16x32_bf16 v[60:63], v[164:167], a[140:143], v[60:63]
    s_add_u32 s50, s48, 16384
    v_accvgpr_write_b32 a9, 0
    s_waitcnt lgkmcnt(6)
    v_mfma_f32_16x16x32_bf16 v[64:67], v[168:171], a[128:131], v[64:67]
    ds_read_b64_tr_b16 v[152:153], v144 offset:57344
    v_subrev_u32 v186, 65536, v186
    v_mfma_f32_16x16x32_bf16 v[68:71], v[168:171], a[132:135], v[68:71]
    ds_read_b64_tr_b16 v[154:155], v144 offset:58368
    v_accvgpr_write_b32 a10, 0
    v_mfma_f32_16x16x32_bf16 v[72:75], v[168:171], a[136:139], v[72:75]
    buffer_load_dwordx4 a[224:227], v7, s[8:11], s50 offen offset:0
    v_mfma_f32_16x16x32_bf16 v[76:79], v[168:171], a[140:143], v[76:79]
    s_waitcnt lgkmcnt(6)
    v_mfma_f32_16x16x32_bf16 v[80:83], v[172:175], a[128:131], v[80:83]
    ds_read_b64_tr_b16 v[156:157], v145 offset:57344
    v_accvgpr_write_b32 a11, 0
    v_mfma_f32_16x16x32_bf16 v[84:87], v[172:175], a[132:135], v[84:87]
    ds_read_b64_tr_b16 v[158:159], v145 offset:58368
    v_accvgpr_write_b32 a12, 0
    v_mfma_f32_16x16x32_bf16 v[88:91], v[172:175], a[136:139], v[88:91]
    buffer_load_dwordx4 a[228:231], v8, s[8:11], s50 offen offset:0
    v_mfma_f32_16x16x32_bf16 v[92:95], v[172:175], a[140:143], v[92:95]
    buffer_load_dwordx4 a[232:235], v9, s[8:11], s50 offen offset:0
    s_waitcnt lgkmcnt(6)
    v_mfma_f32_16x16x32_bf16 v[96:99], v[176:179], a[128:131], v[96:99]
    ds_read_b64_tr_b16 v[160:161], v146 offset:57344
    v_accvgpr_write_b32 a13, 0
    v_mfma_f32_16x16x32_bf16 v[100:103], v[176:179], a[132:135], v[100:103]
    ds_read_b64_tr_b16 v[162:163], v146 offset:58368
    v_accvgpr_write_b32 a14, 0
    v_mfma_f32_16x16x32_bf16 v[104:107], v[176:179], a[136:139], v[104:107]
    v_accvgpr_write_b32 a15, 0
    v_accvgpr_write_b32 a16, 0
    v_mfma_f32_16x16x32_bf16 v[108:111], v[176:179], a[140:143], v[108:111]
    buffer_load_dwordx4 a[236:239], v10, s[8:11], s50 offen offset:0
    s_waitcnt lgkmcnt(6)
    v_mfma_f32_16x16x32_bf16 v[128:131], v[180:183], a[128:131], v[128:131]
    ds_read_b64_tr_b16 v[164:165], v147 offset:57344
    v_subrev_u32 v187, 65536, v187
    v_mfma_f32_16x16x32_bf16 v[132:135], v[180:183], a[132:135], v[132:135]
    ds_read_b64_tr_b16 v[166:167], v147 offset:58368
    v_accvgpr_write_b32 a17, 0
    v_mfma_f32_16x16x32_bf16 v[136:139], v[180:183], a[136:139], v[136:139]
    buffer_load_dwordx4 a[240:243], v7, s[8:11], s50 offen offset:1024
    v_mfma_f32_16x16x32_bf16 v[140:143], v[180:183], a[140:143], v[140:143]
    v_accvgpr_write_b32 a18, 0
    v_accvgpr_write_b32 a19, 0
    s_waitcnt vmcnt(34) lgkmcnt(6)
    v_mfma_f32_16x16x32_bf16 v[112:115], v[152:155], a[144:147], v[112:115]
    ds_read_b64_tr_b16 v[168:169], v148 offset:57344
    v_accvgpr_write_b32 a20, 0
    v_mfma_f32_16x16x32_bf16 v[116:119], v[152:155], a[148:151], v[116:119]
    ds_read_b64_tr_b16 v[170:171], v148 offset:58368
    v_accvgpr_write_b32 a21, 0
    v_mfma_f32_16x16x32_bf16 v[120:123], v[152:155], a[152:155], v[120:123]
    buffer_load_dwordx4 a[244:247], v8, s[8:11], s50 offen offset:1024
    v_mfma_f32_16x16x32_bf16 v[124:127], v[152:155], a[156:159], v[124:127]
    s_waitcnt lgkmcnt(6)
    v_mfma_f32_16x16x32_bf16 v[16:19], v[156:159], a[144:147], v[16:19]
    ds_read_b64_tr_b16 v[172:173], v149 offset:57344
    s_waitcnt vmcnt(10)
    v_mfma_f32_16x16x32_bf16 v[20:23], v[156:159], a[148:151], v[20:23]
    ds_read_b64_tr_b16 v[174:175], v149 offset:58368
    v_cmp_eq_u32 vcc, 3, v224
    s_cmp_eq_u32 s24, 0
    s_cselect_b32 s51, vcc_lo, -1
    s_and_b32 s51, s51, 65535
    s_cmp_eq_u32 s51, 65535
    s_cbranch_scc0 KM_SPK
KM_RTK:
    v_mfma_f32_16x16x32_bf16 v[24:27], v[156:159], a[152:155], v[24:27]
    buffer_load_dwordx4 a[248:251], v9, s[8:11], s50 offen offset:1024
    v_mfma_f32_16x16x32_bf16 v[28:31], v[156:159], a[156:159], v[28:31]
    v_accvgpr_write_b32 a22, 0
    v_accvgpr_write_b32 a23, 0
    s_waitcnt lgkmcnt(6)
    v_mfma_f32_16x16x32_bf16 v[32:35], v[160:163], a[144:147], v[32:35]
    ds_read_b64_tr_b16 v[176:177], v150 offset:57344
    v_subrev_u32 v188, 65536, v188
    v_mfma_f32_16x16x32_bf16 v[36:39], v[160:163], a[148:151], v[36:39]
    ds_read_b64_tr_b16 v[178:179], v150 offset:58368
    v_accvgpr_write_b32 a24, 0
    v_mfma_f32_16x16x32_bf16 v[40:43], v[160:163], a[152:155], v[40:43]
    buffer_load_dwordx4 a[252:255], v10, s[8:11], s50 offen offset:1024
    v_mfma_f32_16x16x32_bf16 v[44:47], v[160:163], a[156:159], v[44:47]
    v_accvgpr_write_b32 a25, 0
    v_accvgpr_write_b32 a26, 0
    s_waitcnt lgkmcnt(6)
    v_mfma_f32_16x16x32_bf16 v[48:51], v[164:167], a[144:147], v[48:51]
    ds_read_b64_tr_b16 v[180:181], v151 offset:57344
    v_accvgpr_write_b32 a27, 0
    v_mfma_f32_16x16x32_bf16 v[52:55], v[164:167], a[148:151], v[52:55]
    ds_read_b64_tr_b16 v[182:183], v151 offset:58368
    v_accvgpr_write_b32 a28, 0
    v_mfma_f32_16x16x32_bf16 v[56:59], v[164:167], a[152:155], v[56:59]
    v_accvgpr_write_b32 a29, 0
    v_accvgpr_write_b32 a30, 0
    v_mfma_f32_16x16x32_bf16 v[60:63], v[164:167], a[156:159], v[60:63]
    s_waitcnt lgkmcnt(6)
    v_mfma_f32_16x16x32_bf16 v[64:67], v[168:171], a[144:147], v[64:67]
    s_barrier
    ds_read_b64_tr_b16 v[152:153], v144 offset:16384
    v_subrev_u32 v189, 65536, v189
    v_mfma_f32_16x16x32_bf16 v[68:71], v[168:171], a[148:151], v[68:71]
    ds_read_b64_tr_b16 v[154:155], v144 offset:17408
    v_accvgpr_write_b32 a31, 0
    v_mfma_f32_16x16x32_bf16 v[72:75], v[168:171], a[152:155], v[72:75]
    v_mfma_f32_16x16x32_bf16 v[76:79], v[168:171], a[156:159], v[76:79]
    v_accvgpr_write_b32 a32, 0
    v_accvgpr_write_b32 a33, 0
    s_waitcnt lgkmcnt(6)
    v_mfma_f32_16x16x32_bf16 v[80:83], v[172:175], a[144:147], v[80:83]
    ds_read_b64_tr_b16 v[156:157], v145 offset:16384
    v_accvgpr_write_b32 a34, 0
    v_mfma_f32_16x16x32_bf16 v[84:87], v[172:175], a[148:151], v[84:87]
    ds_read_b64_tr_b16 v[158:159], v145 offset:17408
    v_accvgpr_write_b32 a35, 0
    v_mfma_f32_16x16x32_bf16 v[88:91], v[172:175], a[152:155], v[88:91]
    v_mfma_f32_16x16x32_bf16 v[92:95], v[172:175], a[156:159], v[92:95]
    s_waitcnt lgkmcnt(6)
    v_mfma_f32_16x16x32_bf16 v[96:99], v[176:179], a[144:147], v[96:99]
    ds_read_b64_tr_b16 v[160:161], v146 offset:16384
    v_subrev_u32 v190, 65536, v190
    v_mfma_f32_16x16x32_bf16 v[100:103], v[176:179], a[148:151], v[100:103]
    ds_read_b64_tr_b16 v[162:163], v146 offset:17408
    v_accvgpr_write_b32 a36, 0
    v_mfma_f32_16x16x32_bf16 v[104:107], v[176:179], a[152:155], v[104:107]
    v_accvgpr_write_b32 a37, 0
    v_accvgpr_write_b32 a38, 0
    v_mfma_f32_16x16x32_bf16 v[108:111], v[176:179], a[156:159], v[108:111]
    s_waitcnt lgkmcnt(6)
    v_mfma_f32_16x16x32_bf16 v[128:131], v[180:183], a[144:147], v[128:131]
    ds_read_b64_tr_b16 v[164:165], v147 offset:16384
    v_accvgpr_write_b32 a39, 0
    v_mfma_f32_16x16x32_bf16 v[132:135], v[180:183], a[148:151], v[132:135]
    ds_read_b64_tr_b16 v[166:167], v147 offset:17408
    v_accvgpr_write_b32 a40, 0
    v_mfma_f32_16x16x32_bf16 v[136:139], v[180:183], a[152:155], v[136:139]
    v_mfma_f32_16x16x32_bf16 v[140:143], v[180:183], a[156:159], v[140:143]
    s_waitcnt lgkmcnt(6)
    v_mfma_f32_16x16x32_bf16 v[112:115], v[152:155], a[160:163], v[112:115]
    ds_read_b64_tr_b16 v[168:169], v148 offset:16384
    s_add_u32 s49, s47, 524288
    v_mfma_f32_16x16x32_bf16 v[116:119], v[152:155], a[164:167], v[116:119]
    ds_read_b64_tr_b16 v[170:171], v148 offset:17408
    s_add_u32 m0, s47, 0
    v_mfma_f32_16x16x32_bf16 v[120:123], v[152:155], a[168:171], v[120:123]
    buffer_load_dwordx4 v1, s[12:15], s49 offen offset:0 lds
    v_mfma_f32_16x16x32_bf16 v[124:127], v[152:155], a[172:175], v[124:127]
    v_accvgpr_write_b32 a41, 0
    v_accvgpr_write_b32 a42, 0
    s_waitcnt lgkmcnt(6)
    v_mfma_f32_16x16x32_bf16 v[16:19], v[156:159], a[160:163], v[16:19]
    ds_read_b64_tr_b16 v[172:173], v149 offset:16384
    v_subrev_u32 v191, 65536, v191
    v_mfma_f32_16x16x32_bf16 v[20:23], v[156:159], a[164:167], v[20:23]
    ds_read_b64_tr_b16 v[174:175], v149 offset:17408
    v_accvgpr_write_b32 a43, 0
    v_mfma_f32_16x16x32_bf16 v[24:27], v[156:159], a[168:171], v[24:27]
    buffer_load_dwordx4 v1, s[12:15], s49 offen offset:1024 lds
    v_mfma_f32_16x16x32_bf16 v[28:31], v[156:159], a[172:175], v[28:31]
    v_accvgpr_write_b32 a44, 0
    v_accvgpr_write_b32 a45, 0
    s_waitcnt lgkmcnt(6)
    v_mfma_f32_16x16x32_bf16 v[32:35], v[160:163], a[160:163], v[32:35]
    ds_read_b64_tr_b16 v[176:177], v150 offset:16384
    v_accvgpr_write_b32 a46, 0
    v_mfma_f32_16x16x32_bf16 v[36:39], v[160:163], a[164:167], v[36:39]
    ds_read_b64_tr_b16 v[178:179], v150 offset:17408
    v_accvgpr_write_b32 a47, 0
    v_mfma_f32_16x16x32_bf16 v[40:43], v[160:163], a[168:171], v[40:43]
    buffer_load_dwordx4 v1, s[12:15], s49 offen offset:2048 lds
    v_mfma_f32_16x16x32_bf16 v[44:47], v[160:163], a[172:175], v[44:47]
    v_accvgpr_write_b32 a48, 0
    v_accvgpr_write_b32 a49, 0
    s_waitcnt lgkmcnt(6)
    v_mfma_f32_16x16x32_bf16 v[48:51], v[164:167], a[160:163], v[48:51]
    ds_read_b64_tr_b16 v[180:181], v151 offset:16384
    v_accvgpr_write_b32 a50, 0
    v_mfma_f32_16x16x32_bf16 v[52:55], v[164:167], a[164:167], v[52:55]
    ds_read_b64_tr_b16 v[182:183], v151 offset:17408
    v_accvgpr_write_b32 a51, 0
    v_mfma_f32_16x16x32_bf16 v[56:59], v[164:167], a[168:171], v[56:59]
    buffer_load_dwordx4 v1, s[12:15], s49 offen offset:3072 lds
    v_mfma_f32_16x16x32_bf16 v[60:63], v[164:167], a[172:175], v[60:63]
    s_add_u32 m0, s42, s43
    v_accvgpr_write_b32 a52, 0
    s_waitcnt lgkmcnt(6)
    v_mfma_f32_16x16x32_bf16 v[64:67], v[168:171], a[160:163], v[64:67]
    ds_read_b64_tr_b16 v[152:153], v144 offset:24576
    v_accvgpr_write_b32 a53, 0
    v_mfma_f32_16x16x32_bf16 v[68:71], v[168:171], a[164:167], v[68:71]
    ds_read_b64_tr_b16 v[154:155], v144 offset:25600
    v_accvgpr_write_b32 a54, 0
    v_mfma_f32_16x16x32_bf16 v[72:75], v[168:171], a[168:171], v[72:75]
    buffer_load_dwordx4 v1, s[12:15], s40 offen offset:0 lds
    v_mfma_f32_16x16x32_bf16 v[76:79], v[168:171], a[172:175], v[76:79]
    buffer_load_dwordx4 v1, s[12:15], s40 offen offset:1024 lds
    s_waitcnt lgkmcnt(6)
    v_mfma_f32_16x16x32_bf16 v[80:83], v[172:175], a[160:163], v[80:83]
    ds_read_b64_tr_b16 v[156:157], v145 offset:24576
    v_accvgpr_write_b32 a55, 0
    v_mfma_f32_16x16x32_bf16 v[84:87], v[172:175], a[164:167], v[84:87]
    ds_read_b64_tr_b16 v[158:159], v145 offset:25600
    v_accvgpr_write_b32 a56, 0
    v_mfma_f32_16x16x32_bf16 v[88:91], v[172:175], a[168:171], v[88:91]
    v_mfma_f32_16x16x32_bf16 v[92:95], v[172:175], a[172:175], v[92:95]
    buffer_load_dwordx4 v1, s[12:15], s40 offen offset:2048 lds
    s_waitcnt lgkmcnt(6)
    v_mfma_f32_16x16x32_bf16 v[96:99], v[176:179], a[160:163], v[96:99]
    ds_read_b64_tr_b16 v[160:161], v146 offset:24576
    v_accvgpr_write_b32 a57, 0
    v_mfma_f32_16x16x32_bf16 v[100:103], v[176:179], a[164:167], v[100:103]
    ds_read_b64_tr_b16 v[162:163], v146 offset:25600
    v_accvgpr_write_b32 a58, 0
    v_mfma_f32_16x16x32_bf16 v[104:107], v[176:179], a[168:171], v[104:107]
    buffer_load_dwordx4 v1, s[12:15], s40 offen offset:3072 lds
    v_mfma_f32_16x16x32_bf16 v[108:111], v[176:179], a[172:175], v[108:111]
    v_accvgpr_write_b32 a59, 0
    v_accvgpr_write_b32 a60, 0
    s_waitcnt lgkmcnt(6)
    v_mfma_f32_16x16x32_bf16 v[128:131], v[180:183], a[160:163], v[128:131]
    ds_read_b64_tr_b16 v[164:165], v147 offset:24576
    s_add_u32 m0, m0, 4096
    v_mfma_f32_16x16x32_bf16 v[132:135], v[180:183], a[164:167], v[132:135]
    ds_read_b64_tr_b16 v[166:167], v147 offset:25600
    v_accvgpr_write_b32 a61, 0
    v_mfma_f32_16x16x32_bf16 v[136:139], v[180:183], a[168:171], v[136:139]
    buffer_load_dwordx4 v2, s[12:15], s40 offen offset:0 lds
    v_mfma_f32_16x16x32_bf16 v[140:143], v[180:183], a[172:175], v[140:143]
    v_accvgpr_write_b32 a62, 0
    v_accvgpr_write_b32 a63, 0
    s_waitcnt lgkmcnt(6)
    v_mfma_f32_16x16x32_bf16 v[112:115], v[152:155], a[176:179], v[112:115]
    ds_read_b64_tr_b16 v[168:169], v148 offset:24576
    v_accvgpr_write_b32 a64, 0
    v_mfma_f32_16x16x32_bf16 v[116:119], v[152:155], a[180:183], v[116:119]
    ds_read_b64_tr_b16 v[170:171], v148 offset:25600
    v_accvgpr_write_b32 a65, 0
    v_mfma_f32_16x16x32_bf16 v[120:123], v[152:155], a[184:187], v[120:123]
    buffer_load_dwordx4 v2, s[12:15], s40 offen offset:1024 lds
    v_mfma_f32_16x16x32_bf16 v[124:127], v[152:155], a[188:191], v[124:127]
    s_waitcnt lgkmcnt(6)
    v_mfma_f32_16x16x32_bf16 v[16:19], v[156:159], a[176:179], v[16:19]
    ds_read_b64_tr_b16 v[172:173], v149 offset:24576
    v_accvgpr_write_b32 a66, 0
    v_mfma_f32_16x16x32_bf16 v[20:23], v[156:159], a[180:183], v[20:23]
    ds_read_b64_tr_b16 v[174:175], v149 offset:25600
    v_accvgpr_write_b32 a67, 0
    v_mfma_f32_16x16x32_bf16 v[24:27], v[156:159], a[184:187], v[24:27]
    buffer_load_dwordx4 v2, s[12:15], s40 offen offset:2048 lds
    v_mfma_f32_16x16x32_bf16 v[28:31], v[156:159], a[188:191], v[28:31]
    v_accvgpr_write_b32 a68, 0
    v_accvgpr_write_b32 a69, 0
    s_waitcnt lgkmcnt(6)
    v_mfma_f32_16x16x32_bf16 v[32:35], v[160:163], a[176:179], v[32:35]
    ds_read_b64_tr_b16 v[176:177], v150 offset:24576
    v_accvgpr_write_b32 a70, 0
    v_mfma_f32_16x16x32_bf16 v[36:39], v[160:163], a[180:183], v[36:39]
    ds_read_b64_tr_b16 v[178:179], v150 offset:25600
    v_accvgpr_write_b32 a71, 0
    v_mfma_f32_16x16x32_bf16 v[40:43], v[160:163], a[184:187], v[40:43]
    buffer_load_dwordx4 v2, s[12:15], s40 offen offset:3072 lds
    v_mfma_f32_16x16x32_bf16 v[44:47], v[160:163], a[188:191], v[44:47]
    s_waitcnt lgkmcnt(6)
    v_mfma_f32_16x16x32_bf16 v[48:51], v[164:167], a[176:179], v[48:51]
    ds_read_b64_tr_b16 v[180:181], v151 offset:24576
    v_accvgpr_write_b32 a72, 0
    v_mfma_f32_16x16x32_bf16 v[52:55], v[164:167], a[180:183], v[52:55]
    ds_read_b64_tr_b16 v[182:183], v151 offset:25600
    v_accvgpr_write_b32 a73, 0
    v_mfma_f32_16x16x32_bf16 v[56:59], v[164:167], a[184:187], v[56:59]
    v_mfma_f32_16x16x32_bf16 v[60:63], v[164:167], a[188:191], v[60:63]
    s_waitcnt lgkmcnt(6)
    v_mfma_f32_16x16x32_bf16 v[64:67], v[168:171], a[176:179], v[64:67]
    s_barrier
    ds_read_b64_tr_b16 v[152:153], v184 offset:32768
    v_accvgpr_write_b32 a74, 0
    v_mfma_f32_16x16x32_bf16 v[68:71], v[168:171], a[180:183], v[68:71]
    ds_read_b64_tr_b16 v[154:155], v184 offset:33792
    v_accvgpr_write_b32 a75, 0
    v_mfma_f32_16x16x32_bf16 v[72:75], v[168:171], a[184:187], v[72:75]
    v_mfma_f32_16x16x32_bf16 v[76:79], v[168:171], a[188:191], v[76:79]
    v_accvgpr_write_b32 a76, 0
    v_accvgpr_write_b32 a77, 0
    s_waitcnt lgkmcnt(6)
    v_mfma_f32_16x16x32_bf16 v[80:83], v[172:175], a[176:179], v[80:83]
    ds_read_b64_tr_b16 v[156:157], v185 offset:32768
    v_accvgpr_write_b32 a78, 0
    v_mfma_f32_16x16x32_bf16 v[84:87], v[172:175], a[180:183], v[84:87]
    ds_read_b64_tr_b16 v[158:159], v185 offset:33792
    v_accvgpr_write_b32 a79, 0
    v_mfma_f32_16x16x32_bf16 v[88:91], v[172:175], a[184:187], v[88:91]
    v_mfma_f32_16x16x32_bf16 v[92:95], v[172:175], a[188:191], v[92:95]
    s_waitcnt lgkmcnt(6)
    v_mfma_f32_16x16x32_bf16 v[96:99], v[176:179], a[176:179], v[96:99]
    ds_read_b64_tr_b16 v[160:161], v186 offset:32768
    v_accvgpr_write_b32 a80, 0
    v_mfma_f32_16x16x32_bf16 v[100:103], v[176:179], a[180:183], v[100:103]
    ds_read_b64_tr_b16 v[162:163], v186 offset:33792
    v_accvgpr_write_b32 a81, 0
    v_mfma_f32_16x16x32_bf16 v[104:107], v[176:179], a[184:187], v[104:107]
    v_mfma_f32_16x16x32_bf16 v[108:111], v[176:179], a[188:191], v[108:111]
    s_waitcnt lgkmcnt(6)
    v_mfma_f32_16x16x32_bf16 v[128:131], v[180:183], a[176:179], v[128:131]
    ds_read_b64_tr_b16 v[164:165], v187 offset:32768
    v_accvgpr_write_b32 a82, 0
    v_mfma_f32_16x16x32_bf16 v[132:135], v[180:183], a[180:183], v[132:135]
    ds_read_b64_tr_b16 v[166:167], v187 offset:33792
    v_accvgpr_write_b32 a83, 0
    v_mfma_f32_16x16x32_bf16 v[136:139], v[180:183], a[184:187], v[136:139]
    v_mfma_f32_16x16x32_bf16 v[140:143], v[180:183], a[188:191], v[140:143]
    v_accvgpr_write_b32 a84, 0
    v_accvgpr_write_b32 a85, 0
    s_waitcnt lgkmcnt(6)
    v_mfma_f32_16x16x32_bf16 v[112:115], v[152:155], a[192:195], v[112:115]
    ds_read_b64_tr_b16 v[168:169], v188 offset:32768
    v_accvgpr_write_b32 a86, 0
    v_mfma_f32_16x16x32_bf16 v[116:119], v[152:155], a[196:199], v[116:119]
    ds_read_b64_tr_b16 v[170:171], v188 offset:33792
    v_accvgpr_write_b32 a87, 0
    v_mfma_f32_16x16x32_bf16 v[120:123], v[152:155], a[200:203], v[120:123]
    v_mfma_f32_16x16x32_bf16 v[124:127], v[152:155], a[204:207], v[124:127]
    s_waitcnt lgkmcnt(6)
    v_mfma_f32_16x16x32_bf16 v[16:19], v[156:159], a[192:195], v[16:19]
    ds_read_b64_tr_b16 v[172:173], v189 offset:32768
    v_accvgpr_write_b32 a88, 0
    v_mfma_f32_16x16x32_bf16 v[20:23], v[156:159], a[196:199], v[20:23]
    ds_read_b64_tr_b16 v[174:175], v189 offset:33792
    v_accvgpr_write_b32 a89, 0
    v_mfma_f32_16x16x32_bf16 v[24:27], v[156:159], a[200:203], v[24:27]
    v_add_u32 v7, s56, v1
    v_add_u32 v8, s57, v1
    v_mfma_f32_16x16x32_bf16 v[28:31], v[156:159], a[204:207], v[28:31]
    s_waitcnt lgkmcnt(6)
    v_mfma_f32_16x16x32_bf16 v[32:35], v[160:163], a[192:195], v[32:35]
    ds_read_b64_tr_b16 v[176:177], v190 offset:32768
    v_accvgpr_write_b32 a90, 0
    v_mfma_f32_16x16x32_bf16 v[36:39], v[160:163], a[196:199], v[36:39]
    ds_read_b64_tr_b16 v[178:179], v190 offset:33792
    v_accvgpr_write_b32 a91, 0
    v_mfma_f32_16x16x32_bf16 v[40:43], v[160:163], a[200:203], v[40:43]
    v_mov_b32 v12, 0x3f803f80
    v_mov_b32 v13, 0x3f803f80
    v_mfma_f32_16x16x32_bf16 v[44:47], v[160:163], a[204:207], v[44:47]
    v_accvgpr_write_b32 a92, 0
    v_accvgpr_write_b32 a93, 0
    s_waitcnt lgkmcnt(6)
    v_mfma_f32_16x16x32_bf16 v[48:51], v[164:167], a[192:195], v[48:51]
    ds_read_b64_tr_b16 v[180:181], v191 offset:32768
    v_accvgpr_write_b32 a94, 0
    v_mfma_f32_16x16x32_bf16 v[52:55], v[164:167], a[196:199], v[52:55]
    ds_read_b64_tr_b16 v[182:183], v191 offset:33792
    v_accvgpr_write_b32 a95, 0
    v_mfma_f32_16x16x32_bf16 v[56:59], v[164:167], a[200:203], v[56:59]
    v_mov_b32 v14, 0x3f803f80
    v_mov_b32 v15, 0x3f803f80
    v_mfma_f32_16x16x32_bf16 v[60:63], v[164:167], a[204:207], v[60:63]
    s_waitcnt lgkmcnt(6)
    v_mfma_f32_16x16x32_bf16 v[64:67], v[168:171], a[192:195], v[64:67]
    ds_read_b64_tr_b16 v[152:153], v184 offset:40960
    v_accvgpr_write_b32 a96, 0
    v_mfma_f32_16x16x32_bf16 v[68:71], v[168:171], a[196:199], v[68:71]
    ds_read_b64_tr_b16 v[154:155], v184 offset:41984
    v_accvgpr_write_b32 a97, 0
    v_mfma_f32_16x16x32_bf16 v[72:75], v[168:171], a[200:203], v[72:75]
    v_mfma_f32_16x16x32_bf16 v[76:79], v[168:171], a[204:207], v[76:79]
    v_accvgpr_write_b32 a98, 0
    v_accvgpr_write_b32 a99, 0
    s_waitcnt lgkmcnt(6)
    v_mfma_f32_16x16x32_bf16 v[80:83], v[172:175], a[192:195], v[80:83]
    ds_read_b64_tr_b16 v[156:157], v185 offset:40960
    v_accvgpr_write_b32 a100, 0
    v_mfma_f32_16x16x32_bf16 v[84:87], v[172:175], a[196:199], v[84:87]
    ds_read_b64_tr_b16 v[158:159], v185 offset:41984
    v_accvgpr_write_b32 a101, 0
    v_mfma_f32_16x16x32_bf16 v[88:91], v[172:175], a[200:203], v[88:91]
    v_mov_b32 v144, 0
    v_mov_b32 v145, 0
    v_mfma_f32_16x16x32_bf16 v[92:95], v[172:175], a[204:207], v[92:95]
    s_waitcnt lgkmcnt(6)
    v_mfma_f32_16x16x32_bf16 v[96:99], v[176:179], a[192:195], v[96:99]
    ds_read_b64_tr_b16 v[160:161], v186 offset:40960
    v_accvgpr_write_b32 a102, 0
    v_mfma_f32_16x16x32_bf16 v[100:103], v[176:179], a[196:199], v[100:103]
    ds_read_b64_tr_b16 v[162:163], v186 offset:41984
    v_accvgpr_write_b32 a103, 0
    v_mfma_f32_16x16x32_bf16 v[104:107], v[176:179], a[200:203], v[104:107]
    v_mov_b32 v146, 0
    v_mov_b32 v147, 0
    v_mfma_f32_16x16x32_bf16 v[108:111], v[176:179], a[204:207], v[108:111]
    s_waitcnt lgkmcnt(6)
    v_mfma_f32_16x16x32_bf16 v[128:131], v[180:183], a[192:195], v[128:131]
    ds_read_b64_tr_b16 v[164:165], v187 offset:40960
    v_accvgpr_write_b32 a104, 0
    v_mfma_f32_16x16x32_bf16 v[132:135], v[180:183], a[196:199], v[132:135]
    ds_read_b64_tr_b16 v[166:167], v187 offset:41984
    v_accvgpr_write_b32 a105, 0
    v_mfma_f32_16x16x32_bf16 v[136:139], v[180:183], a[200:203], v[136:139]
    v_mfma_f32_16x16x32_bf16 v[140:143], v[180:183], a[204:207], v[140:143]
    v_accvgpr_write_b32 a106, 0
    v_accvgpr_write_b32 a107, 0
    s_waitcnt lgkmcnt(6)
    v_mfma_f32_16x16x32_bf16 v[112:115], v[152:155], a[208:211], v[112:115]
    ds_read_b64_tr_b16 v[168:169], v188 offset:40960
    v_accvgpr_write_b32 a108, 0
    v_mfma_f32_16x16x32_bf16 v[116:119], v[152:155], a[212:215], v[116:119]
    ds_read_b64_tr_b16 v[170:171], v188 offset:41984
    v_accvgpr_write_b32 a109, 0
    v_mfma_f32_16x16x32_bf16 v[120:123], v[152:155], a[216:219], v[120:123]
    v_lshlrev_b32 v9, 7, v0
    v_add_u32 v9, s59, v9
    v_mfma_f32_16x16x32_bf16 v[124:127], v[152:155], a[220:223], v[124:127]
    s_waitcnt lgkmcnt(6)
    v_mfma_f32_16x16x32_bf16 v[16:19], v[156:159], a[208:211], v[16:19]
    ds_read_b64_tr_b16 v[172:173], v189 offset:40960
    v_accvgpr_write_b32 a110, 0
    v_mfma_f32_16x16x32_bf16 v[20:23], v[156:159], a[212:215], v[20:23]
    ds_read_b64_tr_b16 v[174:175], v189 offset:41984
    v_accvgpr_write_b32 a111, 0
    v_mfma_f32_16x16x32_bf16 v[24:27], v[156:159], a[216:219], v[24:27]
    v_mov_b32 v10, 0x7f000000
    v_cmp_gt_u32 vcc, 11, v0
    v_mfma_f32_16x16x32_bf16 v[28:31], v[156:159], a[220:223], v[28:31]
    s_waitcnt lgkmcnt(6)
    v_mfma_f32_16x16x32_bf16 v[32:35], v[160:163], a[208:211], v[32:35]
    ds_read_b64_tr_b16 v[176:177], v190 offset:40960
    v_accvgpr_write_b32 a112, 0
    v_mfma_f32_16x16x32_bf16 v[36:39], v[160:163], a[212:215], v[36:39]
    ds_read_b64_tr_b16 v[178:179], v190 offset:41984
    v_accvgpr_write_b32 a113, 0
    v_mfma_f32_16x16x32_bf16 v[40:43], v[160:163], a[216:219], v[40:43]
    v_cndmask_b32 v9, v10, v9, vcc
    v_lshrrev_b32 v10, 3, v0
    v_mfma_f32_16x16x32_bf16 v[44:47], v[160:163], a[220:223], v[44:47]
    v_accvgpr_write_b32 a114, 0
    v_accvgpr_write_b32 a115, 0
    s_waitcnt lgkmcnt(6)
    v_mfma_f32_16x16x32_bf16 v[48:51], v[164:167], a[208:211], v[48:51]
    ds_read_b64_tr_b16 v[180:181], v191 offset:40960
    v_accvgpr_write_b32 a116, 0
    v_mfma_f32_16x16x32_bf16 v[52:55], v[164:167], a[212:215], v[52:55]
    ds_read_b64_tr_b16 v[182:183], v191 offset:41984
    v_accvgpr_write_b32 a117, 0
    v_mfma_f32_16x16x32_bf16 v[56:59], v[164:167], a[216:219], v[56:59]
    v_mfma_f32_16x16x32_bf16 v[60:63], v[164:167], a[220:223], v[60:63]
    v_mul_u32_u24 v10, 1152, v10
    v_and_b32 v11, 7, v0
    s_waitcnt lgkmcnt(6)
    v_mfma_f32_16x16x32_bf16 v[64:67], v[168:171], a[208:211], v[64:67]
    s_waitcnt vmcnt(8)
    s_barrier
    ds_read_b64_tr_b16 v[152:153], v184 offset:49152
    v_accvgpr_write_b32 a118, 0
    v_mfma_f32_16x16x32_bf16 v[68:71], v[168:171], a[212:215], v[68:71]
    ds_read_b64_tr_b16 v[154:155], v184 offset:50176
    v_accvgpr_write_b32 a119, 0
    v_mfma_f32_16x16x32_bf16 v[72:75], v[168:171], a[216:219], v[72:75]
    v_mfma_f32_16x16x32_bf16 v[76:79], v[168:171], a[220:223], v[76:79]
    s_waitcnt lgkmcnt(6)
    v_mfma_f32_16x16x32_bf16 v[80:83], v[172:175], a[208:211], v[80:83]
    ds_read_b64_tr_b16 v[156:157], v184 offset:57344
    v_accvgpr_write_b32 a120, 0
    v_mfma_f32_16x16x32_bf16 v[84:87], v[172:175], a[212:215], v[84:87]
    ds_read_b64_tr_b16 v[158:159], v184 offset:58368
    v_accvgpr_write_b32 a121, 0
    v_mfma_f32_16x16x32_bf16 v[88:91], v[172:175], a[216:219], v[88:91]
    v_lshl_add_u32 v10, v11, 3, v10
    v_add_u32 v10, s59, v10
    v_mfma_f32_16x16x32_bf16 v[92:95], v[172:175], a[220:223], v[92:95]
    v_accvgpr_write_b32 a122, 0
    v_accvgpr_write_b32 a123, 0
    s_waitcnt lgkmcnt(6)
    v_mfma_f32_16x16x32_bf16 v[96:99], v[176:179], a[208:211], v[96:99]
    ds_read_b64_tr_b16 v[160:161], v185 offset:49152
    v_accvgpr_write_b32 a124, 0
    v_mfma_f32_16x16x32_bf16 v[100:103], v[176:179], a[212:215], v[100:103]
    ds_read_b64_tr_b16 v[162:163], v185 offset:50176
    v_accvgpr_write_b32 a125, 0
    v_mfma_f32_16x16x32_bf16 v[104:107], v[176:179], a[216:219], v[104:107]
    s_cmp_ge_u32 s24, 2
    s_cselect_b64 vcc, -1, 0
    v_cndmask_b32 v9, v9, v10, vcc
    v_mfma_f32_16x16x32_bf16 v[108:111], v[176:179], a[220:223], v[108:111]
    s_waitcnt lgkmcnt(6)
    v_mfma_f32_16x16x32_bf16 v[128:131], v[180:183], a[208:211], v[128:131]
    ds_read_b64_tr_b16 v[164:165], v185 offset:57344
    v_accvgpr_write_b32 a126, 0
    v_mfma_f32_16x16x32_bf16 v[132:135], v[180:183], a[212:215], v[132:135]
    ds_read_b64_tr_b16 v[166:167], v185 offset:58368
    v_accvgpr_write_b32 a127, 0
    v_mfma_f32_16x16x32_bf16 v[136:139], v[180:183], a[216:219], v[136:139]
    v_mfma_f32_16x16x32_bf16 v[140:143], v[180:183], a[220:223], v[140:143]
    s_waitcnt lgkmcnt(6)
    v_mfma_f32_16x16x32_bf16 v[112:115], v[152:155], a[224:227], v[112:115]
    ds_read_b64_tr_b16 v[168:169], v186 offset:49152
    v_mfma_f32_16x16x32_bf16 v[116:119], v[152:155], a[228:231], v[116:119]
    ds_read_b64_tr_b16 v[170:171], v186 offset:50176
    v_mfma_f32_16x16x32_bf16 v[120:123], v[152:155], a[232:235], v[120:123]
    v_mfma_f32_16x16x32_bf16 v[124:127], v[152:155], a[236:239], v[124:127]
    s_waitcnt lgkmcnt(6)
    v_mfma_f32_16x16x32_bf16 v[112:115], v[156:159], a[240:243], v[112:115]
    ds_read_b64_tr_b16 v[172:173], v186 offset:57344
    v_mfma_f32_16x16x32_bf16 v[116:119], v[156:159], a[244:247], v[116:119]
    ds_read_b64_tr_b16 v[174:175], v186 offset:58368
    v_mfma_f32_16x16x32_bf16 v[120:123], v[156:159], a[248:251], v[120:123]
    v_mfma_f32_16x16x32_bf16 v[124:127], v[156:159], a[252:255], v[124:127]
    s_waitcnt lgkmcnt(6)
    v_mfma_f32_16x16x32_bf16 v[16:19], v[160:163], a[224:227], v[16:19]
    ds_read_b64_tr_b16 v[176:177], v187 offset:49152
    v_mfma_f32_16x16x32_bf16 v[20:23], v[160:163], a[228:231], v[20:23]
    ds_read_b64_tr_b16 v[178:179], v187 offset:50176
    v_pk_mul_f32 v[112:113], v[112:113], s[52:53]
    v_pk_mul_f32 v[114:115], v[114:115], s[52:53]
    v_mfma_f32_16x16x32_bf16 v[24:27], v[160:163], a[232:235], v[24:27]
    v_pk_mul_f32 v[116:117], v[116:117], s[52:53]
    v_pk_mul_f32 v[118:119], v[118:119], s[52:53]
    v_pk_mul_f32 v[120:121], v[120:121], s[52:53]
    v_mfma_f32_16x16x32_bf16 v[28:31], v[160:163], a[236:239], v[28:31]
    v_pk_mul_f32 v[122:123], v[122:123], s[52:53]
    v_pk_mul_f32 v[124:125], v[124:125], s[52:53]
    v_pk_mul_f32 v[126:127], v[126:127], s[52:53]
    s_waitcnt lgkmcnt(6)
    v_mfma_f32_16x16x32_bf16 v[16:19], v[164:167], a[240:243], v[16:19]
    ds_read_b64_tr_b16 v[180:181], v187 offset:57344
    v_cvt_pk_bf16_f32 v192, v112, v113
    v_cvt_pk_bf16_f32 v193, v114, v115
    v_mfma_f32_16x16x32_bf16 v[20:23], v[164:167], a[244:247], v[20:23]
    ds_read_b64_tr_b16 v[182:183], v187 offset:58368
    v_cvt_pk_bf16_f32 v196, v116, v117
    v_cvt_pk_bf16_f32 v197, v118, v119
    v_mfma_f32_16x16x32_bf16 v[24:27], v[164:167], a[248:251], v[24:27]
    v_mfma_f32_16x16x32_bf16 v[28:31], v[164:167], a[252:255], v[28:31]
    v_cvt_pk_bf16_f32 v200, v120, v121
    v_cvt_pk_bf16_f32 v201, v122, v123
    v_cvt_pk_bf16_f32 v204, v124, v125
    s_waitcnt lgkmcnt(6)
    v_mfma_f32_16x16x32_bf16 v[32:35], v[168:171], a[224:227], v[32:35]
    ds_read_b64_tr_b16 v[152:153], v188 offset:49152
    v_cvt_pk_bf16_f32 v205, v126, v127
    v_mfma_f32_16x16x32_bf16 v[36:39], v[168:171], a[228:231], v[36:39]
    ds_read_b64_tr_b16 v[154:155], v188 offset:50176
    v_pk_mul_f32 v[16:17], v[16:17], s[52:53]
    v_pk_mul_f32 v[18:19], v[18:19], s[52:53]
    v_mfma_f32_16x16x32_bf16 v[40:43], v[168:171], a[232:235], v[40:43]
    v_pk_mul_f32 v[20:21], v[20:21], s[52:53]
    v_pk_mul_f32 v[22:23], v[22:23], s[52:53]
    v_pk_mul_f32 v[24:25], v[24:25], s[52:53]
    v_mfma_f32_16x16x32_bf16 v[44:47], v[168:171], a[236:239], v[44:47]
    v_pk_mul_f32 v[26:27], v[26:27], s[52:53]
    v_pk_mul_f32 v[28:29], v[28:29], s[52:53]
    v_pk_mul_f32 v[30:31], v[30:31], s[52:53]
    s_waitcnt lgkmcnt(6)
    v_mfma_f32_16x16x32_bf16 v[32:35], v[172:175], a[240:243], v[32:35]
    ds_read_b64_tr_b16 v[156:157], v188 offset:57344
    v_cvt_pk_bf16_f32 v194, v16, v17
    v_cvt_pk_bf16_f32 v195, v18, v19
    v_mfma_f32_16x16x32_bf16 v[36:39], v[172:175], a[244:247], v[36:39]
    ds_read_b64_tr_b16 v[158:159], v188 offset:58368
    v_cvt_pk_bf16_f32 v198, v20, v21
    v_cvt_pk_bf16_f32 v199, v22, v23
    v_mfma_f32_16x16x32_bf16 v[40:43], v[172:175], a[248:251], v[40:43]
    v_cvt_pk_bf16_f32 v202, v24, v25
    v_cvt_pk_bf16_f32 v203, v26, v27
    v_cvt_pk_bf16_f32 v206, v28, v29
    v_mfma_f32_16x16x32_bf16 v[44:47], v[172:175], a[252:255], v[44:47]
    v_cvt_pk_bf16_f32 v207, v30, v31
    v_mov_b32 v112, 0
    v_mov_b32 v113, 0
    s_waitcnt lgkmcnt(6)
    v_mfma_f32_16x16x32_bf16 v[48:51], v[176:179], a[224:227], v[48:51]
    ds_read_b64_tr_b16 v[160:161], v189 offset:49152
    v_mov_b32 v114, 0
    v_mov_b32 v115, 0
    v_mfma_f32_16x16x32_bf16 v[52:55], v[176:179], a[228:231], v[52:55]
    ds_read_b64_tr_b16 v[162:163], v189 offset:50176
    v_pk_mul_f32 v[32:33], v[32:33], s[52:53]
    v_pk_mul_f32 v[34:35], v[34:35], s[52:53]
    v_mfma_f32_16x16x32_bf16 v[56:59], v[176:179], a[232:235], v[56:59]
    v_pk_mul_f32 v[36:37], v[36:37], s[52:53]
    v_pk_mul_f32 v[38:39], v[38:39], s[52:53]
    v_pk_mul_f32 v[40:41], v[40:41], s[52:53]
    v_mfma_f32_16x16x32_bf16 v[60:63], v[176:179], a[236:239], v[60:63]
    v_pk_mul_f32 v[42:43], v[42:43], s[52:53]
    v_pk_mul_f32 v[44:45], v[44:45], s[52:53]
    v_pk_mul_f32 v[46:47], v[46:47], s[52:53]
    s_waitcnt lgkmcnt(6)
    v_mfma_f32_16x16x32_bf16 v[48:51], v[180:183], a[240:243], v[48:51]
    ds_read_b64_tr_b16 v[164:165], v189 offset:57344
    v_cvt_pk_bf16_f32 v208, v32, v33
    v_cvt_pk_bf16_f32 v209, v34, v35
    v_mfma_f32_16x16x32_bf16 v[52:55], v[180:183], a[244:247], v[52:55]
    ds_read_b64_tr_b16 v[166:167], v189 offset:58368
    v_cvt_pk_bf16_f32 v212, v36, v37
    v_cvt_pk_bf16_f32 v213, v38, v39
    v_mfma_f32_16x16x32_bf16 v[56:59], v[180:183], a[248:251], v[56:59]
    v_cvt_pk_bf16_f32 v216, v40, v41
    v_cvt_pk_bf16_f32 v217, v42, v43
    v_cvt_pk_bf16_f32 v220, v44, v45
    v_mfma_f32_16x16x32_bf16 v[60:63], v[180:183], a[252:255], v[60:63]
    v_cvt_pk_bf16_f32 v221, v46, v47
    v_mov_b32 v116, 0
    v_mov_b32 v117, 0
    s_waitcnt lgkmcnt(6)
    v_mfma_f32_16x16x32_bf16 v[64:67], v[152:155], a[224:227], v[64:67]
    ds_read_b64_tr_b16 v[168:169], v190 offset:49152
    v_mov_b32 v118, 0
    v_mov_b32 v119, 0
    v_mfma_f32_16x16x32_bf16 v[68:71], v[152:155], a[228:231], v[68:71]
    ds_read_b64_tr_b16 v[170:171], v190 offset:50176
    v_pk_mul_f32 v[48:49], v[48:49], s[52:53]
    v_pk_mul_f32 v[50:51], v[50:51], s[52:53]
    v_mfma_f32_16x16x32_bf16 v[72:75], v[152:155], a[232:235], v[72:75]
    v_pk_mul_f32 v[52:53], v[52:53], s[52:53]
    v_pk_mul_f32 v[54:55], v[54:55], s[52:53]
    v_pk_mul_f32 v[56:57], v[56:57], s[52:53]
    v_mfma_f32_16x16x32_bf16 v[76:79], v[152:155], a[236:239], v[76:79]
    v_pk_mul_f32 v[58:59], v[58:59], s[52:53]
    v_pk_mul_f32 v[60:61], v[60:61], s[52:53]
    v_pk_mul_f32 v[62:63], v[62:63], s[52:53]
    s_waitcnt lgkmcnt(6)
    v_mfma_f32_16x16x32_bf16 v[64:67], v[156:159], a[240:243], v[64:67]
    ds_read_b64_tr_b16 v[172:173], v190 offset:57344
    v_cvt_pk_bf16_f32 v210, v48, v49
    v_cvt_pk_bf16_f32 v211, v50, v51
    v_mfma_f32_16x16x32_bf16 v[68:71], v[156:159], a[244:247], v[68:71]
    ds_read_b64_tr_b16 v[174:175], v190 offset:58368
    v_cvt_pk_bf16_f32 v214, v52, v53
    v_cvt_pk_bf16_f32 v215, v54, v55
    v_mfma_f32_16x16x32_bf16 v[72:75], v[156:159], a[248:251], v[72:75]
    v_cvt_pk_bf16_f32 v218, v56, v57
    v_cvt_pk_bf16_f32 v219, v58, v59
    v_cvt_pk_bf16_f32 v222, v60, v61
    v_mfma_f32_16x16x32_bf16 v[76:79], v[156:159], a[252:255], v[76:79]
    v_cvt_pk_bf16_f32 v223, v62, v63
    v_mov_b32 v120, 0
    v_mov_b32 v121, 0
    s_waitcnt lgkmcnt(6)
    v_mfma_f32_16x16x32_bf16 v[80:83], v[160:163], a[224:227], v[80:83]
    ds_read_b64_tr_b16 v[176:177], v191 offset:49152
    v_mov_b32 v122, 0
    v_mov_b32 v123, 0
    v_mfma_f32_16x16x32_bf16 v[84:87], v[160:163], a[228:231], v[84:87]
    ds_read_b64_tr_b16 v[178:179], v191 offset:50176
    v_pk_mul_f32 v[64:65], v[64:65], s[52:53]
    v_pk_mul_f32 v[66:67], v[66:67], s[52:53]
    v_mfma_f32_16x16x32_bf16 v[88:91], v[160:163], a[232:235], v[88:91]
    v_pk_mul_f32 v[68:69], v[68:69], s[52:53]
    v_pk_mul_f32 v[70:71], v[70:71], s[52:53]
    v_pk_mul_f32 v[72:73], v[72:73], s[52:53]
    v_mfma_f32_16x16x32_bf16 v[92:95], v[160:163], a[236:239], v[92:95]
    v_pk_mul_f32 v[74:75], v[74:75], s[52:53]
    v_pk_mul_f32 v[76:77], v[76:77], s[52:53]
    v_pk_mul_f32 v[78:79], v[78:79], s[52:53]
    s_waitcnt lgkmcnt(6)
    v_mfma_f32_16x16x32_bf16 v[80:83], v[164:167], a[240:243], v[80:83]
    ds_read_b64_tr_b16 v[180:181], v191 offset:57344
    v_cvt_pk_bf16_f32 v224, v64, v65
    v_cvt_pk_bf16_f32 v225, v66, v67
    v_mfma_f32_16x16x32_bf16 v[84:87], v[164:167], a[244:247], v[84:87]
    ds_read_b64_tr_b16 v[182:183], v191 offset:58368
    v_cvt_pk_bf16_f32 v228, v68, v69
    v_cvt_pk_bf16_f32 v229, v70, v71
    v_mfma_f32_16x16x32_bf16 v[88:91], v[164:167], a[248:251], v[88:91]
    v_cvt_pk_bf16_f32 v232, v72, v73
    v_cvt_pk_bf16_f32 v233, v74, v75
    v_cvt_pk_bf16_f32 v236, v76, v77
    v_mfma_f32_16x16x32_bf16 v[92:95], v[164:167], a[252:255], v[92:95]
    v_cvt_pk_bf16_f32 v237, v78, v79
    v_mov_b32 v124, 0
    v_mov_b32 v125, 0
    s_waitcnt lgkmcnt(6)
    v_mfma_f32_16x16x32_bf16 v[96:99], v[168:171], a[224:227], v[96:99]
    ds_read_b128 v[152:155], v3 offset:0
    v_mov_b32 v126, 0
    v_mov_b32 v127, 0
    v_mfma_f32_16x16x32_bf16 v[100:103], v[168:171], a[228:231], v[100:103]
    v_pk_mul_f32 v[80:81], v[80:81], s[52:53]
    v_pk_mul_f32 v[82:83], v[82:83], s[52:53]
    v_pk_mul_f32 v[84:85], v[84:85], s[52:53]
    v_mfma_f32_16x16x32_bf16 v[104:107], v[168:171], a[232:235], v[104:107]
    v_pk_mul_f32 v[86:87], v[86:87], s[52:53]
    v_pk_mul_f32 v[88:89], v[88:89], s[52:53]
    v_pk_mul_f32 v[90:91], v[90:91], s[52:53]
    v_mfma_f32_16x16x32_bf16 v[108:111], v[168:171], a[236:239], v[108:111]
    s_waitcnt lgkmcnt(5)
    v_mfma_f32_16x16x32_bf16 v[96:99], v[172:175], a[240:243], v[96:99]
    ds_read_b128 v[156:159], v3 offset:1024
    v_pk_mul_f32 v[92:93], v[92:93], s[52:53]
    v_pk_mul_f32 v[94:95], v[94:95], s[52:53]
    v_mfma_f32_16x16x32_bf16 v[100:103], v[172:175], a[244:247], v[100:103]
    v_cvt_pk_bf16_f32 v226, v80, v81
    v_cvt_pk_bf16_f32 v227, v82, v83
    v_cvt_pk_bf16_f32 v230, v84, v85
    v_mfma_f32_16x16x32_bf16 v[104:107], v[172:175], a[248:251], v[104:107]
    v_cvt_pk_bf16_f32 v231, v86, v87
    v_cvt_pk_bf16_f32 v234, v88, v89
    v_cvt_pk_bf16_f32 v235, v90, v91
    v_mfma_f32_16x16x32_bf16 v[108:111], v[172:175], a[252:255], v[108:111]
    s_waitcnt lgkmcnt(4)
    v_mfma_f32_16x16x32_bf16 v[128:131], v[176:179], a[224:227], v[128:131]
    ds_read_b128 v[160:163], v3 offset:2048
    v_cvt_pk_bf16_f32 v238, v92, v93
    v_cvt_pk_bf16_f32 v239, v94, v95
    v_mfma_f32_16x16x32_bf16 v[132:135], v[176:179], a[228:231], v[132:135]
    v_pk_mul_f32 v[96:97], v[96:97], s[52:53]
    v_pk_mul_f32 v[98:99], v[98:99], s[52:53]
    v_pk_mul_f32 v[100:101], v[100:101], s[52:53]
    v_mfma_f32_16x16x32_bf16 v[136:139], v[176:179], a[232:235], v[136:139]
    v_pk_mul_f32 v[102:103], v[102:103], s[52:53]
    v_pk_mul_f32 v[104:105], v[104:105], s[52:53]
    v_pk_mul_f32 v[106:107], v[106:107], s[52:53]
    v_mfma_f32_16x16x32_bf16 v[140:143], v[176:179], a[236:239], v[140:143]
    s_waitcnt lgkmcnt(3)
    v_mfma_f32_16x16x32_bf16 v[128:131], v[180:183], a[240:243], v[128:131]
    ds_read_b128 v[164:167], v3 offset:3072
    v_pk_mul_f32 v[108:109], v[108:109], s[52:53]
    v_pk_mul_f32 v[110:111], v[110:111], s[52:53]
    v_mfma_f32_16x16x32_bf16 v[132:135], v[180:183], a[244:247], v[132:135]
    ds_read_b128 v[168:171], v3 offset:4096
    v_cvt_pk_bf16_f32 v240, v96, v97
    v_cvt_pk_bf16_f32 v241, v98, v99
    v_mfma_f32_16x16x32_bf16 v[136:139], v[180:183], a[248:251], v[136:139]
    v_cvt_pk_bf16_f32 v244, v100, v101
    v_cvt_pk_bf16_f32 v245, v102, v103
    v_cvt_pk_bf16_f32 v248, v104, v105
    v_mfma_f32_16x16x32_bf16 v[140:143], v[180:183], a[252:255], v[140:143]
    v_cvt_pk_bf16_f32 v249, v106, v107
    v_cvt_pk_bf16_f32 v252, v108, v109
    v_cvt_pk_bf16_f32 v253, v110, v111
    v_pk_mul_f32 v[128:129], v[128:129], s[52:53]
    v_pk_mul_f32 v[130:131], v[130:131], s[52:53]
    v_pk_mul_f32 v[132:133], v[132:133], s[52:53]
    v_pk_mul_f32 v[134:135], v[134:135], s[52:53]
    v_pk_mul_f32 v[136:137], v[136:137], s[52:53]
    v_pk_mul_f32 v[138:139], v[138:139], s[52:53]
    v_pk_mul_f32 v[140:141], v[140:141], s[52:53]
    v_pk_mul_f32 v[142:143], v[142:143], s[52:53]
    v_cvt_pk_bf16_f32 v242, v128, v129
    v_cvt_pk_bf16_f32 v243, v130, v131
    v_cvt_pk_bf16_f32 v246, v132, v133
    v_cvt_pk_bf16_f32 v247, v134, v135
    v_cvt_pk_bf16_f32 v250, v136, v137
    v_cvt_pk_bf16_f32 v251, v138, v139
    v_cvt_pk_bf16_f32 v254, v140, v141
    v_cvt_pk_bf16_f32 v255, v142, v143
    s_cmp_lg_u32 s58, 0
    s_cbranch_scc1 K2_SAFE
K2_GO:
    s_lshl_b32 s68, s2, 2
    s_add_u32 s68, s68, s24
    s_lshl_b32 s68, s68, 10
    s_add_u32 s68, s68, 5242880
    v_mov_b32 v148, -1
    v_mov_b32 v149, -1
    v_mov_b32 v150, -1
    v_mov_b32 v151, -1
    v_mov_b32 v0, 0
    s_cmp_ge_u32 s24, 2
    s_cbranch_scc1 K2_R23
    s_add_u32 s40, s40, 8192
    s_add_u32 s42, s42, 8192
    s_add_u32 m0, s42, s43
    s_nop 0
    buffer_load_dwordx4 v1, s[12:15], s40 offen offset:0 lds
    buffer_load_dwordx4 v1, s[12:15], s40 offen offset:1024 lds
    buffer_load_dwordx4 v1, s[12:15], s40 offen offset:2048 lds
    buffer_load_dwordx4 v1, s[12:15], s40 offen offset:3072 lds
    s_add_u32 m0, m0, 4096
    s_nop 0
    buffer_load_dwordx4 v2, s[12:15], s40 offen offset:0 lds
    buffer_load_dwordx4 v2, s[12:15], s40 offen offset:1024 lds
    buffer_load_dwordx4 v2, s[12:15], s40 offen offset:2048 lds
    buffer_load_dwordx4 v2, s[12:15], s40 offen offset:3072 lds
    v_mov_b32 v128, 0
    v_mov_b32 v129, 0
    v_mov_b32 v130, 0
    v_mov_b32 v131, 0
    v_mov_b32 v132, 0
    v_mov_b32 v133, 0
    v_mov_b32 v134, 0
    v_mov_b32 v135, 0
    v_mov_b32 v136, 0
    v_mov_b32 v137, 0
    v_mov_b32 v138, 0
    v_mov_b32 v139, 0
    v_mov_b32 v140, 0
    v_mov_b32 v141, 0
    v_mov_b32 v142, 0
    v_mov_b32 v143, 0
    v_add_u32 v3, 81920, v1
    v_add_u32 v4, 114688, v1
    s_mov_b32 s30, 2
    s_mov_b32 s31, 17
    s_barrier
    ds_read_b128 a[128:131], v7 offset:0
    ds_read_b128 a[132:135], v7 offset:1024
    ds_read_b128 a[136:139], v7 offset:2048
    ds_read_b128 a[140:143], v7 offset:3072
    ds_read_b128 a[144:147], v7 offset:4096
    ds_read_b128 a[148:151], v7 offset:5120
    ds_read_b128 a[152:155], v7 offset:6144
    ds_read_b128 a[156:159], v7 offset:7168
    ds_read_b128 a[160:163], v7 offset:8192
    ds_read_b128 a[164:167], v7 offset:9216
    ds_read_b128 a[168:171], v7 offset:10240
    ds_read_b128 a[172:175], v7 offset:11264
    ds_read_b128 a[176:179], v7 offset:12288
    ds_read_b128 a[180:183], v7 offset:13312
    ds_read_b128 a[184:187], v7 offset:14336
    ds_read_b128 a[188:191], v7 offset:15360
    s_add_u32 s40, s40, s41
    s_min_u32 s40, s40, 0x7000000
    s_add_u32 s42, s42, 8192
    s_and_b32 s42, s42, 0x7fff
    s_add_u32 m0, s42, s43
    s_nop 0
    buffer_load_dwordx4 v1, s[12:15], s40 offen offset:0 lds
    buffer_load_dwordx4 v1, s[12:15], s40 offen offset:1024 lds
    buffer_load_dwordx4 v1, s[12:15], s40 offen offset:2048 lds
    buffer_load_dwordx4 v1, s[12:15], s40 offen offset:3072 lds
    s_add_u32 m0, m0, 4096
    s_nop 0
    buffer_load_dwordx4 v2, s[12:15], s40 offen offset:0 lds
    buffer_load_dwordx4 v2, s[12:15], s40 offen offset:1024 lds
    buffer_load_dwordx4 v2, s[12:15], s40 offen offset:2048 lds
    buffer_load_dwordx4 v2, s[12:15], s40 offen offset:3072 lds
    ds_write_b128 v7, v[192:195] offset:0
    ds_write_b128 v7, v[196:199] offset:1024
    ds_write_b128 v7, v[200:203] offset:2048
    ds_write_b128 v7, v[204:207] offset:3072
    ds_write_b128 v7, v[208:211] offset:4096
    ds_write_b128 v7, v[212:215] offset:5120
    ds_write_b128 v7, v[216:219] offset:6144
    ds_write_b128 v7, v[220:223] offset:7168
    ds_write_b128 v7, v[224:227] offset:8192
    ds_write_b128 v7, v[228:231] offset:9216
    ds_write_b128 v7, v[232:235] offset:10240
    ds_write_b128 v7, v[236:239] offset:11264
    ds_write_b128 v7, v[240:243] offset:12288
    ds_write_b128 v7, v[244:247] offset:13312
    ds_write_b128 v7, v[248:251] offset:14336
    ds_write_b128 v7, v[252:255] offset:15360
    s_waitcnt vmcnt(16) lgkmcnt(0)
    s_barrier
    ds_read_b128 v[152:155], v3 offset:0
    ds_read_b128 v[156:159], v3 offset:1024
    ds_read_b128 v[160:163], v3 offset:2048
    ds_read_b128 v[164:167], v3 offset:3072
    ds_read_b128 v[168:171], v3 offset:4096
    s_waitcnt lgkmcnt(3)
    v_mfma_f32_16x16x32_bf16 v[16:19], v[152:155], a[128:131], v[112:115]
    ds_read_b128 v[172:175], v3 offset:5120
    s_add_u32 s40, s40, 8192
    s_add_u32 s42, s42, 8192
    v_mfma_f32_16x16x32_bf16 v[20:23], v[152:155], a[132:135], v[116:119]
    s_add_u32 m0, s42, s43
    v_mfma_f32_16x16x32_bf16 v[24:27], v[152:155], a[136:139], v[120:123]
    buffer_load_dwordx4 v1, s[12:15], s40 offen offset:0 lds
    v_mfma_f32_16x16x32_bf16 v[28:31], v[152:155], a[140:143], v[124:127]
    v_mfma_f32_16x16x32_bf16 v[16:19], v[156:159], a[144:147], v[16:19]
    ds_read_b128 v[176:179], v3 offset:6144
    v_mfma_f32_16x16x32_bf16 v[20:23], v[156:159], a[148:151], v[20:23]
    buffer_load_dwordx4 v1, s[12:15], s40 offen offset:1024 lds
    v_mfma_f32_16x16x32_bf16 v[24:27], v[156:159], a[152:155], v[24:27]
    buffer_load_dwordx4 v1, s[12:15], s40 offen offset:2048 lds
    v_mfma_f32_16x16x32_bf16 v[28:31], v[156:159], a[156:159], v[28:31]
    s_waitcnt lgkmcnt(3)
    v_mfma_f32_16x16x32_bf16 v[16:19], v[160:163], a[160:163], v[16:19]
    ds_read_b128 v[180:183], v3 offset:7168
    v_mfma_f32_16x16x32_bf16 v[20:23], v[160:163], a[164:167], v[20:23]
    buffer_load_dwordx4 v1, s[12:15], s40 offen offset:3072 lds
    v_mfma_f32_16x16x32_bf16 v[24:27], v[160:163], a[168:171], v[24:27]
    s_add_u32 m0, m0, 4096
    v_mfma_f32_16x16x32_bf16 v[28:31], v[160:163], a[172:175], v[28:31]
    buffer_load_dwordx4 v2, s[12:15], s40 offen offset:0 lds
    v_mfma_f32_16x16x32_bf16 v[16:19], v[164:167], a[176:179], v[16:19]
    v_mfma_f32_16x16x32_bf16 v[20:23], v[164:167], a[180:183], v[20:23]
    buffer_load_dwordx4 v2, s[12:15], s40 offen offset:1024 lds
    v_mfma_f32_16x16x32_bf16 v[24:27], v[164:167], a[184:187], v[24:27]
    v_mfma_f32_16x16x32_bf16 v[28:31], v[164:167], a[188:191], v[28:31]
    buffer_load_dwordx4 v2, s[12:15], s40 offen offset:2048 lds
    s_waitcnt lgkmcnt(2)
    v_mfma_f32_16x16x32_bf16 v[32:35], v[168:171], a[128:131], v[112:115]
    v_mfma_f32_16x16x32_bf16 v[36:39], v[168:171], a[132:135], v[116:119]
    buffer_load_dwordx4 v2, s[12:15], s40 offen offset:3072 lds
    v_mfma_f32_16x16x32_bf16 v[40:43], v[168:171], a[136:139], v[120:123]
    v_mfma_f32_16x16x32_bf16 v[44:47], v[168:171], a[140:143], v[124:127]
    s_waitcnt vmcnt(16) lgkmcnt(0)
    s_barrier
    v_mfma_f32_16x16x32_bf16 v[32:35], v[172:175], a[144:147], v[32:35]
    ds_read_b128 v[152:155], v3 offset:8192
    v_mfma_f32_16x16x32_bf16 v[36:39], v[172:175], a[148:151], v[36:39]
    ds_read_b128 v[156:159], v3 offset:9216
    v_mfma_f32_16x16x32_bf16 v[40:43], v[172:175], a[152:155], v[40:43]
    v_mfma_f32_16x16x32_bf16 v[44:47], v[172:175], a[156:159], v[44:47]
    v_mfma_f32_16x16x32_bf16 v[32:35], v[176:179], a[160:163], v[32:35]
    ds_read_b128 v[160:163], v3 offset:10240
    v_mfma_f32_16x16x32_bf16 v[36:39], v[176:179], a[164:167], v[36:39]
    ds_read_b128 v[164:167], v3 offset:11264
    v_mfma_f32_16x16x32_bf16 v[40:43], v[176:179], a[168:171], v[40:43]
    v_mfma_f32_16x16x32_bf16 v[44:47], v[176:179], a[172:175], v[44:47]
    v_mfma_f32_16x16x32_bf16 v[32:35], v[180:183], a[176:179], v[32:35]
    ds_read_b128 v[168:171], v3 offset:12288
    v_mfma_f32_16x16x32_bf16 v[36:39], v[180:183], a[180:183], v[36:39]
    v_mfma_f32_16x16x32_bf16 v[40:43], v[180:183], a[184:187], v[40:43]
    v_mfma_f32_16x16x32_bf16 v[44:47], v[180:183], a[188:191], v[44:47]
    s_waitcnt lgkmcnt(3)
    v_mfma_f32_16x16x32_bf16 v[48:51], v[152:155], a[128:131], v[112:115]
    ds_read_b128 v[172:175], v3 offset:13312
    s_add_u32 s40, s40, s41
    s_min_u32 s40, s40, 0x7000000
    v_mfma_f32_16x16x32_bf16 v[52:55], v[152:155], a[132:135], v[116:119]
    s_add_u32 s42, s42, 8192
    s_and_b32 s42, s42, 0x7fff
    s_add_u32 m0, s42, s43
    v_mfma_f32_16x16x32_bf16 v[56:59], v[152:155], a[136:139], v[120:123]
    buffer_load_dwordx4 v1, s[12:15], s40 offen offset:0 lds
    v_mfma_f32_16x16x32_bf16 v[60:63], v[152:155], a[140:143], v[124:127]
    v_exp_f32 v184, v16
    v_mfma_f32_16x16x32_bf16 v[48:51], v[156:159], a[144:147], v[48:51]
    ds_read_b128 v[176:179], v3 offset:14336
    v_exp_f32 v185, v17
    v_mfma_f32_16x16x32_bf16 v[52:55], v[156:159], a[148:151], v[52:55]
    buffer_load_dwordx4 v1, s[12:15], s40 offen offset:1024 lds
    v_mfma_f32_16x16x32_bf16 v[56:59], v[156:159], a[152:155], v[56:59]
    buffer_load_dwordx4 v1, s[12:15], s40 offen offset:2048 lds
    v_mfma_f32_16x16x32_bf16 v[60:63], v[156:159], a[156:159], v[60:63]
    buffer_load_dwordx4 v1, s[12:15], s40 offen offset:3072 lds
    s_waitcnt lgkmcnt(3)
    v_mfma_f32_16x16x32_bf16 v[48:51], v[160:163], a[160:163], v[48:51]
    ds_read_b128 v[180:183], v3 offset:15360
    s_add_u32 m0, m0, 4096
    v_cvt_pk_bf16_f32 v80, v184, v185
    v_mfma_f32_16x16x32_bf16 v[52:55], v[160:163], a[164:167], v[52:55]
    buffer_load_dwordx4 v2, s[12:15], s40 offen offset:0 lds
    v_mfma_f32_16x16x32_bf16 v[56:59], v[160:163], a[168:171], v[56:59]
    v_exp_f32 v186, v18
    v_mfma_f32_16x16x32_bf16 v[60:63], v[160:163], a[172:175], v[60:63]
    buffer_load_dwordx4 v2, s[12:15], s40 offen offset:1024 lds
    v_mfma_f32_16x16x32_bf16 v[48:51], v[164:167], a[176:179], v[48:51]
    buffer_load_dwordx4 v2, s[12:15], s40 offen offset:2048 lds
    v_mfma_f32_16x16x32_bf16 v[52:55], v[164:167], a[180:183], v[52:55]
    v_exp_f32 v187, v19
    v_mfma_f32_16x16x32_bf16 v[56:59], v[164:167], a[184:187], v[56:59]
    buffer_load_dwordx4 v2, s[12:15], s40 offen offset:3072 lds
    v_mfma_f32_16x16x32_bf16 v[60:63], v[164:167], a[188:191], v[60:63]
    buffer_load_dwordx2 v[10:11], v9, s[20:23], 0 offen
    s_waitcnt lgkmcnt(2)
    v_mfma_f32_16x16x32_bf16 v[64:67], v[168:171], a[128:131], v[112:115]
    v_exp_f32 v188, v20
    v_cvt_pk_bf16_f32 v81, v186, v187
    v_mfma_f32_16x16x32_bf16 v[68:71], v[168:171], a[132:135], v[116:119]
    v_add_u32 v9, s69, v9
    v_exp_f32 v189, v21
    v_mfma_f32_16x16x32_bf16 v[72:75], v[168:171], a[136:139], v[120:123]
    buffer_store_dwordx4 v[148:151], v1, s[64:67], s68 offen sc0 sc1
    v_mfma_f32_16x16x32_bf16 v[76:79], v[168:171], a[140:143], v[124:127]
    s_add_u32 s68, s68, 1048576
    v_exp_f32 v190, v22
    s_waitcnt vmcnt(18) lgkmcnt(0)
    s_barrier
    v_xor_b32 v3, 0x4000, v3
    v_mfma_f32_16x16x32_bf16 v[64:67], v[172:175], a[144:147], v[64:67]
    ds_read_b128 v[152:155], v4 offset:0
    v_exp_f32 v191, v23
    v_mfma_f32_16x16x32_bf16 v[68:71], v[172:175], a[148:151], v[68:71]
    ds_read_b128 v[156:159], v4 offset:1024
    v_exp_f32 v184, v24
    v_mfma_f32_16x16x32_bf16 v[72:75], v[172:175], a[152:155], v[72:75]
    v_exp_f32 v185, v25
    v_cvt_pk_bf16_f32 v84, v188, v189
    v_mfma_f32_16x16x32_bf16 v[76:79], v[172:175], a[156:159], v[76:79]
    v_exp_f32 v186, v26
    v_cvt_pk_bf16_f32 v85, v190, v191
    v_mfma_f32_16x16x32_bf16 v[64:67], v[176:179], a[160:163], v[64:67]
    ds_read_b128 v[160:163], v4 offset:2048
    v_exp_f32 v187, v27
    v_mfma_f32_16x16x32_bf16 v[68:71], v[176:179], a[164:167], v[68:71]
    ds_read_b128 v[164:167], v4 offset:3072
    v_exp_f32 v188, v28
    v_mfma_f32_16x16x32_bf16 v[72:75], v[176:179], a[168:171], v[72:75]
    v_exp_f32 v189, v29
    v_cvt_pk_bf16_f32 v88, v184, v185
    v_mfma_f32_16x16x32_bf16 v[76:79], v[176:179], a[172:175], v[76:79]
    v_exp_f32 v190, v30
    v_cvt_pk_bf16_f32 v89, v186, v187
    v_mfma_f32_16x16x32_bf16 v[64:67], v[180:183], a[176:179], v[64:67]
    ds_read_b128 v[168:171], v4 offset:4096
    v_exp_f32 v191, v31
    v_mfma_f32_16x16x32_bf16 v[68:71], v[180:183], a[180:183], v[68:71]
    v_exp_f32 v184, v32
    v_cvt_pk_bf16_f32 v92, v188, v189
    v_exp_f32 v185, v33
    v_exp_f32 v186, v34
    v_exp_f32 v187, v35
    v_exp_f32 v188, v36
    v_exp_f32 v189, v37
    v_mfma_f32_16x16x32_bf16 v[72:75], v[180:183], a[184:187], v[72:75]
    v_cvt_pk_bf16_f32 v93, v190, v191
    v_cvt_pk_bf16_f32 v82, v184, v185
    v_cvt_pk_bf16_f32 v83, v186, v187
    v_exp_f32 v190, v38
    v_exp_f32 v191, v39
    v_exp_f32 v184, v40
    v_exp_f32 v185, v41
    v_exp_f32 v186, v42
    v_exp_f32 v187, v43
    v_cvt_pk_bf16_f32 v86, v188, v189
    v_cvt_pk_bf16_f32 v87, v190, v191
    v_cvt_pk_bf16_f32 v90, v184, v185
    v_cvt_pk_bf16_f32 v91, v186, v187
    v_exp_f32 v188, v44
    v_exp_f32 v189, v45
    v_exp_f32 v190, v46
    v_exp_f32 v191, v47
    v_cvt_pk_bf16_f32 v94, v188, v189
    v_cvt_pk_bf16_f32 v95, v190, v191
    v_mfma_f32_16x16x32_bf16 v[76:79], v[180:183], a[188:191], v[76:79]
    .p2align 6
K2_MD:
    s_waitcnt lgkmcnt(3)
    v_mfma_f32_16x16x32_bf16 a[0:3], v[152:155], v[80:83], a[0:3]
    ds_read_b128 v[172:175], v4 offset:5120
    s_add_u32 s40, s40, 8192
    v_mfma_f32_16x16x32_bf16 a[4:7], v[152:155], v[84:87], a[4:7]
    v_exp_f32 v184, v48
    v_mfma_f32_16x16x32_bf16 a[8:11], v[152:155], v[88:91], a[8:11]
    v_exp_f32 v185, v49
    v_mfma_f32_16x16x32_bf16 a[12:15], v[152:155], v[92:95], a[12:15]
    s_add_u32 s42, s42, 8192
    s_add_u32 m0, s42, s43
    v_mfma_f32_16x16x32_bf16 a[16:19], v[156:159], v[80:83], a[16:19]
    ds_read_b128 v[176:179], v4 offset:6144
    v_cvt_pk_bf16_f32 v96, v184, v185
    v_mfma_f32_16x16x32_bf16 a[20:23], v[156:159], v[84:87], a[20:23]
    buffer_load_dwordx4 v1, s[12:15], s40 offen offset:0 lds
    v_mfma_f32_16x16x32_bf16 a[24:27], v[156:159], v[88:91], a[24:27]
    v_exp_f32 v186, v50
    v_mfma_f32_16x16x32_bf16 a[28:31], v[156:159], v[92:95], a[28:31]
    v_exp_f32 v187, v51
    v_mfma_f32_16x16x32_bf16 v[128:131], v[12:15], v[80:83], v[128:131]
    v_exp_f32 v188, v52
    s_waitcnt lgkmcnt(3)
    v_mfma_f32_16x16x32_bf16 a[32:35], v[160:163], v[80:83], a[32:35]
    ds_read_b128 v[180:183], v4 offset:7168
    v_cvt_pk_bf16_f32 v97, v186, v187
    v_mfma_f32_16x16x32_bf16 a[36:39], v[160:163], v[84:87], a[36:39]
    buffer_load_dwordx4 v1, s[12:15], s40 offen offset:1024 lds
    v_mfma_f32_16x16x32_bf16 a[40:43], v[160:163], v[88:91], a[40:43]
    v_exp_f32 v189, v53
    v_mfma_f32_16x16x32_bf16 a[44:47], v[160:163], v[92:95], a[44:47]
    v_exp_f32 v190, v54
    v_mfma_f32_16x16x32_bf16 a[48:51], v[164:167], v[80:83], a[48:51]
    ds_read_b128 v[152:155], v3 offset:0
    v_cvt_pk_bf16_f32 v100, v188, v189
    v_mfma_f32_16x16x32_bf16 a[52:55], v[164:167], v[84:87], a[52:55]
    v_exp_f32 v191, v55
    v_mfma_f32_16x16x32_bf16 a[56:59], v[164:167], v[88:91], a[56:59]
    v_cvt_pk_bf16_f32 v101, v190, v191
    v_mfma_f32_16x16x32_bf16 a[60:63], v[164:167], v[92:95], a[60:63]
    buffer_load_dwordx4 v1, s[12:15], s40 offen offset:2048 lds
    v_mfma_f32_16x16x32_bf16 v[132:135], v[12:15], v[84:87], v[132:135]
    v_exp_f32 v184, v56
    s_waitcnt lgkmcnt(3)
    v_mfma_f32_16x16x32_bf16 a[64:67], v[168:171], v[80:83], a[64:67]
    ds_read_b128 v[156:159], v3 offset:1024
    v_mfma_f32_16x16x32_bf16 a[68:71], v[168:171], v[84:87], a[68:71]
    v_exp_f32 v185, v57
    v_mfma_f32_16x16x32_bf16 a[72:75], v[168:171], v[88:91], a[72:75]
    v_exp_f32 v186, v58
    v_mfma_f32_16x16x32_bf16 a[76:79], v[168:171], v[92:95], a[76:79]
    buffer_load_dwordx4 v1, s[12:15], s40 offen offset:3072 lds
    v_mfma_f32_16x16x32_bf16 a[80:83], v[172:175], v[80:83], a[80:83]
    ds_read_b128 v[160:163], v3 offset:2048
    s_add_u32 m0, m0, 4096
    v_mfma_f32_16x16x32_bf16 a[84:87], v[172:175], v[84:87], a[84:87]
    v_exp_f32 v187, v59
    v_mfma_f32_16x16x32_bf16 a[88:91], v[172:175], v[88:91], a[88:91]
    v_exp_f32 v188, v60
    v_mfma_f32_16x16x32_bf16 a[92:95], v[172:175], v[92:95], a[92:95]
    v_cvt_pk_bf16_f32 v104, v184, v185
    v_cvt_pk_bf16_f32 v105, v186, v187
    v_mfma_f32_16x16x32_bf16 v[136:139], v[12:15], v[88:91], v[136:139]
    v_exp_f32 v189, v61
    s_waitcnt lgkmcnt(3)
    v_mfma_f32_16x16x32_bf16 a[96:99], v[176:179], v[80:83], a[96:99]
    ds_read_b128 v[164:167], v3 offset:3072
    v_cvt_pk_bf16_f32 v108, v188, v189
    v_mfma_f32_16x16x32_bf16 a[100:103], v[176:179], v[84:87], a[100:103]
    buffer_load_dwordx4 v2, s[12:15], s40 offen offset:0 lds
    v_mfma_f32_16x16x32_bf16 a[104:107], v[176:179], v[88:91], a[104:107]
    v_exp_f32 v190, v62
    v_mfma_f32_16x16x32_bf16 a[108:111], v[176:179], v[92:95], a[108:111]
    v_exp_f32 v191, v63
    v_mfma_f32_16x16x32_bf16 a[112:115], v[180:183], v[80:83], a[112:115]
    ds_read_b128 v[168:171], v3 offset:4096
    v_cvt_pk_bf16_f32 v109, v190, v191
    v_mfma_f32_16x16x32_bf16 a[116:119], v[180:183], v[84:87], a[116:119]
    v_exp_f32 v184, v64
    v_mfma_f32_16x16x32_bf16 a[120:123], v[180:183], v[88:91], a[120:123]
    buffer_load_dwordx4 v2, s[12:15], s40 offen offset:1024 lds
    v_mfma_f32_16x16x32_bf16 a[124:127], v[180:183], v[92:95], a[124:127]
    v_exp_f32 v185, v65
    v_mfma_f32_16x16x32_bf16 v[140:143], v[12:15], v[92:95], v[140:143]
    v_cvt_pk_bf16_f32 v98, v184, v185
    s_waitcnt lgkmcnt(3)
    v_mfma_f32_16x16x32_bf16 v[16:19], v[152:155], a[128:131], v[112:115]
    ds_read_b128 v[172:175], v3 offset:5120
    v_mfma_f32_16x16x32_bf16 v[20:23], v[152:155], a[132:135], v[116:119]
    v_exp_f32 v186, v66
    v_mfma_f32_16x16x32_bf16 v[24:27], v[152:155], a[136:139], v[120:123]
    v_exp_f32 v187, v67
    v_mfma_f32_16x16x32_bf16 v[28:31], v[152:155], a[140:143], v[124:127]
    buffer_load_dwordx4 v2, s[12:15], s40 offen offset:2048 lds
    v_mfma_f32_16x16x32_bf16 v[16:19], v[156:159], a[144:147], v[16:19]
    ds_read_b128 v[176:179], v3 offset:6144
    v_cvt_pk_bf16_f32 v99, v186, v187
    v_mfma_f32_16x16x32_bf16 v[20:23], v[156:159], a[148:151], v[20:23]
    v_exp_f32 v188, v68
    v_mfma_f32_16x16x32_bf16 v[24:27], v[156:159], a[152:155], v[24:27]
    v_exp_f32 v189, v69
    v_mfma_f32_16x16x32_bf16 v[28:31], v[156:159], a[156:159], v[28:31]
    v_cvt_pk_bf16_f32 v102, v188, v189
    s_waitcnt lgkmcnt(3)
    v_mfma_f32_16x16x32_bf16 v[16:19], v[160:163], a[160:163], v[16:19]
    ds_read_b128 v[180:183], v3 offset:7168
    v_mfma_f32_16x16x32_bf16 v[20:23], v[160:163], a[164:167], v[20:23]
    buffer_load_dwordx4 v2, s[12:15], s40 offen offset:3072 lds
    v_mfma_f32_16x16x32_bf16 v[24:27], v[160:163], a[168:171], v[24:27]
    v_exp_f32 v190, v70
    v_mfma_f32_16x16x32_bf16 v[28:31], v[160:163], a[172:175], v[28:31]
    v_exp_f32 v191, v71
    v_mfma_f32_16x16x32_bf16 v[16:19], v[164:167], a[176:179], v[16:19]
    v_exp_f32 v184, v72
    v_mfma_f32_16x16x32_bf16 v[20:23], v[164:167], a[180:183], v[20:23]
    v_cvt_pk_bf16_f32 v103, v190, v191
    v_mfma_f32_16x16x32_bf16 v[24:27], v[164:167], a[184:187], v[24:27]
    v_exp_f32 v185, v73
    v_mfma_f32_16x16x32_bf16 v[28:31], v[164:167], a[188:191], v[28:31]
    v_cvt_pk_bf16_f32 v106, v184, v185
    s_waitcnt lgkmcnt(2)
    v_mfma_f32_16x16x32_bf16 v[32:35], v[168:171], a[128:131], v[112:115]
    v_exp_f32 v186, v74
    v_mfma_f32_16x16x32_bf16 v[36:39], v[168:171], a[132:135], v[116:119]
    v_mfma_f32_16x16x32_bf16 v[40:43], v[168:171], a[136:139], v[120:123]
    v_exp_f32 v187, v75
    v_mfma_f32_16x16x32_bf16 v[44:47], v[168:171], a[140:143], v[124:127]
    v_cvt_pk_bf16_f32 v107, v186, v187
    s_waitcnt vmcnt(18) lgkmcnt(0)
    s_barrier
    v_mfma_f32_16x16x32_bf16 v[32:35], v[172:175], a[144:147], v[32:35]
    ds_read_b128 v[152:155], v4 offset:8192
    v_mfma_f32_16x16x32_bf16 v[36:39], v[172:175], a[148:151], v[36:39]
    ds_read_b128 v[156:159], v4 offset:9216
    v_mfma_f32_16x16x32_bf16 v[40:43], v[172:175], a[152:155], v[40:43]
    v_exp_f32 v188, v76
    v_mfma_f32_16x16x32_bf16 v[44:47], v[172:175], a[156:159], v[44:47]
    v_exp_f32 v189, v77
    v_mfma_f32_16x16x32_bf16 v[32:35], v[176:179], a[160:163], v[32:35]
    ds_read_b128 v[160:163], v4 offset:10240
    v_cvt_pk_bf16_f32 v110, v188, v189
    v_mfma_f32_16x16x32_bf16 v[36:39], v[176:179], a[164:167], v[36:39]
    ds_read_b128 v[164:167], v4 offset:11264
    v_mfma_f32_16x16x32_bf16 v[40:43], v[176:179], a[168:171], v[40:43]
    v_exp_f32 v190, v78
    v_mfma_f32_16x16x32_bf16 v[44:47], v[176:179], a[172:175], v[44:47]
    v_exp_f32 v191, v79
    v_mfma_f32_16x16x32_bf16 v[32:35], v[180:183], a[176:179], v[32:35]
    ds_read_b128 v[168:171], v4 offset:12288
    v_cvt_pk_bf16_f32 v111, v190, v191
    v_mfma_f32_16x16x32_bf16 v[36:39], v[180:183], a[180:183], v[36:39]
    v_mfma_f32_16x16x32_bf16 v[40:43], v[180:183], a[184:187], v[40:43]
    v_mfma_f32_16x16x32_bf16 v[44:47], v[180:183], a[188:191], v[44:47]
    s_waitcnt lgkmcnt(3)
    v_mfma_f32_16x16x32_bf16 a[0:3], v[152:155], v[96:99], a[0:3]
    ds_read_b128 v[172:175], v4 offset:13312
    s_add_u32 s40, s40, s41
    v_mfma_f32_16x16x32_bf16 a[4:7], v[152:155], v[100:103], a[4:7]
    v_exp_f32 v184, v16
    v_mfma_f32_16x16x32_bf16 a[8:11], v[152:155], v[104:107], a[8:11]
    v_exp_f32 v185, v17
    v_mfma_f32_16x16x32_bf16 a[12:15], v[152:155], v[108:111], a[12:15]
    s_min_u32 s40, s40, 0x7000000
    s_add_u32 s42, s42, 8192
    v_mfma_f32_16x16x32_bf16 a[16:19], v[156:159], v[96:99], a[16:19]
    ds_read_b128 v[176:179], v4 offset:14336
    s_and_b32 s42, s42, 0x7fff
    v_mfma_f32_16x16x32_bf16 a[20:23], v[156:159], v[100:103], a[20:23]
    v_exp_f32 v186, v18
    v_mfma_f32_16x16x32_bf16 a[24:27], v[156:159], v[104:107], a[24:27]
    v_exp_f32 v187, v19
    v_mfma_f32_16x16x32_bf16 a[28:31], v[156:159], v[108:111], a[28:31]
    s_add_u32 m0, s42, s43
    v_cvt_pk_bf16_f32 v80, v184, v185
    v_mfma_f32_16x16x32_bf16 v[128:131], v[12:15], v[96:99], v[128:131]
    buffer_load_dwordx4 v1, s[12:15], s40 offen offset:0 lds
    s_waitcnt lgkmcnt(3)
    v_mfma_f32_16x16x32_bf16 a[32:35], v[160:163], v[96:99], a[32:35]
    ds_read_b128 v[180:183], v4 offset:15360
    v_cvt_pk_bf16_f32 v81, v186, v187
    v_mfma_f32_16x16x32_bf16 a[36:39], v[160:163], v[100:103], a[36:39]
    buffer_load_dwordx4 v1, s[12:15], s40 offen offset:1024 lds
    v_mfma_f32_16x16x32_bf16 a[40:43], v[160:163], v[104:107], a[40:43]
    v_exp_f32 v188, v20
    v_mfma_f32_16x16x32_bf16 a[44:47], v[160:163], v[108:111], a[44:47]
    v_exp_f32 v189, v21
    v_mfma_f32_16x16x32_bf16 a[48:51], v[164:167], v[96:99], a[48:51]
    ds_read_b128 v[152:155], v3 offset:8192
    v_cvt_pk_bf16_f32 v84, v188, v189
    v_mfma_f32_16x16x32_bf16 a[52:55], v[164:167], v[100:103], a[52:55]
    buffer_load_dwordx4 v1, s[12:15], s40 offen offset:2048 lds
    v_mfma_f32_16x16x32_bf16 a[56:59], v[164:167], v[104:107], a[56:59]
    v_exp_f32 v190, v22
    v_mfma_f32_16x16x32_bf16 a[60:63], v[164:167], v[108:111], a[60:63]
    v_exp_f32 v191, v23
    v_mfma_f32_16x16x32_bf16 v[132:135], v[12:15], v[100:103], v[132:135]
    buffer_load_dwordx4 v1, s[12:15], s40 offen offset:3072 lds
    s_waitcnt lgkmcnt(3)
    v_mfma_f32_16x16x32_bf16 a[64:67], v[168:171], v[96:99], a[64:67]
    ds_read_b128 v[156:159], v3 offset:9216
    s_add_u32 m0, m0, 4096
    v_mfma_f32_16x16x32_bf16 a[68:71], v[168:171], v[100:103], a[68:71]
    v_exp_f32 v184, v24
    v_mfma_f32_16x16x32_bf16 a[72:75], v[168:171], v[104:107], a[72:75]
    v_exp_f32 v185, v25
    v_mfma_f32_16x16x32_bf16 a[76:79], v[168:171], v[108:111], a[76:79]
    buffer_load_dwordx4 v2, s[12:15], s40 offen offset:0 lds
    v_mfma_f32_16x16x32_bf16 a[80:83], v[172:175], v[96:99], a[80:83]
    ds_read_b128 v[160:163], v3 offset:10240
    v_cvt_pk_bf16_f32 v85, v190, v191
    v_mfma_f32_16x16x32_bf16 a[84:87], v[172:175], v[100:103], a[84:87]
    v_exp_f32 v186, v26
    v_mfma_f32_16x16x32_bf16 a[88:91], v[172:175], v[104:107], a[88:91]
    v_exp_f32 v187, v27
    v_mfma_f32_16x16x32_bf16 a[92:95], v[172:175], v[108:111], a[92:95]
    buffer_load_dwordx4 v2, s[12:15], s40 offen offset:1024 lds
    v_mfma_f32_16x16x32_bf16 v[136:139], v[12:15], v[104:107], v[136:139]
    v_exp_f32 v188, v28
    s_waitcnt lgkmcnt(3)
    v_mfma_f32_16x16x32_bf16 a[96:99], v[176:179], v[96:99], a[96:99]
    ds_read_b128 v[164:167], v3 offset:11264
    v_cvt_pk_bf16_f32 v88, v184, v185
    v_mfma_f32_16x16x32_bf16 a[100:103], v[176:179], v[100:103], a[100:103]
    v_exp_f32 v189, v29
    v_mfma_f32_16x16x32_bf16 a[104:107], v[176:179], v[104:107], a[104:107]
    buffer_load_dwordx4 v2, s[12:15], s40 offen offset:2048 lds
    v_mfma_f32_16x16x32_bf16 a[108:111], v[176:179], v[108:111], a[108:111]
    v_exp_f32 v190, v30
    v_mfma_f32_16x16x32_bf16 a[112:115], v[180:183], v[96:99], a[112:115]
    ds_read_b128 v[168:171], v3 offset:12288
    v_cvt_pk_bf16_f32 v89, v186, v187
    v_mfma_f32_16x16x32_bf16 a[116:119], v[180:183], v[100:103], a[116:119]
    buffer_load_dwordx4 v2, s[12:15], s40 offen offset:3072 lds
    v_mfma_f32_16x16x32_bf16 a[120:123], v[180:183], v[104:107], a[120:123]
    v_exp_f32 v191, v31
    v_mfma_f32_16x16x32_bf16 a[124:127], v[180:183], v[108:111], a[124:127]
    v_exp_f32 v184, v32
    v_mfma_f32_16x16x32_bf16 v[140:143], v[12:15], v[108:111], v[140:143]
    v_exp_f32 v185, v33
    s_waitcnt lgkmcnt(3)
    v_mfma_f32_16x16x32_bf16 v[48:51], v[152:155], a[128:131], v[112:115]
    ds_read_b128 v[172:175], v3 offset:13312
    s_waitcnt vmcnt(17)
    v_mfma_f32_16x16x32_bf16 v[52:55], v[152:155], a[132:135], v[116:119]
    v_exp_f32 v186, v34
    v_mfma_f32_16x16x32_bf16 v[56:59], v[152:155], a[136:139], v[120:123]
    v_exp_f32 v187, v35
    v_mfma_f32_16x16x32_bf16 v[60:63], v[152:155], a[140:143], v[124:127]
    v_dot2c_f32_bf16 v0, v12, v10
    v_dot2c_f32_bf16 v0, v12, v11
    v_mfma_f32_16x16x32_bf16 v[48:51], v[156:159], a[144:147], v[48:51]
    ds_read_b128 v[176:179], v3 offset:14336
    v_cvt_pk_bf16_f32 v92, v188, v189
    v_mfma_f32_16x16x32_bf16 v[52:55], v[156:159], a[148:151], v[52:55]
    buffer_load_dwordx2 v[10:11], v9, s[20:23], 0 offen
    v_mfma_f32_16x16x32_bf16 v[56:59], v[156:159], a[152:155], v[56:59]
    v_exp_f32 v188, v36
    v_mfma_f32_16x16x32_bf16 v[60:63], v[156:159], a[156:159], v[60:63]
    v_exp_f32 v189, v37
    s_waitcnt lgkmcnt(3)
    v_mfma_f32_16x16x32_bf16 v[48:51], v[160:163], a[160:163], v[48:51]
    ds_read_b128 v[180:183], v3 offset:15360
    v_add_u32 v9, s69, v9
    v_mfma_f32_16x16x32_bf16 v[52:55], v[160:163], a[164:167], v[52:55]
    buffer_store_dwordx4 v[148:151], v1, s[64:67], s68 offen sc0 sc1
    v_mfma_f32_16x16x32_bf16 v[56:59], v[160:163], a[168:171], v[56:59]
    v_cvt_pk_bf16_f32 v93, v190, v191
    v_cvt_pk_bf16_f32 v82, v184, v185
    v_mfma_f32_16x16x32_bf16 v[60:63], v[160:163], a[172:175], v[60:63]
    v_exp_f32 v190, v38
    v_mfma_f32_16x16x32_bf16 v[48:51], v[164:167], a[176:179], v[48:51]
    v_exp_f32 v191, v39
    v_mfma_f32_16x16x32_bf16 v[52:55], v[164:167], a[180:183], v[52:55]
    v_exp_f32 v184, v40
    s_add_u32 s68, s68, 1048576
    v_mfma_f32_16x16x32_bf16 v[56:59], v[164:167], a[184:187], v[56:59]
    v_exp_f32 v185, v41
    v_mfma_f32_16x16x32_bf16 v[60:63], v[164:167], a[188:191], v[60:63]
    v_cvt_pk_bf16_f32 v83, v186, v187
    v_cvt_pk_bf16_f32 v86, v188, v189
    s_waitcnt lgkmcnt(2)
    v_mfma_f32_16x16x32_bf16 v[64:67], v[168:171], a[128:131], v[112:115]
    v_exp_f32 v186, v42
    v_mfma_f32_16x16x32_bf16 v[68:71], v[168:171], a[132:135], v[116:119]
    v_cvt_pk_bf16_f32 v87, v190, v191
    v_cvt_pk_bf16_f32 v90, v184, v185
    v_mfma_f32_16x16x32_bf16 v[72:75], v[168:171], a[136:139], v[120:123]
    v_exp_f32 v187, v43
    v_mfma_f32_16x16x32_bf16 v[76:79], v[168:171], a[140:143], v[124:127]
    v_cvt_pk_bf16_f32 v91, v186, v187
    s_waitcnt vmcnt(20) lgkmcnt(0)
    s_barrier
    v_xor_b32 v4, 0x4000, v4
    v_xor_b32 v3, 0x4000, v3
    v_mfma_f32_16x16x32_bf16 v[64:67], v[172:175], a[144:147], v[64:67]
    ds_read_b128 v[152:155], v4 offset:0
    v_mfma_f32_16x16x32_bf16 v[68:71], v[172:175], a[148:151], v[68:71]
    ds_read_b128 v[156:159], v4 offset:1024
    v_mfma_f32_16x16x32_bf16 v[72:75], v[172:175], a[152:155], v[72:75]
    v_exp_f32 v188, v44
    v_mfma_f32_16x16x32_bf16 v[76:79], v[172:175], a[156:159], v[76:79]
    v_exp_f32 v189, v45
    v_mfma_f32_16x16x32_bf16 v[64:67], v[176:179], a[160:163], v[64:67]
    ds_read_b128 v[160:163], v4 offset:2048
    v_cvt_pk_bf16_f32 v94, v188, v189
    v_mfma_f32_16x16x32_bf16 v[68:71], v[176:179], a[164:167], v[68:71]
    ds_read_b128 v[164:167], v4 offset:3072
    v_mfma_f32_16x16x32_bf16 v[72:75], v[176:179], a[168:171], v[72:75]
    v_exp_f32 v190, v46
    v_mfma_f32_16x16x32_bf16 v[76:79], v[176:179], a[172:175], v[76:79]
    v_exp_f32 v191, v47
    v_mfma_f32_16x16x32_bf16 v[64:67], v[180:183], a[176:179], v[64:67]
    ds_read_b128 v[168:171], v4 offset:4096
    v_cvt_pk_bf16_f32 v95, v190, v191
    v_mfma_f32_16x16x32_bf16 v[68:71], v[180:183], a[180:183], v[68:71]
    v_mfma_f32_16x16x32_bf16 v[72:75], v[180:183], a[184:187], v[72:75]
    v_mfma_f32_16x16x32_bf16 v[76:79], v[180:183], a[188:191], v[76:79]
    s_add_u32 s30, s30, 1
    s_cmp_lg_u32 s30, s31
    s_cbranch_scc1 K2_MD
    s_cmp_ge_u32 s24, 2
    s_cbranch_scc1 K2_S1
    s_waitcnt lgkmcnt(3)
    v_mfma_f32_16x16x32_bf16 a[0:3], v[152:155], v[80:83], a[0:3]
    ds_read_b128 v[172:175], v4 offset:5120
    v_exp_f32 v184, v48
    v_mfma_f32_16x16x32_bf16 a[4:7], v[152:155], v[84:87], a[4:7]
    v_exp_f32 v185, v49
    s_lshl_b32 s44, s27, 17
    v_mfma_f32_16x16x32_bf16 a[8:11], v[152:155], v[88:91], a[8:11]
    v_exp_f32 v186, v50
    v_cvt_pk_bf16_f32 v96, v184, v185
    v_mfma_f32_16x16x32_bf16 a[12:15], v[152:155], v[92:95], a[12:15]
    v_exp_f32 v187, v51
    s_lshl_b32 s45, s25, 12
    v_mfma_f32_16x16x32_bf16 a[16:19], v[156:159], v[80:83], a[16:19]
    ds_read_b128 v[176:179], v4 offset:6144
    v_exp_f32 v188, v52
    v_mfma_f32_16x16x32_bf16 a[20:23], v[156:159], v[84:87], a[20:23]
    v_exp_f32 v189, v53
    v_cvt_pk_bf16_f32 v97, v186, v187
    v_mfma_f32_16x16x32_bf16 a[24:27], v[156:159], v[88:91], a[24:27]
    v_exp_f32 v190, v54
    v_cvt_pk_bf16_f32 v100, v188, v189
    v_mfma_f32_16x16x32_bf16 a[28:31], v[156:159], v[92:95], a[28:31]
    v_exp_f32 v191, v55
    v_mfma_f32_16x16x32_bf16 v[128:131], v[12:15], v[80:83], v[128:131]
    v_exp_f32 v184, v56
    v_cvt_pk_bf16_f32 v101, v190, v191
    s_waitcnt lgkmcnt(3)
    v_mfma_f32_16x16x32_bf16 a[32:35], v[160:163], v[80:83], a[32:35]
    ds_read_b128 v[180:183], v4 offset:7168
    v_exp_f32 v185, v57
    v_mfma_f32_16x16x32_bf16 a[36:39], v[160:163], v[84:87], a[36:39]
    v_exp_f32 v186, v58
    v_cvt_pk_bf16_f32 v104, v184, v185
    v_mfma_f32_16x16x32_bf16 a[40:43], v[160:163], v[88:91], a[40:43]
    v_exp_f32 v187, v59
    s_add_u32 s44, s44, s45
    v_mfma_f32_16x16x32_bf16 a[44:47], v[160:163], v[92:95], a[44:47]
    v_exp_f32 v188, v60
    v_cvt_pk_bf16_f32 v105, v186, v187
    v_mfma_f32_16x16x32_bf16 a[48:51], v[164:167], v[80:83], a[48:51]
    v_exp_f32 v189, v61
    v_mfma_f32_16x16x32_bf16 a[52:55], v[164:167], v[84:87], a[52:55]
    v_exp_f32 v190, v62
    v_cvt_pk_bf16_f32 v108, v188, v189
    v_mfma_f32_16x16x32_bf16 a[56:59], v[164:167], v[88:91], a[56:59]
    v_exp_f32 v191, v63
    s_lshl_b32 s45, s24, 2
    v_mfma_f32_16x16x32_bf16 a[60:63], v[164:167], v[92:95], a[60:63]
    v_cvt_pk_bf16_f32 v109, v190, v191
    v_mfma_f32_16x16x32_bf16 v[132:135], v[12:15], v[84:87], v[132:135]
    v_exp_f32 v184, v64
    s_waitcnt lgkmcnt(2)
    v_mfma_f32_16x16x32_bf16 a[64:67], v[168:171], v[80:83], a[64:67]
    v_exp_f32 v185, v65
    v_mfma_f32_16x16x32_bf16 a[68:71], v[168:171], v[84:87], a[68:71]
    v_exp_f32 v186, v66
    v_cvt_pk_bf16_f32 v98, v184, v185
    v_mfma_f32_16x16x32_bf16 a[72:75], v[168:171], v[88:91], a[72:75]
    v_exp_f32 v187, v67
    v_add_u32 v3, 135168, v1
    v_mfma_f32_16x16x32_bf16 a[76:79], v[168:171], v[92:95], a[76:79]
    v_exp_f32 v188, v68
    v_cvt_pk_bf16_f32 v99, v186, v187
    s_waitcnt vmcnt(10) lgkmcnt(0)
    s_barrier
    v_mfma_f32_16x16x32_bf16 a[80:83], v[172:175], v[80:83], a[80:83]
    ds_read_b128 v[152:155], v4 offset:8192
    v_exp_f32 v189, v69
    v_mfma_f32_16x16x32_bf16 a[84:87], v[172:175], v[84:87], a[84:87]
    ds_read_b128 v[156:159], v4 offset:9216
    v_exp_f32 v190, v70
    v_mfma_f32_16x16x32_bf16 a[88:91], v[172:175], v[88:91], a[88:91]
    v_exp_f32 v191, v71
    v_cvt_pk_bf16_f32 v102, v188, v189
    v_mfma_f32_16x16x32_bf16 a[92:95], v[172:175], v[92:95], a[92:95]
    v_exp_f32 v184, v72
    v_cvt_pk_bf16_f32 v103, v190, v191
    v_mfma_f32_16x16x32_bf16 v[136:139], v[12:15], v[88:91], v[136:139]
    v_exp_f32 v185, v73
    v_add_u32 v9, s45, v3
    v_mfma_f32_16x16x32_bf16 a[96:99], v[176:179], v[80:83], a[96:99]
    ds_read_b128 v[160:163], v4 offset:10240
    v_exp_f32 v186, v74
    v_mfma_f32_16x16x32_bf16 a[100:103], v[176:179], v[84:87], a[100:103]
    ds_read_b128 v[164:167], v4 offset:11264
    v_exp_f32 v187, v75
    v_mfma_f32_16x16x32_bf16 a[104:107], v[176:179], v[88:91], a[104:107]
    v_exp_f32 v188, v76
    v_cvt_pk_bf16_f32 v106, v184, v185
    v_mfma_f32_16x16x32_bf16 a[108:111], v[176:179], v[92:95], a[108:111]
    v_exp_f32 v189, v77
    v_cvt_pk_bf16_f32 v107, v186, v187
    v_mfma_f32_16x16x32_bf16 a[112:115], v[180:183], v[80:83], a[112:115]
    ds_read_b128 v[168:171], v4 offset:12288
    v_exp_f32 v190, v78
    v_mfma_f32_16x16x32_bf16 a[116:119], v[180:183], v[84:87], a[116:119]
    v_exp_f32 v191, v79
    v_cvt_pk_bf16_f32 v110, v188, v189
    v_mfma_f32_16x16x32_bf16 a[120:123], v[180:183], v[88:91], a[120:123]
    v_cvt_pk_bf16_f32 v111, v190, v191
    v_mfma_f32_16x16x32_bf16 a[124:127], v[180:183], v[92:95], a[124:127]
    v_mfma_f32_16x16x32_bf16 v[140:143], v[12:15], v[92:95], v[140:143]
    ds_read_b128 v[144:147], v7
    ds_read_b128 v[172:175], v4 offset:13312
    ds_read_b128 v[176:179], v4 offset:14336
    ds_read_b128 v[180:183], v4 offset:15360
    v_mfma_f32_16x16x32_bf16 v[128:131], v[12:15], v[96:99], v[128:131]
    v_mfma_f32_16x16x32_bf16 v[132:135], v[12:15], v[100:103], v[132:135]
    v_mfma_f32_16x16x32_bf16 v[136:139], v[12:15], v[104:107], v[136:139]
    v_mfma_f32_16x16x32_bf16 v[140:143], v[12:15], v[108:111], v[140:143]
    s_waitcnt lgkmcnt(8)
    v_mfma_f32_16x16x32_bf16 a[0:3], v[152:155], v[96:99], a[0:3]
    ds_read_b128 v[192:195], v8 offset:0
    ds_read_b128 v[196:199], v8 offset:1024
    ds_read_b128 v[200:203], v8 offset:16384
    v_mfma_f32_16x16x32_bf16 a[4:7], v[152:155], v[100:103], a[4:7]
    ds_read_b128 v[204:207], v8 offset:17408
    ds_read_b128 v[208:211], v8 offset:2048
    ds_read_b128 v[212:215], v8 offset:3072
    v_mfma_f32_16x16x32_bf16 a[8:11], v[152:155], v[104:107], a[8:11]
    ds_read_b128 v[216:219], v8 offset:18432
    ds_read_b128 v[220:223], v8 offset:19456
    s_waitcnt lgkmcnt(11)
    v_mfma_f32_16x16x32_bf16 a[12:15], v[152:155], v[108:111], a[12:15]
    v_add_f32 v129, v129, v144
    v_add_f32 v133, v133, v145
    v_add_f32 v137, v137, v146
    v_mfma_f32_16x16x32_bf16 a[16:19], v[156:159], v[96:99], a[16:19]
    v_add_f32 v141, v141, v147
    v_rcp_f32 v128, v129
    v_rcp_f32 v132, v133
    v_mfma_f32_16x16x32_bf16 a[20:23], v[156:159], v[100:103], a[20:23]
    v_rcp_f32 v136, v137
    v_rcp_f32 v140, v141
    ds_read_b128 v[224:227], v8 offset:4096
    v_mfma_f32_16x16x32_bf16 a[24:27], v[156:159], v[104:107], a[24:27]
    ds_read_b128 v[228:231], v8 offset:5120
    ds_read_b128 v[232:235], v8 offset:20480
    ds_read_b128 v[236:239], v8 offset:21504
    v_mfma_f32_16x16x32_bf16 a[28:31], v[156:159], v[108:111], a[28:31]
    ds_read_b128 v[240:243], v8 offset:6144
    ds_read_b128 v[244:247], v8 offset:7168
    ds_read_b128 v[248:251], v8 offset:22528
    v_mfma_f32_16x16x32_bf16 a[32:35], v[160:163], v[96:99], a[32:35]
    ds_read_b128 v[252:255], v8 offset:23552
    v_max3_f32 v11, v128, v129, v132
    v_max3_f32 v11, v11, v133, v136
    v_mfma_f32_16x16x32_bf16 a[36:39], v[160:163], v[100:103], a[36:39]
    v_max3_f32 v11, v11, v137, v140
    v_max_f32 v11, v11, v141
    ds_write_b32 v9, v11
    v_mfma_f32_16x16x32_bf16 a[40:43], v[160:163], v[104:107], a[40:43]
    s_waitcnt vmcnt(2)
    v_lshl_add_u32 v146, v1, 16, s34
    v_and_b32 v146, 0xffffff00, v146
    v_mfma_f32_16x16x32_bf16 a[44:47], v[160:163], v[108:111], a[44:47]
    s_and_b32 s51, s34, 0x7f000000
    v_add_u32 v145, s51, v1
    buffer_load_dwordx4 v[148:151], v145, s[92:95], 0 offen sc0 sc1
    s_lshl_b32 s50, s2, 8
    v_mfma_f32_16x16x32_bf16 a[48:51], v[164:167], v[96:99], a[48:51]
    s_getpc_b64 s[46:47]
K2_PCM0:
    s_bfe_u32 s48, s2, 0x30003
    s_lshl_b32 s48, s48, 13
    s_add_u32 s48, s48, KT_ENTRY-K2_PCM0
    v_lshl_add_u32 v147, v1, 3, s48
    v_mfma_f32_16x16x32_bf16 a[52:55], v[164:167], v[100:103], a[52:55]
    v_min_u32 v147, CODE_END-K2_PCM0-4, v147
    global_load_dword v147, v147, s[46:47]
    s_lshr_b32 s46, s2, 3
    s_lshl_b32 s46, s46, 2
    s_add_u32 s46, s46, s24
    s_bfe_u32 s47, s2, 0x20001
    v_mfma_f32_16x16x32_bf16 a[56:59], v[164:167], v[104:107], a[56:59]
    s_mov_b32 s4, s54
    s_mov_b32 s5, s55
    s_mov_b32 s6, 4718592
    s_lshl_b32 s48, s47, 7
    s_add_u32 s48, s48, s46
    s_mul_i32 s48, s48, 9216
    v_lshrrev_b32 v144, 7, v1
    v_mfma_f32_16x16x32_bf16 a[60:63], v[164:167], v[108:111], a[60:63]
    v_and_b32 v5, 0x70, v1
    v_mul_u32_u24 v144, 1152, v144
    v_lshl_add_u32 v144, v5, 3, v144
    v_mfma_f32_16x16x32_bf16 a[64:67], v[168:171], v[96:99], a[64:67]
    buffer_load_dword v144, v144, s[4:7], s48 offen
    v_accvgpr_read_b32 v112, a0
    v_accvgpr_read_b32 v113, a1
    v_mfma_f32_16x16x32_bf16 a[68:71], v[168:171], v[100:103], a[68:71]
    v_accvgpr_read_b32 v114, a2
    v_accvgpr_read_b32 v115, a3
    v_accvgpr_read_b32 v116, a16
    v_mfma_f32_16x16x32_bf16 a[72:75], v[168:171], v[104:107], a[72:75]
    v_accvgpr_read_b32 v117, a17
    v_accvgpr_read_b32 v118, a18
    v_accvgpr_read_b32 v119, a19
    v_mfma_f32_16x16x32_bf16 a[76:79], v[168:171], v[108:111], a[76:79]
    v_accvgpr_read_b32 v120, a4
    v_accvgpr_read_b32 v121, a5
    v_accvgpr_read_b32 v122, a6
    s_waitcnt lgkmcnt(15)
    v_mfma_f32_16x16x32_bf16 a[80:83], v[172:175], v[96:99], a[80:83]
    v_accvgpr_read_b32 v123, a7
    v_accvgpr_read_b32 v124, a20
    v_accvgpr_read_b32 v125, a21
    v_mfma_f32_16x16x32_bf16 a[84:87], v[172:175], v[100:103], a[84:87]
    v_accvgpr_read_b32 v126, a22
    v_accvgpr_read_b32 v127, a23
    v_accvgpr_read_b32 v80, a8
    v_mfma_f32_16x16x32_bf16 a[88:91], v[172:175], v[104:107], a[88:91]
    v_accvgpr_read_b32 v81, a9
    v_accvgpr_read_b32 v82, a10
    v_accvgpr_read_b32 v83, a11
    v_mfma_f32_16x16x32_bf16 a[92:95], v[172:175], v[108:111], a[92:95]
    v_accvgpr_read_b32 v84, a24
    v_accvgpr_read_b32 v85, a25
    v_accvgpr_read_b32 v86, a26
    v_mfma_f32_16x16x32_bf16 a[96:99], v[176:179], v[96:99], a[96:99]
    v_accvgpr_read_b32 v87, a27
    v_accvgpr_read_b32 v88, a12
    v_accvgpr_read_b32 v89, a13
    v_mfma_f32_16x16x32_bf16 a[100:103], v[176:179], v[100:103], a[100:103]
    v_accvgpr_read_b32 v90, a14
    v_accvgpr_read_b32 v91, a15
    v_accvgpr_read_b32 v92, a28
    v_mfma_f32_16x16x32_bf16 a[104:107], v[176:179], v[104:107], a[104:107]
    v_accvgpr_read_b32 v93, a29
    v_accvgpr_read_b32 v94, a30
    v_accvgpr_read_b32 v95, a31
    v_mfma_f32_16x16x32_bf16 a[108:111], v[176:179], v[108:111], a[108:111]
    ds_read_b128 v[16:19], v8 offset:8192
    ds_read_b128 v[20:23], v8 offset:9216
    ds_read_b128 v[24:27], v8 offset:24576
    v_mfma_f32_16x16x32_bf16 a[112:115], v[180:183], v[96:99], a[112:115]
    ds_read_b128 v[28:31], v8 offset:25600
    ds_read_b128 v[32:35], v8 offset:10240
    ds_read_b128 v[36:39], v8 offset:11264
    v_mfma_f32_16x16x32_bf16 a[116:119], v[180:183], v[100:103], a[116:119]
    ds_read_b128 v[40:43], v8 offset:26624
    ds_read_b128 v[44:47], v8 offset:27648
    s_waitcnt lgkmcnt(15)
    v_mfma_f32_16x16x32_bf16 a[120:123], v[180:183], v[104:107], a[120:123]
    v_pk_add_f32 v[112:113], v[112:113], v[192:193]
    v_pk_add_f32 v[114:115], v[114:115], v[194:195]
    v_pk_add_f32 v[116:117], v[116:117], v[208:209]
    v_mfma_f32_16x16x32_bf16 a[124:127], v[180:183], v[108:111], a[124:127]
    v_pk_add_f32 v[118:119], v[118:119], v[210:211]
    v_pk_mul_f32 v[112:113], v[112:113], v[128:129] op_sel_hi:[1,0]
    v_pk_mul_f32 v[114:115], v[114:115], v[128:129] op_sel_hi:[1,0]
    v_pk_mul_f32 v[116:117], v[116:117], v[128:129] op_sel_hi:[1,0]
    v_pk_mul_f32 v[118:119], v[118:119], v[128:129] op_sel_hi:[1,0]
    v_cvt_pk_bf16_f32 v112, v112, v113
    v_cvt_pk_bf16_f32 v113, v114, v115
    v_cvt_pk_bf16_f32 v114, v116, v117
    v_cvt_pk_bf16_f32 v115, v118, v119
    s_add_u32 s45, s44, 0
    buffer_store_dwordx4 v[112:115], v1, s[16:19], s45 offen offset:0 sc0 sc1
    v_pk_add_f32 v[120:121], v[120:121], v[196:197]
    v_pk_add_f32 v[122:123], v[122:123], v[198:199]
    v_pk_add_f32 v[124:125], v[124:125], v[212:213]
    v_pk_add_f32 v[126:127], v[126:127], v[214:215]
    v_pk_mul_f32 v[120:121], v[120:121], v[132:133] op_sel_hi:[1,0]
    v_pk_mul_f32 v[122:123], v[122:123], v[132:133] op_sel_hi:[1,0]
    v_pk_mul_f32 v[124:125], v[124:125], v[132:133] op_sel_hi:[1,0]
    v_pk_mul_f32 v[126:127], v[126:127], v[132:133] op_sel_hi:[1,0]
    v_cvt_pk_bf16_f32 v120, v120, v121
    v_cvt_pk_bf16_f32 v121, v122, v123
    v_cvt_pk_bf16_f32 v122, v124, v125
    v_cvt_pk_bf16_f32 v123, v126, v127
    s_add_u32 s45, s44, 131072
    buffer_store_dwordx4 v[120:123], v1, s[16:19], s45 offen offset:0 sc0 sc1
    v_pk_add_f32 v[80:81], v[80:81], v[200:201]
    v_pk_add_f32 v[82:83], v[82:83], v[202:203]
    v_pk_add_f32 v[84:85], v[84:85], v[216:217]
    v_pk_add_f32 v[86:87], v[86:87], v[218:219]
    v_pk_mul_f32 v[80:81], v[80:81], v[136:137] op_sel_hi:[1,0]
    v_pk_mul_f32 v[82:83], v[82:83], v[136:137] op_sel_hi:[1,0]
    v_pk_mul_f32 v[84:85], v[84:85], v[136:137] op_sel_hi:[1,0]
    v_pk_mul_f32 v[86:87], v[86:87], v[136:137] op_sel_hi:[1,0]
    v_cvt_pk_bf16_f32 v80, v80, v81
    v_cvt_pk_bf16_f32 v81, v82, v83
    v_cvt_pk_bf16_f32 v82, v84, v85
    v_cvt_pk_bf16_f32 v83, v86, v87
    s_add_u32 s45, s44, 262144
    buffer_store_dwordx4 v[80:83], v1, s[16:19], s45 offen offset:0 sc0 sc1
    v_pk_add_f32 v[88:89], v[88:89], v[204:205]
    v_pk_add_f32 v[90:91], v[90:91], v[206:207]
    v_pk_add_f32 v[92:93], v[92:93], v[220:221]
    v_pk_add_f32 v[94:95], v[94:95], v[222:223]
    v_pk_mul_f32 v[88:89], v[88:89], v[140:141] op_sel_hi:[1,0]
    v_pk_mul_f32 v[90:91], v[90:91], v[140:141] op_sel_hi:[1,0]
    v_pk_mul_f32 v[92:93], v[92:93], v[140:141] op_sel_hi:[1,0]
    v_pk_mul_f32 v[94:95], v[94:95], v[140:141] op_sel_hi:[1,0]
    v_cvt_pk_bf16_f32 v88, v88, v89
    v_cvt_pk_bf16_f32 v89, v90, v91
    v_cvt_pk_bf16_f32 v90, v92, v93
    v_cvt_pk_bf16_f32 v91, v94, v95
    s_add_u32 s45, s44, 393216
    buffer_store_dwordx4 v[88:91], v1, s[16:19], s45 offen offset:0 sc0 sc1
    v_accvgpr_read_b32 v112, a32
    v_accvgpr_read_b32 v113, a33
    v_accvgpr_read_b32 v114, a34
    v_accvgpr_read_b32 v115, a35
    v_accvgpr_read_b32 v116, a48
    v_accvgpr_read_b32 v117, a49
    v_accvgpr_read_b32 v118, a50
    v_accvgpr_read_b32 v119, a51
    v_accvgpr_read_b32 v120, a36
    v_accvgpr_read_b32 v121, a37
    v_accvgpr_read_b32 v122, a38
    v_accvgpr_read_b32 v123, a39
    v_accvgpr_read_b32 v124, a52
    v_accvgpr_read_b32 v125, a53
    v_accvgpr_read_b32 v126, a54
    v_accvgpr_read_b32 v127, a55
    v_accvgpr_read_b32 v80, a40
    v_accvgpr_read_b32 v81, a41
    v_accvgpr_read_b32 v82, a42
    v_accvgpr_read_b32 v83, a43
    v_accvgpr_read_b32 v84, a56
    v_accvgpr_read_b32 v85, a57
    v_accvgpr_read_b32 v86, a58
    v_accvgpr_read_b32 v87, a59
    v_accvgpr_read_b32 v88, a44
    v_accvgpr_read_b32 v89, a45
    v_accvgpr_read_b32 v90, a46
    v_accvgpr_read_b32 v91, a47
    v_accvgpr_read_b32 v92, a60
    v_accvgpr_read_b32 v93, a61
    v_accvgpr_read_b32 v94, a62
    v_accvgpr_read_b32 v95, a63
    ds_read_b128 v[48:51], v8 offset:12288
    ds_read_b128 v[52:55], v8 offset:13312
    ds_read_b128 v[56:59], v8 offset:28672
    ds_read_b128 v[60:63], v8 offset:29696
    ds_read_b128 v[64:67], v8 offset:14336
    ds_read_b128 v[68:71], v8 offset:15360
    ds_read_b128 v[72:75], v8 offset:30720
    ds_read_b128 v[76:79], v8 offset:31744
    s_waitcnt lgkmcnt(15)
    v_pk_add_f32 v[112:113], v[112:113], v[224:225]
    v_pk_add_f32 v[114:115], v[114:115], v[226:227]
    v_pk_add_f32 v[116:117], v[116:117], v[240:241]
    v_pk_add_f32 v[118:119], v[118:119], v[242:243]
    v_pk_mul_f32 v[112:113], v[112:113], v[128:129] op_sel_hi:[1,0]
    v_pk_mul_f32 v[114:115], v[114:115], v[128:129] op_sel_hi:[1,0]
    v_pk_mul_f32 v[116:117], v[116:117], v[128:129] op_sel_hi:[1,0]
    v_pk_mul_f32 v[118:119], v[118:119], v[128:129] op_sel_hi:[1,0]
    v_cvt_pk_bf16_f32 v112, v112, v113
    v_cvt_pk_bf16_f32 v113, v114, v115
    v_cvt_pk_bf16_f32 v114, v116, v117
    v_cvt_pk_bf16_f32 v115, v118, v119
    s_add_u32 s45, s44, 0
    buffer_store_dwordx4 v[112:115], v1, s[16:19], s45 offen offset:1024 sc0 sc1
    v_pk_add_f32 v[120:121], v[120:121], v[228:229]
    v_pk_add_f32 v[122:123], v[122:123], v[230:231]
    v_pk_add_f32 v[124:125], v[124:125], v[244:245]
    v_pk_add_f32 v[126:127], v[126:127], v[246:247]
    v_pk_mul_f32 v[120:121], v[120:121], v[132:133] op_sel_hi:[1,0]
    v_pk_mul_f32 v[122:123], v[122:123], v[132:133] op_sel_hi:[1,0]
    v_pk_mul_f32 v[124:125], v[124:125], v[132:133] op_sel_hi:[1,0]
    v_pk_mul_f32 v[126:127], v[126:127], v[132:133] op_sel_hi:[1,0]
    v_cvt_pk_bf16_f32 v120, v120, v121
    v_cvt_pk_bf16_f32 v121, v122, v123
    v_cvt_pk_bf16_f32 v122, v124, v125
    v_cvt_pk_bf16_f32 v123, v126, v127
    s_add_u32 s45, s44, 131072
    buffer_store_dwordx4 v[120:123], v1, s[16:19], s45 offen offset:1024 sc0 sc1
    v_pk_add_f32 v[80:81], v[80:81], v[232:233]
    v_pk_add_f32 v[82:83], v[82:83], v[234:235]
    v_pk_add_f32 v[84:85], v[84:85], v[248:249]
    v_pk_add_f32 v[86:87], v[86:87], v[250:251]
    v_pk_mul_f32 v[80:81], v[80:81], v[136:137] op_sel_hi:[1,0]
    v_pk_mul_f32 v[82:83], v[82:83], v[136:137] op_sel_hi:[1,0]
    v_pk_mul_f32 v[84:85], v[84:85], v[136:137] op_sel_hi:[1,0]
    v_pk_mul_f32 v[86:87], v[86:87], v[136:137] op_sel_hi:[1,0]
    v_cvt_pk_bf16_f32 v80, v80, v81
    v_cvt_pk_bf16_f32 v81, v82, v83
    v_cvt_pk_bf16_f32 v82, v84, v85
    v_cvt_pk_bf16_f32 v83, v86, v87
    s_add_u32 s45, s44, 262144
    buffer_store_dwordx4 v[80:83], v1, s[16:19], s45 offen offset:1024 sc0 sc1
    v_pk_add_f32 v[88:89], v[88:89], v[236:237]
    v_pk_add_f32 v[90:91], v[90:91], v[238:239]
    v_pk_add_f32 v[92:93], v[92:93], v[252:253]
    v_pk_add_f32 v[94:95], v[94:95], v[254:255]
    v_pk_mul_f32 v[88:89], v[88:89], v[140:141] op_sel_hi:[1,0]
    v_pk_mul_f32 v[90:91], v[90:91], v[140:141] op_sel_hi:[1,0]
    v_pk_mul_f32 v[92:93], v[92:93], v[140:141] op_sel_hi:[1,0]
    v_pk_mul_f32 v[94:95], v[94:95], v[140:141] op_sel_hi:[1,0]
    v_cvt_pk_bf16_f32 v88, v88, v89
    v_cvt_pk_bf16_f32 v89, v90, v91
    v_cvt_pk_bf16_f32 v90, v92, v93
    v_cvt_pk_bf16_f32 v91, v94, v95
    s_add_u32 s45, s44, 393216
    buffer_store_dwordx4 v[88:91], v1, s[16:19], s45 offen offset:1024 sc0 sc1
    v_accvgpr_read_b32 v112, a64
    v_accvgpr_read_b32 v113, a65
    v_accvgpr_read_b32 v114, a66
    v_accvgpr_read_b32 v115, a67
    v_accvgpr_read_b32 v116, a80
    v_accvgpr_read_b32 v117, a81
    v_accvgpr_read_b32 v118, a82
    v_accvgpr_read_b32 v119, a83
    v_accvgpr_read_b32 v120, a68
    v_accvgpr_read_b32 v121, a69
    v_accvgpr_read_b32 v122, a70
    v_accvgpr_read_b32 v123, a71
    v_accvgpr_read_b32 v124, a84
    v_accvgpr_read_b32 v125, a85
    v_accvgpr_read_b32 v126, a86
    v_accvgpr_read_b32 v127, a87
    v_accvgpr_read_b32 v80, a72
    v_accvgpr_read_b32 v81, a73
    v_accvgpr_read_b32 v82, a74
    v_accvgpr_read_b32 v83, a75
    v_accvgpr_read_b32 v84, a88
    v_accvgpr_read_b32 v85, a89
    v_accvgpr_read_b32 v86, a90
    v_accvgpr_read_b32 v87, a91
    v_accvgpr_read_b32 v88, a76
    v_accvgpr_read_b32 v89, a77
    v_accvgpr_read_b32 v90, a78
    v_accvgpr_read_b32 v91, a79
    v_accvgpr_read_b32 v92, a92
    v_accvgpr_read_b32 v93, a93
    v_accvgpr_read_b32 v94, a94
    v_accvgpr_read_b32 v95, a95
    s_waitcnt lgkmcnt(8)
    v_pk_add_f32 v[112:113], v[112:113], v[16:17]
    v_pk_add_f32 v[114:115], v[114:115], v[18:19]
    v_pk_add_f32 v[116:117], v[116:117], v[32:33]
    v_pk_add_f32 v[118:119], v[118:119], v[34:35]
    v_pk_mul_f32 v[112:113], v[112:113], v[128:129] op_sel_hi:[1,0]
    v_pk_mul_f32 v[114:115], v[114:115], v[128:129] op_sel_hi:[1,0]
    v_pk_mul_f32 v[116:117], v[116:117], v[128:129] op_sel_hi:[1,0]
    v_pk_mul_f32 v[118:119], v[118:119], v[128:129] op_sel_hi:[1,0]
    v_cvt_pk_bf16_f32 v112, v112, v113
    v_cvt_pk_bf16_f32 v113, v114, v115
    v_cvt_pk_bf16_f32 v114, v116, v117
    v_cvt_pk_bf16_f32 v115, v118, v119
    s_add_u32 s45, s44, 0
    buffer_store_dwordx4 v[112:115], v1, s[16:19], s45 offen offset:2048 sc0 sc1
    v_pk_add_f32 v[120:121], v[120:121], v[20:21]
    v_pk_add_f32 v[122:123], v[122:123], v[22:23]
    v_pk_add_f32 v[124:125], v[124:125], v[36:37]
    v_pk_add_f32 v[126:127], v[126:127], v[38:39]
    v_pk_mul_f32 v[120:121], v[120:121], v[132:133] op_sel_hi:[1,0]
    v_pk_mul_f32 v[122:123], v[122:123], v[132:133] op_sel_hi:[1,0]
    v_pk_mul_f32 v[124:125], v[124:125], v[132:133] op_sel_hi:[1,0]
    v_pk_mul_f32 v[126:127], v[126:127], v[132:133] op_sel_hi:[1,0]
    v_cvt_pk_bf16_f32 v120, v120, v121
    v_cvt_pk_bf16_f32 v121, v122, v123
    v_cvt_pk_bf16_f32 v122, v124, v125
    v_cvt_pk_bf16_f32 v123, v126, v127
    s_add_u32 s45, s44, 131072
    buffer_store_dwordx4 v[120:123], v1, s[16:19], s45 offen offset:2048 sc0 sc1
    v_pk_add_f32 v[80:81], v[80:81], v[24:25]
    v_pk_add_f32 v[82:83], v[82:83], v[26:27]
    v_pk_add_f32 v[84:85], v[84:85], v[40:41]
    v_pk_add_f32 v[86:87], v[86:87], v[42:43]
    v_pk_mul_f32 v[80:81], v[80:81], v[136:137] op_sel_hi:[1,0]
    v_pk_mul_f32 v[82:83], v[82:83], v[136:137] op_sel_hi:[1,0]
    v_pk_mul_f32 v[84:85], v[84:85], v[136:137] op_sel_hi:[1,0]
    v_pk_mul_f32 v[86:87], v[86:87], v[136:137] op_sel_hi:[1,0]
    v_cvt_pk_bf16_f32 v80, v80, v81
    v_cvt_pk_bf16_f32 v81, v82, v83
    v_cvt_pk_bf16_f32 v82, v84, v85
    v_cvt_pk_bf16_f32 v83, v86, v87
    s_add_u32 s45, s44, 262144
    buffer_store_dwordx4 v[80:83], v1, s[16:19], s45 offen offset:2048 sc0 sc1
    v_pk_add_f32 v[88:89], v[88:89], v[28:29]
    v_pk_add_f32 v[90:91], v[90:91], v[30:31]
    v_pk_add_f32 v[92:93], v[92:93], v[44:45]
    v_pk_add_f32 v[94:95], v[94:95], v[46:47]
    v_pk_mul_f32 v[88:89], v[88:89], v[140:141] op_sel_hi:[1,0]
    v_pk_mul_f32 v[90:91], v[90:91], v[140:141] op_sel_hi:[1,0]
    v_pk_mul_f32 v[92:93], v[92:93], v[140:141] op_sel_hi:[1,0]
    v_pk_mul_f32 v[94:95], v[94:95], v[140:141] op_sel_hi:[1,0]
    v_cvt_pk_bf16_f32 v88, v88, v89
    v_cvt_pk_bf16_f32 v89, v90, v91
    v_cvt_pk_bf16_f32 v90, v92, v93
    v_cvt_pk_bf16_f32 v91, v94, v95
    s_add_u32 s45, s44, 393216
    buffer_store_dwordx4 v[88:91], v1, s[16:19], s45 offen offset:2048 sc0 sc1
    v_accvgpr_read_b32 v112, a96
    v_accvgpr_read_b32 v113, a97
    v_accvgpr_read_b32 v114, a98
    v_accvgpr_read_b32 v115, a99
    v_accvgpr_read_b32 v116, a112
    v_accvgpr_read_b32 v117, a113
    v_accvgpr_read_b32 v118, a114
    v_accvgpr_read_b32 v119, a115
    v_accvgpr_read_b32 v120, a100
    v_accvgpr_read_b32 v121, a101
    v_accvgpr_read_b32 v122, a102
    v_accvgpr_read_b32 v123, a103
    v_accvgpr_read_b32 v124, a116
    v_accvgpr_read_b32 v125, a117
    v_accvgpr_read_b32 v126, a118
    v_accvgpr_read_b32 v127, a119
    v_accvgpr_read_b32 v80, a104
    v_accvgpr_read_b32 v81, a105
    v_accvgpr_read_b32 v82, a106
    v_accvgpr_read_b32 v83, a107
    v_accvgpr_read_b32 v84, a120
    v_accvgpr_read_b32 v85, a121
    v_accvgpr_read_b32 v86, a122
    v_accvgpr_read_b32 v87, a123
    v_accvgpr_read_b32 v88, a108
    v_accvgpr_read_b32 v89, a109
    v_accvgpr_read_b32 v90, a110
    v_accvgpr_read_b32 v91, a111
    v_accvgpr_read_b32 v92, a124
    v_accvgpr_read_b32 v93, a125
    v_accvgpr_read_b32 v94, a126
    v_accvgpr_read_b32 v95, a127
    s_waitcnt lgkmcnt(0)
    v_pk_add_f32 v[112:113], v[112:113], v[48:49]
    v_pk_add_f32 v[114:115], v[114:115], v[50:51]
    v_pk_add_f32 v[116:117], v[116:117], v[64:65]
    v_pk_add_f32 v[118:119], v[118:119], v[66:67]
    v_pk_mul_f32 v[112:113], v[112:113], v[128:129] op_sel_hi:[1,0]
    v_pk_mul_f32 v[114:115], v[114:115], v[128:129] op_sel_hi:[1,0]
    v_pk_mul_f32 v[116:117], v[116:117], v[128:129] op_sel_hi:[1,0]
    v_pk_mul_f32 v[118:119], v[118:119], v[128:129] op_sel_hi:[1,0]
    v_cvt_pk_bf16_f32 v112, v112, v113
    v_cvt_pk_bf16_f32 v113, v114, v115
    v_cvt_pk_bf16_f32 v114, v116, v117
    v_cvt_pk_bf16_f32 v115, v118, v119
    s_add_u32 s45, s44, 0
    buffer_store_dwordx4 v[112:115], v1, s[16:19], s45 offen offset:3072 sc0 sc1
    v_pk_add_f32 v[120:121], v[120:121], v[52:53]
    v_pk_add_f32 v[122:123], v[122:123], v[54:55]
    v_pk_add_f32 v[124:125], v[124:125], v[68:69]
    v_pk_add_f32 v[126:127], v[126:127], v[70:71]
    v_pk_mul_f32 v[120:121], v[120:121], v[132:133] op_sel_hi:[1,0]
    v_pk_mul_f32 v[122:123], v[122:123], v[132:133] op_sel_hi:[1,0]
    v_pk_mul_f32 v[124:125], v[124:125], v[132:133] op_sel_hi:[1,0]
    v_pk_mul_f32 v[126:127], v[126:127], v[132:133] op_sel_hi:[1,0]
    v_cvt_pk_bf16_f32 v120, v120, v121
    v_cvt_pk_bf16_f32 v121, v122, v123
    v_cvt_pk_bf16_f32 v122, v124, v125
    v_cvt_pk_bf16_f32 v123, v126, v127
    s_add_u32 s45, s44, 131072
    buffer_store_dwordx4 v[120:123], v1, s[16:19], s45 offen offset:3072 sc0 sc1
    v_pk_add_f32 v[80:81], v[80:81], v[56:57]
    v_pk_add_f32 v[82:83], v[82:83], v[58:59]
    v_pk_add_f32 v[84:85], v[84:85], v[72:73]
    v_pk_add_f32 v[86:87], v[86:87], v[74:75]
    v_pk_mul_f32 v[80:81], v[80:81], v[136:137] op_sel_hi:[1,0]
    v_pk_mul_f32 v[82:83], v[82:83], v[136:137] op_sel_hi:[1,0]
    v_pk_mul_f32 v[84:85], v[84:85], v[136:137] op_sel_hi:[1,0]
    v_pk_mul_f32 v[86:87], v[86:87], v[136:137] op_sel_hi:[1,0]
    v_cvt_pk_bf16_f32 v80, v80, v81
    v_cvt_pk_bf16_f32 v81, v82, v83
    v_cvt_pk_bf16_f32 v82, v84, v85
    v_cvt_pk_bf16_f32 v83, v86, v87
    s_add_u32 s45, s44, 262144
    buffer_store_dwordx4 v[80:83], v1, s[16:19], s45 offen offset:3072 sc0 sc1
    v_pk_add_f32 v[88:89], v[88:89], v[60:61]
    v_pk_add_f32 v[90:91], v[90:91], v[62:63]
    v_pk_add_f32 v[92:93], v[92:93], v[76:77]
    v_pk_add_f32 v[94:95], v[94:95], v[78:79]
    v_pk_mul_f32 v[88:89], v[88:89], v[140:141] op_sel_hi:[1,0]
    v_pk_mul_f32 v[90:91], v[90:91], v[140:141] op_sel_hi:[1,0]
    v_pk_mul_f32 v[92:93], v[92:93], v[140:141] op_sel_hi:[1,0]
    v_pk_mul_f32 v[94:95], v[94:95], v[140:141] op_sel_hi:[1,0]
    v_cvt_pk_bf16_f32 v88, v88, v89
    v_cvt_pk_bf16_f32 v89, v90, v91
    v_cvt_pk_bf16_f32 v90, v92, v93
    v_cvt_pk_bf16_f32 v91, v94, v95
    s_add_u32 s45, s44, 393216
    buffer_store_dwordx4 v[88:91], v1, s[16:19], s45 offen offset:3072 sc0 sc1
    v_lshl_add_u32 v188, v1, 16, s34
    v_mov_b32 v189, 7
    s_waitcnt vmcnt(0)
    s_waitcnt lgkmcnt(0)
    s_barrier
    ds_read_b128 v[184:187], v3
    s_waitcnt lgkmcnt(0)
    v_max3_f32 v184, v184, v185, v186
    v_max_f32 v184, v184, v187
    v_cmp_nge_f32 vcc, 0x5d800000, v184
    s_cbranch_vccnz K2_REDO
K2_OKM0:
    s_cmp_lg_u32 s24, 0
    s_cbranch_scc1 K2_OKX
    v_and_b32 v148, v148, v149
    v_and_b32 v150, v150, v151
    v_and_b32 v148, v148, v150
    v_and_b32 v148, 0x02020202, v148
    v_cmp_eq_u32 vcc, 0x02020202, v148
    v_mov_b32 v189, 1
    s_and_b32 s51, vcc_lo, 0xffff
    s_cmp_eq_u32 s51, 0xffff
    s_cbranch_scc0 KM_SPZ
KM_RTZ:
    s_add_u32 s92, s36, 0x4300000
    s_addc_u32 s93, s37, 0
    s_mov_b32 s94, 0x10000
    s_mov_b32 s95, 0x00020000
    buffer_store_dword v189, v146, s[92:95], s50 offen offset:32 sc0 sc1
    buffer_atomic_add v189, v146, s[92:95], 0 offen offset:128 sc0 sc1
K2_OKX:
    s_branch KT_ENTRY
K2_R23:
    s_mov_b32 s30, 1
    s_sub_u32 s31, s28, 1
    s_cmp_eq_u32 s28, 1
    s_cbranch_scc1 K2_FD
    s_waitcnt lgkmcnt(3)
    v_mfma_f32_16x16x32_bf16 v[16:19], v[152:155], v[192:195], v[112:115]
    ds_read_b128 v[172:175], v3 offset:5120
    s_add_u32 s40, s40, 8192
    s_add_u32 s42, s42, 8192
    v_mfma_f32_16x16x32_bf16 v[20:23], v[152:155], v[196:199], v[116:119]
    s_add_u32 m0, s42, s43
    ds_write_b128 v7, v[192:195] offset:0
    ds_write_b128 v7, v[196:199] offset:1024
    v_mfma_f32_16x16x32_bf16 v[24:27], v[152:155], v[200:203], v[120:123]
    buffer_load_dwordx4 v1, s[12:15], s40 offen offset:0 lds
    v_mfma_f32_16x16x32_bf16 v[28:31], v[152:155], v[204:207], v[124:127]
    ds_write_b128 v7, v[200:203] offset:2048
    ds_write_b128 v7, v[204:207] offset:3072
    ds_write_b128 v7, v[208:211] offset:4096
    v_mfma_f32_16x16x32_bf16 v[16:19], v[156:159], v[208:211], v[16:19]
    ds_read_b128 v[176:179], v3 offset:6144
    ds_write_b128 v7, v[212:215] offset:5120
    ds_write_b128 v7, v[216:219] offset:6144
    v_mfma_f32_16x16x32_bf16 v[20:23], v[156:159], v[212:215], v[20:23]
    buffer_load_dwordx4 v1, s[12:15], s40 offen offset:1024 lds
    v_mfma_f32_16x16x32_bf16 v[24:27], v[156:159], v[216:219], v[24:27]
    buffer_load_dwordx4 v1, s[12:15], s40 offen offset:2048 lds
    v_mfma_f32_16x16x32_bf16 v[28:31], v[156:159], v[220:223], v[28:31]
    ds_write_b128 v7, v[220:223] offset:7168
    ds_write_b128 v7, v[224:227] offset:8192
    ds_write_b128 v7, v[228:231] offset:9216
    s_waitcnt lgkmcnt(13)
    v_mfma_f32_16x16x32_bf16 v[16:19], v[160:163], v[224:227], v[16:19]
    ds_read_b128 v[180:183], v3 offset:7168
    ds_write_b128 v7, v[232:235] offset:10240
    ds_write_b128 v7, v[236:239] offset:11264
    v_mfma_f32_16x16x32_bf16 v[20:23], v[160:163], v[228:231], v[20:23]
    buffer_load_dwordx4 v1, s[12:15], s40 offen offset:3072 lds
    v_mfma_f32_16x16x32_bf16 v[24:27], v[160:163], v[232:235], v[24:27]
    s_add_u32 m0, m0, 4096
    ds_write_b128 v7, v[240:243] offset:12288
    ds_write_b128 v7, v[244:247] offset:13312
    v_mfma_f32_16x16x32_bf16 v[28:31], v[160:163], v[236:239], v[28:31]
    buffer_load_dwordx4 v2, s[12:15], s40 offen offset:0 lds
    v_mfma_f32_16x16x32_bf16 v[16:19], v[164:167], v[240:243], v[16:19]
    ds_write_b128 v7, v[248:251] offset:14336
    ds_write_b128 v7, v[252:255] offset:15360
    ds_read_b128 a[128:131], v7 offset:0
    v_mfma_f32_16x16x32_bf16 v[20:23], v[164:167], v[244:247], v[20:23]
    buffer_load_dwordx4 v2, s[12:15], s40 offen offset:1024 lds
    v_mfma_f32_16x16x32_bf16 v[24:27], v[164:167], v[248:251], v[24:27]
    ds_read_b128 a[132:135], v7 offset:1024
    ds_read_b128 a[136:139], v7 offset:2048
    ds_read_b128 a[140:143], v7 offset:3072
    v_mfma_f32_16x16x32_bf16 v[28:31], v[164:167], v[252:255], v[28:31]
    buffer_load_dwordx4 v2, s[12:15], s40 offen offset:2048 lds
    s_waitcnt lgkmcnt(15)
    v_mfma_f32_16x16x32_bf16 v[32:35], v[168:171], v[192:195], v[112:115]
    ds_read_b128 a[144:147], v7 offset:4096
    ds_read_b128 a[148:151], v7 offset:5120
    ds_read_b128 a[152:155], v7 offset:6144
    v_mfma_f32_16x16x32_bf16 v[36:39], v[168:171], v[196:199], v[116:119]
    buffer_load_dwordx4 v2, s[12:15], s40 offen offset:3072 lds
    v_mfma_f32_16x16x32_bf16 v[40:43], v[168:171], v[200:203], v[120:123]
    ds_read_b128 a[156:159], v7 offset:7168
    ds_read_b128 a[160:163], v7 offset:8192
    ds_read_b128 a[164:167], v7 offset:9216
    v_mfma_f32_16x16x32_bf16 v[44:47], v[168:171], v[204:207], v[124:127]
    ds_read_b128 a[168:171], v7 offset:10240
    ds_read_b128 a[172:175], v7 offset:11264
    ds_read_b128 a[176:179], v7 offset:12288
    ds_read_b128 a[180:183], v7 offset:13312
    ds_read_b128 a[184:187], v7 offset:14336
    ds_read_b128 a[188:191], v7 offset:15360
    s_waitcnt vmcnt(16) lgkmcnt(0)
    s_barrier
    v_mfma_f32_16x16x32_bf16 v[32:35], v[172:175], v[208:211], v[32:35]
    ds_read_b128 v[152:155], v3 offset:8192
    v_mov_b32 v128, 0
    v_mov_b32 v129, 0
    v_mfma_f32_16x16x32_bf16 v[36:39], v[172:175], v[212:215], v[36:39]
    ds_read_b128 v[156:159], v3 offset:9216
    v_mov_b32 v130, 0
    v_mov_b32 v131, 0
    v_mfma_f32_16x16x32_bf16 v[40:43], v[172:175], v[216:219], v[40:43]
    v_mfma_f32_16x16x32_bf16 v[44:47], v[172:175], v[220:223], v[44:47]
    v_mov_b32 v132, 0
    v_mov_b32 v133, 0
    v_mov_b32 v134, 0
    v_mfma_f32_16x16x32_bf16 v[32:35], v[176:179], v[224:227], v[32:35]
    ds_read_b128 v[160:163], v3 offset:10240
    v_mov_b32 v135, 0
    v_mov_b32 v136, 0
    v_mfma_f32_16x16x32_bf16 v[36:39], v[176:179], v[228:231], v[36:39]
    ds_read_b128 v[164:167], v3 offset:11264
    v_mov_b32 v137, 0
    v_mov_b32 v138, 0
    v_mfma_f32_16x16x32_bf16 v[40:43], v[176:179], v[232:235], v[40:43]
    v_mfma_f32_16x16x32_bf16 v[44:47], v[176:179], v[236:239], v[44:47]
    v_mfma_f32_16x16x32_bf16 v[32:35], v[180:183], v[240:243], v[32:35]
    ds_read_b128 v[168:171], v3 offset:12288
    v_mov_b32 v139, 0
    v_mov_b32 v140, 0
    v_mfma_f32_16x16x32_bf16 v[36:39], v[180:183], v[244:247], v[36:39]
    v_mov_b32 v141, 0
    v_mov_b32 v142, 0
    v_mov_b32 v143, 0
    v_mfma_f32_16x16x32_bf16 v[40:43], v[180:183], v[248:251], v[40:43]
    v_mfma_f32_16x16x32_bf16 v[44:47], v[180:183], v[252:255], v[44:47]
    s_waitcnt lgkmcnt(3)
    v_mfma_f32_16x16x32_bf16 v[48:51], v[152:155], v[192:195], v[112:115]
    ds_read_b128 v[172:175], v3 offset:13312
    s_add_u32 s40, s40, s41
    s_min_u32 s40, s40, 0x7000000
    v_mfma_f32_16x16x32_bf16 v[52:55], v[152:155], v[196:199], v[116:119]
    s_add_u32 s42, s42, 8192
    s_and_b32 s42, s42, 0x7fff
    s_add_u32 m0, s42, s43
    v_mfma_f32_16x16x32_bf16 v[56:59], v[152:155], v[200:203], v[120:123]
    buffer_load_dwordx4 v1, s[12:15], s40 offen offset:0 lds
    v_mfma_f32_16x16x32_bf16 v[60:63], v[152:155], v[204:207], v[124:127]
    v_exp_f32 v184, v16
    v_mfma_f32_16x16x32_bf16 v[48:51], v[156:159], v[208:211], v[48:51]
    ds_read_b128 v[176:179], v3 offset:14336
    v_exp_f32 v185, v17
    v_mfma_f32_16x16x32_bf16 v[52:55], v[156:159], v[212:215], v[52:55]
    buffer_load_dwordx4 v1, s[12:15], s40 offen offset:1024 lds
    v_mfma_f32_16x16x32_bf16 v[56:59], v[156:159], v[216:219], v[56:59]
    buffer_load_dwordx4 v1, s[12:15], s40 offen offset:2048 lds
    v_mfma_f32_16x16x32_bf16 v[60:63], v[156:159], v[220:223], v[60:63]
    buffer_load_dwordx4 v1, s[12:15], s40 offen offset:3072 lds
    s_waitcnt lgkmcnt(3)
    v_mfma_f32_16x16x32_bf16 v[48:51], v[160:163], v[224:227], v[48:51]
    ds_read_b128 v[180:183], v3 offset:15360
    s_add_u32 m0, m0, 4096
    v_cvt_pk_bf16_f32 v80, v184, v185
    v_mfma_f32_16x16x32_bf16 v[52:55], v[160:163], v[228:231], v[52:55]
    buffer_load_dwordx4 v2, s[12:15], s40 offen offset:0 lds
    v_mfma_f32_16x16x32_bf16 v[56:59], v[160:163], v[232:235], v[56:59]
    v_exp_f32 v186, v18
    v_mfma_f32_16x16x32_bf16 v[60:63], v[160:163], v[236:239], v[60:63]
    buffer_load_dwordx4 v2, s[12:15], s40 offen offset:1024 lds
    v_mfma_f32_16x16x32_bf16 v[48:51], v[164:167], v[240:243], v[48:51]
    buffer_load_dwordx4 v2, s[12:15], s40 offen offset:2048 lds
    v_mfma_f32_16x16x32_bf16 v[52:55], v[164:167], v[244:247], v[52:55]
    v_exp_f32 v187, v19
    v_mfma_f32_16x16x32_bf16 v[56:59], v[164:167], v[248:251], v[56:59]
    buffer_load_dwordx4 v2, s[12:15], s40 offen offset:3072 lds
    v_mfma_f32_16x16x32_bf16 v[60:63], v[164:167], v[252:255], v[60:63]
    buffer_load_dwordx2 v[10:11], v9, s[20:23], 0 offen
    s_waitcnt lgkmcnt(2)
    v_mfma_f32_16x16x32_bf16 v[64:67], v[168:171], v[192:195], v[112:115]
    v_exp_f32 v188, v20
    v_cvt_pk_bf16_f32 v81, v186, v187
    v_mfma_f32_16x16x32_bf16 v[68:71], v[168:171], v[196:199], v[116:119]
    v_add_u32 v9, s69, v9
    v_exp_f32 v189, v21
    v_mfma_f32_16x16x32_bf16 v[72:75], v[168:171], v[200:203], v[120:123]
    buffer_store_dwordx4 v[148:151], v1, s[64:67], s68 offen sc0 sc1
    v_mfma_f32_16x16x32_bf16 v[76:79], v[168:171], v[204:207], v[124:127]
    s_add_u32 s68, s68, 1048576
    v_exp_f32 v190, v22
    s_waitcnt vmcnt(18) lgkmcnt(0)
    s_barrier
    v_xor_b32 v3, 0x4000, v3
    v_mfma_f32_16x16x32_bf16 v[64:67], v[172:175], v[208:211], v[64:67]
    ds_read_b128 v[152:155], v4 offset:0
    v_exp_f32 v191, v23
    v_mfma_f32_16x16x32_bf16 v[68:71], v[172:175], v[212:215], v[68:71]
    ds_read_b128 v[156:159], v4 offset:1024
    v_exp_f32 v184, v24
    v_mfma_f32_16x16x32_bf16 v[72:75], v[172:175], v[216:219], v[72:75]
    v_exp_f32 v185, v25
    v_cvt_pk_bf16_f32 v84, v188, v189
    v_mfma_f32_16x16x32_bf16 v[76:79], v[172:175], v[220:223], v[76:79]
    v_exp_f32 v186, v26
    v_cvt_pk_bf16_f32 v85, v190, v191
    v_mfma_f32_16x16x32_bf16 v[64:67], v[176:179], v[224:227], v[64:67]
    ds_read_b128 v[160:163], v4 offset:2048
    v_exp_f32 v187, v27
    v_mfma_f32_16x16x32_bf16 v[68:71], v[176:179], v[228:231], v[68:71]
    ds_read_b128 v[164:167], v4 offset:3072
    v_exp_f32 v188, v28
    v_mfma_f32_16x16x32_bf16 v[72:75], v[176:179], v[232:235], v[72:75]
    v_exp_f32 v189, v29
    v_cvt_pk_bf16_f32 v88, v184, v185
    v_mfma_f32_16x16x32_bf16 v[76:79], v[176:179], v[236:239], v[76:79]
    v_exp_f32 v190, v30
    v_cvt_pk_bf16_f32 v89, v186, v187
    v_mfma_f32_16x16x32_bf16 v[64:67], v[180:183], v[240:243], v[64:67]
    ds_read_b128 v[168:171], v4 offset:4096
    v_exp_f32 v191, v31
    v_mfma_f32_16x16x32_bf16 v[68:71], v[180:183], v[244:247], v[68:71]
    v_exp_f32 v184, v32
    v_cvt_pk_bf16_f32 v92, v188, v189
    v_exp_f32 v185, v33
    v_exp_f32 v186, v34
    v_exp_f32 v187, v35
    v_exp_f32 v188, v36
    v_exp_f32 v189, v37
    v_mfma_f32_16x16x32_bf16 v[72:75], v[180:183], v[248:251], v[72:75]
    v_cvt_pk_bf16_f32 v93, v190, v191
    v_cvt_pk_bf16_f32 v82, v184, v185
    v_cvt_pk_bf16_f32 v83, v186, v187
    v_exp_f32 v190, v38
    v_exp_f32 v191, v39
    v_exp_f32 v184, v40
    v_exp_f32 v185, v41
    v_exp_f32 v186, v42
    v_exp_f32 v187, v43
    v_cvt_pk_bf16_f32 v86, v188, v189
    v_cvt_pk_bf16_f32 v87, v190, v191
    v_cvt_pk_bf16_f32 v90, v184, v185
    v_cvt_pk_bf16_f32 v91, v186, v187
    v_exp_f32 v188, v44
    v_exp_f32 v189, v45
    v_exp_f32 v190, v46
    v_exp_f32 v191, v47
    v_cvt_pk_bf16_f32 v94, v188, v189
    v_cvt_pk_bf16_f32 v95, v190, v191
    v_mfma_f32_16x16x32_bf16 v[76:79], v[180:183], v[252:255], v[76:79]
    s_cmp_lg_u32 s30, s31
    s_cbranch_scc1 K2_MD
K2_S1:
    s_waitcnt lgkmcnt(3)
    v_mfma_f32_16x16x32_bf16 a[0:3], v[152:155], v[80:83], a[0:3]
    ds_read_b128 v[172:175], v4 offset:5120
    s_add_u32 s40, s40, 8192
    s_add_u32 s42, s42, 8192
    v_mfma_f32_16x16x32_bf16 a[4:7], v[152:155], v[84:87], a[4:7]
    v_exp_f32 v184, v48
    v_cmp_le_i32_e64 s[44:45], 0, v5
    v_mfma_f32_16x16x32_bf16 a[8:11], v[152:155], v[88:91], a[8:11]
    v_exp_f32 v185, v49
    v_cmp_le_i32_e64 s[46:47], 1, v5
    v_mfma_f32_16x16x32_bf16 a[12:15], v[152:155], v[92:95], a[12:15]
    s_add_u32 m0, s42, s43
    v_exp_f32 v186, v50
    v_mfma_f32_16x16x32_bf16 a[16:19], v[156:159], v[80:83], a[16:19]
    ds_read_b128 v[176:179], v4 offset:6144
    v_exp_f32 v187, v51
    v_mfma_f32_16x16x32_bf16 a[20:23], v[156:159], v[84:87], a[20:23]
    buffer_load_dwordx4 v1, s[12:15], s40 offen offset:0 lds
    v_mfma_f32_16x16x32_bf16 a[24:27], v[156:159], v[88:91], a[24:27]
    v_cvt_pk_bf16_f32 v96, v184, v185
    v_cvt_pk_bf16_f32 v97, v186, v187
    v_cmp_le_i32_e64 s[48:49], 2, v5
    v_mfma_f32_16x16x32_bf16 a[28:31], v[156:159], v[92:95], a[28:31]
    v_cmp_le_i32_e64 s[50:51], 3, v5
    v_cndmask_b32_e64 v16, v6, v112, s[44:45]
    v_cndmask_b32_e64 v17, v6, v112, s[46:47]
    v_mfma_f32_16x16x32_bf16 v[128:131], v[12:15], v[80:83], v[128:131]
    v_exp_f32 v188, v52
    v_cndmask_b32_e64 v18, v6, v112, s[48:49]
    s_waitcnt lgkmcnt(3)
    v_mfma_f32_16x16x32_bf16 a[32:35], v[160:163], v[80:83], a[32:35]
    ds_read_b128 v[180:183], v4 offset:7168
    v_exp_f32 v189, v53
    v_mfma_f32_16x16x32_bf16 a[36:39], v[160:163], v[84:87], a[36:39]
    buffer_load_dwordx4 v1, s[12:15], s40 offen offset:1024 lds
    v_mfma_f32_16x16x32_bf16 a[40:43], v[160:163], v[88:91], a[40:43]
    v_cvt_pk_bf16_f32 v100, v188, v189
    v_cndmask_b32_e64 v19, v6, v112, s[50:51]
    v_mfma_f32_16x16x32_bf16 a[44:47], v[160:163], v[92:95], a[44:47]
    v_exp_f32 v190, v54
    v_mfma_f32_16x16x32_bf16 a[48:51], v[164:167], v[80:83], a[48:51]
    ds_read_b128 v[152:155], v3 offset:0
    v_exp_f32 v191, v55
    v_mfma_f32_16x16x32_bf16 a[52:55], v[164:167], v[84:87], a[52:55]
    v_cvt_pk_bf16_f32 v101, v190, v191
    v_cmp_le_i32_e64 s[44:45], -16, v5
    v_mfma_f32_16x16x32_bf16 a[56:59], v[164:167], v[88:91], a[56:59]
    v_mfma_f32_16x16x32_bf16 a[60:63], v[164:167], v[92:95], a[60:63]
    buffer_load_dwordx4 v1, s[12:15], s40 offen offset:2048 lds
    v_mfma_f32_16x16x32_bf16 v[132:135], v[12:15], v[84:87], v[132:135]
    v_exp_f32 v184, v56
    v_cmp_le_i32_e64 s[46:47], -15, v5
    s_waitcnt lgkmcnt(3)
    v_mfma_f32_16x16x32_bf16 a[64:67], v[168:171], v[80:83], a[64:67]
    ds_read_b128 v[156:159], v3 offset:1024
    v_exp_f32 v185, v57
    v_mfma_f32_16x16x32_bf16 a[68:71], v[168:171], v[84:87], a[68:71]
    v_cvt_pk_bf16_f32 v104, v184, v185
    v_cmp_le_i32_e64 s[48:49], -14, v5
    v_cmp_le_i32_e64 s[50:51], -13, v5
    v_mfma_f32_16x16x32_bf16 a[72:75], v[168:171], v[88:91], a[72:75]
    v_exp_f32 v186, v58
    v_mfma_f32_16x16x32_bf16 a[76:79], v[168:171], v[92:95], a[76:79]
    buffer_load_dwordx4 v1, s[12:15], s40 offen offset:3072 lds
    v_mfma_f32_16x16x32_bf16 a[80:83], v[172:175], v[80:83], a[80:83]
    ds_read_b128 v[160:163], v3 offset:2048
    s_add_u32 m0, m0, 4096
    v_cndmask_b32_e64 v20, v6, v116, s[44:45]
    v_mfma_f32_16x16x32_bf16 a[84:87], v[172:175], v[84:87], a[84:87]
    v_exp_f32 v187, v59
    v_cndmask_b32_e64 v21, v6, v116, s[46:47]
    v_mfma_f32_16x16x32_bf16 a[88:91], v[172:175], v[88:91], a[88:91]
    v_exp_f32 v188, v60
    v_cvt_pk_bf16_f32 v105, v186, v187
    v_mfma_f32_16x16x32_bf16 a[92:95], v[172:175], v[92:95], a[92:95]
    v_mfma_f32_16x16x32_bf16 v[136:139], v[12:15], v[88:91], v[136:139]
    v_exp_f32 v189, v61
    v_cndmask_b32_e64 v22, v6, v116, s[48:49]
    s_waitcnt lgkmcnt(3)
    v_mfma_f32_16x16x32_bf16 a[96:99], v[176:179], v[80:83], a[96:99]
    ds_read_b128 v[164:167], v3 offset:3072
    v_exp_f32 v190, v62
    v_mfma_f32_16x16x32_bf16 a[100:103], v[176:179], v[84:87], a[100:103]
    buffer_load_dwordx4 v2, s[12:15], s40 offen offset:0 lds
    v_mfma_f32_16x16x32_bf16 a[104:107], v[176:179], v[88:91], a[104:107]
    v_cvt_pk_bf16_f32 v108, v188, v189
    v_cndmask_b32_e64 v23, v6, v116, s[50:51]
    v_mfma_f32_16x16x32_bf16 a[108:111], v[176:179], v[92:95], a[108:111]
    v_exp_f32 v191, v63
    v_mfma_f32_16x16x32_bf16 a[112:115], v[180:183], v[80:83], a[112:115]
    ds_read_b128 v[168:171], v3 offset:4096
    v_exp_f32 v184, v64
    v_mfma_f32_16x16x32_bf16 a[116:119], v[180:183], v[84:87], a[116:119]
    v_cvt_pk_bf16_f32 v109, v190, v191
    v_mfma_f32_16x16x32_bf16 a[120:123], v[180:183], v[88:91], a[120:123]
    buffer_load_dwordx4 v2, s[12:15], s40 offen offset:1024 lds
    v_mfma_f32_16x16x32_bf16 a[124:127], v[180:183], v[92:95], a[124:127]
    v_exp_f32 v185, v65
    v_cmp_le_i32_e64 s[44:45], 8, v5
    v_mfma_f32_16x16x32_bf16 v[140:143], v[12:15], v[92:95], v[140:143]
    v_cvt_pk_bf16_f32 v98, v184, v185
    v_cmp_le_i32_e64 s[46:47], 9, v5
    v_cmp_le_i32_e64 s[48:49], 10, v5
    s_waitcnt lgkmcnt(3)
    v_mfma_f32_16x16x32_bf16 v[16:19], v[152:155], a[128:131], v[16:19]
    ds_read_b128 v[172:175], v3 offset:5120
    v_exp_f32 v186, v66
    v_mfma_f32_16x16x32_bf16 v[20:23], v[152:155], a[132:135], v[20:23]
    v_cmp_le_i32_e64 s[50:51], 11, v5
    v_cndmask_b32_e64 v32, v6, v112, s[44:45]
    v_cndmask_b32_e64 v33, v6, v112, s[46:47]
    v_mfma_f32_16x16x32_bf16 v[24:27], v[152:155], a[136:139], v[120:123]
    v_exp_f32 v187, v67
    v_cndmask_b32_e64 v34, v6, v112, s[48:49]
    v_mfma_f32_16x16x32_bf16 v[28:31], v[152:155], a[140:143], v[124:127]
    buffer_load_dwordx4 v2, s[12:15], s40 offen offset:2048 lds
    v_mfma_f32_16x16x32_bf16 v[16:19], v[156:159], a[144:147], v[16:19]
    ds_read_b128 v[176:179], v3 offset:6144
    v_exp_f32 v188, v68
    v_mfma_f32_16x16x32_bf16 v[20:23], v[156:159], a[148:151], v[20:23]
    v_cvt_pk_bf16_f32 v99, v186, v187
    v_cndmask_b32_e64 v35, v6, v112, s[50:51]
    v_cmp_le_i32_e64 s[44:45], -8, v5
    v_mfma_f32_16x16x32_bf16 v[24:27], v[156:159], a[152:155], v[24:27]
    v_exp_f32 v189, v69
    v_cmp_le_i32_e64 s[46:47], -7, v5
    v_mfma_f32_16x16x32_bf16 v[28:31], v[156:159], a[156:159], v[28:31]
    v_cvt_pk_bf16_f32 v102, v188, v189
    v_cmp_le_i32_e64 s[48:49], -6, v5
    v_cmp_le_i32_e64 s[50:51], -5, v5
    s_waitcnt lgkmcnt(3)
    v_mfma_f32_16x16x32_bf16 v[16:19], v[160:163], a[160:163], v[16:19]
    ds_read_b128 v[180:183], v3 offset:7168
    v_exp_f32 v190, v70
    v_mfma_f32_16x16x32_bf16 v[20:23], v[160:163], a[164:167], v[20:23]
    buffer_load_dwordx4 v2, s[12:15], s40 offen offset:3072 lds
    v_mfma_f32_16x16x32_bf16 v[24:27], v[160:163], a[168:171], v[24:27]
    v_exp_f32 v191, v71
    v_cndmask_b32_e64 v36, v6, v116, s[44:45]
    v_mfma_f32_16x16x32_bf16 v[28:31], v[160:163], a[172:175], v[28:31]
    v_cvt_pk_bf16_f32 v103, v190, v191
    v_cndmask_b32_e64 v37, v6, v116, s[46:47]
    v_cndmask_b32_e64 v38, v6, v116, s[48:49]
    v_mfma_f32_16x16x32_bf16 v[16:19], v[164:167], a[176:179], v[16:19]
    v_exp_f32 v184, v72
    v_cndmask_b32_e64 v39, v6, v116, s[50:51]
    v_mfma_f32_16x16x32_bf16 v[20:23], v[164:167], a[180:183], v[20:23]
    v_mfma_f32_16x16x32_bf16 v[24:27], v[164:167], a[184:187], v[24:27]
    v_exp_f32 v185, v73
    v_mfma_f32_16x16x32_bf16 v[28:31], v[164:167], a[188:191], v[28:31]
    v_cvt_pk_bf16_f32 v106, v184, v185
    s_waitcnt lgkmcnt(2)
    v_mfma_f32_16x16x32_bf16 v[32:35], v[168:171], a[128:131], v[32:35]
    v_exp_f32 v186, v74
    v_mfma_f32_16x16x32_bf16 v[36:39], v[168:171], a[132:135], v[36:39]
    v_mfma_f32_16x16x32_bf16 v[40:43], v[168:171], a[136:139], v[120:123]
    v_exp_f32 v187, v75
    v_mfma_f32_16x16x32_bf16 v[44:47], v[168:171], a[140:143], v[124:127]
    v_cvt_pk_bf16_f32 v107, v186, v187
    s_waitcnt vmcnt(18) lgkmcnt(0)
    s_barrier
    v_mfma_f32_16x16x32_bf16 v[32:35], v[172:175], a[144:147], v[32:35]
    ds_read_b128 v[152:155], v4 offset:8192
    v_exp_f32 v188, v76
    v_mfma_f32_16x16x32_bf16 v[36:39], v[172:175], a[148:151], v[36:39]
    ds_read_b128 v[156:159], v4 offset:9216
    v_exp_f32 v189, v77
    v_mfma_f32_16x16x32_bf16 v[40:43], v[172:175], a[152:155], v[40:43]
    v_cvt_pk_bf16_f32 v110, v188, v189
    v_mfma_f32_16x16x32_bf16 v[44:47], v[172:175], a[156:159], v[44:47]
    v_mfma_f32_16x16x32_bf16 v[32:35], v[176:179], a[160:163], v[32:35]
    ds_read_b128 v[160:163], v4 offset:10240
    v_exp_f32 v190, v78
    v_mfma_f32_16x16x32_bf16 v[36:39], v[176:179], a[164:167], v[36:39]
    ds_read_b128 v[164:167], v4 offset:11264
    v_exp_f32 v191, v79
    v_mfma_f32_16x16x32_bf16 v[40:43], v[176:179], a[168:171], v[40:43]
    v_cvt_pk_bf16_f32 v111, v190, v191
    v_mfma_f32_16x16x32_bf16 v[44:47], v[176:179], a[172:175], v[44:47]
    v_mfma_f32_16x16x32_bf16 v[32:35], v[180:183], a[176:179], v[32:35]
    ds_read_b128 v[168:171], v4 offset:12288
    v_mfma_f32_16x16x32_bf16 v[36:39], v[180:183], a[180:183], v[36:39]
    v_mfma_f32_16x16x32_bf16 v[40:43], v[180:183], a[184:187], v[40:43]
    v_mfma_f32_16x16x32_bf16 v[44:47], v[180:183], a[188:191], v[44:47]
    s_waitcnt lgkmcnt(3)
    v_mfma_f32_16x16x32_bf16 a[0:3], v[152:155], v[96:99], a[0:3]
    ds_read_b128 v[172:175], v4 offset:13312
    s_waitcnt vmcnt(9)
    v_dot2c_f32_bf16 v0, v12, v10
    v_mfma_f32_16x16x32_bf16 a[4:7], v[152:155], v[100:103], a[4:7]
    v_exp_f32 v184, v16
    v_cmp_le_i32_e64 s[44:45], 0, v5
    v_mfma_f32_16x16x32_bf16 a[8:11], v[152:155], v[104:107], a[8:11]
    v_exp_f32 v185, v17
    v_cmp_le_i32_e64 s[46:47], 1, v5
    v_mfma_f32_16x16x32_bf16 a[12:15], v[152:155], v[108:111], a[12:15]
    v_dot2c_f32_bf16 v0, v12, v11
    v_exp_f32 v186, v18
    v_mfma_f32_16x16x32_bf16 a[16:19], v[156:159], v[96:99], a[16:19]
    ds_read_b128 v[176:179], v4 offset:14336
    v_exp_f32 v187, v19
    v_mfma_f32_16x16x32_bf16 a[20:23], v[156:159], v[100:103], a[20:23]
    buffer_load_dwordx2 v[10:11], v9, s[20:23], 0 offen
    v_mfma_f32_16x16x32_bf16 a[24:27], v[156:159], v[104:107], a[24:27]
    v_exp_f32 v188, v20
    v_cvt_pk_bf16_f32 v80, v184, v185
    v_mfma_f32_16x16x32_bf16 a[28:31], v[156:159], v[108:111], a[28:31]
    v_exp_f32 v189, v21
    v_cvt_pk_bf16_f32 v81, v186, v187
    v_mfma_f32_16x16x32_bf16 v[128:131], v[12:15], v[96:99], v[128:131]
    v_cvt_pk_bf16_f32 v84, v188, v189
    v_cmp_le_i32_e64 s[48:49], 2, v5
    v_cmp_le_i32_e64 s[50:51], 3, v5
    s_waitcnt lgkmcnt(3)
    v_mfma_f32_16x16x32_bf16 a[32:35], v[160:163], v[96:99], a[32:35]
    ds_read_b128 v[180:183], v4 offset:15360
    v_add_u32 v9, s69, v9
    v_cndmask_b32_e64 v56, v6, v120, s[44:45]
    v_mfma_f32_16x16x32_bf16 a[36:39], v[160:163], v[100:103], a[36:39]
    v_exp_f32 v190, v22
    v_cndmask_b32_e64 v57, v6, v120, s[46:47]
    v_mfma_f32_16x16x32_bf16 a[40:43], v[160:163], v[104:107], a[40:43]
    v_exp_f32 v191, v23
    v_cndmask_b32_e64 v58, v6, v120, s[48:49]
    v_mfma_f32_16x16x32_bf16 a[44:47], v[160:163], v[108:111], a[44:47]
    buffer_store_dwordx4 v[148:151], v1, s[64:67], s68 offen sc0 sc1
    v_mfma_f32_16x16x32_bf16 a[48:51], v[164:167], v[96:99], a[48:51]
    ds_read_b128 v[152:155], v3 offset:8192
    v_exp_f32 v184, v24
    v_mfma_f32_16x16x32_bf16 a[52:55], v[164:167], v[100:103], a[52:55]
    v_exp_f32 v185, v25
    v_cvt_pk_bf16_f32 v85, v190, v191
    v_mfma_f32_16x16x32_bf16 a[56:59], v[164:167], v[104:107], a[56:59]
    v_exp_f32 v186, v26
    v_cvt_pk_bf16_f32 v88, v184, v185
    v_mfma_f32_16x16x32_bf16 a[60:63], v[164:167], v[108:111], a[60:63]
    v_exp_f32 v187, v27
    v_cndmask_b32_e64 v59, v6, v120, s[50:51]
    v_mfma_f32_16x16x32_bf16 v[132:135], v[12:15], v[100:103], v[132:135]
    v_cvt_pk_bf16_f32 v89, v186, v187
    v_cmp_le_i32_e64 s[44:45], -16, v5
    v_cmp_le_i32_e64 s[46:47], -15, v5
    s_waitcnt lgkmcnt(3)
    v_mfma_f32_16x16x32_bf16 a[64:67], v[168:171], v[96:99], a[64:67]
    ds_read_b128 v[156:159], v3 offset:9216
    s_add_u32 s68, s68, 1048576
    v_cmp_le_i32_e64 s[48:49], -14, v5
    v_mfma_f32_16x16x32_bf16 a[68:71], v[168:171], v[100:103], a[68:71]
    v_exp_f32 v188, v28
    v_cmp_le_i32_e64 s[50:51], -13, v5
    v_mfma_f32_16x16x32_bf16 a[72:75], v[168:171], v[104:107], a[72:75]
    v_exp_f32 v189, v29
    v_mfma_f32_16x16x32_bf16 a[76:79], v[168:171], v[108:111], a[76:79]
    v_exp_f32 v190, v30
    v_cvt_pk_bf16_f32 v92, v188, v189
    v_mfma_f32_16x16x32_bf16 a[80:83], v[172:175], v[96:99], a[80:83]
    ds_read_b128 v[160:163], v3 offset:10240
    v_exp_f32 v191, v31
    v_mfma_f32_16x16x32_bf16 a[84:87], v[172:175], v[100:103], a[84:87]
    v_cvt_pk_bf16_f32 v93, v190, v191
    v_cndmask_b32_e64 v60, v6, v124, s[44:45]
    v_cndmask_b32_e64 v61, v6, v124, s[46:47]
    v_mfma_f32_16x16x32_bf16 a[88:91], v[172:175], v[104:107], a[88:91]
    v_exp_f32 v184, v32
    v_mfma_f32_16x16x32_bf16 a[92:95], v[172:175], v[108:111], a[92:95]
    v_exp_f32 v185, v33
    v_cndmask_b32_e64 v62, v6, v124, s[48:49]
    v_mfma_f32_16x16x32_bf16 v[136:139], v[12:15], v[104:107], v[136:139]
    v_cvt_pk_bf16_f32 v82, v184, v185
    s_waitcnt lgkmcnt(3)
    v_mfma_f32_16x16x32_bf16 a[96:99], v[176:179], v[96:99], a[96:99]
    ds_read_b128 v[164:167], v3 offset:11264
    v_exp_f32 v186, v34
    v_mfma_f32_16x16x32_bf16 a[100:103], v[176:179], v[100:103], a[100:103]
    v_exp_f32 v187, v35
    v_cndmask_b32_e64 v63, v6, v124, s[50:51]
    v_mfma_f32_16x16x32_bf16 a[104:107], v[176:179], v[104:107], a[104:107]
    v_cvt_pk_bf16_f32 v83, v186, v187
    v_mfma_f32_16x16x32_bf16 a[108:111], v[176:179], v[108:111], a[108:111]
    v_exp_f32 v188, v36
    v_mfma_f32_16x16x32_bf16 a[112:115], v[180:183], v[96:99], a[112:115]
    ds_read_b128 v[168:171], v3 offset:12288
    v_exp_f32 v189, v37
    v_mfma_f32_16x16x32_bf16 a[116:119], v[180:183], v[100:103], a[116:119]
    v_cvt_pk_bf16_f32 v86, v188, v189
    v_mfma_f32_16x16x32_bf16 a[120:123], v[180:183], v[104:107], a[120:123]
    v_exp_f32 v190, v38
    v_mfma_f32_16x16x32_bf16 a[124:127], v[180:183], v[108:111], a[124:127]
    v_exp_f32 v191, v39
    v_cmp_le_i32_e64 s[44:45], 8, v5
    v_mfma_f32_16x16x32_bf16 v[140:143], v[12:15], v[108:111], v[140:143]
    v_cvt_pk_bf16_f32 v87, v190, v191
    v_cmp_le_i32_e64 s[46:47], 9, v5
    v_cmp_le_i32_e64 s[48:49], 10, v5
    s_waitcnt lgkmcnt(3)
    v_mfma_f32_16x16x32_bf16 v[56:59], v[152:155], a[136:139], v[56:59]
    ds_read_b128 v[172:175], v3 offset:13312
    v_exp_f32 v184, v40
    v_mfma_f32_16x16x32_bf16 v[60:63], v[152:155], a[140:143], v[60:63]
    v_exp_f32 v185, v41
    v_cmp_le_i32_e64 s[50:51], 11, v5
    v_mfma_f32_16x16x32_bf16 v[56:59], v[156:159], a[152:155], v[56:59]
    ds_read_b128 v[176:179], v3 offset:14336
    v_exp_f32 v186, v42
    v_mfma_f32_16x16x32_bf16 v[60:63], v[156:159], a[156:159], v[60:63]
    v_cvt_pk_bf16_f32 v90, v184, v185
    v_cndmask_b32_e64 v72, v6, v120, s[44:45]
    v_cndmask_b32_e64 v73, v6, v120, s[46:47]
    s_waitcnt lgkmcnt(3)
    v_mfma_f32_16x16x32_bf16 v[56:59], v[160:163], a[168:171], v[56:59]
    ds_read_b128 v[180:183], v3 offset:15360
    v_exp_f32 v187, v43
    v_mfma_f32_16x16x32_bf16 v[60:63], v[160:163], a[172:175], v[60:63]
    v_cvt_pk_bf16_f32 v91, v186, v187
    v_cndmask_b32_e64 v74, v6, v120, s[48:49]
    v_cndmask_b32_e64 v75, v6, v120, s[50:51]
    v_cmp_le_i32_e64 s[44:45], -8, v5
    v_cmp_le_i32_e64 s[46:47], -7, v5
    v_cmp_le_i32_e64 s[48:49], -6, v5
    v_cmp_le_i32_e64 s[50:51], -5, v5
    v_cndmask_b32_e64 v76, v6, v124, s[44:45]
    v_cndmask_b32_e64 v77, v6, v124, s[46:47]
    v_cndmask_b32_e64 v78, v6, v124, s[48:49]
    v_cndmask_b32_e64 v79, v6, v124, s[50:51]
    v_mfma_f32_16x16x32_bf16 v[56:59], v[164:167], a[184:187], v[56:59]
    v_exp_f32 v188, v44
    v_mfma_f32_16x16x32_bf16 v[60:63], v[164:167], a[188:191], v[60:63]
    v_exp_f32 v189, v45
    s_waitcnt lgkmcnt(2)
    v_mfma_f32_16x16x32_bf16 v[72:75], v[168:171], a[136:139], v[72:75]
    v_cvt_pk_bf16_f32 v94, v188, v189
    v_mfma_f32_16x16x32_bf16 v[76:79], v[168:171], a[140:143], v[76:79]
    v_exp_f32 v190, v46
    s_waitcnt vmcnt(10) lgkmcnt(0)
    s_barrier
    v_xor_b32 v4, 0x4000, v4
    v_xor_b32 v3, 81920, v3
    v_mfma_f32_16x16x32_bf16 v[72:75], v[172:175], a[152:155], v[72:75]
    ds_read_b128 v[152:155], v4 offset:0
    v_exp_f32 v191, v47
    v_mfma_f32_16x16x32_bf16 v[76:79], v[172:175], a[156:159], v[76:79]
    ds_read_b128 v[156:159], v4 offset:1024
    v_cvt_pk_bf16_f32 v95, v190, v191
    v_mfma_f32_16x16x32_bf16 v[72:75], v[176:179], a[168:171], v[72:75]
    ds_read_b128 v[160:163], v4 offset:2048
    v_mfma_f32_16x16x32_bf16 v[76:79], v[176:179], a[172:175], v[76:79]
    ds_read_b128 v[164:167], v4 offset:3072
    v_mfma_f32_16x16x32_bf16 v[72:75], v[180:183], a[184:187], v[72:75]
    ds_read_b128 v[168:171], v4 offset:4096
    v_mfma_f32_16x16x32_bf16 v[76:79], v[180:183], a[188:191], v[76:79]
K2_S2:
    s_waitcnt lgkmcnt(3)
    v_mfma_f32_16x16x32_bf16 a[0:3], v[152:155], v[80:83], a[0:3]
    ds_read_b128 v[172:175], v4 offset:5120
    v_exp_f32 v184, v56
    v_mfma_f32_16x16x32_bf16 a[4:7], v[152:155], v[84:87], a[4:7]
    v_cmp_le_i32_e64 s[44:45], 0, v5
    v_cmp_le_i32_e64 s[46:47], 1, v5
    v_cmp_le_i32_e64 s[48:49], 2, v5
    v_mfma_f32_16x16x32_bf16 a[8:11], v[152:155], v[88:91], a[8:11]
    ds_read_b128 v[192:195], v7 offset:0
    ds_read_b128 v[196:199], v7 offset:1024
    ds_read_b128 v[200:203], v7 offset:2048
    v_mfma_f32_16x16x32_bf16 a[12:15], v[152:155], v[92:95], a[12:15]
    v_mov_b32 v120, v146
    v_mov_b32 v121, v146
    v_mfma_f32_16x16x32_bf16 a[16:19], v[156:159], v[80:83], a[16:19]
    ds_read_b128 v[176:179], v4 offset:6144
    v_exp_f32 v185, v57
    v_mfma_f32_16x16x32_bf16 a[20:23], v[156:159], v[84:87], a[20:23]
    v_cvt_pk_bf16_f32 v104, v184, v185
    v_cmp_le_i32_e64 s[50:51], 3, v5
    v_cndmask_b32_e64 v16, v6, v144, s[44:45]
    v_mfma_f32_16x16x32_bf16 a[24:27], v[156:159], v[88:91], a[24:27]
    ds_read_b128 v[204:207], v7 offset:3072
    ds_read_b128 v[208:211], v7 offset:4096
    ds_read_b128 v[212:215], v7 offset:5120
    v_mfma_f32_16x16x32_bf16 a[28:31], v[156:159], v[92:95], a[28:31]
    v_mfma_f32_16x16x32_bf16 v[128:131], v[12:15], v[80:83], v[128:131]
    v_exp_f32 v186, v58
    v_cndmask_b32_e64 v17, v6, v144, s[46:47]
    s_waitcnt lgkmcnt(9)
    v_mfma_f32_16x16x32_bf16 a[32:35], v[160:163], v[80:83], a[32:35]
    ds_read_b128 v[180:183], v4 offset:7168
    v_exp_f32 v187, v59
    v_mfma_f32_16x16x32_bf16 a[36:39], v[160:163], v[84:87], a[36:39]
    v_cvt_pk_bf16_f32 v105, v186, v187
    v_cndmask_b32_e64 v18, v6, v144, s[48:49]
    v_cndmask_b32_e64 v19, v6, v144, s[50:51]
    v_mfma_f32_16x16x32_bf16 a[40:43], v[160:163], v[88:91], a[40:43]
    ds_read_b128 v[216:219], v7 offset:6144
    ds_read_b128 v[220:223], v7 offset:7168
    ds_read_b128 v[224:227], v7 offset:8192
    v_mfma_f32_16x16x32_bf16 a[44:47], v[160:163], v[92:95], a[44:47]
    v_mov_b32 v122, v146
    v_mov_b32 v123, v146
    v_mfma_f32_16x16x32_bf16 a[48:51], v[164:167], v[80:83], a[48:51]
    ds_read_b128 v[152:155], v3 offset:0
    v_exp_f32 v188, v60
    v_mfma_f32_16x16x32_bf16 a[52:55], v[164:167], v[84:87], a[52:55]
    ds_read_b128 v[228:231], v7 offset:9216
    ds_read_b128 v[232:235], v7 offset:10240
    ds_read_b128 v[236:239], v7 offset:11264
    v_mfma_f32_16x16x32_bf16 a[56:59], v[164:167], v[88:91], a[56:59]
    v_mfma_f32_16x16x32_bf16 a[60:63], v[164:167], v[92:95], a[60:63]
    v_mfma_f32_16x16x32_bf16 v[132:135], v[12:15], v[84:87], v[132:135]
    v_cmp_le_i32_e64 s[44:45], -16, v5
    v_cmp_le_i32_e64 s[46:47], -15, v5
    v_cmp_le_i32_e64 s[48:49], -14, v5
    s_waitcnt lgkmcnt(15)
    v_mfma_f32_16x16x32_bf16 a[64:67], v[168:171], v[80:83], a[64:67]
    ds_read_b128 v[156:159], v3 offset:1024
    v_exp_f32 v189, v61
    v_mfma_f32_16x16x32_bf16 a[68:71], v[168:171], v[84:87], a[68:71]
    v_cvt_pk_bf16_f32 v108, v188, v189
    v_cmp_le_i32_e64 s[50:51], -13, v5
    ds_read_b128 v[240:243], v7 offset:12288
    v_mfma_f32_16x16x32_bf16 a[72:75], v[168:171], v[88:91], a[72:75]
    ds_read_b128 v[244:247], v7 offset:13312
    ds_read_b128 v[248:251], v7 offset:14336
    ds_read_b128 v[252:255], v7 offset:15360
    v_mfma_f32_16x16x32_bf16 a[76:79], v[168:171], v[92:95], a[76:79]
    v_mov_b32 v124, v147
    v_mov_b32 v125, v147
    v_mov_b32 v126, v147
    v_mfma_f32_16x16x32_bf16 a[80:83], v[172:175], v[80:83], a[80:83]
    ds_read_b128 v[160:163], v3 offset:2048
    v_exp_f32 v190, v62
    v_mfma_f32_16x16x32_bf16 a[84:87], v[172:175], v[84:87], a[84:87]
    v_mfma_f32_16x16x32_bf16 a[88:91], v[172:175], v[88:91], a[88:91]
    v_mfma_f32_16x16x32_bf16 a[92:95], v[172:175], v[92:95], a[92:95]
    v_cndmask_b32_e64 v20, v6, v145, s[44:45]
    v_cndmask_b32_e64 v21, v6, v145, s[46:47]
    v_cndmask_b32_e64 v22, v6, v145, s[48:49]
    v_mfma_f32_16x16x32_bf16 v[136:139], v[12:15], v[88:91], v[136:139]
    s_waitcnt lgkmcnt(13)
    v_mfma_f32_16x16x32_bf16 a[96:99], v[176:179], v[80:83], a[96:99]
    ds_read_b128 v[164:167], v3 offset:3072
    v_exp_f32 v191, v63
    v_mfma_f32_16x16x32_bf16 a[100:103], v[176:179], v[84:87], a[100:103]
    v_cvt_pk_bf16_f32 v109, v190, v191
    v_cndmask_b32_e64 v23, v6, v145, s[50:51]
    v_mov_b32 v127, v147
    v_mfma_f32_16x16x32_bf16 a[104:107], v[176:179], v[88:91], a[104:107]
    v_mfma_f32_16x16x32_bf16 a[108:111], v[176:179], v[92:95], a[108:111]
    v_mfma_f32_16x16x32_bf16 a[112:115], v[180:183], v[80:83], a[112:115]
    ds_read_b128 v[168:171], v3 offset:4096
    v_exp_f32 v184, v72
    v_mfma_f32_16x16x32_bf16 a[116:119], v[180:183], v[84:87], a[116:119]
    v_mfma_f32_16x16x32_bf16 a[120:123], v[180:183], v[88:91], a[120:123]
    v_mfma_f32_16x16x32_bf16 a[124:127], v[180:183], v[92:95], a[124:127]
    v_cmp_le_i32_e64 s[44:45], 8, v5
    v_cmp_le_i32_e64 s[46:47], 9, v5
    v_cmp_le_i32_e64 s[48:49], 10, v5
    v_mfma_f32_16x16x32_bf16 v[140:143], v[12:15], v[92:95], v[140:143]
    s_waitcnt lgkmcnt(7)
    s_waitcnt lgkmcnt(3)
    v_mfma_f32_16x16x32_bf16 v[16:19], v[152:155], v[192:195], v[16:19]
    ds_read_b128 v[172:175], v3 offset:5120
    v_exp_f32 v185, v73
    v_mfma_f32_16x16x32_bf16 v[20:23], v[152:155], v[196:199], v[20:23]
    v_cvt_pk_bf16_f32 v106, v184, v185
    v_cmp_le_i32_e64 s[50:51], 11, v5
    v_cndmask_b32_e64 v32, v6, v144, s[44:45]
    v_mfma_f32_16x16x32_bf16 v[24:27], v[152:155], v[200:203], v[120:123]
    v_mov_b32 v112, v144
    v_mov_b32 v113, v144
    v_mfma_f32_16x16x32_bf16 v[28:31], v[152:155], v[204:207], v[124:127]
    v_cndmask_b32_e64 v33, v6, v144, s[46:47]
    v_cndmask_b32_e64 v34, v6, v144, s[48:49]
    v_cndmask_b32_e64 v35, v6, v144, s[50:51]
    v_mfma_f32_16x16x32_bf16 v[16:19], v[156:159], v[208:211], v[16:19]
    ds_read_b128 v[176:179], v3 offset:6144
    v_exp_f32 v186, v74
    v_mfma_f32_16x16x32_bf16 v[20:23], v[156:159], v[212:215], v[20:23]
    v_mfma_f32_16x16x32_bf16 v[24:27], v[156:159], v[216:219], v[24:27]
    v_cmp_le_i32_e64 s[44:45], -8, v5
    v_cmp_le_i32_e64 s[46:47], -7, v5
    v_cmp_le_i32_e64 s[48:49], -6, v5
    v_mfma_f32_16x16x32_bf16 v[28:31], v[156:159], v[220:223], v[28:31]
    s_waitcnt lgkmcnt(3)
    v_mfma_f32_16x16x32_bf16 v[16:19], v[160:163], v[224:227], v[16:19]
    ds_read_b128 v[180:183], v3 offset:7168
    v_exp_f32 v187, v75
    v_mfma_f32_16x16x32_bf16 v[20:23], v[160:163], v[228:231], v[20:23]
    v_cvt_pk_bf16_f32 v107, v186, v187
    v_cmp_le_i32_e64 s[50:51], -5, v5
    v_cndmask_b32_e64 v36, v6, v145, s[44:45]
    v_mfma_f32_16x16x32_bf16 v[24:27], v[160:163], v[232:235], v[24:27]
    v_mov_b32 v114, v144
    v_mov_b32 v115, v144
    v_mfma_f32_16x16x32_bf16 v[28:31], v[160:163], v[236:239], v[28:31]
    v_cndmask_b32_e64 v37, v6, v145, s[46:47]
    v_cndmask_b32_e64 v38, v6, v145, s[48:49]
    v_cndmask_b32_e64 v39, v6, v145, s[50:51]
    v_mfma_f32_16x16x32_bf16 v[16:19], v[164:167], v[240:243], v[16:19]
    v_exp_f32 v188, v76
    v_mov_b32 v116, v145
    v_mfma_f32_16x16x32_bf16 v[20:23], v[164:167], v[244:247], v[20:23]
    v_mfma_f32_16x16x32_bf16 v[24:27], v[164:167], v[248:251], v[24:27]
    v_mfma_f32_16x16x32_bf16 v[28:31], v[164:167], v[252:255], v[28:31]
    s_waitcnt lgkmcnt(2)
    v_mfma_f32_16x16x32_bf16 v[32:35], v[168:171], v[192:195], v[32:35]
    v_exp_f32 v189, v77
    v_mov_b32 v117, v145
    v_mfma_f32_16x16x32_bf16 v[36:39], v[168:171], v[196:199], v[36:39]
    v_cvt_pk_bf16_f32 v110, v188, v189
    v_mfma_f32_16x16x32_bf16 v[40:43], v[168:171], v[200:203], v[120:123]
    v_mfma_f32_16x16x32_bf16 v[44:47], v[168:171], v[204:207], v[124:127]
    s_waitcnt vmcnt(2) lgkmcnt(0)
    s_barrier
    v_mfma_f32_16x16x32_bf16 v[32:35], v[172:175], v[208:211], v[32:35]
    ds_read_b128 v[152:155], v4 offset:8192
    v_exp_f32 v190, v78
    v_mfma_f32_16x16x32_bf16 v[36:39], v[172:175], v[212:215], v[36:39]
    ds_read_b128 v[156:159], v4 offset:9216
    v_exp_f32 v191, v79
    v_mfma_f32_16x16x32_bf16 v[40:43], v[172:175], v[216:219], v[40:43]
    v_cvt_pk_bf16_f32 v111, v190, v191
    v_mov_b32 v118, v145
    v_mfma_f32_16x16x32_bf16 v[44:47], v[172:175], v[220:223], v[44:47]
    v_mfma_f32_16x16x32_bf16 v[32:35], v[176:179], v[224:227], v[32:35]
    ds_read_b128 v[160:163], v4 offset:10240
    v_mov_b32 v119, v145
    v_mfma_f32_16x16x32_bf16 v[36:39], v[176:179], v[228:231], v[36:39]
    ds_read_b128 v[164:167], v4 offset:11264
    v_mfma_f32_16x16x32_bf16 v[40:43], v[176:179], v[232:235], v[40:43]
    v_mfma_f32_16x16x32_bf16 v[44:47], v[176:179], v[236:239], v[44:47]
    v_mfma_f32_16x16x32_bf16 v[32:35], v[180:183], v[240:243], v[32:35]
    ds_read_b128 v[168:171], v4 offset:12288
    v_mfma_f32_16x16x32_bf16 v[36:39], v[180:183], v[244:247], v[36:39]
    v_mfma_f32_16x16x32_bf16 v[40:43], v[180:183], v[248:251], v[40:43]
    v_mfma_f32_16x16x32_bf16 v[44:47], v[180:183], v[252:255], v[44:47]
    s_waitcnt lgkmcnt(3)
    v_mfma_f32_16x16x32_bf16 a[8:11], v[152:155], v[104:107], a[8:11]
    ds_read_b128 v[172:175], v4 offset:13312
    s_waitcnt vmcnt(1)
    v_dot2c_f32_bf16 v0, v12, v10
    v_mfma_f32_16x16x32_bf16 a[12:15], v[152:155], v[108:111], a[12:15]
    v_exp_f32 v184, v16
    v_cmp_le_i32_e64 s[44:45], 0, v5
    v_mfma_f32_16x16x32_bf16 a[24:27], v[156:159], v[104:107], a[24:27]
    ds_read_b128 v[176:179], v4 offset:14336
    v_dot2c_f32_bf16 v0, v12, v11
    v_cmp_le_i32_e64 s[46:47], 1, v5
    v_mfma_f32_16x16x32_bf16 a[28:31], v[156:159], v[108:111], a[28:31]
    v_exp_f32 v185, v17
    v_cmp_le_i32_e64 s[48:49], 2, v5
    s_waitcnt lgkmcnt(3)
    v_mfma_f32_16x16x32_bf16 a[40:43], v[160:163], v[104:107], a[40:43]
    ds_read_b128 v[180:183], v4 offset:15360
    v_exp_f32 v186, v18
    v_mfma_f32_16x16x32_bf16 a[44:47], v[160:163], v[108:111], a[44:47]
    buffer_load_dwordx2 v[10:11], v9, s[20:23], 0 offen
    v_mfma_f32_16x16x32_bf16 a[56:59], v[164:167], v[104:107], a[56:59]
    ds_read_b128 v[152:155], v3 offset:8192
    v_add_u32 v9, s69, v9
    v_cvt_pk_bf16_f32 v80, v184, v185
    v_mfma_f32_16x16x32_bf16 a[60:63], v[164:167], v[108:111], a[60:63]
    v_exp_f32 v187, v19
    v_cmp_le_i32_e64 s[50:51], 3, v5
    s_waitcnt lgkmcnt(3)
    v_mfma_f32_16x16x32_bf16 a[72:75], v[168:171], v[104:107], a[72:75]
    ds_read_b128 v[156:159], v3 offset:9216
    v_exp_f32 v188, v20
    v_mfma_f32_16x16x32_bf16 a[76:79], v[168:171], v[108:111], a[76:79]
    v_exp_f32 v189, v21
    v_cvt_pk_bf16_f32 v81, v186, v187
    v_mfma_f32_16x16x32_bf16 a[88:91], v[172:175], v[104:107], a[88:91]
    ds_read_b128 v[160:163], v3 offset:10240
    v_exp_f32 v190, v22
    v_mfma_f32_16x16x32_bf16 a[92:95], v[172:175], v[108:111], a[92:95]
    v_exp_f32 v191, v23
    v_cvt_pk_bf16_f32 v84, v188, v189
    v_mfma_f32_16x16x32_bf16 v[136:139], v[12:15], v[104:107], v[136:139]
    buffer_store_dwordx4 v[148:151], v1, s[64:67], s68 offen sc0 sc1
    s_waitcnt lgkmcnt(3)
    v_mfma_f32_16x16x32_bf16 a[104:107], v[176:179], v[104:107], a[104:107]
    ds_read_b128 v[164:167], v3 offset:11264
    v_exp_f32 v184, v24
    v_mfma_f32_16x16x32_bf16 a[108:111], v[176:179], v[108:111], a[108:111]
    v_exp_f32 v185, v25
    v_cvt_pk_bf16_f32 v85, v190, v191
    v_mfma_f32_16x16x32_bf16 a[120:123], v[180:183], v[104:107], a[120:123]
    ds_read_b128 v[168:171], v3 offset:12288
    s_add_u32 s68, s68, 1048576
    v_cvt_pk_bf16_f32 v88, v184, v185
    v_cndmask_b32_e64 v56, v6, v146, s[44:45]
    v_cndmask_b32_e64 v57, v6, v146, s[46:47]
    v_cndmask_b32_e64 v58, v6, v146, s[48:49]
    v_cndmask_b32_e64 v59, v6, v146, s[50:51]
    v_cmp_le_i32_e64 s[44:45], -16, v5
    v_cmp_le_i32_e64 s[46:47], -15, v5
    v_cmp_le_i32_e64 s[48:49], -14, v5
    v_cmp_le_i32_e64 s[50:51], -13, v5
    v_cndmask_b32_e64 v60, v6, v147, s[44:45]
    v_cndmask_b32_e64 v61, v6, v147, s[46:47]
    v_cndmask_b32_e64 v62, v6, v147, s[48:49]
    v_cndmask_b32_e64 v63, v6, v147, s[50:51]
    v_mfma_f32_16x16x32_bf16 a[124:127], v[180:183], v[108:111], a[124:127]
    v_exp_f32 v186, v26
    v_cmp_le_i32_e64 s[44:45], 8, v5
    v_mfma_f32_16x16x32_bf16 v[140:143], v[12:15], v[108:111], v[140:143]
    v_exp_f32 v187, v27
    v_cmp_le_i32_e64 s[46:47], 9, v5
    s_waitcnt lgkmcnt(3)
    v_mfma_f32_16x16x32_bf16 v[56:59], v[152:155], v[200:203], v[56:59]
    ds_read_b128 v[172:175], v3 offset:13312
    v_exp_f32 v188, v28
    v_mfma_f32_16x16x32_bf16 v[60:63], v[152:155], v[204:207], v[60:63]
    v_exp_f32 v189, v29
    v_cvt_pk_bf16_f32 v89, v186, v187
    v_mfma_f32_16x16x32_bf16 v[56:59], v[156:159], v[216:219], v[56:59]
    ds_read_b128 v[176:179], v3 offset:14336
    v_exp_f32 v190, v30
    v_mfma_f32_16x16x32_bf16 v[60:63], v[156:159], v[220:223], v[60:63]
    v_exp_f32 v191, v31
    v_cvt_pk_bf16_f32 v92, v188, v189
    s_waitcnt lgkmcnt(3)
    v_mfma_f32_16x16x32_bf16 v[56:59], v[160:163], v[232:235], v[56:59]
    ds_read_b128 v[180:183], v3 offset:15360
    v_exp_f32 v184, v32
    v_mfma_f32_16x16x32_bf16 v[60:63], v[160:163], v[236:239], v[60:63]
    v_exp_f32 v185, v33
    v_cvt_pk_bf16_f32 v93, v190, v191
    v_cmp_le_i32_e64 s[48:49], 10, v5
    v_cmp_le_i32_e64 s[50:51], 11, v5
    v_cndmask_b32_e64 v72, v6, v146, s[44:45]
    v_cndmask_b32_e64 v73, v6, v146, s[46:47]
    v_cndmask_b32_e64 v74, v6, v146, s[48:49]
    v_cndmask_b32_e64 v75, v6, v146, s[50:51]
    v_cmp_le_i32_e64 s[44:45], -8, v5
    v_cmp_le_i32_e64 s[46:47], -7, v5
    v_cmp_le_i32_e64 s[48:49], -6, v5
    v_cmp_le_i32_e64 s[50:51], -5, v5
    v_cndmask_b32_e64 v76, v6, v147, s[44:45]
    v_cndmask_b32_e64 v77, v6, v147, s[46:47]
    v_cndmask_b32_e64 v78, v6, v147, s[48:49]
    v_cndmask_b32_e64 v79, v6, v147, s[50:51]
    v_mfma_f32_16x16x32_bf16 v[56:59], v[164:167], v[248:251], v[56:59]
    v_exp_f32 v186, v34
    v_cvt_pk_bf16_f32 v82, v184, v185
    v_mfma_f32_16x16x32_bf16 v[60:63], v[164:167], v[252:255], v[60:63]
    v_exp_f32 v187, v35
    ds_write_b128 v8, a[0:3] offset:0
    s_waitcnt lgkmcnt(3)
    v_mfma_f32_16x16x32_bf16 v[72:75], v[168:171], v[200:203], v[72:75]
    v_exp_f32 v188, v36
    v_cvt_pk_bf16_f32 v83, v186, v187
    v_mfma_f32_16x16x32_bf16 v[76:79], v[168:171], v[204:207], v[76:79]
    v_exp_f32 v189, v37
    ds_write_b128 v8, a[4:7] offset:1024
    ds_write_b128 v8, a[16:19] offset:2048
    ds_write_b128 v8, a[20:23] offset:3072
    ds_write_b128 v8, a[32:35] offset:4096
    ds_write_b128 v8, a[36:39] offset:5120
    ds_write_b128 v8, a[48:51] offset:6144
    ds_write_b128 v8, a[52:55] offset:7168
    ds_write_b128 v8, a[64:67] offset:8192
    ds_write_b128 v8, a[68:71] offset:9216
    ds_write_b128 v8, a[80:83] offset:10240
    ds_write_b128 v8, a[84:87] offset:11264
    ds_write_b128 v8, a[96:99] offset:12288
    ds_write_b128 v8, a[100:103] offset:13312
    ds_write_b128 v8, a[112:115] offset:14336
    ds_write_b128 v8, a[116:119] offset:15360
    ds_write_b32 v7, v128 offset:0
    ds_write_b32 v7, v132 offset:4
    ds_write_b32 v7, v136 offset:8
    ds_write_b32 v7, v140 offset:12
    s_waitcnt lgkmcnt(0)
    s_barrier
    v_xor_b32 v4, 81920, v4
    v_xor_b32 v3, 0x4000, v3
    v_mfma_f32_16x16x32_bf16 v[72:75], v[172:175], v[216:219], v[72:75]
    ds_read_b128 v[152:155], v4 offset:0
    v_exp_f32 v190, v38
    v_mfma_f32_16x16x32_bf16 v[76:79], v[172:175], v[220:223], v[76:79]
    ds_read_b128 v[156:159], v4 offset:1024
    v_exp_f32 v191, v39
    v_exp_f32 v184, v40
    v_exp_f32 v185, v41
    v_exp_f32 v186, v42
    v_exp_f32 v187, v43
    v_mfma_f32_16x16x32_bf16 v[72:75], v[176:179], v[232:235], v[72:75]
    ds_read_b128 v[160:163], v4 offset:2048
    v_cvt_pk_bf16_f32 v86, v188, v189
    v_cvt_pk_bf16_f32 v87, v190, v191
    v_exp_f32 v188, v44
    v_exp_f32 v189, v45
    v_exp_f32 v190, v46
    v_exp_f32 v191, v47
    v_cvt_pk_bf16_f32 v90, v184, v185
    v_cvt_pk_bf16_f32 v91, v186, v187
    v_cvt_pk_bf16_f32 v94, v188, v189
    v_cvt_pk_bf16_f32 v95, v190, v191
    v_mfma_f32_16x16x32_bf16 v[76:79], v[176:179], v[236:239], v[76:79]
    ds_read_b128 v[164:167], v4 offset:3072
    v_mfma_f32_16x16x32_bf16 v[72:75], v[180:183], v[248:251], v[72:75]
    ds_read_b128 v[168:171], v4 offset:4096
    v_mfma_f32_16x16x32_bf16 v[76:79], v[180:183], v[252:255], v[76:79]
    s_cmp_eq_u32 s28, 16
    s_cbranch_scc1 K2_FINZ
    s_waitcnt lgkmcnt(3)
    v_mfma_f32_16x16x32_bf16 a[128:131], v[152:155], v[80:83], 0
    ds_read_b128 v[172:175], v4 offset:5120
    v_exp_f32 v184, v56
    v_mfma_f32_16x16x32_bf16 a[132:135], v[152:155], v[84:87], 0
    ds_write_b128 v8, a[8:11] offset:16384
    ds_write_b128 v8, a[12:15] offset:17408
    v_mfma_f32_16x16x32_bf16 a[136:139], v[152:155], v[88:91], 0
    v_mfma_f32_16x16x32_bf16 a[140:143], v[152:155], v[92:95], 0
    v_mfma_f32_16x16x32_bf16 a[144:147], v[156:159], v[80:83], 0
    ds_read_b128 v[176:179], v4 offset:6144
    v_exp_f32 v185, v57
    v_mfma_f32_16x16x32_bf16 a[148:151], v[156:159], v[84:87], 0
    v_cvt_pk_bf16_f32 v104, v184, v185
    ds_write_b128 v8, a[24:27] offset:18432
    v_mfma_f32_16x16x32_bf16 a[152:155], v[156:159], v[88:91], 0
    v_mfma_f32_16x16x32_bf16 a[156:159], v[156:159], v[92:95], 0
    v_mfma_f32_16x16x32_bf16 v[128:131], v[12:15], v[80:83], 0
    v_exp_f32 v186, v58
    ds_write_b128 v8, a[28:31] offset:19456
    s_waitcnt lgkmcnt(7)
    v_mfma_f32_16x16x32_bf16 a[160:163], v[160:163], v[80:83], 0
    ds_read_b128 v[180:183], v4 offset:7168
    v_exp_f32 v187, v59
    v_mfma_f32_16x16x32_bf16 a[164:167], v[160:163], v[84:87], 0
    v_cvt_pk_bf16_f32 v105, v186, v187
    ds_write_b128 v8, a[40:43] offset:20480
    v_mfma_f32_16x16x32_bf16 a[168:171], v[160:163], v[88:91], 0
    v_mfma_f32_16x16x32_bf16 a[172:175], v[160:163], v[92:95], 0
    v_mfma_f32_16x16x32_bf16 a[176:179], v[164:167], v[80:83], 0
    ds_read_b128 v[152:155], v3 offset:0
    v_exp_f32 v188, v60
    v_mfma_f32_16x16x32_bf16 a[180:183], v[164:167], v[84:87], 0
    v_mfma_f32_16x16x32_bf16 a[184:187], v[164:167], v[88:91], 0
    v_mfma_f32_16x16x32_bf16 a[188:191], v[164:167], v[92:95], 0
    v_mfma_f32_16x16x32_bf16 v[132:135], v[12:15], v[84:87], 0
    ds_write_b128 v8, a[44:47] offset:21504
    ds_write_b128 v8, a[56:59] offset:22528
    s_waitcnt lgkmcnt(10)
    v_mfma_f32_16x16x32_bf16 a[192:195], v[168:171], v[80:83], 0
    ds_read_b128 v[156:159], v3 offset:1024
    v_exp_f32 v189, v61
    v_mfma_f32_16x16x32_bf16 a[196:199], v[168:171], v[84:87], 0
    v_cvt_pk_bf16_f32 v108, v188, v189
    v_mfma_f32_16x16x32_bf16 a[200:203], v[168:171], v[88:91], 0
    v_mfma_f32_16x16x32_bf16 a[204:207], v[168:171], v[92:95], 0
    v_mfma_f32_16x16x32_bf16 a[208:211], v[172:175], v[80:83], 0
    ds_read_b128 v[160:163], v3 offset:2048
    v_exp_f32 v190, v62
    v_mfma_f32_16x16x32_bf16 a[212:215], v[172:175], v[84:87], 0
    v_mfma_f32_16x16x32_bf16 a[216:219], v[172:175], v[88:91], 0
    ds_write_b128 v8, a[60:63] offset:23552
    ds_write_b128 v8, a[72:75] offset:24576
    v_mfma_f32_16x16x32_bf16 a[220:223], v[172:175], v[92:95], 0
    v_mfma_f32_16x16x32_bf16 v[136:139], v[12:15], v[88:91], 0
    s_waitcnt lgkmcnt(8)
    v_mfma_f32_16x16x32_bf16 a[224:227], v[176:179], v[80:83], 0
    ds_read_b128 v[164:167], v3 offset:3072
    v_exp_f32 v191, v63
    v_mfma_f32_16x16x32_bf16 a[228:231], v[176:179], v[84:87], 0
    v_cvt_pk_bf16_f32 v109, v190, v191
    ds_write_b128 v8, a[76:79] offset:25600
    v_mfma_f32_16x16x32_bf16 a[232:235], v[176:179], v[88:91], 0
    v_mfma_f32_16x16x32_bf16 a[236:239], v[176:179], v[92:95], 0
    v_mfma_f32_16x16x32_bf16 a[240:243], v[180:183], v[80:83], 0
    ds_read_b128 v[168:171], v3 offset:4096
    v_exp_f32 v184, v72
    v_mfma_f32_16x16x32_bf16 a[244:247], v[180:183], v[84:87], 0
    v_mfma_f32_16x16x32_bf16 a[248:251], v[180:183], v[88:91], 0
    v_mfma_f32_16x16x32_bf16 a[252:255], v[180:183], v[92:95], 0
    v_mfma_f32_16x16x32_bf16 v[140:143], v[12:15], v[92:95], 0
    ds_write_b128 v8, a[88:91] offset:26624
    ds_write_b128 v8, a[92:95] offset:27648
    s_waitcnt lgkmcnt(8)
    v_mfma_f32_16x16x32_bf16 v[16:19], v[152:155], v[192:195], v[112:115]
    ds_read_b128 v[172:175], v3 offset:5120
    v_exp_f32 v185, v73
    v_mfma_f32_16x16x32_bf16 v[20:23], v[152:155], v[196:199], v[116:119]
    v_cvt_pk_bf16_f32 v106, v184, v185
    v_mfma_f32_16x16x32_bf16 v[24:27], v[152:155], v[200:203], v[120:123]
    v_mfma_f32_16x16x32_bf16 v[28:31], v[152:155], v[204:207], v[124:127]
    v_mfma_f32_16x16x32_bf16 v[16:19], v[156:159], v[208:211], v[16:19]
    ds_read_b128 v[176:179], v3 offset:6144
    v_exp_f32 v186, v74
    v_mfma_f32_16x16x32_bf16 v[20:23], v[156:159], v[212:215], v[20:23]
    v_mfma_f32_16x16x32_bf16 v[24:27], v[156:159], v[216:219], v[24:27]
    ds_write_b128 v8, a[104:107] offset:28672
    ds_write_b128 v8, a[108:111] offset:29696
    v_mfma_f32_16x16x32_bf16 v[28:31], v[156:159], v[220:223], v[28:31]
    s_waitcnt lgkmcnt(8)
    v_mfma_f32_16x16x32_bf16 v[16:19], v[160:163], v[224:227], v[16:19]
    ds_read_b128 v[180:183], v3 offset:7168
    v_exp_f32 v187, v75
    v_mfma_f32_16x16x32_bf16 v[20:23], v[160:163], v[228:231], v[20:23]
    v_cvt_pk_bf16_f32 v107, v186, v187
    ds_write_b128 v8, a[120:123] offset:30720
    v_mfma_f32_16x16x32_bf16 v[24:27], v[160:163], v[232:235], v[24:27]
    v_mfma_f32_16x16x32_bf16 v[28:31], v[160:163], v[236:239], v[28:31]
    v_mfma_f32_16x16x32_bf16 v[16:19], v[164:167], v[240:243], v[16:19]
    v_exp_f32 v188, v76
    ds_write_b128 v8, a[124:127] offset:31744
    v_mfma_f32_16x16x32_bf16 v[20:23], v[164:167], v[244:247], v[20:23]
    v_mfma_f32_16x16x32_bf16 v[24:27], v[164:167], v[248:251], v[24:27]
    v_mfma_f32_16x16x32_bf16 v[28:31], v[164:167], v[252:255], v[28:31]
    s_waitcnt lgkmcnt(6)
    v_mfma_f32_16x16x32_bf16 v[32:35], v[168:171], v[192:195], v[112:115]
    v_exp_f32 v189, v77
    v_mfma_f32_16x16x32_bf16 v[36:39], v[168:171], v[196:199], v[116:119]
    v_cvt_pk_bf16_f32 v110, v188, v189
    v_mfma_f32_16x16x32_bf16 v[40:43], v[168:171], v[200:203], v[120:123]
    v_mfma_f32_16x16x32_bf16 v[44:47], v[168:171], v[204:207], v[124:127]
    s_waitcnt lgkmcnt(0)
    s_barrier
    v_mfma_f32_16x16x32_bf16 v[32:35], v[172:175], v[208:211], v[32:35]
    ds_read_b128 v[152:155], v4 offset:8192
    v_exp_f32 v190, v78
    v_mfma_f32_16x16x32_bf16 v[36:39], v[172:175], v[212:215], v[36:39]
    ds_read_b128 v[156:159], v4 offset:9216
    v_exp_f32 v191, v79
    v_mfma_f32_16x16x32_bf16 v[40:43], v[172:175], v[216:219], v[40:43]
    v_cvt_pk_bf16_f32 v111, v190, v191
    v_mfma_f32_16x16x32_bf16 v[44:47], v[172:175], v[220:223], v[44:47]
    v_mfma_f32_16x16x32_bf16 v[32:35], v[176:179], v[224:227], v[32:35]
    ds_read_b128 v[160:163], v4 offset:10240
    v_mfma_f32_16x16x32_bf16 v[36:39], v[176:179], v[228:231], v[36:39]
    ds_read_b128 v[164:167], v4 offset:11264
    v_mfma_f32_16x16x32_bf16 v[40:43], v[176:179], v[232:235], v[40:43]
    v_mfma_f32_16x16x32_bf16 v[44:47], v[176:179], v[236:239], v[44:47]
    v_mfma_f32_16x16x32_bf16 v[32:35], v[180:183], v[240:243], v[32:35]
    ds_read_b128 v[168:171], v4 offset:12288
    v_mfma_f32_16x16x32_bf16 v[36:39], v[180:183], v[244:247], v[36:39]
    v_mfma_f32_16x16x32_bf16 v[40:43], v[180:183], v[248:251], v[40:43]
    v_mfma_f32_16x16x32_bf16 v[44:47], v[180:183], v[252:255], v[44:47]
    s_waitcnt lgkmcnt(3)
    v_mfma_f32_16x16x32_bf16 a[136:139], v[152:155], v[104:107], a[136:139]
    ds_read_b128 v[172:175], v4 offset:13312
    s_waitcnt vmcnt(1)
    v_dot2c_f32_bf16 v0, v12, v10
    v_mfma_f32_16x16x32_bf16 a[140:143], v[152:155], v[108:111], a[140:143]
    v_exp_f32 v184, v16
    v_mfma_f32_16x16x32_bf16 a[152:155], v[156:159], v[104:107], a[152:155]
    ds_read_b128 v[176:179], v4 offset:14336
    v_dot2c_f32_bf16 v0, v12, v11
    v_mfma_f32_16x16x32_bf16 a[156:159], v[156:159], v[108:111], a[156:159]
    v_exp_f32 v185, v17
    s_waitcnt lgkmcnt(3)
    v_mfma_f32_16x16x32_bf16 a[168:171], v[160:163], v[104:107], a[168:171]
    ds_read_b128 v[180:183], v4 offset:15360
    v_exp_f32 v186, v18
    v_mfma_f32_16x16x32_bf16 a[172:175], v[160:163], v[108:111], a[172:175]
    buffer_load_dwordx2 v[10:11], v9, s[20:23], 0 offen
    v_mfma_f32_16x16x32_bf16 a[184:187], v[164:167], v[104:107], a[184:187]
    ds_read_b128 v[152:155], v3 offset:8192
    v_add_u32 v9, s69, v9
    v_cvt_pk_bf16_f32 v80, v184, v185
    v_mfma_f32_16x16x32_bf16 a[188:191], v[164:167], v[108:111], a[188:191]
    v_exp_f32 v187, v19
    s_waitcnt lgkmcnt(3)
    v_mfma_f32_16x16x32_bf16 a[200:203], v[168:171], v[104:107], a[200:203]
    ds_read_b128 v[156:159], v3 offset:9216
    v_exp_f32 v188, v20
    v_mfma_f32_16x16x32_bf16 a[204:207], v[168:171], v[108:111], a[204:207]
    v_exp_f32 v189, v21
    v_cvt_pk_bf16_f32 v81, v186, v187
    v_mfma_f32_16x16x32_bf16 a[216:219], v[172:175], v[104:107], a[216:219]
    ds_read_b128 v[160:163], v3 offset:10240
    v_exp_f32 v190, v22
    v_mfma_f32_16x16x32_bf16 a[220:223], v[172:175], v[108:111], a[220:223]
    v_exp_f32 v191, v23
    v_cvt_pk_bf16_f32 v84, v188, v189
    v_mfma_f32_16x16x32_bf16 v[136:139], v[12:15], v[104:107], v[136:139]
    buffer_store_dwordx4 v[148:151], v1, s[64:67], s68 offen sc0 sc1
    s_waitcnt lgkmcnt(3)
    v_mfma_f32_16x16x32_bf16 a[232:235], v[176:179], v[104:107], a[232:235]
    ds_read_b128 v[164:167], v3 offset:11264
    v_exp_f32 v184, v24
    v_mfma_f32_16x16x32_bf16 a[236:239], v[176:179], v[108:111], a[236:239]
    v_exp_f32 v185, v25
    v_cvt_pk_bf16_f32 v85, v190, v191
    v_mfma_f32_16x16x32_bf16 a[248:251], v[180:183], v[104:107], a[248:251]
    ds_read_b128 v[168:171], v3 offset:12288
    s_add_u32 s68, s68, 1048576
    v_cvt_pk_bf16_f32 v88, v184, v185
    v_mfma_f32_16x16x32_bf16 a[252:255], v[180:183], v[108:111], a[252:255]
    v_exp_f32 v186, v26
    v_mfma_f32_16x16x32_bf16 v[140:143], v[12:15], v[108:111], v[140:143]
    v_exp_f32 v187, v27
    s_waitcnt lgkmcnt(3)
    v_mfma_f32_16x16x32_bf16 v[48:51], v[152:155], v[192:195], v[112:115]
    ds_read_b128 v[172:175], v3 offset:13312
    v_exp_f32 v188, v28
    v_mfma_f32_16x16x32_bf16 v[52:55], v[152:155], v[196:199], v[116:119]
    v_exp_f32 v189, v29
    v_cvt_pk_bf16_f32 v89, v186, v187
    v_mfma_f32_16x16x32_bf16 v[56:59], v[152:155], v[200:203], v[120:123]
    v_exp_f32 v190, v30
    v_cvt_pk_bf16_f32 v92, v188, v189
    v_mfma_f32_16x16x32_bf16 v[60:63], v[152:155], v[204:207], v[124:127]
    v_exp_f32 v191, v31
    v_mfma_f32_16x16x32_bf16 v[48:51], v[156:159], v[208:211], v[48:51]
    ds_read_b128 v[176:179], v3 offset:14336
    v_exp_f32 v184, v32
    v_mfma_f32_16x16x32_bf16 v[52:55], v[156:159], v[212:215], v[52:55]
    v_cvt_pk_bf16_f32 v93, v190, v191
    v_mfma_f32_16x16x32_bf16 v[56:59], v[156:159], v[216:219], v[56:59]
    v_exp_f32 v185, v33
    v_mfma_f32_16x16x32_bf16 v[60:63], v[156:159], v[220:223], v[60:63]
    v_exp_f32 v186, v34
    v_cvt_pk_bf16_f32 v82, v184, v185
    s_waitcnt lgkmcnt(3)
    v_mfma_f32_16x16x32_bf16 v[48:51], v[160:163], v[224:227], v[48:51]
    ds_read_b128 v[180:183], v3 offset:15360
    v_exp_f32 v187, v35
    v_mfma_f32_16x16x32_bf16 v[52:55], v[160:163], v[228:231], v[52:55]
    v_cvt_pk_bf16_f32 v83, v186, v187
    v_mfma_f32_16x16x32_bf16 v[56:59], v[160:163], v[232:235], v[56:59]
    v_exp_f32 v188, v36
    v_mfma_f32_16x16x32_bf16 v[60:63], v[160:163], v[236:239], v[60:63]
    v_mfma_f32_16x16x32_bf16 v[48:51], v[164:167], v[240:243], v[48:51]
    v_exp_f32 v189, v37
    v_mfma_f32_16x16x32_bf16 v[52:55], v[164:167], v[244:247], v[52:55]
    v_exp_f32 v190, v38
    v_cvt_pk_bf16_f32 v86, v188, v189
    v_mfma_f32_16x16x32_bf16 v[56:59], v[164:167], v[248:251], v[56:59]
    v_mfma_f32_16x16x32_bf16 v[60:63], v[164:167], v[252:255], v[60:63]
    v_exp_f32 v191, v39
    s_waitcnt lgkmcnt(2)
    v_mfma_f32_16x16x32_bf16 v[64:67], v[168:171], v[192:195], v[112:115]
    v_exp_f32 v184, v40
    v_cvt_pk_bf16_f32 v87, v190, v191
    v_mfma_f32_16x16x32_bf16 v[68:71], v[168:171], v[196:199], v[116:119]
    v_exp_f32 v185, v41
    v_mfma_f32_16x16x32_bf16 v[72:75], v[168:171], v[200:203], v[120:123]
    v_cvt_pk_bf16_f32 v90, v184, v185
    v_mfma_f32_16x16x32_bf16 v[76:79], v[168:171], v[204:207], v[124:127]
    v_exp_f32 v186, v42
    s_waitcnt lgkmcnt(0)
    s_barrier
    v_xor_b32 v4, 0x4000, v4
    v_xor_b32 v3, 0x4000, v3
    v_mfma_f32_16x16x32_bf16 v[64:67], v[172:175], v[208:211], v[64:67]
    ds_read_b128 v[152:155], v4 offset:0
    v_exp_f32 v187, v43
    v_mfma_f32_16x16x32_bf16 v[68:71], v[172:175], v[212:215], v[68:71]
    ds_read_b128 v[156:159], v4 offset:1024
    v_exp_f32 v188, v44
    v_mfma_f32_16x16x32_bf16 v[72:75], v[172:175], v[216:219], v[72:75]
    v_cvt_pk_bf16_f32 v91, v186, v187
    v_mfma_f32_16x16x32_bf16 v[76:79], v[172:175], v[220:223], v[76:79]
    v_exp_f32 v189, v45
    v_mfma_f32_16x16x32_bf16 v[64:67], v[176:179], v[224:227], v[64:67]
    ds_read_b128 v[160:163], v4 offset:2048
    v_exp_f32 v190, v46
    v_mfma_f32_16x16x32_bf16 v[68:71], v[176:179], v[228:231], v[68:71]
    ds_read_b128 v[164:167], v4 offset:3072
    v_exp_f32 v191, v47
    v_mfma_f32_16x16x32_bf16 v[72:75], v[176:179], v[232:235], v[72:75]
    v_cvt_pk_bf16_f32 v94, v188, v189
    v_cvt_pk_bf16_f32 v95, v190, v191
    v_mfma_f32_16x16x32_bf16 v[76:79], v[176:179], v[236:239], v[76:79]
    v_mfma_f32_16x16x32_bf16 v[64:67], v[180:183], v[240:243], v[64:67]
    ds_read_b128 v[168:171], v4 offset:4096
    v_mfma_f32_16x16x32_bf16 v[68:71], v[180:183], v[244:247], v[68:71]
    v_mfma_f32_16x16x32_bf16 v[72:75], v[180:183], v[248:251], v[72:75]
    v_mfma_f32_16x16x32_bf16 v[76:79], v[180:183], v[252:255], v[76:79]
    s_add_u32 s30, s28, 2
    s_cmp_eq_u32 s30, 17
    s_cbranch_scc1 K2_FIN23
    .p2align 6
K2_MS:
    s_waitcnt lgkmcnt(3)
    v_mfma_f32_16x16x32_bf16 a[128:131], v[152:155], v[80:83], a[128:131]
    ds_read_b128 v[172:175], v4 offset:5120
    v_mfma_f32_16x16x32_bf16 a[132:135], v[152:155], v[84:87], a[132:135]
    v_exp_f32 v184, v48
    v_mfma_f32_16x16x32_bf16 a[136:139], v[152:155], v[88:91], a[136:139]
    v_exp_f32 v185, v49
    v_mfma_f32_16x16x32_bf16 a[140:143], v[152:155], v[92:95], a[140:143]
    v_cvt_pk_bf16_f32 v96, v184, v185
    v_mfma_f32_16x16x32_bf16 a[144:147], v[156:159], v[80:83], a[144:147]
    ds_read_b128 v[176:179], v4 offset:6144
    v_mfma_f32_16x16x32_bf16 a[148:151], v[156:159], v[84:87], a[148:151]
    v_exp_f32 v186, v50
    v_mfma_f32_16x16x32_bf16 a[152:155], v[156:159], v[88:91], a[152:155]
    v_exp_f32 v187, v51
    v_mfma_f32_16x16x32_bf16 a[156:159], v[156:159], v[92:95], a[156:159]
    v_cvt_pk_bf16_f32 v97, v186, v187
    v_mfma_f32_16x16x32_bf16 v[128:131], v[12:15], v[80:83], v[128:131]
    v_exp_f32 v188, v52
    s_waitcnt lgkmcnt(3)
    v_mfma_f32_16x16x32_bf16 a[160:163], v[160:163], v[80:83], a[160:163]
    ds_read_b128 v[180:183], v4 offset:7168
    v_mfma_f32_16x16x32_bf16 a[164:167], v[160:163], v[84:87], a[164:167]
    v_exp_f32 v189, v53
    v_mfma_f32_16x16x32_bf16 a[168:171], v[160:163], v[88:91], a[168:171]
    v_cvt_pk_bf16_f32 v100, v188, v189
    v_mfma_f32_16x16x32_bf16 a[172:175], v[160:163], v[92:95], a[172:175]
    v_exp_f32 v190, v54
    v_mfma_f32_16x16x32_bf16 a[176:179], v[164:167], v[80:83], a[176:179]
    ds_read_b128 v[152:155], v3 offset:0
    v_mfma_f32_16x16x32_bf16 a[180:183], v[164:167], v[84:87], a[180:183]
    v_exp_f32 v191, v55
    v_mfma_f32_16x16x32_bf16 a[184:187], v[164:167], v[88:91], a[184:187]
    v_cvt_pk_bf16_f32 v101, v190, v191
    v_mfma_f32_16x16x32_bf16 a[188:191], v[164:167], v[92:95], a[188:191]
    v_exp_f32 v184, v56
    v_mfma_f32_16x16x32_bf16 v[132:135], v[12:15], v[84:87], v[132:135]
    s_waitcnt lgkmcnt(3)
    v_mfma_f32_16x16x32_bf16 a[192:195], v[168:171], v[80:83], a[192:195]
    ds_read_b128 v[156:159], v3 offset:1024
    v_mfma_f32_16x16x32_bf16 a[196:199], v[168:171], v[84:87], a[196:199]
    v_exp_f32 v185, v57
    v_mfma_f32_16x16x32_bf16 a[200:203], v[168:171], v[88:91], a[200:203]
    v_exp_f32 v186, v58
    v_mfma_f32_16x16x32_bf16 a[204:207], v[168:171], v[92:95], a[204:207]
    v_cvt_pk_bf16_f32 v104, v184, v185
    v_mfma_f32_16x16x32_bf16 a[208:211], v[172:175], v[80:83], a[208:211]
    ds_read_b128 v[160:163], v3 offset:2048
    v_mfma_f32_16x16x32_bf16 a[212:215], v[172:175], v[84:87], a[212:215]
    v_exp_f32 v187, v59
    v_mfma_f32_16x16x32_bf16 a[216:219], v[172:175], v[88:91], a[216:219]
    v_exp_f32 v188, v60
    v_mfma_f32_16x16x32_bf16 a[220:223], v[172:175], v[92:95], a[220:223]
    v_cvt_pk_bf16_f32 v105, v186, v187
    v_mfma_f32_16x16x32_bf16 v[136:139], v[12:15], v[88:91], v[136:139]
    v_exp_f32 v189, v61
    s_waitcnt lgkmcnt(3)
    v_mfma_f32_16x16x32_bf16 a[224:227], v[176:179], v[80:83], a[224:227]
    ds_read_b128 v[164:167], v3 offset:3072
    v_cvt_pk_bf16_f32 v108, v188, v189
    v_mfma_f32_16x16x32_bf16 a[228:231], v[176:179], v[84:87], a[228:231]
    v_exp_f32 v190, v62
    v_mfma_f32_16x16x32_bf16 a[232:235], v[176:179], v[88:91], a[232:235]
    v_mfma_f32_16x16x32_bf16 a[236:239], v[176:179], v[92:95], a[236:239]
    v_exp_f32 v191, v63
    v_mfma_f32_16x16x32_bf16 a[240:243], v[180:183], v[80:83], a[240:243]
    ds_read_b128 v[168:171], v3 offset:4096
    v_cvt_pk_bf16_f32 v109, v190, v191
    v_mfma_f32_16x16x32_bf16 a[244:247], v[180:183], v[84:87], a[244:247]
    v_exp_f32 v184, v64
    v_mfma_f32_16x16x32_bf16 a[248:251], v[180:183], v[88:91], a[248:251]
    v_mfma_f32_16x16x32_bf16 a[252:255], v[180:183], v[92:95], a[252:255]
    v_exp_f32 v185, v65
    v_mfma_f32_16x16x32_bf16 v[140:143], v[12:15], v[92:95], v[140:143]
    v_cvt_pk_bf16_f32 v98, v184, v185
    s_waitcnt lgkmcnt(3)
    v_mfma_f32_16x16x32_bf16 v[16:19], v[152:155], v[192:195], v[112:115]
    ds_read_b128 v[172:175], v3 offset:5120
    v_mfma_f32_16x16x32_bf16 v[20:23], v[152:155], v[196:199], v[116:119]
    v_exp_f32 v186, v66
    v_mfma_f32_16x16x32_bf16 v[24:27], v[152:155], v[200:203], v[120:123]
    v_exp_f32 v187, v67
    v_mfma_f32_16x16x32_bf16 v[28:31], v[152:155], v[204:207], v[124:127]
    v_cvt_pk_bf16_f32 v99, v186, v187
    v_mfma_f32_16x16x32_bf16 v[16:19], v[156:159], v[208:211], v[16:19]
    ds_read_b128 v[176:179], v3 offset:6144
    v_mfma_f32_16x16x32_bf16 v[20:23], v[156:159], v[212:215], v[20:23]
    v_exp_f32 v188, v68
    v_mfma_f32_16x16x32_bf16 v[24:27], v[156:159], v[216:219], v[24:27]
    v_exp_f32 v189, v69
    v_mfma_f32_16x16x32_bf16 v[28:31], v[156:159], v[220:223], v[28:31]
    v_cvt_pk_bf16_f32 v102, v188, v189
    s_waitcnt lgkmcnt(3)
    v_mfma_f32_16x16x32_bf16 v[16:19], v[160:163], v[224:227], v[16:19]
    ds_read_b128 v[180:183], v3 offset:7168
    v_mfma_f32_16x16x32_bf16 v[20:23], v[160:163], v[228:231], v[20:23]
    v_exp_f32 v190, v70
    v_mfma_f32_16x16x32_bf16 v[24:27], v[160:163], v[232:235], v[24:27]
    v_exp_f32 v191, v71
    v_mfma_f32_16x16x32_bf16 v[28:31], v[160:163], v[236:239], v[28:31]
    v_cvt_pk_bf16_f32 v103, v190, v191
    v_mfma_f32_16x16x32_bf16 v[16:19], v[164:167], v[240:243], v[16:19]
    v_exp_f32 v184, v72
    v_mfma_f32_16x16x32_bf16 v[20:23], v[164:167], v[244:247], v[20:23]
    v_mfma_f32_16x16x32_bf16 v[24:27], v[164:167], v[248:251], v[24:27]
    v_exp_f32 v185, v73
    v_mfma_f32_16x16x32_bf16 v[28:31], v[164:167], v[252:255], v[28:31]
    v_cvt_pk_bf16_f32 v106, v184, v185
    s_waitcnt lgkmcnt(2)
    v_mfma_f32_16x16x32_bf16 v[32:35], v[168:171], v[192:195], v[112:115]
    v_exp_f32 v186, v74
    v_mfma_f32_16x16x32_bf16 v[36:39], v[168:171], v[196:199], v[116:119]
    v_mfma_f32_16x16x32_bf16 v[40:43], v[168:171], v[200:203], v[120:123]
    v_exp_f32 v187, v75
    v_mfma_f32_16x16x32_bf16 v[44:47], v[168:171], v[204:207], v[124:127]
    v_cvt_pk_bf16_f32 v107, v186, v187
    s_waitcnt lgkmcnt(0)
    s_barrier
    v_mfma_f32_16x16x32_bf16 v[32:35], v[172:175], v[208:211], v[32:35]
    ds_read_b128 v[152:155], v4 offset:8192
    v_mfma_f32_16x16x32_bf16 v[36:39], v[172:175], v[212:215], v[36:39]
    ds_read_b128 v[156:159], v4 offset:9216
    v_mfma_f32_16x16x32_bf16 v[40:43], v[172:175], v[216:219], v[40:43]
    v_exp_f32 v188, v76
    v_mfma_f32_16x16x32_bf16 v[44:47], v[172:175], v[220:223], v[44:47]
    v_exp_f32 v189, v77
    v_mfma_f32_16x16x32_bf16 v[32:35], v[176:179], v[224:227], v[32:35]
    ds_read_b128 v[160:163], v4 offset:10240
    v_cvt_pk_bf16_f32 v110, v188, v189
    v_mfma_f32_16x16x32_bf16 v[36:39], v[176:179], v[228:231], v[36:39]
    ds_read_b128 v[164:167], v4 offset:11264
    v_mfma_f32_16x16x32_bf16 v[40:43], v[176:179], v[232:235], v[40:43]
    v_exp_f32 v190, v78
    v_mfma_f32_16x16x32_bf16 v[44:47], v[176:179], v[236:239], v[44:47]
    v_exp_f32 v191, v79
    v_mfma_f32_16x16x32_bf16 v[32:35], v[180:183], v[240:243], v[32:35]
    ds_read_b128 v[168:171], v4 offset:12288
    v_cvt_pk_bf16_f32 v111, v190, v191
    v_mfma_f32_16x16x32_bf16 v[36:39], v[180:183], v[244:247], v[36:39]
    v_mfma_f32_16x16x32_bf16 v[40:43], v[180:183], v[248:251], v[40:43]
    v_mfma_f32_16x16x32_bf16 v[44:47], v[180:183], v[252:255], v[44:47]
    s_waitcnt lgkmcnt(3)
    v_mfma_f32_16x16x32_bf16 a[128:131], v[152:155], v[96:99], a[128:131]
    ds_read_b128 v[172:175], v4 offset:13312
    s_waitcnt vmcnt(1)
    v_mfma_f32_16x16x32_bf16 a[132:135], v[152:155], v[100:103], a[132:135]
    v_exp_f32 v184, v16
    v_mfma_f32_16x16x32_bf16 a[136:139], v[152:155], v[104:107], a[136:139]
    v_exp_f32 v185, v17
    v_mfma_f32_16x16x32_bf16 a[140:143], v[152:155], v[108:111], a[140:143]
    v_dot2c_f32_bf16 v0, v12, v10
    v_dot2c_f32_bf16 v0, v12, v11
    v_mfma_f32_16x16x32_bf16 a[144:147], v[156:159], v[96:99], a[144:147]
    ds_read_b128 v[176:179], v4 offset:14336
    v_cvt_pk_bf16_f32 v80, v184, v185
    v_mfma_f32_16x16x32_bf16 a[148:151], v[156:159], v[100:103], a[148:151]
    buffer_load_dwordx2 v[10:11], v9, s[20:23], 0 offen
    v_mfma_f32_16x16x32_bf16 a[152:155], v[156:159], v[104:107], a[152:155]
    v_exp_f32 v186, v18
    v_mfma_f32_16x16x32_bf16 a[156:159], v[156:159], v[108:111], a[156:159]
    v_exp_f32 v187, v19
    v_mfma_f32_16x16x32_bf16 v[128:131], v[12:15], v[96:99], v[128:131]
    v_exp_f32 v188, v20
    s_waitcnt lgkmcnt(3)
    v_mfma_f32_16x16x32_bf16 a[160:163], v[160:163], v[96:99], a[160:163]
    ds_read_b128 v[180:183], v4 offset:15360
    v_add_u32 v9, s69, v9
    v_mfma_f32_16x16x32_bf16 a[164:167], v[160:163], v[100:103], a[164:167]
    v_exp_f32 v189, v21
    v_mfma_f32_16x16x32_bf16 a[168:171], v[160:163], v[104:107], a[168:171]
    v_cvt_pk_bf16_f32 v81, v186, v187
    v_cvt_pk_bf16_f32 v84, v188, v189
    v_mfma_f32_16x16x32_bf16 a[172:175], v[160:163], v[108:111], a[172:175]
    buffer_store_dwordx4 v[148:151], v1, s[64:67], s68 offen sc0 sc1
    v_mfma_f32_16x16x32_bf16 a[176:179], v[164:167], v[96:99], a[176:179]
    ds_read_b128 v[152:155], v3 offset:8192
    v_mfma_f32_16x16x32_bf16 a[180:183], v[164:167], v[100:103], a[180:183]
    v_exp_f32 v190, v22
    v_mfma_f32_16x16x32_bf16 a[184:187], v[164:167], v[104:107], a[184:187]
    v_exp_f32 v191, v23
    v_mfma_f32_16x16x32_bf16 a[188:191], v[164:167], v[108:111], a[188:191]
    v_exp_f32 v184, v24
    v_mfma_f32_16x16x32_bf16 v[132:135], v[12:15], v[100:103], v[132:135]
    v_cvt_pk_bf16_f32 v85, v190, v191
    s_waitcnt lgkmcnt(3)
    v_mfma_f32_16x16x32_bf16 a[192:195], v[168:171], v[96:99], a[192:195]
    ds_read_b128 v[156:159], v3 offset:9216
    s_add_u32 s68, s68, 1048576
    v_mfma_f32_16x16x32_bf16 a[196:199], v[168:171], v[100:103], a[196:199]
    v_exp_f32 v185, v25
    v_mfma_f32_16x16x32_bf16 a[200:203], v[168:171], v[104:107], a[200:203]
    v_exp_f32 v186, v26
    v_mfma_f32_16x16x32_bf16 a[204:207], v[168:171], v[108:111], a[204:207]
    v_cvt_pk_bf16_f32 v88, v184, v185
    v_mfma_f32_16x16x32_bf16 a[208:211], v[172:175], v[96:99], a[208:211]
    ds_read_b128 v[160:163], v3 offset:10240
    v_mfma_f32_16x16x32_bf16 a[212:215], v[172:175], v[100:103], a[212:215]
    v_exp_f32 v187, v27
    v_mfma_f32_16x16x32_bf16 a[216:219], v[172:175], v[104:107], a[216:219]
    v_exp_f32 v188, v28
    v_mfma_f32_16x16x32_bf16 a[220:223], v[172:175], v[108:111], a[220:223]
    v_cvt_pk_bf16_f32 v89, v186, v187
    v_mfma_f32_16x16x32_bf16 v[136:139], v[12:15], v[104:107], v[136:139]
    v_exp_f32 v189, v29
    s_waitcnt lgkmcnt(3)
    v_mfma_f32_16x16x32_bf16 a[224:227], v[176:179], v[96:99], a[224:227]
    ds_read_b128 v[164:167], v3 offset:11264
    v_cvt_pk_bf16_f32 v92, v188, v189
    v_mfma_f32_16x16x32_bf16 a[228:231], v[176:179], v[100:103], a[228:231]
    v_exp_f32 v190, v30
    v_mfma_f32_16x16x32_bf16 a[232:235], v[176:179], v[104:107], a[232:235]
    v_mfma_f32_16x16x32_bf16 a[236:239], v[176:179], v[108:111], a[236:239]
    v_exp_f32 v191, v31
    v_mfma_f32_16x16x32_bf16 a[240:243], v[180:183], v[96:99], a[240:243]
    ds_read_b128 v[168:171], v3 offset:12288
    v_cvt_pk_bf16_f32 v93, v190, v191
    v_mfma_f32_16x16x32_bf16 a[244:247], v[180:183], v[100:103], a[244:247]
    v_exp_f32 v184, v32
    v_mfma_f32_16x16x32_bf16 a[248:251], v[180:183], v[104:107], a[248:251]
    v_mfma_f32_16x16x32_bf16 a[252:255], v[180:183], v[108:111], a[252:255]
    v_exp_f32 v185, v33
    v_mfma_f32_16x16x32_bf16 v[140:143], v[12:15], v[108:111], v[140:143]
    v_cvt_pk_bf16_f32 v82, v184, v185
    s_waitcnt lgkmcnt(3)
    v_mfma_f32_16x16x32_bf16 v[48:51], v[152:155], v[192:195], v[112:115]
    ds_read_b128 v[172:175], v3 offset:13312
    v_mfma_f32_16x16x32_bf16 v[52:55], v[152:155], v[196:199], v[116:119]
    v_exp_f32 v186, v34
    v_mfma_f32_16x16x32_bf16 v[56:59], v[152:155], v[200:203], v[120:123]
    v_exp_f32 v187, v35
    v_mfma_f32_16x16x32_bf16 v[60:63], v[152:155], v[204:207], v[124:127]
    v_cvt_pk_bf16_f32 v83, v186, v187
    v_mfma_f32_16x16x32_bf16 v[48:51], v[156:159], v[208:211], v[48:51]
    ds_read_b128 v[176:179], v3 offset:14336
    v_mfma_f32_16x16x32_bf16 v[52:55], v[156:159], v[212:215], v[52:55]
    v_exp_f32 v188, v36
    v_mfma_f32_16x16x32_bf16 v[56:59], v[156:159], v[216:219], v[56:59]
    v_exp_f32 v189, v37
    v_mfma_f32_16x16x32_bf16 v[60:63], v[156:159], v[220:223], v[60:63]
    v_cvt_pk_bf16_f32 v86, v188, v189
    s_waitcnt lgkmcnt(3)
    v_mfma_f32_16x16x32_bf16 v[48:51], v[160:163], v[224:227], v[48:51]
    ds_read_b128 v[180:183], v3 offset:15360
    v_mfma_f32_16x16x32_bf16 v[52:55], v[160:163], v[228:231], v[52:55]
    v_exp_f32 v190, v38
    v_mfma_f32_16x16x32_bf16 v[56:59], v[160:163], v[232:235], v[56:59]
    v_exp_f32 v191, v39
    v_mfma_f32_16x16x32_bf16 v[60:63], v[160:163], v[236:239], v[60:63]
    v_cvt_pk_bf16_f32 v87, v190, v191
    v_mfma_f32_16x16x32_bf16 v[48:51], v[164:167], v[240:243], v[48:51]
    v_exp_f32 v184, v40
    v_mfma_f32_16x16x32_bf16 v[52:55], v[164:167], v[244:247], v[52:55]
    v_mfma_f32_16x16x32_bf16 v[56:59], v[164:167], v[248:251], v[56:59]
    v_exp_f32 v185, v41
    v_mfma_f32_16x16x32_bf16 v[60:63], v[164:167], v[252:255], v[60:63]
    v_cvt_pk_bf16_f32 v90, v184, v185
    s_waitcnt lgkmcnt(2)
    v_mfma_f32_16x16x32_bf16 v[64:67], v[168:171], v[192:195], v[112:115]
    v_exp_f32 v186, v42
    v_mfma_f32_16x16x32_bf16 v[68:71], v[168:171], v[196:199], v[116:119]
    v_mfma_f32_16x16x32_bf16 v[72:75], v[168:171], v[200:203], v[120:123]
    v_exp_f32 v187, v43
    v_mfma_f32_16x16x32_bf16 v[76:79], v[168:171], v[204:207], v[124:127]
    v_cvt_pk_bf16_f32 v91, v186, v187
    s_waitcnt lgkmcnt(0)
    s_barrier
    v_xor_b32 v4, 0x4000, v4
    v_xor_b32 v3, 0x4000, v3
    v_mfma_f32_16x16x32_bf16 v[64:67], v[172:175], v[208:211], v[64:67]
    ds_read_b128 v[152:155], v4 offset:0
    v_mfma_f32_16x16x32_bf16 v[68:71], v[172:175], v[212:215], v[68:71]
    ds_read_b128 v[156:159], v4 offset:1024
    v_mfma_f32_16x16x32_bf16 v[72:75], v[172:175], v[216:219], v[72:75]
    v_exp_f32 v188, v44
    v_mfma_f32_16x16x32_bf16 v[76:79], v[172:175], v[220:223], v[76:79]
    v_exp_f32 v189, v45
    v_mfma_f32_16x16x32_bf16 v[64:67], v[176:179], v[224:227], v[64:67]
    ds_read_b128 v[160:163], v4 offset:2048
    v_cvt_pk_bf16_f32 v94, v188, v189
    v_mfma_f32_16x16x32_bf16 v[68:71], v[176:179], v[228:231], v[68:71]
    ds_read_b128 v[164:167], v4 offset:3072
    v_mfma_f32_16x16x32_bf16 v[72:75], v[176:179], v[232:235], v[72:75]
    v_exp_f32 v190, v46
    v_mfma_f32_16x16x32_bf16 v[76:79], v[176:179], v[236:239], v[76:79]
    v_exp_f32 v191, v47
    v_mfma_f32_16x16x32_bf16 v[64:67], v[180:183], v[240:243], v[64:67]
    ds_read_b128 v[168:171], v4 offset:4096
    v_cvt_pk_bf16_f32 v95, v190, v191
    v_mfma_f32_16x16x32_bf16 v[68:71], v[180:183], v[244:247], v[68:71]
    v_mfma_f32_16x16x32_bf16 v[72:75], v[180:183], v[248:251], v[72:75]
    v_mfma_f32_16x16x32_bf16 v[76:79], v[180:183], v[252:255], v[76:79]
    s_add_u32 s30, s30, 1
    s_cmp_lg_u32 s30, 17
    s_cbranch_scc1 K2_MS
K2_FIN23:
    s_waitcnt lgkmcnt(3)
    v_mfma_f32_16x16x32_bf16 a[128:131], v[152:155], v[80:83], a[128:131]
    ds_read_b128 v[172:175], v4 offset:5120
    v_exp_f32 v184, v48
    v_mfma_f32_16x16x32_bf16 a[132:135], v[152:155], v[84:87], a[132:135]
    v_exp_f32 v185, v49
    s_lshl_b32 s44, s27, 17
    v_mfma_f32_16x16x32_bf16 a[136:139], v[152:155], v[88:91], a[136:139]
    v_exp_f32 v186, v50
    v_cvt_pk_bf16_f32 v96, v184, v185
    v_mfma_f32_16x16x32_bf16 a[140:143], v[152:155], v[92:95], a[140:143]
    v_exp_f32 v187, v51
    s_lshl_b32 s45, s25, 12
    v_mfma_f32_16x16x32_bf16 a[144:147], v[156:159], v[80:83], a[144:147]
    ds_read_b128 v[176:179], v4 offset:6144
    v_exp_f32 v188, v52
    v_mfma_f32_16x16x32_bf16 a[148:151], v[156:159], v[84:87], a[148:151]
    v_exp_f32 v189, v53
    v_cvt_pk_bf16_f32 v97, v186, v187
    v_mfma_f32_16x16x32_bf16 a[152:155], v[156:159], v[88:91], a[152:155]
    v_exp_f32 v190, v54
    v_cvt_pk_bf16_f32 v100, v188, v189
    v_mfma_f32_16x16x32_bf16 a[156:159], v[156:159], v[92:95], a[156:159]
    v_exp_f32 v191, v55
    s_waitcnt vmcnt(1)
    v_mfma_f32_16x16x32_bf16 v[128:131], v[12:15], v[80:83], v[128:131]
    v_exp_f32 v184, v56
    v_cvt_pk_bf16_f32 v101, v190, v191
    s_waitcnt lgkmcnt(3)
    v_mfma_f32_16x16x32_bf16 a[160:163], v[160:163], v[80:83], a[160:163]
    ds_read_b128 v[180:183], v4 offset:7168
    v_exp_f32 v185, v57
    v_mfma_f32_16x16x32_bf16 a[164:167], v[160:163], v[84:87], a[164:167]
    v_exp_f32 v186, v58
    v_cvt_pk_bf16_f32 v104, v184, v185
    v_mfma_f32_16x16x32_bf16 a[168:171], v[160:163], v[88:91], a[168:171]
    v_exp_f32 v187, v59
    s_add_u32 s44, s44, s45
    v_mfma_f32_16x16x32_bf16 a[172:175], v[160:163], v[92:95], a[172:175]
    v_exp_f32 v188, v60
    v_cvt_pk_bf16_f32 v105, v186, v187
    v_mfma_f32_16x16x32_bf16 a[176:179], v[164:167], v[80:83], a[176:179]
    v_exp_f32 v189, v61
    v_add_f32_dpp v0, v0, v0 quad_perm:[1,0,3,2] row_mask:0xf bank_mask:0xf
    v_mfma_f32_16x16x32_bf16 a[180:183], v[164:167], v[84:87], a[180:183]
    v_exp_f32 v190, v62
    v_cvt_pk_bf16_f32 v108, v188, v189
    v_mfma_f32_16x16x32_bf16 a[184:187], v[164:167], v[88:91], a[184:187]
    v_exp_f32 v191, v63
    s_lshl_b32 s45, s24, 2
    v_mfma_f32_16x16x32_bf16 a[188:191], v[164:167], v[92:95], a[188:191]
    v_cvt_pk_bf16_f32 v109, v190, v191
    v_and_b32 v2, 0x70, v1
    v_lshlrev_b32 v2, 22, v2
    v_mfma_f32_16x16x32_bf16 v[132:135], v[12:15], v[84:87], v[132:135]
    v_exp_f32 v184, v64
    v_add_f32_dpp v0, v0, v0 quad_perm:[2,3,0,1] row_mask:0xf bank_mask:0xf
    s_waitcnt lgkmcnt(2)
    v_mfma_f32_16x16x32_bf16 a[192:195], v[168:171], v[80:83], a[192:195]
    v_exp_f32 v185, v65
    v_lshrrev_b32 v11, 2, v1
    v_mfma_f32_16x16x32_bf16 a[196:199], v[168:171], v[84:87], a[196:199]
    v_exp_f32 v186, v66
    v_cvt_pk_bf16_f32 v98, v184, v185
    v_mfma_f32_16x16x32_bf16 a[200:203], v[168:171], v[88:91], a[200:203]
    v_exp_f32 v187, v67
    v_add_u32 v3, 135168, v1
    v_mfma_f32_16x16x32_bf16 a[204:207], v[168:171], v[92:95], a[204:207]
    v_exp_f32 v188, v68
    v_cvt_pk_bf16_f32 v99, v186, v187
    s_waitcnt lgkmcnt(0)
    s_barrier
    v_mfma_f32_16x16x32_bf16 a[208:211], v[172:175], v[80:83], a[208:211]
    ds_read_b128 v[152:155], v4 offset:8192
    v_exp_f32 v189, v69
    v_mfma_f32_16x16x32_bf16 a[212:215], v[172:175], v[84:87], a[212:215]
    ds_read_b128 v[156:159], v4 offset:9216
    v_exp_f32 v190, v70
    v_mfma_f32_16x16x32_bf16 a[216:219], v[172:175], v[88:91], a[216:219]
    v_exp_f32 v191, v71
    v_cvt_pk_bf16_f32 v102, v188, v189
    v_mfma_f32_16x16x32_bf16 a[220:223], v[172:175], v[92:95], a[220:223]
    v_exp_f32 v184, v72
    v_cvt_pk_bf16_f32 v103, v190, v191
    v_mfma_f32_16x16x32_bf16 v[136:139], v[12:15], v[88:91], v[136:139]
    v_exp_f32 v185, v73
    v_add_u32 v9, s45, v3
    v_mfma_f32_16x16x32_bf16 a[224:227], v[176:179], v[80:83], a[224:227]
    ds_read_b128 v[160:163], v4 offset:10240
    v_exp_f32 v186, v74
    v_mfma_f32_16x16x32_bf16 a[228:231], v[176:179], v[84:87], a[228:231]
    ds_read_b128 v[164:167], v4 offset:11264
    v_exp_f32 v187, v75
    v_mfma_f32_16x16x32_bf16 a[232:235], v[176:179], v[88:91], a[232:235]
    v_exp_f32 v188, v76
    v_cvt_pk_bf16_f32 v106, v184, v185
    v_mfma_f32_16x16x32_bf16 a[236:239], v[176:179], v[92:95], a[236:239]
    v_exp_f32 v189, v77
    v_cvt_pk_bf16_f32 v107, v186, v187
    v_mfma_f32_16x16x32_bf16 a[240:243], v[180:183], v[80:83], a[240:243]
    ds_read_b128 v[168:171], v4 offset:12288
    v_exp_f32 v190, v78
    v_mfma_f32_16x16x32_bf16 a[244:247], v[180:183], v[84:87], a[244:247]
    v_exp_f32 v191, v79
    v_cvt_pk_bf16_f32 v110, v188, v189
    v_mfma_f32_16x16x32_bf16 a[248:251], v[180:183], v[88:91], a[248:251]
    v_cvt_pk_bf16_f32 v111, v190, v191
    v_add_u32 v2, v2, v11
    v_add_f32_dpp v0, v0, v0 row_half_mirror row_mask:0xf bank_mask:0xf
    v_mfma_f32_16x16x32_bf16 a[252:255], v[180:183], v[92:95], a[252:255]
    v_mul_f32 v0, 0x3ae38e39, v0
    v_cvt_pk_bf16_f32 v10, v0, v0
    v_and_b32 v10, 0xffff0000, v10
    v_mfma_f32_16x16x32_bf16 v[140:143], v[12:15], v[92:95], v[140:143]
    v_sub_f32 v10, v0, v10
    v_cvt_pk_bf16_f32 v10, v0, v10
    buffer_store_dword v10, v2, s[64:67], s70 offen sc0 sc1
    ds_read_b128 v[172:175], v4 offset:13312
    ds_read_b128 v[176:179], v4 offset:14336
    ds_read_b128 v[180:183], v4 offset:15360
    v_mfma_f32_16x16x32_bf16 v[128:131], v[12:15], v[96:99], v[128:131]
    v_mfma_f32_16x16x32_bf16 v[132:135], v[12:15], v[100:103], v[132:135]
    v_mfma_f32_16x16x32_bf16 v[136:139], v[12:15], v[104:107], v[136:139]
    v_mfma_f32_16x16x32_bf16 v[140:143], v[12:15], v[108:111], v[140:143]
    s_waitcnt lgkmcnt(7)
    v_mfma_f32_16x16x32_bf16 a[128:131], v[152:155], v[96:99], a[128:131]
    s_nop 2
    v_rcp_f32 v128, v129
    v_rcp_f32 v132, v133
    v_rcp_f32 v136, v137
    v_mfma_f32_16x16x32_bf16 a[132:135], v[152:155], v[100:103], a[132:135]
    v_rcp_f32 v140, v141
    v_max3_f32 v11, v128, v129, v132
    v_max3_f32 v11, v11, v133, v136
    v_mfma_f32_16x16x32_bf16 a[136:139], v[152:155], v[104:107], a[136:139]
    v_max3_f32 v11, v11, v137, v140
    v_max_f32 v11, v11, v141
    ds_write_b32 v9, v11
    v_mfma_f32_16x16x32_bf16 a[140:143], v[152:155], v[108:111], a[140:143]
    s_getpc_b64 s[46:47]
K2_PCM1:
    s_bfe_u32 s48, s2, 0x30003
    s_lshl_b32 s48, s48, 13
    s_add_u32 s48, s48, KT_ENTRY-K2_PCM1
    v_lshl_add_u32 v147, v1, 3, s48
    s_waitcnt lgkmcnt(7)
    v_mfma_f32_16x16x32_bf16 a[144:147], v[156:159], v[96:99], a[144:147]
    v_min_u32 v147, CODE_END-K2_PCM1-4, v147
    global_load_dword v147, v147, s[46:47]
    s_lshr_b32 s46, s2, 3
    s_lshl_b32 s46, s46, 2
    s_add_u32 s46, s46, s24
    s_bfe_u32 s47, s2, 0x20001
    v_mfma_f32_16x16x32_bf16 a[148:151], v[156:159], v[100:103], a[148:151]
    s_mov_b32 s4, s54
    s_mov_b32 s5, s55
    s_mov_b32 s6, 4718592
    s_lshl_b32 s48, s47, 7
    s_add_u32 s48, s48, s46
    s_mul_i32 s48, s48, 9216
    v_lshrrev_b32 v144, 7, v1
    v_mfma_f32_16x16x32_bf16 a[152:155], v[156:159], v[104:107], a[152:155]
    v_and_b32 v5, 0x70, v1
    v_mul_u32_u24 v144, 1152, v144
    v_lshl_add_u32 v144, v5, 3, v144
    v_mfma_f32_16x16x32_bf16 a[156:159], v[156:159], v[108:111], a[156:159]
    buffer_load_dword v144, v144, s[4:7], s48 offen
    s_waitcnt lgkmcnt(6)
    v_mfma_f32_16x16x32_bf16 a[160:163], v[160:163], v[96:99], a[160:163]
    v_mfma_f32_16x16x32_bf16 a[164:167], v[160:163], v[100:103], a[164:167]
    v_mfma_f32_16x16x32_bf16 a[168:171], v[160:163], v[104:107], a[168:171]
    v_mfma_f32_16x16x32_bf16 a[172:175], v[160:163], v[108:111], a[172:175]
    s_waitcnt lgkmcnt(5)
    v_mfma_f32_16x16x32_bf16 a[176:179], v[164:167], v[96:99], a[176:179]
    v_accvgpr_read_b32 v112, a128
    v_accvgpr_read_b32 v113, a129
    v_accvgpr_read_b32 v114, a130
    v_mfma_f32_16x16x32_bf16 a[180:183], v[164:167], v[100:103], a[180:183]
    v_accvgpr_read_b32 v115, a131
    v_accvgpr_read_b32 v116, a144
    v_accvgpr_read_b32 v117, a145
    v_mfma_f32_16x16x32_bf16 a[184:187], v[164:167], v[104:107], a[184:187]
    v_accvgpr_read_b32 v118, a146
    v_accvgpr_read_b32 v119, a147
    v_accvgpr_read_b32 v120, a132
    v_mfma_f32_16x16x32_bf16 a[188:191], v[164:167], v[108:111], a[188:191]
    v_accvgpr_read_b32 v121, a133
    v_accvgpr_read_b32 v122, a134
    v_accvgpr_read_b32 v123, a135
    s_waitcnt lgkmcnt(4)
    v_mfma_f32_16x16x32_bf16 a[192:195], v[168:171], v[96:99], a[192:195]
    v_accvgpr_read_b32 v124, a148
    v_accvgpr_read_b32 v125, a149
    v_accvgpr_read_b32 v126, a150
    v_mfma_f32_16x16x32_bf16 a[196:199], v[168:171], v[100:103], a[196:199]
    v_accvgpr_read_b32 v127, a151
    v_accvgpr_read_b32 v80, a136
    v_accvgpr_read_b32 v81, a137
    v_mfma_f32_16x16x32_bf16 a[200:203], v[168:171], v[104:107], a[200:203]
    v_accvgpr_read_b32 v82, a138
    v_accvgpr_read_b32 v83, a139
    v_accvgpr_read_b32 v84, a152
    v_mfma_f32_16x16x32_bf16 a[204:207], v[168:171], v[108:111], a[204:207]
    v_accvgpr_read_b32 v85, a153
    v_accvgpr_read_b32 v86, a154
    v_accvgpr_read_b32 v87, a155
    s_waitcnt lgkmcnt(3)
    v_mfma_f32_16x16x32_bf16 a[208:211], v[172:175], v[96:99], a[208:211]
    v_accvgpr_read_b32 v88, a140
    v_accvgpr_read_b32 v89, a141
    v_accvgpr_read_b32 v90, a142
    v_mfma_f32_16x16x32_bf16 a[212:215], v[172:175], v[100:103], a[212:215]
    v_accvgpr_read_b32 v91, a143
    v_accvgpr_read_b32 v92, a156
    v_accvgpr_read_b32 v93, a157
    v_mfma_f32_16x16x32_bf16 a[216:219], v[172:175], v[104:107], a[216:219]
    v_accvgpr_read_b32 v94, a158
    v_accvgpr_read_b32 v95, a159
    v_pk_mul_f32 v[112:113], v[112:113], v[128:129] op_sel_hi:[1,0]
    s_nop 0
    v_mfma_f32_16x16x32_bf16 a[220:223], v[172:175], v[108:111], a[220:223]
    v_pk_mul_f32 v[114:115], v[114:115], v[128:129] op_sel_hi:[1,0]
    v_pk_mul_f32 v[116:117], v[116:117], v[128:129] op_sel_hi:[1,0]
    v_pk_mul_f32 v[118:119], v[118:119], v[128:129] op_sel_hi:[1,0]
    s_waitcnt lgkmcnt(2)
    v_mfma_f32_16x16x32_bf16 a[224:227], v[176:179], v[96:99], a[224:227]
    v_cvt_pk_bf16_f32 v112, v112, v113
    v_cvt_pk_bf16_f32 v113, v114, v115
    v_cvt_pk_bf16_f32 v114, v116, v117
    v_mfma_f32_16x16x32_bf16 a[228:231], v[176:179], v[100:103], a[228:231]
    v_cvt_pk_bf16_f32 v115, v118, v119
    s_add_u32 s45, s44, 0
    buffer_store_dwordx4 v[112:115], v1, s[16:19], s45 offen offset:0 sc0 sc1
    v_mfma_f32_16x16x32_bf16 a[232:235], v[176:179], v[104:107], a[232:235]
    v_pk_mul_f32 v[120:121], v[120:121], v[132:133] op_sel_hi:[1,0]
    v_pk_mul_f32 v[122:123], v[122:123], v[132:133] op_sel_hi:[1,0]
    v_pk_mul_f32 v[124:125], v[124:125], v[132:133] op_sel_hi:[1,0]
    s_nop 0
    v_mfma_f32_16x16x32_bf16 a[236:239], v[176:179], v[108:111], a[236:239]
    v_pk_mul_f32 v[126:127], v[126:127], v[132:133] op_sel_hi:[1,0]
    v_cvt_pk_bf16_f32 v120, v120, v121
    v_cvt_pk_bf16_f32 v121, v122, v123
    s_waitcnt lgkmcnt(1)
    v_mfma_f32_16x16x32_bf16 a[240:243], v[180:183], v[96:99], a[240:243]
    v_cvt_pk_bf16_f32 v122, v124, v125
    v_cvt_pk_bf16_f32 v123, v126, v127
    s_add_u32 s45, s44, 131072
    v_mfma_f32_16x16x32_bf16 a[244:247], v[180:183], v[100:103], a[244:247]
    buffer_store_dwordx4 v[120:123], v1, s[16:19], s45 offen offset:0 sc0 sc1
    v_pk_mul_f32 v[80:81], v[80:81], v[136:137] op_sel_hi:[1,0]
    v_pk_mul_f32 v[82:83], v[82:83], v[136:137] op_sel_hi:[1,0]
    s_nop 0
    v_mfma_f32_16x16x32_bf16 a[248:251], v[180:183], v[104:107], a[248:251]
    v_pk_mul_f32 v[84:85], v[84:85], v[136:137] op_sel_hi:[1,0]
    v_pk_mul_f32 v[86:87], v[86:87], v[136:137] op_sel_hi:[1,0]
    v_cvt_pk_bf16_f32 v80, v80, v81
    v_mfma_f32_16x16x32_bf16 a[252:255], v[180:183], v[108:111], a[252:255]
    v_cvt_pk_bf16_f32 v81, v82, v83
    v_cvt_pk_bf16_f32 v82, v84, v85
    v_cvt_pk_bf16_f32 v83, v86, v87
    s_add_u32 s45, s44, 262144
    buffer_store_dwordx4 v[80:83], v1, s[16:19], s45 offen offset:0 sc0 sc1
    v_pk_mul_f32 v[88:89], v[88:89], v[140:141] op_sel_hi:[1,0]
    v_pk_mul_f32 v[90:91], v[90:91], v[140:141] op_sel_hi:[1,0]
    v_pk_mul_f32 v[92:93], v[92:93], v[140:141] op_sel_hi:[1,0]
    v_pk_mul_f32 v[94:95], v[94:95], v[140:141] op_sel_hi:[1,0]
    v_cvt_pk_bf16_f32 v88, v88, v89
    v_cvt_pk_bf16_f32 v89, v90, v91
    v_cvt_pk_bf16_f32 v90, v92, v93
    v_cvt_pk_bf16_f32 v91, v94, v95
    s_add_u32 s45, s44, 393216
    buffer_store_dwordx4 v[88:91], v1, s[16:19], s45 offen offset:0 sc0 sc1
    v_accvgpr_read_b32 v112, a160
    v_accvgpr_read_b32 v113, a161
    v_accvgpr_read_b32 v114, a162
    v_accvgpr_read_b32 v115, a163
    v_accvgpr_read_b32 v116, a176
    v_accvgpr_read_b32 v117, a177
    v_accvgpr_read_b32 v118, a178
    v_accvgpr_read_b32 v119, a179
    v_accvgpr_read_b32 v120, a164
    v_accvgpr_read_b32 v121, a165
    v_accvgpr_read_b32 v122, a166
    v_accvgpr_read_b32 v123, a167
    v_accvgpr_read_b32 v124, a180
    v_accvgpr_read_b32 v125, a181
    v_accvgpr_read_b32 v126, a182
    v_accvgpr_read_b32 v127, a183
    v_accvgpr_read_b32 v80, a168
    v_accvgpr_read_b32 v81, a169
    v_accvgpr_read_b32 v82, a170
    v_accvgpr_read_b32 v83, a171
    v_accvgpr_read_b32 v84, a184
    v_accvgpr_read_b32 v85, a185
    v_accvgpr_read_b32 v86, a186
    v_accvgpr_read_b32 v87, a187
    v_accvgpr_read_b32 v88, a172
    v_accvgpr_read_b32 v89, a173
    v_accvgpr_read_b32 v90, a174
    v_accvgpr_read_b32 v91, a175
    v_accvgpr_read_b32 v92, a188
    v_accvgpr_read_b32 v93, a189
    v_accvgpr_read_b32 v94, a190
    v_accvgpr_read_b32 v95, a191
    v_pk_mul_f32 v[112:113], v[112:113], v[128:129] op_sel_hi:[1,0]
    v_pk_mul_f32 v[114:115], v[114:115], v[128:129] op_sel_hi:[1,0]
    v_pk_mul_f32 v[116:117], v[116:117], v[128:129] op_sel_hi:[1,0]
    v_pk_mul_f32 v[118:119], v[118:119], v[128:129] op_sel_hi:[1,0]
    v_cvt_pk_bf16_f32 v112, v112, v113
    v_cvt_pk_bf16_f32 v113, v114, v115
    v_cvt_pk_bf16_f32 v114, v116, v117
    v_cvt_pk_bf16_f32 v115, v118, v119
    s_add_u32 s45, s44, 0
    buffer_store_dwordx4 v[112:115], v1, s[16:19], s45 offen offset:1024 sc0 sc1
    v_pk_mul_f32 v[120:121], v[120:121], v[132:133] op_sel_hi:[1,0]
    v_pk_mul_f32 v[122:123], v[122:123], v[132:133] op_sel_hi:[1,0]
    v_pk_mul_f32 v[124:125], v[124:125], v[132:133] op_sel_hi:[1,0]
    v_pk_mul_f32 v[126:127], v[126:127], v[132:133] op_sel_hi:[1,0]
    v_cvt_pk_bf16_f32 v120, v120, v121
    v_cvt_pk_bf16_f32 v121, v122, v123
    v_cvt_pk_bf16_f32 v122, v124, v125
    v_cvt_pk_bf16_f32 v123, v126, v127
    s_add_u32 s45, s44, 131072
    buffer_store_dwordx4 v[120:123], v1, s[16:19], s45 offen offset:1024 sc0 sc1
    v_pk_mul_f32 v[80:81], v[80:81], v[136:137] op_sel_hi:[1,0]
    v_pk_mul_f32 v[82:83], v[82:83], v[136:137] op_sel_hi:[1,0]
    v_pk_mul_f32 v[84:85], v[84:85], v[136:137] op_sel_hi:[1,0]
    v_pk_mul_f32 v[86:87], v[86:87], v[136:137] op_sel_hi:[1,0]
    v_cvt_pk_bf16_f32 v80, v80, v81
    v_cvt_pk_bf16_f32 v81, v82, v83
    v_cvt_pk_bf16_f32 v82, v84, v85
    v_cvt_pk_bf16_f32 v83, v86, v87
    s_add_u32 s45, s44, 262144
    buffer_store_dwordx4 v[80:83], v1, s[16:19], s45 offen offset:1024 sc0 sc1
    v_pk_mul_f32 v[88:89], v[88:89], v[140:141] op_sel_hi:[1,0]
    v_pk_mul_f32 v[90:91], v[90:91], v[140:141] op_sel_hi:[1,0]
    v_pk_mul_f32 v[92:93], v[92:93], v[140:141] op_sel_hi:[1,0]
    v_pk_mul_f32 v[94:95], v[94:95], v[140:141] op_sel_hi:[1,0]
    v_cvt_pk_bf16_f32 v88, v88, v89
    v_cvt_pk_bf16_f32 v89, v90, v91
    v_cvt_pk_bf16_f32 v90, v92, v93
    v_cvt_pk_bf16_f32 v91, v94, v95
    s_add_u32 s45, s44, 393216
    buffer_store_dwordx4 v[88:91], v1, s[16:19], s45 offen offset:1024 sc0 sc1
    v_accvgpr_read_b32 v112, a192
    v_accvgpr_read_b32 v113, a193
    v_accvgpr_read_b32 v114, a194
    v_accvgpr_read_b32 v115, a195
    v_accvgpr_read_b32 v116, a208
    v_accvgpr_read_b32 v117, a209
    v_accvgpr_read_b32 v118, a210
    v_accvgpr_read_b32 v119, a211
    v_accvgpr_read_b32 v120, a196
    v_accvgpr_read_b32 v121, a197
    v_accvgpr_read_b32 v122, a198
    v_accvgpr_read_b32 v123, a199
    v_accvgpr_read_b32 v124, a212
    v_accvgpr_read_b32 v125, a213
    v_accvgpr_read_b32 v126, a214
    v_accvgpr_read_b32 v127, a215
    v_accvgpr_read_b32 v80, a200
    v_accvgpr_read_b32 v81, a201
    v_accvgpr_read_b32 v82, a202
    v_accvgpr_read_b32 v83, a203
    v_accvgpr_read_b32 v84, a216
    v_accvgpr_read_b32 v85, a217
    v_accvgpr_read_b32 v86, a218
    v_accvgpr_read_b32 v87, a219
    v_accvgpr_read_b32 v88, a204
    v_accvgpr_read_b32 v89, a205
    v_accvgpr_read_b32 v90, a206
    v_accvgpr_read_b32 v91, a207
    v_accvgpr_read_b32 v92, a220
    v_accvgpr_read_b32 v93, a221
    v_accvgpr_read_b32 v94, a222
    v_accvgpr_read_b32 v95, a223
    v_pk_mul_f32 v[112:113], v[112:113], v[128:129] op_sel_hi:[1,0]
    v_pk_mul_f32 v[114:115], v[114:115], v[128:129] op_sel_hi:[1,0]
    v_pk_mul_f32 v[116:117], v[116:117], v[128:129] op_sel_hi:[1,0]
    v_pk_mul_f32 v[118:119], v[118:119], v[128:129] op_sel_hi:[1,0]
    v_cvt_pk_bf16_f32 v112, v112, v113
    v_cvt_pk_bf16_f32 v113, v114, v115
    v_cvt_pk_bf16_f32 v114, v116, v117
    v_cvt_pk_bf16_f32 v115, v118, v119
    s_add_u32 s45, s44, 0
    buffer_store_dwordx4 v[112:115], v1, s[16:19], s45 offen offset:2048 sc0 sc1
    v_pk_mul_f32 v[120:121], v[120:121], v[132:133] op_sel_hi:[1,0]
    v_pk_mul_f32 v[122:123], v[122:123], v[132:133] op_sel_hi:[1,0]
    v_pk_mul_f32 v[124:125], v[124:125], v[132:133] op_sel_hi:[1,0]
    v_pk_mul_f32 v[126:127], v[126:127], v[132:133] op_sel_hi:[1,0]
    v_cvt_pk_bf16_f32 v120, v120, v121
    v_cvt_pk_bf16_f32 v121, v122, v123
    v_cvt_pk_bf16_f32 v122, v124, v125
    v_cvt_pk_bf16_f32 v123, v126, v127
    s_add_u32 s45, s44, 131072
    buffer_store_dwordx4 v[120:123], v1, s[16:19], s45 offen offset:2048 sc0 sc1
    v_pk_mul_f32 v[80:81], v[80:81], v[136:137] op_sel_hi:[1,0]
    v_pk_mul_f32 v[82:83], v[82:83], v[136:137] op_sel_hi:[1,0]
    v_pk_mul_f32 v[84:85], v[84:85], v[136:137] op_sel_hi:[1,0]
    v_pk_mul_f32 v[86:87], v[86:87], v[136:137] op_sel_hi:[1,0]
    v_cvt_pk_bf16_f32 v80, v80, v81
    v_cvt_pk_bf16_f32 v81, v82, v83
    v_cvt_pk_bf16_f32 v82, v84, v85
    v_cvt_pk_bf16_f32 v83, v86, v87
    s_add_u32 s45, s44, 262144
    buffer_store_dwordx4 v[80:83], v1, s[16:19], s45 offen offset:2048 sc0 sc1
    v_pk_mul_f32 v[88:89], v[88:89], v[140:141] op_sel_hi:[1,0]
    v_pk_mul_f32 v[90:91], v[90:91], v[140:141] op_sel_hi:[1,0]
    v_pk_mul_f32 v[92:93], v[92:93], v[140:141] op_sel_hi:[1,0]
    v_pk_mul_f32 v[94:95], v[94:95], v[140:141] op_sel_hi:[1,0]
    v_cvt_pk_bf16_f32 v88, v88, v89
    v_cvt_pk_bf16_f32 v89, v90, v91
    v_cvt_pk_bf16_f32 v90, v92, v93
    v_cvt_pk_bf16_f32 v91, v94, v95
    s_add_u32 s45, s44, 393216
    buffer_store_dwordx4 v[88:91], v1, s[16:19], s45 offen offset:2048 sc0 sc1
    v_accvgpr_read_b32 v112, a224
    v_accvgpr_read_b32 v113, a225
    v_accvgpr_read_b32 v114, a226
    v_accvgpr_read_b32 v115, a227
    v_accvgpr_read_b32 v116, a240
    v_accvgpr_read_b32 v117, a241
    v_accvgpr_read_b32 v118, a242
    v_accvgpr_read_b32 v119, a243
    v_accvgpr_read_b32 v120, a228
    v_accvgpr_read_b32 v121, a229
    v_accvgpr_read_b32 v122, a230
    v_accvgpr_read_b32 v123, a231
    v_accvgpr_read_b32 v124, a244
    v_accvgpr_read_b32 v125, a245
    v_accvgpr_read_b32 v126, a246
    v_accvgpr_read_b32 v127, a247
    v_accvgpr_read_b32 v80, a232
    v_accvgpr_read_b32 v81, a233
    v_accvgpr_read_b32 v82, a234
    v_accvgpr_read_b32 v83, a235
    v_accvgpr_read_b32 v84, a248
    v_accvgpr_read_b32 v85, a249
    v_accvgpr_read_b32 v86, a250
    v_accvgpr_read_b32 v87, a251
    v_accvgpr_read_b32 v88, a236
    v_accvgpr_read_b32 v89, a237
    v_accvgpr_read_b32 v90, a238
    v_accvgpr_read_b32 v91, a239
    v_accvgpr_read_b32 v92, a252
    v_accvgpr_read_b32 v93, a253
    v_accvgpr_read_b32 v94, a254
    v_accvgpr_read_b32 v95, a255
    v_pk_mul_f32 v[112:113], v[112:113], v[128:129] op_sel_hi:[1,0]
    v_pk_mul_f32 v[114:115], v[114:115], v[128:129] op_sel_hi:[1,0]
    v_pk_mul_f32 v[116:117], v[116:117], v[128:129] op_sel_hi:[1,0]
    v_pk_mul_f32 v[118:119], v[118:119], v[128:129] op_sel_hi:[1,0]
    v_cvt_pk_bf16_f32 v112, v112, v113
    v_cvt_pk_bf16_f32 v113, v114, v115
    v_cvt_pk_bf16_f32 v114, v116, v117
    v_cvt_pk_bf16_f32 v115, v118, v119
    s_add_u32 s45, s44, 0
    buffer_store_dwordx4 v[112:115], v1, s[16:19], s45 offen offset:3072 sc0 sc1
    v_pk_mul_f32 v[120:121], v[120:121], v[132:133] op_sel_hi:[1,0]
    v_pk_mul_f32 v[122:123], v[122:123], v[132:133] op_sel_hi:[1,0]
    v_pk_mul_f32 v[124:125], v[124:125], v[132:133] op_sel_hi:[1,0]
    v_pk_mul_f32 v[126:127], v[126:127], v[132:133] op_sel_hi:[1,0]
    v_cvt_pk_bf16_f32 v120, v120, v121
    v_cvt_pk_bf16_f32 v121, v122, v123
    v_cvt_pk_bf16_f32 v122, v124, v125
    v_cvt_pk_bf16_f32 v123, v126, v127
    s_add_u32 s45, s44, 131072
    buffer_store_dwordx4 v[120:123], v1, s[16:19], s45 offen offset:3072 sc0 sc1
    v_pk_mul_f32 v[80:81], v[80:81], v[136:137] op_sel_hi:[1,0]
    v_pk_mul_f32 v[82:83], v[82:83], v[136:137] op_sel_hi:[1,0]
    v_pk_mul_f32 v[84:85], v[84:85], v[136:137] op_sel_hi:[1,0]
    v_pk_mul_f32 v[86:87], v[86:87], v[136:137] op_sel_hi:[1,0]
    v_cvt_pk_bf16_f32 v80, v80, v81
    v_cvt_pk_bf16_f32 v81, v82, v83
    v_cvt_pk_bf16_f32 v82, v84, v85
    v_cvt_pk_bf16_f32 v83, v86, v87
    s_add_u32 s45, s44, 262144
    buffer_store_dwordx4 v[80:83], v1, s[16:19], s45 offen offset:3072 sc0 sc1
    v_pk_mul_f32 v[88:89], v[88:89], v[140:141] op_sel_hi:[1,0]
    v_pk_mul_f32 v[90:91], v[90:91], v[140:141] op_sel_hi:[1,0]
    v_pk_mul_f32 v[92:93], v[92:93], v[140:141] op_sel_hi:[1,0]
    v_pk_mul_f32 v[94:95], v[94:95], v[140:141] op_sel_hi:[1,0]
    v_cvt_pk_bf16_f32 v88, v88, v89
    v_cvt_pk_bf16_f32 v89, v90, v91
    v_cvt_pk_bf16_f32 v90, v92, v93
    v_cvt_pk_bf16_f32 v91, v94, v95
    s_add_u32 s45, s44, 393216
    buffer_store_dwordx4 v[88:91], v1, s[16:19], s45 offen offset:3072 sc0 sc1
    v_lshl_add_u32 v188, v1, 16, s34
    v_mov_b32 v189, 7
    s_waitcnt vmcnt(0)
    s_waitcnt lgkmcnt(0)
    s_barrier
    ds_read_b128 v[184:187], v3
    s_waitcnt lgkmcnt(0)
    v_max3_f32 v184, v184, v185, v186
    v_max_f32 v184, v184, v187
    v_cmp_nge_f32 vcc, 0x5d800000, v184
    s_cbranch_vccnz K2_REDO
K2_OKM1:
    s_branch KT_ENTRY
K2_FINZ:
    s_waitcnt lgkmcnt(3)
    v_mfma_f32_16x16x32_bf16 a[128:131], v[152:155], v[80:83], 0
    ds_read_b128 v[172:175], v4 offset:5120
    v_exp_f32 v184, v56
    v_mfma_f32_16x16x32_bf16 a[132:135], v[152:155], v[84:87], 0
    ds_write_b128 v8, a[8:11] offset:16384
    ds_write_b128 v8, a[12:15] offset:17408
    ds_write_b128 v8, a[24:27] offset:18432
    v_mfma_f32_16x16x32_bf16 a[136:139], v[152:155], v[88:91], 0
    v_exp_f32 v185, v57
    ds_write_b128 v8, a[28:31] offset:19456
    v_mfma_f32_16x16x32_bf16 a[140:143], v[152:155], v[92:95], 0
    v_cvt_pk_bf16_f32 v104, v184, v185
    ds_write_b128 v8, a[40:43] offset:20480
    ds_write_b128 v8, a[44:47] offset:21504
    v_mfma_f32_16x16x32_bf16 a[144:147], v[156:159], v[80:83], 0
    ds_read_b128 v[176:179], v4 offset:6144
    v_exp_f32 v186, v58
    v_mfma_f32_16x16x32_bf16 a[148:151], v[156:159], v[84:87], 0
    s_lshl_b32 s44, s27, 17
    s_lshl_b32 s45, s25, 12
    s_waitcnt vmcnt(1)
    v_mfma_f32_16x16x32_bf16 a[152:155], v[156:159], v[88:91], 0
    v_exp_f32 v187, v59
    ds_write_b128 v8, a[56:59] offset:22528
    v_mfma_f32_16x16x32_bf16 a[156:159], v[156:159], v[92:95], 0
    v_cvt_pk_bf16_f32 v105, v186, v187
    ds_write_b128 v8, a[60:63] offset:23552
    ds_write_b128 v8, a[72:75] offset:24576
    v_mfma_f32_16x16x32_bf16 v[128:131], v[12:15], v[80:83], 0
    v_exp_f32 v188, v60
    ds_write_b128 v8, a[76:79] offset:25600
    s_waitcnt lgkmcnt(13)
    v_mfma_f32_16x16x32_bf16 a[160:163], v[160:163], v[80:83], 0
    ds_read_b128 v[180:183], v4 offset:7168
    v_exp_f32 v189, v61
    v_mfma_f32_16x16x32_bf16 a[164:167], v[160:163], v[84:87], 0
    v_cvt_pk_bf16_f32 v108, v188, v189
    ds_write_b128 v8, a[88:91] offset:26624
    s_add_u32 s44, s44, s45
    v_mfma_f32_16x16x32_bf16 a[168:171], v[160:163], v[88:91], 0
    v_add_f32_dpp v0, v0, v0 quad_perm:[1,0,3,2] row_mask:0xf bank_mask:0xf
    v_and_b32 v2, 0x70, v1
    v_lshlrev_b32 v2, 22, v2
    v_mfma_f32_16x16x32_bf16 a[172:175], v[160:163], v[92:95], 0
    v_exp_f32 v190, v62
    ds_write_b128 v8, a[92:95] offset:27648
    v_mfma_f32_16x16x32_bf16 a[176:179], v[164:167], v[80:83], 0
    v_add_f32_dpp v0, v0, v0 quad_perm:[2,3,0,1] row_mask:0xf bank_mask:0xf
    v_lshrrev_b32 v11, 2, v1
    v_add_u32 v2, v2, v11
    v_mfma_f32_16x16x32_bf16 a[180:183], v[164:167], v[84:87], 0
    v_exp_f32 v191, v63
    ds_write_b128 v8, a[104:107] offset:28672
    v_mfma_f32_16x16x32_bf16 a[184:187], v[164:167], v[88:91], 0
    v_cvt_pk_bf16_f32 v109, v190, v191
    ds_write_b128 v8, a[108:111] offset:29696
    ds_write_b128 v8, a[120:123] offset:30720
    v_mfma_f32_16x16x32_bf16 a[188:191], v[164:167], v[92:95], 0
    v_add_f32_dpp v0, v0, v0 row_half_mirror row_mask:0xf bank_mask:0xf
    v_mul_f32 v0, 0x3ae38e39, v0
    v_cvt_pk_bf16_f32 v10, v0, v0
    v_mfma_f32_16x16x32_bf16 v[132:135], v[12:15], v[84:87], 0
    v_exp_f32 v184, v72
    ds_write_b128 v8, a[124:127] offset:31744
    s_waitcnt lgkmcnt(15)
    v_mfma_f32_16x16x32_bf16 a[192:195], v[168:171], v[80:83], 0
    s_lshl_b32 s45, s24, 2
    v_and_b32 v10, 0xffff0000, v10
    v_mfma_f32_16x16x32_bf16 a[196:199], v[168:171], v[84:87], 0
    v_exp_f32 v185, v73
    v_mfma_f32_16x16x32_bf16 a[200:203], v[168:171], v[88:91], 0
    v_cvt_pk_bf16_f32 v106, v184, v185
    v_add_u32 v3, 135168, v1
    v_sub_f32 v10, v0, v10
    v_mfma_f32_16x16x32_bf16 a[204:207], v[168:171], v[92:95], 0
    v_exp_f32 v186, v74
    s_waitcnt lgkmcnt(0)
    s_barrier
    v_mfma_f32_16x16x32_bf16 a[208:211], v[172:175], v[80:83], 0
    ds_read_b128 v[152:155], v4 offset:8192
    v_exp_f32 v187, v75
    v_mfma_f32_16x16x32_bf16 a[212:215], v[172:175], v[84:87], 0
    ds_read_b128 v[156:159], v4 offset:9216
    v_exp_f32 v188, v76
    v_mfma_f32_16x16x32_bf16 a[216:219], v[172:175], v[88:91], 0
    v_cvt_pk_bf16_f32 v107, v186, v187
    v_cvt_pk_bf16_f32 v10, v0, v10
    v_mfma_f32_16x16x32_bf16 a[220:223], v[172:175], v[92:95], 0
    v_mfma_f32_16x16x32_bf16 v[136:139], v[12:15], v[88:91], 0
    v_mfma_f32_16x16x32_bf16 a[224:227], v[176:179], v[80:83], 0
    ds_read_b128 v[160:163], v4 offset:10240
    v_exp_f32 v189, v77
    v_mfma_f32_16x16x32_bf16 a[228:231], v[176:179], v[84:87], 0
    ds_read_b128 v[164:167], v4 offset:11264
    v_exp_f32 v190, v78
    v_mfma_f32_16x16x32_bf16 a[232:235], v[176:179], v[88:91], 0
    buffer_store_dword v10, v2, s[64:67], s70 offen sc0 sc1
    v_mfma_f32_16x16x32_bf16 a[236:239], v[176:179], v[92:95], 0
    v_cvt_pk_bf16_f32 v110, v188, v189
    v_add_u32 v9, s45, v3
    v_mfma_f32_16x16x32_bf16 a[240:243], v[180:183], v[80:83], 0
    ds_read_b128 v[168:171], v4 offset:12288
    v_exp_f32 v191, v79
    v_mfma_f32_16x16x32_bf16 a[244:247], v[180:183], v[84:87], 0
    v_cvt_pk_bf16_f32 v111, v190, v191
    v_mfma_f32_16x16x32_bf16 a[248:251], v[180:183], v[88:91], 0
    v_mfma_f32_16x16x32_bf16 a[252:255], v[180:183], v[92:95], 0
    v_mfma_f32_16x16x32_bf16 v[140:143], v[12:15], v[92:95], 0
    ds_read_b128 v[172:175], v4 offset:13312
    ds_read_b128 v[176:179], v4 offset:14336
    ds_read_b128 v[180:183], v4 offset:15360
    v_mfma_f32_16x16x32_bf16 v[136:139], v[12:15], v[104:107], v[136:139]
    v_mfma_f32_16x16x32_bf16 v[140:143], v[12:15], v[108:111], v[140:143]
    s_waitcnt lgkmcnt(7)
    v_mfma_f32_16x16x32_bf16 a[136:139], v[152:155], v[104:107], a[136:139]
    v_rcp_f32 v128, v129
    v_rcp_f32 v132, v133
    s_nop 2
    v_rcp_f32 v136, v137
    v_mfma_f32_16x16x32_bf16 a[140:143], v[152:155], v[108:111], a[140:143]
    v_rcp_f32 v140, v141
    v_max3_f32 v11, v128, v129, v132
    v_max3_f32 v11, v11, v133, v136
    s_waitcnt lgkmcnt(6)
    v_mfma_f32_16x16x32_bf16 a[152:155], v[156:159], v[104:107], a[152:155]
    v_max3_f32 v11, v11, v137, v140
    v_max_f32 v11, v11, v141
    ds_write_b32 v9, v11
    v_mfma_f32_16x16x32_bf16 a[156:159], v[156:159], v[108:111], a[156:159]
    s_getpc_b64 s[46:47]
K2_PCS31:
    s_bfe_u32 s48, s2, 0x30003
    s_lshl_b32 s48, s48, 13
    s_add_u32 s48, s48, KT_ENTRY-K2_PCS31
    v_lshl_add_u32 v147, v1, 3, s48
    s_waitcnt lgkmcnt(6)
    v_mfma_f32_16x16x32_bf16 a[168:171], v[160:163], v[104:107], a[168:171]
    v_min_u32 v147, CODE_END-K2_PCS31-4, v147
    global_load_dword v147, v147, s[46:47]
    s_lshr_b32 s46, s2, 3
    s_lshl_b32 s46, s46, 2
    s_add_u32 s46, s46, s24
    s_bfe_u32 s47, s2, 0x20001
    v_mfma_f32_16x16x32_bf16 a[172:175], v[160:163], v[108:111], a[172:175]
    s_mov_b32 s4, s54
    s_mov_b32 s5, s55
    s_mov_b32 s6, 4718592
    s_lshl_b32 s48, s47, 7
    s_add_u32 s48, s48, s46
    s_mul_i32 s48, s48, 9216
    v_lshrrev_b32 v144, 7, v1
    s_waitcnt lgkmcnt(5)
    v_mfma_f32_16x16x32_bf16 a[184:187], v[164:167], v[104:107], a[184:187]
    v_and_b32 v5, 0x70, v1
    v_mul_u32_u24 v144, 1152, v144
    v_lshl_add_u32 v144, v5, 3, v144
    v_mfma_f32_16x16x32_bf16 a[188:191], v[164:167], v[108:111], a[188:191]
    buffer_load_dword v144, v144, s[4:7], s48 offen
    v_accvgpr_read_b32 v112, a128
    v_accvgpr_read_b32 v113, a129
    s_waitcnt lgkmcnt(4)
    v_mfma_f32_16x16x32_bf16 a[200:203], v[168:171], v[104:107], a[200:203]
    v_accvgpr_read_b32 v114, a130
    v_accvgpr_read_b32 v115, a131
    v_accvgpr_read_b32 v116, a144
    v_mfma_f32_16x16x32_bf16 a[204:207], v[168:171], v[108:111], a[204:207]
    v_accvgpr_read_b32 v117, a145
    v_accvgpr_read_b32 v118, a146
    v_accvgpr_read_b32 v119, a147
    s_waitcnt lgkmcnt(3)
    v_mfma_f32_16x16x32_bf16 a[216:219], v[172:175], v[104:107], a[216:219]
    v_accvgpr_read_b32 v120, a132
    v_accvgpr_read_b32 v121, a133
    v_accvgpr_read_b32 v122, a134
    v_mfma_f32_16x16x32_bf16 a[220:223], v[172:175], v[108:111], a[220:223]
    v_accvgpr_read_b32 v123, a135
    v_accvgpr_read_b32 v124, a148
    v_accvgpr_read_b32 v125, a149
    s_waitcnt lgkmcnt(2)
    v_mfma_f32_16x16x32_bf16 a[232:235], v[176:179], v[104:107], a[232:235]
    v_accvgpr_read_b32 v126, a150
    v_accvgpr_read_b32 v127, a151
    v_accvgpr_read_b32 v80, a136
    v_mfma_f32_16x16x32_bf16 a[236:239], v[176:179], v[108:111], a[236:239]
    v_accvgpr_read_b32 v81, a137
    v_accvgpr_read_b32 v82, a138
    v_accvgpr_read_b32 v83, a139
    s_waitcnt lgkmcnt(1)
    v_mfma_f32_16x16x32_bf16 a[248:251], v[180:183], v[104:107], a[248:251]
    v_accvgpr_read_b32 v84, a152
    v_accvgpr_read_b32 v85, a153
    v_accvgpr_read_b32 v86, a154
    v_mfma_f32_16x16x32_bf16 a[252:255], v[180:183], v[108:111], a[252:255]
    v_accvgpr_read_b32 v87, a155
    v_accvgpr_read_b32 v88, a140
    v_accvgpr_read_b32 v89, a141
    v_accvgpr_read_b32 v90, a142
    v_accvgpr_read_b32 v91, a143
    v_accvgpr_read_b32 v92, a156
    v_accvgpr_read_b32 v93, a157
    v_accvgpr_read_b32 v94, a158
    v_accvgpr_read_b32 v95, a159
    v_pk_mul_f32 v[112:113], v[112:113], v[128:129] op_sel_hi:[1,0]
    v_pk_mul_f32 v[114:115], v[114:115], v[128:129] op_sel_hi:[1,0]
    v_pk_mul_f32 v[116:117], v[116:117], v[128:129] op_sel_hi:[1,0]
    v_pk_mul_f32 v[118:119], v[118:119], v[128:129] op_sel_hi:[1,0]
    v_cvt_pk_bf16_f32 v112, v112, v113
    v_cvt_pk_bf16_f32 v113, v114, v115
    v_cvt_pk_bf16_f32 v114, v116, v117
    v_cvt_pk_bf16_f32 v115, v118, v119
    s_add_u32 s45, s44, 0
    buffer_store_dwordx4 v[112:115], v1, s[16:19], s45 offen offset:0 sc0 sc1
    v_pk_mul_f32 v[120:121], v[120:121], v[132:133] op_sel_hi:[1,0]
    v_pk_mul_f32 v[122:123], v[122:123], v[132:133] op_sel_hi:[1,0]
    v_pk_mul_f32 v[124:125], v[124:125], v[132:133] op_sel_hi:[1,0]
    v_pk_mul_f32 v[126:127], v[126:127], v[132:133] op_sel_hi:[1,0]
    v_cvt_pk_bf16_f32 v120, v120, v121
    v_cvt_pk_bf16_f32 v121, v122, v123
    v_cvt_pk_bf16_f32 v122, v124, v125
    v_cvt_pk_bf16_f32 v123, v126, v127
    s_add_u32 s45, s44, 131072
    buffer_store_dwordx4 v[120:123], v1, s[16:19], s45 offen offset:0 sc0 sc1
    v_pk_mul_f32 v[80:81], v[80:81], v[136:137] op_sel_hi:[1,0]
    v_pk_mul_f32 v[82:83], v[82:83], v[136:137] op_sel_hi:[1,0]
    v_pk_mul_f32 v[84:85], v[84:85], v[136:137] op_sel_hi:[1,0]
    v_pk_mul_f32 v[86:87], v[86:87], v[136:137] op_sel_hi:[1,0]
    v_cvt_pk_bf16_f32 v80, v80, v81
    v_cvt_pk_bf16_f32 v81, v82, v83
    v_cvt_pk_bf16_f32 v82, v84, v85
    v_cvt_pk_bf16_f32 v83, v86, v87
    s_add_u32 s45, s44, 262144
    buffer_store_dwordx4 v[80:83], v1, s[16:19], s45 offen offset:0 sc0 sc1
    v_pk_mul_f32 v[88:89], v[88:89], v[140:141] op_sel_hi:[1,0]
    v_pk_mul_f32 v[90:91], v[90:91], v[140:141] op_sel_hi:[1,0]
    v_pk_mul_f32 v[92:93], v[92:93], v[140:141] op_sel_hi:[1,0]
    v_pk_mul_f32 v[94:95], v[94:95], v[140:141] op_sel_hi:[1,0]
    v_cvt_pk_bf16_f32 v88, v88, v89
    v_cvt_pk_bf16_f32 v89, v90, v91
    v_cvt_pk_bf16_f32 v90, v92, v93
    v_cvt_pk_bf16_f32 v91, v94, v95
    s_add_u32 s45, s44, 393216
    buffer_store_dwordx4 v[88:91], v1, s[16:19], s45 offen offset:0 sc0 sc1
    v_accvgpr_read_b32 v112, a160
    v_accvgpr_read_b32 v113, a161
    v_accvgpr_read_b32 v114, a162
    v_accvgpr_read_b32 v115, a163
    v_accvgpr_read_b32 v116, a176
    v_accvgpr_read_b32 v117, a177
    v_accvgpr_read_b32 v118, a178
    v_accvgpr_read_b32 v119, a179
    v_accvgpr_read_b32 v120, a164
    v_accvgpr_read_b32 v121, a165
    v_accvgpr_read_b32 v122, a166
    v_accvgpr_read_b32 v123, a167
    v_accvgpr_read_b32 v124, a180
    v_accvgpr_read_b32 v125, a181
    v_accvgpr_read_b32 v126, a182
    v_accvgpr_read_b32 v127, a183
    v_accvgpr_read_b32 v80, a168
    v_accvgpr_read_b32 v81, a169
    v_accvgpr_read_b32 v82, a170
    v_accvgpr_read_b32 v83, a171
    v_accvgpr_read_b32 v84, a184
    v_accvgpr_read_b32 v85, a185
    v_accvgpr_read_b32 v86, a186
    v_accvgpr_read_b32 v87, a187
    v_accvgpr_read_b32 v88, a172
    v_accvgpr_read_b32 v89, a173
    v_accvgpr_read_b32 v90, a174
    v_accvgpr_read_b32 v91, a175
    v_accvgpr_read_b32 v92, a188
    v_accvgpr_read_b32 v93, a189
    v_accvgpr_read_b32 v94, a190
    v_accvgpr_read_b32 v95, a191
    v_pk_mul_f32 v[112:113], v[112:113], v[128:129] op_sel_hi:[1,0]
    v_pk_mul_f32 v[114:115], v[114:115], v[128:129] op_sel_hi:[1,0]
    v_pk_mul_f32 v[116:117], v[116:117], v[128:129] op_sel_hi:[1,0]
    v_pk_mul_f32 v[118:119], v[118:119], v[128:129] op_sel_hi:[1,0]
    v_cvt_pk_bf16_f32 v112, v112, v113
    v_cvt_pk_bf16_f32 v113, v114, v115
    v_cvt_pk_bf16_f32 v114, v116, v117
    v_cvt_pk_bf16_f32 v115, v118, v119
    s_add_u32 s45, s44, 0
    buffer_store_dwordx4 v[112:115], v1, s[16:19], s45 offen offset:1024 sc0 sc1
    v_pk_mul_f32 v[120:121], v[120:121], v[132:133] op_sel_hi:[1,0]
    v_pk_mul_f32 v[122:123], v[122:123], v[132:133] op_sel_hi:[1,0]
    v_pk_mul_f32 v[124:125], v[124:125], v[132:133] op_sel_hi:[1,0]
    v_pk_mul_f32 v[126:127], v[126:127], v[132:133] op_sel_hi:[1,0]
    v_cvt_pk_bf16_f32 v120, v120, v121
    v_cvt_pk_bf16_f32 v121, v122, v123
    v_cvt_pk_bf16_f32 v122, v124, v125
    v_cvt_pk_bf16_f32 v123, v126, v127
    s_add_u32 s45, s44, 131072
    buffer_store_dwordx4 v[120:123], v1, s[16:19], s45 offen offset:1024 sc0 sc1
    v_pk_mul_f32 v[80:81], v[80:81], v[136:137] op_sel_hi:[1,0]
    v_pk_mul_f32 v[82:83], v[82:83], v[136:137] op_sel_hi:[1,0]
    v_pk_mul_f32 v[84:85], v[84:85], v[136:137] op_sel_hi:[1,0]
    v_pk_mul_f32 v[86:87], v[86:87], v[136:137] op_sel_hi:[1,0]
    v_cvt_pk_bf16_f32 v80, v80, v81
    v_cvt_pk_bf16_f32 v81, v82, v83
    v_cvt_pk_bf16_f32 v82, v84, v85
    v_cvt_pk_bf16_f32 v83, v86, v87
    s_add_u32 s45, s44, 262144
    buffer_store_dwordx4 v[80:83], v1, s[16:19], s45 offen offset:1024 sc0 sc1
    v_pk_mul_f32 v[88:89], v[88:89], v[140:141] op_sel_hi:[1,0]
    v_pk_mul_f32 v[90:91], v[90:91], v[140:141] op_sel_hi:[1,0]
    v_pk_mul_f32 v[92:93], v[92:93], v[140:141] op_sel_hi:[1,0]
    v_pk_mul_f32 v[94:95], v[94:95], v[140:141] op_sel_hi:[1,0]
    v_cvt_pk_bf16_f32 v88, v88, v89
    v_cvt_pk_bf16_f32 v89, v90, v91
    v_cvt_pk_bf16_f32 v90, v92, v93
    v_cvt_pk_bf16_f32 v91, v94, v95
    s_add_u32 s45, s44, 393216
    buffer_store_dwordx4 v[88:91], v1, s[16:19], s45 offen offset:1024 sc0 sc1
    v_accvgpr_read_b32 v112, a192
    v_accvgpr_read_b32 v113, a193
    v_accvgpr_read_b32 v114, a194
    v_accvgpr_read_b32 v115, a195
    v_accvgpr_read_b32 v116, a208
    v_accvgpr_read_b32 v117, a209
    v_accvgpr_read_b32 v118, a210
    v_accvgpr_read_b32 v119, a211
    v_accvgpr_read_b32 v120, a196
    v_accvgpr_read_b32 v121, a197
    v_accvgpr_read_b32 v122, a198
    v_accvgpr_read_b32 v123, a199
    v_accvgpr_read_b32 v124, a212
    v_accvgpr_read_b32 v125, a213
    v_accvgpr_read_b32 v126, a214
    v_accvgpr_read_b32 v127, a215
    v_accvgpr_read_b32 v80, a200
    v_accvgpr_read_b32 v81, a201
    v_accvgpr_read_b32 v82, a202
    v_accvgpr_read_b32 v83, a203
    v_accvgpr_read_b32 v84, a216
    v_accvgpr_read_b32 v85, a217
    v_accvgpr_read_b32 v86, a218
    v_accvgpr_read_b32 v87, a219
    v_accvgpr_read_b32 v88, a204
    v_accvgpr_read_b32 v89, a205
    v_accvgpr_read_b32 v90, a206
    v_accvgpr_read_b32 v91, a207
    v_accvgpr_read_b32 v92, a220
    v_accvgpr_read_b32 v93, a221
    v_accvgpr_read_b32 v94, a222
    v_accvgpr_read_b32 v95, a223
    v_pk_mul_f32 v[112:113], v[112:113], v[128:129] op_sel_hi:[1,0]
    v_pk_mul_f32 v[114:115], v[114:115], v[128:129] op_sel_hi:[1,0]
    v_pk_mul_f32 v[116:117], v[116:117], v[128:129] op_sel_hi:[1,0]
    v_pk_mul_f32 v[118:119], v[118:119], v[128:129] op_sel_hi:[1,0]
    v_cvt_pk_bf16_f32 v112, v112, v113
    v_cvt_pk_bf16_f32 v113, v114, v115
    v_cvt_pk_bf16_f32 v114, v116, v117
    v_cvt_pk_bf16_f32 v115, v118, v119
    s_add_u32 s45, s44, 0
    buffer_store_dwordx4 v[112:115], v1, s[16:19], s45 offen offset:2048 sc0 sc1
    v_pk_mul_f32 v[120:121], v[120:121], v[132:133] op_sel_hi:[1,0]
    v_pk_mul_f32 v[122:123], v[122:123], v[132:133] op_sel_hi:[1,0]
    v_pk_mul_f32 v[124:125], v[124:125], v[132:133] op_sel_hi:[1,0]
    v_pk_mul_f32 v[126:127], v[126:127], v[132:133] op_sel_hi:[1,0]
    v_cvt_pk_bf16_f32 v120, v120, v121
    v_cvt_pk_bf16_f32 v121, v122, v123
    v_cvt_pk_bf16_f32 v122, v124, v125
    v_cvt_pk_bf16_f32 v123, v126, v127
    s_add_u32 s45, s44, 131072
    buffer_store_dwordx4 v[120:123], v1, s[16:19], s45 offen offset:2048 sc0 sc1
    v_pk_mul_f32 v[80:81], v[80:81], v[136:137] op_sel_hi:[1,0]
    v_pk_mul_f32 v[82:83], v[82:83], v[136:137] op_sel_hi:[1,0]
    v_pk_mul_f32 v[84:85], v[84:85], v[136:137] op_sel_hi:[1,0]
    v_pk_mul_f32 v[86:87], v[86:87], v[136:137] op_sel_hi:[1,0]
    v_cvt_pk_bf16_f32 v80, v80, v81
    v_cvt_pk_bf16_f32 v81, v82, v83
    v_cvt_pk_bf16_f32 v82, v84, v85
    v_cvt_pk_bf16_f32 v83, v86, v87
    s_add_u32 s45, s44, 262144
    buffer_store_dwordx4 v[80:83], v1, s[16:19], s45 offen offset:2048 sc0 sc1
    v_pk_mul_f32 v[88:89], v[88:89], v[140:141] op_sel_hi:[1,0]
    v_pk_mul_f32 v[90:91], v[90:91], v[140:141] op_sel_hi:[1,0]
    v_pk_mul_f32 v[92:93], v[92:93], v[140:141] op_sel_hi:[1,0]
    v_pk_mul_f32 v[94:95], v[94:95], v[140:141] op_sel_hi:[1,0]
    v_cvt_pk_bf16_f32 v88, v88, v89
    v_cvt_pk_bf16_f32 v89, v90, v91
    v_cvt_pk_bf16_f32 v90, v92, v93
    v_cvt_pk_bf16_f32 v91, v94, v95
    s_add_u32 s45, s44, 393216
    buffer_store_dwordx4 v[88:91], v1, s[16:19], s45 offen offset:2048 sc0 sc1
    v_accvgpr_read_b32 v112, a224
    v_accvgpr_read_b32 v113, a225
    v_accvgpr_read_b32 v114, a226
    v_accvgpr_read_b32 v115, a227
    v_accvgpr_read_b32 v116, a240
    v_accvgpr_read_b32 v117, a241
    v_accvgpr_read_b32 v118, a242
    v_accvgpr_read_b32 v119, a243
    v_accvgpr_read_b32 v120, a228
    v_accvgpr_read_b32 v121, a229
    v_accvgpr_read_b32 v122, a230
    v_accvgpr_read_b32 v123, a231
    v_accvgpr_read_b32 v124, a244
    v_accvgpr_read_b32 v125, a245
    v_accvgpr_read_b32 v126, a246
    v_accvgpr_read_b32 v127, a247
    v_accvgpr_read_b32 v80, a232
    v_accvgpr_read_b32 v81, a233
    v_accvgpr_read_b32 v82, a234
    v_accvgpr_read_b32 v83, a235
    v_accvgpr_read_b32 v84, a248
    v_accvgpr_read_b32 v85, a249
    v_accvgpr_read_b32 v86, a250
    v_accvgpr_read_b32 v87, a251
    v_accvgpr_read_b32 v88, a236
    v_accvgpr_read_b32 v89, a237
    v_accvgpr_read_b32 v90, a238
    v_accvgpr_read_b32 v91, a239
    v_accvgpr_read_b32 v92, a252
    v_accvgpr_read_b32 v93, a253
    v_accvgpr_read_b32 v94, a254
    v_accvgpr_read_b32 v95, a255
    v_pk_mul_f32 v[112:113], v[112:113], v[128:129] op_sel_hi:[1,0]
    v_pk_mul_f32 v[114:115], v[114:115], v[128:129] op_sel_hi:[1,0]
    v_pk_mul_f32 v[116:117], v[116:117], v[128:129] op_sel_hi:[1,0]
    v_pk_mul_f32 v[118:119], v[118:119], v[128:129] op_sel_hi:[1,0]
    v_cvt_pk_bf16_f32 v112, v112, v113
    v_cvt_pk_bf16_f32 v113, v114, v115
    v_cvt_pk_bf16_f32 v114, v116, v117
    v_cvt_pk_bf16_f32 v115, v118, v119
    s_add_u32 s45, s44, 0
    buffer_store_dwordx4 v[112:115], v1, s[16:19], s45 offen offset:3072 sc0 sc1
    v_pk_mul_f32 v[120:121], v[120:121], v[132:133] op_sel_hi:[1,0]
    v_pk_mul_f32 v[122:123], v[122:123], v[132:133] op_sel_hi:[1,0]
    v_pk_mul_f32 v[124:125], v[124:125], v[132:133] op_sel_hi:[1,0]
    v_pk_mul_f32 v[126:127], v[126:127], v[132:133] op_sel_hi:[1,0]
    v_cvt_pk_bf16_f32 v120, v120, v121
    v_cvt_pk_bf16_f32 v121, v122, v123
    v_cvt_pk_bf16_f32 v122, v124, v125
    v_cvt_pk_bf16_f32 v123, v126, v127
    s_add_u32 s45, s44, 131072
    buffer_store_dwordx4 v[120:123], v1, s[16:19], s45 offen offset:3072 sc0 sc1
    v_pk_mul_f32 v[80:81], v[80:81], v[136:137] op_sel_hi:[1,0]
    v_pk_mul_f32 v[82:83], v[82:83], v[136:137] op_sel_hi:[1,0]
    v_pk_mul_f32 v[84:85], v[84:85], v[136:137] op_sel_hi:[1,0]
    v_pk_mul_f32 v[86:87], v[86:87], v[136:137] op_sel_hi:[1,0]
    v_cvt_pk_bf16_f32 v80, v80, v81
    v_cvt_pk_bf16_f32 v81, v82, v83
    v_cvt_pk_bf16_f32 v82, v84, v85
    v_cvt_pk_bf16_f32 v83, v86, v87
    s_add_u32 s45, s44, 262144
    buffer_store_dwordx4 v[80:83], v1, s[16:19], s45 offen offset:3072 sc0 sc1
    v_pk_mul_f32 v[88:89], v[88:89], v[140:141] op_sel_hi:[1,0]
    v_pk_mul_f32 v[90:91], v[90:91], v[140:141] op_sel_hi:[1,0]
    v_pk_mul_f32 v[92:93], v[92:93], v[140:141] op_sel_hi:[1,0]
    v_pk_mul_f32 v[94:95], v[94:95], v[140:141] op_sel_hi:[1,0]
    v_cvt_pk_bf16_f32 v88, v88, v89
    v_cvt_pk_bf16_f32 v89, v90, v91
    v_cvt_pk_bf16_f32 v90, v92, v93
    v_cvt_pk_bf16_f32 v91, v94, v95
    s_add_u32 s45, s44, 393216
    buffer_store_dwordx4 v[88:91], v1, s[16:19], s45 offen offset:3072 sc0 sc1
    v_lshl_add_u32 v188, v1, 16, s34
    v_mov_b32 v189, 7
    s_waitcnt vmcnt(0)
    s_waitcnt lgkmcnt(0)
    s_barrier
    ds_read_b128 v[184:187], v3
    s_waitcnt lgkmcnt(0)
    v_max3_f32 v184, v184, v185, v186
    v_max_f32 v184, v184, v187
    v_cmp_nge_f32 vcc, 0x5d800000, v184
    s_cbranch_vccnz K2_REDO
K2_OKS31:
    s_branch KT_ENTRY
K2_FD:
    v_cmp_le_i32_e64 s[44:45], 0, v5
    v_cmp_le_i32_e64 s[46:47], 1, v5
    v_cmp_le_i32_e64 s[48:49], 2, v5
    v_cmp_le_i32_e64 s[50:51], 3, v5
    v_cndmask_b32_e64 v16, v6, v112, s[44:45]
    v_cndmask_b32_e64 v17, v6, v112, s[46:47]
    v_cndmask_b32_e64 v18, v6, v112, s[48:49]
    v_cndmask_b32_e64 v19, v6, v112, s[50:51]
    v_cmp_le_i32_e64 s[44:45], -16, v5
    v_cmp_le_i32_e64 s[46:47], -15, v5
    v_cmp_le_i32_e64 s[48:49], -14, v5
    v_cmp_le_i32_e64 s[50:51], -13, v5
    v_cndmask_b32_e64 v20, v6, v116, s[44:45]
    v_cndmask_b32_e64 v21, v6, v116, s[46:47]
    v_cndmask_b32_e64 v22, v6, v116, s[48:49]
    v_cndmask_b32_e64 v23, v6, v116, s[50:51]
    s_waitcnt lgkmcnt(3)
    v_mfma_f32_16x16x32_bf16 v[16:19], v[152:155], v[192:195], v[16:19]
    ds_read_b128 v[172:175], v3 offset:5120
    s_add_u32 s40, s40, 8192
    s_add_u32 s42, s42, 8192
    v_mfma_f32_16x16x32_bf16 v[20:23], v[152:155], v[196:199], v[20:23]
    s_add_u32 m0, s42, s43
    v_cmp_le_i32_e64 s[44:45], 8, v5
    v_cmp_le_i32_e64 s[46:47], 9, v5
    v_mfma_f32_16x16x32_bf16 v[24:27], v[152:155], v[200:203], v[120:123]
    buffer_load_dwordx4 v1, s[12:15], s40 offen offset:0 lds
    v_mfma_f32_16x16x32_bf16 v[28:31], v[152:155], v[204:207], v[124:127]
    v_cmp_le_i32_e64 s[48:49], 10, v5
    v_cmp_le_i32_e64 s[50:51], 11, v5
    v_cndmask_b32_e64 v32, v6, v112, s[44:45]
    v_mfma_f32_16x16x32_bf16 v[16:19], v[156:159], v[208:211], v[16:19]
    ds_read_b128 v[176:179], v3 offset:6144
    v_cndmask_b32_e64 v33, v6, v112, s[46:47]
    v_cndmask_b32_e64 v34, v6, v112, s[48:49]
    v_mfma_f32_16x16x32_bf16 v[20:23], v[156:159], v[212:215], v[20:23]
    buffer_load_dwordx4 v1, s[12:15], s40 offen offset:1024 lds
    v_mfma_f32_16x16x32_bf16 v[24:27], v[156:159], v[216:219], v[24:27]
    buffer_load_dwordx4 v1, s[12:15], s40 offen offset:2048 lds
    v_mfma_f32_16x16x32_bf16 v[28:31], v[156:159], v[220:223], v[28:31]
    v_cndmask_b32_e64 v35, v6, v112, s[50:51]
    v_cmp_le_i32_e64 s[44:45], -8, v5
    v_cmp_le_i32_e64 s[46:47], -7, v5
    s_waitcnt lgkmcnt(3)
    v_mfma_f32_16x16x32_bf16 v[16:19], v[160:163], v[224:227], v[16:19]
    ds_read_b128 v[180:183], v3 offset:7168
    v_cmp_le_i32_e64 s[48:49], -6, v5
    v_cmp_le_i32_e64 s[50:51], -5, v5
    v_mfma_f32_16x16x32_bf16 v[20:23], v[160:163], v[228:231], v[20:23]
    buffer_load_dwordx4 v1, s[12:15], s40 offen offset:3072 lds
    v_mfma_f32_16x16x32_bf16 v[24:27], v[160:163], v[232:235], v[24:27]
    s_add_u32 m0, m0, 4096
    v_cndmask_b32_e64 v36, v6, v116, s[44:45]
    v_cndmask_b32_e64 v37, v6, v116, s[46:47]
    v_mfma_f32_16x16x32_bf16 v[28:31], v[160:163], v[236:239], v[28:31]
    buffer_load_dwordx4 v2, s[12:15], s40 offen offset:0 lds
    v_mfma_f32_16x16x32_bf16 v[16:19], v[164:167], v[240:243], v[16:19]
    v_cndmask_b32_e64 v38, v6, v116, s[48:49]
    v_cndmask_b32_e64 v39, v6, v116, s[50:51]
    ds_write_b128 v7, v[192:195] offset:0
    v_mfma_f32_16x16x32_bf16 v[20:23], v[164:167], v[244:247], v[20:23]
    buffer_load_dwordx4 v2, s[12:15], s40 offen offset:1024 lds
    v_mfma_f32_16x16x32_bf16 v[24:27], v[164:167], v[248:251], v[24:27]
    v_cmp_le_i32_e64 s[44:45], 0, v5
    v_cmp_le_i32_e64 s[46:47], 1, v5
    v_cmp_le_i32_e64 s[48:49], 2, v5
    v_mfma_f32_16x16x32_bf16 v[28:31], v[164:167], v[252:255], v[28:31]
    buffer_load_dwordx4 v2, s[12:15], s40 offen offset:2048 lds
    s_waitcnt lgkmcnt(3)
    v_mfma_f32_16x16x32_bf16 v[32:35], v[168:171], v[192:195], v[32:35]
    v_cmp_le_i32_e64 s[50:51], 3, v5
    v_cndmask_b32_e64 v56, v6, v120, s[44:45]
    v_cndmask_b32_e64 v57, v6, v120, s[46:47]
    v_mfma_f32_16x16x32_bf16 v[36:39], v[168:171], v[196:199], v[36:39]
    buffer_load_dwordx4 v2, s[12:15], s40 offen offset:3072 lds
    v_mfma_f32_16x16x32_bf16 v[40:43], v[168:171], v[200:203], v[120:123]
    v_cndmask_b32_e64 v58, v6, v120, s[48:49]
    v_cndmask_b32_e64 v59, v6, v120, s[50:51]
    v_cmp_le_i32_e64 s[44:45], -16, v5
    v_mfma_f32_16x16x32_bf16 v[44:47], v[168:171], v[204:207], v[124:127]
    v_cmp_le_i32_e64 s[46:47], -15, v5
    v_cmp_le_i32_e64 s[48:49], -14, v5
    v_cmp_le_i32_e64 s[50:51], -13, v5
    ds_write_b128 v7, v[196:199] offset:1024
    ds_write_b128 v7, v[200:203] offset:2048
    ds_write_b128 v7, v[204:207] offset:3072
    ds_write_b128 v7, v[208:211] offset:4096
    ds_write_b128 v7, v[212:215] offset:5120
    ds_write_b128 v7, v[216:219] offset:6144
    ds_write_b128 v7, v[220:223] offset:7168
    ds_write_b128 v7, v[224:227] offset:8192
    ds_write_b128 v7, v[228:231] offset:9216
    ds_write_b128 v7, v[232:235] offset:10240
    ds_write_b128 v7, v[236:239] offset:11264
    ds_write_b128 v7, v[240:243] offset:12288
    ds_write_b128 v7, v[244:247] offset:13312
    ds_write_b128 v7, v[248:251] offset:14336
    ds_write_b128 v7, v[252:255] offset:15360
    s_waitcnt vmcnt(16) lgkmcnt(0)
    s_barrier
    v_mfma_f32_16x16x32_bf16 v[32:35], v[172:175], v[208:211], v[32:35]
    ds_read_b128 v[152:155], v3 offset:8192
    v_cndmask_b32_e64 v60, v6, v124, s[44:45]
    v_cndmask_b32_e64 v61, v6, v124, s[46:47]
    v_mfma_f32_16x16x32_bf16 v[36:39], v[172:175], v[212:215], v[36:39]
    ds_read_b128 v[156:159], v3 offset:9216
    v_cndmask_b32_e64 v62, v6, v124, s[48:49]
    v_cndmask_b32_e64 v63, v6, v124, s[50:51]
    v_mfma_f32_16x16x32_bf16 v[40:43], v[172:175], v[216:219], v[40:43]
    v_cmp_le_i32_e64 s[44:45], 8, v5
    v_cmp_le_i32_e64 s[46:47], 9, v5
    v_cmp_le_i32_e64 s[48:49], 10, v5
    v_mfma_f32_16x16x32_bf16 v[44:47], v[172:175], v[220:223], v[44:47]
    v_cmp_le_i32_e64 s[50:51], 11, v5
    v_cndmask_b32_e64 v72, v6, v120, s[44:45]
    v_cndmask_b32_e64 v73, v6, v120, s[46:47]
    v_mfma_f32_16x16x32_bf16 v[32:35], v[176:179], v[224:227], v[32:35]
    ds_read_b128 v[160:163], v3 offset:10240
    v_cndmask_b32_e64 v74, v6, v120, s[48:49]
    v_cndmask_b32_e64 v75, v6, v120, s[50:51]
    v_mfma_f32_16x16x32_bf16 v[36:39], v[176:179], v[228:231], v[36:39]
    ds_read_b128 v[164:167], v3 offset:11264
    v_cmp_le_i32_e64 s[44:45], -8, v5
    v_cmp_le_i32_e64 s[46:47], -7, v5
    v_mfma_f32_16x16x32_bf16 v[40:43], v[176:179], v[232:235], v[40:43]
    v_mov_b32 v128, 0
    v_mov_b32 v129, 0
    v_mov_b32 v130, 0
    v_mfma_f32_16x16x32_bf16 v[44:47], v[176:179], v[236:239], v[44:47]
    v_cmp_le_i32_e64 s[48:49], -6, v5
    v_cmp_le_i32_e64 s[50:51], -5, v5
    v_cndmask_b32_e64 v76, v6, v124, s[44:45]
    v_mfma_f32_16x16x32_bf16 v[32:35], v[180:183], v[240:243], v[32:35]
    ds_read_b128 v[168:171], v3 offset:12288
    v_cndmask_b32_e64 v77, v6, v124, s[46:47]
    v_cndmask_b32_e64 v78, v6, v124, s[48:49]
    v_mfma_f32_16x16x32_bf16 v[36:39], v[180:183], v[244:247], v[36:39]
    v_cndmask_b32_e64 v79, v6, v124, s[50:51]
    v_mov_b32 v131, 0
    v_mov_b32 v132, 0
    v_mfma_f32_16x16x32_bf16 v[40:43], v[180:183], v[248:251], v[40:43]
    v_mov_b32 v133, 0
    v_mov_b32 v134, 0
    v_mov_b32 v135, 0
    v_mfma_f32_16x16x32_bf16 v[44:47], v[180:183], v[252:255], v[44:47]
    v_mov_b32 v136, 0
    v_mov_b32 v137, 0
    v_mov_b32 v138, 0
    v_mov_b32 v139, 0
    v_mov_b32 v140, 0
    v_mov_b32 v141, 0
    v_mov_b32 v142, 0
    v_mov_b32 v143, 0
    s_waitcnt lgkmcnt(3)
    v_mfma_f32_16x16x32_bf16 v[56:59], v[152:155], v[200:203], v[56:59]
    ds_read_b128 v[172:175], v3 offset:13312
    v_exp_f32 v184, v16
    v_mfma_f32_16x16x32_bf16 v[60:63], v[152:155], v[204:207], v[60:63]
    buffer_load_dwordx2 v[10:11], v9, s[20:23], 0 offen
    v_mfma_f32_16x16x32_bf16 v[56:59], v[156:159], v[216:219], v[56:59]
    ds_read_b128 v[176:179], v3 offset:14336
    v_add_u32 v9, s69, v9
    v_mfma_f32_16x16x32_bf16 v[60:63], v[156:159], v[220:223], v[60:63]
    v_exp_f32 v185, v17
    s_waitcnt lgkmcnt(3)
    v_mfma_f32_16x16x32_bf16 v[56:59], v[160:163], v[232:235], v[56:59]
    ds_read_b128 v[180:183], v3 offset:15360
    v_exp_f32 v186, v18
    v_mfma_f32_16x16x32_bf16 v[60:63], v[160:163], v[236:239], v[60:63]
    buffer_store_dwordx4 v[148:151], v1, s[64:67], s68 offen sc0 sc1
    v_mfma_f32_16x16x32_bf16 v[56:59], v[164:167], v[248:251], v[56:59]
    v_exp_f32 v187, v19
    v_cvt_pk_bf16_f32 v80, v184, v185
    v_mfma_f32_16x16x32_bf16 v[60:63], v[164:167], v[252:255], v[60:63]
    s_add_u32 s68, s68, 1048576
    v_exp_f32 v188, v20
    s_waitcnt lgkmcnt(2)
    v_mfma_f32_16x16x32_bf16 v[72:75], v[168:171], v[200:203], v[72:75]
    v_exp_f32 v189, v21
    v_cvt_pk_bf16_f32 v81, v186, v187
    v_mfma_f32_16x16x32_bf16 v[76:79], v[168:171], v[204:207], v[76:79]
    v_exp_f32 v190, v22
    v_cvt_pk_bf16_f32 v84, v188, v189
    s_waitcnt vmcnt(10) lgkmcnt(0)
    s_barrier
    v_xor_b32 v3, 81920, v3
    v_mfma_f32_16x16x32_bf16 v[72:75], v[172:175], v[216:219], v[72:75]
    ds_read_b128 v[152:155], v4 offset:0
    v_exp_f32 v191, v23
    v_mfma_f32_16x16x32_bf16 v[76:79], v[172:175], v[220:223], v[76:79]
    ds_read_b128 v[156:159], v4 offset:1024
    v_exp_f32 v184, v24
    v_mfma_f32_16x16x32_bf16 v[72:75], v[176:179], v[232:235], v[72:75]
    ds_read_b128 v[160:163], v4 offset:2048
    v_exp_f32 v185, v25
    v_mfma_f32_16x16x32_bf16 v[76:79], v[176:179], v[236:239], v[76:79]
    ds_read_b128 v[164:167], v4 offset:3072
    v_exp_f32 v186, v26
    v_exp_f32 v187, v27
    v_exp_f32 v188, v28
    v_exp_f32 v189, v29
    v_mfma_f32_16x16x32_bf16 v[72:75], v[180:183], v[248:251], v[72:75]
    ds_read_b128 v[168:171], v4 offset:4096
    v_cvt_pk_bf16_f32 v85, v190, v191
    v_cvt_pk_bf16_f32 v88, v184, v185
    v_exp_f32 v190, v30
    v_exp_f32 v191, v31
    v_exp_f32 v184, v32
    v_exp_f32 v185, v33
    v_cvt_pk_bf16_f32 v89, v186, v187
    v_cvt_pk_bf16_f32 v92, v188, v189
    v_cvt_pk_bf16_f32 v93, v190, v191
    v_cvt_pk_bf16_f32 v82, v184, v185
    v_exp_f32 v186, v34
    v_exp_f32 v187, v35
    v_exp_f32 v188, v36
    v_exp_f32 v189, v37
    v_exp_f32 v190, v38
    v_exp_f32 v191, v39
    v_exp_f32 v184, v40
    v_exp_f32 v185, v41
    v_cvt_pk_bf16_f32 v83, v186, v187
    v_cvt_pk_bf16_f32 v86, v188, v189
    v_cvt_pk_bf16_f32 v87, v190, v191
    v_cvt_pk_bf16_f32 v90, v184, v185
    v_exp_f32 v186, v42
    v_exp_f32 v187, v43
    v_exp_f32 v188, v44
    v_exp_f32 v189, v45
    v_exp_f32 v190, v46
    v_exp_f32 v191, v47
    v_cvt_pk_bf16_f32 v91, v186, v187
    v_cvt_pk_bf16_f32 v94, v188, v189
    v_cvt_pk_bf16_f32 v95, v190, v191
    v_mfma_f32_16x16x32_bf16 v[76:79], v[180:183], v[252:255], v[76:79]
    s_branch K2_S2
K2_REDO:
    s_cmp_lg_u32 s58, 0
    s_cbranch_scc1 K2_OKM0
    v_lshrrev_b32 v0, 4, v1
    s_waitcnt vmcnt(0)
    s_barrier
    s_load_dwordx2 s[32:33], s[0:1], 16
    s_waitcnt lgkmcnt(0)
    s_mov_b32 s4, s32
    s_mov_b32 s5, s33
    s_mov_b32 s6, 0x480000
    s_mov_b32 s7, 0x00020000
    s_and_b32 s38, s2, 7
    s_lshr_b32 s39, s2, 3
    s_and_b32 s26, s39, 7
    s_lshr_b32 s39, s39, 3
    s_lshl_b32 s38, s38, 2
    s_add_u32 s25, s38, s39
    s_sub_u32 s38, 15, s26
    s_cmp_ge_u32 s24, 2
    s_cselect_b32 s39, s26, s38
    s_cselect_b32 s45, s38, s26
    s_and_b32 s44, s24, 1
    s_lshl_b32 s39, s39, 1
    s_add_u32 s39, s39, s44
    s_lshl_b32 s27, s39, 2
    s_lshl_b32 s45, s45, 1
    s_add_u32 s45, s45, 1
    s_sub_u32 s29, s45, s44
    s_lshl_b32 s35, s29, 3
    s_mul_i32 s48, s29, 73728
    s_load_dwordx2 s[54:55], s[0:1], 40
    s_load_dwordx4 s[60:63], s[0:1], 56
    v_lshlrev_b32 v1, 4, v0
    v_lshrrev_b32 v48, 4, v0
    v_lshl_or_b32 v49, v48, 2, s44
    v_and_b32 v50, 15, v0
    v_xor_b32 v49, v49, v50
    s_lshr_b32 s45, s24, 1
    s_lshl_b32 s45, s45, 2
    s_add_u32 s45, s45, s44
    s_lshl_b32 s45, s45, 16
    s_lshl_b32 s46, s25, 8
    s_add_u32 s45, s45, s46
    v_lshlrev_b32 v48, 13, v48
    v_lshl_add_u32 v48, v49, 4, v48
    v_add_u32 v11, s45, v48
    v_add_u32 v12, 31744, v11
    v_add_u32 v13, 129024, v11
    v_add_u32 v14, 160768, v11
    v_mov_b32 v7, v1
    v_add_u32 v8, 18432, v1
    v_add_u32 v9, 36864, v1
    v_add_u32 v10, 55296, v1
    s_lshl_b32 s47, s24, 12
    s_add_u32 s8, s36, 0x2000000
    s_addc_u32 s9, s37, 0
    s_mov_b32 s10, 0x240000
    s_mov_b32 s11, 0x00020000
    s_mov_b32 s49, 0
    s_add_u32 m0, s47, 16384
    s_nop 0
    buffer_load_dwordx4 v11, s[4:7], s49 offen offset:0 lds
    buffer_load_dwordx4 v12, s[4:7], s49 offen offset:1024 lds
    buffer_load_dwordx4 v13, s[4:7], s49 offen offset:2048 lds
    buffer_load_dwordx4 v14, s[4:7], s49 offen offset:3072 lds
    s_add_u32 s50, s48, 0
    buffer_load_dwordx4 v[192:195], v7, s[8:11], s50 offen offset:0
    buffer_load_dwordx4 v[196:199], v8, s[8:11], s50 offen offset:0
    buffer_load_dwordx4 v[200:203], v9, s[8:11], s50 offen offset:0
    buffer_load_dwordx4 v[204:207], v10, s[8:11], s50 offen offset:0
    buffer_load_dwordx4 v[208:211], v7, s[8:11], s50 offen offset:1024
    buffer_load_dwordx4 v[212:215], v8, s[8:11], s50 offen offset:1024
    buffer_load_dwordx4 v[216:219], v9, s[8:11], s50 offen offset:1024
    buffer_load_dwordx4 v[220:223], v10, s[8:11], s50 offen offset:1024
    s_mov_b32 s49, 524288
    s_add_u32 m0, s47, 32768
    s_nop 0
    buffer_load_dwordx4 v11, s[4:7], s49 offen offset:0 lds
    buffer_load_dwordx4 v12, s[4:7], s49 offen offset:1024 lds
    buffer_load_dwordx4 v13, s[4:7], s49 offen offset:2048 lds
    buffer_load_dwordx4 v14, s[4:7], s49 offen offset:3072 lds
    s_add_u32 s50, s48, 2048
    buffer_load_dwordx4 a[0:3], v7, s[8:11], s50 offen offset:0
    buffer_load_dwordx4 a[4:7], v8, s[8:11], s50 offen offset:0
    buffer_load_dwordx4 a[8:11], v9, s[8:11], s50 offen offset:0
    buffer_load_dwordx4 a[12:15], v10, s[8:11], s50 offen offset:0
    buffer_load_dwordx4 a[16:19], v7, s[8:11], s50 offen offset:1024
    buffer_load_dwordx4 a[20:23], v8, s[8:11], s50 offen offset:1024
    buffer_load_dwordx4 a[24:27], v9, s[8:11], s50 offen offset:1024
    buffer_load_dwordx4 a[28:31], v10, s[8:11], s50 offen offset:1024
    s_mov_b32 s49, 1048576
    s_add_u32 m0, s47, 81920
    s_nop 0
    buffer_load_dwordx4 v11, s[4:7], s49 offen offset:0 lds
    buffer_load_dwordx4 v12, s[4:7], s49 offen offset:1024 lds
    buffer_load_dwordx4 v13, s[4:7], s49 offen offset:2048 lds
    buffer_load_dwordx4 v14, s[4:7], s49 offen offset:3072 lds
    s_add_u32 s50, s48, 4096
    buffer_load_dwordx4 a[32:35], v7, s[8:11], s50 offen offset:0
    buffer_load_dwordx4 a[36:39], v8, s[8:11], s50 offen offset:0
    buffer_load_dwordx4 a[40:43], v9, s[8:11], s50 offen offset:0
    buffer_load_dwordx4 a[44:47], v10, s[8:11], s50 offen offset:0
    buffer_load_dwordx4 a[48:51], v7, s[8:11], s50 offen offset:1024
    buffer_load_dwordx4 a[52:55], v8, s[8:11], s50 offen offset:1024
    buffer_load_dwordx4 a[56:59], v9, s[8:11], s50 offen offset:1024
    buffer_load_dwordx4 a[60:63], v10, s[8:11], s50 offen offset:1024
    s_mov_b32 s49, 1572864
    s_add_u32 m0, s47, 98304
    s_nop 0
    buffer_load_dwordx4 v11, s[4:7], s49 offen offset:0 lds
    buffer_load_dwordx4 v12, s[4:7], s49 offen offset:1024 lds
    buffer_load_dwordx4 v13, s[4:7], s49 offen offset:2048 lds
    buffer_load_dwordx4 v14, s[4:7], s49 offen offset:3072 lds
    s_add_u32 s50, s48, 6144
    buffer_load_dwordx4 a[64:67], v7, s[8:11], s50 offen offset:0
    buffer_load_dwordx4 a[68:71], v8, s[8:11], s50 offen offset:0
    buffer_load_dwordx4 a[72:75], v9, s[8:11], s50 offen offset:0
    buffer_load_dwordx4 a[76:79], v10, s[8:11], s50 offen offset:0
    buffer_load_dwordx4 a[80:83], v7, s[8:11], s50 offen offset:1024
    buffer_load_dwordx4 a[84:87], v8, s[8:11], s50 offen offset:1024
    buffer_load_dwordx4 a[88:91], v9, s[8:11], s50 offen offset:1024
    buffer_load_dwordx4 a[92:95], v10, s[8:11], s50 offen offset:1024
    s_lshl_b32 s39, s25, 20
    s_add_u32 s12, s36, s39
    s_addc_u32 s13, s37, 0
    s_add_u32 s14, s38, 1
    s_lshl_b32 s14, s14, 16
    s_mov_b32 s15, 0x00020000
    s_add_u32 s16, s36, 0x2400000
    s_addc_u32 s17, s37, 0
    s_mov_b32 s18, 0x1000000
    s_mov_b32 s19, 0x00020000
    v_add_u32 v2, 4096, v1
    s_lshl_b32 s39, s26, 1
    s_add_u32 s39, s39, s44
    s_sub_u32 s28, 16, s39
    s_mov_b32 s40, 491520
    s_mov_b32 s43, 65536
    s_mov_b32 s42, 16384
    s_mov_b32 s41, 4294926336
    s_cmp_eq_u32 s24, 1
    s_cselect_b32 s40, 540672, s40
    s_cselect_b32 s43, 98304, s43
    s_cselect_b32 s42, 0, s42
    s_cmp_eq_u32 s24, 2
    s_cselect_b32 s40, 540672, s40
    s_cselect_b32 s43, 32768, s43
    s_cselect_b32 s42, 0, s42
    s_cmp_eq_u32 s24, 3
    s_cselect_b32 s40, 557056, s40
    s_cselect_b32 s43, 0, s43
    s_cmp_ge_u32 s24, 2
    s_cselect_b32 s41, 24576, s41
    v_bfe_u32 v48, v0, 4, 1
    v_bfe_u32 v49, v0, 2, 2
    v_lshrrev_b32 v50, 5, v0
    v_lshlrev_b32 v51, 12, v48
    v_lshl_add_u32 v51, v50, 11, v51
    v_lshl_add_u32 v51, v49, 8, v51
    v_lshl_add_u32 v51, v49, 6, v51
    v_lshl_add_u32 v51, v48, 4, v51
    v_bfe_u32 v52, v0, 1, 1
    v_lshl_add_u32 v51, v52, 5, v51
    v_and_b32 v52, 1, v0
    v_lshl_add_u32 v51, v52, 3, v51
    v_and_b32 v52, 15, v0
    v_lshlrev_b32 v50, 4, v50
    v_lshl_add_u32 v50, v48, 2, v50
    v_sub_u32 v5, v52, v50
    v_mov_b32 v6, 0xff800000
    v_add_u32 v3, 0, v1
    v_add_u32 v4, 32768, v1
    s_mov_b32 s52, 0x3e0293ee
    s_mov_b32 s53, 0x3e0293ee
    s_add_u32 s56, s24, 1
    s_bfe_u32 s56, s56, 0x10001
    s_lshl_b32 s57, s56, 15
    s_lshl_b32 s56, s56, 14
    s_add_u32 s56, s56, 131072
    s_mul_i32 s59, s2, 22528
    s_waitcnt lgkmcnt(0)
    s_mov_b32 s22, 4718592
    s_mov_b32 s23, 0x00020000
    s_mov_b32 s20, s54
    s_mov_b32 s21, s55
    s_cmp_eq_u32 s24, 0
    s_cselect_b32 s20, s60, s20
    s_cselect_b32 s21, s61, s21
    s_cselect_b32 s22, 5308416, s22
    s_cmp_eq_u32 s24, 1
    s_cselect_b32 s20, s62, s20
    s_cselect_b32 s21, s63, s21
    s_cselect_b32 s22, 5308416, s22
    s_lshl_b32 s51, s25, 3
    s_add_u32 s51, s51, s26
    s_lshl_b32 s70, s51, 1
    s_add_u32 s70, s70, s44
    s_mul_i32 s71, s70, 9216
    s_cmp_ge_u32 s24, 2
    s_cselect_b32 s59, s71, s59
    s_cselect_b32 s69, 64, 1408
    s_and_b32 s70, s70, 15
    s_lshl_b32 s70, s70, 8
    s_lshr_b32 s71, s51, 5
    s_lshl_b32 s71, s71, 12
    s_add_u32 s70, s70, s71
    s_and_b32 s71, s51, 24
    s_add_u32 s70, s70, s71
    s_add_u32 s70, s70, 262144
    s_add_u32 s64, s36, 0x4300000
    s_addc_u32 s65, s37, 0
    s_mov_b32 s66, 0x1500000
    s_mov_b32 s67, 0x00020000
    v_add_u32 v144, 16384, v51
    v_xor_b32 v145, 16, v144
    v_xor_b32 v146, 64, v144
    v_xor_b32 v147, 80, v144
    v_xor_b32 v148, 128, v144
    v_xor_b32 v149, 144, v144
    v_xor_b32 v150, 192, v144
    v_xor_b32 v151, 208, v144
    v_add_u32 v184, 65536, v144
    v_add_u32 v185, 65536, v145
    v_add_u32 v186, 65536, v146
    v_add_u32 v187, 65536, v147
    v_add_u32 v188, 65536, v148
    v_add_u32 v189, 65536, v149
    v_add_u32 v190, 65536, v150
    v_add_u32 v191, 65536, v151
    s_mov_b32 s58, 1
    s_waitcnt vmcnt(0)
    s_waitcnt vmcnt(40)
    s_barrier
    ds_read_b64_tr_b16 v[152:153], v144 offset:0
    ds_read_b64_tr_b16 v[154:155], v144 offset:1024
    ds_read_b64_tr_b16 v[156:157], v145 offset:0
    ds_read_b64_tr_b16 v[158:159], v145 offset:1024
    ds_read_b64_tr_b16 v[160:161], v146 offset:0
    ds_read_b64_tr_b16 v[162:163], v146 offset:1024
    ds_read_b64_tr_b16 v[164:165], v147 offset:0
    ds_read_b64_tr_b16 v[166:167], v147 offset:1024
    s_branch K2_JOIN
KM_SPK:
    s_mov_b32 s101, 0
KM_SLK:
    s_sleep 8
    buffer_load_dword v224, v230, s[64:67], 0 offen offset:48 sc0 sc1
    s_add_u32 s101, s101, 1
    s_waitcnt vmcnt(0)
    v_cmp_eq_u32 vcc, 3, v224
    s_cmp_eq_u32 s24, 0
    s_cselect_b32 s51, vcc_lo, -1
    s_and_b32 s51, s51, 65535
    s_cmp_eq_u32 s51, 65535
    s_cbranch_scc1 KM_RTK
    s_cmp_lt_u32 s101, 0x8000
    s_cbranch_scc1 KM_SLK
    s_branch KM_RTK
KM_SPX0:
    s_mov_b32 s101, 0
KM_SLX0:
    s_sleep 8
    buffer_load_dwordx4 v[32:35], v38, s[92:95], 0 offen sc0 sc1
    s_add_u32 s101, s101, 1
    s_waitcnt vmcnt(0)
    v_and_b32 v32, v32, v33
    v_and_b32 v32, v32, v34
    v_and_b32 v32, v32, v35
    v_and_b32 v32, 0x01010101, v32
    v_cmp_eq_u32 vcc, 0x01010101, v32
    s_cmp_eq_u32 s24, 0
    s_cselect_b32 s51, vcc_lo, -1
    s_and_b32 s51, s51, 7
    s_cmp_eq_u32 s51, 7
    s_cbranch_scc1 KM_RTX0
    s_cmp_lt_u32 s101, 0x8000
    s_cbranch_scc1 KM_SLX0
    s_branch KM_RTX0
KM_SPX1:
    s_mov_b32 s101, 0
KM_SLX1:
    s_sleep 8
    buffer_load_dwordx4 v[32:35], v38, s[92:95], 0 offen sc0 sc1
    s_add_u32 s101, s101, 1
    s_waitcnt vmcnt(0)
    v_and_b32 v32, v32, v33
    v_and_b32 v32, v32, v34
    v_and_b32 v32, v32, v35
    v_and_b32 v32, 0x01010101, v32
    v_cmp_eq_u32 vcc, 0x01010101, v32
    s_cmp_eq_u32 s24, 0
    s_cselect_b32 s51, vcc_lo, -1
    s_and_b32 s51, s51, 7
    s_cmp_eq_u32 s51, 7
    s_cbranch_scc1 KM_RTX1
    s_cmp_lt_u32 s101, 0x8000
    s_cbranch_scc1 KM_SLX1
    s_branch KM_RTX1
KM_SPZ:
    s_mov_b32 s101, 0
KM_SLZ:
    s_sleep 8
    buffer_load_dwordx4 v[148:151], v145, s[92:95], 0 offen sc0 sc1
    s_add_u32 s101, s101, 1
    s_waitcnt vmcnt(0)
    v_and_b32 v148, v148, v149
    v_and_b32 v150, v150, v151
    v_and_b32 v148, v148, v150
    v_and_b32 v148, 0x02020202, v148
    v_cmp_eq_u32 vcc, 0x02020202, v148
    s_and_b32 s51, vcc_lo, 0xffff
    s_cmp_eq_u32 s51, 0xffff
    s_cbranch_scc1 KM_RTZ
    s_cmp_lt_u32 s101, 0x8000
    s_cbranch_scc1 KM_SLZ
    s_branch KM_RTZ
K2_SAFE:
    s_waitcnt lgkmcnt(0)
    s_mov_b32 s44, 0
    s_lshl_b32 s45, s29, 6
    v_mov_b32 v184, v6
    v_mov_b32 v185, v6
    v_mov_b32 v186, v6
    v_mov_b32 v187, v6
K2_SL:
    s_lshr_b32 s46, s44, 1
    s_lshl_b32 s46, s46, 15
    s_and_b32 s47, s44, 1
    s_lshl_b32 s47, s47, 13
    s_add_u32 s46, s46, s47
    buffer_load_dwordx4 v[152:155], v1, s[12:15], s46 offen offset:0
    buffer_load_dwordx4 v[156:159], v1, s[12:15], s46 offen offset:1024
    buffer_load_dwordx4 v[160:163], v1, s[12:15], s46 offen offset:2048
    buffer_load_dwordx4 v[164:167], v1, s[12:15], s46 offen offset:3072
    buffer_load_dwordx4 v[168:171], v2, s[12:15], s46 offen offset:0
    buffer_load_dwordx4 v[172:175], v2, s[12:15], s46 offen offset:1024
    buffer_load_dwordx4 v[176:179], v2, s[12:15], s46 offen offset:2048
    buffer_load_dwordx4 v[180:183], v2, s[12:15], s46 offen offset:3072
    v_add_u32 v11, s45, v5
    s_waitcnt vmcnt(0)
    v_mfma_f32_16x16x32_bf16 v[16:19], v[152:155], v[192:195], 0
    v_mfma_f32_16x16x32_bf16 v[20:23], v[152:155], v[196:199], 0
    v_mfma_f32_16x16x32_bf16 v[24:27], v[152:155], v[200:203], 0
    v_mfma_f32_16x16x32_bf16 v[28:31], v[152:155], v[204:207], 0
    v_mfma_f32_16x16x32_bf16 v[16:19], v[156:159], v[208:211], v[16:19]
    v_mfma_f32_16x16x32_bf16 v[20:23], v[156:159], v[212:215], v[20:23]
    v_mfma_f32_16x16x32_bf16 v[24:27], v[156:159], v[216:219], v[24:27]
    v_mfma_f32_16x16x32_bf16 v[28:31], v[156:159], v[220:223], v[28:31]
    v_mfma_f32_16x16x32_bf16 v[16:19], v[160:163], v[224:227], v[16:19]
    v_mfma_f32_16x16x32_bf16 v[20:23], v[160:163], v[228:231], v[20:23]
    v_mfma_f32_16x16x32_bf16 v[24:27], v[160:163], v[232:235], v[24:27]
    v_mfma_f32_16x16x32_bf16 v[28:31], v[160:163], v[236:239], v[28:31]
    v_mfma_f32_16x16x32_bf16 v[16:19], v[164:167], v[240:243], v[16:19]
    v_mfma_f32_16x16x32_bf16 v[20:23], v[164:167], v[244:247], v[20:23]
    v_mfma_f32_16x16x32_bf16 v[24:27], v[164:167], v[248:251], v[24:27]
    v_mfma_f32_16x16x32_bf16 v[28:31], v[164:167], v[252:255], v[28:31]
    v_mfma_f32_16x16x32_bf16 v[32:35], v[168:171], v[192:195], 0
    v_mfma_f32_16x16x32_bf16 v[36:39], v[168:171], v[196:199], 0
    v_mfma_f32_16x16x32_bf16 v[40:43], v[168:171], v[200:203], 0
    v_mfma_f32_16x16x32_bf16 v[44:47], v[168:171], v[204:207], 0
    v_mfma_f32_16x16x32_bf16 v[32:35], v[172:175], v[208:211], v[32:35]
    v_mfma_f32_16x16x32_bf16 v[36:39], v[172:175], v[212:215], v[36:39]
    v_mfma_f32_16x16x32_bf16 v[40:43], v[172:175], v[216:219], v[40:43]
    v_mfma_f32_16x16x32_bf16 v[44:47], v[172:175], v[220:223], v[44:47]
    v_mfma_f32_16x16x32_bf16 v[32:35], v[176:179], v[224:227], v[32:35]
    v_mfma_f32_16x16x32_bf16 v[36:39], v[176:179], v[228:231], v[36:39]
    v_mfma_f32_16x16x32_bf16 v[40:43], v[176:179], v[232:235], v[40:43]
    v_mfma_f32_16x16x32_bf16 v[44:47], v[176:179], v[236:239], v[44:47]
    v_mfma_f32_16x16x32_bf16 v[32:35], v[180:183], v[240:243], v[32:35]
    v_mfma_f32_16x16x32_bf16 v[36:39], v[180:183], v[244:247], v[36:39]
    v_mfma_f32_16x16x32_bf16 v[40:43], v[180:183], v[248:251], v[40:43]
    v_mfma_f32_16x16x32_bf16 v[44:47], v[180:183], v[252:255], v[44:47]
    v_cmp_le_i32 vcc, 0, v11
    s_nop 1
    v_cndmask_b32 v16, v6, v16, vcc
    v_max_f32 v184, v184, v16
    v_cmp_le_i32 vcc, 1, v11
    s_nop 1
    v_cndmask_b32 v17, v6, v17, vcc
    v_max_f32 v184, v184, v17
    v_cmp_le_i32 vcc, 2, v11
    s_nop 1
    v_cndmask_b32 v18, v6, v18, vcc
    v_max_f32 v184, v184, v18
    v_cmp_le_i32 vcc, 3, v11
    s_nop 1
    v_cndmask_b32 v19, v6, v19, vcc
    v_max_f32 v184, v184, v19
    v_cmp_le_i32 vcc, -16, v11
    s_nop 1
    v_cndmask_b32 v20, v6, v20, vcc
    v_max_f32 v185, v185, v20
    v_cmp_le_i32 vcc, -15, v11
    s_nop 1
    v_cndmask_b32 v21, v6, v21, vcc
    v_max_f32 v185, v185, v21
    v_cmp_le_i32 vcc, -14, v11
    s_nop 1
    v_cndmask_b32 v22, v6, v22, vcc
    v_max_f32 v185, v185, v22
    v_cmp_le_i32 vcc, -13, v11
    s_nop 1
    v_cndmask_b32 v23, v6, v23, vcc
    v_max_f32 v185, v185, v23
    v_cmp_le_i32 vcc, -32, v11
    s_nop 1
    v_cndmask_b32 v24, v6, v24, vcc
    v_max_f32 v186, v186, v24
    v_cmp_le_i32 vcc, -31, v11
    s_nop 1
    v_cndmask_b32 v25, v6, v25, vcc
    v_max_f32 v186, v186, v25
    v_cmp_le_i32 vcc, -30, v11
    s_nop 1
    v_cndmask_b32 v26, v6, v26, vcc
    v_max_f32 v186, v186, v26
    v_cmp_le_i32 vcc, -29, v11
    s_nop 1
    v_cndmask_b32 v27, v6, v27, vcc
    v_max_f32 v186, v186, v27
    v_cmp_le_i32 vcc, -48, v11
    s_nop 1
    v_cndmask_b32 v28, v6, v28, vcc
    v_max_f32 v187, v187, v28
    v_cmp_le_i32 vcc, -47, v11
    s_nop 1
    v_cndmask_b32 v29, v6, v29, vcc
    v_max_f32 v187, v187, v29
    v_cmp_le_i32 vcc, -46, v11
    s_nop 1
    v_cndmask_b32 v30, v6, v30, vcc
    v_max_f32 v187, v187, v30
    v_cmp_le_i32 vcc, -45, v11
    s_nop 1
    v_cndmask_b32 v31, v6, v31, vcc
    v_max_f32 v187, v187, v31
    v_cmp_le_i32 vcc, 8, v11
    s_nop 1
    v_cndmask_b32 v32, v6, v32, vcc
    v_max_f32 v184, v184, v32
    v_cmp_le_i32 vcc, 9, v11
    s_nop 1
    v_cndmask_b32 v33, v6, v33, vcc
    v_max_f32 v184, v184, v33
    v_cmp_le_i32 vcc, 10, v11
    s_nop 1
    v_cndmask_b32 v34, v6, v34, vcc
    v_max_f32 v184, v184, v34
    v_cmp_le_i32 vcc, 11, v11
    s_nop 1
    v_cndmask_b32 v35, v6, v35, vcc
    v_max_f32 v184, v184, v35
    v_cmp_le_i32 vcc, -8, v11
    s_nop 1
    v_cndmask_b32 v36, v6, v36, vcc
    v_max_f32 v185, v185, v36
    v_cmp_le_i32 vcc, -7, v11
    s_nop 1
    v_cndmask_b32 v37, v6, v37, vcc
    v_max_f32 v185, v185, v37
    v_cmp_le_i32 vcc, -6, v11
    s_nop 1
    v_cndmask_b32 v38, v6, v38, vcc
    v_max_f32 v185, v185, v38
    v_cmp_le_i32 vcc, -5, v11
    s_nop 1
    v_cndmask_b32 v39, v6, v39, vcc
    v_max_f32 v185, v185, v39
    v_cmp_le_i32 vcc, -24, v11
    s_nop 1
    v_cndmask_b32 v40, v6, v40, vcc
    v_max_f32 v186, v186, v40
    v_cmp_le_i32 vcc, -23, v11
    s_nop 1
    v_cndmask_b32 v41, v6, v41, vcc
    v_max_f32 v186, v186, v41
    v_cmp_le_i32 vcc, -22, v11
    s_nop 1
    v_cndmask_b32 v42, v6, v42, vcc
    v_max_f32 v186, v186, v42
    v_cmp_le_i32 vcc, -21, v11
    s_nop 1
    v_cndmask_b32 v43, v6, v43, vcc
    v_max_f32 v186, v186, v43
    v_cmp_le_i32 vcc, -40, v11
    s_nop 1
    v_cndmask_b32 v44, v6, v44, vcc
    v_max_f32 v187, v187, v44
    v_cmp_le_i32 vcc, -39, v11
    s_nop 1
    v_cndmask_b32 v45, v6, v45, vcc
    v_max_f32 v187, v187, v45
    v_cmp_le_i32 vcc, -38, v11
    s_nop 1
    v_cndmask_b32 v46, v6, v46, vcc
    v_max_f32 v187, v187, v46
    v_cmp_le_i32 vcc, -37, v11
    s_nop 1
    v_cndmask_b32 v47, v6, v47, vcc
    v_max_f32 v187, v187, v47
    s_add_u32 s44, s44, 1
    s_sub_u32 s45, s45, 32
    s_cmp_ge_i32 s45, -32
    s_cbranch_scc1 K2_SL
    v_mov_b32 v188, v184
    v_mov_b32 v189, v185
    v_mov_b32 v190, v186
    v_mov_b32 v191, v187
    v_permlane16_swap_b32 v184, v188
    v_permlane16_swap_b32 v185, v189
    v_permlane16_swap_b32 v186, v190
    v_permlane16_swap_b32 v187, v191
    v_max_f32 v184, v184, v188
    v_max_f32 v185, v185, v189
    v_max_f32 v186, v186, v190
    v_max_f32 v187, v187, v191
    v_mov_b32 v188, v184
    v_mov_b32 v189, v185
    v_mov_b32 v190, v186
    v_mov_b32 v191, v187
    v_permlane32_swap_b32 v184, v188
    v_permlane32_swap_b32 v185, v189
    v_permlane32_swap_b32 v186, v190
    v_permlane32_swap_b32 v187, v191
    v_max_f32 v184, v184, v188
    v_max_f32 v185, v185, v189
    v_max_f32 v186, v186, v190
    v_max_f32 v187, v187, v191
    v_sub_f32 v184, 0, v184
    v_sub_f32 v185, 0, v185
    v_sub_f32 v186, 0, v186
    v_sub_f32 v187, 0, v187
    s_lshl_b32 s44, s24, 10
    s_add_u32 s45, s44, 131072
    s_sub_u32 s46, 134144, s44
    v_add_u32 v11, s45, v1
    v_add_u32 v188, s46, v1
    ds_write_b128 v11, v[184:187]
    s_waitcnt lgkmcnt(0)
    s_barrier
    ds_read_b128 v[144:147], v188
    s_waitcnt lgkmcnt(0)
    s_barrier
    s_cmp_ge_u32 s24, 2
    s_cselect_b64 vcc, -1, 0
    v_cndmask_b32 v112, v144, v184, vcc
    v_cndmask_b32 v113, v144, v184, vcc
    v_cndmask_b32 v114, v144, v184, vcc
    v_cndmask_b32 v115, v144, v184, vcc
    v_cndmask_b32 v116, v145, v185, vcc
    v_cndmask_b32 v117, v145, v185, vcc
    v_cndmask_b32 v118, v145, v185, vcc
    v_cndmask_b32 v119, v145, v185, vcc
    v_cndmask_b32 v120, v146, v186, vcc
    v_cndmask_b32 v121, v146, v186, vcc
    v_cndmask_b32 v122, v146, v186, vcc
    v_cndmask_b32 v123, v146, v186, vcc
    v_cndmask_b32 v124, v147, v187, vcc
    v_cndmask_b32 v125, v147, v187, vcc
    v_cndmask_b32 v126, v147, v187, vcc
    v_cndmask_b32 v127, v147, v187, vcc
    ds_read_b128 v[152:155], v3 offset:0
    ds_read_b128 v[156:159], v3 offset:1024
    ds_read_b128 v[160:163], v3 offset:2048
    ds_read_b128 v[164:167], v3 offset:3072
    ds_read_b128 v[168:171], v3 offset:4096
    s_branch K2_GO
K2_END:
    s_endpgm
    .p2align 6
KT_ENTRY:
    v_lshrrev_b32 v0, 4, v1
    v_lshl_add_u32 v104, v0, 20, s34
    v_mov_b32 v105, 7
    v_lshlrev_b32 v106, 20, v0
    s_load_dwordx2 s[8:9], s[0:1], 40
    s_load_dwordx2 s[4:5], s[0:1], 88
    s_load_dwordx2 s[20:21], s[0:1], 0
    s_load_dwordx2 s[12:13], s[0:1], 56
    s_load_dwordx2 s[16:17], s[0:1], 64
    s_load_dwordx2 s[28:29], s[0:1], 72
    s_bfe_u32 s25, s2, 0x20001
    s_bfe_u32 s26, s2, 0x30003
    s_and_b32 s40, s2, 1
    s_lshl_b32 s40, s40, 3
    s_add_u32 s26, s26, s40
    s_lshr_b32 s27, s2, 6
    s_and_b32 s3, s34, 0x7f000000
    s_lshr_b32 s3, s3, 8
    s_add_u32 s3, s3, s25
    s_add_u32 s3, s3, s25
    v_and_b32 v108, 1, v0
    v_lshrrev_b32 v107, 1, v0
    v_lshl_add_u32 v108, v107, 3, v108
    v_add_u32 v108, s3, v108
    v_lshlrev_b32 v108, 8, v108
    buffer_load_dword v107, v108, s[92:95], 0 offen offset:32 sc0 sc1
    v_lshlrev_b32 v1, 4, v0
    v_lshrrev_b32 v18, 3, v0
    v_and_b32 v19, 7, v0
    v_bfe_u32 v20, v0, 4, 1
    v_lshlrev_b32 v21, 2, v20
    v_xor_b32 v255, v19, v21
    v_mul_u32_u24 v18, 1152, v18
    v_lshl_add_u32 v2, v255, 4, v18
    v_add_u32 v3, 8192, v2
    v_add_u32 v4, 16384, v2
    v_add_u32 v5, 24576, v2
    v_and_b32 v19, 15, v0
    v_lshrrev_b32 v21, 5, v0
    v_lshlrev_b32 v20, 17, v20
    v_lshl_add_u32 v20, v21, 8, v20
    v_lshl_add_u32 v15, v19, 4, v20
    s_lshl_b32 s41, s25, 5
    s_add_u32 s42, s41, s24
    s_mul_i32 s32, s42, 36864
    s_lshl_b32 s61, s27, 8
    s_lshl_b32 s43, s25, 6
    s_and_b32 s43, s43, 128
    s_xor_b32 s36, s43, 128
    s_add_u32 s61, s61, s36
    s_add_u32 s32, s32, s61
    s_sub_u32 s36, s43, s36
    s_lshl_b32 s38, s24, 12
    s_lshl_b32 s39, s24, 10
    s_mov_b32 s10, 4718592
    s_mov_b32 s11, 0x00020000
    s_mov_b32 s6, 0x5800000
    s_mov_b32 s7, 0x00020000
    s_lshl_b32 s33, s27, 7
    s_add_u32 s33, s33, s42
    s_lshl_b32 s33, s33, 10
    s_add_u32 s33, s33, 0x4400000
    s_lshl_b32 s37, s26, 2
    s_add_u32 s37, s37, s24
    s_and_b32 s40, s25, 1
    s_lshl_b32 s34, s37, 8
    s_add_u32 s34, s34, s41
    s_lshl_b32 s34, s34, 10
    s_add_u32 s34, s34, 0x2400000
    s_lshl_b32 s58, s25, 13
    s_add_u32 s58, s58, s39
    s_add_u32 s58, s58, 0x4340000
    s_waitcnt lgkmcnt(0)
    s_add_u32 m0, s38, 0
    s_add_u32 s3, s32, 0
    buffer_load_dwordx4 v2, s[8:11], s3 offen offset:0 lds
    buffer_load_dwordx4 v3, s[8:11], s3 offen offset:1024 lds
    buffer_load_dwordx4 v4, s[8:11], s3 offen offset:2048 lds
    buffer_load_dwordx4 v5, s[8:11], s3 offen offset:3072 lds
    s_add_u32 m0, s38, 16384
    s_add_u32 s3, s32, 147456
    buffer_load_dwordx4 v2, s[8:11], s3 offen offset:0 lds
    buffer_load_dwordx4 v3, s[8:11], s3 offen offset:1024 lds
    buffer_load_dwordx4 v4, s[8:11], s3 offen offset:2048 lds
    buffer_load_dwordx4 v5, s[8:11], s3 offen offset:3072 lds
    s_add_u32 m0, s38, 32768
    s_add_u32 s3, s32, 294912
    buffer_load_dwordx4 v2, s[8:11], s3 offen offset:0 lds
    buffer_load_dwordx4 v3, s[8:11], s3 offen offset:1024 lds
    buffer_load_dwordx4 v4, s[8:11], s3 offen offset:2048 lds
    buffer_load_dwordx4 v5, s[8:11], s3 offen offset:3072 lds
    v_lshrrev_b32 v40, 5, v0
    v_bfe_u32 v41, v0, 2, 2
    v_lshl_add_u32 v40, v40, 2, v41
    v_and_b32 v41, 3, v0
    v_lshlrev_b32 v41, 3, v41
    s_lshl_b32 s43, s40, 4
    v_lshl_add_u32 v9, v40, 5, v41
    v_xor_b32 v9, s43, v9
    v_bfe_u32 v103, v0, 4, 1
    v_lshl_add_u32 v41, v103, 5, v41
    v_mul_u32_u24 v42, 31, v103
    v_bfi_b32 v9, v42, 0, v9
    v_lshl_add_u32 v10, v40, 6, v41
    v_lshl_add_u32 v40, v40, 7, v41
    v_bfe_u32 v41, v0, 3, 1
    v_lshl_add_u32 v40, v41, 6, v40
    s_lshl_b32 s43, s40, 6
    v_xor_b32 v7, s43, v40
    v_xor_b32 v8, 64, v7
    s_cmp_lg_u32 s24, 0
    s_cbranch_scc1 KT_GO1
    s_waitcnt vmcnt(12)
    v_cmp_eq_u32 vcc, 0xff, v189
    s_mov_b32 s3, 0
    s_cbranch_vccz KT_CHK1
    buffer_store_dword v105, v106, s[92:95], 0 offen offset:64 sc0 sc1
    s_branch KT_GO1
KT_WAIT1:
    s_sleep 8
    buffer_load_dword v107, v108, s[92:95], 0 offen offset:32 sc0 sc1
    s_add_u32 s3, s3, 1
    s_waitcnt vmcnt(0)
KT_CHK1:
    v_cmp_ne_u32 vcc, 1, v107
    s_cbranch_vccz KT_GO1
    s_cmp_lt_u32 s3, 0x8000
    s_cbranch_scc1 KT_WAIT1
KT_GO1:
    s_mov_b32 s92, 0x4300040
    s_cmp_eq_u32 s24, 0
    s_cselect_b32 s93, 1, 0
    s_barrier
    s_add_u32 m0, s39, 155648
    s_add_u32 s3, s58, 0
    buffer_load_dwordx4 v1, s[4:7], s3 offen sc0 sc1 lds
    s_add_u32 m0, s39, 151552
    s_add_u32 s3, s33, 0
    buffer_load_dwordx4 v1, s[4:7], s3 offen lds
    buffer_load_dwordx4 a[0:3], v15, s[4:7], s34 offen offset:0
    buffer_load_dwordx4 a[4:7], v15, s[4:7], s34 offen offset:512
    buffer_load_dwordx4 a[8:11], v15, s[4:7], s34 offen offset:1024
    buffer_load_dwordx4 a[12:15], v15, s[4:7], s34 offen offset:1536
    buffer_load_dwordx4 a[16:19], v15, s[4:7], s34 offen offset:2048
    buffer_load_dwordx4 a[20:23], v15, s[4:7], s34 offen offset:2560
    buffer_load_dwordx4 a[24:27], v15, s[4:7], s34 offen offset:3072
    buffer_load_dwordx4 a[28:31], v15, s[4:7], s34 offen offset:3584
    s_add_u32 s34, s34, 4096
    s_add_u32 m0, s39, 147456
    s_add_u32 s3, s33, 4096
    buffer_load_dwordx4 v1, s[4:7], s3 offen lds
    buffer_load_dwordx4 a[32:35], v15, s[4:7], s34 offen offset:0
    buffer_load_dwordx4 a[36:39], v15, s[4:7], s34 offen offset:512
    buffer_load_dwordx4 a[40:43], v15, s[4:7], s34 offen offset:1024
    buffer_load_dwordx4 a[44:47], v15, s[4:7], s34 offen offset:1536
    buffer_load_dwordx4 a[48:51], v15, s[4:7], s34 offen offset:2048
    buffer_load_dwordx4 a[52:55], v15, s[4:7], s34 offen offset:2560
    buffer_load_dwordx4 a[56:59], v15, s[4:7], s34 offen offset:3072
    buffer_load_dwordx4 a[60:63], v15, s[4:7], s34 offen offset:3584
    s_add_u32 s34, s34, 4096
    s_waitcnt vmcnt(17)
    s_barrier
    ds_read_b64_tr_b16 v[16:17], v7 offset:0
    ds_read_b64_tr_b16 v[18:19], v7 offset:2048
    ds_read_b64_tr_b16 v[20:21], v8 offset:0
    ds_read_b64_tr_b16 v[22:23], v8 offset:2048
    s_mov_b32 s69, 4096
    v_mad_i32_i24 v9, v103, s69, v9
    v_add_u32 v9, 147456, v9
    ds_read_b64_tr_b16 v[24:25], v9 offset:4096
    ds_read_b64_tr_b16 v[26:27], v9 offset:4608
    ds_read_b64_tr_b16 v[28:29], v7 offset:1024
    ds_read_b64_tr_b16 v[30:31], v7 offset:3072
    ds_read_b64_tr_b16 v[32:33], v8 offset:1024
    ds_read_b64_tr_b16 v[34:35], v8 offset:3072
    s_waitcnt vmcnt(15) lgkmcnt(6)
    v_mfma_f32_32x32x16_bf16 v[104:119], v[16:19], a[0:3], 0
    ds_read_b64_tr_b16 v[36:37], v9 offset:4352
    ds_read_b64_tr_b16 v[38:39], v9 offset:4864
    s_add_u32 m0, s39, 159744
    s_add_u32 s3, s58, 4096
    buffer_load_dwordx4 v1, s[4:7], s3 offen sc0 sc1 lds
    v_mfma_f32_32x32x16_bf16 v[120:135], v[20:23], a[0:3], 0
    ds_read_b64_tr_b16 v[16:17], v7 offset:4096
    ds_read_b64_tr_b16 v[18:19], v7 offset:6144
    s_add_u32 m0, s39, 143360
    s_add_u32 s3, s33, 8192
    buffer_load_dwordx4 v1, s[4:7], s3 offen lds
    s_waitcnt lgkmcnt(6)
    v_mfma_f32_32x32x16_bf16 v[136:151], v[24:27], a[0:3], 0
    ds_read_b64_tr_b16 v[20:21], v8 offset:4096
    ds_read_b64_tr_b16 v[22:23], v8 offset:6144
    buffer_load_dwordx4 a[64:67], v15, s[4:7], s34 offen offset:0
    v_mov_b32 v254, v2
    v_mfma_f32_32x32x16_bf16 v[104:119], v[28:31], a[4:7], v[104:119]
    ds_read_b64_tr_b16 v[24:25], v9 offset:5120
    ds_read_b64_tr_b16 v[26:27], v9 offset:5632
    buffer_load_dwordx4 a[68:71], v15, s[4:7], s34 offen offset:512
    s_mov_b32 s14, 5308416
    s_mov_b32 s15, 0x00020000
    s_waitcnt lgkmcnt(6)
    v_mfma_f32_32x32x16_bf16 v[120:135], v[32:35], a[4:7], v[120:135]
    ds_read_b64_tr_b16 v[28:29], v7 offset:5120
    ds_read_b64_tr_b16 v[30:31], v7 offset:7168
    buffer_load_dwordx4 a[72:75], v15, s[4:7], s34 offen offset:1024
    s_mov_b32 s18, 5308416
    v_mfma_f32_32x32x16_bf16 v[136:151], v[36:39], a[4:7], v[136:151]
    ds_read_b64_tr_b16 v[32:33], v8 offset:5120
    ds_read_b64_tr_b16 v[34:35], v8 offset:7168
    buffer_load_dwordx4 a[76:79], v15, s[4:7], s34 offen offset:1536
    s_mov_b32 s19, 0x00020000
    s_mov_b32 s22, 2359296
    s_waitcnt vmcnt(19) lgkmcnt(6)
    v_mfma_f32_32x32x16_bf16 v[104:119], v[16:19], a[8:11], v[104:119]
    ds_read_b64_tr_b16 v[36:37], v9 offset:5376
    ds_read_b64_tr_b16 v[38:39], v9 offset:5888
    buffer_load_dwordx4 a[80:83], v15, s[4:7], s34 offen offset:2048
    s_mov_b32 s23, 0x00020000
    v_mfma_f32_32x32x16_bf16 v[120:135], v[20:23], a[8:11], v[120:135]
    ds_read_b64_tr_b16 v[16:17], v7 offset:8192
    ds_read_b64_tr_b16 v[18:19], v7 offset:10240
    buffer_load_dwordx4 a[84:87], v15, s[4:7], s34 offen offset:2560
    s_mov_b32 s30, 2359296
    s_mov_b32 s31, 0x00020000
    s_waitcnt lgkmcnt(6)
    v_mfma_f32_32x32x16_bf16 v[136:151], v[24:27], a[8:11], v[136:151]
    ds_read_b64_tr_b16 v[20:21], v8 offset:8192
    ds_read_b64_tr_b16 v[22:23], v8 offset:10240
    buffer_load_dwordx4 a[88:91], v15, s[4:7], s34 offen offset:3072
    s_lshl_b32 s48, s26, 2
    v_mfma_f32_32x32x16_bf16 v[104:119], v[28:31], a[12:15], v[104:119]
    ds_read_b64_tr_b16 v[24:25], v9 offset:6144
    ds_read_b64_tr_b16 v[26:27], v9 offset:6656
    buffer_load_dwordx4 a[92:95], v15, s[4:7], s34 offen offset:3584
    s_add_u32 s34, s34, 4096
    s_add_u32 s48, s48, s27
    s_lshl_b32 s80, s48, 2
    s_waitcnt lgkmcnt(6)
    v_mfma_f32_32x32x16_bf16 v[120:135], v[32:35], a[12:15], v[120:135]
    ds_read_b64_tr_b16 v[28:29], v7 offset:9216
    ds_read_b64_tr_b16 v[30:31], v7 offset:11264
    s_add_u32 s80, s80, s24
    s_lshl_b32 s80, s80, 9
    v_mfma_f32_32x32x16_bf16 v[136:151], v[36:39], a[12:15], v[136:151]
    ds_read_b64_tr_b16 v[32:33], v8 offset:9216
    ds_read_b64_tr_b16 v[34:35], v8 offset:11264
    s_add_u32 s80, s80, 0x4320000
    s_lshl_b32 s43, s25, 7
    s_add_u32 s79, s80, s43
    s_waitcnt vmcnt(21) lgkmcnt(6)
    v_mfma_f32_32x32x16_bf16 v[104:119], v[16:19], a[16:19], v[104:119]
    ds_read_b64_tr_b16 v[36:37], v9 offset:6400
    ds_read_b64_tr_b16 v[38:39], v9 offset:6912
    s_lshl_b32 s81, s37, 10
    s_add_u32 s81, s81, 0x4200000
    v_mfma_f32_32x32x16_bf16 v[120:135], v[20:23], a[16:19], v[120:135]
    ds_read_b64_tr_b16 v[16:17], v7 offset:12288
    ds_read_b64_tr_b16 v[18:19], v7 offset:14336
    s_mul_i32 s48, s48, 110592
    s_lshl_b32 s43, s24, 11
    s_add_u32 s48, s48, s43
    s_waitcnt lgkmcnt(6)
    v_mfma_f32_32x32x16_bf16 v[136:151], v[24:27], a[16:19], v[136:151]
    ds_read_b64_tr_b16 v[20:21], v8 offset:12288
    ds_read_b64_tr_b16 v[22:23], v8 offset:14336
    s_add_u32 s48, s48, 0x4800000
    s_lshr_b32 s77, s24, 1
    v_mfma_f32_32x32x16_bf16 v[104:119], v[28:31], a[20:23], v[104:119]
    ds_read_b64_tr_b16 v[24:25], v9 offset:7168
    ds_read_b64_tr_b16 v[26:27], v9 offset:7680
    s_lshl_b32 s77, s77, 9
    s_add_u32 s77, s77, 8192
    s_sub_u32 s77, s77, s43
    s_waitcnt lgkmcnt(6)
    v_mfma_f32_32x32x16_bf16 v[120:135], v[32:35], a[20:23], v[120:135]
    ds_read_b64_tr_b16 v[28:29], v7 offset:13312
    ds_read_b64_tr_b16 v[30:31], v7 offset:15360
    s_xor_b32 s43, s25, 1
    s_mul_i32 s43, s43, 27648
    v_mfma_f32_32x32x16_bf16 v[136:151], v[36:39], a[20:23], v[136:151]
    ds_read_b64_tr_b16 v[32:33], v8 offset:13312
    ds_read_b64_tr_b16 v[34:35], v8 offset:15360
    s_add_u32 s49, s48, s43
    s_xor_b32 s43, s25, 2
    s_mul_i32 s43, s43, 27648
    s_waitcnt vmcnt(19) lgkmcnt(6)
    v_mfma_f32_32x32x16_bf16 v[104:119], v[16:19], a[24:27], v[104:119]
    ds_read_b64_tr_b16 v[36:37], v9 offset:7424
    ds_read_b64_tr_b16 v[38:39], v9 offset:7936
    s_add_u32 s50, s48, s43
    s_add_u32 s50, s50, 9216
    v_mfma_f32_32x32x16_bf16 v[120:135], v[20:23], a[24:27], v[120:135]
    s_waitcnt vmcnt(18)
    s_barrier
    ds_read_b64_tr_b16 v[16:17], v7 offset:16384
    ds_read_b64_tr_b16 v[18:19], v7 offset:18432
    s_add_u32 m0, s38, 0
    s_add_u32 s3, s32, 442368
    buffer_load_dwordx4 v2, s[8:11], s3 offen offset:0 lds
    s_waitcnt lgkmcnt(6)
    v_mfma_f32_32x32x16_bf16 v[136:151], v[24:27], a[24:27], v[136:151]
    ds_read_b64_tr_b16 v[20:21], v8 offset:16384
    ds_read_b64_tr_b16 v[22:23], v8 offset:18432
    buffer_load_dwordx4 v3, s[8:11], s3 offen offset:1024 lds
    s_xor_b32 s43, s25, 3
    v_mfma_f32_32x32x16_bf16 v[104:119], v[28:31], a[28:31], v[104:119]
    s_mov_b32 s69, 4104
    v_mad_i32_i24 v9, v103, s69, v9
    ds_read_b64_tr_b16 v[24:25], v9 offset:0
    ds_read_b64_tr_b16 v[26:27], v9 offset:512
    buffer_load_dwordx4 v4, s[8:11], s3 offen offset:2048 lds
    s_mul_i32 s43, s43, 27648
    s_add_u32 s51, s48, s43
    s_waitcnt lgkmcnt(6)
    v_mfma_f32_32x32x16_bf16 v[120:135], v[32:35], a[28:31], v[120:135]
    ds_read_b64_tr_b16 v[28:29], v7 offset:17408
    ds_read_b64_tr_b16 v[30:31], v7 offset:19456
    buffer_load_dwordx4 v5, s[8:11], s3 offen offset:3072 lds
    s_add_u32 s51, s51, 18432
    v_mfma_f32_32x32x16_bf16 v[136:151], v[36:39], a[28:31], v[136:151]
    ds_read_b64_tr_b16 v[32:33], v8 offset:17408
    ds_read_b64_tr_b16 v[34:35], v8 offset:19456
    s_add_u32 m0, s39, 151552
    s_add_u32 s3, s33, 12288
    buffer_load_dwordx4 v1, s[4:7], s3 offen lds
    s_waitcnt vmcnt(21) lgkmcnt(6)
    v_mfma_f32_32x32x16_bf16 v[104:119], v[16:19], a[32:35], v[104:119]
    ds_read_b64_tr_b16 v[36:37], v9 offset:256
    ds_read_b64_tr_b16 v[38:39], v9 offset:768
    buffer_load_dwordx4 a[96:99], v15, s[4:7], s34 offen offset:0
    s_mul_i32 s43, s25, 27648
    v_mfma_f32_32x32x16_bf16 v[120:135], v[20:23], a[32:35], v[120:135]
    ds_read_b64_tr_b16 v[16:17], v7 offset:20480
    ds_read_b64_tr_b16 v[18:19], v7 offset:22528
    buffer_load_dwordx4 a[100:103], v15, s[4:7], s34 offen offset:512
    s_add_u32 s48, s48, s43
    s_lshr_b32 s43, s25, 1
    s_waitcnt lgkmcnt(6)
    v_mfma_f32_32x32x16_bf16 v[136:151], v[24:27], a[32:35], v[136:151]
    ds_read_b64_tr_b16 v[20:21], v8 offset:20480
    ds_read_b64_tr_b16 v[22:23], v8 offset:22528
    buffer_load_dwordx4 a[104:107], v15, s[4:7], s34 offen offset:1024
    s_xor_b32 s43, s43, s24
    v_mfma_f32_32x32x16_bf16 v[104:119], v[28:31], a[36:39], v[104:119]
    ds_read_b64_tr_b16 v[24:25], v9 offset:1024
    ds_read_b64_tr_b16 v[26:27], v9 offset:1536
    buffer_load_dwordx4 a[108:111], v15, s[4:7], s34 offen offset:1536
    s_bitcmp0_b32 s43, 0
    s_cselect_b32 s53, s49, s51
    s_waitcnt lgkmcnt(6)
    v_mfma_f32_32x32x16_bf16 v[120:135], v[32:35], a[36:39], v[120:135]
    ds_read_b64_tr_b16 v[28:29], v7 offset:21504
    ds_read_b64_tr_b16 v[30:31], v7 offset:23552
    buffer_load_dwordx4 a[112:115], v15, s[4:7], s34 offen offset:2048
    v_mfma_f32_32x32x16_bf16 v[136:151], v[36:39], a[36:39], v[136:151]
    ds_read_b64_tr_b16 v[32:33], v8 offset:21504
    ds_read_b64_tr_b16 v[34:35], v8 offset:23552
    buffer_load_dwordx4 a[116:119], v15, s[4:7], s34 offen offset:2560
    s_bitcmp0_b32 s43, 0
    s_cselect_b32 s54, 0, 0x7f000000
    s_waitcnt vmcnt(25) lgkmcnt(6)
    v_mfma_f32_32x32x16_bf16 v[104:119], v[16:19], a[40:43], v[104:119]
    ds_read_b64_tr_b16 v[36:37], v9 offset:1280
    ds_read_b64_tr_b16 v[38:39], v9 offset:1792
    buffer_load_dwordx4 a[120:123], v15, s[4:7], s34 offen offset:3072
    v_mfma_f32_32x32x16_bf16 v[120:135], v[20:23], a[40:43], v[120:135]
    ds_read_b64_tr_b16 v[16:17], v7 offset:24576
    ds_read_b64_tr_b16 v[18:19], v7 offset:26624
    buffer_load_dwordx4 a[124:127], v15, s[4:7], s34 offen offset:3584
    s_add_u32 s34, s34, 4096
    s_bitcmp0_b32 s43, 0
    s_cselect_b32 s59, 1.0, 0
    s_waitcnt lgkmcnt(6)
    v_mfma_f32_32x32x16_bf16 v[136:151], v[24:27], a[40:43], v[136:151]
    ds_read_b64_tr_b16 v[20:21], v8 offset:24576
    ds_read_b64_tr_b16 v[22:23], v8 offset:26624
    s_add_u32 s52, s50, s77
    s_add_u32 s53, s53, s77
    v_mfma_f32_32x32x16_bf16 v[104:119], v[28:31], a[44:47], v[104:119]
    ds_read_b64_tr_b16 v[24:25], v9 offset:2048
    ds_read_b64_tr_b16 v[26:27], v9 offset:2560
    s_add_u32 s77, s77, s54
    v_mov_b32 v242, 0x7fffff00
    s_waitcnt lgkmcnt(6)
    v_mfma_f32_32x32x16_bf16 v[120:135], v[32:35], a[44:47], v[120:135]
    ds_read_b64_tr_b16 v[28:29], v7 offset:25600
    ds_read_b64_tr_b16 v[30:31], v7 offset:27648
    v_cmp_eq_u32 vcc, 0, v0
    s_nop 1
    v_cndmask_b32 v11, v242, v0, vcc
    v_mfma_f32_32x32x16_bf16 v[136:151], v[36:39], a[44:47], v[136:151]
    ds_read_b64_tr_b16 v[32:33], v8 offset:25600
    ds_read_b64_tr_b16 v[34:35], v8 offset:27648
    v_cmp_gt_u32 vcc, 32, v0
    s_nop 1
    v_cndmask_b32 v241, v242, v1, vcc
    v_and_b32 v12, 15, v0
    s_waitcnt vmcnt(25) lgkmcnt(6)
    v_mfma_f32_32x32x16_bf16 v[104:119], v[16:19], a[48:51], v[104:119]
    ds_read_b64_tr_b16 v[36:37], v9 offset:2304
    ds_read_b64_tr_b16 v[38:39], v9 offset:2816
    v_lshlrev_b32 v12, 2, v12
    v_lshlrev_b32 v245, 3, v0
    v_mfma_f32_32x32x16_bf16 v[120:135], v[20:23], a[48:51], v[120:135]
    ds_read_b64_tr_b16 v[16:17], v7 offset:28672
    ds_read_b64_tr_b16 v[18:19], v7 offset:30720
    v_add_u32 v239, s77, v245
    s_xor_b32 s41, s54, 0x7f000000
    v_add_u32 v240, s41, v245
    s_waitcnt lgkmcnt(6)
    v_mfma_f32_32x32x16_bf16 v[136:151], v[24:27], a[48:51], v[136:151]
    ds_read_b64_tr_b16 v[20:21], v8 offset:28672
    ds_read_b64_tr_b16 v[22:23], v8 offset:30720
    v_and_b32 v242, 31, v0
    v_lshrrev_b32 v243, 5, v0
    v_mfma_f32_32x32x16_bf16 v[104:119], v[28:31], a[52:55], v[104:119]
    ds_read_b64_tr_b16 v[24:25], v9 offset:3072
    ds_read_b64_tr_b16 v[26:27], v9 offset:3584
    v_mul_u32_u24 v244, 1152, v242
    v_lshl_add_u32 v236, v243, 4, v244
    v_lshl_add_u32 v243, v243, 3, s54
    s_waitcnt lgkmcnt(6)
    v_mfma_f32_32x32x16_bf16 v[120:135], v[32:35], a[52:55], v[120:135]
    ds_read_b64_tr_b16 v[28:29], v7 offset:29696
    ds_read_b64_tr_b16 v[30:31], v7 offset:31744
    v_add_u32 v237, v243, v244
    v_lshl_add_u32 v238, v242, 4, v243
    v_mfma_f32_32x32x16_bf16 v[136:151], v[36:39], a[52:55], v[136:151]
    ds_read_b64_tr_b16 v[32:33], v8 offset:29696
    ds_read_b64_tr_b16 v[34:35], v8 offset:31744
    v_lshlrev_b32 v246, 2, v242
    v_lshlrev_b32 v247, 5, v242
    v_lshlrev_b32 v250, 9, v12
    s_waitcnt vmcnt(23) lgkmcnt(6)
    v_mfma_f32_32x32x16_bf16 v[104:119], v[16:19], a[56:59], v[104:119]
    ds_read_b64_tr_b16 v[36:37], v9 offset:3328
    ds_read_b64_tr_b16 v[38:39], v9 offset:3840
    v_lshrrev_b32 v242, 5, v0
    v_lshl_add_u32 v250, v242, 9, v250
    v_mfma_f32_32x32x16_bf16 v[120:135], v[20:23], a[56:59], v[120:135]
    s_waitcnt vmcnt(21)
    s_barrier
    ds_read_b64_tr_b16 v[16:17], v7 offset:32768
    ds_read_b64_tr_b16 v[18:19], v7 offset:34816
    s_add_u32 m0, s38, 16384
    s_add_u32 s3, s32, 589824
    buffer_load_dwordx4 v2, s[8:11], s3 offen offset:0 lds
    s_waitcnt lgkmcnt(6)
    v_mfma_f32_32x32x16_bf16 v[136:151], v[24:27], a[56:59], v[136:151]
    ds_read_b64_tr_b16 v[20:21], v8 offset:32768
    ds_read_b64_tr_b16 v[22:23], v8 offset:34816
    buffer_load_dwordx4 v3, s[8:11], s3 offen offset:1024 lds
    v_add_u32 v250, 1024, v250
    v_mfma_f32_32x32x16_bf16 v[104:119], v[28:31], a[60:63], v[104:119]
    s_mov_b32 s69, 4104
    v_mad_i32_i24 v9, v103, s69, v9
    v_add_u32 v9, 4294950912, v9
    ds_read_b64_tr_b16 v[24:25], v9 offset:12288
    ds_read_b64_tr_b16 v[26:27], v9 offset:12800
    buffer_load_dwordx4 v4, s[8:11], s3 offen offset:2048 lds
    v_and_b32 v243, 7, v0
    v_lshl_add_u32 v242, v243, 1, v242
    s_waitcnt lgkmcnt(6)
    v_mfma_f32_32x32x16_bf16 v[120:135], v[32:35], a[60:63], v[120:135]
    ds_read_b64_tr_b16 v[28:29], v7 offset:33792
    ds_read_b64_tr_b16 v[30:31], v7 offset:35840
    buffer_load_dwordx4 v5, s[8:11], s3 offen offset:3072 lds
    v_lshlrev_b32 v242, 8, v242
    v_mfma_f32_32x32x16_bf16 v[136:151], v[36:39], a[60:63], v[136:151]
    ds_read_b64_tr_b16 v[32:33], v8 offset:33792
    ds_read_b64_tr_b16 v[34:35], v8 offset:35840
    s_add_u32 m0, s39, 147456
    s_add_u32 s3, s33, 16384
    buffer_load_dwordx4 v1, s[4:7], s3 offen lds
    s_waitcnt vmcnt(24) lgkmcnt(6)
    v_mfma_f32_32x32x16_bf16 v[104:119], v[16:19], a[64:67], v[104:119]
    ds_read_b64_tr_b16 v[36:37], v9 offset:12544
    ds_read_b64_tr_b16 v[38:39], v9 offset:13056
    buffer_load_dwordx4 a[128:131], v15, s[4:7], s34 offen offset:0
    v_add_u32 v242, 32768, v242
    v_mfma_f32_32x32x16_bf16 v[120:135], v[20:23], a[64:67], v[120:135]
    ds_read_b64_tr_b16 v[16:17], v7 offset:36864
    ds_read_b64_tr_b16 v[18:19], v7 offset:38912
    buffer_load_dwordx4 a[132:135], v15, s[4:7], s34 offen offset:512
    v_cmp_eq_u32 vcc, 1, v103
    s_nop 1
    v_cndmask_b32 v250, v250, v242, vcc
    s_waitcnt lgkmcnt(6)
    v_mfma_f32_32x32x16_bf16 v[136:151], v[24:27], a[64:67], v[136:151]
    ds_read_b64_tr_b16 v[20:21], v8 offset:36864
    ds_read_b64_tr_b16 v[22:23], v8 offset:38912
    buffer_load_dwordx4 a[136:139], v15, s[4:7], s34 offen offset:1024
    s_lshl_b32 s41, s27, 2
    v_mfma_f32_32x32x16_bf16 v[104:119], v[28:31], a[68:71], v[104:119]
    ds_read_b64_tr_b16 v[24:25], v9 offset:13312
    ds_read_b64_tr_b16 v[26:27], v9 offset:13824
    buffer_load_dwordx4 a[140:143], v15, s[4:7], s34 offen offset:1536
    s_add_u32 s41, s41, s25
    s_mul_i32 s55, s37, 36864
    s_waitcnt lgkmcnt(6)
    v_mfma_f32_32x32x16_bf16 v[120:135], v[32:35], a[68:71], v[120:135]
    ds_read_b64_tr_b16 v[28:29], v7 offset:37888
    ds_read_b64_tr_b16 v[30:31], v7 offset:39936
    buffer_load_dwordx4 a[144:147], v15, s[4:7], s34 offen offset:2048
    s_add_u32 s74, s55, 0x5580000
    v_mfma_f32_32x32x16_bf16 v[136:151], v[36:39], a[68:71], v[136:151]
    ds_read_b64_tr_b16 v[32:33], v8 offset:37888
    ds_read_b64_tr_b16 v[34:35], v8 offset:39936
    buffer_load_dwordx4 a[148:151], v15, s[4:7], s34 offen offset:2560
    s_lshl_b32 s42, s27, 1
    s_add_u32 s42, s42, s40
    s_waitcnt vmcnt(28) lgkmcnt(6)
    v_mfma_f32_32x32x16_bf16 v[104:119], v[16:19], a[72:75], v[104:119]
    ds_read_b64_tr_b16 v[36:37], v9 offset:13568
    ds_read_b64_tr_b16 v[38:39], v9 offset:14080
    buffer_load_dwordx4 a[152:155], v15, s[4:7], s34 offen offset:3072
    s_add_u32 s42, s42, 64
    v_mfma_f32_32x32x16_bf16 v[120:135], v[20:23], a[72:75], v[120:135]
    ds_read_b64_tr_b16 v[16:17], v7 offset:40960
    ds_read_b64_tr_b16 v[18:19], v7 offset:43008
    buffer_load_dwordx4 a[156:159], v15, s[4:7], s34 offen offset:3584
    s_add_u32 s34, s34, 4096
    s_lshl_b32 s57, s42, 4
    s_add_u32 s57, s57, s55
    s_waitcnt lgkmcnt(6)
    v_mfma_f32_32x32x16_bf16 v[136:151], v[24:27], a[72:75], v[136:151]
    ds_read_b64_tr_b16 v[20:21], v8 offset:40960
    ds_read_b64_tr_b16 v[22:23], v8 offset:43008
    s_lshl_b32 s70, s42, 9
    s_add_u32 s70, s70, s74
    v_mfma_f32_32x32x16_bf16 v[104:119], v[28:31], a[76:79], v[104:119]
    ds_read_b64_tr_b16 v[24:25], v9 offset:14336
    ds_read_b64_tr_b16 v[26:27], v9 offset:14848
    s_lshl_b32 s68, s41, 11
    s_add_u32 s68, s68, s74
    s_lshl_b32 s42, s41, 6
    s_waitcnt lgkmcnt(6)
    v_mfma_f32_32x32x16_bf16 v[120:135], v[32:35], a[76:79], v[120:135]
    ds_read_b64_tr_b16 v[28:29], v7 offset:41984
    ds_read_b64_tr_b16 v[30:31], v7 offset:44032
    s_add_u32 s55, s55, s42
    s_lshl_b32 s76, s37, 12
    v_mfma_f32_32x32x16_bf16 v[136:151], v[36:39], a[76:79], v[136:151]
    ds_read_b64_tr_b16 v[32:33], v8 offset:41984
    ds_read_b64_tr_b16 v[34:35], v8 offset:44032
    s_add_u32 s76, s76, 0x57c0000
    s_lshl_b32 s71, s41, 8
    s_add_u32 s71, s71, s76
    s_waitcnt vmcnt(28) lgkmcnt(6)
    v_mfma_f32_32x32x16_bf16 v[104:119], v[16:19], a[80:83], v[104:119]
    ds_read_b64_tr_b16 v[36:37], v9 offset:14592
    ds_read_b64_tr_b16 v[38:39], v9 offset:15104
    s_lshl_b32 s78, s26, 2
    s_add_u32 s78, s78, s25
    v_mfma_f32_32x32x16_bf16 v[120:135], v[20:23], a[80:83], v[120:135]
    ds_read_b64_tr_b16 v[16:17], v7 offset:45056
    ds_read_b64_tr_b16 v[18:19], v7 offset:47104
    s_lshl_b32 s78, s78, 2
    s_add_u32 s78, s78, s24
    s_lshl_b32 s78, s78, 6
    s_waitcnt lgkmcnt(6)
    v_mfma_f32_32x32x16_bf16 v[136:151], v[24:27], a[80:83], v[136:151]
    ds_read_b64_tr_b16 v[20:21], v8 offset:45056
    ds_read_b64_tr_b16 v[22:23], v8 offset:47104
    s_add_u32 s78, s78, 0x4304000
    s_lshl_b32 s41, s25, 2
    v_mfma_f32_32x32x16_bf16 v[104:119], v[28:31], a[84:87], v[104:119]
    ds_read_b64_tr_b16 v[24:25], v9 offset:15360
    ds_read_b64_tr_b16 v[26:27], v9 offset:15872
    s_add_u32 s41, s41, s27
    s_mul_i32 s41, s41, 576
    s_and_b32 s42, s27, 1
    s_waitcnt lgkmcnt(6)
    v_mfma_f32_32x32x16_bf16 v[120:135], v[32:35], a[84:87], v[120:135]
    ds_read_b64_tr_b16 v[28:29], v7 offset:46080
    ds_read_b64_tr_b16 v[30:31], v7 offset:48128
    s_lshl_b32 s43, s42, 6
    s_add_u32 s43, s43, s41
    v_mfma_f32_32x32x16_bf16 v[136:151], v[36:39], a[84:87], v[136:151]
    ds_read_b64_tr_b16 v[32:33], v8 offset:46080
    ds_read_b64_tr_b16 v[34:35], v8 offset:48128
    s_xor_b32 s42, s42, 1
    s_lshl_b32 s42, s42, 9
    s_add_u32 s42, s42, s41
    s_waitcnt vmcnt(26) lgkmcnt(6)
    v_mfma_f32_32x32x16_bf16 v[104:119], v[16:19], a[88:91], v[104:119]
    ds_read_b64_tr_b16 v[36:37], v9 offset:15616
    ds_read_b64_tr_b16 v[38:39], v9 offset:16128
    s_mov_b32 s44, 0
    v_mfma_f32_32x32x16_bf16 v[120:135], v[20:23], a[88:91], v[120:135]
    s_waitcnt vmcnt(21)
    s_barrier
    ds_read_b64_tr_b16 v[16:17], v7 offset:0
    ds_read_b64_tr_b16 v[18:19], v7 offset:2048
    s_add_u32 m0, s38, 32768
    s_add_u32 s3, s32, 737280
    buffer_load_dwordx4 v2, s[8:11], s3 offen offset:0 lds
    s_waitcnt lgkmcnt(6)
    v_mfma_f32_32x32x16_bf16 v[136:151], v[24:27], a[88:91], v[136:151]
    ds_read_b64_tr_b16 v[20:21], v8 offset:0
    ds_read_b64_tr_b16 v[22:23], v8 offset:2048
    buffer_load_dwordx4 v3, s[8:11], s3 offen offset:1024 lds
    v_mfma_f32_32x32x16_bf16 v[104:119], v[28:31], a[92:95], v[104:119]
    s_mov_b32 s69, 4294959112
    v_mad_i32_i24 v9, v103, s69, v9
    ds_read_b64_tr_b16 v[24:25], v9 offset:20480
    ds_read_b64_tr_b16 v[26:27], v9 offset:20992
    buffer_load_dwordx4 v4, s[8:11], s3 offen offset:2048 lds
    s_cmp_eq_u32 s24, 1
    s_cselect_b32 s44, 128, s44
    s_waitcnt lgkmcnt(6)
    v_mfma_f32_32x32x16_bf16 v[120:135], v[32:35], a[92:95], v[120:135]
    ds_read_b64_tr_b16 v[28:29], v7 offset:1024
    ds_read_b64_tr_b16 v[30:31], v7 offset:3072
    buffer_load_dwordx4 v5, s[8:11], s3 offen offset:3072 lds
    v_mfma_f32_32x32x16_bf16 v[136:151], v[36:39], a[92:95], v[136:151]
    ds_read_b64_tr_b16 v[32:33], v8 offset:1024
    ds_read_b64_tr_b16 v[34:35], v8 offset:3072
    s_add_u32 m0, s39, 143360
    s_add_u32 s3, s33, 20480
    buffer_load_dwordx4 v1, s[4:7], s3 offen lds
    s_waitcnt vmcnt(24) lgkmcnt(6)
    v_mfma_f32_32x32x16_bf16 v[104:119], v[16:19], a[96:99], v[104:119]
    ds_read_b64_tr_b16 v[36:37], v9 offset:20736
    ds_read_b64_tr_b16 v[38:39], v9 offset:21248
    buffer_load_dwordx4 a[160:163], v15, s[4:7], s34 offen offset:0
    v_mfma_f32_32x32x16_bf16 v[120:135], v[20:23], a[96:99], v[120:135]
    ds_read_b64_tr_b16 v[16:17], v7 offset:4096
    ds_read_b64_tr_b16 v[18:19], v7 offset:6144
    buffer_load_dwordx4 a[164:167], v15, s[4:7], s34 offen offset:512
    s_cmp_eq_u32 s24, 2
    s_cselect_b32 s44, 294912, s44
    s_waitcnt lgkmcnt(6)
    v_mfma_f32_32x32x16_bf16 v[136:151], v[24:27], a[96:99], v[136:151]
    ds_read_b64_tr_b16 v[20:21], v8 offset:4096
    ds_read_b64_tr_b16 v[22:23], v8 offset:6144
    buffer_load_dwordx4 a[168:171], v15, s[4:7], s34 offen offset:1024
    v_mfma_f32_32x32x16_bf16 v[104:119], v[28:31], a[100:103], v[104:119]
    ds_read_b64_tr_b16 v[24:25], v9 offset:21504
    ds_read_b64_tr_b16 v[26:27], v9 offset:22016
    buffer_load_dwordx4 a[172:175], v15, s[4:7], s34 offen offset:1536
    s_cmp_eq_u32 s24, 3
    s_cselect_b32 s44, 295040, s44
    s_waitcnt lgkmcnt(6)
    v_mfma_f32_32x32x16_bf16 v[120:135], v[32:35], a[100:103], v[120:135]
    ds_read_b64_tr_b16 v[28:29], v7 offset:5120
    ds_read_b64_tr_b16 v[30:31], v7 offset:7168
    buffer_load_dwordx4 a[176:179], v15, s[4:7], s34 offen offset:2048
    s_add_u32 s44, s44, s43
    v_mfma_f32_32x32x16_bf16 v[136:151], v[36:39], a[100:103], v[136:151]
    ds_read_b64_tr_b16 v[32:33], v8 offset:5120
    ds_read_b64_tr_b16 v[34:35], v8 offset:7168
    buffer_load_dwordx4 a[180:183], v15, s[4:7], s34 offen offset:2560
    s_mul_i32 s45, s24, 294912
    s_add_u32 s45, s45, s43
    s_waitcnt vmcnt(28) lgkmcnt(6)
    v_mfma_f32_32x32x16_bf16 v[104:119], v[16:19], a[104:107], v[104:119]
    ds_read_b64_tr_b16 v[36:37], v9 offset:21760
    ds_read_b64_tr_b16 v[38:39], v9 offset:22272
    buffer_load_dwordx4 a[184:187], v15, s[4:7], s34 offen offset:3072
    s_mov_b32 s46, 0
    v_mfma_f32_32x32x16_bf16 v[120:135], v[20:23], a[104:107], v[120:135]
    ds_read_b64_tr_b16 v[16:17], v7 offset:8192
    ds_read_b64_tr_b16 v[18:19], v7 offset:10240
    buffer_load_dwordx4 a[188:191], v15, s[4:7], s34 offen offset:3584
    s_add_u32 s34, s34, 4096
    s_cmp_eq_u32 s24, 1
    s_cselect_b32 s46, 294912, s46
    s_waitcnt lgkmcnt(6)
    v_mfma_f32_32x32x16_bf16 v[136:151], v[24:27], a[104:107], v[136:151]
    ds_read_b64_tr_b16 v[20:21], v8 offset:8192
    ds_read_b64_tr_b16 v[22:23], v8 offset:10240
    s_cmp_eq_u32 s24, 2
    s_cselect_b32 s46, 4290248832, s46
    v_mfma_f32_32x32x16_bf16 v[104:119], v[28:31], a[108:111], v[104:119]
    ds_read_b64_tr_b16 v[24:25], v9 offset:22528
    ds_read_b64_tr_b16 v[26:27], v9 offset:23040
    s_cmp_eq_u32 s24, 3
    s_cselect_b32 s46, 4290543744, s46
    s_add_u32 s46, s46, s43
    s_waitcnt lgkmcnt(6)
    v_mfma_f32_32x32x16_bf16 v[120:135], v[32:35], a[108:111], v[120:135]
    ds_read_b64_tr_b16 v[28:29], v7 offset:9216
    ds_read_b64_tr_b16 v[30:31], v7 offset:11264
    s_mul_i32 s47, s24, 589824
    s_add_u32 s47, s47, s42
    v_mfma_f32_32x32x16_bf16 v[136:151], v[36:39], a[108:111], v[136:151]
    ds_read_b64_tr_b16 v[32:33], v8 offset:9216
    ds_read_b64_tr_b16 v[34:35], v8 offset:11264
    s_mul_i32 s60, s24, 147456
    s_add_u32 s60, s60, s42
    v_lshrrev_b32 v242, 5, v0
    s_waitcnt vmcnt(28) lgkmcnt(6)
    v_mfma_f32_32x32x16_bf16 v[104:119], v[16:19], a[112:115], v[104:119]
    ds_read_b64_tr_b16 v[36:37], v9 offset:22784
    ds_read_b64_tr_b16 v[38:39], v9 offset:23296
    v_bfe_u32 v243, v0, 3, 2
    v_lshl_add_u32 v243, v242, 3, v243
    v_mfma_f32_32x32x16_bf16 v[120:135], v[20:23], a[112:115], v[120:135]
    ds_read_b64_tr_b16 v[16:17], v7 offset:12288
    ds_read_b64_tr_b16 v[18:19], v7 offset:14336
    v_mul_u32_u24 v243, 9216, v243
    v_lshl_add_u32 v255, v255, 4, v243
    v_bfe_u32 v243, v0, 2, 2
    s_waitcnt lgkmcnt(6)
    v_mfma_f32_32x32x16_bf16 v[136:151], v[24:27], a[112:115], v[136:151]
    ds_read_b64_tr_b16 v[20:21], v8 offset:12288
    ds_read_b64_tr_b16 v[22:23], v8 offset:14336
    v_lshl_add_u32 v242, v242, 2, v243
    v_bfe_u32 v243, v0, 4, 1
    v_mfma_f32_32x32x16_bf16 v[104:119], v[28:31], a[116:119], v[104:119]
    ds_read_b64_tr_b16 v[24:25], v9 offset:23552
    ds_read_b64_tr_b16 v[26:27], v9 offset:24064
    v_lshl_add_u32 v242, v243, 3, v242
    v_mul_u32_u24 v242, 9216, v242
    v_and_b32 v243, 3, v0
    s_waitcnt lgkmcnt(6)
    v_mfma_f32_32x32x16_bf16 v[120:135], v[32:35], a[116:119], v[120:135]
    ds_read_b64_tr_b16 v[28:29], v7 offset:13312
    ds_read_b64_tr_b16 v[30:31], v7 offset:15360
    v_lshl_add_u32 v6, v243, 4, v242
    s_mul_i32 s73, s25, 36
    v_mfma_f32_32x32x16_bf16 v[136:151], v[36:39], a[116:119], v[136:151]
    ds_read_b64_tr_b16 v[32:33], v8 offset:13312
    ds_read_b64_tr_b16 v[34:35], v8 offset:15360
    s_xor_b32 s41, s24, s27
    s_and_b32 s42, s41, 1
    s_xor_b32 s42, s42, 1
    s_waitcnt vmcnt(26) lgkmcnt(6)
    v_mfma_f32_32x32x16_bf16 v[104:119], v[16:19], a[120:123], v[104:119]
    ds_read_b64_tr_b16 v[36:37], v9 offset:23808
    ds_read_b64_tr_b16 v[38:39], v9 offset:24320
    s_lshl_b32 s42, s42, 3
    s_mul_i32 s41, s41, 9
    v_mfma_f32_32x32x16_bf16 v[120:135], v[20:23], a[120:123], v[120:135]
    s_waitcnt vmcnt(21)
    s_barrier
    ds_read_b64_tr_b16 v[16:17], v7 offset:16384
    ds_read_b64_tr_b16 v[18:19], v7 offset:18432
    s_add_u32 m0, s38, 0
    s_add_u32 s3, s32, 884736
    buffer_load_dwordx4 v2, s[8:11], s3 offen offset:0 lds
    s_waitcnt lgkmcnt(6)
    v_mfma_f32_32x32x16_bf16 v[136:151], v[24:27], a[120:123], v[136:151]
    ds_read_b64_tr_b16 v[20:21], v8 offset:16384
    ds_read_b64_tr_b16 v[22:23], v8 offset:18432
    buffer_load_dwordx4 v3, s[8:11], s3 offen offset:1024 lds
    s_add_u32 s41, s41, s42
    v_mfma_f32_32x32x16_bf16 v[104:119], v[28:31], a[124:127], v[104:119]
    s_mov_b32 s69, 8168
    v_mad_i32_i24 v9, v103, s69, v9
    ds_read_b64_tr_b16 v[24:25], v9 offset:16384
    ds_read_b64_tr_b16 v[26:27], v9 offset:16896
    buffer_load_dwordx4 v4, s[8:11], s3 offen offset:2048 lds
    s_add_u32 s41, s41, s73
    s_mul_i32 s42, s27, 144
    s_waitcnt lgkmcnt(6)
    v_mfma_f32_32x32x16_bf16 v[120:135], v[32:35], a[124:127], v[120:135]
    ds_read_b64_tr_b16 v[28:29], v7 offset:17408
    ds_read_b64_tr_b16 v[30:31], v7 offset:19456
    buffer_load_dwordx4 v5, s[8:11], s3 offen offset:3072 lds
    s_add_u32 s42, s42, s41
    v_mfma_f32_32x32x16_bf16 v[136:151], v[36:39], a[124:127], v[136:151]
    ds_read_b64_tr_b16 v[32:33], v8 offset:17408
    ds_read_b64_tr_b16 v[34:35], v8 offset:19456
    s_add_u32 m0, s39, 151552
    s_add_u32 s3, s33, 24576
    buffer_load_dwordx4 v1, s[4:7], s3 offen lds
    s_waitcnt vmcnt(24) lgkmcnt(6)
    v_mfma_f32_32x32x16_bf16 v[104:119], v[16:19], a[128:131], v[104:119]
    ds_read_b64_tr_b16 v[36:37], v9 offset:16640
    ds_read_b64_tr_b16 v[38:39], v9 offset:17152
    buffer_load_dwordx4 a[192:195], v15, s[4:7], s34 offen offset:0
    s_lshl_b32 s42, s42, 10
    v_mfma_f32_32x32x16_bf16 v[120:135], v[20:23], a[128:131], v[120:135]
    ds_read_b64_tr_b16 v[16:17], v7 offset:20480
    ds_read_b64_tr_b16 v[18:19], v7 offset:22528
    buffer_load_dwordx4 a[196:199], v15, s[4:7], s34 offen offset:512
    s_add_u32 s66, s42, 0x4500000
    s_mul_i32 s41, s41, 36864
    s_waitcnt lgkmcnt(6)
    v_mfma_f32_32x32x16_bf16 v[136:151], v[24:27], a[128:131], v[136:151]
    ds_read_b64_tr_b16 v[20:21], v8 offset:20480
    ds_read_b64_tr_b16 v[22:23], v8 offset:22528
    buffer_load_dwordx4 a[200:203], v15, s[4:7], s34 offen offset:1024
    s_add_u32 s63, s61, s41
    v_mfma_f32_32x32x16_bf16 v[104:119], v[28:31], a[132:135], v[104:119]
    ds_read_b64_tr_b16 v[24:25], v9 offset:17408
    ds_read_b64_tr_b16 v[26:27], v9 offset:17920
    buffer_load_dwordx4 a[204:207], v15, s[4:7], s34 offen offset:1536
    s_lshr_b32 s41, s24, 1
    s_xor_b32 s41, s41, s27
    s_waitcnt lgkmcnt(6)
    v_mfma_f32_32x32x16_bf16 v[120:135], v[32:35], a[132:135], v[120:135]
    ds_read_b64_tr_b16 v[28:29], v7 offset:21504
    ds_read_b64_tr_b16 v[30:31], v7 offset:23552
    buffer_load_dwordx4 a[208:211], v15, s[4:7], s34 offen offset:2048
    s_xor_b32 s41, s41, 2
    v_mfma_f32_32x32x16_bf16 v[136:151], v[36:39], a[132:135], v[136:151]
    ds_read_b64_tr_b16 v[32:33], v8 offset:21504
    ds_read_b64_tr_b16 v[34:35], v8 offset:23552
    buffer_load_dwordx4 a[212:215], v15, s[4:7], s34 offen offset:2560
    s_and_b32 s42, s41, 1
    s_and_b32 s43, s24, 1
    s_waitcnt vmcnt(28) lgkmcnt(6)
    v_mfma_f32_32x32x16_bf16 v[104:119], v[16:19], a[136:139], v[104:119]
    ds_read_b64_tr_b16 v[36:37], v9 offset:17664
    ds_read_b64_tr_b16 v[38:39], v9 offset:18176
    buffer_load_dwordx4 a[216:219], v15, s[4:7], s34 offen offset:3072
    s_add_u32 s42, s42, s43
    v_mfma_f32_32x32x16_bf16 v[120:135], v[20:23], a[136:139], v[120:135]
    ds_read_b64_tr_b16 v[16:17], v7 offset:24576
    ds_read_b64_tr_b16 v[18:19], v7 offset:26624
    buffer_load_dwordx4 a[220:223], v15, s[4:7], s34 offen offset:3584
    s_add_u32 s34, s34, 4096
    s_mul_i32 s41, s41, 9
    s_add_u32 s41, s41, s42
    s_waitcnt lgkmcnt(6)
    v_mfma_f32_32x32x16_bf16 v[136:151], v[24:27], a[136:139], v[136:151]
    ds_read_b64_tr_b16 v[20:21], v8 offset:24576
    ds_read_b64_tr_b16 v[22:23], v8 offset:26624
    s_add_u32 s41, s41, s73
    s_mul_i32 s42, s27, 144
    v_mfma_f32_32x32x16_bf16 v[104:119], v[28:31], a[140:143], v[104:119]
    ds_read_b64_tr_b16 v[24:25], v9 offset:18432
    ds_read_b64_tr_b16 v[26:27], v9 offset:18944
    s_add_u32 s42, s42, s41
    s_lshl_b32 s42, s42, 10
    s_add_u32 s65, s42, 0x4500000
    s_waitcnt lgkmcnt(6)
    v_mfma_f32_32x32x16_bf16 v[120:135], v[32:35], a[140:143], v[120:135]
    ds_read_b64_tr_b16 v[28:29], v7 offset:25600
    ds_read_b64_tr_b16 v[30:31], v7 offset:27648
    s_mul_i32 s41, s41, 36864
    s_add_u32 s62, s61, s41
    v_mfma_f32_32x32x16_bf16 v[136:151], v[36:39], a[140:143], v[136:151]
    ds_read_b64_tr_b16 v[32:33], v8 offset:25600
    ds_read_b64_tr_b16 v[34:35], v8 offset:27648
    s_lshr_b32 s41, s24, 1
    s_xor_b32 s41, s41, s27
    s_xor_b32 s41, s41, 0
    s_waitcnt vmcnt(28) lgkmcnt(6)
    v_mfma_f32_32x32x16_bf16 v[104:119], v[16:19], a[144:147], v[104:119]
    ds_read_b64_tr_b16 v[36:37], v9 offset:18688
    ds_read_b64_tr_b16 v[38:39], v9 offset:19200
    s_and_b32 s42, s41, 1
    s_and_b32 s43, s24, 1
    v_mfma_f32_32x32x16_bf16 v[120:135], v[20:23], a[144:147], v[120:135]
    ds_read_b64_tr_b16 v[16:17], v7 offset:28672
    ds_read_b64_tr_b16 v[18:19], v7 offset:30720
    s_add_u32 s42, s42, s43
    s_mul_i32 s41, s41, 9
    s_add_u32 s41, s41, s42
    s_waitcnt lgkmcnt(6)
    v_mfma_f32_32x32x16_bf16 v[136:151], v[24:27], a[144:147], v[136:151]
    ds_read_b64_tr_b16 v[20:21], v8 offset:28672
    ds_read_b64_tr_b16 v[22:23], v8 offset:30720
    s_add_u32 s41, s41, s73
    s_mul_i32 s42, s27, 144
    v_mfma_f32_32x32x16_bf16 v[104:119], v[28:31], a[148:151], v[104:119]
    ds_read_b64_tr_b16 v[24:25], v9 offset:19456
    ds_read_b64_tr_b16 v[26:27], v9 offset:19968
    s_add_u32 s42, s42, s41
    s_lshl_b32 s42, s42, 10
    s_add_u32 s64, s42, 0x4500000
    s_waitcnt lgkmcnt(6)
    v_mfma_f32_32x32x16_bf16 v[120:135], v[32:35], a[148:151], v[120:135]
    ds_read_b64_tr_b16 v[28:29], v7 offset:29696
    ds_read_b64_tr_b16 v[30:31], v7 offset:31744
    s_mul_i32 s41, s41, 36864
    s_add_u32 s61, s61, s41
    v_mfma_f32_32x32x16_bf16 v[136:151], v[36:39], a[148:151], v[136:151]
    ds_read_b64_tr_b16 v[32:33], v8 offset:29696
    ds_read_b64_tr_b16 v[34:35], v8 offset:31744
    s_waitcnt vmcnt(26) lgkmcnt(6)
    v_mfma_f32_32x32x16_bf16 v[104:119], v[16:19], a[152:155], v[104:119]
    ds_read_b64_tr_b16 v[36:37], v9 offset:19712
    ds_read_b64_tr_b16 v[38:39], v9 offset:20224
    v_mfma_f32_32x32x16_bf16 v[120:135], v[20:23], a[152:155], v[120:135]
    s_waitcnt vmcnt(21)
    s_barrier
    ds_read_b64_tr_b16 v[16:17], v7 offset:32768
    ds_read_b64_tr_b16 v[18:19], v7 offset:34816
    s_add_u32 m0, s38, 16384
    s_add_u32 s3, s32, 1032192
    buffer_load_dwordx4 v2, s[8:11], s3 offen offset:0 lds
    s_waitcnt lgkmcnt(6)
    v_mfma_f32_32x32x16_bf16 v[136:151], v[24:27], a[152:155], v[136:151]
    ds_read_b64_tr_b16 v[20:21], v8 offset:32768
    ds_read_b64_tr_b16 v[22:23], v8 offset:34816
    buffer_load_dwordx4 v3, s[8:11], s3 offen offset:1024 lds
    v_mfma_f32_32x32x16_bf16 v[104:119], v[28:31], a[156:159], v[104:119]
    s_mov_b32 s69, 4104
    v_mad_i32_i24 v9, v103, s69, v9
    ds_read_b64_tr_b16 v[24:25], v9 offset:12288
    ds_read_b64_tr_b16 v[26:27], v9 offset:12800
    buffer_load_dwordx4 v4, s[8:11], s3 offen offset:2048 lds
    s_waitcnt lgkmcnt(6)
    v_mfma_f32_32x32x16_bf16 v[120:135], v[32:35], a[156:159], v[120:135]
    ds_read_b64_tr_b16 v[28:29], v7 offset:33792
    ds_read_b64_tr_b16 v[30:31], v7 offset:35840
    buffer_load_dwordx4 v5, s[8:11], s3 offen offset:3072 lds
    v_mfma_f32_32x32x16_bf16 v[136:151], v[36:39], a[156:159], v[136:151]
    ds_read_b64_tr_b16 v[32:33], v8 offset:33792
    ds_read_b64_tr_b16 v[34:35], v8 offset:35840
    s_add_u32 m0, s39, 147456
    s_add_u32 s3, s33, 28672
    buffer_load_dwordx4 v1, s[4:7], s3 offen lds
    s_waitcnt vmcnt(24) lgkmcnt(6)
    v_mfma_f32_32x32x16_bf16 v[104:119], v[16:19], a[160:163], v[104:119]
    ds_read_b64_tr_b16 v[36:37], v9 offset:12544
    ds_read_b64_tr_b16 v[38:39], v9 offset:13056
    buffer_load_dwordx4 a[224:227], v15, s[4:7], s34 offen offset:0
    v_mfma_f32_32x32x16_bf16 v[120:135], v[20:23], a[160:163], v[120:135]
    ds_read_b64_tr_b16 v[16:17], v7 offset:36864
    ds_read_b64_tr_b16 v[18:19], v7 offset:38912
    buffer_load_dwordx4 a[228:231], v15, s[4:7], s34 offen offset:512
    s_waitcnt lgkmcnt(6)
    v_mfma_f32_32x32x16_bf16 v[136:151], v[24:27], a[160:163], v[136:151]
    ds_read_b64_tr_b16 v[20:21], v8 offset:36864
    ds_read_b64_tr_b16 v[22:23], v8 offset:38912
    buffer_load_dwordx4 a[232:235], v15, s[4:7], s34 offen offset:1024
    v_mfma_f32_32x32x16_bf16 v[104:119], v[28:31], a[164:167], v[104:119]
    ds_read_b64_tr_b16 v[24:25], v9 offset:13312
    ds_read_b64_tr_b16 v[26:27], v9 offset:13824
    buffer_load_dwordx4 a[236:239], v15, s[4:7], s34 offen offset:1536
    s_waitcnt lgkmcnt(6)
    v_mfma_f32_32x32x16_bf16 v[120:135], v[32:35], a[164:167], v[120:135]
    ds_read_b64_tr_b16 v[28:29], v7 offset:37888
    ds_read_b64_tr_b16 v[30:31], v7 offset:39936
    buffer_load_dwordx4 a[240:243], v15, s[4:7], s34 offen offset:2048
    v_mfma_f32_32x32x16_bf16 v[136:151], v[36:39], a[164:167], v[136:151]
    ds_read_b64_tr_b16 v[32:33], v8 offset:37888
    ds_read_b64_tr_b16 v[34:35], v8 offset:39936
    buffer_load_dwordx4 a[244:247], v15, s[4:7], s34 offen offset:2560
    s_waitcnt vmcnt(28) lgkmcnt(6)
    v_mfma_f32_32x32x16_bf16 v[104:119], v[16:19], a[168:171], v[104:119]
    ds_read_b64_tr_b16 v[36:37], v9 offset:13568
    ds_read_b64_tr_b16 v[38:39], v9 offset:14080
    buffer_load_dwordx4 a[248:251], v15, s[4:7], s34 offen offset:3072
    v_mfma_f32_32x32x16_bf16 v[120:135], v[20:23], a[168:171], v[120:135]
    ds_read_b64_tr_b16 v[16:17], v7 offset:40960
    ds_read_b64_tr_b16 v[18:19], v7 offset:43008
    buffer_load_dwordx4 a[252:255], v15, s[4:7], s34 offen offset:3584
    s_add_u32 s34, s34, 4096
    s_waitcnt lgkmcnt(6)
    v_mfma_f32_32x32x16_bf16 v[136:151], v[24:27], a[168:171], v[136:151]
    ds_read_b64_tr_b16 v[20:21], v8 offset:40960
    ds_read_b64_tr_b16 v[22:23], v8 offset:43008
    v_mfma_f32_32x32x16_bf16 v[104:119], v[28:31], a[172:175], v[104:119]
    ds_read_b64_tr_b16 v[24:25], v9 offset:14336
    ds_read_b64_tr_b16 v[26:27], v9 offset:14848
    s_waitcnt lgkmcnt(6)
    v_mfma_f32_32x32x16_bf16 v[120:135], v[32:35], a[172:175], v[120:135]
    ds_read_b64_tr_b16 v[28:29], v7 offset:41984
    ds_read_b64_tr_b16 v[30:31], v7 offset:44032
    s_add_u32 s32, s32, s36
    s_add_u32 m0, s38, 49152
    s_add_u32 s3, s32, 0
    buffer_load_dwordx4 v2, s[8:11], s3 offen offset:0 lds
    v_mfma_f32_32x32x16_bf16 v[136:151], v[36:39], a[172:175], v[136:151]
    ds_read_b64_tr_b16 v[32:33], v8 offset:41984
    ds_read_b64_tr_b16 v[34:35], v8 offset:44032
    buffer_load_dwordx4 v3, s[8:11], s3 offen offset:1024 lds
    s_waitcnt vmcnt(30) lgkmcnt(6)
    v_mfma_f32_32x32x16_bf16 v[104:119], v[16:19], a[176:179], v[104:119]
    ds_read_b64_tr_b16 v[36:37], v9 offset:14592
    ds_read_b64_tr_b16 v[38:39], v9 offset:15104
    buffer_load_dwordx4 v4, s[8:11], s3 offen offset:2048 lds
    v_mfma_f32_32x32x16_bf16 v[120:135], v[20:23], a[176:179], v[120:135]
    ds_read_b64_tr_b16 v[16:17], v7 offset:45056
    ds_read_b64_tr_b16 v[18:19], v7 offset:47104
    buffer_load_dwordx4 v5, s[8:11], s3 offen offset:3072 lds
    s_waitcnt lgkmcnt(6)
    v_mfma_f32_32x32x16_bf16 v[136:151], v[24:27], a[176:179], v[136:151]
    ds_read_b64_tr_b16 v[20:21], v8 offset:45056
    ds_read_b64_tr_b16 v[22:23], v8 offset:47104
    s_add_u32 m0, s38, 65536
    s_add_u32 s3, s32, 147456
    buffer_load_dwordx4 v2, s[8:11], s3 offen offset:0 lds
    v_mfma_f32_32x32x16_bf16 v[104:119], v[28:31], a[180:183], v[104:119]
    ds_read_b64_tr_b16 v[24:25], v9 offset:15360
    ds_read_b64_tr_b16 v[26:27], v9 offset:15872
    buffer_load_dwordx4 v3, s[8:11], s3 offen offset:1024 lds
    s_waitcnt lgkmcnt(6)
    v_mfma_f32_32x32x16_bf16 v[120:135], v[32:35], a[180:183], v[120:135]
    ds_read_b64_tr_b16 v[28:29], v7 offset:46080
    ds_read_b64_tr_b16 v[30:31], v7 offset:48128
    buffer_load_dwordx4 v4, s[8:11], s3 offen offset:2048 lds
    v_mfma_f32_32x32x16_bf16 v[136:151], v[36:39], a[180:183], v[136:151]
    ds_read_b64_tr_b16 v[32:33], v8 offset:46080
    ds_read_b64_tr_b16 v[34:35], v8 offset:48128
    buffer_load_dwordx4 v5, s[8:11], s3 offen offset:3072 lds
    s_waitcnt vmcnt(34) lgkmcnt(6)
    v_mfma_f32_32x32x16_bf16 v[104:119], v[16:19], a[184:187], v[104:119]
    ds_read_b64_tr_b16 v[36:37], v9 offset:15616
    ds_read_b64_tr_b16 v[38:39], v9 offset:16128
    s_add_u32 m0, s38, 81920
    s_add_u32 s3, s32, 294912
    buffer_load_dwordx4 v2, s[8:11], s3 offen offset:0 lds
    v_mfma_f32_32x32x16_bf16 v[120:135], v[20:23], a[184:187], v[120:135]
    s_waitcnt vmcnt(30)
    s_barrier
    ds_read_b64_tr_b16 v[16:17], v7 offset:0
    ds_read_b64_tr_b16 v[18:19], v7 offset:2048
    buffer_load_dwordx4 v3, s[8:11], s3 offen offset:1024 lds
    s_waitcnt lgkmcnt(6)
    v_mfma_f32_32x32x16_bf16 v[136:151], v[24:27], a[184:187], v[136:151]
    ds_read_b64_tr_b16 v[20:21], v8 offset:0
    ds_read_b64_tr_b16 v[22:23], v8 offset:2048
    buffer_load_dwordx4 v4, s[8:11], s3 offen offset:2048 lds
    v_mfma_f32_32x32x16_bf16 v[104:119], v[28:31], a[188:191], v[104:119]
    s_mov_b32 s69, 4294959112
    v_mad_i32_i24 v9, v103, s69, v9
    ds_read_b64_tr_b16 v[24:25], v9 offset:20480
    ds_read_b64_tr_b16 v[26:27], v9 offset:20992
    buffer_load_dwordx4 v5, s[8:11], s3 offen offset:3072 lds
    s_waitcnt lgkmcnt(6)
    v_mfma_f32_32x32x16_bf16 v[120:135], v[32:35], a[188:191], v[120:135]
    ds_read_b64_tr_b16 v[28:29], v7 offset:1024
    ds_read_b64_tr_b16 v[30:31], v7 offset:3072
    s_add_u32 m0, s38, 32768
    s_add_u32 s3, s32, 442368
    buffer_load_dwordx4 v2, s[8:11], s3 offen offset:0 lds
    v_mfma_f32_32x32x16_bf16 v[136:151], v[36:39], a[188:191], v[136:151]
    ds_read_b64_tr_b16 v[32:33], v8 offset:1024
    ds_read_b64_tr_b16 v[34:35], v8 offset:3072
    buffer_load_dwordx4 v3, s[8:11], s3 offen offset:1024 lds
    s_waitcnt vmcnt(33) lgkmcnt(6)
    v_mfma_f32_32x32x16_bf16 v[104:119], v[16:19], a[192:195], v[104:119]
    ds_read_b64_tr_b16 v[36:37], v9 offset:20736
    ds_read_b64_tr_b16 v[38:39], v9 offset:21248
    buffer_load_dwordx4 v4, s[8:11], s3 offen offset:2048 lds
    v_mfma_f32_32x32x16_bf16 v[120:135], v[20:23], a[192:195], v[120:135]
    ds_read_b64_tr_b16 v[16:17], v7 offset:4096
    ds_read_b64_tr_b16 v[18:19], v7 offset:6144
    buffer_load_dwordx4 v5, s[8:11], s3 offen offset:3072 lds
    s_waitcnt lgkmcnt(6)
    v_mfma_f32_32x32x16_bf16 v[136:151], v[24:27], a[192:195], v[136:151]
    ds_read_b64_tr_b16 v[20:21], v8 offset:4096
    ds_read_b64_tr_b16 v[22:23], v8 offset:6144
    s_add_u32 m0, s38, 98304
    s_add_u32 s3, s32, 589824
    buffer_load_dwordx4 v2, s[8:11], s3 offen offset:0 lds
    v_mfma_f32_32x32x16_bf16 v[104:119], v[28:31], a[196:199], v[104:119]
    ds_read_b64_tr_b16 v[24:25], v9 offset:21504
    ds_read_b64_tr_b16 v[26:27], v9 offset:22016
    buffer_load_dwordx4 v3, s[8:11], s3 offen offset:1024 lds
    s_waitcnt lgkmcnt(6)
    v_mfma_f32_32x32x16_bf16 v[120:135], v[32:35], a[196:199], v[120:135]
    ds_read_b64_tr_b16 v[28:29], v7 offset:5120
    ds_read_b64_tr_b16 v[30:31], v7 offset:7168
    buffer_load_dwordx4 v4, s[8:11], s3 offen offset:2048 lds
    v_mfma_f32_32x32x16_bf16 v[136:151], v[36:39], a[196:199], v[136:151]
    ds_read_b64_tr_b16 v[32:33], v8 offset:5120
    ds_read_b64_tr_b16 v[34:35], v8 offset:7168
    buffer_load_dwordx4 v5, s[8:11], s3 offen offset:3072 lds
    s_waitcnt vmcnt(37) lgkmcnt(6)
    v_mfma_f32_32x32x16_bf16 v[104:119], v[16:19], a[200:203], v[104:119]
    ds_read_b64_tr_b16 v[36:37], v9 offset:21760
    ds_read_b64_tr_b16 v[38:39], v9 offset:22272
    buffer_load_dword v13, v12, s[4:7], s92 offen sc0 sc1
    v_mfma_f32_32x32x16_bf16 v[120:135], v[20:23], a[200:203], v[120:135]
    ds_read_b64_tr_b16 v[16:17], v7 offset:8192
    ds_read_b64_tr_b16 v[18:19], v7 offset:10240
    s_add_u32 m0, s38, 114688
    s_add_u32 s3, s32, 737280
    buffer_load_dwordx4 v2, s[8:11], s3 offen offset:0 lds
    s_waitcnt lgkmcnt(6)
    v_mfma_f32_32x32x16_bf16 v[136:151], v[24:27], a[200:203], v[136:151]
    ds_read_b64_tr_b16 v[20:21], v8 offset:8192
    ds_read_b64_tr_b16 v[22:23], v8 offset:10240
    buffer_load_dwordx4 v3, s[8:11], s3 offen offset:1024 lds
    v_mfma_f32_32x32x16_bf16 v[104:119], v[28:31], a[204:207], v[104:119]
    ds_read_b64_tr_b16 v[24:25], v9 offset:22528
    ds_read_b64_tr_b16 v[26:27], v9 offset:23040
    buffer_load_dwordx4 v4, s[8:11], s3 offen offset:2048 lds
    s_waitcnt lgkmcnt(6)
    v_mfma_f32_32x32x16_bf16 v[120:135], v[32:35], a[204:207], v[120:135]
    ds_read_b64_tr_b16 v[28:29], v7 offset:9216
    ds_read_b64_tr_b16 v[30:31], v7 offset:11264
    buffer_load_dwordx4 v5, s[8:11], s3 offen offset:3072 lds
    v_mfma_f32_32x32x16_bf16 v[136:151], v[36:39], a[204:207], v[136:151]
    ds_read_b64_tr_b16 v[32:33], v8 offset:9216
    ds_read_b64_tr_b16 v[34:35], v8 offset:11264
    s_add_u32 m0, s38, 131072
    s_add_u32 s3, s32, 884736
    buffer_load_dwordx4 v2, s[8:11], s3 offen offset:0 lds
    s_waitcnt vmcnt(41) lgkmcnt(6)
    v_mfma_f32_32x32x16_bf16 v[104:119], v[16:19], a[208:211], v[104:119]
    ds_read_b64_tr_b16 v[36:37], v9 offset:22784
    ds_read_b64_tr_b16 v[38:39], v9 offset:23296
    buffer_load_dwordx4 v3, s[8:11], s3 offen offset:1024 lds
    v_mfma_f32_32x32x16_bf16 v[120:135], v[20:23], a[208:211], v[120:135]
    ds_read_b64_tr_b16 v[16:17], v7 offset:12288
    ds_read_b64_tr_b16 v[18:19], v7 offset:14336
    buffer_load_dwordx4 v4, s[8:11], s3 offen offset:2048 lds
    s_waitcnt lgkmcnt(6)
    v_mfma_f32_32x32x16_bf16 v[136:151], v[24:27], a[208:211], v[136:151]
    ds_read_b64_tr_b16 v[20:21], v8 offset:12288
    ds_read_b64_tr_b16 v[22:23], v8 offset:14336
    buffer_load_dwordx4 v5, s[8:11], s3 offen offset:3072 lds
    v_mfma_f32_32x32x16_bf16 v[104:119], v[28:31], a[212:215], v[104:119]
    ds_read_b64_tr_b16 v[24:25], v9 offset:23552
    ds_read_b64_tr_b16 v[26:27], v9 offset:24064
    s_waitcnt lgkmcnt(6)
    v_mfma_f32_32x32x16_bf16 v[120:135], v[32:35], a[212:215], v[120:135]
    ds_read_b64_tr_b16 v[28:29], v7 offset:13312
    ds_read_b64_tr_b16 v[30:31], v7 offset:15360
    v_mfma_f32_32x32x16_bf16 v[136:151], v[36:39], a[212:215], v[136:151]
    ds_read_b64_tr_b16 v[32:33], v8 offset:13312
    ds_read_b64_tr_b16 v[34:35], v8 offset:15360
    s_waitcnt vmcnt(42) lgkmcnt(6)
    v_mfma_f32_32x32x16_bf16 v[104:119], v[16:19], a[216:219], v[104:119]
    ds_read_b64_tr_b16 v[36:37], v9 offset:23808
    ds_read_b64_tr_b16 v[38:39], v9 offset:24320
    v_mfma_f32_32x32x16_bf16 v[120:135], v[20:23], a[216:219], v[120:135]
    s_waitcnt vmcnt(37)
    s_barrier
    ds_read_b64_tr_b16 v[16:17], v7 offset:16384
    ds_read_b64_tr_b16 v[18:19], v7 offset:18432
    s_add_u32 m0, s38, 0
    s_add_u32 s3, s32, 1032192
    buffer_load_dwordx4 v2, s[8:11], s3 offen offset:0 lds
    s_waitcnt lgkmcnt(6)
    v_mfma_f32_32x32x16_bf16 v[136:151], v[24:27], a[216:219], v[136:151]
    ds_read_b64_tr_b16 v[20:21], v8 offset:16384
    ds_read_b64_tr_b16 v[22:23], v8 offset:18432
    buffer_load_dwordx4 v3, s[8:11], s3 offen offset:1024 lds
    v_mfma_f32_32x32x16_bf16 v[104:119], v[28:31], a[220:223], v[104:119]
    s_mov_b32 s69, 4104
    v_mad_i32_i24 v9, v103, s69, v9
    ds_read_b64_tr_b16 v[24:25], v9 offset:16384
    ds_read_b64_tr_b16 v[26:27], v9 offset:16896
    buffer_load_dwordx4 v4, s[8:11], s3 offen offset:2048 lds
    s_waitcnt lgkmcnt(6)
    v_mfma_f32_32x32x16_bf16 v[120:135], v[32:35], a[220:223], v[120:135]
    ds_read_b64_tr_b16 v[28:29], v7 offset:17408
    ds_read_b64_tr_b16 v[30:31], v7 offset:19456
    buffer_load_dwordx4 v5, s[8:11], s3 offen offset:3072 lds
    v_mfma_f32_32x32x16_bf16 v[136:151], v[36:39], a[220:223], v[136:151]
    ds_read_b64_tr_b16 v[32:33], v8 offset:17408
    ds_read_b64_tr_b16 v[34:35], v8 offset:19456
    s_mul_i32 s43, s37, 144
    s_add_u32 s43, s43, s73
    s_xor_b32 s41, s27, 0
    s_waitcnt vmcnt(39) lgkmcnt(6)
    v_mfma_f32_32x32x16_bf16 v[104:119], v[16:19], a[224:227], v[104:119]
    ds_read_b64_tr_b16 v[36:37], v9 offset:16640
    ds_read_b64_tr_b16 v[38:39], v9 offset:17152
    s_and_b32 s42, s41, 1
    s_mul_i32 s41, s41, 9
    v_mfma_f32_32x32x16_bf16 v[120:135], v[20:23], a[224:227], v[120:135]
    ds_read_b64_tr_b16 v[16:17], v7 offset:20480
    ds_read_b64_tr_b16 v[18:19], v7 offset:22528
    s_add_u32 s41, s41, s42
    s_add_u32 s41, s41, s43
    s_lshl_b32 s32, s41, 11
    s_waitcnt lgkmcnt(6)
    v_mfma_f32_32x32x16_bf16 v[136:151], v[24:27], a[224:227], v[136:151]
    ds_read_b64_tr_b16 v[20:21], v8 offset:20480
    ds_read_b64_tr_b16 v[22:23], v8 offset:22528
    s_xor_b32 s41, s27, 1
    s_and_b32 s42, s41, 1
    v_mfma_f32_32x32x16_bf16 v[104:119], v[28:31], a[228:231], v[104:119]
    ds_read_b64_tr_b16 v[24:25], v9 offset:17408
    ds_read_b64_tr_b16 v[26:27], v9 offset:17920
    s_mul_i32 s41, s41, 9
    s_add_u32 s41, s41, s42
    s_add_u32 s41, s41, s43
    s_waitcnt lgkmcnt(6)
    v_mfma_f32_32x32x16_bf16 v[120:135], v[32:35], a[228:231], v[120:135]
    ds_read_b64_tr_b16 v[28:29], v7 offset:21504
    ds_read_b64_tr_b16 v[30:31], v7 offset:23552
    s_lshl_b32 s33, s41, 11
    s_xor_b32 s41, s27, 2
    v_mfma_f32_32x32x16_bf16 v[136:151], v[36:39], a[228:231], v[136:151]
    ds_read_b64_tr_b16 v[32:33], v8 offset:21504
    ds_read_b64_tr_b16 v[34:35], v8 offset:23552
    s_and_b32 s42, s41, 1
    s_mul_i32 s41, s41, 9
    s_add_u32 s41, s41, s42
    s_waitcnt vmcnt(37) lgkmcnt(6)
    v_mfma_f32_32x32x16_bf16 v[104:119], v[16:19], a[232:235], v[104:119]
    ds_read_b64_tr_b16 v[36:37], v9 offset:17664
    ds_read_b64_tr_b16 v[38:39], v9 offset:18176
    s_add_u32 s41, s41, s43
    s_lshl_b32 s34, s41, 11
    v_mfma_f32_32x32x16_bf16 v[120:135], v[20:23], a[232:235], v[120:135]
    ds_read_b64_tr_b16 v[16:17], v7 offset:24576
    ds_read_b64_tr_b16 v[18:19], v7 offset:26624
    s_xor_b32 s41, s27, 3
    s_and_b32 s42, s41, 1
    s_mul_i32 s41, s41, 9
    s_waitcnt lgkmcnt(6)
    v_mfma_f32_32x32x16_bf16 v[136:151], v[24:27], a[232:235], v[136:151]
    ds_read_b64_tr_b16 v[20:21], v8 offset:24576
    ds_read_b64_tr_b16 v[22:23], v8 offset:26624
    s_add_u32 s41, s41, s42
    s_add_u32 s41, s41, s43
    v_mfma_f32_32x32x16_bf16 v[104:119], v[28:31], a[236:239], v[104:119]
    ds_read_b64_tr_b16 v[24:25], v9 offset:18432
    ds_read_b64_tr_b16 v[26:27], v9 offset:18944
    s_lshl_b32 s35, s41, 11
    s_waitcnt lgkmcnt(6)
    v_mfma_f32_32x32x16_bf16 v[120:135], v[32:35], a[236:239], v[120:135]
    ds_read_b64_tr_b16 v[28:29], v7 offset:25600
    ds_read_b64_tr_b16 v[30:31], v7 offset:27648
    v_mfma_f32_32x32x16_bf16 v[136:151], v[36:39], a[236:239], v[136:151]
    ds_read_b64_tr_b16 v[32:33], v8 offset:25600
    ds_read_b64_tr_b16 v[34:35], v8 offset:27648
    s_waitcnt vmcnt(35) lgkmcnt(6)
    v_mfma_f32_32x32x16_bf16 v[104:119], v[16:19], a[240:243], v[104:119]
    ds_read_b64_tr_b16 v[36:37], v9 offset:18688
    ds_read_b64_tr_b16 v[38:39], v9 offset:19200
    buffer_load_dwordx4 v[216:219], v236, s[20:23], s55 offen offset:0
    v_mfma_f32_32x32x16_bf16 v[120:135], v[20:23], a[240:243], v[120:135]
    ds_read_b64_tr_b16 v[16:17], v7 offset:28672
    ds_read_b64_tr_b16 v[18:19], v7 offset:30720
    s_waitcnt lgkmcnt(6)
    v_mfma_f32_32x32x16_bf16 v[136:151], v[24:27], a[240:243], v[136:151]
    ds_read_b64_tr_b16 v[20:21], v8 offset:28672
    ds_read_b64_tr_b16 v[22:23], v8 offset:30720
    v_mfma_f32_32x32x16_bf16 v[104:119], v[28:31], a[244:247], v[104:119]
    ds_read_b64_tr_b16 v[24:25], v9 offset:19456
    ds_read_b64_tr_b16 v[26:27], v9 offset:19968
    buffer_load_dwordx4 v[220:223], v236, s[20:23], s55 offen offset:32
    s_waitcnt lgkmcnt(6)
    v_mfma_f32_32x32x16_bf16 v[120:135], v[32:35], a[244:247], v[120:135]
    ds_read_b64_tr_b16 v[28:29], v7 offset:29696
    ds_read_b64_tr_b16 v[30:31], v7 offset:31744
    s_waitcnt vmcnt(14)
    v_cmp_gt_u32 vcc, 7, v13
    s_and_b32 vcc_lo, vcc_lo, s93
    s_cbranch_scc1 KT_SLOW0
KT_BACK0:
    v_mfma_f32_32x32x16_bf16 v[136:151], v[36:39], a[244:247], v[136:151]
    ds_read_b64_tr_b16 v[32:33], v8 offset:29696
    ds_read_b64_tr_b16 v[34:35], v8 offset:31744
    s_waitcnt lgkmcnt(6)
    v_mfma_f32_32x32x16_bf16 v[104:119], v[16:19], a[248:251], v[104:119]
    ds_read_b64_tr_b16 v[36:37], v9 offset:19712
    ds_read_b64_tr_b16 v[38:39], v9 offset:20224
    buffer_load_dwordx2 v[224:225], v237, s[20:23], s57 offen
    v_mfma_f32_32x32x16_bf16 v[120:135], v[20:23], a[248:251], v[120:135]
    s_barrier
    ds_read_b64_tr_b16 v[16:17], v8 offset:49152
    ds_read_b64_tr_b16 v[18:19], v8 offset:51200
    s_waitcnt lgkmcnt(6)
    v_mfma_f32_32x32x16_bf16 v[136:151], v[24:27], a[248:251], v[136:151]
    ds_read_b64_tr_b16 v[20:21], v8 offset:50176
    ds_read_b64_tr_b16 v[22:23], v8 offset:52224
    v_mfma_f32_32x32x16_bf16 v[104:119], v[28:31], a[252:255], v[104:119]
    ds_read_b64_tr_b16 v[24:25], v8 offset:53248
    ds_read_b64_tr_b16 v[26:27], v8 offset:55296
    buffer_load_dword v94, v247, s[4:7], s81 offen
    s_waitcnt lgkmcnt(6)
    v_mfma_f32_32x32x16_bf16 v[120:135], v[32:35], a[252:255], v[120:135]
    ds_read_b64_tr_b16 v[28:29], v8 offset:54272
    ds_read_b64_tr_b16 v[30:31], v8 offset:56320
    v_mfma_f32_32x32x16_bf16 v[136:151], v[36:39], a[252:255], v[136:151]
    ds_read_b64_tr_b16 v[32:33], v8 offset:57344
    ds_read_b64_tr_b16 v[34:35], v8 offset:59392
    s_waitcnt lgkmcnt(6)
    v_mfma_f32_32x32x16_bf16 v[152:167], v[16:19], a[0:3], 0
    ds_read_b64_tr_b16 v[36:37], v8 offset:58368
    ds_read_b64_tr_b16 v[38:39], v8 offset:60416
    v_mfma_f32_32x32x16_bf16 v[152:167], v[20:23], a[4:7], v[152:167]
    ds_read_b64_tr_b16 v[16:17], v8 offset:61440
    ds_read_b64_tr_b16 v[18:19], v8 offset:63488
    v_cvt_pk_f16_f32 v104, v104, v105
    v_cvt_pk_f16_f32 v105, v106, v107
    v_cvt_pk_f16_f32 v106, v108, v109
    s_waitcnt lgkmcnt(6)
    v_mfma_f32_32x32x16_bf16 v[152:167], v[24:27], a[8:11], v[152:167]
    ds_read_b64_tr_b16 v[20:21], v8 offset:62464
    ds_read_b64_tr_b16 v[22:23], v8 offset:64512
    v_cvt_pk_f16_f32 v107, v110, v111
    v_cvt_pk_f16_f32 v108, v112, v113
    v_mfma_f32_32x32x16_bf16 v[152:167], v[28:31], a[12:15], v[152:167]
    v_add_u32 v8, 65536, v8
    ds_read_b64_tr_b16 v[24:25], v8 offset:0
    ds_read_b64_tr_b16 v[26:27], v8 offset:2048
    v_cvt_pk_f16_f32 v109, v114, v115
    v_cvt_pk_f16_f32 v110, v116, v117
    v_cvt_pk_f16_f32 v111, v118, v119
    s_waitcnt lgkmcnt(6)
    v_mfma_f32_32x32x16_bf16 v[152:167], v[32:35], a[16:19], v[152:167]
    ds_read_b64_tr_b16 v[28:29], v8 offset:1024
    ds_read_b64_tr_b16 v[30:31], v8 offset:3072
    v_cvt_pk_f16_f32 v120, v120, v121
    v_cvt_pk_f16_f32 v121, v122, v123
    v_mfma_f32_32x32x16_bf16 v[152:167], v[36:39], a[20:23], v[152:167]
    ds_read_b64_tr_b16 v[32:33], v8 offset:4096
    ds_read_b64_tr_b16 v[34:35], v8 offset:6144
    v_cvt_pk_f16_f32 v122, v124, v125
    v_cvt_pk_f16_f32 v123, v126, v127
    v_cvt_pk_f16_f32 v124, v128, v129
    s_waitcnt lgkmcnt(6)
    v_mfma_f32_32x32x16_bf16 v[152:167], v[16:19], a[24:27], v[152:167]
    ds_read_b64_tr_b16 v[36:37], v8 offset:5120
    ds_read_b64_tr_b16 v[38:39], v8 offset:7168
    buffer_store_dwordx4 v[104:107], v1, s[4:7], s50 offen offset:0 sc0 sc1
    v_cvt_pk_f16_f32 v125, v130, v131
    v_mfma_f32_32x32x16_bf16 v[152:167], v[20:23], a[28:31], v[152:167]
    ds_read_b64_tr_b16 v[16:17], v8 offset:8192
    ds_read_b64_tr_b16 v[18:19], v8 offset:10240
    v_cvt_pk_f16_f32 v126, v132, v133
    v_cvt_pk_f16_f32 v127, v134, v135
    v_cvt_pk_f16_f32 v148, v136, v137
    s_waitcnt lgkmcnt(6)
    v_mfma_f32_32x32x16_bf16 v[152:167], v[24:27], a[32:35], v[152:167]
    ds_read_b64_tr_b16 v[20:21], v8 offset:9216
    ds_read_b64_tr_b16 v[22:23], v8 offset:11264
    v_cvt_pk_f16_f32 v149, v138, v139
    v_cvt_pk_f16_f32 v150, v140, v141
    v_add_u32 v2, 0, v255
    v_add_u32 v3, 35840, v255
    v_add_u32 v4, 145408, v255
    v_add_u32 v5, 181248, v255
    s_add_u32 m0, s38, 16384
    s_add_u32 s3, s44, 0
    buffer_load_dwordx4 v2, s[12:15], s3 offen offset:0 lds
    v_mfma_f32_32x32x16_bf16 v[152:167], v[28:31], a[36:39], v[152:167]
    ds_read_b64_tr_b16 v[24:25], v8 offset:12288
    ds_read_b64_tr_b16 v[26:27], v8 offset:14336
    v_cvt_pk_f16_f32 v151, v142, v143
    v_add_f32 v144, v144, v145
    v_add_f32 v146, v146, v147
    s_waitcnt lgkmcnt(6)
    v_mfma_f32_32x32x16_bf16 v[152:167], v[32:35], a[40:43], v[152:167]
    ds_read_b64_tr_b16 v[28:29], v8 offset:13312
    ds_read_b64_tr_b16 v[30:31], v8 offset:15360
    v_add_f32 v146, v146, v144
    v_lshrrev_b32 v145, 2, v241
    v_mfma_f32_32x32x16_bf16 v[152:167], v[36:39], a[44:47], v[152:167]
    s_barrier
    ds_read_b64_tr_b16 v[32:33], v8 offset:16384
    ds_read_b64_tr_b16 v[34:35], v8 offset:18432
    buffer_load_dwordx4 v3, s[12:15], s3 offen offset:1024 lds
    s_waitcnt lgkmcnt(6)
    v_mfma_f32_32x32x16_bf16 v[152:167], v[16:19], a[48:51], v[152:167]
    ds_read_b64_tr_b16 v[36:37], v8 offset:17408
    ds_read_b64_tr_b16 v[38:39], v8 offset:19456
    buffer_store_dwordx4 v[108:111], v1, s[4:7], s50 offen offset:1024 sc0 sc1
    v_mfma_f32_32x32x16_bf16 v[152:167], v[20:23], a[52:55], v[152:167]
    ds_read_b64_tr_b16 v[16:17], v8 offset:20480
    ds_read_b64_tr_b16 v[18:19], v8 offset:22528
    s_waitcnt lgkmcnt(6)
    v_mfma_f32_32x32x16_bf16 v[152:167], v[24:27], a[56:59], v[152:167]
    ds_read_b64_tr_b16 v[20:21], v8 offset:21504
    ds_read_b64_tr_b16 v[22:23], v8 offset:23552
    buffer_load_dwordx4 v4, s[12:15], s3 offen offset:2048 lds
    v_mfma_f32_32x32x16_bf16 v[152:167], v[28:31], a[60:63], v[152:167]
    ds_read_b64_tr_b16 v[24:25], v8 offset:24576
    ds_read_b64_tr_b16 v[26:27], v8 offset:26624
    s_waitcnt lgkmcnt(6)
    v_mfma_f32_32x32x16_bf16 v[152:167], v[32:35], a[64:67], v[152:167]
    ds_read_b64_tr_b16 v[28:29], v8 offset:25600
    ds_read_b64_tr_b16 v[30:31], v8 offset:27648
    v_mfma_f32_32x32x16_bf16 v[152:167], v[36:39], a[68:71], v[152:167]
    ds_read_b64_tr_b16 v[32:33], v8 offset:28672
    ds_read_b64_tr_b16 v[34:35], v8 offset:30720
    buffer_load_dwordx4 v5, s[12:15], s3 offen offset:3072 lds
    s_waitcnt lgkmcnt(6)
    v_mfma_f32_32x32x16_bf16 v[152:167], v[16:19], a[72:75], v[152:167]
    ds_read_b64_tr_b16 v[36:37], v8 offset:29696
    ds_read_b64_tr_b16 v[38:39], v8 offset:31744
    buffer_store_dwordx4 v[120:123], v1, s[4:7], s51 offen offset:0 sc0 sc1
    v_mfma_f32_32x32x16_bf16 v[152:167], v[20:23], a[76:79], v[152:167]
    v_add_u32 v8, 4294934528, v8
    ds_read_b64_tr_b16 v[16:17], v8 offset:0
    ds_read_b64_tr_b16 v[18:19], v8 offset:2048
    s_waitcnt lgkmcnt(6)
    v_mfma_f32_32x32x16_bf16 v[152:167], v[24:27], a[80:83], v[152:167]
    ds_read_b64_tr_b16 v[20:21], v8 offset:1024
    ds_read_b64_tr_b16 v[22:23], v8 offset:3072
    s_add_u32 m0, s38, 147456
    s_add_u32 s3, s44, 589824
    buffer_load_dwordx4 v2, s[12:15], s3 offen offset:0 lds
    v_mfma_f32_32x32x16_bf16 v[152:167], v[28:31], a[84:87], v[152:167]
    ds_read_b64_tr_b16 v[24:25], v8 offset:4096
    ds_read_b64_tr_b16 v[26:27], v8 offset:6144
    s_waitcnt lgkmcnt(6)
    v_mfma_f32_32x32x16_bf16 v[152:167], v[32:35], a[88:91], v[152:167]
    ds_read_b64_tr_b16 v[28:29], v8 offset:5120
    ds_read_b64_tr_b16 v[30:31], v8 offset:7168
    v_mfma_f32_32x32x16_bf16 v[152:167], v[36:39], a[92:95], v[152:167]
    ds_read_b64_tr_b16 v[32:33], v8 offset:8192
    ds_read_b64_tr_b16 v[34:35], v8 offset:10240
    buffer_load_dwordx4 v3, s[12:15], s3 offen offset:1024 lds
    s_waitcnt lgkmcnt(6)
    v_mfma_f32_32x32x16_bf16 v[152:167], v[16:19], a[96:99], v[152:167]
    ds_read_b64_tr_b16 v[36:37], v8 offset:9216
    ds_read_b64_tr_b16 v[38:39], v8 offset:11264
    buffer_store_dwordx4 v[124:127], v1, s[4:7], s51 offen offset:1024 sc0 sc1
    v_mfma_f32_32x32x16_bf16 v[152:167], v[20:23], a[100:103], v[152:167]
    ds_read_b64_tr_b16 v[16:17], v8 offset:12288
    ds_read_b64_tr_b16 v[18:19], v8 offset:14336
    s_waitcnt lgkmcnt(6)
    v_mfma_f32_32x32x16_bf16 v[152:167], v[24:27], a[104:107], v[152:167]
    ds_read_b64_tr_b16 v[20:21], v8 offset:13312
    ds_read_b64_tr_b16 v[22:23], v8 offset:15360
    buffer_load_dwordx4 v4, s[12:15], s3 offen offset:2048 lds
    v_mfma_f32_32x32x16_bf16 v[152:167], v[28:31], a[108:111], v[152:167]
    s_waitcnt vmcnt(23)
    s_barrier
    v_add_u32 v8, 65536, v8
    ds_read_b64_tr_b16 v[24:25], v8 offset:0
    ds_read_b64_tr_b16 v[26:27], v8 offset:2048
    s_waitcnt lgkmcnt(6)
    v_mfma_f32_32x32x16_bf16 v[152:167], v[32:35], a[112:115], v[152:167]
    ds_read_b64_tr_b16 v[28:29], v8 offset:1024
    ds_read_b64_tr_b16 v[30:31], v8 offset:3072
    v_mfma_f32_32x32x16_bf16 v[152:167], v[36:39], a[116:119], v[152:167]
    ds_read_b64_tr_b16 v[32:33], v8 offset:4096
    ds_read_b64_tr_b16 v[34:35], v8 offset:6144
    buffer_load_dwordx4 v5, s[12:15], s3 offen offset:3072 lds
    s_waitcnt lgkmcnt(6)
    v_mfma_f32_32x32x16_bf16 v[152:167], v[16:19], a[120:123], v[152:167]
    ds_read_b64_tr_b16 v[36:37], v8 offset:5120
    ds_read_b64_tr_b16 v[38:39], v8 offset:7168
    buffer_store_dwordx2 v[148:149], v240, s[4:7], s52 offen offset:0 sc0 sc1
    v_mfma_f32_32x32x16_bf16 v[152:167], v[20:23], a[124:127], v[152:167]
    ds_read_b64_tr_b16 v[16:17], v8 offset:8192
    ds_read_b64_tr_b16 v[18:19], v8 offset:10240
    s_waitcnt lgkmcnt(6)
    v_mfma_f32_32x32x16_bf16 v[152:167], v[24:27], a[128:131], v[152:167]
    ds_read_b64_tr_b16 v[20:21], v8 offset:9216
    ds_read_b64_tr_b16 v[22:23], v8 offset:11264
    v_mfma_f32_32x32x16_bf16 v[152:167], v[28:31], a[132:135], v[152:167]
    ds_read_b64_tr_b16 v[24:25], v8 offset:12288
    ds_read_b64_tr_b16 v[26:27], v8 offset:14336
    s_waitcnt lgkmcnt(6)
    v_mfma_f32_32x32x16_bf16 v[152:167], v[32:35], a[136:139], v[152:167]
    ds_read_b64_tr_b16 v[28:29], v8 offset:13312
    ds_read_b64_tr_b16 v[30:31], v8 offset:15360
    v_mfma_f32_32x32x16_bf16 v[152:167], v[36:39], a[140:143], v[152:167]
    ds_read_b64_tr_b16 v[32:33], v8 offset:16384
    ds_read_b64_tr_b16 v[34:35], v8 offset:18432
    s_waitcnt lgkmcnt(6)
    v_mfma_f32_32x32x16_bf16 v[152:167], v[16:19], a[144:147], v[152:167]
    ds_read_b64_tr_b16 v[36:37], v8 offset:17408
    ds_read_b64_tr_b16 v[38:39], v8 offset:19456
    buffer_store_dwordx2 v[150:151], v245, s[4:7], s53 offen offset:0 sc0 sc1
    v_mfma_f32_32x32x16_bf16 v[152:167], v[20:23], a[148:151], v[152:167]
    ds_read_b64_tr_b16 v[16:17], v8 offset:20480
    ds_read_b64_tr_b16 v[18:19], v8 offset:22528
    s_waitcnt lgkmcnt(6)
    v_mfma_f32_32x32x16_bf16 v[152:167], v[24:27], a[152:155], v[152:167]
    ds_read_b64_tr_b16 v[20:21], v8 offset:21504
    ds_read_b64_tr_b16 v[22:23], v8 offset:23552
    v_mfma_f32_32x32x16_bf16 v[152:167], v[28:31], a[156:159], v[152:167]
    ds_read_b64_tr_b16 v[24:25], v8 offset:24576
    ds_read_b64_tr_b16 v[26:27], v8 offset:26624
    s_waitcnt lgkmcnt(6)
    v_mfma_f32_32x32x16_bf16 v[152:167], v[32:35], a[160:163], v[152:167]
    ds_read_b64_tr_b16 v[28:29], v8 offset:25600
    ds_read_b64_tr_b16 v[30:31], v8 offset:27648
    v_mfma_f32_32x32x16_bf16 v[152:167], v[36:39], a[164:167], v[152:167]
    ds_read_b64_tr_b16 v[32:33], v8 offset:28672
    ds_read_b64_tr_b16 v[34:35], v8 offset:30720
    s_waitcnt lgkmcnt(6)
    v_mfma_f32_32x32x16_bf16 v[152:167], v[16:19], a[168:171], v[152:167]
    ds_read_b64_tr_b16 v[36:37], v8 offset:29696
    ds_read_b64_tr_b16 v[38:39], v8 offset:31744
    buffer_store_dword v146, v145, s[4:7], s79 offen offset:0 sc0 sc1
    v_mfma_f32_32x32x16_bf16 v[152:167], v[20:23], a[172:175], v[152:167]
    s_waitcnt vmcnt(19)
    s_barrier
    ds_read_b64_tr_b16 v[16:17], v8 offset:32768
    ds_read_b64_tr_b16 v[18:19], v8 offset:34816
    s_waitcnt lgkmcnt(6)
    v_mfma_f32_32x32x16_bf16 v[152:167], v[24:27], a[176:179], v[152:167]
    ds_read_b64_tr_b16 v[20:21], v8 offset:33792
    ds_read_b64_tr_b16 v[22:23], v8 offset:35840
    v_mfma_f32_32x32x16_bf16 v[152:167], v[28:31], a[180:183], v[152:167]
    ds_read_b64_tr_b16 v[24:25], v8 offset:36864
    ds_read_b64_tr_b16 v[26:27], v8 offset:38912
    s_waitcnt lgkmcnt(6)
    v_mfma_f32_32x32x16_bf16 v[152:167], v[32:35], a[184:187], v[152:167]
    ds_read_b64_tr_b16 v[28:29], v8 offset:37888
    ds_read_b64_tr_b16 v[30:31], v8 offset:39936
    v_mfma_f32_32x32x16_bf16 v[152:167], v[36:39], a[188:191], v[152:167]
    ds_read_b64_tr_b16 v[32:33], v8 offset:40960
    ds_read_b64_tr_b16 v[34:35], v8 offset:43008
    s_waitcnt lgkmcnt(6)
    v_mfma_f32_32x32x16_bf16 v[152:167], v[16:19], a[192:195], v[152:167]
    ds_read_b64_tr_b16 v[36:37], v8 offset:41984
    ds_read_b64_tr_b16 v[38:39], v8 offset:44032
    v_mfma_f32_32x32x16_bf16 v[152:167], v[20:23], a[196:199], v[152:167]
    ds_read_b64_tr_b16 v[16:17], v8 offset:45056
    ds_read_b64_tr_b16 v[18:19], v8 offset:47104
    s_waitcnt lgkmcnt(6)
    v_mfma_f32_32x32x16_bf16 v[152:167], v[24:27], a[200:203], v[152:167]
    ds_read_b64_tr_b16 v[20:21], v8 offset:46080
    ds_read_b64_tr_b16 v[22:23], v8 offset:48128
    v_mfma_f32_32x32x16_bf16 v[152:167], v[28:31], a[204:207], v[152:167]
    v_add_u32 v8, 4294868992, v8
    ds_read_b64_tr_b16 v[24:25], v8 offset:0
    ds_read_b64_tr_b16 v[26:27], v8 offset:2048
    s_waitcnt lgkmcnt(6)
    v_mfma_f32_32x32x16_bf16 v[152:167], v[32:35], a[208:211], v[152:167]
    ds_read_b64_tr_b16 v[28:29], v8 offset:1024
    ds_read_b64_tr_b16 v[30:31], v8 offset:3072
    v_mfma_f32_32x32x16_bf16 v[152:167], v[36:39], a[212:215], v[152:167]
    ds_read_b64_tr_b16 v[32:33], v8 offset:4096
    ds_read_b64_tr_b16 v[34:35], v8 offset:6144
    s_waitcnt lgkmcnt(6)
    v_mfma_f32_32x32x16_bf16 v[152:167], v[16:19], a[216:219], v[152:167]
    ds_read_b64_tr_b16 v[36:37], v8 offset:5120
    ds_read_b64_tr_b16 v[38:39], v8 offset:7168
    v_mfma_f32_32x32x16_bf16 v[152:167], v[20:23], a[220:223], v[152:167]
    ds_read_b64_tr_b16 v[16:17], v8 offset:8192
    ds_read_b64_tr_b16 v[18:19], v8 offset:10240
    s_waitcnt lgkmcnt(6)
    v_mfma_f32_32x32x16_bf16 v[152:167], v[24:27], a[224:227], v[152:167]
    ds_read_b64_tr_b16 v[20:21], v8 offset:9216
    ds_read_b64_tr_b16 v[22:23], v8 offset:11264
    v_mfma_f32_32x32x16_bf16 v[152:167], v[28:31], a[228:231], v[152:167]
    ds_read_b64_tr_b16 v[24:25], v8 offset:12288
    ds_read_b64_tr_b16 v[26:27], v8 offset:14336
    s_waitcnt lgkmcnt(6)
    v_mfma_f32_32x32x16_bf16 v[152:167], v[32:35], a[232:235], v[152:167]
    ds_read_b64_tr_b16 v[28:29], v8 offset:13312
    ds_read_b64_tr_b16 v[30:31], v8 offset:15360
    v_mfma_f32_32x32x16_bf16 v[152:167], v[36:39], a[236:239], v[152:167]
    ds_read_b64_tr_b16 v[32:33], v7 offset:49152
    ds_read_b64_tr_b16 v[34:35], v7 offset:51200
    s_waitcnt lgkmcnt(6)
    v_mfma_f32_32x32x16_bf16 v[152:167], v[16:19], a[240:243], v[152:167]
    ds_read_b64_tr_b16 v[36:37], v7 offset:50176
    ds_read_b64_tr_b16 v[38:39], v7 offset:52224
    v_mfma_f32_32x32x16_bf16 v[152:167], v[20:23], a[244:247], v[152:167]
    ds_read_b64_tr_b16 v[16:17], v7 offset:53248
    ds_read_b64_tr_b16 v[18:19], v7 offset:55296
    s_waitcnt lgkmcnt(6)
    v_mfma_f32_32x32x16_bf16 v[152:167], v[24:27], a[248:251], v[152:167]
    ds_read_b64_tr_b16 v[20:21], v7 offset:54272
    ds_read_b64_tr_b16 v[22:23], v7 offset:56320
    v_mfma_f32_32x32x16_bf16 v[152:167], v[28:31], a[252:255], v[152:167]
    ds_read_b64_tr_b16 v[24:25], v7 offset:57344
    ds_read_b64_tr_b16 v[26:27], v7 offset:59392
    s_waitcnt lgkmcnt(6)
    v_mfma_f32_32x32x16_bf16 v[168:183], v[32:35], a[0:3], 0
    ds_read_b64_tr_b16 v[28:29], v7 offset:58368
    ds_read_b64_tr_b16 v[30:31], v7 offset:60416
    v_mfma_f32_32x32x16_bf16 v[168:183], v[36:39], a[4:7], v[168:183]
    ds_read_b64_tr_b16 v[32:33], v7 offset:61440
    ds_read_b64_tr_b16 v[34:35], v7 offset:63488
    s_waitcnt lgkmcnt(6)
    v_mfma_f32_32x32x16_bf16 v[168:183], v[16:19], a[8:11], v[168:183]
    ds_read_b64_tr_b16 v[36:37], v7 offset:62464
    ds_read_b64_tr_b16 v[38:39], v7 offset:64512
    v_cvt_pk_f16_f32 v152, v152, v153
    v_cvt_pk_f16_f32 v153, v154, v155
    v_mfma_f32_32x32x16_bf16 v[168:183], v[20:23], a[12:15], v[168:183]
    v_add_u32 v7, 65536, v7
    ds_read_b64_tr_b16 v[16:17], v7 offset:0
    ds_read_b64_tr_b16 v[18:19], v7 offset:2048
    v_cvt_pk_f16_f32 v154, v156, v157
    v_cvt_pk_f16_f32 v155, v158, v159
    v_cvt_pk_f16_f32 v156, v160, v161
    s_waitcnt lgkmcnt(6)
    v_mfma_f32_32x32x16_bf16 v[168:183], v[24:27], a[16:19], v[168:183]
    ds_read_b64_tr_b16 v[20:21], v7 offset:1024
    ds_read_b64_tr_b16 v[22:23], v7 offset:3072
    v_cvt_pk_f16_f32 v157, v162, v163
    v_cvt_pk_f16_f32 v158, v164, v165
    v_mfma_f32_32x32x16_bf16 v[168:183], v[28:31], a[20:23], v[168:183]
    ds_read_b64_tr_b16 v[24:25], v7 offset:4096
    ds_read_b64_tr_b16 v[26:27], v7 offset:6144
    v_cvt_pk_f16_f32 v159, v166, v167
    s_waitcnt lgkmcnt(6)
    v_mfma_f32_32x32x16_bf16 v[168:183], v[32:35], a[24:27], v[168:183]
    ds_read_b64_tr_b16 v[28:29], v7 offset:5120
    ds_read_b64_tr_b16 v[30:31], v7 offset:7168
    buffer_store_dwordx4 v[152:155], v1, s[4:7], s49 offen offset:0 sc0 sc1
    v_mfma_f32_32x32x16_bf16 v[168:183], v[36:39], a[28:31], v[168:183]
    ds_read_b64_tr_b16 v[32:33], v7 offset:8192
    ds_read_b64_tr_b16 v[34:35], v7 offset:10240
    s_waitcnt lgkmcnt(6)
    v_mfma_f32_32x32x16_bf16 v[168:183], v[16:19], a[32:35], v[168:183]
    ds_read_b64_tr_b16 v[36:37], v7 offset:9216
    ds_read_b64_tr_b16 v[38:39], v7 offset:11264
    v_mfma_f32_32x32x16_bf16 v[168:183], v[20:23], a[36:39], v[168:183]
    ds_read_b64_tr_b16 v[16:17], v7 offset:12288
    ds_read_b64_tr_b16 v[18:19], v7 offset:14336
    s_waitcnt lgkmcnt(6)
    v_mfma_f32_32x32x16_bf16 v[168:183], v[24:27], a[40:43], v[168:183]
    ds_read_b64_tr_b16 v[20:21], v7 offset:13312
    ds_read_b64_tr_b16 v[22:23], v7 offset:15360
    v_mfma_f32_32x32x16_bf16 v[168:183], v[28:31], a[44:47], v[168:183]
    s_barrier
    ds_read_b64_tr_b16 v[24:25], v7 offset:16384
    ds_read_b64_tr_b16 v[26:27], v7 offset:18432
    s_add_u32 m0, s38, 49152
    s_add_u32 s3, s44, 1179648
    buffer_load_dwordx4 v2, s[12:15], s3 offen offset:0 lds
    s_waitcnt lgkmcnt(6)
    v_mfma_f32_32x32x16_bf16 v[168:183], v[32:35], a[48:51], v[168:183]
    ds_read_b64_tr_b16 v[28:29], v7 offset:17408
    ds_read_b64_tr_b16 v[30:31], v7 offset:19456
    buffer_store_dwordx4 v[156:159], v1, s[4:7], s49 offen offset:1024 sc0 sc1
    s_waitcnt vmcnt(18)
    v_mfma_f32_32x32x16_bf16 v[168:183], v[36:39], a[52:55], v[168:183]
    ds_read_b64_tr_b16 v[32:33], v7 offset:20480
    ds_read_b64_tr_b16 v[34:35], v7 offset:22528
    v_lshlrev_b32 v104, 16, v216
    v_lshlrev_b32 v106, 16, v217
    v_lshlrev_b32 v108, 16, v218
    s_waitcnt lgkmcnt(6)
    v_mfma_f32_32x32x16_bf16 v[168:183], v[16:19], a[56:59], v[168:183]
    ds_read_b64_tr_b16 v[36:37], v7 offset:21504
    ds_read_b64_tr_b16 v[38:39], v7 offset:23552
    buffer_load_dwordx4 v3, s[12:15], s3 offen offset:1024 lds
    v_lshlrev_b32 v110, 16, v219
    v_mfma_f32_32x32x16_bf16 v[168:183], v[20:23], a[60:63], v[168:183]
    ds_read_b64_tr_b16 v[16:17], v7 offset:24576
    ds_read_b64_tr_b16 v[18:19], v7 offset:26624
    v_lshlrev_b32 v112, 16, v220
    v_lshlrev_b32 v114, 16, v221
    v_lshlrev_b32 v116, 16, v222
    s_waitcnt lgkmcnt(6)
    v_mfma_f32_32x32x16_bf16 v[168:183], v[24:27], a[64:67], v[168:183]
    ds_read_b64_tr_b16 v[20:21], v7 offset:25600
    ds_read_b64_tr_b16 v[22:23], v7 offset:27648
    v_lshlrev_b32 v118, 16, v223
    v_lshlrev_b32 v120, 16, v224
    v_mfma_f32_32x32x16_bf16 v[168:183], v[28:31], a[68:71], v[168:183]
    ds_read_b64_tr_b16 v[24:25], v7 offset:28672
    ds_read_b64_tr_b16 v[26:27], v7 offset:30720
    buffer_load_dwordx4 v4, s[12:15], s3 offen offset:2048 lds
    v_lshlrev_b32 v122, 16, v225
    v_and_b32 v105, 0xffff0000, v216
    s_waitcnt lgkmcnt(6)
    v_mfma_f32_32x32x16_bf16 v[168:183], v[32:35], a[72:75], v[168:183]
    ds_read_b64_tr_b16 v[28:29], v7 offset:29696
    ds_read_b64_tr_b16 v[30:31], v7 offset:31744
    v_and_b32 v107, 0xffff0000, v217
    v_and_b32 v109, 0xffff0000, v218
    v_mfma_f32_32x32x16_bf16 v[168:183], v[36:39], a[76:79], v[168:183]
    v_add_u32 v7, 4294934528, v7
    ds_read_b64_tr_b16 v[32:33], v7 offset:0
    ds_read_b64_tr_b16 v[34:35], v7 offset:2048
    v_and_b32 v111, 0xffff0000, v219
    v_and_b32 v113, 0xffff0000, v220
    v_and_b32 v115, 0xffff0000, v221
    s_waitcnt lgkmcnt(6)
    v_mfma_f32_32x32x16_bf16 v[168:183], v[16:19], a[80:83], v[168:183]
    ds_read_b64_tr_b16 v[36:37], v7 offset:1024
    ds_read_b64_tr_b16 v[38:39], v7 offset:3072
    buffer_load_dwordx4 v5, s[12:15], s3 offen offset:3072 lds
    v_and_b32 v117, 0xffff0000, v222
    v_mfma_f32_32x32x16_bf16 v[168:183], v[20:23], a[84:87], v[168:183]
    ds_read_b64_tr_b16 v[16:17], v7 offset:4096
    ds_read_b64_tr_b16 v[18:19], v7 offset:6144
    v_and_b32 v119, 0xffff0000, v223
    v_and_b32 v121, 0xffff0000, v224
    v_and_b32 v123, 0xffff0000, v225
    s_waitcnt lgkmcnt(6)
    v_mfma_f32_32x32x16_bf16 v[168:183], v[24:27], a[88:91], v[168:183]
    ds_read_b64_tr_b16 v[20:21], v7 offset:5120
    ds_read_b64_tr_b16 v[22:23], v7 offset:7168
    v_mfma_f32_32x32x16_bf16 v[168:183], v[28:31], a[92:95], v[168:183]
    ds_read_b64_tr_b16 v[24:25], v7 offset:8192
    ds_read_b64_tr_b16 v[26:27], v7 offset:10240
    s_add_u32 m0, s38, 65536
    s_add_u32 s3, s44, 1769472
    buffer_load_dwordx4 v2, s[12:15], s3 offen offset:0 lds
    s_waitcnt lgkmcnt(6)
    v_mfma_f32_32x32x16_bf16 v[168:183], v[32:35], a[96:99], v[168:183]
    ds_read_b64_tr_b16 v[28:29], v7 offset:9216
    ds_read_b64_tr_b16 v[30:31], v7 offset:11264
    v_mfma_f32_32x32x16_bf16 v[168:183], v[36:39], a[100:103], v[168:183]
    ds_read_b64_tr_b16 v[32:33], v7 offset:12288
    ds_read_b64_tr_b16 v[34:35], v7 offset:14336
    s_waitcnt lgkmcnt(6)
    v_mfma_f32_32x32x16_bf16 v[168:183], v[16:19], a[104:107], v[168:183]
    ds_read_b64_tr_b16 v[36:37], v7 offset:13312
    ds_read_b64_tr_b16 v[38:39], v7 offset:15360
    s_add_u32 s75, s48, 9216
    buffer_load_dwordx4 v[50:53], v1, s[4:7], s75 offen offset:0 sc0 sc1
    v_mfma_f32_32x32x16_bf16 v[168:183], v[20:23], a[108:111], v[168:183]
    s_barrier
    v_add_u32 v7, 65536, v7
    ds_read_b64_tr_b16 v[16:17], v7 offset:0
    ds_read_b64_tr_b16 v[18:19], v7 offset:2048
    buffer_load_dwordx4 v[54:57], v1, s[4:7], s75 offen offset:1024 sc0 sc1
    s_waitcnt lgkmcnt(6)
    v_mfma_f32_32x32x16_bf16 v[168:183], v[24:27], a[112:115], v[168:183]
    ds_read_b64_tr_b16 v[20:21], v7 offset:1024
    ds_read_b64_tr_b16 v[22:23], v7 offset:3072
    buffer_load_dwordx2 v[58:59], v239, s[4:7], s75 offen offset:0 sc0 sc1
    v_mfma_f32_32x32x16_bf16 v[168:183], v[28:31], a[116:119], v[168:183]
    ds_read_b64_tr_b16 v[24:25], v7 offset:4096
    ds_read_b64_tr_b16 v[26:27], v7 offset:6144
    s_add_u32 s75, s48, 18432
    buffer_load_dwordx4 v[60:63], v1, s[4:7], s75 offen offset:0 sc0 sc1
    s_waitcnt lgkmcnt(6)
    v_mfma_f32_32x32x16_bf16 v[168:183], v[32:35], a[120:123], v[168:183]
    ds_read_b64_tr_b16 v[28:29], v7 offset:5120
    ds_read_b64_tr_b16 v[30:31], v7 offset:7168
    buffer_load_dwordx4 v[64:67], v1, s[4:7], s75 offen offset:1024 sc0 sc1
    v_mfma_f32_32x32x16_bf16 v[168:183], v[36:39], a[124:127], v[168:183]
    ds_read_b64_tr_b16 v[32:33], v7 offset:8192
    ds_read_b64_tr_b16 v[34:35], v7 offset:10240
    buffer_load_dwordx2 v[68:69], v239, s[4:7], s75 offen offset:0 sc0 sc1
    s_waitcnt lgkmcnt(6)
    v_mfma_f32_32x32x16_bf16 v[168:183], v[16:19], a[128:131], v[168:183]
    ds_read_b64_tr_b16 v[36:37], v7 offset:9216
    ds_read_b64_tr_b16 v[38:39], v7 offset:11264
    buffer_load_dword v90, v246, s[4:7], s80 offen offset:0 sc0 sc1
    v_mfma_f32_32x32x16_bf16 v[168:183], v[20:23], a[132:135], v[168:183]
    ds_read_b64_tr_b16 v[16:17], v7 offset:12288
    ds_read_b64_tr_b16 v[18:19], v7 offset:14336
    buffer_load_dword v91, v246, s[4:7], s80 offen offset:128 sc0 sc1
    s_waitcnt lgkmcnt(6)
    v_mfma_f32_32x32x16_bf16 v[168:183], v[24:27], a[136:139], v[168:183]
    ds_read_b64_tr_b16 v[20:21], v7 offset:13312
    ds_read_b64_tr_b16 v[22:23], v7 offset:15360
    buffer_load_dword v92, v246, s[4:7], s80 offen offset:256 sc0 sc1
    v_mfma_f32_32x32x16_bf16 v[168:183], v[28:31], a[140:143], v[168:183]
    ds_read_b64_tr_b16 v[24:25], v7 offset:16384
    ds_read_b64_tr_b16 v[26:27], v7 offset:18432
    buffer_load_dword v93, v246, s[4:7], s80 offen offset:384 sc0 sc1
    s_waitcnt lgkmcnt(6)
    v_mfma_f32_32x32x16_bf16 v[168:183], v[32:35], a[144:147], v[168:183]
    ds_read_b64_tr_b16 v[28:29], v7 offset:17408
    ds_read_b64_tr_b16 v[30:31], v7 offset:19456
    buffer_load_dwordx4 v3, s[12:15], s3 offen offset:1024 lds
    v_mfma_f32_32x32x16_bf16 v[168:183], v[36:39], a[148:151], v[168:183]
    ds_read_b64_tr_b16 v[32:33], v7 offset:20480
    ds_read_b64_tr_b16 v[34:35], v7 offset:22528
    s_waitcnt lgkmcnt(6)
    v_mfma_f32_32x32x16_bf16 v[168:183], v[16:19], a[152:155], v[168:183]
    ds_read_b64_tr_b16 v[36:37], v7 offset:21504
    ds_read_b64_tr_b16 v[38:39], v7 offset:23552
    v_mfma_f32_32x32x16_bf16 v[168:183], v[20:23], a[156:159], v[168:183]
    ds_read_b64_tr_b16 v[16:17], v7 offset:24576
    ds_read_b64_tr_b16 v[18:19], v7 offset:26624
    buffer_load_dwordx4 v4, s[12:15], s3 offen offset:2048 lds
    s_waitcnt lgkmcnt(6)
    v_mfma_f32_32x32x16_bf16 v[168:183], v[24:27], a[160:163], v[168:183]
    ds_read_b64_tr_b16 v[20:21], v7 offset:25600
    ds_read_b64_tr_b16 v[22:23], v7 offset:27648
    v_mfma_f32_32x32x16_bf16 v[168:183], v[28:31], a[164:167], v[168:183]
    ds_read_b64_tr_b16 v[24:25], v7 offset:28672
    ds_read_b64_tr_b16 v[26:27], v7 offset:30720
    s_waitcnt lgkmcnt(6)
    v_mfma_f32_32x32x16_bf16 v[168:183], v[32:35], a[168:171], v[168:183]
    ds_read_b64_tr_b16 v[28:29], v7 offset:29696
    ds_read_b64_tr_b16 v[30:31], v7 offset:31744
    buffer_load_dwordx4 v5, s[12:15], s3 offen offset:3072 lds
    v_mfma_f32_32x32x16_bf16 v[168:183], v[36:39], a[172:175], v[168:183]
    s_barrier
    ds_read_b64_tr_b16 v[32:33], v7 offset:32768
    ds_read_b64_tr_b16 v[34:35], v7 offset:34816
    s_waitcnt lgkmcnt(6)
    v_mfma_f32_32x32x16_bf16 v[168:183], v[16:19], a[176:179], v[168:183]
    ds_read_b64_tr_b16 v[36:37], v7 offset:33792
    ds_read_b64_tr_b16 v[38:39], v7 offset:35840
    v_mfma_f32_32x32x16_bf16 v[168:183], v[20:23], a[180:183], v[168:183]
    ds_read_b64_tr_b16 v[16:17], v7 offset:36864
    ds_read_b64_tr_b16 v[18:19], v7 offset:38912
    s_add_u32 m0, s38, 32768
    s_add_u32 s3, s44, 2359296
    buffer_load_dwordx4 v2, s[12:15], s3 offen offset:0 lds
    s_waitcnt lgkmcnt(6)
    v_mfma_f32_32x32x16_bf16 v[168:183], v[24:27], a[184:187], v[168:183]
    ds_read_b64_tr_b16 v[20:21], v7 offset:37888
    ds_read_b64_tr_b16 v[22:23], v7 offset:39936
    s_waitcnt vmcnt(4)
    v_fma_mix_f32 v70, v50, 1.0, v60 op_sel:[0,0,0] op_sel_hi:[1,0,1]
    v_mfma_f32_32x32x16_bf16 v[168:183], v[28:31], a[188:191], v[168:183]
    ds_read_b64_tr_b16 v[24:25], v7 offset:40960
    ds_read_b64_tr_b16 v[26:27], v7 offset:43008
    v_fma_mix_f32 v71, v50, 1.0, v60 op_sel:[1,0,1] op_sel_hi:[1,0,1]
    v_fma_mix_f32 v72, v51, 1.0, v61 op_sel:[0,0,0] op_sel_hi:[1,0,1]
    v_fma_mix_f32 v73, v51, 1.0, v61 op_sel:[1,0,1] op_sel_hi:[1,0,1]
    s_waitcnt lgkmcnt(6)
    v_mfma_f32_32x32x16_bf16 v[168:183], v[32:35], a[192:195], v[168:183]
    ds_read_b64_tr_b16 v[28:29], v7 offset:41984
    ds_read_b64_tr_b16 v[30:31], v7 offset:44032
    buffer_load_dwordx4 v3, s[12:15], s3 offen offset:1024 lds
    v_fma_mix_f32 v74, v52, 1.0, v62 op_sel:[0,0,0] op_sel_hi:[1,0,1]
    v_mfma_f32_32x32x16_bf16 v[168:183], v[36:39], a[196:199], v[168:183]
    ds_read_b64_tr_b16 v[32:33], v7 offset:45056
    ds_read_b64_tr_b16 v[34:35], v7 offset:47104
    v_fma_mix_f32 v75, v52, 1.0, v62 op_sel:[1,0,1] op_sel_hi:[1,0,1]
    v_fma_mix_f32 v76, v53, 1.0, v63 op_sel:[0,0,0] op_sel_hi:[1,0,1]
    v_fma_mix_f32 v77, v53, 1.0, v63 op_sel:[1,0,1] op_sel_hi:[1,0,1]
    s_waitcnt lgkmcnt(6)
    v_mfma_f32_32x32x16_bf16 v[168:183], v[16:19], a[200:203], v[168:183]
    ds_read_b64_tr_b16 v[36:37], v7 offset:46080
    ds_read_b64_tr_b16 v[38:39], v7 offset:48128
    buffer_load_dwordx4 v[40:43], v1, s[4:7], s48 offen offset:0 sc0 sc1
    v_fma_mix_f32 v78, v54, 1.0, v64 op_sel:[0,0,0] op_sel_hi:[1,0,1]
    v_mfma_f32_32x32x16_bf16 v[168:183], v[20:23], a[204:207], v[168:183]
    v_add_u32 v7, 4294868992, v7
    ds_read_b64_tr_b16 v[16:17], v7 offset:0
    ds_read_b64_tr_b16 v[18:19], v7 offset:2048
    buffer_load_dwordx4 v[44:47], v1, s[4:7], s48 offen offset:1024 sc0 sc1
    v_fma_mix_f32 v79, v54, 1.0, v64 op_sel:[1,0,1] op_sel_hi:[1,0,1]
    v_fma_mix_f32 v80, v55, 1.0, v65 op_sel:[0,0,0] op_sel_hi:[1,0,1]
    s_waitcnt lgkmcnt(6)
    v_mfma_f32_32x32x16_bf16 v[168:183], v[24:27], a[208:211], v[168:183]
    ds_read_b64_tr_b16 v[20:21], v7 offset:1024
    ds_read_b64_tr_b16 v[22:23], v7 offset:3072
    buffer_load_dwordx2 v[48:49], v239, s[4:7], s48 offen offset:0 sc0 sc1
    v_fma_mix_f32 v81, v55, 1.0, v65 op_sel:[1,0,1] op_sel_hi:[1,0,1]
    v_mfma_f32_32x32x16_bf16 v[168:183], v[28:31], a[212:215], v[168:183]
    ds_read_b64_tr_b16 v[24:25], v7 offset:4096
    ds_read_b64_tr_b16 v[26:27], v7 offset:6144
    buffer_load_dwordx4 v4, s[12:15], s3 offen offset:2048 lds
    v_fma_mix_f32 v82, v56, 1.0, v66 op_sel:[0,0,0] op_sel_hi:[1,0,1]
    v_fma_mix_f32 v83, v56, 1.0, v66 op_sel:[1,0,1] op_sel_hi:[1,0,1]
    s_waitcnt lgkmcnt(6)
    v_mfma_f32_32x32x16_bf16 v[168:183], v[32:35], a[216:219], v[168:183]
    ds_read_b64_tr_b16 v[28:29], v7 offset:5120
    ds_read_b64_tr_b16 v[30:31], v7 offset:7168
    v_fma_mix_f32 v84, v57, 1.0, v67 op_sel:[0,0,0] op_sel_hi:[1,0,1]
    v_fma_mix_f32 v85, v57, 1.0, v67 op_sel:[1,0,1] op_sel_hi:[1,0,1]
    v_mfma_f32_32x32x16_bf16 v[168:183], v[36:39], a[220:223], v[168:183]
    ds_read_b64_tr_b16 v[32:33], v7 offset:8192
    ds_read_b64_tr_b16 v[34:35], v7 offset:10240
    v_fma_mix_f32 v86, v58, 1.0, v68 op_sel:[0,0,0] op_sel_hi:[1,0,1]
    v_fma_mix_f32 v87, v58, 1.0, v68 op_sel:[1,0,1] op_sel_hi:[1,0,1]
    v_fma_mix_f32 v88, v59, 1.0, v69 op_sel:[0,0,0] op_sel_hi:[1,0,1]
    s_waitcnt lgkmcnt(6)
    v_mfma_f32_32x32x16_bf16 v[168:183], v[16:19], a[224:227], v[168:183]
    ds_read_b64_tr_b16 v[36:37], v7 offset:9216
    ds_read_b64_tr_b16 v[38:39], v7 offset:11264
    buffer_load_dwordx4 v5, s[12:15], s3 offen offset:3072 lds
    v_fma_mix_f32 v89, v59, 1.0, v69 op_sel:[1,0,1] op_sel_hi:[1,0,1]
    v_mfma_f32_32x32x16_bf16 v[168:183], v[20:23], a[228:231], v[168:183]
    ds_read_b64_tr_b16 v[16:17], v7 offset:12288
    ds_read_b64_tr_b16 v[18:19], v7 offset:14336
    v_add_f32 v90, v90, v91
    v_add_f32 v92, v92, v93
    v_add_f32 v90, v90, v94
    s_waitcnt lgkmcnt(6)
    v_mfma_f32_32x32x16_bf16 v[168:183], v[24:27], a[232:235], v[168:183]
    ds_read_b64_tr_b16 v[20:21], v7 offset:13312
    ds_read_b64_tr_b16 v[22:23], v7 offset:15360
    v_add_f32 v90, v90, v92
    v_cvt_pk_bf16_f32 v90, v90, v90
    v_mfma_f32_32x32x16_bf16 v[168:183], v[28:31], a[236:239], v[168:183]
    s_add_u32 m0, s38, 81920
    s_add_u32 s3, s45, 2949120
    buffer_load_dwordx4 v2, s[12:15], s3 offen offset:0 lds
    s_waitcnt lgkmcnt(4)
    v_mfma_f32_32x32x16_bf16 v[168:183], v[32:35], a[240:243], v[168:183]
    v_and_b32 v90, 0xffff0000, v90
    v_mfma_f32_32x32x16_bf16 v[168:183], v[36:39], a[244:247], v[168:183]
    s_waitcnt lgkmcnt(0)
    v_mfma_f32_32x32x16_bf16 v[168:183], v[16:19], a[248:251], v[168:183]
    buffer_load_dwordx4 v3, s[12:15], s3 offen offset:1024 lds
    v_mfma_f32_32x32x16_bf16 v[168:183], v[20:23], a[252:255], v[168:183]
    s_waitcnt vmcnt(4)
    v_fma_mix_f32 v70, v40, 1.0, v70 op_sel:[0,0,0] op_sel_hi:[1,0,0]
    v_fma_mix_f32 v71, v40, 1.0, v71 op_sel:[1,0,0] op_sel_hi:[1,0,0]
    v_fma_mix_f32 v72, v41, 1.0, v72 op_sel:[0,0,0] op_sel_hi:[1,0,0]
    v_fma_mix_f32 v73, v41, 1.0, v73 op_sel:[1,0,0] op_sel_hi:[1,0,0]
    v_fma_mix_f32 v74, v42, 1.0, v74 op_sel:[0,0,0] op_sel_hi:[1,0,0]
    v_fma_mix_f32 v75, v42, 1.0, v75 op_sel:[1,0,0] op_sel_hi:[1,0,0]
    v_fma_mix_f32 v76, v43, 1.0, v76 op_sel:[0,0,0] op_sel_hi:[1,0,0]
    v_fma_mix_f32 v77, v43, 1.0, v77 op_sel:[1,0,0] op_sel_hi:[1,0,0]
    v_fma_mix_f32 v78, v44, 1.0, v78 op_sel:[0,0,0] op_sel_hi:[1,0,0]
    v_fma_mix_f32 v79, v44, 1.0, v79 op_sel:[1,0,0] op_sel_hi:[1,0,0]
    v_fma_mix_f32 v80, v45, 1.0, v80 op_sel:[0,0,0] op_sel_hi:[1,0,0]
    v_fma_mix_f32 v81, v45, 1.0, v81 op_sel:[1,0,0] op_sel_hi:[1,0,0]
    v_fma_mix_f32 v82, v46, 1.0, v82 op_sel:[0,0,0] op_sel_hi:[1,0,0]
    v_fma_mix_f32 v83, v46, 1.0, v83 op_sel:[1,0,0] op_sel_hi:[1,0,0]
    v_fma_mix_f32 v84, v47, 1.0, v84 op_sel:[0,0,0] op_sel_hi:[1,0,0]
    v_fma_mix_f32 v85, v47, 1.0, v85 op_sel:[1,0,0] op_sel_hi:[1,0,0]
    v_fma_mix_f32 v86, v48, 1.0, v86 op_sel:[0,0,0] op_sel_hi:[1,0,0]
    v_fma_mix_f32 v87, v48, 1.0, v87 op_sel:[1,0,0] op_sel_hi:[1,0,0]
    v_fma_mix_f32 v88, v49, 1.0, v88 op_sel:[0,0,0] op_sel_hi:[1,0,0]
    v_fma_mix_f32 v89, v49, 1.0, v89 op_sel:[1,0,0] op_sel_hi:[1,0,0]
    v_fma_f32 v242, v70, v78, v86
    v_cmp_u_f32 vcc, v242, v90
    s_cbranch_vccnz KT_SLOW1
KT_BACK1:
    v_pk_add_f32 v[168:169], v[168:169], v[70:71]
    v_pk_add_f32 v[170:171], v[170:171], v[72:73]
    v_cvt_pk_bf16_f32 v226, v168, v169
    v_cvt_pk_bf16_f32 v227, v170, v171
    v_pk_add_f32 v[172:173], v[172:173], v[74:75]
    v_pk_add_f32 v[174:175], v[174:175], v[76:77]
    v_cvt_pk_bf16_f32 v228, v172, v173
    v_cvt_pk_bf16_f32 v229, v174, v175
    v_pk_add_f32 v[176:177], v[176:177], v[78:79]
    v_pk_add_f32 v[178:179], v[178:179], v[80:81]
    v_cvt_pk_bf16_f32 v230, v176, v177
    v_cvt_pk_bf16_f32 v231, v178, v179
    v_pk_add_f32 v[180:181], v[180:181], v[82:83]
    v_pk_add_f32 v[182:183], v[182:183], v[84:85]
    v_cvt_pk_bf16_f32 v232, v180, v181
    v_cvt_pk_bf16_f32 v233, v182, v183
    v_pk_add_f32 v[136:137], v[136:137], v[86:87]
    v_pk_add_f32 v[138:139], v[138:139], v[88:89]
    v_cvt_pk_bf16_f32 v234, v136, v137
    v_cvt_pk_bf16_f32 v235, v138, v139
    v_permlane32_swap_b32 v226, v228
    v_permlane32_swap_b32 v227, v229
    v_permlane32_swap_b32 v230, v232
    v_permlane32_swap_b32 v231, v233
    v_lshlrev_b32 v40, 16, v226
    v_and_b32 v41, 0xffff0000, v226
    v_lshlrev_b32 v42, 16, v227
    v_and_b32 v43, 0xffff0000, v227
    v_lshlrev_b32 v44, 16, v228
    v_and_b32 v45, 0xffff0000, v228
    v_lshlrev_b32 v46, 16, v229
    v_and_b32 v47, 0xffff0000, v229
    v_pk_add_f32 v[40:41], v[40:41], v[104:105]
    v_pk_add_f32 v[42:43], v[42:43], v[106:107]
    v_pk_add_f32 v[44:45], v[44:45], v[108:109]
    v_pk_add_f32 v[46:47], v[46:47], v[110:111]
    v_cvt_pk_bf16_f32 v226, v40, v41
    v_cvt_pk_bf16_f32 v227, v42, v43
    v_cvt_pk_bf16_f32 v228, v44, v45
    v_cvt_pk_bf16_f32 v229, v46, v47
    v_lshlrev_b32 v40, 16, v226
    v_and_b32 v41, 0xffff0000, v226
    v_lshlrev_b32 v42, 16, v227
    v_and_b32 v43, 0xffff0000, v227
    v_lshlrev_b32 v44, 16, v228
    v_and_b32 v45, 0xffff0000, v228
    v_lshlrev_b32 v46, 16, v229
    v_and_b32 v47, 0xffff0000, v229
    v_pk_add_f32 v[104:105], v[40:41], v[90:91] op_sel_hi:[1,0] neg_lo:[0,1] neg_hi:[0,1]
    v_pk_add_f32 v[106:107], v[42:43], v[90:91] op_sel_hi:[1,0] neg_lo:[0,1] neg_hi:[0,1]
    v_pk_add_f32 v[108:109], v[44:45], v[90:91] op_sel_hi:[1,0] neg_lo:[0,1] neg_hi:[0,1]
    v_pk_add_f32 v[110:111], v[46:47], v[90:91] op_sel_hi:[1,0] neg_lo:[0,1] neg_hi:[0,1]
    v_cvt_pk_bf16_f32 v216, v104, v105
    v_cvt_pk_bf16_f32 v217, v106, v107
    v_cvt_pk_bf16_f32 v218, v108, v109
    v_cvt_pk_bf16_f32 v219, v110, v111
    buffer_store_dwordx4 v[216:219], v1, s[4:7], s68 offen offset:0 sc0 sc1
    v_lshlrev_b32 v48, 16, v230
    v_and_b32 v49, 0xffff0000, v230
    v_lshlrev_b32 v50, 16, v231
    v_and_b32 v51, 0xffff0000, v231
    v_lshlrev_b32 v52, 16, v232
    v_and_b32 v53, 0xffff0000, v232
    v_lshlrev_b32 v54, 16, v233
    v_and_b32 v55, 0xffff0000, v233
    v_pk_add_f32 v[48:49], v[48:49], v[112:113]
    v_pk_add_f32 v[50:51], v[50:51], v[114:115]
    v_pk_add_f32 v[52:53], v[52:53], v[116:117]
    v_pk_add_f32 v[54:55], v[54:55], v[118:119]
    v_cvt_pk_bf16_f32 v230, v48, v49
    v_cvt_pk_bf16_f32 v231, v50, v51
    v_cvt_pk_bf16_f32 v232, v52, v53
    v_cvt_pk_bf16_f32 v233, v54, v55
    v_lshlrev_b32 v48, 16, v230
    v_and_b32 v49, 0xffff0000, v230
    v_lshlrev_b32 v50, 16, v231
    v_and_b32 v51, 0xffff0000, v231
    v_lshlrev_b32 v52, 16, v232
    v_and_b32 v53, 0xffff0000, v232
    v_lshlrev_b32 v54, 16, v233
    v_and_b32 v55, 0xffff0000, v233
    v_pk_add_f32 v[112:113], v[48:49], v[90:91] op_sel_hi:[1,0] neg_lo:[0,1] neg_hi:[0,1]
    v_pk_add_f32 v[114:115], v[50:51], v[90:91] op_sel_hi:[1,0] neg_lo:[0,1] neg_hi:[0,1]
    v_pk_add_f32 v[116:117], v[52:53], v[90:91] op_sel_hi:[1,0] neg_lo:[0,1] neg_hi:[0,1]
    v_pk_add_f32 v[118:119], v[54:55], v[90:91] op_sel_hi:[1,0] neg_lo:[0,1] neg_hi:[0,1]
    v_cvt_pk_bf16_f32 v220, v112, v113
    v_cvt_pk_bf16_f32 v221, v114, v115
    v_cvt_pk_bf16_f32 v222, v116, v117
    v_cvt_pk_bf16_f32 v223, v118, v119
    buffer_store_dwordx4 v[220:223], v1, s[4:7], s68 offen offset:1024 sc0 sc1
    v_lshlrev_b32 v56, 16, v234
    v_and_b32 v57, 0xffff0000, v234
    v_lshlrev_b32 v58, 16, v235
    v_and_b32 v59, 0xffff0000, v235
    v_pk_add_f32 v[56:57], v[56:57], v[120:121]
    v_pk_add_f32 v[58:59], v[58:59], v[122:123]
    v_cvt_pk_bf16_f32 v234, v56, v57
    v_cvt_pk_bf16_f32 v235, v58, v59
    v_lshlrev_b32 v56, 16, v234
    v_and_b32 v57, 0xffff0000, v234
    v_lshlrev_b32 v58, 16, v235
    v_and_b32 v59, 0xffff0000, v235
    v_pk_add_f32 v[120:121], v[56:57], v[90:91] op_sel_hi:[1,0] neg_lo:[0,1] neg_hi:[0,1]
    v_pk_add_f32 v[122:123], v[58:59], v[90:91] op_sel_hi:[1,0] neg_lo:[0,1] neg_hi:[0,1]
    v_cvt_pk_bf16_f32 v224, v120, v121
    v_cvt_pk_bf16_f32 v225, v122, v123
    buffer_store_dwordx2 v[224:225], v238, s[4:7], s70 offen sc0 sc1
    s_barrier
    buffer_load_dwordx4 v4, s[12:15], s3 offen offset:2048 lds
    buffer_load_dwordx4 v5, s[12:15], s3 offen offset:3072 lds
    s_add_u32 m0, s38, 0
    s_add_u32 s3, s45, 4128768
    buffer_load_dwordx4 v2, s[12:15], s3 offen offset:0 lds
    buffer_load_dwordx4 v3, s[12:15], s3 offen offset:1024 lds
    buffer_load_dwordx4 v4, s[12:15], s3 offen offset:2048 lds
    buffer_load_dwordx4 v5, s[12:15], s3 offen offset:3072 lds
    s_add_u32 m0, s38, 98304
    s_add_u32 s3, s45, 2949248
    buffer_load_dwordx4 v2, s[12:15], s3 offen offset:0 lds
    buffer_load_dwordx4 v3, s[12:15], s3 offen offset:1024 lds
    v_accvgpr_write_b32 a246, v226
    v_accvgpr_write_b32 a247, v227
    v_accvgpr_write_b32 a248, v228
    v_accvgpr_write_b32 a249, v229
    v_accvgpr_write_b32 a250, v230
    v_accvgpr_write_b32 a251, v231
    v_accvgpr_write_b32 a252, v232
    v_accvgpr_write_b32 a253, v233
    v_accvgpr_write_b32 a254, v234
    v_accvgpr_write_b32 a255, v235
    v_mul_f32 v56, s59, v56
    v_mul_f32 v57, s59, v57
    v_mul_f32 v58, s59, v58
    v_mul_f32 v59, s59, v59
    v_pk_add_f32 v[70:71], v[40:41], v[42:43]
    v_pk_mul_f32 v[72:73], v[40:41], v[40:41]
    v_pk_fma_f32 v[72:73], v[42:43], v[42:43], v[72:73]
    v_pk_add_f32 v[70:71], v[70:71], v[44:45]
    v_pk_fma_f32 v[72:73], v[44:45], v[44:45], v[72:73]
    v_pk_add_f32 v[70:71], v[70:71], v[46:47]
    v_pk_fma_f32 v[72:73], v[46:47], v[46:47], v[72:73]
    v_pk_add_f32 v[70:71], v[70:71], v[48:49]
    v_pk_fma_f32 v[72:73], v[48:49], v[48:49], v[72:73]
    v_pk_add_f32 v[70:71], v[70:71], v[50:51]
    v_pk_fma_f32 v[72:73], v[50:51], v[50:51], v[72:73]
    v_pk_add_f32 v[70:71], v[70:71], v[52:53]
    v_pk_fma_f32 v[72:73], v[52:53], v[52:53], v[72:73]
    v_pk_add_f32 v[70:71], v[70:71], v[54:55]
    v_pk_fma_f32 v[72:73], v[54:55], v[54:55], v[72:73]
    v_pk_add_f32 v[70:71], v[70:71], v[56:57]
    v_pk_fma_f32 v[72:73], v[56:57], v[56:57], v[72:73]
    v_pk_add_f32 v[70:71], v[70:71], v[58:59]
    v_pk_fma_f32 v[72:73], v[58:59], v[58:59], v[72:73]
    v_add_f32 v70, v70, v71
    v_add_f32 v71, v72, v73
    v_mov_b32 v72, v70
    v_mov_b32 v73, v71
    s_nop 0
    v_permlane32_swap_b32 v70, v72
    v_permlane32_swap_b32 v71, v73
    v_add_f32 v70, v70, v72
    v_add_f32 v71, v71, v73
    v_lshrrev_b32 v72, 1, v241
    v_lshrrev_b32 v252, 1, v1
    buffer_store_dwordx2 v[70:71], v72, s[4:7], s71 offen sc0 sc1
    s_lshl_b32 s43, s40, 6
    v_xor_b32 v7, s43, v7
    v_xor_b32 v8, s43, v8
    buffer_load_dwordx4 v4, s[12:15], s3 offen offset:2048 lds
    buffer_load_dwordx4 v5, s[12:15], s3 offen offset:3072 lds
    s_add_u32 m0, s38, 114688
    s_add_u32 s3, s45, 4128896
    buffer_load_dwordx4 v2, s[12:15], s3 offen offset:0 lds
    buffer_load_dwordx4 v3, s[12:15], s3 offen offset:1024 lds
    buffer_load_dwordx4 v4, s[12:15], s3 offen offset:2048 lds
    buffer_load_dwordx4 v5, s[12:15], s3 offen offset:3072 lds
    s_add_u32 m0, s38, 131072
    s_add_u32 s3, s45, 256
    buffer_load_dwordx4 v2, s[12:15], s3 offen offset:0 lds
    buffer_load_dwordx4 v3, s[12:15], s3 offen offset:1024 lds
    buffer_load_dwordx4 v4, s[12:15], s3 offen offset:2048 lds
    buffer_load_dwordx4 v5, s[12:15], s3 offen offset:3072 lds
    buffer_load_dword v13, v250, s[4:7], s74 offen sc0 sc1
    buffer_load_dwordx4 v[104:107], v1, s[4:7], s74 offen offset:0 sc0 sc1
    buffer_load_dwordx4 v[108:111], v1, s[4:7], s74 offen offset:1024 sc0 sc1
    buffer_load_dwordx4 v[112:115], v1, s[4:7], s74 offen offset:2048 sc0 sc1
    buffer_load_dwordx4 v[116:119], v1, s[4:7], s74 offen offset:3072 sc0 sc1
    s_add_u32 s74, s74, 4096
    buffer_load_dwordx4 v[120:123], v1, s[4:7], s74 offen offset:0 sc0 sc1
    buffer_load_dwordx4 v[124:127], v1, s[4:7], s74 offen offset:1024 sc0 sc1
    s_barrier
    ds_read_b64_tr_b16 v[24:25], v7 offset:16384
    ds_read_b64_tr_b16 v[26:27], v7 offset:17408
    ds_read_b64_tr_b16 v[28:29], v8 offset:16384
    ds_read_b64_tr_b16 v[30:31], v8 offset:17408
    ds_read_b64_tr_b16 v[32:33], v7 offset:18432
    ds_read_b64_tr_b16 v[34:35], v7 offset:19456
    ds_read_b64_tr_b16 v[36:37], v8 offset:18432
    ds_read_b64_tr_b16 v[38:39], v8 offset:19456
    ds_read_b64_tr_b16 v[16:17], v7 offset:20480
    ds_read_b64_tr_b16 v[18:19], v7 offset:21504
    s_waitcnt vmcnt(6)
    v_cmp_u_f32 vcc, v13, v13
    s_cbranch_vccnz KT_SLOW2
KT_BACK2:
    v_lshrrev_b32 v250, 5, v0
    v_bfe_u32 v251, v0, 2, 2
    v_lshl_add_u32 v250, v250, 2, v251
    v_and_b32 v251, 3, v0
    v_lshlrev_b32 v251, 3, v251
    s_lshl_b32 s43, s40, 4
    v_lshl_add_u32 v9, v250, 5, v251
    v_xor_b32 v9, s43, v9
    s_waitcnt vmcnt(4)
    v_cmp_u_f32 vcc, v104, v108
    s_cbranch_vccnz KT_SLOW3
KT_BACK3:
    s_waitcnt lgkmcnt(6)
    v_mfma_f32_32x32x16_bf16 v[40:55], v[24:27], v[104:107], 0
    ds_read_b64_tr_b16 v[20:21], v8 offset:20480
    ds_read_b64_tr_b16 v[22:23], v8 offset:21504
    buffer_load_dwordx4 v[128:131], v1, s[4:7], s74 offen offset:2048 sc0 sc1
    v_mfma_f32_32x32x16_bf16 v[56:71], v[28:31], v[104:107], 0
    ds_read_b64_tr_b16 v[24:25], v7 offset:22528
    ds_read_b64_tr_b16 v[26:27], v7 offset:23552
    s_waitcnt lgkmcnt(6)
    v_mfma_f32_32x32x16_bf16 v[40:55], v[32:35], v[108:111], v[40:55]
    ds_read_b64_tr_b16 v[28:29], v8 offset:22528
    ds_read_b64_tr_b16 v[30:31], v8 offset:23552
    buffer_load_dwordx4 v[132:135], v1, s[4:7], s74 offen offset:3072 sc0 sc1
    s_add_u32 s74, s74, 4096
    v_mfma_f32_32x32x16_bf16 v[56:71], v[36:39], v[108:111], v[56:71]
    ds_read_b64_tr_b16 v[32:33], v7 offset:24576
    ds_read_b64_tr_b16 v[34:35], v7 offset:25600
    s_waitcnt lgkmcnt(6)
    v_mfma_f32_32x32x16_bf16 v[72:87], v[16:19], v[104:107], 0
    ds_read_b64_tr_b16 v[36:37], v8 offset:24576
    ds_read_b64_tr_b16 v[38:39], v8 offset:25600
    buffer_load_dwordx4 v[136:139], v1, s[4:7], s74 offen offset:0 sc0 sc1
    v_mfma_f32_32x32x16_bf16 v[88:103], v[20:23], v[104:107], 0
    ds_read_b64_tr_b16 v[16:17], v7 offset:26624
    ds_read_b64_tr_b16 v[18:19], v7 offset:27648
    s_waitcnt lgkmcnt(6)
    v_mfma_f32_32x32x16_bf16 v[72:87], v[24:27], v[108:111], v[72:87]
    ds_read_b64_tr_b16 v[20:21], v8 offset:26624
    ds_read_b64_tr_b16 v[22:23], v8 offset:27648
    buffer_load_dwordx4 v[140:143], v1, s[4:7], s74 offen offset:1024 sc0 sc1
    v_mfma_f32_32x32x16_bf16 v[88:103], v[28:31], v[108:111], v[88:103]
    ds_read_b64_tr_b16 v[24:25], v7 offset:28672
    ds_read_b64_tr_b16 v[26:27], v7 offset:29696
    s_waitcnt vmcnt(6)
    v_cmp_u_f32 vcc, v112, v116
    s_cbranch_vccnz KT_SLOW4
KT_BACK4:
    s_waitcnt lgkmcnt(6)
    v_mfma_f32_32x32x16_bf16 v[40:55], v[32:35], v[112:115], v[40:55]
    ds_read_b64_tr_b16 v[28:29], v8 offset:28672
    ds_read_b64_tr_b16 v[30:31], v8 offset:29696
    buffer_load_dwordx4 v[144:147], v1, s[4:7], s74 offen offset:2048 sc0 sc1
    v_mfma_f32_32x32x16_bf16 v[56:71], v[36:39], v[112:115], v[56:71]
    ds_read_b64_tr_b16 v[32:33], v7 offset:30720
    ds_read_b64_tr_b16 v[34:35], v7 offset:31744
    s_waitcnt lgkmcnt(6)
    v_mfma_f32_32x32x16_bf16 v[40:55], v[16:19], v[116:119], v[40:55]
    ds_read_b64_tr_b16 v[36:37], v8 offset:30720
    ds_read_b64_tr_b16 v[38:39], v8 offset:31744
    buffer_load_dwordx4 v[148:151], v1, s[4:7], s74 offen offset:3072 sc0 sc1
    s_add_u32 s74, s74, 4096
    v_mfma_f32_32x32x16_bf16 v[56:71], v[20:23], v[116:119], v[56:71]
    s_barrier
    v_add_u32 v7, 147456, v7
    ds_read_b64_tr_b16 v[16:17], v7 offset:0
    ds_read_b64_tr_b16 v[18:19], v7 offset:1024
    s_add_u32 m0, s38, 16384
    s_add_u32 s3, s45, 1179904
    buffer_load_dwordx4 v2, s[12:15], s3 offen offset:0 lds
    s_waitcnt lgkmcnt(6)
    v_mfma_f32_32x32x16_bf16 v[72:87], v[24:27], v[112:115], v[72:87]
    v_add_u32 v8, 147456, v8
    ds_read_b64_tr_b16 v[20:21], v8 offset:0
    ds_read_b64_tr_b16 v[22:23], v8 offset:1024
    buffer_load_dwordx4 v[152:155], v1, s[4:7], s74 offen offset:0 sc0 sc1
    v_mfma_f32_32x32x16_bf16 v[88:103], v[28:31], v[112:115], v[88:103]
    ds_read_b64_tr_b16 v[24:25], v7 offset:2048
    ds_read_b64_tr_b16 v[26:27], v7 offset:3072
    s_waitcnt lgkmcnt(6)
    v_mfma_f32_32x32x16_bf16 v[72:87], v[32:35], v[116:119], v[72:87]
    ds_read_b64_tr_b16 v[28:29], v8 offset:2048
    ds_read_b64_tr_b16 v[30:31], v8 offset:3072
    buffer_load_dwordx4 v[156:159], v1, s[4:7], s74 offen offset:1024 sc0 sc1
    v_mfma_f32_32x32x16_bf16 v[88:103], v[36:39], v[116:119], v[88:103]
    ds_read_b64_tr_b16 v[32:33], v7 offset:4096
    ds_read_b64_tr_b16 v[34:35], v7 offset:5120
    buffer_load_dwordx4 v3, s[12:15], s3 offen offset:1024 lds
    s_waitcnt vmcnt(10)
    v_cmp_u_f32 vcc, v120, v124
    s_cbranch_vccnz KT_SLOW5
KT_BACK5:
    s_waitcnt lgkmcnt(6)
    v_mfma_f32_32x32x16_bf16 v[40:55], v[16:19], v[120:123], v[40:55]
    ds_read_b64_tr_b16 v[36:37], v8 offset:4096
    ds_read_b64_tr_b16 v[38:39], v8 offset:5120
    buffer_load_dwordx4 v[160:163], v1, s[4:7], s74 offen offset:2048 sc0 sc1
    v_mfma_f32_32x32x16_bf16 v[56:71], v[20:23], v[120:123], v[56:71]
    ds_read_b64_tr_b16 v[16:17], v7 offset:6144
    ds_read_b64_tr_b16 v[18:19], v7 offset:7168
    s_waitcnt lgkmcnt(6)
    v_mfma_f32_32x32x16_bf16 v[40:55], v[24:27], v[124:127], v[40:55]
    ds_read_b64_tr_b16 v[20:21], v8 offset:6144
    ds_read_b64_tr_b16 v[22:23], v8 offset:7168
    buffer_load_dwordx4 v[164:167], v1, s[4:7], s74 offen offset:3072 sc0 sc1
    s_add_u32 s74, s74, 4096
    v_mfma_f32_32x32x16_bf16 v[56:71], v[28:31], v[124:127], v[56:71]
    ds_read_b64_tr_b16 v[24:25], v7 offset:8192
    ds_read_b64_tr_b16 v[26:27], v7 offset:9216
    buffer_load_dwordx4 v4, s[12:15], s3 offen offset:2048 lds
    s_waitcnt lgkmcnt(6)
    v_mfma_f32_32x32x16_bf16 v[72:87], v[32:35], v[120:123], v[72:87]
    ds_read_b64_tr_b16 v[28:29], v8 offset:8192
    ds_read_b64_tr_b16 v[30:31], v8 offset:9216
    buffer_load_dwordx4 v[168:171], v1, s[4:7], s74 offen offset:0 sc0 sc1
    v_mfma_f32_32x32x16_bf16 v[88:103], v[36:39], v[120:123], v[88:103]
    ds_read_b64_tr_b16 v[32:33], v7 offset:10240
    ds_read_b64_tr_b16 v[34:35], v7 offset:11264
    s_waitcnt lgkmcnt(6)
    v_mfma_f32_32x32x16_bf16 v[72:87], v[16:19], v[124:127], v[72:87]
    ds_read_b64_tr_b16 v[36:37], v8 offset:10240
    ds_read_b64_tr_b16 v[38:39], v8 offset:11264
    buffer_load_dwordx4 v[172:175], v1, s[4:7], s74 offen offset:1024 sc0 sc1
    v_mfma_f32_32x32x16_bf16 v[88:103], v[20:23], v[124:127], v[88:103]
    ds_read_b64_tr_b16 v[16:17], v7 offset:12288
    ds_read_b64_tr_b16 v[18:19], v7 offset:13312
    buffer_load_dwordx4 v5, s[12:15], s3 offen offset:3072 lds
    s_waitcnt vmcnt(14)
    v_cmp_u_f32 vcc, v128, v132
    s_cbranch_vccnz KT_SLOW6
KT_BACK6:
    s_waitcnt lgkmcnt(6)
    v_mfma_f32_32x32x16_bf16 v[40:55], v[24:27], v[128:131], v[40:55]
    ds_read_b64_tr_b16 v[20:21], v8 offset:12288
    ds_read_b64_tr_b16 v[22:23], v8 offset:13312
    buffer_load_dwordx4 v[176:179], v1, s[4:7], s74 offen offset:2048 sc0 sc1
    v_mfma_f32_32x32x16_bf16 v[56:71], v[28:31], v[128:131], v[56:71]
    ds_read_b64_tr_b16 v[24:25], v7 offset:14336
    ds_read_b64_tr_b16 v[26:27], v7 offset:15360
    s_waitcnt lgkmcnt(6)
    v_mfma_f32_32x32x16_bf16 v[40:55], v[32:35], v[132:135], v[40:55]
    ds_read_b64_tr_b16 v[28:29], v8 offset:14336
    ds_read_b64_tr_b16 v[30:31], v8 offset:15360
    buffer_load_dwordx4 v[180:183], v1, s[4:7], s74 offen offset:3072 sc0 sc1
    s_add_u32 s74, s74, 4096
    v_mfma_f32_32x32x16_bf16 v[56:71], v[36:39], v[132:135], v[56:71]
    s_barrier
    v_add_u32 v7, 4294868992, v7
    ds_read_b64_tr_b16 v[32:33], v7 offset:0
    ds_read_b64_tr_b16 v[34:35], v7 offset:1024
    s_add_u32 m0, s38, 147456
    s_add_u32 s3, s45, 2359552
    buffer_load_dwordx4 v2, s[12:15], s3 offen offset:0 lds
    s_waitcnt lgkmcnt(6)
    v_mfma_f32_32x32x16_bf16 v[72:87], v[16:19], v[128:131], v[72:87]
    v_add_u32 v8, 4294868992, v8
    ds_read_b64_tr_b16 v[36:37], v8 offset:0
    ds_read_b64_tr_b16 v[38:39], v8 offset:1024
    buffer_load_dwordx4 v[184:187], v1, s[4:7], s74 offen offset:0 sc0 sc1
    v_mfma_f32_32x32x16_bf16 v[88:103], v[20:23], v[128:131], v[88:103]
    ds_read_b64_tr_b16 v[16:17], v7 offset:2048
    ds_read_b64_tr_b16 v[18:19], v7 offset:3072
    s_waitcnt lgkmcnt(6)
    v_mfma_f32_32x32x16_bf16 v[72:87], v[24:27], v[132:135], v[72:87]
    ds_read_b64_tr_b16 v[20:21], v8 offset:2048
    ds_read_b64_tr_b16 v[22:23], v8 offset:3072
    buffer_load_dwordx4 v[188:191], v1, s[4:7], s74 offen offset:1024 sc0 sc1
    v_mfma_f32_32x32x16_bf16 v[88:103], v[28:31], v[132:135], v[88:103]
    ds_read_b64_tr_b16 v[24:25], v7 offset:4096
    ds_read_b64_tr_b16 v[26:27], v7 offset:5120
    buffer_load_dwordx4 v3, s[12:15], s3 offen offset:1024 lds
    s_waitcnt vmcnt(18)
    v_cmp_u_f32 vcc, v136, v140
    s_cbranch_vccnz KT_SLOW7
KT_BACK7:
    s_waitcnt lgkmcnt(6)
    v_mfma_f32_32x32x16_bf16 v[40:55], v[32:35], v[136:139], v[40:55]
    ds_read_b64_tr_b16 v[28:29], v8 offset:4096
    ds_read_b64_tr_b16 v[30:31], v8 offset:5120
    buffer_load_dwordx4 v[192:195], v1, s[4:7], s74 offen offset:2048 sc0 sc1
    v_mfma_f32_32x32x16_bf16 v[56:71], v[36:39], v[136:139], v[56:71]
    ds_read_b64_tr_b16 v[32:33], v7 offset:6144
    ds_read_b64_tr_b16 v[34:35], v7 offset:7168
    s_waitcnt lgkmcnt(6)
    v_mfma_f32_32x32x16_bf16 v[40:55], v[16:19], v[140:143], v[40:55]
    ds_read_b64_tr_b16 v[36:37], v8 offset:6144
    ds_read_b64_tr_b16 v[38:39], v8 offset:7168
    buffer_load_dwordx4 v[196:199], v1, s[4:7], s74 offen offset:3072 sc0 sc1
    s_add_u32 s74, s74, 4096
    v_mfma_f32_32x32x16_bf16 v[56:71], v[20:23], v[140:143], v[56:71]
    ds_read_b64_tr_b16 v[16:17], v7 offset:8192
    ds_read_b64_tr_b16 v[18:19], v7 offset:9216
    buffer_load_dwordx4 v4, s[12:15], s3 offen offset:2048 lds
    s_waitcnt lgkmcnt(6)
    v_mfma_f32_32x32x16_bf16 v[72:87], v[24:27], v[136:139], v[72:87]
    ds_read_b64_tr_b16 v[20:21], v8 offset:8192
    ds_read_b64_tr_b16 v[22:23], v8 offset:9216
    buffer_load_dwordx4 v[200:203], v1, s[4:7], s74 offen offset:0 sc0 sc1
    v_mfma_f32_32x32x16_bf16 v[88:103], v[28:31], v[136:139], v[88:103]
    ds_read_b64_tr_b16 v[24:25], v7 offset:10240
    ds_read_b64_tr_b16 v[26:27], v7 offset:11264
    s_waitcnt lgkmcnt(6)
    v_mfma_f32_32x32x16_bf16 v[72:87], v[32:35], v[140:143], v[72:87]
    ds_read_b64_tr_b16 v[28:29], v8 offset:10240
    ds_read_b64_tr_b16 v[30:31], v8 offset:11264
    buffer_load_dwordx4 v[204:207], v1, s[4:7], s74 offen offset:1024 sc0 sc1
    v_mfma_f32_32x32x16_bf16 v[88:103], v[36:39], v[140:143], v[88:103]
    ds_read_b64_tr_b16 v[32:33], v7 offset:12288
    ds_read_b64_tr_b16 v[34:35], v7 offset:13312
    buffer_load_dwordx4 v5, s[12:15], s3 offen offset:3072 lds
    s_waitcnt vmcnt(22)
    v_cmp_u_f32 vcc, v144, v148
    s_cbranch_vccnz KT_SLOW8
KT_BACK8:
    s_waitcnt lgkmcnt(6)
    v_mfma_f32_32x32x16_bf16 v[40:55], v[16:19], v[144:147], v[40:55]
    ds_read_b64_tr_b16 v[36:37], v8 offset:12288
    ds_read_b64_tr_b16 v[38:39], v8 offset:13312
    buffer_load_dwordx4 v[208:211], v1, s[4:7], s74 offen offset:2048 sc0 sc1
    v_mfma_f32_32x32x16_bf16 v[56:71], v[20:23], v[144:147], v[56:71]
    ds_read_b64_tr_b16 v[16:17], v7 offset:14336
    ds_read_b64_tr_b16 v[18:19], v7 offset:15360
    s_waitcnt lgkmcnt(6)
    v_mfma_f32_32x32x16_bf16 v[40:55], v[24:27], v[148:151], v[40:55]
    ds_read_b64_tr_b16 v[20:21], v8 offset:14336
    ds_read_b64_tr_b16 v[22:23], v8 offset:15360
    buffer_load_dwordx4 v[212:215], v1, s[4:7], s74 offen offset:3072 sc0 sc1
    s_add_u32 s74, s74, 4096
    v_mfma_f32_32x32x16_bf16 v[56:71], v[28:31], v[148:151], v[56:71]
    s_barrier
    ds_read_b64_tr_b16 v[24:25], v7 offset:16384
    ds_read_b64_tr_b16 v[26:27], v7 offset:17408
    s_add_u32 m0, s38, 49152
    s_add_u32 s3, s45, 3539200
    buffer_load_dwordx4 v2, s[12:15], s3 offen offset:0 lds
    s_waitcnt lgkmcnt(6)
    v_mfma_f32_32x32x16_bf16 v[72:87], v[32:35], v[144:147], v[72:87]
    ds_read_b64_tr_b16 v[28:29], v8 offset:16384
    ds_read_b64_tr_b16 v[30:31], v8 offset:17408
    buffer_load_dwordx4 v[216:219], v1, s[4:7], s74 offen offset:0 sc0 sc1
    v_mfma_f32_32x32x16_bf16 v[88:103], v[36:39], v[144:147], v[88:103]
    ds_read_b64_tr_b16 v[32:33], v7 offset:18432
    ds_read_b64_tr_b16 v[34:35], v7 offset:19456
    s_waitcnt lgkmcnt(6)
    v_mfma_f32_32x32x16_bf16 v[72:87], v[16:19], v[148:151], v[72:87]
    ds_read_b64_tr_b16 v[36:37], v8 offset:18432
    ds_read_b64_tr_b16 v[38:39], v8 offset:19456
    buffer_load_dwordx4 v[220:223], v1, s[4:7], s74 offen offset:1024 sc0 sc1
    v_mfma_f32_32x32x16_bf16 v[88:103], v[20:23], v[148:151], v[88:103]
    ds_read_b64_tr_b16 v[16:17], v7 offset:20480
    ds_read_b64_tr_b16 v[18:19], v7 offset:21504
    buffer_load_dwordx4 v3, s[12:15], s3 offen offset:1024 lds
    s_waitcnt vmcnt(25)
    v_cmp_u_f32 vcc, v152, v156
    s_cbranch_vccnz KT_SLOW9
KT_BACK9:
    s_waitcnt lgkmcnt(6)
    v_mfma_f32_32x32x16_bf16 v[40:55], v[24:27], v[152:155], v[40:55]
    ds_read_b64_tr_b16 v[20:21], v8 offset:20480
    ds_read_b64_tr_b16 v[22:23], v8 offset:21504
    buffer_load_dwordx4 v[224:227], v1, s[4:7], s74 offen offset:2048 sc0 sc1
    v_mfma_f32_32x32x16_bf16 v[56:71], v[28:31], v[152:155], v[56:71]
    ds_read_b64_tr_b16 v[24:25], v7 offset:22528
    ds_read_b64_tr_b16 v[26:27], v7 offset:23552
    s_waitcnt lgkmcnt(6)
    v_mfma_f32_32x32x16_bf16 v[40:55], v[32:35], v[156:159], v[40:55]
    ds_read_b64_tr_b16 v[28:29], v8 offset:22528
    ds_read_b64_tr_b16 v[30:31], v8 offset:23552
    buffer_load_dwordx4 v[228:231], v1, s[4:7], s74 offen offset:3072 sc0 sc1
    s_add_u32 s74, s74, 4096
    v_mfma_f32_32x32x16_bf16 v[56:71], v[36:39], v[156:159], v[56:71]
    ds_read_b64_tr_b16 v[32:33], v7 offset:24576
    ds_read_b64_tr_b16 v[34:35], v7 offset:25600
    buffer_load_dwordx4 v4, s[12:15], s3 offen offset:2048 lds
    s_waitcnt lgkmcnt(6)
    v_mfma_f32_32x32x16_bf16 v[72:87], v[16:19], v[152:155], v[72:87]
    ds_read_b64_tr_b16 v[36:37], v8 offset:24576
    ds_read_b64_tr_b16 v[38:39], v8 offset:25600
    buffer_load_dwordx4 v[232:235], v1, s[4:7], s74 offen offset:0 sc0 sc1
    v_mfma_f32_32x32x16_bf16 v[88:103], v[20:23], v[152:155], v[88:103]
    ds_read_b64_tr_b16 v[16:17], v7 offset:26624
    ds_read_b64_tr_b16 v[18:19], v7 offset:27648
    s_waitcnt lgkmcnt(6)
    v_mfma_f32_32x32x16_bf16 v[72:87], v[24:27], v[156:159], v[72:87]
    ds_read_b64_tr_b16 v[20:21], v8 offset:26624
    ds_read_b64_tr_b16 v[22:23], v8 offset:27648
    buffer_load_dwordx4 v[236:239], v1, s[4:7], s74 offen offset:1024 sc0 sc1
    v_mfma_f32_32x32x16_bf16 v[88:103], v[28:31], v[156:159], v[88:103]
    ds_read_b64_tr_b16 v[24:25], v7 offset:28672
    ds_read_b64_tr_b16 v[26:27], v7 offset:29696
    buffer_load_dwordx4 v5, s[12:15], s3 offen offset:3072 lds
    s_waitcnt vmcnt(28)
    v_cmp_u_f32 vcc, v160, v164
    s_cbranch_vccnz KT_SLOW10
KT_BACK10:
    s_waitcnt lgkmcnt(6)
    v_mfma_f32_32x32x16_bf16 v[40:55], v[32:35], v[160:163], v[40:55]
    ds_read_b64_tr_b16 v[28:29], v8 offset:28672
    ds_read_b64_tr_b16 v[30:31], v8 offset:29696
    buffer_load_dwordx4 v[240:243], v1, s[4:7], s74 offen offset:2048 sc0 sc1
    v_mfma_f32_32x32x16_bf16 v[56:71], v[36:39], v[160:163], v[56:71]
    ds_read_b64_tr_b16 v[32:33], v7 offset:30720
    ds_read_b64_tr_b16 v[34:35], v7 offset:31744
    s_waitcnt lgkmcnt(6)
    v_mfma_f32_32x32x16_bf16 v[40:55], v[16:19], v[164:167], v[40:55]
    ds_read_b64_tr_b16 v[36:37], v8 offset:30720
    ds_read_b64_tr_b16 v[38:39], v8 offset:31744
    buffer_load_dwordx4 v[244:247], v1, s[4:7], s74 offen offset:3072 sc0 sc1
    s_add_u32 s74, s74, 4096
    v_mfma_f32_32x32x16_bf16 v[56:71], v[20:23], v[164:167], v[56:71]
    s_barrier
    v_add_u32 v7, 4294950912, v7
    ds_read_b64_tr_b16 v[16:17], v7 offset:0
    ds_read_b64_tr_b16 v[18:19], v7 offset:1024
    s_add_u32 m0, s38, 65536
    s_add_u32 s3, s46, 4718848
    buffer_load_dwordx4 v2, s[12:15], s3 offen offset:0 lds
    s_waitcnt lgkmcnt(6)
    v_mfma_f32_32x32x16_bf16 v[72:87], v[24:27], v[160:163], v[72:87]
    v_add_u32 v8, 4294950912, v8
    ds_read_b64_tr_b16 v[20:21], v8 offset:0
    ds_read_b64_tr_b16 v[22:23], v8 offset:1024
    v_mfma_f32_32x32x16_bf16 v[88:103], v[28:31], v[160:163], v[88:103]
    ds_read_b64_tr_b16 v[24:25], v7 offset:2048
    ds_read_b64_tr_b16 v[26:27], v7 offset:3072
    s_waitcnt lgkmcnt(6)
    v_mfma_f32_32x32x16_bf16 v[72:87], v[32:35], v[164:167], v[72:87]
    ds_read_b64_tr_b16 v[28:29], v8 offset:2048
    ds_read_b64_tr_b16 v[30:31], v8 offset:3072
    buffer_load_dwordx4 v3, s[12:15], s3 offen offset:1024 lds
    v_mfma_f32_32x32x16_bf16 v[88:103], v[36:39], v[164:167], v[88:103]
    ds_read_b64_tr_b16 v[32:33], v7 offset:4096
    ds_read_b64_tr_b16 v[34:35], v7 offset:5120
    s_waitcnt vmcnt(29)
    v_cmp_u_f32 vcc, v168, v172
    s_cbranch_vccnz KT_SLOW11
KT_BACK11:
    s_waitcnt lgkmcnt(6)
    v_mfma_f32_32x32x16_bf16 v[40:55], v[16:19], v[168:171], v[40:55]
    ds_read_b64_tr_b16 v[36:37], v8 offset:4096
    ds_read_b64_tr_b16 v[38:39], v8 offset:5120
    v_mfma_f32_32x32x16_bf16 v[56:71], v[20:23], v[168:171], v[56:71]
    ds_read_b64_tr_b16 v[16:17], v7 offset:6144
    ds_read_b64_tr_b16 v[18:19], v7 offset:7168
    buffer_load_dwordx4 v4, s[12:15], s3 offen offset:2048 lds
    s_waitcnt lgkmcnt(6)
    v_mfma_f32_32x32x16_bf16 v[40:55], v[24:27], v[172:175], v[40:55]
    ds_read_b64_tr_b16 v[20:21], v8 offset:6144
    ds_read_b64_tr_b16 v[22:23], v8 offset:7168
    v_mfma_f32_32x32x16_bf16 v[56:71], v[28:31], v[172:175], v[56:71]
    ds_read_b64_tr_b16 v[24:25], v7 offset:8192
    ds_read_b64_tr_b16 v[26:27], v7 offset:9216
    s_waitcnt lgkmcnt(6)
    v_mfma_f32_32x32x16_bf16 v[72:87], v[32:35], v[168:171], v[72:87]
    ds_read_b64_tr_b16 v[28:29], v8 offset:8192
    ds_read_b64_tr_b16 v[30:31], v8 offset:9216
    buffer_load_dwordx4 v5, s[12:15], s3 offen offset:3072 lds
    v_mfma_f32_32x32x16_bf16 v[88:103], v[36:39], v[168:171], v[88:103]
    ds_read_b64_tr_b16 v[32:33], v7 offset:10240
    ds_read_b64_tr_b16 v[34:35], v7 offset:11264
    s_waitcnt lgkmcnt(6)
    v_mfma_f32_32x32x16_bf16 v[72:87], v[16:19], v[172:175], v[72:87]
    ds_read_b64_tr_b16 v[36:37], v8 offset:10240
    ds_read_b64_tr_b16 v[38:39], v8 offset:11264
    v_mfma_f32_32x32x16_bf16 v[88:103], v[20:23], v[172:175], v[88:103]
    ds_read_b64_tr_b16 v[16:17], v7 offset:12288
    ds_read_b64_tr_b16 v[18:19], v7 offset:13312
    s_waitcnt vmcnt(28)
    v_cmp_u_f32 vcc, v176, v180
    s_cbranch_vccnz KT_SLOW12
KT_BACK12:
    s_waitcnt lgkmcnt(6)
    v_mfma_f32_32x32x16_bf16 v[40:55], v[24:27], v[176:179], v[40:55]
    ds_read_b64_tr_b16 v[20:21], v8 offset:12288
    ds_read_b64_tr_b16 v[22:23], v8 offset:13312
    v_mfma_f32_32x32x16_bf16 v[56:71], v[28:31], v[176:179], v[56:71]
    ds_read_b64_tr_b16 v[24:25], v7 offset:14336
    ds_read_b64_tr_b16 v[26:27], v7 offset:15360
    s_waitcnt lgkmcnt(6)
    v_mfma_f32_32x32x16_bf16 v[40:55], v[32:35], v[180:183], v[40:55]
    ds_read_b64_tr_b16 v[28:29], v8 offset:14336
    ds_read_b64_tr_b16 v[30:31], v8 offset:15360
    v_mfma_f32_32x32x16_bf16 v[56:71], v[36:39], v[180:183], v[56:71]
    s_barrier
    ds_read_b64_tr_b16 v[32:33], v7 offset:49152
    ds_read_b64_tr_b16 v[34:35], v7 offset:50176
    s_add_u32 m0, s38, 32768
    s_add_u32 s3, s45, 590208
    buffer_load_dwordx4 v2, s[12:15], s3 offen offset:0 lds
    s_waitcnt lgkmcnt(6)
    v_mfma_f32_32x32x16_bf16 v[72:87], v[16:19], v[176:179], v[72:87]
    ds_read_b64_tr_b16 v[36:37], v8 offset:49152
    ds_read_b64_tr_b16 v[38:39], v8 offset:50176
    v_mfma_f32_32x32x16_bf16 v[88:103], v[20:23], v[176:179], v[88:103]
    ds_read_b64_tr_b16 v[16:17], v7 offset:51200
    ds_read_b64_tr_b16 v[18:19], v7 offset:52224
    s_waitcnt lgkmcnt(6)
    v_mfma_f32_32x32x16_bf16 v[72:87], v[24:27], v[180:183], v[72:87]
    ds_read_b64_tr_b16 v[20:21], v8 offset:51200
    ds_read_b64_tr_b16 v[22:23], v8 offset:52224
    buffer_load_dwordx4 v3, s[12:15], s3 offen offset:1024 lds
    v_mfma_f32_32x32x16_bf16 v[88:103], v[28:31], v[180:183], v[88:103]
    ds_read_b64_tr_b16 v[24:25], v7 offset:53248
    ds_read_b64_tr_b16 v[26:27], v7 offset:54272
    s_waitcnt vmcnt(27)
    v_cmp_u_f32 vcc, v184, v188
    s_cbranch_vccnz KT_SLOW13
KT_BACK13:
    s_waitcnt lgkmcnt(6)
    v_mfma_f32_32x32x16_bf16 v[40:55], v[32:35], v[184:187], v[40:55]
    ds_read_b64_tr_b16 v[28:29], v8 offset:53248
    ds_read_b64_tr_b16 v[30:31], v8 offset:54272
    v_mfma_f32_32x32x16_bf16 v[56:71], v[36:39], v[184:187], v[56:71]
    ds_read_b64_tr_b16 v[32:33], v7 offset:55296
    ds_read_b64_tr_b16 v[34:35], v7 offset:56320
    buffer_load_dwordx4 v4, s[12:15], s3 offen offset:2048 lds
    s_waitcnt lgkmcnt(6)
    v_mfma_f32_32x32x16_bf16 v[40:55], v[16:19], v[188:191], v[40:55]
    ds_read_b64_tr_b16 v[36:37], v8 offset:55296
    ds_read_b64_tr_b16 v[38:39], v8 offset:56320
    v_mfma_f32_32x32x16_bf16 v[56:71], v[20:23], v[188:191], v[56:71]
    ds_read_b64_tr_b16 v[16:17], v7 offset:57344
    ds_read_b64_tr_b16 v[18:19], v7 offset:58368
    s_waitcnt vmcnt(25)
    v_cmp_u_f32 vcc, v192, v196
    s_cbranch_vccnz KT_SLOW14
KT_BACK14:
    s_waitcnt lgkmcnt(6)
    v_mfma_f32_32x32x16_bf16 v[40:55], v[24:27], v[192:195], v[40:55]
    ds_read_b64_tr_b16 v[20:21], v8 offset:57344
    ds_read_b64_tr_b16 v[22:23], v8 offset:58368
    buffer_load_dwordx4 v5, s[12:15], s3 offen offset:3072 lds
    v_mfma_f32_32x32x16_bf16 v[56:71], v[28:31], v[192:195], v[56:71]
    ds_read_b64_tr_b16 v[24:25], v7 offset:59392
    ds_read_b64_tr_b16 v[26:27], v7 offset:60416
    s_waitcnt lgkmcnt(6)
    v_mfma_f32_32x32x16_bf16 v[40:55], v[32:35], v[196:199], v[40:55]
    ds_read_b64_tr_b16 v[28:29], v8 offset:59392
    ds_read_b64_tr_b16 v[30:31], v8 offset:60416
    v_mfma_f32_32x32x16_bf16 v[56:71], v[36:39], v[196:199], v[56:71]
    ds_read_b64_tr_b16 v[32:33], v7 offset:61440
    ds_read_b64_tr_b16 v[34:35], v7 offset:62464
    s_waitcnt vmcnt(23)
    v_cmp_u_f32 vcc, v200, v204
    s_cbranch_vccnz KT_SLOW15
KT_BACK15:
    s_waitcnt lgkmcnt(6)
    v_mfma_f32_32x32x16_bf16 v[40:55], v[16:19], v[200:203], v[40:55]
    ds_read_b64_tr_b16 v[36:37], v8 offset:61440
    ds_read_b64_tr_b16 v[38:39], v8 offset:62464
    v_mfma_f32_32x32x16_bf16 v[56:71], v[20:23], v[200:203], v[56:71]
    ds_read_b64_tr_b16 v[16:17], v7 offset:63488
    ds_read_b64_tr_b16 v[18:19], v7 offset:64512
    s_waitcnt lgkmcnt(6)
    v_mfma_f32_32x32x16_bf16 v[40:55], v[24:27], v[204:207], v[40:55]
    ds_read_b64_tr_b16 v[20:21], v8 offset:63488
    ds_read_b64_tr_b16 v[22:23], v8 offset:64512
    v_mfma_f32_32x32x16_bf16 v[56:71], v[28:31], v[204:207], v[56:71]
    s_barrier
    v_add_u32 v7, 4294934528, v7
    ds_read_b64_tr_b16 v[24:25], v7 offset:0
    ds_read_b64_tr_b16 v[26:27], v7 offset:1024
    s_add_u32 m0, s38, 81920
    s_add_u32 s3, s45, 1769856
    buffer_load_dwordx4 v2, s[12:15], s3 offen offset:0 lds
    s_waitcnt vmcnt(21)
    v_cmp_u_f32 vcc, v208, v212
    s_cbranch_vccnz KT_SLOW16
KT_BACK16:
    s_waitcnt lgkmcnt(6)
    v_mfma_f32_32x32x16_bf16 v[40:55], v[32:35], v[208:211], v[40:55]
    v_add_u32 v8, 4294934528, v8
    ds_read_b64_tr_b16 v[28:29], v8 offset:0
    ds_read_b64_tr_b16 v[30:31], v8 offset:1024
    v_mfma_f32_32x32x16_bf16 v[56:71], v[36:39], v[208:211], v[56:71]
    ds_read_b64_tr_b16 v[32:33], v7 offset:2048
    ds_read_b64_tr_b16 v[34:35], v7 offset:3072
    s_waitcnt lgkmcnt(6)
    v_mfma_f32_32x32x16_bf16 v[40:55], v[16:19], v[212:215], v[40:55]
    ds_read_b64_tr_b16 v[36:37], v8 offset:2048
    ds_read_b64_tr_b16 v[38:39], v8 offset:3072
    buffer_load_dwordx4 v3, s[12:15], s3 offen offset:1024 lds
    v_mfma_f32_32x32x16_bf16 v[56:71], v[20:23], v[212:215], v[56:71]
    ds_read_b64_tr_b16 v[16:17], v7 offset:4096
    ds_read_b64_tr_b16 v[18:19], v7 offset:5120
    s_waitcnt vmcnt(19)
    v_cmp_u_f32 vcc, v216, v220
    s_cbranch_vccnz KT_SLOW17
KT_BACK17:
    s_waitcnt lgkmcnt(6)
    v_mfma_f32_32x32x16_bf16 v[40:55], v[24:27], v[216:219], v[40:55]
    ds_read_b64_tr_b16 v[20:21], v8 offset:4096
    ds_read_b64_tr_b16 v[22:23], v8 offset:5120
    v_mfma_f32_32x32x16_bf16 v[56:71], v[28:31], v[216:219], v[56:71]
    ds_read_b64_tr_b16 v[24:25], v7 offset:6144
    ds_read_b64_tr_b16 v[26:27], v7 offset:7168
    buffer_load_dwordx4 v4, s[12:15], s3 offen offset:2048 lds
    s_waitcnt lgkmcnt(6)
    v_mfma_f32_32x32x16_bf16 v[40:55], v[32:35], v[220:223], v[40:55]
    ds_read_b64_tr_b16 v[28:29], v8 offset:6144
    ds_read_b64_tr_b16 v[30:31], v8 offset:7168
    v_mfma_f32_32x32x16_bf16 v[56:71], v[36:39], v[220:223], v[56:71]
    ds_read_b64_tr_b16 v[32:33], v7 offset:8192
    ds_read_b64_tr_b16 v[34:35], v7 offset:9216
    s_waitcnt vmcnt(17)
    v_cmp_u_f32 vcc, v224, v228
    s_cbranch_vccnz KT_SLOW18
KT_BACK18:
    s_waitcnt lgkmcnt(6)
    v_mfma_f32_32x32x16_bf16 v[40:55], v[16:19], v[224:227], v[40:55]
    ds_read_b64_tr_b16 v[36:37], v8 offset:8192
    ds_read_b64_tr_b16 v[38:39], v8 offset:9216
    buffer_load_dwordx4 v5, s[12:15], s3 offen offset:3072 lds
    v_mfma_f32_32x32x16_bf16 v[56:71], v[20:23], v[224:227], v[56:71]
    ds_read_b64_tr_b16 v[16:17], v7 offset:10240
    ds_read_b64_tr_b16 v[18:19], v7 offset:11264
    s_waitcnt lgkmcnt(6)
    v_mfma_f32_32x32x16_bf16 v[40:55], v[24:27], v[228:231], v[40:55]
    ds_read_b64_tr_b16 v[20:21], v8 offset:10240
    ds_read_b64_tr_b16 v[22:23], v8 offset:11264
    v_mfma_f32_32x32x16_bf16 v[56:71], v[28:31], v[228:231], v[56:71]
    ds_read_b64_tr_b16 v[24:25], v7 offset:12288
    ds_read_b64_tr_b16 v[26:27], v7 offset:13312
    s_waitcnt vmcnt(15)
    v_fma_f32 v250, v232, v234, v236
    v_cmp_u_f32 vcc, v250, v238
    s_cbranch_vccnz KT_SLOW19
KT_BACK19:
    s_waitcnt lgkmcnt(6)
    v_mfma_f32_32x32x16_bf16 v[40:55], v[32:35], v[232:235], v[40:55]
    ds_read_b64_tr_b16 v[28:29], v8 offset:12288
    ds_read_b64_tr_b16 v[30:31], v8 offset:13312
    v_mfma_f32_32x32x16_bf16 v[56:71], v[36:39], v[232:235], v[56:71]
    ds_read_b64_tr_b16 v[32:33], v7 offset:14336
    ds_read_b64_tr_b16 v[34:35], v7 offset:15360
    s_waitcnt lgkmcnt(6)
    v_mfma_f32_32x32x16_bf16 v[40:55], v[16:19], v[236:239], v[40:55]
    ds_read_b64_tr_b16 v[36:37], v8 offset:14336
    ds_read_b64_tr_b16 v[38:39], v8 offset:15360
    v_mfma_f32_32x32x16_bf16 v[56:71], v[20:23], v[236:239], v[56:71]
    s_barrier
    v_add_u32 v7, 98304, v7
    ds_read_b64_tr_b16 v[16:17], v7 offset:0
    ds_read_b64_tr_b16 v[18:19], v7 offset:1024
    s_add_u32 m0, s38, 0
    s_add_u32 s3, s45, 2949504
    buffer_load_dwordx4 v2, s[12:15], s3 offen offset:0 lds
    s_waitcnt vmcnt(13)
    v_fma_f32 v250, v240, v242, v244
    v_cmp_u_f32 vcc, v250, v246
    s_cbranch_vccnz KT_SLOW20
KT_BACK20:
    s_waitcnt lgkmcnt(6)
    v_mfma_f32_32x32x16_bf16 v[40:55], v[24:27], v[240:243], v[40:55]
    v_add_u32 v8, 98304, v8
    ds_read_b64_tr_b16 v[20:21], v8 offset:0
    ds_read_b64_tr_b16 v[22:23], v8 offset:1024
    v_mfma_f32_32x32x16_bf16 v[56:71], v[28:31], v[240:243], v[56:71]
    ds_read_b64_tr_b16 v[24:25], v7 offset:2048
    ds_read_b64_tr_b16 v[26:27], v7 offset:3072
    s_waitcnt lgkmcnt(6)
    v_mfma_f32_32x32x16_bf16 v[40:55], v[32:35], v[244:247], v[40:55]
    ds_read_b64_tr_b16 v[28:29], v8 offset:2048
    ds_read_b64_tr_b16 v[30:31], v8 offset:3072
    buffer_load_dwordx4 v3, s[12:15], s3 offen offset:1024 lds
    v_mfma_f32_32x32x16_bf16 v[56:71], v[36:39], v[244:247], v[56:71]
    ds_read_b64_tr_b16 v[32:33], v7 offset:4096
    ds_read_b64_tr_b16 v[34:35], v7 offset:5120
    s_waitcnt lgkmcnt(6)
    v_mfma_f32_32x32x16_bf16 v[72:87], v[16:19], v[184:187], v[72:87]
    ds_read_b64_tr_b16 v[36:37], v8 offset:4096
    ds_read_b64_tr_b16 v[38:39], v8 offset:5120
    v_mfma_f32_32x32x16_bf16 v[88:103], v[20:23], v[184:187], v[88:103]
    ds_read_b64_tr_b16 v[16:17], v7 offset:6144
    ds_read_b64_tr_b16 v[18:19], v7 offset:7168
    buffer_load_dwordx4 v4, s[12:15], s3 offen offset:2048 lds
    v_cvt_pk_bf16_f32 v40, v40, v41
    v_cvt_pk_bf16_f32 v41, v42, v43
    v_cvt_pk_bf16_f32 v42, v44, v45
    s_waitcnt lgkmcnt(6)
    v_mfma_f32_32x32x16_bf16 v[72:87], v[24:27], v[188:191], v[72:87]
    ds_read_b64_tr_b16 v[20:21], v8 offset:6144
    ds_read_b64_tr_b16 v[22:23], v8 offset:7168
    v_cvt_pk_bf16_f32 v43, v46, v47
    v_pk_max_i16 v40, v40, 0
    v_pk_max_i16 v41, v41, 0
    v_mfma_f32_32x32x16_bf16 v[88:103], v[28:31], v[188:191], v[88:103]
    ds_read_b64_tr_b16 v[24:25], v7 offset:8192
    ds_read_b64_tr_b16 v[26:27], v7 offset:9216
    v_pk_max_i16 v42, v42, 0
    v_pk_max_i16 v43, v43, 0
    v_accvgpr_write_b32 a0, v40
    v_accvgpr_write_b32 a1, v41
    s_waitcnt lgkmcnt(6)
    v_mfma_f32_32x32x16_bf16 v[72:87], v[32:35], v[192:195], v[72:87]
    ds_read_b64_tr_b16 v[28:29], v8 offset:8192
    ds_read_b64_tr_b16 v[30:31], v8 offset:9216
    buffer_load_dwordx4 v5, s[12:15], s3 offen offset:3072 lds
    v_accvgpr_write_b32 a2, v42
    v_accvgpr_write_b32 a3, v43
    v_mfma_f32_32x32x16_bf16 v[88:103], v[36:39], v[192:195], v[88:103]
    ds_read_b64_tr_b16 v[32:33], v7 offset:10240
    ds_read_b64_tr_b16 v[34:35], v7 offset:11264
    v_cvt_pk_bf16_f32 v48, v48, v49
    v_cvt_pk_bf16_f32 v49, v50, v51
    v_cvt_pk_bf16_f32 v50, v52, v53
    v_cvt_pk_bf16_f32 v51, v54, v55
    s_waitcnt lgkmcnt(6)
    v_mfma_f32_32x32x16_bf16 v[72:87], v[16:19], v[196:199], v[72:87]
    ds_read_b64_tr_b16 v[36:37], v8 offset:10240
    ds_read_b64_tr_b16 v[38:39], v8 offset:11264
    v_pk_max_i16 v48, v48, 0
    v_pk_max_i16 v49, v49, 0
    v_pk_max_i16 v50, v50, 0
    v_mfma_f32_32x32x16_bf16 v[88:103], v[20:23], v[196:199], v[88:103]
    ds_read_b64_tr_b16 v[16:17], v7 offset:12288
    ds_read_b64_tr_b16 v[18:19], v7 offset:13312
    v_pk_max_i16 v51, v51, 0
    v_accvgpr_write_b32 a4, v48
    v_accvgpr_write_b32 a5, v49
    v_accvgpr_write_b32 a6, v50
    s_waitcnt lgkmcnt(6)
    v_mfma_f32_32x32x16_bf16 v[72:87], v[24:27], v[200:203], v[72:87]
    ds_read_b64_tr_b16 v[20:21], v8 offset:12288
    ds_read_b64_tr_b16 v[22:23], v8 offset:13312
    v_accvgpr_write_b32 a7, v51
    v_cvt_pk_bf16_f32 v56, v56, v57
    v_cvt_pk_bf16_f32 v57, v58, v59
    v_mfma_f32_32x32x16_bf16 v[88:103], v[28:31], v[200:203], v[88:103]
    ds_read_b64_tr_b16 v[24:25], v7 offset:14336
    ds_read_b64_tr_b16 v[26:27], v7 offset:15360
    v_cvt_pk_bf16_f32 v58, v60, v61
    v_cvt_pk_bf16_f32 v59, v62, v63
    v_pk_max_i16 v56, v56, 0
    v_pk_max_i16 v57, v57, 0
    s_waitcnt lgkmcnt(6)
    v_mfma_f32_32x32x16_bf16 v[72:87], v[32:35], v[204:207], v[72:87]
    ds_read_b64_tr_b16 v[28:29], v8 offset:14336
    ds_read_b64_tr_b16 v[30:31], v8 offset:15360
    v_pk_max_i16 v58, v58, 0
    v_pk_max_i16 v59, v59, 0
    v_accvgpr_write_b32 a8, v56
    v_mfma_f32_32x32x16_bf16 v[88:103], v[36:39], v[204:207], v[88:103]
    s_barrier
    ds_read_b64_tr_b16 v[32:33], v7 offset:16384
    ds_read_b64_tr_b16 v[34:35], v7 offset:17408
    s_add_u32 m0, s38, 98304
    s_add_u32 s3, s45, 4129152
    buffer_load_dwordx4 v2, s[12:15], s3 offen offset:0 lds
    s_waitcnt lgkmcnt(6)
    v_mfma_f32_32x32x16_bf16 v[72:87], v[16:19], v[208:211], v[72:87]
    ds_read_b64_tr_b16 v[36:37], v8 offset:16384
    ds_read_b64_tr_b16 v[38:39], v8 offset:17408
    v_accvgpr_write_b32 a9, v57
    v_accvgpr_write_b32 a10, v58
    v_accvgpr_write_b32 a11, v59
    v_mfma_f32_32x32x16_bf16 v[88:103], v[20:23], v[208:211], v[88:103]
    ds_read_b64_tr_b16 v[16:17], v7 offset:18432
    ds_read_b64_tr_b16 v[18:19], v7 offset:19456
    v_cvt_pk_bf16_f32 v64, v64, v65
    v_cvt_pk_bf16_f32 v65, v66, v67
    v_cvt_pk_bf16_f32 v66, v68, v69
    v_cvt_pk_bf16_f32 v67, v70, v71
    s_waitcnt lgkmcnt(6)
    v_mfma_f32_32x32x16_bf16 v[72:87], v[24:27], v[212:215], v[72:87]
    ds_read_b64_tr_b16 v[20:21], v8 offset:18432
    ds_read_b64_tr_b16 v[22:23], v8 offset:19456
    buffer_load_dwordx4 v3, s[12:15], s3 offen offset:1024 lds
    v_pk_max_i16 v64, v64, 0
    v_pk_max_i16 v65, v65, 0
    v_mfma_f32_32x32x16_bf16 v[88:103], v[28:31], v[212:215], v[88:103]
    ds_read_b64_tr_b16 v[24:25], v7 offset:20480
    ds_read_b64_tr_b16 v[26:27], v7 offset:21504
    v_pk_max_i16 v66, v66, 0
    v_pk_max_i16 v67, v67, 0
    v_accvgpr_write_b32 a12, v64
    v_accvgpr_write_b32 a13, v65
    s_waitcnt lgkmcnt(6)
    v_mfma_f32_32x32x16_bf16 v[72:87], v[32:35], v[216:219], v[72:87]
    ds_read_b64_tr_b16 v[28:29], v8 offset:20480
    ds_read_b64_tr_b16 v[30:31], v8 offset:21504
    v_accvgpr_write_b32 a14, v66
    v_accvgpr_write_b32 a15, v67
    v_mfma_f32_32x32x16_bf16 v[88:103], v[36:39], v[216:219], v[88:103]
    ds_read_b64_tr_b16 v[32:33], v7 offset:22528
    ds_read_b64_tr_b16 v[34:35], v7 offset:23552
    buffer_load_dwordx4 v4, s[12:15], s3 offen offset:2048 lds
    s_waitcnt lgkmcnt(6)
    v_mfma_f32_32x32x16_bf16 v[72:87], v[16:19], v[220:223], v[72:87]
    ds_read_b64_tr_b16 v[36:37], v8 offset:22528
    ds_read_b64_tr_b16 v[38:39], v8 offset:23552
    v_mfma_f32_32x32x16_bf16 v[88:103], v[20:23], v[220:223], v[88:103]
    ds_read_b64_tr_b16 v[16:17], v7 offset:24576
    ds_read_b64_tr_b16 v[18:19], v7 offset:25600
    s_waitcnt lgkmcnt(6)
    v_mfma_f32_32x32x16_bf16 v[72:87], v[24:27], v[224:227], v[72:87]
    ds_read_b64_tr_b16 v[20:21], v8 offset:24576
    ds_read_b64_tr_b16 v[22:23], v8 offset:25600
    buffer_load_dwordx4 v5, s[12:15], s3 offen offset:3072 lds
    v_mfma_f32_32x32x16_bf16 v[88:103], v[28:31], v[224:227], v[88:103]
    ds_read_b64_tr_b16 v[24:25], v7 offset:26624
    ds_read_b64_tr_b16 v[26:27], v7 offset:27648
    s_waitcnt lgkmcnt(6)
    v_mfma_f32_32x32x16_bf16 v[72:87], v[32:35], v[228:231], v[72:87]
    ds_read_b64_tr_b16 v[28:29], v8 offset:26624
    ds_read_b64_tr_b16 v[30:31], v8 offset:27648
    s_add_u32 s8, s32, 0
    buffer_store_dwordx4 a[0:3], v1, s[4:7], s8 offen offset:0 sc0 sc1
    v_mfma_f32_32x32x16_bf16 v[88:103], v[36:39], v[228:231], v[88:103]
    ds_read_b64_tr_b16 v[32:33], v7 offset:28672
    ds_read_b64_tr_b16 v[34:35], v7 offset:29696
    s_waitcnt lgkmcnt(6)
    v_mfma_f32_32x32x16_bf16 v[72:87], v[16:19], v[232:235], v[72:87]
    ds_read_b64_tr_b16 v[36:37], v8 offset:28672
    ds_read_b64_tr_b16 v[38:39], v8 offset:29696
    v_mfma_f32_32x32x16_bf16 v[88:103], v[20:23], v[232:235], v[88:103]
    ds_read_b64_tr_b16 v[16:17], v7 offset:30720
    ds_read_b64_tr_b16 v[18:19], v7 offset:31744
    s_waitcnt lgkmcnt(6)
    v_mfma_f32_32x32x16_bf16 v[72:87], v[24:27], v[236:239], v[72:87]
    ds_read_b64_tr_b16 v[20:21], v8 offset:30720
    ds_read_b64_tr_b16 v[22:23], v8 offset:31744
    v_mfma_f32_32x32x16_bf16 v[88:103], v[28:31], v[236:239], v[88:103]
    s_barrier
    ds_read_b64_tr_b16 v[24:25], v7 offset:32768
    ds_read_b64_tr_b16 v[26:27], v7 offset:33792
    s_add_u32 m0, s38, 114688
    s_add_u32 s3, s47, 0
    buffer_load_dwordx4 v6, s[12:15], s3 offen lds
    s_waitcnt lgkmcnt(6)
    v_mfma_f32_32x32x16_bf16 v[72:87], v[32:35], v[240:243], v[72:87]
    ds_read_b64_tr_b16 v[28:29], v8 offset:32768
    ds_read_b64_tr_b16 v[30:31], v8 offset:33792
    v_mfma_f32_32x32x16_bf16 v[88:103], v[36:39], v[240:243], v[88:103]
    ds_read_b64_tr_b16 v[32:33], v7 offset:34816
    ds_read_b64_tr_b16 v[34:35], v7 offset:35840
    s_waitcnt lgkmcnt(6)
    v_mfma_f32_32x32x16_bf16 v[72:87], v[16:19], v[244:247], v[72:87]
    ds_read_b64_tr_b16 v[36:37], v8 offset:34816
    ds_read_b64_tr_b16 v[38:39], v8 offset:35840
    buffer_store_dwordx4 a[4:7], v1, s[4:7], s8 offen offset:1024 sc0 sc1
    v_mfma_f32_32x32x16_bf16 v[88:103], v[20:23], v[244:247], v[88:103]
    ds_read_b64_tr_b16 v[16:17], v7 offset:36864
    ds_read_b64_tr_b16 v[18:19], v7 offset:37888
    s_add_u32 m0, s38, 115712
    s_add_u32 s3, s47, 147456
    buffer_load_dwordx4 v6, s[12:15], s3 offen lds
    s_waitcnt lgkmcnt(6)
    v_mfma_f32_32x32x16_bf16 v[40:55], v[24:27], v[104:107], 0
    ds_read_b64_tr_b16 v[20:21], v8 offset:36864
    ds_read_b64_tr_b16 v[22:23], v8 offset:37888
    v_mfma_f32_32x32x16_bf16 v[56:71], v[28:31], v[104:107], 0
    ds_read_b64_tr_b16 v[24:25], v7 offset:38912
    ds_read_b64_tr_b16 v[26:27], v7 offset:39936
    v_cvt_pk_bf16_f32 v72, v72, v73
    v_cvt_pk_bf16_f32 v73, v74, v75
    v_cvt_pk_bf16_f32 v74, v76, v77
    v_cvt_pk_bf16_f32 v75, v78, v79
    s_waitcnt lgkmcnt(6)
    v_mfma_f32_32x32x16_bf16 v[40:55], v[32:35], v[108:111], v[40:55]
    ds_read_b64_tr_b16 v[28:29], v8 offset:38912
    ds_read_b64_tr_b16 v[30:31], v8 offset:39936
    s_add_u32 m0, s38, 116736
    s_add_u32 s3, s47, 294912
    buffer_load_dwordx4 v6, s[12:15], s3 offen lds
    v_mfma_f32_32x32x16_bf16 v[56:71], v[36:39], v[108:111], v[56:71]
    ds_read_b64_tr_b16 v[32:33], v7 offset:40960
    ds_read_b64_tr_b16 v[34:35], v7 offset:41984
    v_pk_max_i16 v72, v72, 0
    v_pk_max_i16 v73, v73, 0
    v_pk_max_i16 v74, v74, 0
    v_pk_max_i16 v75, v75, 0
    s_waitcnt lgkmcnt(6)
    v_mfma_f32_32x32x16_bf16 v[40:55], v[16:19], v[112:115], v[40:55]
    ds_read_b64_tr_b16 v[36:37], v8 offset:40960
    ds_read_b64_tr_b16 v[38:39], v8 offset:41984
    v_accvgpr_write_b32 a64, v72
    v_accvgpr_write_b32 a65, v73
    v_accvgpr_write_b32 a66, v74
    v_mfma_f32_32x32x16_bf16 v[56:71], v[20:23], v[112:115], v[56:71]
    ds_read_b64_tr_b16 v[16:17], v7 offset:43008
    ds_read_b64_tr_b16 v[18:19], v7 offset:44032
    s_add_u32 m0, s38, 117760
    s_add_u32 s3, s47, 442368
    buffer_load_dwordx4 v6, s[12:15], s3 offen lds
    v_accvgpr_write_b32 a67, v75
    s_waitcnt lgkmcnt(6)
    v_mfma_f32_32x32x16_bf16 v[40:55], v[24:27], v[116:119], v[40:55]
    ds_read_b64_tr_b16 v[20:21], v8 offset:43008
    ds_read_b64_tr_b16 v[22:23], v8 offset:44032
    buffer_store_dwordx4 a[8:11], v1, s[4:7], s8 offen offset:2048 sc0 sc1
    v_cvt_pk_bf16_f32 v80, v80, v81
    v_cvt_pk_bf16_f32 v81, v82, v83
    v_mfma_f32_32x32x16_bf16 v[56:71], v[28:31], v[116:119], v[56:71]
    ds_read_b64_tr_b16 v[24:25], v7 offset:45056
    ds_read_b64_tr_b16 v[26:27], v7 offset:46080
    v_cvt_pk_bf16_f32 v82, v84, v85
    v_cvt_pk_bf16_f32 v83, v86, v87
    v_pk_max_i16 v80, v80, 0
    v_pk_max_i16 v81, v81, 0
    s_waitcnt lgkmcnt(6)
    v_mfma_f32_32x32x16_bf16 v[40:55], v[32:35], v[120:123], v[40:55]
    ds_read_b64_tr_b16 v[28:29], v8 offset:45056
    ds_read_b64_tr_b16 v[30:31], v8 offset:46080
    v_pk_max_i16 v82, v82, 0
    v_pk_max_i16 v83, v83, 0
    v_accvgpr_write_b32 a68, v80
    v_mfma_f32_32x32x16_bf16 v[56:71], v[36:39], v[120:123], v[56:71]
    ds_read_b64_tr_b16 v[32:33], v7 offset:47104
    ds_read_b64_tr_b16 v[34:35], v7 offset:48128
    v_accvgpr_write_b32 a69, v81
    v_accvgpr_write_b32 a70, v82
    v_accvgpr_write_b32 a71, v83
    v_cvt_pk_bf16_f32 v88, v88, v89
    s_waitcnt lgkmcnt(6)
    v_mfma_f32_32x32x16_bf16 v[40:55], v[16:19], v[124:127], v[40:55]
    ds_read_b64_tr_b16 v[36:37], v8 offset:47104
    ds_read_b64_tr_b16 v[38:39], v8 offset:48128
    v_cvt_pk_bf16_f32 v89, v90, v91
    v_cvt_pk_bf16_f32 v90, v92, v93
    v_cvt_pk_bf16_f32 v91, v94, v95
    v_mfma_f32_32x32x16_bf16 v[56:71], v[20:23], v[124:127], v[56:71]
    s_barrier
    v_add_u32 v7, 4294885376, v7
    ds_read_b64_tr_b16 v[16:17], v7 offset:0
    ds_read_b64_tr_b16 v[18:19], v7 offset:1024
    s_add_u32 m0, s38, 131072
    s_add_u32 s3, s47, 2359296
    buffer_load_dwordx4 v6, s[12:15], s3 offen lds
    s_waitcnt lgkmcnt(6)
    v_mfma_f32_32x32x16_bf16 v[40:55], v[24:27], v[128:131], v[40:55]
    v_add_u32 v8, 4294885376, v8
    ds_read_b64_tr_b16 v[20:21], v8 offset:0
    ds_read_b64_tr_b16 v[22:23], v8 offset:1024
    v_pk_max_i16 v88, v88, 0
    v_pk_max_i16 v89, v89, 0
    v_pk_max_i16 v90, v90, 0
    v_mfma_f32_32x32x16_bf16 v[56:71], v[28:31], v[128:131], v[56:71]
    ds_read_b64_tr_b16 v[24:25], v7 offset:2048
    ds_read_b64_tr_b16 v[26:27], v7 offset:3072
    v_pk_max_i16 v91, v91, 0
    v_accvgpr_write_b32 a72, v88
    v_accvgpr_write_b32 a73, v89
    v_accvgpr_write_b32 a74, v90
    s_waitcnt lgkmcnt(6)
    v_mfma_f32_32x32x16_bf16 v[40:55], v[32:35], v[132:135], v[40:55]
    ds_read_b64_tr_b16 v[28:29], v8 offset:2048
    ds_read_b64_tr_b16 v[30:31], v8 offset:3072
    buffer_store_dwordx4 a[12:15], v1, s[4:7], s8 offen offset:3072 sc0 sc1
    v_accvgpr_write_b32 a75, v91
    v_cvt_pk_bf16_f32 v96, v96, v97
    v_mfma_f32_32x32x16_bf16 v[56:71], v[36:39], v[132:135], v[56:71]
    ds_read_b64_tr_b16 v[32:33], v7 offset:4096
    ds_read_b64_tr_b16 v[34:35], v7 offset:5120
    s_add_u32 m0, s38, 132096
    s_add_u32 s3, s47, 2506752
    buffer_load_dwordx4 v6, s[12:15], s3 offen lds
    v_cvt_pk_bf16_f32 v97, v98, v99
    s_waitcnt lgkmcnt(6)
    v_mfma_f32_32x32x16_bf16 v[40:55], v[16:19], v[136:139], v[40:55]
    ds_read_b64_tr_b16 v[36:37], v8 offset:4096
    ds_read_b64_tr_b16 v[38:39], v8 offset:5120
    v_cvt_pk_bf16_f32 v98, v100, v101
    v_cvt_pk_bf16_f32 v99, v102, v103
    v_pk_max_i16 v96, v96, 0
    v_mfma_f32_32x32x16_bf16 v[56:71], v[20:23], v[136:139], v[56:71]
    ds_read_b64_tr_b16 v[16:17], v7 offset:6144
    ds_read_b64_tr_b16 v[18:19], v7 offset:7168
    v_pk_max_i16 v97, v97, 0
    v_pk_max_i16 v98, v98, 0
    v_pk_max_i16 v99, v99, 0
    v_accvgpr_write_b32 a76, v96
    s_waitcnt lgkmcnt(6)
    v_mfma_f32_32x32x16_bf16 v[40:55], v[24:27], v[140:143], v[40:55]
    ds_read_b64_tr_b16 v[20:21], v8 offset:6144
    ds_read_b64_tr_b16 v[22:23], v8 offset:7168
    s_add_u32 m0, s38, 133120
    s_add_u32 s3, s47, 2654208
    buffer_load_dwordx4 v6, s[12:15], s3 offen lds
    v_mfma_f32_32x32x16_bf16 v[56:71], v[28:31], v[140:143], v[56:71]
    ds_read_b64_tr_b16 v[24:25], v7 offset:8192
    ds_read_b64_tr_b16 v[26:27], v7 offset:9216
    v_accvgpr_write_b32 a77, v97
    v_accvgpr_write_b32 a78, v98
    v_accvgpr_write_b32 a79, v99
    s_waitcnt lgkmcnt(6)
    v_mfma_f32_32x32x16_bf16 v[40:55], v[32:35], v[144:147], v[40:55]
    ds_read_b64_tr_b16 v[28:29], v8 offset:8192
    ds_read_b64_tr_b16 v[30:31], v8 offset:9216
    s_movk_i32 s41, 4096
    s_movk_i32 s42, -14336
    v_mfma_f32_32x32x16_bf16 v[56:71], v[36:39], v[144:147], v[56:71]
    ds_read_b64_tr_b16 v[32:33], v7 offset:10240
    ds_read_b64_tr_b16 v[34:35], v7 offset:11264
    s_add_u32 m0, s38, 134144
    s_add_u32 s3, s47, 2801664
    buffer_load_dwordx4 v6, s[12:15], s3 offen lds
    s_waitcnt lgkmcnt(6)
    v_mfma_f32_32x32x16_bf16 v[40:55], v[16:19], v[148:151], v[40:55]
    ds_read_b64_tr_b16 v[36:37], v8 offset:10240
    ds_read_b64_tr_b16 v[38:39], v8 offset:11264
    s_add_u32 s9, s32, 4096
    buffer_store_dwordx4 a[64:67], v1, s[4:7], s9 offen offset:0 sc0 sc1
    v_mfma_f32_32x32x16_bf16 v[56:71], v[20:23], v[148:151], v[56:71]
    ds_read_b64_tr_b16 v[16:17], v7 offset:12288
    ds_read_b64_tr_b16 v[18:19], v7 offset:13312
    s_bitcmp1_b32 s27, 0
    s_cselect_b32 s72, s42, s41
    s_cselect_b32 s73, s41, s42
    s_waitcnt lgkmcnt(6)
    v_mfma_f32_32x32x16_bf16 v[40:55], v[24:27], v[152:155], v[40:55]
    ds_read_b64_tr_b16 v[20:21], v8 offset:12288
    ds_read_b64_tr_b16 v[22:23], v8 offset:13312
    s_lshl_b32 s71, s27, 2
    s_add_u32 s71, s71, s78
    v_mfma_f32_32x32x16_bf16 v[56:71], v[28:31], v[152:155], v[56:71]
    ds_read_b64_tr_b16 v[24:25], v7 offset:14336
    ds_read_b64_tr_b16 v[26:27], v7 offset:15360
    s_add_u32 s48, s48, 7077888
    s_add_u32 s49, s49, 7077888
    s_add_u32 s50, s50, 7077888
    s_waitcnt lgkmcnt(6)
    v_mfma_f32_32x32x16_bf16 v[40:55], v[32:35], v[156:159], v[40:55]
    ds_read_b64_tr_b16 v[28:29], v8 offset:14336
    ds_read_b64_tr_b16 v[30:31], v8 offset:15360
    s_add_u32 s51, s51, 7077888
    s_add_u32 s52, s52, 7077888
    v_mfma_f32_32x32x16_bf16 v[56:71], v[36:39], v[156:159], v[56:71]
    s_barrier
    v_add_u32 v7, 131072, v7
    ds_read_b64_tr_b16 v[32:33], v7 offset:0
    ds_read_b64_tr_b16 v[34:35], v7 offset:1024
    s_add_u32 m0, s39, 28672
    s_add_u32 s3, s60, 4718592
    buffer_load_dwordx4 v6, s[12:15], s3 offen lds
    s_waitcnt lgkmcnt(6)
    v_mfma_f32_32x32x16_bf16 v[40:55], v[16:19], v[160:163], v[40:55]
    v_add_u32 v8, 131072, v8
    ds_read_b64_tr_b16 v[36:37], v8 offset:0
    ds_read_b64_tr_b16 v[38:39], v8 offset:1024
    s_add_u32 s53, s53, 7077888
    v_mfma_f32_32x32x16_bf16 v[56:71], v[20:23], v[160:163], v[56:71]
    ds_read_b64_tr_b16 v[16:17], v7 offset:2048
    ds_read_b64_tr_b16 v[18:19], v7 offset:3072
    s_waitcnt lgkmcnt(6)
    v_mfma_f32_32x32x16_bf16 v[40:55], v[24:27], v[164:167], v[40:55]
    ds_read_b64_tr_b16 v[20:21], v8 offset:2048
    ds_read_b64_tr_b16 v[22:23], v8 offset:3072
    buffer_store_dwordx4 a[68:71], v1, s[4:7], s9 offen offset:1024 sc0 sc1
    v_mfma_f32_32x32x16_bf16 v[56:71], v[28:31], v[164:167], v[56:71]
    ds_read_b64_tr_b16 v[24:25], v7 offset:4096
    ds_read_b64_tr_b16 v[26:27], v7 offset:5120
    s_waitcnt lgkmcnt(6)
    v_mfma_f32_32x32x16_bf16 v[40:55], v[32:35], v[168:171], v[40:55]
    ds_read_b64_tr_b16 v[28:29], v8 offset:4096
    ds_read_b64_tr_b16 v[30:31], v8 offset:5120
    v_mfma_f32_32x32x16_bf16 v[56:71], v[36:39], v[168:171], v[56:71]
    ds_read_b64_tr_b16 v[32:33], v7 offset:6144
    ds_read_b64_tr_b16 v[34:35], v7 offset:7168
    s_waitcnt lgkmcnt(6)
    v_mfma_f32_32x32x16_bf16 v[40:55], v[16:19], v[172:175], v[40:55]
    ds_read_b64_tr_b16 v[36:37], v8 offset:6144
    ds_read_b64_tr_b16 v[38:39], v8 offset:7168
    v_mfma_f32_32x32x16_bf16 v[56:71], v[20:23], v[172:175], v[56:71]
    ds_read_b64_tr_b16 v[16:17], v7 offset:8192
    ds_read_b64_tr_b16 v[18:19], v7 offset:9216
    s_waitcnt lgkmcnt(6)
    v_mfma_f32_32x32x16_bf16 v[40:55], v[24:27], v[176:179], v[40:55]
    ds_read_b64_tr_b16 v[20:21], v8 offset:8192
    ds_read_b64_tr_b16 v[22:23], v8 offset:9216
    v_mfma_f32_32x32x16_bf16 v[56:71], v[28:31], v[176:179], v[56:71]
    ds_read_b64_tr_b16 v[24:25], v7 offset:10240
    ds_read_b64_tr_b16 v[26:27], v7 offset:11264
    s_waitcnt lgkmcnt(6)
    v_mfma_f32_32x32x16_bf16 v[40:55], v[32:35], v[180:183], v[40:55]
    ds_read_b64_tr_b16 v[28:29], v8 offset:10240
    ds_read_b64_tr_b16 v[30:31], v8 offset:11264
    buffer_store_dwordx4 a[72:75], v1, s[4:7], s9 offen offset:2048 sc0 sc1
    v_mfma_f32_32x32x16_bf16 v[56:71], v[36:39], v[180:183], v[56:71]
    ds_read_b64_tr_b16 v[32:33], v7 offset:12288
    ds_read_b64_tr_b16 v[34:35], v7 offset:13312
    s_waitcnt lgkmcnt(6)
    v_mfma_f32_32x32x16_bf16 v[40:55], v[16:19], v[184:187], v[40:55]
    ds_read_b64_tr_b16 v[36:37], v8 offset:12288
    ds_read_b64_tr_b16 v[38:39], v8 offset:13312
    v_mfma_f32_32x32x16_bf16 v[56:71], v[20:23], v[184:187], v[56:71]
    ds_read_b64_tr_b16 v[16:17], v7 offset:14336
    ds_read_b64_tr_b16 v[18:19], v7 offset:15360
    s_waitcnt lgkmcnt(6)
    v_mfma_f32_32x32x16_bf16 v[40:55], v[24:27], v[188:191], v[40:55]
    ds_read_b64_tr_b16 v[20:21], v8 offset:14336
    ds_read_b64_tr_b16 v[22:23], v8 offset:15360
    v_mfma_f32_32x32x16_bf16 v[56:71], v[28:31], v[188:191], v[56:71]
    s_barrier
    v_add_u32 v7, 4294868992, v7
    ds_read_b64_tr_b16 v[24:25], v7 offset:0
    ds_read_b64_tr_b16 v[26:27], v7 offset:1024
    s_waitcnt lgkmcnt(6)
    v_mfma_f32_32x32x16_bf16 v[40:55], v[32:35], v[192:195], v[40:55]
    v_add_u32 v8, 4294868992, v8
    ds_read_b64_tr_b16 v[28:29], v8 offset:0
    ds_read_b64_tr_b16 v[30:31], v8 offset:1024
    v_mfma_f32_32x32x16_bf16 v[56:71], v[36:39], v[192:195], v[56:71]
    ds_read_b64_tr_b16 v[32:33], v7 offset:2048
    ds_read_b64_tr_b16 v[34:35], v7 offset:3072
    s_waitcnt lgkmcnt(6)
    v_mfma_f32_32x32x16_bf16 v[40:55], v[16:19], v[196:199], v[40:55]
    ds_read_b64_tr_b16 v[36:37], v8 offset:2048
    ds_read_b64_tr_b16 v[38:39], v8 offset:3072
    buffer_store_dwordx4 a[76:79], v1, s[4:7], s9 offen offset:3072 sc0 sc1
    v_mfma_f32_32x32x16_bf16 v[56:71], v[20:23], v[196:199], v[56:71]
    ds_read_b64_tr_b16 v[16:17], v7 offset:4096
    ds_read_b64_tr_b16 v[18:19], v7 offset:5120
    s_waitcnt lgkmcnt(6)
    v_mfma_f32_32x32x16_bf16 v[40:55], v[24:27], v[200:203], v[40:55]
    ds_read_b64_tr_b16 v[20:21], v8 offset:4096
    ds_read_b64_tr_b16 v[22:23], v8 offset:5120
    v_mfma_f32_32x32x16_bf16 v[56:71], v[28:31], v[200:203], v[56:71]
    ds_read_b64_tr_b16 v[24:25], v7 offset:6144
    ds_read_b64_tr_b16 v[26:27], v7 offset:7168
    s_waitcnt lgkmcnt(6)
    v_mfma_f32_32x32x16_bf16 v[40:55], v[32:35], v[204:207], v[40:55]
    ds_read_b64_tr_b16 v[28:29], v8 offset:6144
    ds_read_b64_tr_b16 v[30:31], v8 offset:7168
    v_mfma_f32_32x32x16_bf16 v[56:71], v[36:39], v[204:207], v[56:71]
    ds_read_b64_tr_b16 v[32:33], v7 offset:8192
    ds_read_b64_tr_b16 v[34:35], v7 offset:9216
    s_waitcnt lgkmcnt(6)
    v_mfma_f32_32x32x16_bf16 v[40:55], v[16:19], v[208:211], v[40:55]
    ds_read_b64_tr_b16 v[36:37], v8 offset:8192
    ds_read_b64_tr_b16 v[38:39], v8 offset:9216
    v_mfma_f32_32x32x16_bf16 v[56:71], v[20:23], v[208:211], v[56:71]
    ds_read_b64_tr_b16 v[16:17], v7 offset:10240
    ds_read_b64_tr_b16 v[18:19], v7 offset:11264
    s_waitcnt lgkmcnt(6)
    v_mfma_f32_32x32x16_bf16 v[40:55], v[24:27], v[212:215], v[40:55]
    ds_read_b64_tr_b16 v[20:21], v8 offset:10240
    ds_read_b64_tr_b16 v[22:23], v8 offset:11264
    v_mfma_f32_32x32x16_bf16 v[56:71], v[28:31], v[212:215], v[56:71]
    ds_read_b64_tr_b16 v[24:25], v7 offset:12288
    ds_read_b64_tr_b16 v[26:27], v7 offset:13312
    s_waitcnt lgkmcnt(6)
    v_mfma_f32_32x32x16_bf16 v[40:55], v[32:35], v[216:219], v[40:55]
    ds_read_b64_tr_b16 v[28:29], v8 offset:12288
    ds_read_b64_tr_b16 v[30:31], v8 offset:13312
    v_add_u32 v2, 0, v254
    v_add_u32 v3, 8192, v254
    v_add_u32 v4, 16384, v254
    v_add_u32 v5, 24576, v254
    s_add_u32 m0, s38, 147456
    s_add_u32 s3, s61, 0
    buffer_load_dwordx4 v2, s[16:19], s3 offen offset:0 lds
    v_mfma_f32_32x32x16_bf16 v[56:71], v[36:39], v[216:219], v[56:71]
    ds_read_b64_tr_b16 v[32:33], v7 offset:14336
    ds_read_b64_tr_b16 v[34:35], v7 offset:15360
    s_waitcnt lgkmcnt(6)
    v_mfma_f32_32x32x16_bf16 v[40:55], v[16:19], v[220:223], v[40:55]
    ds_read_b64_tr_b16 v[36:37], v8 offset:14336
    ds_read_b64_tr_b16 v[38:39], v8 offset:15360
    v_mfma_f32_32x32x16_bf16 v[56:71], v[20:23], v[220:223], v[56:71]
    s_waitcnt vmcnt(34)
    s_barrier
    ds_read_b64_tr_b16 v[16:17], v7 offset:16384
    ds_read_b64_tr_b16 v[18:19], v7 offset:17408
    buffer_load_dwordx4 v3, s[16:19], s3 offen offset:1024 lds
    s_waitcnt lgkmcnt(6)
    v_mfma_f32_32x32x16_bf16 v[40:55], v[24:27], v[224:227], v[40:55]
    ds_read_b64_tr_b16 v[20:21], v8 offset:16384
    ds_read_b64_tr_b16 v[22:23], v8 offset:17408
    v_mfma_f32_32x32x16_bf16 v[56:71], v[28:31], v[224:227], v[56:71]
    ds_read_b64_tr_b16 v[24:25], v7 offset:18432
    ds_read_b64_tr_b16 v[26:27], v7 offset:19456
    s_waitcnt lgkmcnt(6)
    v_mfma_f32_32x32x16_bf16 v[40:55], v[32:35], v[228:231], v[40:55]
    ds_read_b64_tr_b16 v[28:29], v8 offset:18432
    ds_read_b64_tr_b16 v[30:31], v8 offset:19456
    buffer_load_dwordx4 v4, s[16:19], s3 offen offset:2048 lds
    v_mfma_f32_32x32x16_bf16 v[56:71], v[36:39], v[228:231], v[56:71]
    ds_read_b64_tr_b16 v[32:33], v7 offset:20480
    ds_read_b64_tr_b16 v[34:35], v7 offset:21504
    s_waitcnt lgkmcnt(6)
    v_mfma_f32_32x32x16_bf16 v[40:55], v[16:19], v[232:235], v[40:55]
    ds_read_b64_tr_b16 v[36:37], v8 offset:20480
    ds_read_b64_tr_b16 v[38:39], v8 offset:21504
    v_mfma_f32_32x32x16_bf16 v[56:71], v[20:23], v[232:235], v[56:71]
    ds_read_b64_tr_b16 v[16:17], v7 offset:22528
    ds_read_b64_tr_b16 v[18:19], v7 offset:23552
    buffer_load_dwordx4 v5, s[16:19], s3 offen offset:3072 lds
    s_waitcnt lgkmcnt(6)
    v_mfma_f32_32x32x16_bf16 v[40:55], v[24:27], v[236:239], v[40:55]
    ds_read_b64_tr_b16 v[20:21], v8 offset:22528
    ds_read_b64_tr_b16 v[22:23], v8 offset:23552
    v_mfma_f32_32x32x16_bf16 v[56:71], v[28:31], v[236:239], v[56:71]
    ds_read_b64_tr_b16 v[24:25], v7 offset:24576
    ds_read_b64_tr_b16 v[26:27], v7 offset:25600
    s_waitcnt lgkmcnt(6)
    v_mfma_f32_32x32x16_bf16 v[40:55], v[32:35], v[240:243], v[40:55]
    ds_read_b64_tr_b16 v[28:29], v8 offset:24576
    ds_read_b64_tr_b16 v[30:31], v8 offset:25600
    s_add_u32 m0, s39, 24576
    s_add_u32 s3, s64, 0
    buffer_load_dwordx4 v1, s[4:7], s3 offen lds
    v_mfma_f32_32x32x16_bf16 v[56:71], v[36:39], v[240:243], v[56:71]
    ds_read_b64_tr_b16 v[32:33], v7 offset:26624
    ds_read_b64_tr_b16 v[34:35], v7 offset:27648
    s_waitcnt lgkmcnt(6)
    v_mfma_f32_32x32x16_bf16 v[40:55], v[16:19], v[244:247], v[40:55]
    ds_read_b64_tr_b16 v[36:37], v8 offset:26624
    ds_read_b64_tr_b16 v[38:39], v8 offset:27648
    v_mfma_f32_32x32x16_bf16 v[56:71], v[20:23], v[244:247], v[56:71]
    ds_read_b64_tr_b16 v[16:17], v7 offset:28672
    ds_read_b64_tr_b16 v[18:19], v7 offset:29696
    s_add_u32 m0, s38, 49152
    s_add_u32 s3, s62, 0
    buffer_load_dwordx4 v2, s[16:19], s3 offen offset:0 lds
    s_waitcnt lgkmcnt(6)
    v_mfma_f32_32x32x16_bf16 v[72:87], v[24:27], v[104:107], 0
    ds_read_b64_tr_b16 v[20:21], v8 offset:28672
    ds_read_b64_tr_b16 v[22:23], v8 offset:29696
    v_mfma_f32_32x32x16_bf16 v[88:103], v[28:31], v[104:107], 0
    ds_read_b64_tr_b16 v[24:25], v7 offset:30720
    ds_read_b64_tr_b16 v[26:27], v7 offset:31744
    v_cvt_pk_bf16_f32 v40, v40, v41
    v_cvt_pk_bf16_f32 v41, v42, v43
    v_cvt_pk_bf16_f32 v42, v44, v45
    v_cvt_pk_bf16_f32 v43, v46, v47
    s_waitcnt lgkmcnt(6)
    v_mfma_f32_32x32x16_bf16 v[72:87], v[32:35], v[108:111], v[72:87]
    ds_read_b64_tr_b16 v[28:29], v8 offset:30720
    ds_read_b64_tr_b16 v[30:31], v8 offset:31744
    buffer_load_dwordx4 v3, s[16:19], s3 offen offset:1024 lds
    v_pk_max_i16 v40, v40, 0
    v_pk_max_i16 v41, v41, 0
    v_mfma_f32_32x32x16_bf16 v[88:103], v[36:39], v[108:111], v[88:103]
    s_waitcnt vmcnt(36)
    s_barrier
    v_add_u32 v7, 4294950912, v7
    ds_read_b64_tr_b16 v[32:33], v7 offset:0
    ds_read_b64_tr_b16 v[34:35], v7 offset:1024
    v_pk_max_i16 v42, v42, 0
    v_pk_max_i16 v43, v43, 0
    s_waitcnt lgkmcnt(6)
    v_mfma_f32_32x32x16_bf16 v[72:87], v[16:19], v[112:115], v[72:87]
    v_add_u32 v8, 4294950912, v8
    ds_read_b64_tr_b16 v[36:37], v8 offset:0
    ds_read_b64_tr_b16 v[38:39], v8 offset:1024
    v_accvgpr_write_b32 a128, v40
    v_accvgpr_write_b32 a129, v41
    v_accvgpr_write_b32 a130, v42
    v_mfma_f32_32x32x16_bf16 v[88:103], v[20:23], v[112:115], v[88:103]
    ds_read_b64_tr_b16 v[16:17], v7 offset:2048
    ds_read_b64_tr_b16 v[18:19], v7 offset:3072
    buffer_load_dwordx4 v4, s[16:19], s3 offen offset:2048 lds
    v_accvgpr_write_b32 a131, v43
    v_cvt_pk_bf16_f32 v48, v48, v49
    v_cvt_pk_bf16_f32 v49, v50, v51
    s_waitcnt lgkmcnt(6)
    v_mfma_f32_32x32x16_bf16 v[72:87], v[24:27], v[116:119], v[72:87]
    ds_read_b64_tr_b16 v[20:21], v8 offset:2048
    ds_read_b64_tr_b16 v[22:23], v8 offset:3072
    v_cvt_pk_bf16_f32 v50, v52, v53
    v_cvt_pk_bf16_f32 v51, v54, v55
    v_pk_max_i16 v48, v48, 0
    v_mfma_f32_32x32x16_bf16 v[88:103], v[28:31], v[116:119], v[88:103]
    ds_read_b64_tr_b16 v[24:25], v7 offset:4096
    ds_read_b64_tr_b16 v[26:27], v7 offset:5120
    v_pk_max_i16 v49, v49, 0
    v_pk_max_i16 v50, v50, 0
    v_pk_max_i16 v51, v51, 0
    v_accvgpr_write_b32 a132, v48
    s_waitcnt lgkmcnt(6)
    v_mfma_f32_32x32x16_bf16 v[72:87], v[32:35], v[120:123], v[72:87]
    ds_read_b64_tr_b16 v[28:29], v8 offset:4096
    ds_read_b64_tr_b16 v[30:31], v8 offset:5120
    buffer_load_dwordx4 v5, s[16:19], s3 offen offset:3072 lds
    v_accvgpr_write_b32 a133, v49
    v_accvgpr_write_b32 a134, v50
    v_mfma_f32_32x32x16_bf16 v[88:103], v[36:39], v[120:123], v[88:103]
    ds_read_b64_tr_b16 v[32:33], v7 offset:6144
    ds_read_b64_tr_b16 v[34:35], v7 offset:7168
    v_accvgpr_write_b32 a135, v51
    v_cvt_pk_bf16_f32 v56, v56, v57
    v_cvt_pk_bf16_f32 v57, v58, v59
    v_cvt_pk_bf16_f32 v58, v60, v61
    s_waitcnt lgkmcnt(6)
    v_mfma_f32_32x32x16_bf16 v[72:87], v[16:19], v[124:127], v[72:87]
    ds_read_b64_tr_b16 v[36:37], v8 offset:6144
    ds_read_b64_tr_b16 v[38:39], v8 offset:7168
    v_cvt_pk_bf16_f32 v59, v62, v63
    v_pk_max_i16 v56, v56, 0
    v_pk_max_i16 v57, v57, 0
    v_mfma_f32_32x32x16_bf16 v[88:103], v[20:23], v[124:127], v[88:103]
    ds_read_b64_tr_b16 v[16:17], v7 offset:8192
    ds_read_b64_tr_b16 v[18:19], v7 offset:9216
    s_add_u32 m0, s39, 20480
    s_add_u32 s3, s65, 0
    buffer_load_dwordx4 v1, s[4:7], s3 offen lds
    v_pk_max_i16 v58, v58, 0
    s_waitcnt lgkmcnt(6)
    v_mfma_f32_32x32x16_bf16 v[72:87], v[24:27], v[128:131], v[72:87]
    ds_read_b64_tr_b16 v[20:21], v8 offset:8192
    ds_read_b64_tr_b16 v[22:23], v8 offset:9216
    v_pk_max_i16 v59, v59, 0
    v_accvgpr_write_b32 a136, v56
    v_accvgpr_write_b32 a137, v57
    v_mfma_f32_32x32x16_bf16 v[88:103], v[28:31], v[128:131], v[88:103]
    ds_read_b64_tr_b16 v[24:25], v7 offset:10240
    ds_read_b64_tr_b16 v[26:27], v7 offset:11264
    v_accvgpr_write_b32 a138, v58
    v_accvgpr_write_b32 a139, v59
    v_cvt_pk_bf16_f32 v64, v64, v65
    v_cvt_pk_bf16_f32 v65, v66, v67
    s_waitcnt lgkmcnt(6)
    v_mfma_f32_32x32x16_bf16 v[72:87], v[32:35], v[132:135], v[72:87]
    ds_read_b64_tr_b16 v[28:29], v8 offset:10240
    ds_read_b64_tr_b16 v[30:31], v8 offset:11264
    s_add_u32 m0, s38, 65536
    s_add_u32 s3, s61, 73728
    buffer_load_dwordx4 v2, s[16:19], s3 offen offset:0 lds
    v_mfma_f32_32x32x16_bf16 v[88:103], v[36:39], v[132:135], v[88:103]
    ds_read_b64_tr_b16 v[32:33], v7 offset:12288
    ds_read_b64_tr_b16 v[34:35], v7 offset:13312
    v_cvt_pk_bf16_f32 v66, v68, v69
    v_cvt_pk_bf16_f32 v67, v70, v71
    v_pk_max_i16 v64, v64, 0
    v_pk_max_i16 v65, v65, 0
    s_waitcnt lgkmcnt(6)
    v_mfma_f32_32x32x16_bf16 v[72:87], v[16:19], v[136:139], v[72:87]
    ds_read_b64_tr_b16 v[36:37], v8 offset:12288
    ds_read_b64_tr_b16 v[38:39], v8 offset:13312
    v_pk_max_i16 v66, v66, 0
    v_pk_max_i16 v67, v67, 0
    v_accvgpr_write_b32 a140, v64
    v_mfma_f32_32x32x16_bf16 v[88:103], v[20:23], v[136:139], v[88:103]
    ds_read_b64_tr_b16 v[16:17], v7 offset:14336
    ds_read_b64_tr_b16 v[18:19], v7 offset:15360
    buffer_load_dwordx4 v3, s[16:19], s3 offen offset:1024 lds
    v_accvgpr_write_b32 a141, v65
    v_accvgpr_write_b32 a142, v66
    v_accvgpr_write_b32 a143, v67
    s_waitcnt lgkmcnt(6)
    v_mfma_f32_32x32x16_bf16 v[72:87], v[24:27], v[140:143], v[72:87]
    ds_read_b64_tr_b16 v[20:21], v8 offset:14336
    ds_read_b64_tr_b16 v[22:23], v8 offset:15360
    s_waitcnt vmcnt(12)
    v_mov_b32 v14, 2
    buffer_store_dword v14, v11, s[4:7], s71 offen offset:0 sc0 sc1
    v_mfma_f32_32x32x16_bf16 v[88:103], v[28:31], v[140:143], v[88:103]
    s_barrier
    ds_read_b64_tr_b16 v[24:25], v7 offset:49152
    ds_read_b64_tr_b16 v[26:27], v7 offset:50176
    s_waitcnt lgkmcnt(6)
    v_mfma_f32_32x32x16_bf16 v[72:87], v[32:35], v[144:147], v[72:87]
    ds_read_b64_tr_b16 v[28:29], v8 offset:49152
    ds_read_b64_tr_b16 v[30:31], v8 offset:50176
    buffer_load_dwordx4 v4, s[16:19], s3 offen offset:2048 lds
    v_mfma_f32_32x32x16_bf16 v[88:103], v[36:39], v[144:147], v[88:103]
    ds_read_b64_tr_b16 v[32:33], v7 offset:51200
    ds_read_b64_tr_b16 v[34:35], v7 offset:52224
    s_waitcnt lgkmcnt(6)
    v_mfma_f32_32x32x16_bf16 v[72:87], v[16:19], v[148:151], v[72:87]
    ds_read_b64_tr_b16 v[36:37], v8 offset:51200
    ds_read_b64_tr_b16 v[38:39], v8 offset:52224
    s_add_u32 s8, s32, 8192
    buffer_store_dwordx4 a[128:131], v1, s[4:7], s8 offen offset:0 sc0 sc1
    v_mfma_f32_32x32x16_bf16 v[88:103], v[20:23], v[148:151], v[88:103]
    ds_read_b64_tr_b16 v[16:17], v7 offset:53248
    ds_read_b64_tr_b16 v[18:19], v7 offset:54272
    buffer_load_dwordx4 v5, s[16:19], s3 offen offset:3072 lds
    s_waitcnt lgkmcnt(6)
    v_mfma_f32_32x32x16_bf16 v[72:87], v[24:27], v[152:155], v[72:87]
    ds_read_b64_tr_b16 v[20:21], v8 offset:53248
    ds_read_b64_tr_b16 v[22:23], v8 offset:54272
    v_mfma_f32_32x32x16_bf16 v[88:103], v[28:31], v[152:155], v[88:103]
    ds_read_b64_tr_b16 v[24:25], v7 offset:55296
    ds_read_b64_tr_b16 v[26:27], v7 offset:56320
    s_waitcnt lgkmcnt(6)
    v_mfma_f32_32x32x16_bf16 v[72:87], v[32:35], v[156:159], v[72:87]
    ds_read_b64_tr_b16 v[28:29], v8 offset:55296
    ds_read_b64_tr_b16 v[30:31], v8 offset:56320
    s_add_u32 m0, s39, 16384
    s_add_u32 s3, s64, 2048
    buffer_load_dwordx4 v1, s[4:7], s3 offen lds
    v_mfma_f32_32x32x16_bf16 v[88:103], v[36:39], v[156:159], v[88:103]
    ds_read_b64_tr_b16 v[32:33], v7 offset:57344
    ds_read_b64_tr_b16 v[34:35], v7 offset:58368
    s_waitcnt lgkmcnt(6)
    v_mfma_f32_32x32x16_bf16 v[72:87], v[16:19], v[160:163], v[72:87]
    ds_read_b64_tr_b16 v[36:37], v8 offset:57344
    ds_read_b64_tr_b16 v[38:39], v8 offset:58368
    v_mfma_f32_32x32x16_bf16 v[88:103], v[20:23], v[160:163], v[88:103]
    ds_read_b64_tr_b16 v[16:17], v7 offset:59392
    ds_read_b64_tr_b16 v[18:19], v7 offset:60416
    s_add_u32 m0, s38, 32768
    s_add_u32 s3, s62, 73728
    buffer_load_dwordx4 v2, s[16:19], s3 offen offset:0 lds
    s_waitcnt lgkmcnt(6)
    v_mfma_f32_32x32x16_bf16 v[72:87], v[24:27], v[164:167], v[72:87]
    ds_read_b64_tr_b16 v[20:21], v8 offset:59392
    ds_read_b64_tr_b16 v[22:23], v8 offset:60416
    buffer_store_dwordx4 a[132:135], v1, s[4:7], s8 offen offset:1024 sc0 sc1
    v_mfma_f32_32x32x16_bf16 v[88:103], v[28:31], v[164:167], v[88:103]
    ds_read_b64_tr_b16 v[24:25], v7 offset:61440
    ds_read_b64_tr_b16 v[26:27], v7 offset:62464
    s_waitcnt lgkmcnt(6)
    v_mfma_f32_32x32x16_bf16 v[72:87], v[32:35], v[168:171], v[72:87]
    ds_read_b64_tr_b16 v[28:29], v8 offset:61440
    ds_read_b64_tr_b16 v[30:31], v8 offset:62464
    buffer_load_dwordx4 v3, s[16:19], s3 offen offset:1024 lds
    v_mfma_f32_32x32x16_bf16 v[88:103], v[36:39], v[168:171], v[88:103]
    ds_read_b64_tr_b16 v[32:33], v7 offset:63488
    ds_read_b64_tr_b16 v[34:35], v7 offset:64512
    s_waitcnt lgkmcnt(6)
    v_mfma_f32_32x32x16_bf16 v[72:87], v[16:19], v[172:175], v[72:87]
    ds_read_b64_tr_b16 v[36:37], v8 offset:63488
    ds_read_b64_tr_b16 v[38:39], v8 offset:64512
    v_mfma_f32_32x32x16_bf16 v[88:103], v[20:23], v[172:175], v[88:103]
    s_barrier
    v_add_u32 v7, 4294934528, v7
    ds_read_b64_tr_b16 v[16:17], v7 offset:0
    ds_read_b64_tr_b16 v[18:19], v7 offset:1024
    buffer_load_dwordx4 v4, s[16:19], s3 offen offset:2048 lds
    s_waitcnt lgkmcnt(6)
    v_mfma_f32_32x32x16_bf16 v[72:87], v[24:27], v[176:179], v[72:87]
    v_add_u32 v8, 4294934528, v8
    ds_read_b64_tr_b16 v[20:21], v8 offset:0
    ds_read_b64_tr_b16 v[22:23], v8 offset:1024
    v_mfma_f32_32x32x16_bf16 v[88:103], v[28:31], v[176:179], v[88:103]
    ds_read_b64_tr_b16 v[24:25], v7 offset:2048
    ds_read_b64_tr_b16 v[26:27], v7 offset:3072
    s_waitcnt lgkmcnt(6)
    v_mfma_f32_32x32x16_bf16 v[72:87], v[32:35], v[180:183], v[72:87]
    ds_read_b64_tr_b16 v[28:29], v8 offset:2048
    ds_read_b64_tr_b16 v[30:31], v8 offset:3072
    buffer_store_dwordx4 a[136:139], v1, s[4:7], s8 offen offset:2048 sc0 sc1
    v_mfma_f32_32x32x16_bf16 v[88:103], v[36:39], v[180:183], v[88:103]
    ds_read_b64_tr_b16 v[32:33], v7 offset:4096
    ds_read_b64_tr_b16 v[34:35], v7 offset:5120
    buffer_load_dwordx4 v5, s[16:19], s3 offen offset:3072 lds
    s_waitcnt lgkmcnt(6)
    v_mfma_f32_32x32x16_bf16 v[72:87], v[16:19], v[184:187], v[72:87]
    ds_read_b64_tr_b16 v[36:37], v8 offset:4096
    ds_read_b64_tr_b16 v[38:39], v8 offset:5120
    v_mfma_f32_32x32x16_bf16 v[88:103], v[20:23], v[184:187], v[88:103]
    ds_read_b64_tr_b16 v[16:17], v7 offset:6144
    ds_read_b64_tr_b16 v[18:19], v7 offset:7168
    s_waitcnt lgkmcnt(6)
    v_mfma_f32_32x32x16_bf16 v[72:87], v[24:27], v[188:191], v[72:87]
    ds_read_b64_tr_b16 v[20:21], v8 offset:6144
    ds_read_b64_tr_b16 v[22:23], v8 offset:7168
    s_add_u32 m0, s39, 94208
    s_add_u32 s3, s65, 2048
    buffer_load_dwordx4 v1, s[4:7], s3 offen lds
    v_mfma_f32_32x32x16_bf16 v[88:103], v[28:31], v[188:191], v[88:103]
    ds_read_b64_tr_b16 v[24:25], v7 offset:8192
    ds_read_b64_tr_b16 v[26:27], v7 offset:9216
    s_waitcnt lgkmcnt(6)
    v_mfma_f32_32x32x16_bf16 v[72:87], v[32:35], v[192:195], v[72:87]
    ds_read_b64_tr_b16 v[28:29], v8 offset:8192
    ds_read_b64_tr_b16 v[30:31], v8 offset:9216
    v_mfma_f32_32x32x16_bf16 v[88:103], v[36:39], v[192:195], v[88:103]
    ds_read_b64_tr_b16 v[32:33], v7 offset:10240
    ds_read_b64_tr_b16 v[34:35], v7 offset:11264
    s_waitcnt lgkmcnt(6)
    v_mfma_f32_32x32x16_bf16 v[72:87], v[16:19], v[196:199], v[72:87]
    ds_read_b64_tr_b16 v[36:37], v8 offset:10240
    ds_read_b64_tr_b16 v[38:39], v8 offset:11264
    buffer_store_dwordx4 a[140:143], v1, s[4:7], s8 offen offset:3072 sc0 sc1
    v_mfma_f32_32x32x16_bf16 v[88:103], v[20:23], v[196:199], v[88:103]
    ds_read_b64_tr_b16 v[16:17], v7 offset:12288
    ds_read_b64_tr_b16 v[18:19], v7 offset:13312
    s_waitcnt lgkmcnt(6)
    v_mfma_f32_32x32x16_bf16 v[72:87], v[24:27], v[200:203], v[72:87]
    ds_read_b64_tr_b16 v[20:21], v8 offset:12288
    ds_read_b64_tr_b16 v[22:23], v8 offset:13312
    buffer_load_dword v13, v12, s[4:7], s78 offen sc0 sc1
    v_mfma_f32_32x32x16_bf16 v[88:103], v[28:31], v[200:203], v[88:103]
    ds_read_b64_tr_b16 v[24:25], v7 offset:14336
    ds_read_b64_tr_b16 v[26:27], v7 offset:15360
    s_waitcnt lgkmcnt(6)
    v_mfma_f32_32x32x16_bf16 v[72:87], v[32:35], v[204:207], v[72:87]
    ds_read_b64_tr_b16 v[28:29], v8 offset:14336
    ds_read_b64_tr_b16 v[30:31], v8 offset:15360
    v_mfma_f32_32x32x16_bf16 v[88:103], v[36:39], v[204:207], v[88:103]
    s_barrier
    v_add_u32 v7, 98304, v7
    ds_read_b64_tr_b16 v[32:33], v7 offset:0
    ds_read_b64_tr_b16 v[34:35], v7 offset:1024
    s_add_u32 m0, s38, 0
    s_add_u32 s3, s61, 147456
    buffer_load_dwordx4 v2, s[16:19], s3 offen offset:0 lds
    s_waitcnt lgkmcnt(6)
    v_mfma_f32_32x32x16_bf16 v[72:87], v[16:19], v[208:211], v[72:87]
    v_add_u32 v8, 98304, v8
    ds_read_b64_tr_b16 v[36:37], v8 offset:0
    ds_read_b64_tr_b16 v[38:39], v8 offset:1024
    v_mfma_f32_32x32x16_bf16 v[88:103], v[20:23], v[208:211], v[88:103]
    ds_read_b64_tr_b16 v[16:17], v7 offset:2048
    ds_read_b64_tr_b16 v[18:19], v7 offset:3072
    s_waitcnt lgkmcnt(6)
    v_mfma_f32_32x32x16_bf16 v[72:87], v[24:27], v[212:215], v[72:87]
    ds_read_b64_tr_b16 v[20:21], v8 offset:2048
    ds_read_b64_tr_b16 v[22:23], v8 offset:3072
    buffer_load_dwordx4 v3, s[16:19], s3 offen offset:1024 lds
    v_mfma_f32_32x32x16_bf16 v[88:103], v[28:31], v[212:215], v[88:103]
    ds_read_b64_tr_b16 v[24:25], v7 offset:4096
    ds_read_b64_tr_b16 v[26:27], v7 offset:5120
    s_waitcnt lgkmcnt(6)
    v_mfma_f32_32x32x16_bf16 v[72:87], v[32:35], v[216:219], v[72:87]
    ds_read_b64_tr_b16 v[28:29], v8 offset:4096
    ds_read_b64_tr_b16 v[30:31], v8 offset:5120
    v_mfma_f32_32x32x16_bf16 v[88:103], v[36:39], v[216:219], v[88:103]
    ds_read_b64_tr_b16 v[32:33], v7 offset:6144
    ds_read_b64_tr_b16 v[34:35], v7 offset:7168
    buffer_load_dwordx4 v4, s[16:19], s3 offen offset:2048 lds
    s_waitcnt lgkmcnt(6)
    v_mfma_f32_32x32x16_bf16 v[72:87], v[16:19], v[220:223], v[72:87]
    ds_read_b64_tr_b16 v[36:37], v8 offset:6144
    ds_read_b64_tr_b16 v[38:39], v8 offset:7168
    v_mfma_f32_32x32x16_bf16 v[88:103], v[20:23], v[220:223], v[88:103]
    ds_read_b64_tr_b16 v[16:17], v7 offset:8192
    ds_read_b64_tr_b16 v[18:19], v7 offset:9216
    s_waitcnt lgkmcnt(6)
    v_mfma_f32_32x32x16_bf16 v[72:87], v[24:27], v[224:227], v[72:87]
    ds_read_b64_tr_b16 v[20:21], v8 offset:8192
    ds_read_b64_tr_b16 v[22:23], v8 offset:9216
    buffer_load_dwordx4 v5, s[16:19], s3 offen offset:3072 lds
    v_mfma_f32_32x32x16_bf16 v[88:103], v[28:31], v[224:227], v[88:103]
    ds_read_b64_tr_b16 v[24:25], v7 offset:10240
    ds_read_b64_tr_b16 v[26:27], v7 offset:11264
    s_waitcnt lgkmcnt(6)
    v_mfma_f32_32x32x16_bf16 v[72:87], v[32:35], v[228:231], v[72:87]
    ds_read_b64_tr_b16 v[28:29], v8 offset:10240
    ds_read_b64_tr_b16 v[30:31], v8 offset:11264
    v_mfma_f32_32x32x16_bf16 v[88:103], v[36:39], v[228:231], v[88:103]
    ds_read_b64_tr_b16 v[32:33], v7 offset:12288
    ds_read_b64_tr_b16 v[34:35], v7 offset:13312
    s_add_u32 m0, s39, 90112
    s_add_u32 s3, s64, 4096
    buffer_load_dwordx4 v1, s[4:7], s3 offen lds
    s_waitcnt lgkmcnt(6)
    v_mfma_f32_32x32x16_bf16 v[72:87], v[16:19], v[232:235], v[72:87]
    ds_read_b64_tr_b16 v[36:37], v8 offset:12288
    ds_read_b64_tr_b16 v[38:39], v8 offset:13312
    v_mfma_f32_32x32x16_bf16 v[88:103], v[20:23], v[232:235], v[88:103]
    ds_read_b64_tr_b16 v[16:17], v7 offset:14336
    ds_read_b64_tr_b16 v[18:19], v7 offset:15360
    s_waitcnt lgkmcnt(6)
    v_mfma_f32_32x32x16_bf16 v[72:87], v[24:27], v[236:239], v[72:87]
    ds_read_b64_tr_b16 v[20:21], v8 offset:14336
    ds_read_b64_tr_b16 v[22:23], v8 offset:15360
    v_mfma_f32_32x32x16_bf16 v[88:103], v[28:31], v[236:239], v[88:103]
    s_barrier
    v_add_u32 v10, 114688, v10
    ds_read_b64_tr_b16 v[24:25], v10 offset:0
    ds_read_b64_tr_b16 v[26:27], v10 offset:512
    s_add_u32 m0, s38, 98304
    s_add_u32 s3, s62, 147456
    buffer_load_dwordx4 v2, s[16:19], s3 offen offset:0 lds
    s_waitcnt lgkmcnt(6)
    v_mfma_f32_32x32x16_bf16 v[72:87], v[32:35], v[240:243], v[72:87]
    ds_read_b64_tr_b16 v[28:29], v10 offset:1024
    ds_read_b64_tr_b16 v[30:31], v10 offset:1536
    v_mfma_f32_32x32x16_bf16 v[88:103], v[36:39], v[240:243], v[88:103]
    ds_read_b64_tr_b16 v[32:33], v10 offset:2048
    ds_read_b64_tr_b16 v[34:35], v10 offset:2560
    s_waitcnt lgkmcnt(6)
    v_mfma_f32_32x32x16_bf16 v[72:87], v[16:19], v[244:247], v[72:87]
    ds_read_b64_tr_b16 v[36:37], v10 offset:3072
    ds_read_b64_tr_b16 v[38:39], v10 offset:3584
    buffer_load_dwordx4 v3, s[16:19], s3 offen offset:1024 lds
    v_mfma_f32_32x32x16_bf16 v[88:103], v[20:23], v[244:247], v[88:103]
    ds_read_b64_tr_b16 v[16:17], v10 offset:4096
    ds_read_b64_tr_b16 v[18:19], v10 offset:4608
    s_waitcnt lgkmcnt(6)
    v_mfma_f32_32x32x16_bf16 v[40:55], v[24:27], v[104:107], 0
    ds_read_b64_tr_b16 v[20:21], v10 offset:5120
    ds_read_b64_tr_b16 v[22:23], v10 offset:5632
    v_mfma_f32_32x32x16_bf16 v[40:55], v[28:31], v[108:111], v[40:55]
    ds_read_b64_tr_b16 v[24:25], v10 offset:6144
    ds_read_b64_tr_b16 v[26:27], v10 offset:6656
    s_waitcnt vmcnt(7)
    v_cmp_gt_u32 vcc, 2, v13
    s_and_b32 vcc_lo, vcc_lo, 15
    s_cbranch_scc1 KT_SLOW21
KT_BACK21:
    buffer_load_dwordx4 a[16:19], v1, s[4:7], s33 offen offset:0 sc0 sc1
    s_waitcnt lgkmcnt(6)
    v_mfma_f32_32x32x16_bf16 v[40:55], v[32:35], v[112:115], v[40:55]
    ds_read_b64_tr_b16 v[28:29], v10 offset:7168
    ds_read_b64_tr_b16 v[30:31], v10 offset:7680
    buffer_load_dwordx4 v4, s[16:19], s3 offen offset:2048 lds
    v_cvt_pk_bf16_f32 v72, v72, v73
    v_cvt_pk_bf16_f32 v73, v74, v75
    v_cvt_pk_bf16_f32 v74, v76, v77
    v_mfma_f32_32x32x16_bf16 v[40:55], v[36:39], v[116:119], v[40:55]
    ds_read_b64_tr_b16 v[32:33], v10 offset:8192
    ds_read_b64_tr_b16 v[34:35], v10 offset:8704
    buffer_load_dwordx4 a[20:23], v1, s[4:7], s33 offen offset:1024 sc0 sc1
    v_cvt_pk_bf16_f32 v75, v78, v79
    v_pk_max_i16 v72, v72, 0
    v_pk_max_i16 v73, v73, 0
    v_pk_max_i16 v74, v74, 0
    s_waitcnt lgkmcnt(6)
    v_mfma_f32_32x32x16_bf16 v[40:55], v[16:19], v[120:123], v[40:55]
    ds_read_b64_tr_b16 v[36:37], v10 offset:9216
    ds_read_b64_tr_b16 v[38:39], v10 offset:9728
    v_pk_max_i16 v75, v75, 0
    v_accvgpr_write_b32 a192, v72
    v_accvgpr_write_b32 a193, v73
    v_accvgpr_write_b32 a194, v74
    v_mfma_f32_32x32x16_bf16 v[40:55], v[20:23], v[124:127], v[40:55]
    ds_read_b64_tr_b16 v[16:17], v10 offset:10240
    ds_read_b64_tr_b16 v[18:19], v10 offset:10752
    buffer_load_dwordx4 a[24:27], v1, s[4:7], s33 offen offset:2048 sc0 sc1
    v_accvgpr_write_b32 a195, v75
    v_cvt_pk_bf16_f32 v80, v80, v81
    v_cvt_pk_bf16_f32 v81, v82, v83
    v_cvt_pk_bf16_f32 v82, v84, v85
    s_waitcnt lgkmcnt(6)
    v_mfma_f32_32x32x16_bf16 v[40:55], v[24:27], v[128:131], v[40:55]
    ds_read_b64_tr_b16 v[20:21], v10 offset:11264
    ds_read_b64_tr_b16 v[22:23], v10 offset:11776
    buffer_load_dwordx4 v5, s[16:19], s3 offen offset:3072 lds
    v_cvt_pk_bf16_f32 v83, v86, v87
    v_pk_max_i16 v80, v80, 0
    v_pk_max_i16 v81, v81, 0
    v_mfma_f32_32x32x16_bf16 v[40:55], v[28:31], v[132:135], v[40:55]
    ds_read_b64_tr_b16 v[24:25], v10 offset:12288
    ds_read_b64_tr_b16 v[26:27], v10 offset:12800
    buffer_load_dwordx4 a[28:31], v1, s[4:7], s33 offen offset:3072 sc0 sc1
    s_add_u32 s33, s33, 4096
    v_pk_max_i16 v82, v82, 0
    v_pk_max_i16 v83, v83, 0
    v_accvgpr_write_b32 a196, v80
    v_accvgpr_write_b32 a197, v81
    s_waitcnt lgkmcnt(6)
    v_mfma_f32_32x32x16_bf16 v[40:55], v[32:35], v[136:139], v[40:55]
    ds_read_b64_tr_b16 v[28:29], v10 offset:13312
    ds_read_b64_tr_b16 v[30:31], v10 offset:13824
    v_accvgpr_write_b32 a198, v82
    v_accvgpr_write_b32 a199, v83
    v_cvt_pk_bf16_f32 v88, v88, v89
    v_cvt_pk_bf16_f32 v89, v90, v91
    v_mfma_f32_32x32x16_bf16 v[40:55], v[36:39], v[140:143], v[40:55]
    ds_read_b64_tr_b16 v[32:33], v10 offset:14336
    ds_read_b64_tr_b16 v[34:35], v10 offset:14848
    buffer_load_dwordx4 a[32:35], v1, s[4:7], s34 offen offset:0 sc0 sc1
    v_cvt_pk_bf16_f32 v90, v92, v93
    v_cvt_pk_bf16_f32 v91, v94, v95
    v_pk_max_i16 v88, v88, 0
    v_pk_max_i16 v89, v89, 0
    s_waitcnt lgkmcnt(6)
    v_mfma_f32_32x32x16_bf16 v[40:55], v[16:19], v[144:147], v[40:55]
    ds_read_b64_tr_b16 v[36:37], v10 offset:15360
    ds_read_b64_tr_b16 v[38:39], v10 offset:15872
    s_add_u32 m0, s39, 86016
    s_add_u32 s3, s65, 4096
    buffer_load_dwordx4 v1, s[4:7], s3 offen lds
    v_pk_max_i16 v90, v90, 0
    v_mfma_f32_32x32x16_bf16 v[40:55], v[20:23], v[148:151], v[40:55]
    s_barrier
    ds_read_b64_tr_b16 v[16:17], v10 offset:16384
    ds_read_b64_tr_b16 v[18:19], v10 offset:16896
    buffer_load_dwordx4 a[36:39], v1, s[4:7], s34 offen offset:1024 sc0 sc1
    v_pk_max_i16 v91, v91, 0
    v_accvgpr_write_b32 a200, v88
    s_waitcnt lgkmcnt(6)
    v_mfma_f32_32x32x16_bf16 v[40:55], v[24:27], v[152:155], v[40:55]
    ds_read_b64_tr_b16 v[20:21], v10 offset:17408
    ds_read_b64_tr_b16 v[22:23], v10 offset:17920
    v_accvgpr_write_b32 a201, v89
    v_accvgpr_write_b32 a202, v90
    v_accvgpr_write_b32 a203, v91
    v_cvt_pk_bf16_f32 v96, v96, v97
    v_mfma_f32_32x32x16_bf16 v[40:55], v[28:31], v[156:159], v[40:55]
    ds_read_b64_tr_b16 v[24:25], v10 offset:18432
    ds_read_b64_tr_b16 v[26:27], v10 offset:18944
    buffer_load_dwordx4 a[40:43], v1, s[4:7], s34 offen offset:2048 sc0 sc1
    v_cvt_pk_bf16_f32 v97, v98, v99
    v_cvt_pk_bf16_f32 v98, v100, v101
    v_cvt_pk_bf16_f32 v99, v102, v103
    v_pk_max_i16 v96, v96, 0
    s_waitcnt lgkmcnt(6)
    v_mfma_f32_32x32x16_bf16 v[40:55], v[32:35], v[160:163], v[40:55]
    ds_read_b64_tr_b16 v[28:29], v10 offset:19456
    ds_read_b64_tr_b16 v[30:31], v10 offset:19968
    s_add_u32 m0, s38, 114688
    s_add_u32 s3, s61, 221184
    buffer_load_dwordx4 v2, s[16:19], s3 offen offset:0 lds
    v_pk_max_i16 v97, v97, 0
    v_mfma_f32_32x32x16_bf16 v[40:55], v[36:39], v[164:167], v[40:55]
    ds_read_b64_tr_b16 v[32:33], v10 offset:20480
    ds_read_b64_tr_b16 v[34:35], v10 offset:20992
    buffer_load_dwordx4 a[44:47], v1, s[4:7], s34 offen offset:3072 sc0 sc1
    s_add_u32 s34, s34, 4096
    v_pk_max_i16 v98, v98, 0
    v_pk_max_i16 v99, v99, 0
    v_accvgpr_write_b32 a204, v96
    v_accvgpr_write_b32 a205, v97
    s_waitcnt lgkmcnt(6)
    v_mfma_f32_32x32x16_bf16 v[40:55], v[16:19], v[168:171], v[40:55]
    ds_read_b64_tr_b16 v[36:37], v10 offset:21504
    ds_read_b64_tr_b16 v[38:39], v10 offset:22016
    v_accvgpr_write_b32 a206, v98
    v_accvgpr_write_b32 a207, v99
    v_mfma_f32_32x32x16_bf16 v[40:55], v[20:23], v[172:175], v[40:55]
    ds_read_b64_tr_b16 v[16:17], v10 offset:22528
    ds_read_b64_tr_b16 v[18:19], v10 offset:23040
    buffer_load_dwordx4 a[48:51], v1, s[4:7], s35 offen offset:0 sc0 sc1
    s_lshl_b32 s43, s40, 6
    v_xor_b32 v7, s43, v7
    v_xor_b32 v8, s43, v8
    s_waitcnt lgkmcnt(6)
    v_mfma_f32_32x32x16_bf16 v[40:55], v[24:27], v[176:179], v[40:55]
    ds_read_b64_tr_b16 v[20:21], v10 offset:23552
    ds_read_b64_tr_b16 v[22:23], v10 offset:24064
    v_mov_b32 v14, 3
    buffer_store_dword v14, v11, s[4:7], s71 offen offset:0 sc0 sc1
    v_mfma_f32_32x32x16_bf16 v[40:55], v[28:31], v[180:183], v[40:55]
    ds_read_b64_tr_b16 v[24:25], v10 offset:24576
    ds_read_b64_tr_b16 v[26:27], v10 offset:25088
    buffer_load_dwordx4 a[52:55], v1, s[4:7], s35 offen offset:1024 sc0 sc1
    s_waitcnt lgkmcnt(6)
    v_mfma_f32_32x32x16_bf16 v[40:55], v[32:35], v[184:187], v[40:55]
    ds_read_b64_tr_b16 v[28:29], v10 offset:25600
    ds_read_b64_tr_b16 v[30:31], v10 offset:26112
    buffer_load_dwordx4 v3, s[16:19], s3 offen offset:1024 lds
    v_mfma_f32_32x32x16_bf16 v[40:55], v[36:39], v[188:191], v[40:55]
    ds_read_b64_tr_b16 v[32:33], v10 offset:26624
    ds_read_b64_tr_b16 v[34:35], v10 offset:27136
    buffer_load_dwordx4 a[56:59], v1, s[4:7], s35 offen offset:2048 sc0 sc1
    s_waitcnt lgkmcnt(6)
    v_mfma_f32_32x32x16_bf16 v[40:55], v[16:19], v[192:195], v[40:55]
    ds_read_b64_tr_b16 v[36:37], v10 offset:27648
    ds_read_b64_tr_b16 v[38:39], v10 offset:28160
    s_add_u32 s9, s32, 12288
    buffer_store_dwordx4 a[192:195], v1, s[4:7], s9 offen offset:0 sc0 sc1
    v_mfma_f32_32x32x16_bf16 v[40:55], v[20:23], v[196:199], v[40:55]
    ds_read_b64_tr_b16 v[16:17], v10 offset:28672
    ds_read_b64_tr_b16 v[18:19], v10 offset:29184
    buffer_load_dwordx4 a[60:63], v1, s[4:7], s35 offen offset:3072 sc0 sc1
    s_add_u32 s35, s35, 4096
    s_waitcnt lgkmcnt(6)
    v_mfma_f32_32x32x16_bf16 v[40:55], v[24:27], v[200:203], v[40:55]
    ds_read_b64_tr_b16 v[20:21], v10 offset:29696
    ds_read_b64_tr_b16 v[22:23], v10 offset:30208
    buffer_load_dwordx4 v4, s[16:19], s3 offen offset:2048 lds
    v_mfma_f32_32x32x16_bf16 v[40:55], v[28:31], v[204:207], v[40:55]
    ds_read_b64_tr_b16 v[24:25], v10 offset:30720
    ds_read_b64_tr_b16 v[26:27], v10 offset:31232
    buffer_load_dwordx4 a[80:83], v1, s[4:7], s33 offen offset:0 sc0 sc1
    s_waitcnt lgkmcnt(6)
    v_mfma_f32_32x32x16_bf16 v[40:55], v[32:35], v[208:211], v[40:55]
    ds_read_b64_tr_b16 v[28:29], v10 offset:31744
    ds_read_b64_tr_b16 v[30:31], v10 offset:32256
    v_mfma_f32_32x32x16_bf16 v[40:55], v[36:39], v[212:215], v[40:55]
    s_barrier
    v_add_u32 v10, 4294868992, v10
    ds_read_b64_tr_b16 v[32:33], v10 offset:12288
    ds_read_b64_tr_b16 v[34:35], v10 offset:12800
    buffer_load_dwordx4 a[84:87], v1, s[4:7], s33 offen offset:1024 sc0 sc1
    s_waitcnt lgkmcnt(6)
    v_mfma_f32_32x32x16_bf16 v[40:55], v[16:19], v[216:219], v[40:55]
    ds_read_b64_tr_b16 v[36:37], v10 offset:13312
    ds_read_b64_tr_b16 v[38:39], v10 offset:13824
    buffer_load_dwordx4 v5, s[16:19], s3 offen offset:3072 lds
    v_mfma_f32_32x32x16_bf16 v[40:55], v[20:23], v[220:223], v[40:55]
    ds_read_b64_tr_b16 v[16:17], v10 offset:14336
    ds_read_b64_tr_b16 v[18:19], v10 offset:14848
    buffer_load_dwordx4 a[88:91], v1, s[4:7], s33 offen offset:2048 sc0 sc1
    s_waitcnt lgkmcnt(6)
    v_mfma_f32_32x32x16_bf16 v[40:55], v[24:27], v[224:227], v[40:55]
    ds_read_b64_tr_b16 v[20:21], v10 offset:15360
    ds_read_b64_tr_b16 v[22:23], v10 offset:15872
    buffer_store_dwordx4 a[196:199], v1, s[4:7], s9 offen offset:1024 sc0 sc1
    v_mfma_f32_32x32x16_bf16 v[40:55], v[28:31], v[228:231], v[40:55]
    s_barrier
    ds_read_b64_tr_b16 v[24:25], v7 offset:49152
    ds_read_b64_tr_b16 v[26:27], v7 offset:50176
    buffer_load_dwordx4 a[92:95], v1, s[4:7], s33 offen offset:3072 sc0 sc1
    s_add_u32 s33, s33, 4096
    s_waitcnt lgkmcnt(6)
    v_mfma_f32_32x32x16_bf16 v[40:55], v[32:35], v[232:235], v[40:55]
    ds_read_b64_tr_b16 v[28:29], v8 offset:49152
    ds_read_b64_tr_b16 v[30:31], v8 offset:50176
    s_add_u32 m0, s39, 81920
    s_add_u32 s3, s64, 6144
    buffer_load_dwordx4 v1, s[4:7], s3 offen lds
    v_mfma_f32_32x32x16_bf16 v[40:55], v[36:39], v[236:239], v[40:55]
    ds_read_b64_tr_b16 v[32:33], v9 offset:24576
    ds_read_b64_tr_b16 v[34:35], v9 offset:24832
    buffer_load_dwordx4 a[96:99], v1, s[4:7], s34 offen offset:0 sc0 sc1
    s_waitcnt lgkmcnt(6)
    v_mfma_f32_32x32x16_bf16 v[40:55], v[16:19], v[240:243], v[40:55]
    ds_read_b64_tr_b16 v[36:37], v7 offset:51200
    ds_read_b64_tr_b16 v[38:39], v7 offset:52224
    buffer_load_dwordx2 v[72:73], v252, s[4:7], s76 offen offset:0 sc0 sc1
    v_mfma_f32_32x32x16_bf16 v[40:55], v[20:23], v[244:247], v[40:55]
    ds_read_b64_tr_b16 v[16:17], v8 offset:51200
    ds_read_b64_tr_b16 v[18:19], v8 offset:52224
    buffer_load_dwordx4 a[100:103], v1, s[4:7], s34 offen offset:1024 sc0 sc1
    s_waitcnt lgkmcnt(6)
    v_mfma_f32_32x32x16_bf16 v[104:119], v[24:27], a[0:3], 0
    ds_read_b64_tr_b16 v[20:21], v9 offset:25088
    ds_read_b64_tr_b16 v[22:23], v9 offset:25344
    s_add_u32 m0, s38, 131072
    s_add_u32 s3, s62, 221184
    buffer_load_dwordx4 v2, s[16:19], s3 offen offset:0 lds
    v_mfma_f32_32x32x16_bf16 v[120:135], v[28:31], a[0:3], 0
    ds_read_b64_tr_b16 v[24:25], v7 offset:53248
    ds_read_b64_tr_b16 v[26:27], v7 offset:54272
    buffer_load_dwordx4 a[104:107], v1, s[4:7], s34 offen offset:2048 sc0 sc1
    v_cvt_pk_bf16_f32 v184, v40, v41
    v_cvt_pk_bf16_f32 v185, v42, v43
    v_cvt_pk_bf16_f32 v186, v44, v45
    v_cvt_pk_bf16_f32 v187, v46, v47
    s_waitcnt lgkmcnt(6)
    v_mfma_f32_32x32x16_bf16 v[136:151], v[32:35], a[0:3], 0
    ds_read_b64_tr_b16 v[28:29], v8 offset:53248
    ds_read_b64_tr_b16 v[30:31], v8 offset:54272
    buffer_store_dwordx4 a[200:203], v1, s[4:7], s9 offen offset:2048 sc0 sc1
    v_pk_max_i16 v184, v184, 0
    v_pk_max_i16 v185, v185, 0
    v_pk_max_i16 v186, v186, 0
    v_mfma_f32_32x32x16_bf16 v[104:119], v[36:39], a[4:7], v[104:119]
    ds_read_b64_tr_b16 v[32:33], v9 offset:25600
    ds_read_b64_tr_b16 v[34:35], v9 offset:25856
    buffer_load_dwordx4 a[108:111], v1, s[4:7], s34 offen offset:3072 sc0 sc1
    s_add_u32 s34, s34, 4096
    v_pk_max_i16 v187, v187, 0
    v_cvt_pk_bf16_f32 v188, v48, v49
    v_cvt_pk_bf16_f32 v189, v50, v51
    v_cvt_pk_bf16_f32 v190, v52, v53
    s_waitcnt lgkmcnt(6)
    v_mfma_f32_32x32x16_bf16 v[120:135], v[16:19], a[4:7], v[120:135]
    ds_read_b64_tr_b16 v[36:37], v7 offset:55296
    ds_read_b64_tr_b16 v[38:39], v7 offset:56320
    buffer_load_dwordx4 v3, s[16:19], s3 offen offset:1024 lds
    v_cvt_pk_bf16_f32 v191, v54, v55
    v_pk_max_i16 v188, v188, 0
    v_pk_max_i16 v189, v189, 0
    v_mfma_f32_32x32x16_bf16 v[136:151], v[20:23], a[4:7], v[136:151]
    ds_read_b64_tr_b16 v[16:17], v8 offset:55296
    ds_read_b64_tr_b16 v[18:19], v8 offset:56320
    buffer_load_dwordx4 a[112:115], v1, s[4:7], s35 offen offset:0 sc0 sc1
    v_pk_max_i16 v190, v190, 0
    v_pk_max_i16 v191, v191, 0
    s_waitcnt lgkmcnt(6)
    v_mfma_f32_32x32x16_bf16 v[104:119], v[24:27], a[8:11], v[104:119]
    ds_read_b64_tr_b16 v[20:21], v9 offset:26112
    ds_read_b64_tr_b16 v[22:23], v9 offset:26368
    buffer_load_dwordx2 v[74:75], v252, s[4:7], s76 offen offset:512 sc0 sc1
    v_accvgpr_read_b32 v216, a246
    v_mfma_f32_32x32x16_bf16 v[120:135], v[28:31], a[8:11], v[120:135]
    ds_read_b64_tr_b16 v[24:25], v7 offset:57344
    ds_read_b64_tr_b16 v[26:27], v7 offset:58368
    buffer_load_dwordx4 a[116:119], v1, s[4:7], s35 offen offset:1024 sc0 sc1
    v_accvgpr_read_b32 v217, a247
    v_accvgpr_read_b32 v218, a248
    s_waitcnt lgkmcnt(6)
    v_mfma_f32_32x32x16_bf16 v[136:151], v[32:35], a[8:11], v[136:151]
    ds_read_b64_tr_b16 v[28:29], v8 offset:57344
    ds_read_b64_tr_b16 v[30:31], v8 offset:58368
    s_add_u32 s8, s9, s72
    buffer_store_dwordx4 v[184:187], v1, s[4:7], s8 offen offset:0 sc0 sc1
    v_accvgpr_read_b32 v219, a249
    v_mfma_f32_32x32x16_bf16 v[104:119], v[36:39], a[12:15], v[104:119]
    ds_read_b64_tr_b16 v[32:33], v9 offset:26624
    ds_read_b64_tr_b16 v[34:35], v9 offset:26880
    buffer_load_dwordx4 a[120:123], v1, s[4:7], s35 offen offset:2048 sc0 sc1
    v_accvgpr_read_b32 v220, a250
    v_accvgpr_read_b32 v221, a251
    s_waitcnt lgkmcnt(6)
    v_mfma_f32_32x32x16_bf16 v[120:135], v[16:19], a[12:15], v[120:135]
    ds_read_b64_tr_b16 v[36:37], v7 offset:59392
    ds_read_b64_tr_b16 v[38:39], v7 offset:60416
    buffer_store_dwordx4 a[204:207], v1, s[4:7], s9 offen offset:3072 sc0 sc1
    v_accvgpr_read_b32 v222, a252
    v_mfma_f32_32x32x16_bf16 v[136:151], v[20:23], a[12:15], v[136:151]
    ds_read_b64_tr_b16 v[16:17], v8 offset:59392
    ds_read_b64_tr_b16 v[18:19], v8 offset:60416
    buffer_load_dwordx4 a[124:127], v1, s[4:7], s35 offen offset:3072 sc0 sc1
    s_add_u32 s35, s35, 4096
    v_accvgpr_read_b32 v223, a253
    v_accvgpr_read_b32 v224, a254
    s_waitcnt vmcnt(39) lgkmcnt(6)
    v_mfma_f32_32x32x16_bf16 v[104:119], v[24:27], a[16:19], v[104:119]
    ds_read_b64_tr_b16 v[20:21], v9 offset:27136
    ds_read_b64_tr_b16 v[22:23], v9 offset:27392
    buffer_load_dword v13, v12, s[4:7], s78 offen sc0 sc1
    v_accvgpr_read_b32 v225, a255
    v_mfma_f32_32x32x16_bf16 v[120:135], v[28:31], a[16:19], v[120:135]
    ds_read_b64_tr_b16 v[24:25], v7 offset:61440
    ds_read_b64_tr_b16 v[26:27], v7 offset:62464
    buffer_load_dwordx4 v4, s[16:19], s3 offen offset:2048 lds
    s_waitcnt lgkmcnt(6)
    v_mfma_f32_32x32x16_bf16 v[136:151], v[32:35], a[16:19], v[136:151]
    ds_read_b64_tr_b16 v[28:29], v8 offset:61440
    ds_read_b64_tr_b16 v[30:31], v8 offset:62464
    buffer_load_dwordx2 v[76:77], v252, s[4:7], s76 offen offset:1024 sc0 sc1
    v_mfma_f32_32x32x16_bf16 v[104:119], v[36:39], a[20:23], v[104:119]
    ds_read_b64_tr_b16 v[32:33], v9 offset:27648
    ds_read_b64_tr_b16 v[34:35], v9 offset:27904
    s_waitcnt lgkmcnt(6)
    v_mfma_f32_32x32x16_bf16 v[120:135], v[16:19], a[20:23], v[120:135]
    ds_read_b64_tr_b16 v[36:37], v7 offset:63488
    ds_read_b64_tr_b16 v[38:39], v7 offset:64512
    buffer_store_dwordx4 v[188:191], v1, s[4:7], s8 offen offset:1024 sc0 sc1
    v_mfma_f32_32x32x16_bf16 v[136:151], v[20:23], a[20:23], v[136:151]
    ds_read_b64_tr_b16 v[16:17], v8 offset:63488
    ds_read_b64_tr_b16 v[18:19], v8 offset:64512
    buffer_load_dwordx4 v5, s[16:19], s3 offen offset:3072 lds
    s_waitcnt vmcnt(41) lgkmcnt(6)
    v_mfma_f32_32x32x16_bf16 v[104:119], v[24:27], a[24:27], v[104:119]
    ds_read_b64_tr_b16 v[20:21], v9 offset:28160
    ds_read_b64_tr_b16 v[22:23], v9 offset:28416
    buffer_load_dwordx2 v[78:79], v252, s[4:7], s76 offen offset:1536 sc0 sc1
    v_mfma_f32_32x32x16_bf16 v[120:135], v[28:31], a[24:27], v[120:135]
    s_barrier
    v_add_u32 v7, 4294918144, v7
    ds_read_b64_tr_b16 v[24:25], v7 offset:0
    ds_read_b64_tr_b16 v[26:27], v7 offset:1024
    s_waitcnt lgkmcnt(6)
    v_mfma_f32_32x32x16_bf16 v[136:151], v[32:35], a[24:27], v[136:151]
    v_add_u32 v8, 4294918144, v8
    ds_read_b64_tr_b16 v[28:29], v8 offset:0
    ds_read_b64_tr_b16 v[30:31], v8 offset:1024
    s_add_u32 m0, s39, 28672
    s_add_u32 s3, s65, 6144
    buffer_load_dwordx4 v1, s[4:7], s3 offen lds
    v_mfma_f32_32x32x16_bf16 v[104:119], v[36:39], a[28:31], v[104:119]
    ds_read_b64_tr_b16 v[32:33], v9 offset:20480
    ds_read_b64_tr_b16 v[34:35], v9 offset:20736
    buffer_load_dwordx2 v[80:81], v252, s[4:7], s76 offen offset:2048 sc0 sc1
    s_waitcnt lgkmcnt(6)
    v_mfma_f32_32x32x16_bf16 v[120:135], v[16:19], a[28:31], v[120:135]
    ds_read_b64_tr_b16 v[36:37], v7 offset:2048
    ds_read_b64_tr_b16 v[38:39], v7 offset:3072
    v_mfma_f32_32x32x16_bf16 v[136:151], v[20:23], a[28:31], v[136:151]
    ds_read_b64_tr_b16 v[16:17], v8 offset:2048
    ds_read_b64_tr_b16 v[18:19], v8 offset:3072
    s_add_u32 m0, s38, 147456
    s_add_u32 s3, s63, 0
    buffer_load_dwordx4 v2, s[16:19], s3 offen offset:0 lds
    s_waitcnt vmcnt(42) lgkmcnt(6)
    v_mfma_f32_32x32x16_bf16 v[104:119], v[24:27], a[32:35], v[104:119]
    ds_read_b64_tr_b16 v[20:21], v9 offset:20992
    ds_read_b64_tr_b16 v[22:23], v9 offset:21248
    buffer_load_dwordx2 v[82:83], v252, s[4:7], s76 offen offset:2560 sc0 sc1
    v_mfma_f32_32x32x16_bf16 v[120:135], v[28:31], a[32:35], v[120:135]
    ds_read_b64_tr_b16 v[24:25], v7 offset:4096
    ds_read_b64_tr_b16 v[26:27], v7 offset:5120
    s_waitcnt lgkmcnt(6)
    v_mfma_f32_32x32x16_bf16 v[136:151], v[32:35], a[32:35], v[136:151]
    ds_read_b64_tr_b16 v[28:29], v8 offset:4096
    ds_read_b64_tr_b16 v[30:31], v8 offset:5120
    buffer_load_dwordx4 v3, s[16:19], s3 offen offset:1024 lds
    v_mfma_f32_32x32x16_bf16 v[104:119], v[36:39], a[36:39], v[104:119]
    ds_read_b64_tr_b16 v[32:33], v9 offset:21504
    ds_read_b64_tr_b16 v[34:35], v9 offset:21760
    buffer_load_dwordx2 v[84:85], v252, s[4:7], s76 offen offset:3072 sc0 sc1
    s_waitcnt lgkmcnt(6)
    v_mfma_f32_32x32x16_bf16 v[120:135], v[16:19], a[36:39], v[120:135]
    ds_read_b64_tr_b16 v[36:37], v7 offset:6144
    ds_read_b64_tr_b16 v[38:39], v7 offset:7168
    v_mfma_f32_32x32x16_bf16 v[136:151], v[20:23], a[36:39], v[136:151]
    ds_read_b64_tr_b16 v[16:17], v8 offset:6144
    ds_read_b64_tr_b16 v[18:19], v8 offset:7168
    buffer_load_dwordx4 v4, s[16:19], s3 offen offset:2048 lds
    s_waitcnt vmcnt(43) lgkmcnt(6)
    v_mfma_f32_32x32x16_bf16 v[104:119], v[24:27], a[40:43], v[104:119]
    ds_read_b64_tr_b16 v[20:21], v9 offset:22016
    ds_read_b64_tr_b16 v[22:23], v9 offset:22272
    buffer_load_dwordx2 v[86:87], v252, s[4:7], s76 offen offset:3584 sc0 sc1
    v_mfma_f32_32x32x16_bf16 v[120:135], v[28:31], a[40:43], v[120:135]
    ds_read_b64_tr_b16 v[24:25], v7 offset:8192
    ds_read_b64_tr_b16 v[26:27], v7 offset:9216
    s_waitcnt lgkmcnt(6)
    v_mfma_f32_32x32x16_bf16 v[136:151], v[32:35], a[40:43], v[136:151]
    ds_read_b64_tr_b16 v[28:29], v8 offset:8192
    ds_read_b64_tr_b16 v[30:31], v8 offset:9216
    buffer_load_dwordx4 v5, s[16:19], s3 offen offset:3072 lds
    v_mfma_f32_32x32x16_bf16 v[104:119], v[36:39], a[44:47], v[104:119]
    ds_read_b64_tr_b16 v[32:33], v9 offset:22528
    ds_read_b64_tr_b16 v[34:35], v9 offset:22784
    s_waitcnt lgkmcnt(6)
    v_mfma_f32_32x32x16_bf16 v[120:135], v[16:19], a[44:47], v[120:135]
    ds_read_b64_tr_b16 v[36:37], v7 offset:10240
    ds_read_b64_tr_b16 v[38:39], v7 offset:11264
    v_mfma_f32_32x32x16_bf16 v[136:151], v[20:23], a[44:47], v[136:151]
    ds_read_b64_tr_b16 v[16:17], v8 offset:10240
    ds_read_b64_tr_b16 v[18:19], v8 offset:11264
    s_add_u32 m0, s39, 24576
    s_add_u32 s3, s66, 0
    buffer_load_dwordx4 v1, s[4:7], s3 offen lds
    s_waitcnt vmcnt(43) lgkmcnt(6)
    v_mfma_f32_32x32x16_bf16 v[104:119], v[24:27], a[48:51], v[104:119]
    ds_read_b64_tr_b16 v[20:21], v9 offset:23040
    ds_read_b64_tr_b16 v[22:23], v9 offset:23296
    v_mfma_f32_32x32x16_bf16 v[120:135], v[28:31], a[48:51], v[120:135]
    ds_read_b64_tr_b16 v[24:25], v7 offset:12288
    ds_read_b64_tr_b16 v[26:27], v7 offset:13312
    s_waitcnt vmcnt(15)
    v_cmp_gt_u32 vcc, 3, v13
    s_and_b32 vcc_lo, vcc_lo, 15
    s_cbranch_scc1 KT_SLOW22
KT_BACK22:
    buffer_load_dwordx4 a[144:147], v1, s[4:7], s33 offen offset:0 sc0 sc1
    s_waitcnt lgkmcnt(6)
    v_mfma_f32_32x32x16_bf16 v[136:151], v[32:35], a[48:51], v[136:151]
    ds_read_b64_tr_b16 v[28:29], v8 offset:12288
    ds_read_b64_tr_b16 v[30:31], v8 offset:13312
    v_mfma_f32_32x32x16_bf16 v[104:119], v[36:39], a[52:55], v[104:119]
    ds_read_b64_tr_b16 v[32:33], v9 offset:23552
    ds_read_b64_tr_b16 v[34:35], v9 offset:23808
    buffer_load_dwordx4 a[148:151], v1, s[4:7], s33 offen offset:1024 sc0 sc1
    s_waitcnt lgkmcnt(6)
    v_mfma_f32_32x32x16_bf16 v[120:135], v[16:19], a[52:55], v[120:135]
    ds_read_b64_tr_b16 v[36:37], v7 offset:14336
    ds_read_b64_tr_b16 v[38:39], v7 offset:15360
    v_mfma_f32_32x32x16_bf16 v[136:151], v[20:23], a[52:55], v[136:151]
    ds_read_b64_tr_b16 v[16:17], v8 offset:14336
    ds_read_b64_tr_b16 v[18:19], v8 offset:15360
    buffer_load_dwordx4 a[152:155], v1, s[4:7], s33 offen offset:2048 sc0 sc1
    s_waitcnt lgkmcnt(6)
    v_mfma_f32_32x32x16_bf16 v[104:119], v[24:27], a[56:59], v[104:119]
    ds_read_b64_tr_b16 v[20:21], v9 offset:24064
    ds_read_b64_tr_b16 v[22:23], v9 offset:24320
    v_mfma_f32_32x32x16_bf16 v[120:135], v[28:31], a[56:59], v[120:135]
    s_barrier
    ds_read_b64_tr_b16 v[24:25], v7 offset:16384
    ds_read_b64_tr_b16 v[26:27], v7 offset:17408
    buffer_load_dwordx4 a[156:159], v1, s[4:7], s33 offen offset:3072 sc0 sc1
    s_add_u32 s33, s33, 4096
    s_waitcnt lgkmcnt(6)
    v_mfma_f32_32x32x16_bf16 v[136:151], v[32:35], a[56:59], v[136:151]
    ds_read_b64_tr_b16 v[28:29], v8 offset:16384
    ds_read_b64_tr_b16 v[30:31], v8 offset:17408
    v_mfma_f32_32x32x16_bf16 v[104:119], v[36:39], a[60:63], v[104:119]
    ds_read_b64_tr_b16 v[32:33], v9 offset:16384
    ds_read_b64_tr_b16 v[34:35], v9 offset:16640
    buffer_load_dwordx4 a[160:163], v1, s[4:7], s34 offen offset:0 sc0 sc1
    s_waitcnt lgkmcnt(6)
    v_mfma_f32_32x32x16_bf16 v[120:135], v[16:19], a[60:63], v[120:135]
    ds_read_b64_tr_b16 v[36:37], v7 offset:18432
    ds_read_b64_tr_b16 v[38:39], v7 offset:19456
    v_mfma_f32_32x32x16_bf16 v[136:151], v[20:23], a[60:63], v[136:151]
    ds_read_b64_tr_b16 v[16:17], v8 offset:18432
    ds_read_b64_tr_b16 v[18:19], v8 offset:19456
    buffer_load_dwordx4 a[164:167], v1, s[4:7], s34 offen offset:1024 sc0 sc1
    s_waitcnt lgkmcnt(6)
    v_mfma_f32_32x32x16_bf16 v[104:119], v[24:27], a[64:67], v[104:119]
    ds_read_b64_tr_b16 v[20:21], v9 offset:16896
    ds_read_b64_tr_b16 v[22:23], v9 offset:17152
    v_mfma_f32_32x32x16_bf16 v[120:135], v[28:31], a[64:67], v[120:135]
    ds_read_b64_tr_b16 v[24:25], v7 offset:20480
    ds_read_b64_tr_b16 v[26:27], v7 offset:21504
    buffer_load_dwordx4 a[168:171], v1, s[4:7], s34 offen offset:2048 sc0 sc1
    s_waitcnt lgkmcnt(6)
    v_mfma_f32_32x32x16_bf16 v[136:151], v[32:35], a[64:67], v[136:151]
    ds_read_b64_tr_b16 v[28:29], v8 offset:20480
    ds_read_b64_tr_b16 v[30:31], v8 offset:21504
    s_waitcnt vmcnt(9)
    v_add_f32 v72, v72, v74
    v_mfma_f32_32x32x16_bf16 v[104:119], v[36:39], a[68:71], v[104:119]
    ds_read_b64_tr_b16 v[32:33], v9 offset:17408
    ds_read_b64_tr_b16 v[34:35], v9 offset:17664
    buffer_load_dwordx4 a[172:175], v1, s[4:7], s34 offen offset:3072 sc0 sc1
    s_add_u32 s34, s34, 4096
    v_add_f32 v73, v73, v75
    v_add_f32 v76, v76, v78
    s_waitcnt lgkmcnt(6)
    v_mfma_f32_32x32x16_bf16 v[120:135], v[16:19], a[68:71], v[120:135]
    ds_read_b64_tr_b16 v[36:37], v7 offset:22528
    ds_read_b64_tr_b16 v[38:39], v7 offset:23552
    v_add_f32 v77, v77, v79
    v_add_f32 v80, v80, v82
    v_mfma_f32_32x32x16_bf16 v[136:151], v[20:23], a[68:71], v[136:151]
    ds_read_b64_tr_b16 v[16:17], v8 offset:22528
    ds_read_b64_tr_b16 v[18:19], v8 offset:23552
    buffer_load_dwordx4 a[176:179], v1, s[4:7], s35 offen offset:0 sc0 sc1
    v_add_f32 v81, v81, v83
    v_add_f32 v84, v84, v86
    s_waitcnt lgkmcnt(6)
    v_mfma_f32_32x32x16_bf16 v[104:119], v[24:27], a[72:75], v[104:119]
    ds_read_b64_tr_b16 v[20:21], v9 offset:17920
    ds_read_b64_tr_b16 v[22:23], v9 offset:18176
    v_mov_b32 v14, 4
    buffer_store_dword v14, v11, s[4:7], s71 offen offset:0 sc0 sc1
    v_mfma_f32_32x32x16_bf16 v[120:135], v[28:31], a[72:75], v[120:135]
    ds_read_b64_tr_b16 v[24:25], v7 offset:24576
    ds_read_b64_tr_b16 v[26:27], v7 offset:25600
    buffer_load_dwordx4 a[180:183], v1, s[4:7], s35 offen offset:1024 sc0 sc1
    v_add_f32 v85, v85, v87
    v_add_f32 v72, v72, v76
    s_waitcnt lgkmcnt(6)
    v_mfma_f32_32x32x16_bf16 v[136:151], v[32:35], a[72:75], v[136:151]
    ds_read_b64_tr_b16 v[28:29], v8 offset:24576
    ds_read_b64_tr_b16 v[30:31], v8 offset:25600
    v_add_f32 v73, v73, v77
    v_add_f32 v80, v80, v84
    v_mfma_f32_32x32x16_bf16 v[104:119], v[36:39], a[76:79], v[104:119]
    ds_read_b64_tr_b16 v[32:33], v9 offset:18432
    ds_read_b64_tr_b16 v[34:35], v9 offset:18688
    buffer_load_dwordx4 a[184:187], v1, s[4:7], s35 offen offset:2048 sc0 sc1
    v_add_f32 v81, v81, v85
    v_add_f32 v72, v72, v80
    s_waitcnt lgkmcnt(6)
    v_mfma_f32_32x32x16_bf16 v[120:135], v[16:19], a[76:79], v[120:135]
    ds_read_b64_tr_b16 v[36:37], v7 offset:26624
    ds_read_b64_tr_b16 v[38:39], v7 offset:27648
    v_add_f32 v73, v73, v81
    v_mov_b32 v74, v72
    v_mfma_f32_32x32x16_bf16 v[136:151], v[20:23], a[76:79], v[136:151]
    ds_read_b64_tr_b16 v[16:17], v8 offset:26624
    ds_read_b64_tr_b16 v[18:19], v8 offset:27648
    buffer_load_dwordx4 a[188:191], v1, s[4:7], s35 offen offset:3072 sc0 sc1
    s_add_u32 s35, s35, 4096
    v_mov_b32 v75, v73
    v_permlane32_swap_b32 v72, v74
    s_waitcnt lgkmcnt(6)
    v_mfma_f32_32x32x16_bf16 v[104:119], v[24:27], a[80:83], v[104:119]
    ds_read_b64_tr_b16 v[20:21], v9 offset:18944
    ds_read_b64_tr_b16 v[22:23], v9 offset:19200
    v_permlane32_swap_b32 v73, v75
    v_add_f32 v72, v72, v74
    v_mfma_f32_32x32x16_bf16 v[120:135], v[28:31], a[80:83], v[120:135]
    ds_read_b64_tr_b16 v[24:25], v7 offset:28672
    ds_read_b64_tr_b16 v[26:27], v7 offset:29696
    v_add_f32 v73, v73, v75
    v_cmp_u_f32 vcc, v72, v73
    s_cbranch_vccnz KT_SLOW23
KT_BACK23:
    s_waitcnt lgkmcnt(6)
    v_mfma_f32_32x32x16_bf16 v[136:151], v[32:35], a[80:83], v[136:151]
    ds_read_b64_tr_b16 v[28:29], v8 offset:28672
    ds_read_b64_tr_b16 v[30:31], v8 offset:29696
    v_mul_f32 v72, 0x3ae38e39, v72
    v_mul_f32 v249, 0x3ae38e39, v73
    v_mfma_f32_32x32x16_bf16 v[104:119], v[36:39], a[84:87], v[104:119]
    ds_read_b64_tr_b16 v[32:33], v9 offset:19456
    ds_read_b64_tr_b16 v[34:35], v9 offset:19712
    v_fma_f32 v249, -v72, v72, v249
    v_max_f32 v249, 0, v249
    v_cvt_pk_bf16_f32 v249, v249, v249
    s_waitcnt lgkmcnt(6)
    v_mfma_f32_32x32x16_bf16 v[120:135], v[16:19], a[84:87], v[120:135]
    ds_read_b64_tr_b16 v[36:37], v7 offset:30720
    ds_read_b64_tr_b16 v[38:39], v7 offset:31744
    v_and_b32 v249, 0xffff0000, v249
    v_add_f32 v249, 0x3727c5ac, v249
    v_mfma_f32_32x32x16_bf16 v[136:151], v[20:23], a[84:87], v[136:151]
    ds_read_b64_tr_b16 v[16:17], v8 offset:30720
    ds_read_b64_tr_b16 v[18:19], v8 offset:31744
    v_cvt_pk_bf16_f32 v249, v249, v249
    v_and_b32 v249, 0xffff0000, v249
    v_sqrt_f32 v249, v249
    s_waitcnt lgkmcnt(6)
    v_mfma_f32_32x32x16_bf16 v[104:119], v[24:27], a[88:91], v[104:119]
    ds_read_b64_tr_b16 v[20:21], v9 offset:19968
    ds_read_b64_tr_b16 v[22:23], v9 offset:20224
    v_cvt_pk_bf16_f32 v249, v249, v249
    v_and_b32 v249, 0xffff0000, v249
    v_mfma_f32_32x32x16_bf16 v[120:135], v[28:31], a[88:91], v[120:135]
    s_barrier
    v_add_u32 v7, 4294950912, v7
    ds_read_b64_tr_b16 v[24:25], v7 offset:0
    ds_read_b64_tr_b16 v[26:27], v7 offset:1024
    v_rcp_f32 v248, v249
    s_waitcnt lgkmcnt(6)
    v_mfma_f32_32x32x16_bf16 v[136:151], v[32:35], a[88:91], v[136:151]
    v_add_u32 v8, 4294950912, v8
    ds_read_b64_tr_b16 v[28:29], v8 offset:0
    ds_read_b64_tr_b16 v[30:31], v8 offset:1024
    v_rcp_f32 v249, v249
    v_lshlrev_b32 v245, 3, v0
    v_mfma_f32_32x32x16_bf16 v[104:119], v[36:39], a[92:95], v[104:119]
    v_add_u32 v9, 81920, v9
    ds_read_b64_tr_b16 v[32:33], v9 offset:12288
    ds_read_b64_tr_b16 v[34:35], v9 offset:12544
    v_add_u32 v239, s77, v245
    s_xor_b32 s41, s54, 0x7f000000
    v_add_u32 v240, s41, v245
    s_waitcnt lgkmcnt(6)
    v_mfma_f32_32x32x16_bf16 v[120:135], v[16:19], a[92:95], v[120:135]
    ds_read_b64_tr_b16 v[36:37], v7 offset:2048
    ds_read_b64_tr_b16 v[38:39], v7 offset:3072
    v_and_b32 v242, 31, v0
    v_lshrrev_b32 v243, 5, v0
    v_mfma_f32_32x32x16_bf16 v[136:151], v[20:23], a[92:95], v[136:151]
    ds_read_b64_tr_b16 v[16:17], v8 offset:2048
    ds_read_b64_tr_b16 v[18:19], v8 offset:3072
    v_mul_u32_u24 v244, 1152, v242
    v_lshl_add_u32 v236, v243, 4, v244
    v_lshl_add_u32 v243, v243, 3, s54
    s_waitcnt lgkmcnt(6)
    v_mfma_f32_32x32x16_bf16 v[104:119], v[24:27], a[96:99], v[104:119]
    ds_read_b64_tr_b16 v[20:21], v9 offset:12800
    ds_read_b64_tr_b16 v[22:23], v9 offset:13056
    v_add_u32 v237, v243, v244
    v_lshl_add_u32 v238, v242, 4, v243
    v_mfma_f32_32x32x16_bf16 v[120:135], v[28:31], a[96:99], v[120:135]
    ds_read_b64_tr_b16 v[24:25], v7 offset:4096
    ds_read_b64_tr_b16 v[26:27], v7 offset:5120
    s_waitcnt lgkmcnt(6)
    v_mfma_f32_32x32x16_bf16 v[136:151], v[32:35], a[96:99], v[136:151]
    ds_read_b64_tr_b16 v[28:29], v8 offset:4096
    ds_read_b64_tr_b16 v[30:31], v8 offset:5120
    v_mov_b32 v14, 5
    buffer_store_dword v14, v11, s[4:7], s71 offen offset:0 sc0 sc1
    v_mfma_f32_32x32x16_bf16 v[104:119], v[36:39], a[100:103], v[104:119]
    ds_read_b64_tr_b16 v[32:33], v9 offset:13312
    ds_read_b64_tr_b16 v[34:35], v9 offset:13568
    s_waitcnt lgkmcnt(6)
    v_mfma_f32_32x32x16_bf16 v[120:135], v[16:19], a[100:103], v[120:135]
    ds_read_b64_tr_b16 v[36:37], v7 offset:6144
    ds_read_b64_tr_b16 v[38:39], v7 offset:7168
    v_mfma_f32_32x32x16_bf16 v[136:151], v[20:23], a[100:103], v[136:151]
    ds_read_b64_tr_b16 v[16:17], v8 offset:6144
    ds_read_b64_tr_b16 v[18:19], v8 offset:7168
    s_waitcnt lgkmcnt(6)
    v_mfma_f32_32x32x16_bf16 v[104:119], v[24:27], a[104:107], v[104:119]
    ds_read_b64_tr_b16 v[20:21], v9 offset:13824
    ds_read_b64_tr_b16 v[22:23], v9 offset:14080
    v_mfma_f32_32x32x16_bf16 v[120:135], v[28:31], a[104:107], v[120:135]
    ds_read_b64_tr_b16 v[24:25], v7 offset:8192
    ds_read_b64_tr_b16 v[26:27], v7 offset:9216
    s_waitcnt lgkmcnt(6)
    v_mfma_f32_32x32x16_bf16 v[136:151], v[32:35], a[104:107], v[136:151]
    ds_read_b64_tr_b16 v[28:29], v8 offset:8192
    ds_read_b64_tr_b16 v[30:31], v8 offset:9216
    v_mfma_f32_32x32x16_bf16 v[104:119], v[36:39], a[108:111], v[104:119]
    ds_read_b64_tr_b16 v[32:33], v9 offset:14336
    ds_read_b64_tr_b16 v[34:35], v9 offset:14592
    s_waitcnt lgkmcnt(6)
    v_mfma_f32_32x32x16_bf16 v[120:135], v[16:19], a[108:111], v[120:135]
    ds_read_b64_tr_b16 v[36:37], v7 offset:10240
    ds_read_b64_tr_b16 v[38:39], v7 offset:11264
    v_mfma_f32_32x32x16_bf16 v[136:151], v[20:23], a[108:111], v[136:151]
    ds_read_b64_tr_b16 v[16:17], v8 offset:10240
    ds_read_b64_tr_b16 v[18:19], v8 offset:11264
    s_waitcnt lgkmcnt(6)
    v_mfma_f32_32x32x16_bf16 v[104:119], v[24:27], a[112:115], v[104:119]
    ds_read_b64_tr_b16 v[20:21], v9 offset:14848
    ds_read_b64_tr_b16 v[22:23], v9 offset:15104
    buffer_load_dword v13, v12, s[4:7], s78 offen sc0 sc1
    v_mfma_f32_32x32x16_bf16 v[120:135], v[28:31], a[112:115], v[120:135]
    ds_read_b64_tr_b16 v[24:25], v7 offset:12288
    ds_read_b64_tr_b16 v[26:27], v7 offset:13312
    s_waitcnt lgkmcnt(6)
    v_mfma_f32_32x32x16_bf16 v[136:151], v[32:35], a[112:115], v[136:151]
    ds_read_b64_tr_b16 v[28:29], v8 offset:12288
    ds_read_b64_tr_b16 v[30:31], v8 offset:13312
    v_mfma_f32_32x32x16_bf16 v[104:119], v[36:39], a[116:119], v[104:119]
    ds_read_b64_tr_b16 v[32:33], v9 offset:15360
    ds_read_b64_tr_b16 v[34:35], v9 offset:15616
    s_waitcnt lgkmcnt(6)
    v_mfma_f32_32x32x16_bf16 v[120:135], v[16:19], a[116:119], v[120:135]
    ds_read_b64_tr_b16 v[36:37], v7 offset:14336
    ds_read_b64_tr_b16 v[38:39], v7 offset:15360
    v_mfma_f32_32x32x16_bf16 v[136:151], v[20:23], a[116:119], v[136:151]
    ds_read_b64_tr_b16 v[16:17], v8 offset:14336
    ds_read_b64_tr_b16 v[18:19], v8 offset:15360
    s_waitcnt lgkmcnt(6)
    v_mfma_f32_32x32x16_bf16 v[104:119], v[24:27], a[120:123], v[104:119]
    ds_read_b64_tr_b16 v[20:21], v9 offset:15872
    ds_read_b64_tr_b16 v[22:23], v9 offset:16128
    v_mfma_f32_32x32x16_bf16 v[120:135], v[28:31], a[120:123], v[120:135]
    s_barrier
    v_add_u32 v7, 4294934528, v7
    ds_read_b64_tr_b16 v[24:25], v7 offset:0
    ds_read_b64_tr_b16 v[26:27], v7 offset:1024
    s_waitcnt lgkmcnt(6)
    v_mfma_f32_32x32x16_bf16 v[136:151], v[32:35], a[120:123], v[136:151]
    v_add_u32 v8, 4294934528, v8
    ds_read_b64_tr_b16 v[28:29], v8 offset:0
    ds_read_b64_tr_b16 v[30:31], v8 offset:1024
    v_mfma_f32_32x32x16_bf16 v[104:119], v[36:39], a[124:127], v[104:119]
    ds_read_b64_tr_b16 v[32:33], v9 offset:8192
    ds_read_b64_tr_b16 v[34:35], v9 offset:8448
    s_waitcnt lgkmcnt(6)
    v_mfma_f32_32x32x16_bf16 v[120:135], v[16:19], a[124:127], v[120:135]
    ds_read_b64_tr_b16 v[36:37], v7 offset:2048
    ds_read_b64_tr_b16 v[38:39], v7 offset:3072
    v_mfma_f32_32x32x16_bf16 v[136:151], v[20:23], a[124:127], v[136:151]
    ds_read_b64_tr_b16 v[16:17], v8 offset:2048
    ds_read_b64_tr_b16 v[18:19], v8 offset:3072
    s_waitcnt lgkmcnt(6)
    v_mfma_f32_32x32x16_bf16 v[104:119], v[24:27], a[128:131], v[104:119]
    ds_read_b64_tr_b16 v[20:21], v9 offset:8704
    ds_read_b64_tr_b16 v[22:23], v9 offset:8960
    v_mfma_f32_32x32x16_bf16 v[120:135], v[28:31], a[128:131], v[120:135]
    ds_read_b64_tr_b16 v[24:25], v7 offset:4096
    ds_read_b64_tr_b16 v[26:27], v7 offset:5120
    s_waitcnt lgkmcnt(6)
    v_mfma_f32_32x32x16_bf16 v[136:151], v[32:35], a[128:131], v[136:151]
    ds_read_b64_tr_b16 v[28:29], v8 offset:4096
    ds_read_b64_tr_b16 v[30:31], v8 offset:5120
    v_mfma_f32_32x32x16_bf16 v[104:119], v[36:39], a[132:135], v[104:119]
    ds_read_b64_tr_b16 v[32:33], v9 offset:9216
    ds_read_b64_tr_b16 v[34:35], v9 offset:9472
    s_waitcnt lgkmcnt(6)
    v_mfma_f32_32x32x16_bf16 v[120:135], v[16:19], a[132:135], v[120:135]
    ds_read_b64_tr_b16 v[36:37], v7 offset:6144
    ds_read_b64_tr_b16 v[38:39], v7 offset:7168
    v_mfma_f32_32x32x16_bf16 v[136:151], v[20:23], a[132:135], v[136:151]
    ds_read_b64_tr_b16 v[16:17], v8 offset:6144
    ds_read_b64_tr_b16 v[18:19], v8 offset:7168
    s_waitcnt lgkmcnt(6)
    v_mfma_f32_32x32x16_bf16 v[104:119], v[24:27], a[136:139], v[104:119]
    ds_read_b64_tr_b16 v[20:21], v9 offset:9728
    ds_read_b64_tr_b16 v[22:23], v9 offset:9984
    v_mfma_f32_32x32x16_bf16 v[120:135], v[28:31], a[136:139], v[120:135]
    ds_read_b64_tr_b16 v[24:25], v7 offset:8192
    ds_read_b64_tr_b16 v[26:27], v7 offset:9216
    s_waitcnt lgkmcnt(6)
    v_mfma_f32_32x32x16_bf16 v[136:151], v[32:35], a[136:139], v[136:151]
    ds_read_b64_tr_b16 v[28:29], v8 offset:8192
    ds_read_b64_tr_b16 v[30:31], v8 offset:9216
    buffer_load_dword v13, v12, s[4:7], s78 offen sc0 sc1
    v_mfma_f32_32x32x16_bf16 v[104:119], v[36:39], a[140:143], v[104:119]
    ds_read_b64_tr_b16 v[32:33], v9 offset:10240
    ds_read_b64_tr_b16 v[34:35], v9 offset:10496
    s_waitcnt lgkmcnt(6)
    v_mfma_f32_32x32x16_bf16 v[120:135], v[16:19], a[140:143], v[120:135]
    ds_read_b64_tr_b16 v[36:37], v7 offset:10240
    ds_read_b64_tr_b16 v[38:39], v7 offset:11264
    v_mfma_f32_32x32x16_bf16 v[136:151], v[20:23], a[140:143], v[136:151]
    ds_read_b64_tr_b16 v[16:17], v8 offset:10240
    ds_read_b64_tr_b16 v[18:19], v8 offset:11264
    s_waitcnt vmcnt(14) lgkmcnt(6)
    v_mfma_f32_32x32x16_bf16 v[104:119], v[24:27], a[144:147], v[104:119]
    ds_read_b64_tr_b16 v[20:21], v9 offset:10752
    ds_read_b64_tr_b16 v[22:23], v9 offset:11008
    v_mfma_f32_32x32x16_bf16 v[120:135], v[28:31], a[144:147], v[120:135]
    ds_read_b64_tr_b16 v[24:25], v7 offset:12288
    ds_read_b64_tr_b16 v[26:27], v7 offset:13312
    s_waitcnt vmcnt(0)
    v_cmp_gt_u32 vcc, 4, v13
    s_and_b32 vcc_lo, vcc_lo, 15
    s_cbranch_scc1 KT_SLOW24
KT_BACK24:
    buffer_load_dwordx4 a[208:211], v1, s[4:7], s33 offen offset:0 sc0 sc1
    s_waitcnt lgkmcnt(6)
    v_mfma_f32_32x32x16_bf16 v[136:151], v[32:35], a[144:147], v[136:151]
    ds_read_b64_tr_b16 v[28:29], v8 offset:12288
    ds_read_b64_tr_b16 v[30:31], v8 offset:13312
    v_mfma_f32_32x32x16_bf16 v[104:119], v[36:39], a[148:151], v[104:119]
    ds_read_b64_tr_b16 v[32:33], v9 offset:11264
    ds_read_b64_tr_b16 v[34:35], v9 offset:11520
    buffer_load_dwordx4 a[212:215], v1, s[4:7], s33 offen offset:1024 sc0 sc1
    s_waitcnt lgkmcnt(6)
    v_mfma_f32_32x32x16_bf16 v[120:135], v[16:19], a[148:151], v[120:135]
    ds_read_b64_tr_b16 v[36:37], v7 offset:14336
    ds_read_b64_tr_b16 v[38:39], v7 offset:15360
    v_mfma_f32_32x32x16_bf16 v[136:151], v[20:23], a[148:151], v[136:151]
    ds_read_b64_tr_b16 v[16:17], v8 offset:14336
    ds_read_b64_tr_b16 v[18:19], v8 offset:15360
    buffer_load_dwordx4 a[216:219], v1, s[4:7], s33 offen offset:2048 sc0 sc1
    s_waitcnt lgkmcnt(6)
    v_mfma_f32_32x32x16_bf16 v[104:119], v[24:27], a[152:155], v[104:119]
    ds_read_b64_tr_b16 v[20:21], v9 offset:11776
    ds_read_b64_tr_b16 v[22:23], v9 offset:12032
    v_mfma_f32_32x32x16_bf16 v[120:135], v[28:31], a[152:155], v[120:135]
    s_barrier
    v_add_u32 v7, 98304, v7
    ds_read_b64_tr_b16 v[24:25], v7 offset:0
    ds_read_b64_tr_b16 v[26:27], v7 offset:1024
    buffer_load_dwordx4 a[220:223], v1, s[4:7], s33 offen offset:3072 sc0 sc1
    s_add_u32 s33, s33, s73
    s_waitcnt lgkmcnt(6)
    v_mfma_f32_32x32x16_bf16 v[136:151], v[32:35], a[152:155], v[136:151]
    v_add_u32 v8, 98304, v8
    ds_read_b64_tr_b16 v[28:29], v8 offset:0
    ds_read_b64_tr_b16 v[30:31], v8 offset:1024
    v_mfma_f32_32x32x16_bf16 v[104:119], v[36:39], a[156:159], v[104:119]
    ds_read_b64_tr_b16 v[32:33], v9 offset:4096
    ds_read_b64_tr_b16 v[34:35], v9 offset:4352
    buffer_load_dwordx4 a[224:227], v1, s[4:7], s34 offen offset:0 sc0 sc1
    s_waitcnt lgkmcnt(6)
    v_mfma_f32_32x32x16_bf16 v[120:135], v[16:19], a[156:159], v[120:135]
    ds_read_b64_tr_b16 v[36:37], v7 offset:2048
    ds_read_b64_tr_b16 v[38:39], v7 offset:3072
    v_mfma_f32_32x32x16_bf16 v[136:151], v[20:23], a[156:159], v[136:151]
    ds_read_b64_tr_b16 v[16:17], v8 offset:2048
    ds_read_b64_tr_b16 v[18:19], v8 offset:3072
    buffer_load_dwordx4 a[228:231], v1, s[4:7], s34 offen offset:1024 sc0 sc1
    s_waitcnt lgkmcnt(6)
    v_mfma_f32_32x32x16_bf16 v[104:119], v[24:27], a[160:163], v[104:119]
    ds_read_b64_tr_b16 v[20:21], v9 offset:4608
    ds_read_b64_tr_b16 v[22:23], v9 offset:4864
    v_mfma_f32_32x32x16_bf16 v[120:135], v[28:31], a[160:163], v[120:135]
    ds_read_b64_tr_b16 v[24:25], v7 offset:4096
    ds_read_b64_tr_b16 v[26:27], v7 offset:5120
    buffer_load_dwordx4 a[232:235], v1, s[4:7], s34 offen offset:2048 sc0 sc1
    s_waitcnt lgkmcnt(6)
    v_mfma_f32_32x32x16_bf16 v[136:151], v[32:35], a[160:163], v[136:151]
    ds_read_b64_tr_b16 v[28:29], v8 offset:4096
    ds_read_b64_tr_b16 v[30:31], v8 offset:5120
    v_mfma_f32_32x32x16_bf16 v[104:119], v[36:39], a[164:167], v[104:119]
    ds_read_b64_tr_b16 v[32:33], v9 offset:5120
    ds_read_b64_tr_b16 v[34:35], v9 offset:5376
    buffer_load_dwordx4 a[236:239], v1, s[4:7], s34 offen offset:3072 sc0 sc1
    s_add_u32 s34, s34, s72
    s_waitcnt lgkmcnt(6)
    v_mfma_f32_32x32x16_bf16 v[120:135], v[16:19], a[164:167], v[120:135]
    ds_read_b64_tr_b16 v[36:37], v7 offset:6144
    ds_read_b64_tr_b16 v[38:39], v7 offset:7168
    v_mfma_f32_32x32x16_bf16 v[136:151], v[20:23], a[164:167], v[136:151]
    ds_read_b64_tr_b16 v[16:17], v8 offset:6144
    ds_read_b64_tr_b16 v[18:19], v8 offset:7168
    buffer_load_dwordx4 a[240:243], v1, s[4:7], s35 offen offset:0 sc0 sc1
    s_waitcnt lgkmcnt(6)
    v_mfma_f32_32x32x16_bf16 v[104:119], v[24:27], a[168:171], v[104:119]
    ds_read_b64_tr_b16 v[20:21], v9 offset:5632
    ds_read_b64_tr_b16 v[22:23], v9 offset:5888
    v_mfma_f32_32x32x16_bf16 v[120:135], v[28:31], a[168:171], v[120:135]
    ds_read_b64_tr_b16 v[24:25], v7 offset:8192
    ds_read_b64_tr_b16 v[26:27], v7 offset:9216
    buffer_load_dwordx4 a[244:247], v1, s[4:7], s35 offen offset:1024 sc0 sc1
    s_waitcnt lgkmcnt(6)
    v_mfma_f32_32x32x16_bf16 v[136:151], v[32:35], a[168:171], v[136:151]
    ds_read_b64_tr_b16 v[28:29], v8 offset:8192
    ds_read_b64_tr_b16 v[30:31], v8 offset:9216
    v_mfma_f32_32x32x16_bf16 v[104:119], v[36:39], a[172:175], v[104:119]
    ds_read_b64_tr_b16 v[32:33], v9 offset:6144
    ds_read_b64_tr_b16 v[34:35], v9 offset:6400
    buffer_load_dwordx4 a[248:251], v1, s[4:7], s35 offen offset:2048 sc0 sc1
    s_waitcnt lgkmcnt(6)
    v_mfma_f32_32x32x16_bf16 v[120:135], v[16:19], a[172:175], v[120:135]
    ds_read_b64_tr_b16 v[36:37], v7 offset:10240
    ds_read_b64_tr_b16 v[38:39], v7 offset:11264
    v_cmp_gt_u32 vcc, 5, v13
    s_and_b32 vcc_lo, vcc_lo, 15
    s_cbranch_scc1 KT_SLOW25
KT_BACK25:
    buffer_load_dwordx4 v[192:195], v1, s[4:7], s33 offen offset:0 sc0 sc1
    v_mfma_f32_32x32x16_bf16 v[136:151], v[20:23], a[172:175], v[136:151]
    ds_read_b64_tr_b16 v[16:17], v8 offset:10240
    ds_read_b64_tr_b16 v[18:19], v8 offset:11264
    buffer_load_dwordx4 a[252:255], v1, s[4:7], s35 offen offset:3072 sc0 sc1
    s_add_u32 s35, s35, s73
    s_waitcnt lgkmcnt(6)
    v_mfma_f32_32x32x16_bf16 v[104:119], v[24:27], a[176:179], v[104:119]
    ds_read_b64_tr_b16 v[20:21], v9 offset:6656
    ds_read_b64_tr_b16 v[22:23], v9 offset:6912
    buffer_load_dwordx4 v[196:199], v1, s[4:7], s33 offen offset:1024 sc0 sc1
    v_mfma_f32_32x32x16_bf16 v[120:135], v[28:31], a[176:179], v[120:135]
    ds_read_b64_tr_b16 v[24:25], v7 offset:12288
    ds_read_b64_tr_b16 v[26:27], v7 offset:13312
    s_add_u32 s61, s61, s36
    s_add_u32 s62, s62, s36
    s_add_u32 s63, s63, s36
    s_add_u32 m0, s38, 0
    s_add_u32 s3, s61, 0
    buffer_load_dwordx4 v2, s[16:19], s3 offen offset:0 lds
    s_waitcnt lgkmcnt(6)
    v_mfma_f32_32x32x16_bf16 v[136:151], v[32:35], a[176:179], v[136:151]
    ds_read_b64_tr_b16 v[28:29], v8 offset:12288
    ds_read_b64_tr_b16 v[30:31], v8 offset:13312
    buffer_load_dwordx4 v[200:203], v1, s[4:7], s34 offen offset:0 sc0 sc1
    v_mfma_f32_32x32x16_bf16 v[104:119], v[36:39], a[180:183], v[104:119]
    ds_read_b64_tr_b16 v[32:33], v9 offset:7168
    ds_read_b64_tr_b16 v[34:35], v9 offset:7424
    buffer_load_dwordx4 v3, s[16:19], s3 offen offset:1024 lds
    s_waitcnt lgkmcnt(6)
    v_mfma_f32_32x32x16_bf16 v[120:135], v[16:19], a[180:183], v[120:135]
    ds_read_b64_tr_b16 v[36:37], v7 offset:14336
    ds_read_b64_tr_b16 v[38:39], v7 offset:15360
    buffer_load_dwordx4 v[204:207], v1, s[4:7], s34 offen offset:1024 sc0 sc1
    v_mfma_f32_32x32x16_bf16 v[136:151], v[20:23], a[180:183], v[136:151]
    ds_read_b64_tr_b16 v[16:17], v8 offset:14336
    ds_read_b64_tr_b16 v[18:19], v8 offset:15360
    buffer_load_dwordx4 v4, s[16:19], s3 offen offset:2048 lds
    s_waitcnt lgkmcnt(6)
    v_mfma_f32_32x32x16_bf16 v[104:119], v[24:27], a[184:187], v[104:119]
    ds_read_b64_tr_b16 v[20:21], v9 offset:7680
    ds_read_b64_tr_b16 v[22:23], v9 offset:7936
    buffer_load_dwordx4 v[208:211], v1, s[4:7], s35 offen offset:0 sc0 sc1
    v_mfma_f32_32x32x16_bf16 v[120:135], v[28:31], a[184:187], v[120:135]
    s_barrier
    ds_read_b64_tr_b16 v[24:25], v7 offset:16384
    ds_read_b64_tr_b16 v[26:27], v7 offset:17408
    buffer_load_dwordx4 v5, s[16:19], s3 offen offset:3072 lds
    s_waitcnt lgkmcnt(6)
    v_mfma_f32_32x32x16_bf16 v[136:151], v[32:35], a[184:187], v[136:151]
    ds_read_b64_tr_b16 v[28:29], v8 offset:16384
    ds_read_b64_tr_b16 v[30:31], v8 offset:17408
    buffer_load_dwordx4 v[212:215], v1, s[4:7], s35 offen offset:1024 sc0 sc1
    v_mfma_f32_32x32x16_bf16 v[104:119], v[36:39], a[188:191], v[104:119]
    ds_read_b64_tr_b16 v[32:33], v9 offset:0
    ds_read_b64_tr_b16 v[34:35], v9 offset:256
    s_add_u32 m0, s38, 32768
    s_add_u32 s3, s62, 0
    buffer_load_dwordx4 v2, s[16:19], s3 offen offset:0 lds
    s_waitcnt lgkmcnt(6)
    v_mfma_f32_32x32x16_bf16 v[120:135], v[16:19], a[188:191], v[120:135]
    ds_read_b64_tr_b16 v[36:37], v7 offset:18432
    ds_read_b64_tr_b16 v[38:39], v7 offset:19456
    v_mfma_f32_32x32x16_bf16 v[136:151], v[20:23], a[188:191], v[136:151]
    ds_read_b64_tr_b16 v[16:17], v8 offset:18432
    ds_read_b64_tr_b16 v[18:19], v8 offset:19456
    buffer_load_dwordx4 v3, s[16:19], s3 offen offset:1024 lds
    s_waitcnt lgkmcnt(6)
    v_mfma_f32_32x32x16_bf16 v[104:119], v[24:27], a[192:195], v[104:119]
    ds_read_b64_tr_b16 v[20:21], v9 offset:512
    ds_read_b64_tr_b16 v[22:23], v9 offset:768
    v_mfma_f32_32x32x16_bf16 v[120:135], v[28:31], a[192:195], v[120:135]
    ds_read_b64_tr_b16 v[24:25], v7 offset:20480
    ds_read_b64_tr_b16 v[26:27], v7 offset:21504
    buffer_load_dwordx4 v4, s[16:19], s3 offen offset:2048 lds
    s_waitcnt lgkmcnt(6)
    v_mfma_f32_32x32x16_bf16 v[136:151], v[32:35], a[192:195], v[136:151]
    ds_read_b64_tr_b16 v[28:29], v8 offset:20480
    ds_read_b64_tr_b16 v[30:31], v8 offset:21504
    v_mfma_f32_32x32x16_bf16 v[104:119], v[36:39], a[196:199], v[104:119]
    ds_read_b64_tr_b16 v[32:33], v9 offset:1024
    ds_read_b64_tr_b16 v[34:35], v9 offset:1280
    buffer_load_dwordx4 v5, s[16:19], s3 offen offset:3072 lds
    s_waitcnt lgkmcnt(6)
    v_mfma_f32_32x32x16_bf16 v[120:135], v[16:19], a[196:199], v[120:135]
    ds_read_b64_tr_b16 v[36:37], v7 offset:22528
    ds_read_b64_tr_b16 v[38:39], v7 offset:23552
    v_mfma_f32_32x32x16_bf16 v[136:151], v[20:23], a[196:199], v[136:151]
    ds_read_b64_tr_b16 v[16:17], v8 offset:22528
    ds_read_b64_tr_b16 v[18:19], v8 offset:23552
    s_add_u32 m0, s38, 49152
    s_add_u32 s3, s61, 73728
    buffer_load_dwordx4 v2, s[16:19], s3 offen offset:0 lds
    s_waitcnt lgkmcnt(6)
    v_mfma_f32_32x32x16_bf16 v[104:119], v[24:27], a[200:203], v[104:119]
    ds_read_b64_tr_b16 v[20:21], v9 offset:1536
    ds_read_b64_tr_b16 v[22:23], v9 offset:1792
    v_mfma_f32_32x32x16_bf16 v[120:135], v[28:31], a[200:203], v[120:135]
    ds_read_b64_tr_b16 v[24:25], v7 offset:24576
    ds_read_b64_tr_b16 v[26:27], v7 offset:25600
    buffer_load_dwordx4 v3, s[16:19], s3 offen offset:1024 lds
    s_waitcnt lgkmcnt(6)
    v_mfma_f32_32x32x16_bf16 v[136:151], v[32:35], a[200:203], v[136:151]
    ds_read_b64_tr_b16 v[28:29], v8 offset:24576
    ds_read_b64_tr_b16 v[30:31], v8 offset:25600
    v_mfma_f32_32x32x16_bf16 v[104:119], v[36:39], a[204:207], v[104:119]
    ds_read_b64_tr_b16 v[32:33], v9 offset:2048
    ds_read_b64_tr_b16 v[34:35], v9 offset:2304
    buffer_load_dwordx4 v4, s[16:19], s3 offen offset:2048 lds
    s_waitcnt lgkmcnt(6)
    v_mfma_f32_32x32x16_bf16 v[120:135], v[16:19], a[204:207], v[120:135]
    ds_read_b64_tr_b16 v[36:37], v7 offset:26624
    ds_read_b64_tr_b16 v[38:39], v7 offset:27648
    v_mfma_f32_32x32x16_bf16 v[136:151], v[20:23], a[204:207], v[136:151]
    ds_read_b64_tr_b16 v[16:17], v8 offset:26624
    ds_read_b64_tr_b16 v[18:19], v8 offset:27648
    buffer_load_dwordx4 v5, s[16:19], s3 offen offset:3072 lds
    s_waitcnt vmcnt(28) lgkmcnt(6)
    v_mfma_f32_32x32x16_bf16 v[104:119], v[24:27], a[208:211], v[104:119]
    ds_read_b64_tr_b16 v[20:21], v9 offset:2560
    ds_read_b64_tr_b16 v[22:23], v9 offset:2816
    v_mfma_f32_32x32x16_bf16 v[120:135], v[28:31], a[208:211], v[120:135]
    ds_read_b64_tr_b16 v[24:25], v7 offset:28672
    ds_read_b64_tr_b16 v[26:27], v7 offset:29696
    s_add_u32 m0, s38, 65536
    s_add_u32 s3, s62, 73728
    buffer_load_dwordx4 v2, s[16:19], s3 offen offset:0 lds
    s_waitcnt lgkmcnt(6)
    v_mfma_f32_32x32x16_bf16 v[136:151], v[32:35], a[208:211], v[136:151]
    ds_read_b64_tr_b16 v[28:29], v8 offset:28672
    ds_read_b64_tr_b16 v[30:31], v8 offset:29696
    v_mfma_f32_32x32x16_bf16 v[104:119], v[36:39], a[212:215], v[104:119]
    ds_read_b64_tr_b16 v[32:33], v9 offset:3072
    ds_read_b64_tr_b16 v[34:35], v9 offset:3328
    buffer_load_dwordx4 v3, s[16:19], s3 offen offset:1024 lds
    s_waitcnt lgkmcnt(6)
    v_mfma_f32_32x32x16_bf16 v[120:135], v[16:19], a[212:215], v[120:135]
    ds_read_b64_tr_b16 v[36:37], v7 offset:30720
    ds_read_b64_tr_b16 v[38:39], v7 offset:31744
    v_mfma_f32_32x32x16_bf16 v[136:151], v[20:23], a[212:215], v[136:151]
    ds_read_b64_tr_b16 v[16:17], v8 offset:30720
    ds_read_b64_tr_b16 v[18:19], v8 offset:31744
    buffer_load_dwordx4 v4, s[16:19], s3 offen offset:2048 lds
    s_waitcnt vmcnt(29) lgkmcnt(6)
    v_mfma_f32_32x32x16_bf16 v[104:119], v[24:27], a[216:219], v[104:119]
    ds_read_b64_tr_b16 v[20:21], v9 offset:3584
    ds_read_b64_tr_b16 v[22:23], v9 offset:3840
    v_mfma_f32_32x32x16_bf16 v[120:135], v[28:31], a[216:219], v[120:135]
    s_barrier
    ds_read_b64_tr_b16 v[24:25], v7 offset:32768
    ds_read_b64_tr_b16 v[26:27], v7 offset:33792
    buffer_load_dwordx4 v5, s[16:19], s3 offen offset:3072 lds
    s_waitcnt lgkmcnt(6)
    v_mfma_f32_32x32x16_bf16 v[136:151], v[32:35], a[216:219], v[136:151]
    ds_read_b64_tr_b16 v[28:29], v8 offset:32768
    ds_read_b64_tr_b16 v[30:31], v8 offset:33792
    v_mfma_f32_32x32x16_bf16 v[104:119], v[36:39], a[220:223], v[104:119]
    v_add_u32 v9, 4294901760, v9
    ds_read_b64_tr_b16 v[32:33], v9 offset:12288
    ds_read_b64_tr_b16 v[34:35], v9 offset:12544
    s_add_u32 m0, s38, 81920
    s_add_u32 s3, s61, 147456
    buffer_load_dwordx4 v2, s[16:19], s3 offen offset:0 lds
    s_waitcnt lgkmcnt(6)
    v_mfma_f32_32x32x16_bf16 v[120:135], v[16:19], a[220:223], v[120:135]
    ds_read_b64_tr_b16 v[36:37], v7 offset:34816
    ds_read_b64_tr_b16 v[38:39], v7 offset:35840
    v_mfma_f32_32x32x16_bf16 v[136:151], v[20:23], a[220:223], v[136:151]
    ds_read_b64_tr_b16 v[16:17], v8 offset:34816
    ds_read_b64_tr_b16 v[18:19], v8 offset:35840
    buffer_load_dwordx4 v3, s[16:19], s3 offen offset:1024 lds
    s_waitcnt vmcnt(30) lgkmcnt(6)
    v_mfma_f32_32x32x16_bf16 v[104:119], v[24:27], a[224:227], v[104:119]
    ds_read_b64_tr_b16 v[20:21], v9 offset:12800
    ds_read_b64_tr_b16 v[22:23], v9 offset:13056
    v_mfma_f32_32x32x16_bf16 v[120:135], v[28:31], a[224:227], v[120:135]
    ds_read_b64_tr_b16 v[24:25], v7 offset:36864
    ds_read_b64_tr_b16 v[26:27], v7 offset:37888
    buffer_load_dwordx4 v4, s[16:19], s3 offen offset:2048 lds
    s_waitcnt lgkmcnt(6)
    v_mfma_f32_32x32x16_bf16 v[136:151], v[32:35], a[224:227], v[136:151]
    ds_read_b64_tr_b16 v[28:29], v8 offset:36864
    ds_read_b64_tr_b16 v[30:31], v8 offset:37888
    v_mfma_f32_32x32x16_bf16 v[104:119], v[36:39], a[228:231], v[104:119]
    ds_read_b64_tr_b16 v[32:33], v9 offset:13312
    ds_read_b64_tr_b16 v[34:35], v9 offset:13568
    buffer_load_dwordx4 v5, s[16:19], s3 offen offset:3072 lds
    s_waitcnt lgkmcnt(6)
    v_mfma_f32_32x32x16_bf16 v[120:135], v[16:19], a[228:231], v[120:135]
    ds_read_b64_tr_b16 v[36:37], v7 offset:38912
    ds_read_b64_tr_b16 v[38:39], v7 offset:39936
    v_mfma_f32_32x32x16_bf16 v[136:151], v[20:23], a[228:231], v[136:151]
    ds_read_b64_tr_b16 v[16:17], v8 offset:38912
    ds_read_b64_tr_b16 v[18:19], v8 offset:39936
    s_add_u32 m0, s38, 98304
    s_add_u32 s3, s62, 147456
    buffer_load_dwordx4 v2, s[16:19], s3 offen offset:0 lds
    s_waitcnt vmcnt(31) lgkmcnt(6)
    v_mfma_f32_32x32x16_bf16 v[104:119], v[24:27], a[232:235], v[104:119]
    ds_read_b64_tr_b16 v[20:21], v9 offset:13824
    ds_read_b64_tr_b16 v[22:23], v9 offset:14080
    v_mfma_f32_32x32x16_bf16 v[120:135], v[28:31], a[232:235], v[120:135]
    ds_read_b64_tr_b16 v[24:25], v7 offset:40960
    ds_read_b64_tr_b16 v[26:27], v7 offset:41984
    buffer_load_dwordx4 v3, s[16:19], s3 offen offset:1024 lds
    s_waitcnt lgkmcnt(6)
    v_mfma_f32_32x32x16_bf16 v[136:151], v[32:35], a[232:235], v[136:151]
    ds_read_b64_tr_b16 v[28:29], v8 offset:40960
    ds_read_b64_tr_b16 v[30:31], v8 offset:41984
    v_mfma_f32_32x32x16_bf16 v[104:119], v[36:39], a[236:239], v[104:119]
    ds_read_b64_tr_b16 v[32:33], v9 offset:14336
    ds_read_b64_tr_b16 v[34:35], v9 offset:14592
    buffer_load_dwordx4 v4, s[16:19], s3 offen offset:2048 lds
    s_waitcnt lgkmcnt(6)
    v_mfma_f32_32x32x16_bf16 v[120:135], v[16:19], a[236:239], v[120:135]
    ds_read_b64_tr_b16 v[36:37], v7 offset:43008
    ds_read_b64_tr_b16 v[38:39], v7 offset:44032
    v_mfma_f32_32x32x16_bf16 v[136:151], v[20:23], a[236:239], v[136:151]
    ds_read_b64_tr_b16 v[16:17], v8 offset:43008
    ds_read_b64_tr_b16 v[18:19], v8 offset:44032
    buffer_load_dwordx4 v5, s[16:19], s3 offen offset:3072 lds
    s_waitcnt vmcnt(32) lgkmcnt(6)
    v_mfma_f32_32x32x16_bf16 v[104:119], v[24:27], a[240:243], v[104:119]
    ds_read_b64_tr_b16 v[20:21], v9 offset:14848
    ds_read_b64_tr_b16 v[22:23], v9 offset:15104
    v_mfma_f32_32x32x16_bf16 v[120:135], v[28:31], a[240:243], v[120:135]
    ds_read_b64_tr_b16 v[24:25], v7 offset:45056
    ds_read_b64_tr_b16 v[26:27], v7 offset:46080
    s_add_u32 m0, s38, 114688
    s_add_u32 s3, s61, 221184
    buffer_load_dwordx4 v2, s[16:19], s3 offen offset:0 lds
    s_waitcnt lgkmcnt(6)
    v_mfma_f32_32x32x16_bf16 v[136:151], v[32:35], a[240:243], v[136:151]
    ds_read_b64_tr_b16 v[28:29], v8 offset:45056
    ds_read_b64_tr_b16 v[30:31], v8 offset:46080
    v_mfma_f32_32x32x16_bf16 v[104:119], v[36:39], a[244:247], v[104:119]
    ds_read_b64_tr_b16 v[32:33], v9 offset:15360
    ds_read_b64_tr_b16 v[34:35], v9 offset:15616
    buffer_load_dwordx4 v3, s[16:19], s3 offen offset:1024 lds
    s_waitcnt lgkmcnt(6)
    v_mfma_f32_32x32x16_bf16 v[120:135], v[16:19], a[244:247], v[120:135]
    ds_read_b64_tr_b16 v[36:37], v7 offset:47104
    ds_read_b64_tr_b16 v[38:39], v7 offset:48128
    v_mfma_f32_32x32x16_bf16 v[136:151], v[20:23], a[244:247], v[136:151]
    ds_read_b64_tr_b16 v[16:17], v8 offset:47104
    ds_read_b64_tr_b16 v[18:19], v8 offset:48128
    buffer_load_dwordx4 v4, s[16:19], s3 offen offset:2048 lds
    s_waitcnt vmcnt(32) lgkmcnt(6)
    v_mfma_f32_32x32x16_bf16 v[104:119], v[24:27], a[248:251], v[104:119]
    ds_read_b64_tr_b16 v[20:21], v9 offset:15872
    ds_read_b64_tr_b16 v[22:23], v9 offset:16128
    v_mfma_f32_32x32x16_bf16 v[120:135], v[28:31], a[248:251], v[120:135]
    s_barrier
    ds_read_b64_tr_b16 v[24:25], v7 offset:49152
    ds_read_b64_tr_b16 v[26:27], v7 offset:50176
    buffer_load_dwordx4 v5, s[16:19], s3 offen offset:3072 lds
    s_waitcnt lgkmcnt(6)
    v_mfma_f32_32x32x16_bf16 v[136:151], v[32:35], a[248:251], v[136:151]
    ds_read_b64_tr_b16 v[28:29], v8 offset:49152
    ds_read_b64_tr_b16 v[30:31], v8 offset:50176
    v_mfma_f32_32x32x16_bf16 v[104:119], v[36:39], a[252:255], v[104:119]
    ds_read_b64_tr_b16 v[32:33], v9 offset:8192
    ds_read_b64_tr_b16 v[34:35], v9 offset:8448
    s_add_u32 m0, s38, 131072
    s_add_u32 s3, s62, 221184
    buffer_load_dwordx4 v2, s[16:19], s3 offen offset:0 lds
    s_waitcnt lgkmcnt(6)
    v_mfma_f32_32x32x16_bf16 v[120:135], v[16:19], a[252:255], v[120:135]
    ds_read_b64_tr_b16 v[36:37], v7 offset:51200
    ds_read_b64_tr_b16 v[38:39], v7 offset:52224
    v_mfma_f32_32x32x16_bf16 v[136:151], v[20:23], a[252:255], v[136:151]
    ds_read_b64_tr_b16 v[16:17], v8 offset:51200
    ds_read_b64_tr_b16 v[18:19], v8 offset:52224
    buffer_load_dwordx4 v3, s[16:19], s3 offen offset:1024 lds
    s_waitcnt lgkmcnt(6)
    v_mfma_f32_32x32x16_bf16 v[104:119], v[24:27], v[184:187], v[104:119]
    ds_read_b64_tr_b16 v[20:21], v9 offset:8704
    ds_read_b64_tr_b16 v[22:23], v9 offset:8960
    v_mfma_f32_32x32x16_bf16 v[120:135], v[28:31], v[184:187], v[120:135]
    ds_read_b64_tr_b16 v[24:25], v7 offset:53248
    ds_read_b64_tr_b16 v[26:27], v7 offset:54272
    buffer_load_dwordx4 v4, s[16:19], s3 offen offset:2048 lds
    s_waitcnt lgkmcnt(6)
    v_mfma_f32_32x32x16_bf16 v[136:151], v[32:35], v[184:187], v[136:151]
    ds_read_b64_tr_b16 v[28:29], v8 offset:53248
    ds_read_b64_tr_b16 v[30:31], v8 offset:54272
    v_mfma_f32_32x32x16_bf16 v[104:119], v[36:39], v[188:191], v[104:119]
    ds_read_b64_tr_b16 v[32:33], v9 offset:9216
    ds_read_b64_tr_b16 v[34:35], v9 offset:9472
    buffer_load_dwordx4 v5, s[16:19], s3 offen offset:3072 lds
    s_waitcnt lgkmcnt(6)
    v_mfma_f32_32x32x16_bf16 v[120:135], v[16:19], v[188:191], v[120:135]
    ds_read_b64_tr_b16 v[36:37], v7 offset:55296
    ds_read_b64_tr_b16 v[38:39], v7 offset:56320
    v_mfma_f32_32x32x16_bf16 v[136:151], v[20:23], v[188:191], v[136:151]
    ds_read_b64_tr_b16 v[16:17], v8 offset:55296
    ds_read_b64_tr_b16 v[18:19], v8 offset:56320
    s_waitcnt vmcnt(36) lgkmcnt(6)
    v_mfma_f32_32x32x16_bf16 v[104:119], v[24:27], v[192:195], v[104:119]
    ds_read_b64_tr_b16 v[20:21], v9 offset:9728
    ds_read_b64_tr_b16 v[22:23], v9 offset:9984
    v_mfma_f32_32x32x16_bf16 v[120:135], v[28:31], v[192:195], v[120:135]
    ds_read_b64_tr_b16 v[24:25], v7 offset:57344
    ds_read_b64_tr_b16 v[26:27], v7 offset:58368
    s_waitcnt lgkmcnt(6)
    v_mfma_f32_32x32x16_bf16 v[136:151], v[32:35], v[192:195], v[136:151]
    ds_read_b64_tr_b16 v[28:29], v8 offset:57344
    ds_read_b64_tr_b16 v[30:31], v8 offset:58368
    v_mfma_f32_32x32x16_bf16 v[104:119], v[36:39], v[196:199], v[104:119]
    ds_read_b64_tr_b16 v[32:33], v9 offset:10240
    ds_read_b64_tr_b16 v[34:35], v9 offset:10496
    s_waitcnt lgkmcnt(6)
    v_mfma_f32_32x32x16_bf16 v[120:135], v[16:19], v[196:199], v[120:135]
    ds_read_b64_tr_b16 v[36:37], v7 offset:59392
    ds_read_b64_tr_b16 v[38:39], v7 offset:60416
    v_mfma_f32_32x32x16_bf16 v[136:151], v[20:23], v[196:199], v[136:151]
    ds_read_b64_tr_b16 v[16:17], v8 offset:59392
    ds_read_b64_tr_b16 v[18:19], v8 offset:60416
    s_waitcnt vmcnt(32) lgkmcnt(6)
    v_mfma_f32_32x32x16_bf16 v[104:119], v[24:27], v[200:203], v[104:119]
    ds_read_b64_tr_b16 v[20:21], v9 offset:10752
    ds_read_b64_tr_b16 v[22:23], v9 offset:11008
    v_mfma_f32_32x32x16_bf16 v[120:135], v[28:31], v[200:203], v[120:135]
    ds_read_b64_tr_b16 v[24:25], v7 offset:61440
    ds_read_b64_tr_b16 v[26:27], v7 offset:62464
    s_waitcnt lgkmcnt(6)
    v_mfma_f32_32x32x16_bf16 v[136:151], v[32:35], v[200:203], v[136:151]
    ds_read_b64_tr_b16 v[28:29], v8 offset:61440
    ds_read_b64_tr_b16 v[30:31], v8 offset:62464
    v_mfma_f32_32x32x16_bf16 v[104:119], v[36:39], v[204:207], v[104:119]
    ds_read_b64_tr_b16 v[32:33], v9 offset:11264
    ds_read_b64_tr_b16 v[34:35], v9 offset:11520
    s_waitcnt lgkmcnt(6)
    v_mfma_f32_32x32x16_bf16 v[120:135], v[16:19], v[204:207], v[120:135]
    ds_read_b64_tr_b16 v[36:37], v7 offset:63488
    ds_read_b64_tr_b16 v[38:39], v7 offset:64512
    v_mfma_f32_32x32x16_bf16 v[136:151], v[20:23], v[204:207], v[136:151]
    ds_read_b64_tr_b16 v[16:17], v8 offset:63488
    ds_read_b64_tr_b16 v[18:19], v8 offset:64512
    s_waitcnt vmcnt(28) lgkmcnt(6)
    v_mfma_f32_32x32x16_bf16 v[104:119], v[24:27], v[208:211], v[104:119]
    ds_read_b64_tr_b16 v[20:21], v9 offset:11776
    ds_read_b64_tr_b16 v[22:23], v9 offset:12032
    v_mfma_f32_32x32x16_bf16 v[120:135], v[28:31], v[208:211], v[120:135]
    s_waitcnt vmcnt(24)
    s_barrier
    v_add_u32 v8, 4294868992, v8
    ds_read_b64_tr_b16 v[24:25], v8 offset:0
    ds_read_b64_tr_b16 v[26:27], v8 offset:1024
    s_add_u32 m0, s38, 16384
    s_add_u32 s3, s63, 0
    buffer_load_dwordx4 v2, s[16:19], s3 offen offset:0 lds
    s_waitcnt lgkmcnt(6)
    v_mfma_f32_32x32x16_bf16 v[136:151], v[32:35], v[208:211], v[136:151]
    ds_read_b64_tr_b16 v[28:29], v8 offset:2048
    ds_read_b64_tr_b16 v[30:31], v8 offset:3072
    v_mfma_f32_32x32x16_bf16 v[104:119], v[36:39], v[212:215], v[104:119]
    ds_read_b64_tr_b16 v[32:33], v8 offset:4096
    ds_read_b64_tr_b16 v[34:35], v8 offset:5120
    buffer_load_dwordx4 v3, s[16:19], s3 offen offset:1024 lds
    s_waitcnt lgkmcnt(6)
    v_mfma_f32_32x32x16_bf16 v[120:135], v[16:19], v[212:215], v[120:135]
    ds_read_b64_tr_b16 v[36:37], v8 offset:6144
    ds_read_b64_tr_b16 v[38:39], v8 offset:7168
    v_mfma_f32_32x32x16_bf16 v[136:151], v[20:23], v[212:215], v[136:151]
    ds_read_b64_tr_b16 v[16:17], v8 offset:8192
    ds_read_b64_tr_b16 v[18:19], v8 offset:9216
    buffer_load_dwordx4 v4, s[16:19], s3 offen offset:2048 lds
    s_waitcnt lgkmcnt(6)
    v_mfma_f32_32x32x16_bf16 v[152:167], v[24:27], a[0:3], 0
    ds_read_b64_tr_b16 v[20:21], v8 offset:10240
    ds_read_b64_tr_b16 v[22:23], v8 offset:11264
    v_mfma_f32_32x32x16_bf16 v[152:167], v[28:31], a[4:7], v[152:167]
    ds_read_b64_tr_b16 v[24:25], v8 offset:12288
    ds_read_b64_tr_b16 v[26:27], v8 offset:13312
    v_cvt_pk_f16_f32 v104, v104, v105
    v_cvt_pk_f16_f32 v105, v106, v107
    v_cvt_pk_f16_f32 v106, v108, v109
    buffer_load_dwordx4 v5, s[16:19], s3 offen offset:3072 lds
    s_waitcnt lgkmcnt(6)
    v_mfma_f32_32x32x16_bf16 v[152:167], v[32:35], a[8:11], v[152:167]
    ds_read_b64_tr_b16 v[28:29], v8 offset:14336
    ds_read_b64_tr_b16 v[30:31], v8 offset:15360
    v_cvt_pk_f16_f32 v107, v110, v111
    v_cvt_pk_f16_f32 v108, v112, v113
    v_mfma_f32_32x32x16_bf16 v[152:167], v[36:39], a[12:15], v[152:167]
    ds_read_b64_tr_b16 v[32:33], v8 offset:32768
    ds_read_b64_tr_b16 v[34:35], v8 offset:33792
    v_cvt_pk_f16_f32 v109, v114, v115
    v_cvt_pk_f16_f32 v110, v116, v117
    v_cvt_pk_f16_f32 v111, v118, v119
    s_waitcnt lgkmcnt(6)
    v_mfma_f32_32x32x16_bf16 v[152:167], v[16:19], a[16:19], v[152:167]
    ds_read_b64_tr_b16 v[36:37], v8 offset:34816
    ds_read_b64_tr_b16 v[38:39], v8 offset:35840
    v_cvt_pk_f16_f32 v120, v120, v121
    v_cvt_pk_f16_f32 v121, v122, v123
    v_mfma_f32_32x32x16_bf16 v[152:167], v[20:23], a[20:23], v[152:167]
    ds_read_b64_tr_b16 v[16:17], v8 offset:36864
    ds_read_b64_tr_b16 v[18:19], v8 offset:37888
    v_cvt_pk_f16_f32 v122, v124, v125
    v_cvt_pk_f16_f32 v123, v126, v127
    v_cvt_pk_f16_f32 v124, v128, v129
    s_waitcnt lgkmcnt(6)
    v_mfma_f32_32x32x16_bf16 v[152:167], v[24:27], a[24:27], v[152:167]
    ds_read_b64_tr_b16 v[20:21], v8 offset:38912
    ds_read_b64_tr_b16 v[22:23], v8 offset:39936
    buffer_store_dwordx4 v[104:107], v1, s[4:7], s50 offen offset:0 sc0 sc1
    v_cvt_pk_f16_f32 v125, v130, v131
    v_mfma_f32_32x32x16_bf16 v[152:167], v[28:31], a[28:31], v[152:167]
    ds_read_b64_tr_b16 v[24:25], v8 offset:40960
    ds_read_b64_tr_b16 v[26:27], v8 offset:41984
    v_cvt_pk_f16_f32 v126, v132, v133
    v_cvt_pk_f16_f32 v127, v134, v135
    v_cvt_pk_f16_f32 v148, v136, v137
    s_waitcnt lgkmcnt(6)
    v_mfma_f32_32x32x16_bf16 v[152:167], v[32:35], a[32:35], v[152:167]
    ds_read_b64_tr_b16 v[28:29], v8 offset:43008
    ds_read_b64_tr_b16 v[30:31], v8 offset:44032
    v_cvt_pk_f16_f32 v149, v138, v139
    v_cvt_pk_f16_f32 v150, v140, v141
    v_mfma_f32_32x32x16_bf16 v[152:167], v[36:39], a[36:39], v[152:167]
    ds_read_b64_tr_b16 v[32:33], v8 offset:45056
    ds_read_b64_tr_b16 v[34:35], v8 offset:46080
    v_cvt_pk_f16_f32 v151, v142, v143
    s_waitcnt lgkmcnt(6)
    v_mfma_f32_32x32x16_bf16 v[152:167], v[16:19], a[40:43], v[152:167]
    ds_read_b64_tr_b16 v[36:37], v8 offset:47104
    ds_read_b64_tr_b16 v[38:39], v8 offset:48128
    v_mfma_f32_32x32x16_bf16 v[152:167], v[20:23], a[44:47], v[152:167]
    s_waitcnt vmcnt(21)
    s_barrier
    ds_read_b64_tr_b16 v[16:17], v8 offset:49152
    ds_read_b64_tr_b16 v[18:19], v8 offset:50176
    s_waitcnt lgkmcnt(6)
    v_mfma_f32_32x32x16_bf16 v[152:167], v[24:27], a[48:51], v[152:167]
    ds_read_b64_tr_b16 v[20:21], v8 offset:51200
    ds_read_b64_tr_b16 v[22:23], v8 offset:52224
    buffer_store_dwordx4 v[108:111], v1, s[4:7], s50 offen offset:1024 sc0 sc1
    v_mfma_f32_32x32x16_bf16 v[152:167], v[28:31], a[52:55], v[152:167]
    ds_read_b64_tr_b16 v[24:25], v8 offset:53248
    ds_read_b64_tr_b16 v[26:27], v8 offset:54272
    s_waitcnt lgkmcnt(6)
    v_mfma_f32_32x32x16_bf16 v[152:167], v[32:35], a[56:59], v[152:167]
    ds_read_b64_tr_b16 v[28:29], v8 offset:55296
    ds_read_b64_tr_b16 v[30:31], v8 offset:56320
    v_mfma_f32_32x32x16_bf16 v[152:167], v[36:39], a[60:63], v[152:167]
    ds_read_b64_tr_b16 v[32:33], v8 offset:57344
    ds_read_b64_tr_b16 v[34:35], v8 offset:58368
    s_waitcnt lgkmcnt(6)
    v_mfma_f32_32x32x16_bf16 v[152:167], v[16:19], a[64:67], v[152:167]
    ds_read_b64_tr_b16 v[36:37], v8 offset:59392
    ds_read_b64_tr_b16 v[38:39], v8 offset:60416
    v_mfma_f32_32x32x16_bf16 v[152:167], v[20:23], a[68:71], v[152:167]
    ds_read_b64_tr_b16 v[16:17], v8 offset:61440
    ds_read_b64_tr_b16 v[18:19], v8 offset:62464
    s_waitcnt lgkmcnt(6)
    v_mfma_f32_32x32x16_bf16 v[152:167], v[24:27], a[72:75], v[152:167]
    ds_read_b64_tr_b16 v[20:21], v8 offset:63488
    ds_read_b64_tr_b16 v[22:23], v8 offset:64512
    buffer_store_dwordx4 v[120:123], v1, s[4:7], s51 offen offset:0 sc0 sc1
    v_mfma_f32_32x32x16_bf16 v[152:167], v[28:31], a[76:79], v[152:167]
    v_add_u32 v8, 65536, v8
    ds_read_b64_tr_b16 v[24:25], v8 offset:0
    ds_read_b64_tr_b16 v[26:27], v8 offset:1024
    s_waitcnt lgkmcnt(6)
    v_mfma_f32_32x32x16_bf16 v[152:167], v[32:35], a[80:83], v[152:167]
    ds_read_b64_tr_b16 v[28:29], v8 offset:2048
    ds_read_b64_tr_b16 v[30:31], v8 offset:3072
    v_mfma_f32_32x32x16_bf16 v[152:167], v[36:39], a[84:87], v[152:167]
    ds_read_b64_tr_b16 v[32:33], v8 offset:4096
    ds_read_b64_tr_b16 v[34:35], v8 offset:5120
    s_waitcnt lgkmcnt(6)
    v_mfma_f32_32x32x16_bf16 v[152:167], v[16:19], a[88:91], v[152:167]
    ds_read_b64_tr_b16 v[36:37], v8 offset:6144
    ds_read_b64_tr_b16 v[38:39], v8 offset:7168
    v_mfma_f32_32x32x16_bf16 v[152:167], v[20:23], a[92:95], v[152:167]
    ds_read_b64_tr_b16 v[16:17], v8 offset:8192
    ds_read_b64_tr_b16 v[18:19], v8 offset:9216
    s_waitcnt lgkmcnt(6)
    v_mfma_f32_32x32x16_bf16 v[152:167], v[24:27], a[96:99], v[152:167]
    ds_read_b64_tr_b16 v[20:21], v8 offset:10240
    ds_read_b64_tr_b16 v[22:23], v8 offset:11264
    buffer_store_dwordx4 v[124:127], v1, s[4:7], s51 offen offset:1024 sc0 sc1
    v_mfma_f32_32x32x16_bf16 v[152:167], v[28:31], a[100:103], v[152:167]
    ds_read_b64_tr_b16 v[24:25], v8 offset:12288
    ds_read_b64_tr_b16 v[26:27], v8 offset:13312
    s_waitcnt lgkmcnt(6)
    v_mfma_f32_32x32x16_bf16 v[152:167], v[32:35], a[104:107], v[152:167]
    ds_read_b64_tr_b16 v[28:29], v8 offset:14336
    ds_read_b64_tr_b16 v[30:31], v8 offset:15360
    v_mfma_f32_32x32x16_bf16 v[152:167], v[36:39], a[108:111], v[152:167]
    s_waitcnt vmcnt(16)
    s_barrier
    ds_read_b64_tr_b16 v[32:33], v8 offset:16384
    ds_read_b64_tr_b16 v[34:35], v8 offset:17408
    s_waitcnt lgkmcnt(6)
    v_mfma_f32_32x32x16_bf16 v[152:167], v[16:19], a[112:115], v[152:167]
    ds_read_b64_tr_b16 v[36:37], v8 offset:18432
    ds_read_b64_tr_b16 v[38:39], v8 offset:19456
    v_mfma_f32_32x32x16_bf16 v[152:167], v[20:23], a[116:119], v[152:167]
    ds_read_b64_tr_b16 v[16:17], v8 offset:20480
    ds_read_b64_tr_b16 v[18:19], v8 offset:21504
    s_waitcnt lgkmcnt(6)
    v_mfma_f32_32x32x16_bf16 v[152:167], v[24:27], a[120:123], v[152:167]
    ds_read_b64_tr_b16 v[20:21], v8 offset:22528
    ds_read_b64_tr_b16 v[22:23], v8 offset:23552
    buffer_store_dwordx2 v[148:149], v240, s[4:7], s52 offen offset:0 sc0 sc1
    v_mfma_f32_32x32x16_bf16 v[152:167], v[28:31], a[124:127], v[152:167]
    ds_read_b64_tr_b16 v[24:25], v8 offset:24576
    ds_read_b64_tr_b16 v[26:27], v8 offset:25600
    s_waitcnt lgkmcnt(6)
    v_mfma_f32_32x32x16_bf16 v[152:167], v[32:35], a[128:131], v[152:167]
    ds_read_b64_tr_b16 v[28:29], v8 offset:26624
    ds_read_b64_tr_b16 v[30:31], v8 offset:27648
    v_mfma_f32_32x32x16_bf16 v[152:167], v[36:39], a[132:135], v[152:167]
    ds_read_b64_tr_b16 v[32:33], v8 offset:28672
    ds_read_b64_tr_b16 v[34:35], v8 offset:29696
    s_waitcnt lgkmcnt(6)
    v_mfma_f32_32x32x16_bf16 v[152:167], v[16:19], a[136:139], v[152:167]
    ds_read_b64_tr_b16 v[36:37], v8 offset:30720
    ds_read_b64_tr_b16 v[38:39], v8 offset:31744
    v_mfma_f32_32x32x16_bf16 v[152:167], v[20:23], a[140:143], v[152:167]
    ds_read_b64_tr_b16 v[16:17], v8 offset:32768
    ds_read_b64_tr_b16 v[18:19], v8 offset:33792
    s_waitcnt lgkmcnt(6)
    v_mfma_f32_32x32x16_bf16 v[152:167], v[24:27], a[144:147], v[152:167]
    ds_read_b64_tr_b16 v[20:21], v8 offset:34816
    ds_read_b64_tr_b16 v[22:23], v8 offset:35840
    buffer_store_dwordx2 v[150:151], v245, s[4:7], s53 offen offset:0 sc0 sc1
    v_mfma_f32_32x32x16_bf16 v[152:167], v[28:31], a[148:151], v[152:167]
    ds_read_b64_tr_b16 v[24:25], v8 offset:36864
    ds_read_b64_tr_b16 v[26:27], v8 offset:37888
    s_waitcnt lgkmcnt(6)
    v_mfma_f32_32x32x16_bf16 v[152:167], v[32:35], a[152:155], v[152:167]
    ds_read_b64_tr_b16 v[28:29], v8 offset:38912
    ds_read_b64_tr_b16 v[30:31], v8 offset:39936
    v_mfma_f32_32x32x16_bf16 v[152:167], v[36:39], a[156:159], v[152:167]
    ds_read_b64_tr_b16 v[32:33], v8 offset:40960
    ds_read_b64_tr_b16 v[34:35], v8 offset:41984
    s_waitcnt lgkmcnt(6)
    v_mfma_f32_32x32x16_bf16 v[152:167], v[16:19], a[160:163], v[152:167]
    ds_read_b64_tr_b16 v[36:37], v8 offset:43008
    ds_read_b64_tr_b16 v[38:39], v8 offset:44032
    v_mfma_f32_32x32x16_bf16 v[152:167], v[20:23], a[164:167], v[152:167]
    ds_read_b64_tr_b16 v[16:17], v8 offset:45056
    ds_read_b64_tr_b16 v[18:19], v8 offset:46080
    s_waitcnt lgkmcnt(6)
    v_mfma_f32_32x32x16_bf16 v[152:167], v[24:27], a[168:171], v[152:167]
    ds_read_b64_tr_b16 v[20:21], v8 offset:47104
    ds_read_b64_tr_b16 v[22:23], v8 offset:48128
    v_mfma_f32_32x32x16_bf16 v[152:167], v[28:31], a[172:175], v[152:167]
    s_waitcnt vmcnt(10)
    s_barrier
    ds_read_b64_tr_b16 v[24:25], v8 offset:49152
    ds_read_b64_tr_b16 v[26:27], v8 offset:50176
    s_waitcnt lgkmcnt(6)
    v_mfma_f32_32x32x16_bf16 v[152:167], v[32:35], a[176:179], v[152:167]
    ds_read_b64_tr_b16 v[28:29], v8 offset:51200
    ds_read_b64_tr_b16 v[30:31], v8 offset:52224
    v_mfma_f32_32x32x16_bf16 v[152:167], v[36:39], a[180:183], v[152:167]
    ds_read_b64_tr_b16 v[32:33], v8 offset:53248
    ds_read_b64_tr_b16 v[34:35], v8 offset:54272
    s_waitcnt lgkmcnt(6)
    v_mfma_f32_32x32x16_bf16 v[152:167], v[16:19], a[184:187], v[152:167]
    ds_read_b64_tr_b16 v[36:37], v8 offset:55296
    ds_read_b64_tr_b16 v[38:39], v8 offset:56320
    v_mfma_f32_32x32x16_bf16 v[152:167], v[20:23], a[188:191], v[152:167]
    ds_read_b64_tr_b16 v[16:17], v8 offset:57344
    ds_read_b64_tr_b16 v[18:19], v8 offset:58368
    s_waitcnt lgkmcnt(6)
    v_mfma_f32_32x32x16_bf16 v[152:167], v[24:27], a[192:195], v[152:167]
    ds_read_b64_tr_b16 v[20:21], v8 offset:59392
    ds_read_b64_tr_b16 v[22:23], v8 offset:60416
    v_mfma_f32_32x32x16_bf16 v[152:167], v[28:31], a[196:199], v[152:167]
    ds_read_b64_tr_b16 v[24:25], v8 offset:61440
    ds_read_b64_tr_b16 v[26:27], v8 offset:62464
    s_waitcnt lgkmcnt(6)
    v_mfma_f32_32x32x16_bf16 v[152:167], v[32:35], a[200:203], v[152:167]
    ds_read_b64_tr_b16 v[28:29], v8 offset:63488
    ds_read_b64_tr_b16 v[30:31], v8 offset:64512
    v_mfma_f32_32x32x16_bf16 v[152:167], v[36:39], a[204:207], v[152:167]
    v_add_u32 v8, 65536, v8
    ds_read_b64_tr_b16 v[32:33], v8 offset:0
    ds_read_b64_tr_b16 v[34:35], v8 offset:1024
    s_waitcnt lgkmcnt(6)
    v_mfma_f32_32x32x16_bf16 v[152:167], v[16:19], a[208:211], v[152:167]
    ds_read_b64_tr_b16 v[36:37], v8 offset:2048
    ds_read_b64_tr_b16 v[38:39], v8 offset:3072
    v_mfma_f32_32x32x16_bf16 v[152:167], v[20:23], a[212:215], v[152:167]
    ds_read_b64_tr_b16 v[16:17], v8 offset:4096
    ds_read_b64_tr_b16 v[18:19], v8 offset:5120
    s_waitcnt lgkmcnt(6)
    v_mfma_f32_32x32x16_bf16 v[152:167], v[24:27], a[216:219], v[152:167]
    ds_read_b64_tr_b16 v[20:21], v8 offset:6144
    ds_read_b64_tr_b16 v[22:23], v8 offset:7168
    v_mfma_f32_32x32x16_bf16 v[152:167], v[28:31], a[220:223], v[152:167]
    ds_read_b64_tr_b16 v[24:25], v8 offset:8192
    ds_read_b64_tr_b16 v[26:27], v8 offset:9216
    s_waitcnt lgkmcnt(6)
    v_mfma_f32_32x32x16_bf16 v[152:167], v[32:35], a[224:227], v[152:167]
    ds_read_b64_tr_b16 v[28:29], v8 offset:10240
    ds_read_b64_tr_b16 v[30:31], v8 offset:11264
    v_mfma_f32_32x32x16_bf16 v[152:167], v[36:39], a[228:231], v[152:167]
    ds_read_b64_tr_b16 v[32:33], v8 offset:12288
    ds_read_b64_tr_b16 v[34:35], v8 offset:13312
    s_waitcnt lgkmcnt(6)
    v_mfma_f32_32x32x16_bf16 v[152:167], v[16:19], a[232:235], v[152:167]
    ds_read_b64_tr_b16 v[36:37], v8 offset:14336
    ds_read_b64_tr_b16 v[38:39], v8 offset:15360
    v_mfma_f32_32x32x16_bf16 v[152:167], v[20:23], a[236:239], v[152:167]
    s_waitcnt vmcnt(6)
    s_barrier
    v_add_u32 v8, 4294852608, v8
    ds_read_b64_tr_b16 v[16:17], v8 offset:0
    ds_read_b64_tr_b16 v[18:19], v8 offset:1024
    s_waitcnt lgkmcnt(6)
    v_mfma_f32_32x32x16_bf16 v[152:167], v[24:27], a[240:243], v[152:167]
    ds_read_b64_tr_b16 v[20:21], v8 offset:2048
    ds_read_b64_tr_b16 v[22:23], v8 offset:3072
    v_mfma_f32_32x32x16_bf16 v[152:167], v[28:31], a[244:247], v[152:167]
    ds_read_b64_tr_b16 v[24:25], v8 offset:4096
    ds_read_b64_tr_b16 v[26:27], v8 offset:5120
    s_waitcnt lgkmcnt(6)
    v_mfma_f32_32x32x16_bf16 v[152:167], v[32:35], a[248:251], v[152:167]
    ds_read_b64_tr_b16 v[28:29], v8 offset:6144
    ds_read_b64_tr_b16 v[30:31], v8 offset:7168
    v_mfma_f32_32x32x16_bf16 v[152:167], v[36:39], a[252:255], v[152:167]
    ds_read_b64_tr_b16 v[32:33], v8 offset:8192
    ds_read_b64_tr_b16 v[34:35], v8 offset:9216
    s_waitcnt lgkmcnt(6)
    v_mfma_f32_32x32x16_bf16 v[152:167], v[16:19], v[184:187], v[152:167]
    ds_read_b64_tr_b16 v[36:37], v8 offset:10240
    ds_read_b64_tr_b16 v[38:39], v8 offset:11264
    v_mfma_f32_32x32x16_bf16 v[152:167], v[20:23], v[188:191], v[152:167]
    ds_read_b64_tr_b16 v[16:17], v8 offset:12288
    ds_read_b64_tr_b16 v[18:19], v8 offset:13312
    s_waitcnt lgkmcnt(6)
    v_mfma_f32_32x32x16_bf16 v[152:167], v[24:27], v[192:195], v[152:167]
    ds_read_b64_tr_b16 v[20:21], v8 offset:14336
    ds_read_b64_tr_b16 v[22:23], v8 offset:15360
    v_mfma_f32_32x32x16_bf16 v[152:167], v[28:31], v[196:199], v[152:167]
    v_add_u32 v7, 4294868992, v7
    ds_read_b64_tr_b16 v[24:25], v7 offset:0
    ds_read_b64_tr_b16 v[26:27], v7 offset:1024
    s_waitcnt lgkmcnt(6)
    v_mfma_f32_32x32x16_bf16 v[152:167], v[32:35], v[200:203], v[152:167]
    ds_read_b64_tr_b16 v[28:29], v7 offset:2048
    ds_read_b64_tr_b16 v[30:31], v7 offset:3072
    v_mfma_f32_32x32x16_bf16 v[152:167], v[36:39], v[204:207], v[152:167]
    ds_read_b64_tr_b16 v[32:33], v7 offset:4096
    ds_read_b64_tr_b16 v[34:35], v7 offset:5120
    s_waitcnt lgkmcnt(6)
    v_mfma_f32_32x32x16_bf16 v[152:167], v[16:19], v[208:211], v[152:167]
    ds_read_b64_tr_b16 v[36:37], v7 offset:6144
    ds_read_b64_tr_b16 v[38:39], v7 offset:7168
    v_mfma_f32_32x32x16_bf16 v[152:167], v[20:23], v[212:215], v[152:167]
    ds_read_b64_tr_b16 v[16:17], v7 offset:8192
    ds_read_b64_tr_b16 v[18:19], v7 offset:9216
    s_waitcnt lgkmcnt(6)
    v_mfma_f32_32x32x16_bf16 v[168:183], v[24:27], a[0:3], 0
    ds_read_b64_tr_b16 v[20:21], v7 offset:10240
    ds_read_b64_tr_b16 v[22:23], v7 offset:11264
    v_mfma_f32_32x32x16_bf16 v[168:183], v[28:31], a[4:7], v[168:183]
    ds_read_b64_tr_b16 v[24:25], v7 offset:12288
    ds_read_b64_tr_b16 v[26:27], v7 offset:13312
    s_waitcnt lgkmcnt(6)
    v_mfma_f32_32x32x16_bf16 v[168:183], v[32:35], a[8:11], v[168:183]
    ds_read_b64_tr_b16 v[28:29], v7 offset:14336
    ds_read_b64_tr_b16 v[30:31], v7 offset:15360
    v_cvt_pk_f16_f32 v152, v152, v153
    v_cvt_pk_f16_f32 v153, v154, v155
    v_mfma_f32_32x32x16_bf16 v[168:183], v[36:39], a[12:15], v[168:183]
    ds_read_b64_tr_b16 v[32:33], v7 offset:32768
    ds_read_b64_tr_b16 v[34:35], v7 offset:33792
    v_cvt_pk_f16_f32 v154, v156, v157
    v_cvt_pk_f16_f32 v155, v158, v159
    v_cvt_pk_f16_f32 v156, v160, v161
    s_waitcnt lgkmcnt(6)
    v_mfma_f32_32x32x16_bf16 v[168:183], v[16:19], a[16:19], v[168:183]
    ds_read_b64_tr_b16 v[36:37], v7 offset:34816
    ds_read_b64_tr_b16 v[38:39], v7 offset:35840
    v_cvt_pk_f16_f32 v157, v162, v163
    v_cvt_pk_f16_f32 v158, v164, v165
    v_mfma_f32_32x32x16_bf16 v[168:183], v[20:23], a[20:23], v[168:183]
    ds_read_b64_tr_b16 v[16:17], v7 offset:36864
    ds_read_b64_tr_b16 v[18:19], v7 offset:37888
    v_cvt_pk_f16_f32 v159, v166, v167
    s_waitcnt lgkmcnt(6)
    v_mfma_f32_32x32x16_bf16 v[168:183], v[24:27], a[24:27], v[168:183]
    ds_read_b64_tr_b16 v[20:21], v7 offset:38912
    ds_read_b64_tr_b16 v[22:23], v7 offset:39936
    buffer_store_dwordx4 v[152:155], v1, s[4:7], s49 offen offset:0 sc0 sc1
    v_mfma_f32_32x32x16_bf16 v[168:183], v[28:31], a[28:31], v[168:183]
    ds_read_b64_tr_b16 v[24:25], v7 offset:40960
    ds_read_b64_tr_b16 v[26:27], v7 offset:41984
    s_waitcnt lgkmcnt(6)
    v_mfma_f32_32x32x16_bf16 v[168:183], v[32:35], a[32:35], v[168:183]
    ds_read_b64_tr_b16 v[28:29], v7 offset:43008
    ds_read_b64_tr_b16 v[30:31], v7 offset:44032
    v_mfma_f32_32x32x16_bf16 v[168:183], v[36:39], a[36:39], v[168:183]
    ds_read_b64_tr_b16 v[32:33], v7 offset:45056
    ds_read_b64_tr_b16 v[34:35], v7 offset:46080
    s_waitcnt lgkmcnt(6)
    v_mfma_f32_32x32x16_bf16 v[168:183], v[16:19], a[40:43], v[168:183]
    ds_read_b64_tr_b16 v[36:37], v7 offset:47104
    ds_read_b64_tr_b16 v[38:39], v7 offset:48128
    v_mfma_f32_32x32x16_bf16 v[168:183], v[20:23], a[44:47], v[168:183]
    ds_read_b64_tr_b16 v[16:17], v7 offset:49152
    ds_read_b64_tr_b16 v[18:19], v7 offset:50176
    s_waitcnt lgkmcnt(6)
    v_mfma_f32_32x32x16_bf16 v[168:183], v[24:27], a[48:51], v[168:183]
    ds_read_b64_tr_b16 v[20:21], v7 offset:51200
    ds_read_b64_tr_b16 v[22:23], v7 offset:52224
    buffer_store_dwordx4 v[156:159], v1, s[4:7], s49 offen offset:1024 sc0 sc1
    v_lshlrev_b32 v104, 16, v216
    v_mfma_f32_32x32x16_bf16 v[168:183], v[28:31], a[52:55], v[168:183]
    ds_read_b64_tr_b16 v[24:25], v7 offset:53248
    ds_read_b64_tr_b16 v[26:27], v7 offset:54272
    v_lshlrev_b32 v106, 16, v217
    v_lshlrev_b32 v108, 16, v218
    v_lshlrev_b32 v110, 16, v219
    s_waitcnt lgkmcnt(6)
    v_mfma_f32_32x32x16_bf16 v[168:183], v[32:35], a[56:59], v[168:183]
    ds_read_b64_tr_b16 v[28:29], v7 offset:55296
    ds_read_b64_tr_b16 v[30:31], v7 offset:56320
    v_lshlrev_b32 v112, 16, v220
    v_lshlrev_b32 v114, 16, v221
    v_mfma_f32_32x32x16_bf16 v[168:183], v[36:39], a[60:63], v[168:183]
    ds_read_b64_tr_b16 v[32:33], v7 offset:57344
    ds_read_b64_tr_b16 v[34:35], v7 offset:58368
    v_lshlrev_b32 v116, 16, v222
    v_lshlrev_b32 v118, 16, v223
    v_lshlrev_b32 v120, 16, v224
    s_waitcnt lgkmcnt(6)
    v_mfma_f32_32x32x16_bf16 v[168:183], v[16:19], a[64:67], v[168:183]
    ds_read_b64_tr_b16 v[36:37], v7 offset:59392
    ds_read_b64_tr_b16 v[38:39], v7 offset:60416
    v_lshlrev_b32 v122, 16, v225
    v_and_b32 v105, 0xffff0000, v216
    v_mfma_f32_32x32x16_bf16 v[168:183], v[20:23], a[68:71], v[168:183]
    ds_read_b64_tr_b16 v[16:17], v7 offset:61440
    ds_read_b64_tr_b16 v[18:19], v7 offset:62464
    v_and_b32 v107, 0xffff0000, v217
    v_and_b32 v109, 0xffff0000, v218
    v_and_b32 v111, 0xffff0000, v219
    s_waitcnt lgkmcnt(6)
    v_mfma_f32_32x32x16_bf16 v[168:183], v[24:27], a[72:75], v[168:183]
    ds_read_b64_tr_b16 v[20:21], v7 offset:63488
    ds_read_b64_tr_b16 v[22:23], v7 offset:64512
    v_and_b32 v113, 0xffff0000, v220
    v_and_b32 v115, 0xffff0000, v221
    v_mfma_f32_32x32x16_bf16 v[168:183], v[28:31], a[76:79], v[168:183]
    v_add_u32 v7, 65536, v7
    ds_read_b64_tr_b16 v[24:25], v7 offset:0
    ds_read_b64_tr_b16 v[26:27], v7 offset:1024
    v_and_b32 v117, 0xffff0000, v222
    v_and_b32 v119, 0xffff0000, v223
    v_and_b32 v121, 0xffff0000, v224
    s_waitcnt lgkmcnt(6)
    v_mfma_f32_32x32x16_bf16 v[168:183], v[32:35], a[80:83], v[168:183]
    ds_read_b64_tr_b16 v[28:29], v7 offset:2048
    ds_read_b64_tr_b16 v[30:31], v7 offset:3072
    v_and_b32 v123, 0xffff0000, v225
    v_mfma_f32_32x32x16_bf16 v[168:183], v[36:39], a[84:87], v[168:183]
    ds_read_b64_tr_b16 v[32:33], v7 offset:4096
    ds_read_b64_tr_b16 v[34:35], v7 offset:5120
    s_waitcnt lgkmcnt(6)
    v_mfma_f32_32x32x16_bf16 v[168:183], v[16:19], a[88:91], v[168:183]
    ds_read_b64_tr_b16 v[36:37], v7 offset:6144
    ds_read_b64_tr_b16 v[38:39], v7 offset:7168
    v_mfma_f32_32x32x16_bf16 v[168:183], v[20:23], a[92:95], v[168:183]
    ds_read_b64_tr_b16 v[16:17], v7 offset:8192
    ds_read_b64_tr_b16 v[18:19], v7 offset:9216
    s_waitcnt lgkmcnt(6)
    v_mfma_f32_32x32x16_bf16 v[168:183], v[24:27], a[96:99], v[168:183]
    ds_read_b64_tr_b16 v[20:21], v7 offset:10240
    ds_read_b64_tr_b16 v[22:23], v7 offset:11264
    v_mfma_f32_32x32x16_bf16 v[168:183], v[28:31], a[100:103], v[168:183]
    ds_read_b64_tr_b16 v[24:25], v7 offset:12288
    ds_read_b64_tr_b16 v[26:27], v7 offset:13312
    s_waitcnt lgkmcnt(6)
    v_mfma_f32_32x32x16_bf16 v[168:183], v[32:35], a[104:107], v[168:183]
    ds_read_b64_tr_b16 v[28:29], v7 offset:14336
    ds_read_b64_tr_b16 v[30:31], v7 offset:15360
    v_mfma_f32_32x32x16_bf16 v[168:183], v[36:39], a[108:111], v[168:183]
    ds_read_b64_tr_b16 v[32:33], v7 offset:16384
    ds_read_b64_tr_b16 v[34:35], v7 offset:17408
    s_waitcnt lgkmcnt(6)
    v_mfma_f32_32x32x16_bf16 v[168:183], v[16:19], a[112:115], v[168:183]
    ds_read_b64_tr_b16 v[36:37], v7 offset:18432
    ds_read_b64_tr_b16 v[38:39], v7 offset:19456
    v_mfma_f32_32x32x16_bf16 v[168:183], v[20:23], a[116:119], v[168:183]
    ds_read_b64_tr_b16 v[16:17], v7 offset:20480
    ds_read_b64_tr_b16 v[18:19], v7 offset:21504
    s_waitcnt lgkmcnt(6)
    v_mfma_f32_32x32x16_bf16 v[168:183], v[24:27], a[120:123], v[168:183]
    ds_read_b64_tr_b16 v[20:21], v7 offset:22528
    ds_read_b64_tr_b16 v[22:23], v7 offset:23552
    v_mfma_f32_32x32x16_bf16 v[168:183], v[28:31], a[124:127], v[168:183]
    ds_read_b64_tr_b16 v[24:25], v7 offset:24576
    ds_read_b64_tr_b16 v[26:27], v7 offset:25600
    s_waitcnt lgkmcnt(6)
    v_mfma_f32_32x32x16_bf16 v[168:183], v[32:35], a[128:131], v[168:183]
    ds_read_b64_tr_b16 v[28:29], v7 offset:26624
    ds_read_b64_tr_b16 v[30:31], v7 offset:27648
    v_mfma_f32_32x32x16_bf16 v[168:183], v[36:39], a[132:135], v[168:183]
    ds_read_b64_tr_b16 v[32:33], v7 offset:28672
    ds_read_b64_tr_b16 v[34:35], v7 offset:29696
    s_waitcnt lgkmcnt(6)
    v_mfma_f32_32x32x16_bf16 v[168:183], v[16:19], a[136:139], v[168:183]
    ds_read_b64_tr_b16 v[36:37], v7 offset:30720
    ds_read_b64_tr_b16 v[38:39], v7 offset:31744
    s_add_u32 s75, s48, 9216
    buffer_load_dwordx4 v[50:53], v1, s[4:7], s75 offen offset:0 sc0 sc1
    v_mfma_f32_32x32x16_bf16 v[168:183], v[20:23], a[140:143], v[168:183]
    ds_read_b64_tr_b16 v[16:17], v7 offset:32768
    ds_read_b64_tr_b16 v[18:19], v7 offset:33792
    buffer_load_dwordx4 v[54:57], v1, s[4:7], s75 offen offset:1024 sc0 sc1
    s_waitcnt lgkmcnt(6)
    v_mfma_f32_32x32x16_bf16 v[168:183], v[24:27], a[144:147], v[168:183]
    ds_read_b64_tr_b16 v[20:21], v7 offset:34816
    ds_read_b64_tr_b16 v[22:23], v7 offset:35840
    buffer_load_dwordx2 v[58:59], v239, s[4:7], s75 offen offset:0 sc0 sc1
    v_mfma_f32_32x32x16_bf16 v[168:183], v[28:31], a[148:151], v[168:183]
    ds_read_b64_tr_b16 v[24:25], v7 offset:36864
    ds_read_b64_tr_b16 v[26:27], v7 offset:37888
    s_add_u32 s75, s48, 18432
    buffer_load_dwordx4 v[60:63], v1, s[4:7], s75 offen offset:0 sc0 sc1
    s_waitcnt lgkmcnt(6)
    v_mfma_f32_32x32x16_bf16 v[168:183], v[32:35], a[152:155], v[168:183]
    ds_read_b64_tr_b16 v[28:29], v7 offset:38912
    ds_read_b64_tr_b16 v[30:31], v7 offset:39936
    buffer_load_dwordx4 v[64:67], v1, s[4:7], s75 offen offset:1024 sc0 sc1
    v_mfma_f32_32x32x16_bf16 v[168:183], v[36:39], a[156:159], v[168:183]
    ds_read_b64_tr_b16 v[32:33], v7 offset:40960
    ds_read_b64_tr_b16 v[34:35], v7 offset:41984
    buffer_load_dwordx2 v[68:69], v239, s[4:7], s75 offen offset:0 sc0 sc1
    s_waitcnt lgkmcnt(6)
    v_mfma_f32_32x32x16_bf16 v[168:183], v[16:19], a[160:163], v[168:183]
    ds_read_b64_tr_b16 v[36:37], v7 offset:43008
    ds_read_b64_tr_b16 v[38:39], v7 offset:44032
    v_mfma_f32_32x32x16_bf16 v[168:183], v[20:23], a[164:167], v[168:183]
    ds_read_b64_tr_b16 v[16:17], v7 offset:45056
    ds_read_b64_tr_b16 v[18:19], v7 offset:46080
    s_waitcnt lgkmcnt(6)
    v_mfma_f32_32x32x16_bf16 v[168:183], v[24:27], a[168:171], v[168:183]
    ds_read_b64_tr_b16 v[20:21], v7 offset:47104
    ds_read_b64_tr_b16 v[22:23], v7 offset:48128
    v_mfma_f32_32x32x16_bf16 v[168:183], v[28:31], a[172:175], v[168:183]
    ds_read_b64_tr_b16 v[24:25], v7 offset:49152
    ds_read_b64_tr_b16 v[26:27], v7 offset:50176
    s_waitcnt lgkmcnt(6)
    v_mfma_f32_32x32x16_bf16 v[168:183], v[32:35], a[176:179], v[168:183]
    ds_read_b64_tr_b16 v[28:29], v7 offset:51200
    ds_read_b64_tr_b16 v[30:31], v7 offset:52224
    v_mfma_f32_32x32x16_bf16 v[168:183], v[36:39], a[180:183], v[168:183]
    ds_read_b64_tr_b16 v[32:33], v7 offset:53248
    ds_read_b64_tr_b16 v[34:35], v7 offset:54272
    s_waitcnt lgkmcnt(6)
    v_mfma_f32_32x32x16_bf16 v[168:183], v[16:19], a[184:187], v[168:183]
    ds_read_b64_tr_b16 v[36:37], v7 offset:55296
    ds_read_b64_tr_b16 v[38:39], v7 offset:56320
    v_mfma_f32_32x32x16_bf16 v[168:183], v[20:23], a[188:191], v[168:183]
    ds_read_b64_tr_b16 v[16:17], v7 offset:57344
    ds_read_b64_tr_b16 v[18:19], v7 offset:58368
    s_waitcnt lgkmcnt(6)
    v_mfma_f32_32x32x16_bf16 v[168:183], v[24:27], a[192:195], v[168:183]
    ds_read_b64_tr_b16 v[20:21], v7 offset:59392
    ds_read_b64_tr_b16 v[22:23], v7 offset:60416
    v_mfma_f32_32x32x16_bf16 v[168:183], v[28:31], a[196:199], v[168:183]
    ds_read_b64_tr_b16 v[24:25], v7 offset:61440
    ds_read_b64_tr_b16 v[26:27], v7 offset:62464
    s_waitcnt lgkmcnt(6)
    v_mfma_f32_32x32x16_bf16 v[168:183], v[32:35], a[200:203], v[168:183]
    ds_read_b64_tr_b16 v[28:29], v7 offset:63488
    ds_read_b64_tr_b16 v[30:31], v7 offset:64512
    v_mfma_f32_32x32x16_bf16 v[168:183], v[36:39], a[204:207], v[168:183]
    v_add_u32 v7, 65536, v7
    ds_read_b64_tr_b16 v[32:33], v7 offset:0
    ds_read_b64_tr_b16 v[34:35], v7 offset:1024
    s_waitcnt lgkmcnt(6)
    v_mfma_f32_32x32x16_bf16 v[168:183], v[16:19], a[208:211], v[168:183]
    ds_read_b64_tr_b16 v[36:37], v7 offset:2048
    ds_read_b64_tr_b16 v[38:39], v7 offset:3072
    v_mfma_f32_32x32x16_bf16 v[168:183], v[20:23], a[212:215], v[168:183]
    ds_read_b64_tr_b16 v[16:17], v7 offset:4096
    ds_read_b64_tr_b16 v[18:19], v7 offset:5120
    s_waitcnt lgkmcnt(6)
    v_mfma_f32_32x32x16_bf16 v[168:183], v[24:27], a[216:219], v[168:183]
    ds_read_b64_tr_b16 v[20:21], v7 offset:6144
    ds_read_b64_tr_b16 v[22:23], v7 offset:7168
    s_waitcnt vmcnt(0)
    v_fma_mix_f32 v70, v50, 1.0, v60 op_sel:[0,0,0] op_sel_hi:[1,0,1]
    v_mfma_f32_32x32x16_bf16 v[168:183], v[28:31], a[220:223], v[168:183]
    ds_read_b64_tr_b16 v[24:25], v7 offset:8192
    ds_read_b64_tr_b16 v[26:27], v7 offset:9216
    v_fma_mix_f32 v71, v50, 1.0, v60 op_sel:[1,0,1] op_sel_hi:[1,0,1]
    v_fma_mix_f32 v72, v51, 1.0, v61 op_sel:[0,0,0] op_sel_hi:[1,0,1]
    v_fma_mix_f32 v73, v51, 1.0, v61 op_sel:[1,0,1] op_sel_hi:[1,0,1]
    s_waitcnt lgkmcnt(6)
    v_mfma_f32_32x32x16_bf16 v[168:183], v[32:35], a[224:227], v[168:183]
    ds_read_b64_tr_b16 v[28:29], v7 offset:10240
    ds_read_b64_tr_b16 v[30:31], v7 offset:11264
    v_fma_mix_f32 v74, v52, 1.0, v62 op_sel:[0,0,0] op_sel_hi:[1,0,1]
    v_fma_mix_f32 v75, v52, 1.0, v62 op_sel:[1,0,1] op_sel_hi:[1,0,1]
    v_mfma_f32_32x32x16_bf16 v[168:183], v[36:39], a[228:231], v[168:183]
    ds_read_b64_tr_b16 v[32:33], v7 offset:12288
    ds_read_b64_tr_b16 v[34:35], v7 offset:13312
    v_fma_mix_f32 v76, v53, 1.0, v63 op_sel:[0,0,0] op_sel_hi:[1,0,1]
    v_fma_mix_f32 v77, v53, 1.0, v63 op_sel:[1,0,1] op_sel_hi:[1,0,1]
    v_fma_mix_f32 v78, v54, 1.0, v64 op_sel:[0,0,0] op_sel_hi:[1,0,1]
    s_waitcnt lgkmcnt(6)
    v_mfma_f32_32x32x16_bf16 v[168:183], v[16:19], a[232:235], v[168:183]
    ds_read_b64_tr_b16 v[36:37], v7 offset:14336
    ds_read_b64_tr_b16 v[38:39], v7 offset:15360
    buffer_load_dwordx4 v[40:43], v1, s[4:7], s48 offen offset:0 sc0 sc1
    v_fma_mix_f32 v79, v54, 1.0, v64 op_sel:[1,0,1] op_sel_hi:[1,0,1]
    v_mfma_f32_32x32x16_bf16 v[168:183], v[20:23], a[236:239], v[168:183]
    v_add_u32 v7, 4294852608, v7
    ds_read_b64_tr_b16 v[16:17], v7 offset:0
    ds_read_b64_tr_b16 v[18:19], v7 offset:1024
    buffer_load_dwordx4 v[44:47], v1, s[4:7], s48 offen offset:1024 sc0 sc1
    v_fma_mix_f32 v80, v55, 1.0, v65 op_sel:[0,0,0] op_sel_hi:[1,0,1]
    v_fma_mix_f32 v81, v55, 1.0, v65 op_sel:[1,0,1] op_sel_hi:[1,0,1]
    s_waitcnt lgkmcnt(6)
    v_mfma_f32_32x32x16_bf16 v[168:183], v[24:27], a[240:243], v[168:183]
    ds_read_b64_tr_b16 v[20:21], v7 offset:2048
    ds_read_b64_tr_b16 v[22:23], v7 offset:3072
    buffer_load_dwordx2 v[48:49], v239, s[4:7], s48 offen offset:0 sc0 sc1
    v_fma_mix_f32 v82, v56, 1.0, v66 op_sel:[0,0,0] op_sel_hi:[1,0,1]
    v_mfma_f32_32x32x16_bf16 v[168:183], v[28:31], a[244:247], v[168:183]
    ds_read_b64_tr_b16 v[24:25], v7 offset:4096
    ds_read_b64_tr_b16 v[26:27], v7 offset:5120
    v_fma_mix_f32 v83, v56, 1.0, v66 op_sel:[1,0,1] op_sel_hi:[1,0,1]
    v_fma_mix_f32 v84, v57, 1.0, v67 op_sel:[0,0,0] op_sel_hi:[1,0,1]
    v_fma_mix_f32 v85, v57, 1.0, v67 op_sel:[1,0,1] op_sel_hi:[1,0,1]
    s_waitcnt lgkmcnt(6)
    v_mfma_f32_32x32x16_bf16 v[168:183], v[32:35], a[248:251], v[168:183]
    ds_read_b64_tr_b16 v[28:29], v7 offset:6144
    ds_read_b64_tr_b16 v[30:31], v7 offset:7168
    v_fma_mix_f32 v86, v58, 1.0, v68 op_sel:[0,0,0] op_sel_hi:[1,0,1]
    v_fma_mix_f32 v87, v58, 1.0, v68 op_sel:[1,0,1] op_sel_hi:[1,0,1]
    v_mfma_f32_32x32x16_bf16 v[168:183], v[36:39], a[252:255], v[168:183]
    ds_read_b64_tr_b16 v[32:33], v7 offset:8192
    ds_read_b64_tr_b16 v[34:35], v7 offset:9216
    v_fma_mix_f32 v88, v59, 1.0, v69 op_sel:[0,0,0] op_sel_hi:[1,0,1]
    v_fma_mix_f32 v89, v59, 1.0, v69 op_sel:[1,0,1] op_sel_hi:[1,0,1]
    s_waitcnt lgkmcnt(6)
    v_mfma_f32_32x32x16_bf16 v[168:183], v[16:19], v[184:187], v[168:183]
    ds_read_b64_tr_b16 v[36:37], v7 offset:10240
    ds_read_b64_tr_b16 v[38:39], v7 offset:11264
    v_mfma_f32_32x32x16_bf16 v[168:183], v[20:23], v[188:191], v[168:183]
    ds_read_b64_tr_b16 v[16:17], v7 offset:12288
    ds_read_b64_tr_b16 v[18:19], v7 offset:13312
    s_waitcnt lgkmcnt(6)
    v_mfma_f32_32x32x16_bf16 v[168:183], v[24:27], v[192:195], v[168:183]
    ds_read_b64_tr_b16 v[20:21], v7 offset:14336
    ds_read_b64_tr_b16 v[22:23], v7 offset:15360
    v_mfma_f32_32x32x16_bf16 v[168:183], v[28:31], v[196:199], v[168:183]
    s_waitcnt lgkmcnt(4)
    v_mfma_f32_32x32x16_bf16 v[168:183], v[32:35], v[200:203], v[168:183]
    v_mfma_f32_32x32x16_bf16 v[168:183], v[36:39], v[204:207], v[168:183]
    s_waitcnt lgkmcnt(0)
    v_mfma_f32_32x32x16_bf16 v[168:183], v[16:19], v[208:211], v[168:183]
    v_mfma_f32_32x32x16_bf16 v[168:183], v[20:23], v[212:215], v[168:183]
    s_waitcnt vmcnt(0)
    v_fma_mix_f32 v70, v40, 1.0, v70 op_sel:[0,0,0] op_sel_hi:[1,0,0]
    v_fma_mix_f32 v71, v40, 1.0, v71 op_sel:[1,0,0] op_sel_hi:[1,0,0]
    v_fma_mix_f32 v72, v41, 1.0, v72 op_sel:[0,0,0] op_sel_hi:[1,0,0]
    v_fma_mix_f32 v73, v41, 1.0, v73 op_sel:[1,0,0] op_sel_hi:[1,0,0]
    v_fma_mix_f32 v74, v42, 1.0, v74 op_sel:[0,0,0] op_sel_hi:[1,0,0]
    v_fma_mix_f32 v75, v42, 1.0, v75 op_sel:[1,0,0] op_sel_hi:[1,0,0]
    v_fma_mix_f32 v76, v43, 1.0, v76 op_sel:[0,0,0] op_sel_hi:[1,0,0]
    v_fma_mix_f32 v77, v43, 1.0, v77 op_sel:[1,0,0] op_sel_hi:[1,0,0]
    v_fma_mix_f32 v78, v44, 1.0, v78 op_sel:[0,0,0] op_sel_hi:[1,0,0]
    v_fma_mix_f32 v79, v44, 1.0, v79 op_sel:[1,0,0] op_sel_hi:[1,0,0]
    v_fma_mix_f32 v80, v45, 1.0, v80 op_sel:[0,0,0] op_sel_hi:[1,0,0]
    v_fma_mix_f32 v81, v45, 1.0, v81 op_sel:[1,0,0] op_sel_hi:[1,0,0]
    v_fma_mix_f32 v82, v46, 1.0, v82 op_sel:[0,0,0] op_sel_hi:[1,0,0]
    v_fma_mix_f32 v83, v46, 1.0, v83 op_sel:[1,0,0] op_sel_hi:[1,0,0]
    v_fma_mix_f32 v84, v47, 1.0, v84 op_sel:[0,0,0] op_sel_hi:[1,0,0]
    v_fma_mix_f32 v85, v47, 1.0, v85 op_sel:[1,0,0] op_sel_hi:[1,0,0]
    v_fma_mix_f32 v86, v48, 1.0, v86 op_sel:[0,0,0] op_sel_hi:[1,0,0]
    v_fma_mix_f32 v87, v48, 1.0, v87 op_sel:[1,0,0] op_sel_hi:[1,0,0]
    v_fma_mix_f32 v88, v49, 1.0, v88 op_sel:[0,0,0] op_sel_hi:[1,0,0]
    v_fma_mix_f32 v89, v49, 1.0, v89 op_sel:[1,0,0] op_sel_hi:[1,0,0]
    v_fma_f32 v242, v70, v78, v86
    v_cmp_u_f32 vcc, v242, v242
    s_cbranch_vccnz KT_SLOW26
KT_BACK26:
    v_pk_add_f32 v[168:169], v[168:169], v[70:71]
    v_pk_add_f32 v[170:171], v[170:171], v[72:73]
    v_pk_mul_f32 v[168:169], v[168:169], v[248:249]
    v_pk_mul_f32 v[170:171], v[170:171], v[248:249]
    v_cvt_pk_bf16_f32 v226, v168, v169
    v_cvt_pk_bf16_f32 v227, v170, v171
    v_pk_add_f32 v[172:173], v[172:173], v[74:75]
    v_pk_add_f32 v[174:175], v[174:175], v[76:77]
    v_pk_mul_f32 v[172:173], v[172:173], v[248:249]
    v_pk_mul_f32 v[174:175], v[174:175], v[248:249]
    v_cvt_pk_bf16_f32 v228, v172, v173
    v_cvt_pk_bf16_f32 v229, v174, v175
    v_pk_add_f32 v[176:177], v[176:177], v[78:79]
    v_pk_add_f32 v[178:179], v[178:179], v[80:81]
    v_pk_mul_f32 v[176:177], v[176:177], v[248:249]
    v_pk_mul_f32 v[178:179], v[178:179], v[248:249]
    v_cvt_pk_bf16_f32 v230, v176, v177
    v_cvt_pk_bf16_f32 v231, v178, v179
    v_pk_add_f32 v[180:181], v[180:181], v[82:83]
    v_pk_add_f32 v[182:183], v[182:183], v[84:85]
    v_pk_mul_f32 v[180:181], v[180:181], v[248:249]
    v_pk_mul_f32 v[182:183], v[182:183], v[248:249]
    v_cvt_pk_bf16_f32 v232, v180, v181
    v_cvt_pk_bf16_f32 v233, v182, v183
    v_pk_add_f32 v[136:137], v[136:137], v[86:87]
    v_pk_add_f32 v[138:139], v[138:139], v[88:89]
    v_pk_mul_f32 v[136:137], v[136:137], v[248:249]
    v_pk_mul_f32 v[138:139], v[138:139], v[248:249]
    v_cvt_pk_bf16_f32 v234, v136, v137
    v_cvt_pk_bf16_f32 v235, v138, v139
    v_permlane32_swap_b32 v226, v228
    v_permlane32_swap_b32 v227, v229
    v_permlane32_swap_b32 v230, v232
    v_permlane32_swap_b32 v231, v233
    v_lshlrev_b32 v40, 16, v226
    v_and_b32 v41, 0xffff0000, v226
    v_lshlrev_b32 v42, 16, v227
    v_and_b32 v43, 0xffff0000, v227
    v_lshlrev_b32 v44, 16, v228
    v_and_b32 v45, 0xffff0000, v228
    v_lshlrev_b32 v46, 16, v229
    v_and_b32 v47, 0xffff0000, v229
    v_pk_add_f32 v[40:41], v[40:41], v[104:105]
    v_pk_add_f32 v[42:43], v[42:43], v[106:107]
    v_pk_add_f32 v[44:45], v[44:45], v[108:109]
    v_pk_add_f32 v[46:47], v[46:47], v[110:111]
    v_cvt_pk_bf16_f32 v226, v40, v41
    v_cvt_pk_bf16_f32 v227, v42, v43
    v_cvt_pk_bf16_f32 v228, v44, v45
    v_cvt_pk_bf16_f32 v229, v46, v47
    buffer_store_dwordx4 v[226:229], v236, s[28:31], s55 offen offset:0 sc0 sc1
    v_lshlrev_b32 v48, 16, v230
    v_and_b32 v49, 0xffff0000, v230
    v_lshlrev_b32 v50, 16, v231
    v_and_b32 v51, 0xffff0000, v231
    v_lshlrev_b32 v52, 16, v232
    v_and_b32 v53, 0xffff0000, v232
    v_lshlrev_b32 v54, 16, v233
    v_and_b32 v55, 0xffff0000, v233
    v_pk_add_f32 v[48:49], v[48:49], v[112:113]
    v_pk_add_f32 v[50:51], v[50:51], v[114:115]
    v_pk_add_f32 v[52:53], v[52:53], v[116:117]
    v_pk_add_f32 v[54:55], v[54:55], v[118:119]
    v_cvt_pk_bf16_f32 v230, v48, v49
    v_cvt_pk_bf16_f32 v231, v50, v51
    v_cvt_pk_bf16_f32 v232, v52, v53
    v_cvt_pk_bf16_f32 v233, v54, v55
    buffer_store_dwordx4 v[230:233], v236, s[28:31], s55 offen offset:32 sc0 sc1
    v_lshlrev_b32 v56, 16, v234
    v_and_b32 v57, 0xffff0000, v234
    v_lshlrev_b32 v58, 16, v235
    v_and_b32 v59, 0xffff0000, v235
    v_pk_add_f32 v[56:57], v[56:57], v[120:121]
    v_pk_add_f32 v[58:59], v[58:59], v[122:123]
    v_cvt_pk_bf16_f32 v234, v56, v57
    v_cvt_pk_bf16_f32 v235, v58, v59
    buffer_store_dwordx2 v[234:235], v237, s[28:31], s57 offen sc0 sc1
    s_endpgm
KT_SLOW0:
    s_mov_b32 s67, 0
KT_SPIN0:
    buffer_load_dword v13, v12, s[4:7], s92 offen sc0 sc1
    s_waitcnt vmcnt(0)
    v_cmp_gt_u32 vcc, 7, v13
    s_and_b32 vcc_lo, vcc_lo, s93
    s_cbranch_scc0 KT_BACK0
    s_add_u32 s67, s67, 1
    s_cmp_lt_u32 s67, 0x4000
    s_cbranch_scc1 KT_SPIN0
    s_branch KT_BACK0
KT_SLOW1:
    s_mov_b32 s67, 0
KT_SPIN1:
    buffer_load_dwordx4 v[40:43], v1, s[4:7], s48 offen offset:0 sc0 sc1
    buffer_load_dwordx4 v[44:47], v1, s[4:7], s48 offen offset:1024 sc0 sc1
    buffer_load_dwordx2 v[48:49], v239, s[4:7], s48 offen offset:0 sc0 sc1
    s_add_u32 s75, s48, 9216
    buffer_load_dwordx4 v[50:53], v1, s[4:7], s75 offen offset:0 sc0 sc1
    buffer_load_dwordx4 v[54:57], v1, s[4:7], s75 offen offset:1024 sc0 sc1
    buffer_load_dwordx2 v[58:59], v239, s[4:7], s75 offen offset:0 sc0 sc1
    s_add_u32 s75, s48, 18432
    buffer_load_dwordx4 v[60:63], v1, s[4:7], s75 offen offset:0 sc0 sc1
    buffer_load_dwordx4 v[64:67], v1, s[4:7], s75 offen offset:1024 sc0 sc1
    buffer_load_dwordx2 v[68:69], v239, s[4:7], s75 offen offset:0 sc0 sc1
    buffer_load_dword v90, v246, s[4:7], s80 offen offset:0 sc0 sc1
    buffer_load_dword v91, v246, s[4:7], s80 offen offset:128 sc0 sc1
    buffer_load_dword v92, v246, s[4:7], s80 offen offset:256 sc0 sc1
    buffer_load_dword v93, v246, s[4:7], s80 offen offset:384 sc0 sc1
    s_waitcnt vmcnt(0)
    v_fma_mix_f32 v70, v50, 1.0, v60 op_sel:[0,0,0] op_sel_hi:[1,0,1]
    v_fma_mix_f32 v71, v50, 1.0, v60 op_sel:[1,0,1] op_sel_hi:[1,0,1]
    v_fma_mix_f32 v72, v51, 1.0, v61 op_sel:[0,0,0] op_sel_hi:[1,0,1]
    v_fma_mix_f32 v73, v51, 1.0, v61 op_sel:[1,0,1] op_sel_hi:[1,0,1]
    v_fma_mix_f32 v74, v52, 1.0, v62 op_sel:[0,0,0] op_sel_hi:[1,0,1]
    v_fma_mix_f32 v75, v52, 1.0, v62 op_sel:[1,0,1] op_sel_hi:[1,0,1]
    v_fma_mix_f32 v76, v53, 1.0, v63 op_sel:[0,0,0] op_sel_hi:[1,0,1]
    v_fma_mix_f32 v77, v53, 1.0, v63 op_sel:[1,0,1] op_sel_hi:[1,0,1]
    v_fma_mix_f32 v78, v54, 1.0, v64 op_sel:[0,0,0] op_sel_hi:[1,0,1]
    v_fma_mix_f32 v79, v54, 1.0, v64 op_sel:[1,0,1] op_sel_hi:[1,0,1]
    v_fma_mix_f32 v80, v55, 1.0, v65 op_sel:[0,0,0] op_sel_hi:[1,0,1]
    v_fma_mix_f32 v81, v55, 1.0, v65 op_sel:[1,0,1] op_sel_hi:[1,0,1]
    v_fma_mix_f32 v82, v56, 1.0, v66 op_sel:[0,0,0] op_sel_hi:[1,0,1]
    v_fma_mix_f32 v83, v56, 1.0, v66 op_sel:[1,0,1] op_sel_hi:[1,0,1]
    v_fma_mix_f32 v84, v57, 1.0, v67 op_sel:[0,0,0] op_sel_hi:[1,0,1]
    v_fma_mix_f32 v85, v57, 1.0, v67 op_sel:[1,0,1] op_sel_hi:[1,0,1]
    v_fma_mix_f32 v86, v58, 1.0, v68 op_sel:[0,0,0] op_sel_hi:[1,0,1]
    v_fma_mix_f32 v87, v58, 1.0, v68 op_sel:[1,0,1] op_sel_hi:[1,0,1]
    v_fma_mix_f32 v88, v59, 1.0, v69 op_sel:[0,0,0] op_sel_hi:[1,0,1]
    v_fma_mix_f32 v89, v59, 1.0, v69 op_sel:[1,0,1] op_sel_hi:[1,0,1]
    v_add_f32 v90, v90, v91
    v_add_f32 v92, v92, v93
    v_add_f32 v90, v90, v94
    v_add_f32 v90, v90, v92
    v_cvt_pk_bf16_f32 v90, v90, v90
    v_and_b32 v90, 0xffff0000, v90
    v_fma_mix_f32 v70, v40, 1.0, v70 op_sel:[0,0,0] op_sel_hi:[1,0,0]
    v_fma_mix_f32 v71, v40, 1.0, v71 op_sel:[1,0,0] op_sel_hi:[1,0,0]
    v_fma_mix_f32 v72, v41, 1.0, v72 op_sel:[0,0,0] op_sel_hi:[1,0,0]
    v_fma_mix_f32 v73, v41, 1.0, v73 op_sel:[1,0,0] op_sel_hi:[1,0,0]
    v_fma_mix_f32 v74, v42, 1.0, v74 op_sel:[0,0,0] op_sel_hi:[1,0,0]
    v_fma_mix_f32 v75, v42, 1.0, v75 op_sel:[1,0,0] op_sel_hi:[1,0,0]
    v_fma_mix_f32 v76, v43, 1.0, v76 op_sel:[0,0,0] op_sel_hi:[1,0,0]
    v_fma_mix_f32 v77, v43, 1.0, v77 op_sel:[1,0,0] op_sel_hi:[1,0,0]
    v_fma_mix_f32 v78, v44, 1.0, v78 op_sel:[0,0,0] op_sel_hi:[1,0,0]
    v_fma_mix_f32 v79, v44, 1.0, v79 op_sel:[1,0,0] op_sel_hi:[1,0,0]
    v_fma_mix_f32 v80, v45, 1.0, v80 op_sel:[0,0,0] op_sel_hi:[1,0,0]
    v_fma_mix_f32 v81, v45, 1.0, v81 op_sel:[1,0,0] op_sel_hi:[1,0,0]
    v_fma_mix_f32 v82, v46, 1.0, v82 op_sel:[0,0,0] op_sel_hi:[1,0,0]
    v_fma_mix_f32 v83, v46, 1.0, v83 op_sel:[1,0,0] op_sel_hi:[1,0,0]
    v_fma_mix_f32 v84, v47, 1.0, v84 op_sel:[0,0,0] op_sel_hi:[1,0,0]
    v_fma_mix_f32 v85, v47, 1.0, v85 op_sel:[1,0,0] op_sel_hi:[1,0,0]
    v_fma_mix_f32 v86, v48, 1.0, v86 op_sel:[0,0,0] op_sel_hi:[1,0,0]
    v_fma_mix_f32 v87, v48, 1.0, v87 op_sel:[1,0,0] op_sel_hi:[1,0,0]
    v_fma_mix_f32 v88, v49, 1.0, v88 op_sel:[0,0,0] op_sel_hi:[1,0,0]
    v_fma_mix_f32 v89, v49, 1.0, v89 op_sel:[1,0,0] op_sel_hi:[1,0,0]
    v_fma_f32 v242, v70, v78, v86
    v_cmp_u_f32 vcc, v242, v90
    s_cbranch_vccz KT_BACK1
    s_add_u32 s67, s67, 1
    s_cmp_lt_u32 s67, 0x4000
    s_cbranch_scc1 KT_SPIN1
    s_branch KT_BACK1
KT_SLOW2:
    s_mov_b32 s67, 0
KT_SPIN2:
    s_sub_u32 s69, s74, 4096
    buffer_load_dword v13, v250, s[4:7], s69 offen sc0 sc1
    buffer_load_dwordx4 v[104:107], v1, s[4:7], s69 offen offset:0 sc0 sc1
    buffer_load_dwordx4 v[108:111], v1, s[4:7], s69 offen offset:1024 sc0 sc1
    buffer_load_dwordx4 v[112:115], v1, s[4:7], s69 offen offset:2048 sc0 sc1
    buffer_load_dwordx4 v[116:119], v1, s[4:7], s69 offen offset:3072 sc0 sc1
    s_add_u32 s69, s69, 4096
    buffer_load_dwordx4 v[120:123], v1, s[4:7], s69 offen offset:0 sc0 sc1
    buffer_load_dwordx4 v[124:127], v1, s[4:7], s69 offen offset:1024 sc0 sc1
    s_waitcnt vmcnt(6)
    v_cmp_u_f32 vcc, v13, v13
    s_cbranch_vccz KT_BACK2
    s_add_u32 s67, s67, 1
    s_cmp_lt_u32 s67, 0x4000
    s_cbranch_scc1 KT_SPIN2
    s_branch KT_BACK2
KT_SLOW3:
    s_mov_b32 s67, 0
KT_SPIN3:
    s_add_u32 s69, s74, 4294963200
    buffer_load_dwordx4 v[104:107], v1, s[4:7], s69 offen offset:0 sc0 sc1
    buffer_load_dwordx4 v[108:111], v1, s[4:7], s69 offen offset:1024 sc0 sc1
    s_waitcnt vmcnt(0)
    v_cmp_u_f32 vcc, v104, v108
    s_cbranch_vccz KT_BACK3
    s_add_u32 s67, s67, 1
    s_cmp_lt_u32 s67, 0x4000
    s_cbranch_scc1 KT_SPIN3
    s_branch KT_BACK3
KT_SLOW4:
    s_mov_b32 s67, 0
KT_SPIN4:
    s_add_u32 s69, s74, 4294961152
    buffer_load_dwordx4 v[112:115], v1, s[4:7], s69 offen offset:0 sc0 sc1
    buffer_load_dwordx4 v[116:119], v1, s[4:7], s69 offen offset:1024 sc0 sc1
    s_waitcnt vmcnt(0)
    v_cmp_u_f32 vcc, v112, v116
    s_cbranch_vccz KT_BACK4
    s_add_u32 s67, s67, 1
    s_cmp_lt_u32 s67, 0x4000
    s_cbranch_scc1 KT_SPIN4
    s_branch KT_BACK4
KT_SLOW5:
    s_mov_b32 s67, 0
KT_SPIN5:
    s_add_u32 s69, s74, 4294959104
    buffer_load_dwordx4 v[120:123], v1, s[4:7], s69 offen offset:0 sc0 sc1
    buffer_load_dwordx4 v[124:127], v1, s[4:7], s69 offen offset:1024 sc0 sc1
    s_waitcnt vmcnt(0)
    v_cmp_u_f32 vcc, v120, v124
    s_cbranch_vccz KT_BACK5
    s_add_u32 s67, s67, 1
    s_cmp_lt_u32 s67, 0x4000
    s_cbranch_scc1 KT_SPIN5
    s_branch KT_BACK5
KT_SLOW6:
    s_mov_b32 s67, 0
KT_SPIN6:
    s_add_u32 s69, s74, 4294957056
    buffer_load_dwordx4 v[128:131], v1, s[4:7], s69 offen offset:0 sc0 sc1
    buffer_load_dwordx4 v[132:135], v1, s[4:7], s69 offen offset:1024 sc0 sc1
    s_waitcnt vmcnt(0)
    v_cmp_u_f32 vcc, v128, v132
    s_cbranch_vccz KT_BACK6
    s_add_u32 s67, s67, 1
    s_cmp_lt_u32 s67, 0x4000
    s_cbranch_scc1 KT_SPIN6
    s_branch KT_BACK6
KT_SLOW7:
    s_mov_b32 s67, 0
KT_SPIN7:
    s_add_u32 s69, s74, 4294955008
    buffer_load_dwordx4 v[136:139], v1, s[4:7], s69 offen offset:0 sc0 sc1
    buffer_load_dwordx4 v[140:143], v1, s[4:7], s69 offen offset:1024 sc0 sc1
    s_waitcnt vmcnt(0)
    v_cmp_u_f32 vcc, v136, v140
    s_cbranch_vccz KT_BACK7
    s_add_u32 s67, s67, 1
    s_cmp_lt_u32 s67, 0x4000
    s_cbranch_scc1 KT_SPIN7
    s_branch KT_BACK7
KT_SLOW8:
    s_mov_b32 s67, 0
KT_SPIN8:
    s_add_u32 s69, s74, 4294952960
    buffer_load_dwordx4 v[144:147], v1, s[4:7], s69 offen offset:0 sc0 sc1
    buffer_load_dwordx4 v[148:151], v1, s[4:7], s69 offen offset:1024 sc0 sc1
    s_waitcnt vmcnt(0)
    v_cmp_u_f32 vcc, v144, v148
    s_cbranch_vccz KT_BACK8
    s_add_u32 s67, s67, 1
    s_cmp_lt_u32 s67, 0x4000
    s_cbranch_scc1 KT_SPIN8
    s_branch KT_BACK8
KT_SLOW9:
    s_mov_b32 s67, 0
KT_SPIN9:
    s_add_u32 s69, s74, 4294950912
    buffer_load_dwordx4 v[152:155], v1, s[4:7], s69 offen offset:0 sc0 sc1
    buffer_load_dwordx4 v[156:159], v1, s[4:7], s69 offen offset:1024 sc0 sc1
    s_waitcnt vmcnt(0)
    v_cmp_u_f32 vcc, v152, v156
    s_cbranch_vccz KT_BACK9
    s_add_u32 s67, s67, 1
    s_cmp_lt_u32 s67, 0x4000
    s_cbranch_scc1 KT_SPIN9
    s_branch KT_BACK9
KT_SLOW10:
    s_mov_b32 s67, 0
KT_SPIN10:
    s_add_u32 s69, s74, 4294948864
    buffer_load_dwordx4 v[160:163], v1, s[4:7], s69 offen offset:0 sc0 sc1
    buffer_load_dwordx4 v[164:167], v1, s[4:7], s69 offen offset:1024 sc0 sc1
    s_waitcnt vmcnt(0)
    v_cmp_u_f32 vcc, v160, v164
    s_cbranch_vccz KT_BACK10
    s_add_u32 s67, s67, 1
    s_cmp_lt_u32 s67, 0x4000
    s_cbranch_scc1 KT_SPIN10
    s_branch KT_BACK10
KT_SLOW11:
    s_mov_b32 s67, 0
KT_SPIN11:
    s_add_u32 s69, s74, 4294946816
    buffer_load_dwordx4 v[168:171], v1, s[4:7], s69 offen offset:0 sc0 sc1
    buffer_load_dwordx4 v[172:175], v1, s[4:7], s69 offen offset:1024 sc0 sc1
    s_waitcnt vmcnt(0)
    v_cmp_u_f32 vcc, v168, v172
    s_cbranch_vccz KT_BACK11
    s_add_u32 s67, s67, 1
    s_cmp_lt_u32 s67, 0x4000
    s_cbranch_scc1 KT_SPIN11
    s_branch KT_BACK11
KT_SLOW12:
    s_mov_b32 s67, 0
KT_SPIN12:
    s_add_u32 s69, s74, 4294948864
    buffer_load_dwordx4 v[176:179], v1, s[4:7], s69 offen offset:0 sc0 sc1
    buffer_load_dwordx4 v[180:183], v1, s[4:7], s69 offen offset:1024 sc0 sc1
    s_waitcnt vmcnt(0)
    v_cmp_u_f32 vcc, v176, v180
    s_cbranch_vccz KT_BACK12
    s_add_u32 s67, s67, 1
    s_cmp_lt_u32 s67, 0x4000
    s_cbranch_scc1 KT_SPIN12
    s_branch KT_BACK12
KT_SLOW13:
    s_mov_b32 s67, 0
KT_SPIN13:
    s_add_u32 s69, s74, 4294950912
    buffer_load_dwordx4 v[184:187], v1, s[4:7], s69 offen offset:0 sc0 sc1
    buffer_load_dwordx4 v[188:191], v1, s[4:7], s69 offen offset:1024 sc0 sc1
    s_waitcnt vmcnt(0)
    v_cmp_u_f32 vcc, v184, v188
    s_cbranch_vccz KT_BACK13
    s_add_u32 s67, s67, 1
    s_cmp_lt_u32 s67, 0x4000
    s_cbranch_scc1 KT_SPIN13
    s_branch KT_BACK13
KT_SLOW14:
    s_mov_b32 s67, 0
KT_SPIN14:
    s_add_u32 s69, s74, 4294952960
    buffer_load_dwordx4 v[192:195], v1, s[4:7], s69 offen offset:0 sc0 sc1
    buffer_load_dwordx4 v[196:199], v1, s[4:7], s69 offen offset:1024 sc0 sc1
    s_waitcnt vmcnt(0)
    v_cmp_u_f32 vcc, v192, v196
    s_cbranch_vccz KT_BACK14
    s_add_u32 s67, s67, 1
    s_cmp_lt_u32 s67, 0x4000
    s_cbranch_scc1 KT_SPIN14
    s_branch KT_BACK14
KT_SLOW15:
    s_mov_b32 s67, 0
KT_SPIN15:
    s_add_u32 s69, s74, 4294955008
    buffer_load_dwordx4 v[200:203], v1, s[4:7], s69 offen offset:0 sc0 sc1
    buffer_load_dwordx4 v[204:207], v1, s[4:7], s69 offen offset:1024 sc0 sc1
    s_waitcnt vmcnt(0)
    v_cmp_u_f32 vcc, v200, v204
    s_cbranch_vccz KT_BACK15
    s_add_u32 s67, s67, 1
    s_cmp_lt_u32 s67, 0x4000
    s_cbranch_scc1 KT_SPIN15
    s_branch KT_BACK15
KT_SLOW16:
    s_mov_b32 s67, 0
KT_SPIN16:
    s_add_u32 s69, s74, 4294957056
    buffer_load_dwordx4 v[208:211], v1, s[4:7], s69 offen offset:0 sc0 sc1
    buffer_load_dwordx4 v[212:215], v1, s[4:7], s69 offen offset:1024 sc0 sc1
    s_waitcnt vmcnt(0)
    v_cmp_u_f32 vcc, v208, v212
    s_cbranch_vccz KT_BACK16
    s_add_u32 s67, s67, 1
    s_cmp_lt_u32 s67, 0x4000
    s_cbranch_scc1 KT_SPIN16
    s_branch KT_BACK16
KT_SLOW17:
    s_mov_b32 s67, 0
KT_SPIN17:
    s_add_u32 s69, s74, 4294959104
    buffer_load_dwordx4 v[216:219], v1, s[4:7], s69 offen offset:0 sc0 sc1
    buffer_load_dwordx4 v[220:223], v1, s[4:7], s69 offen offset:1024 sc0 sc1
    s_waitcnt vmcnt(0)
    v_cmp_u_f32 vcc, v216, v220
    s_cbranch_vccz KT_BACK17
    s_add_u32 s67, s67, 1
    s_cmp_lt_u32 s67, 0x4000
    s_cbranch_scc1 KT_SPIN17
    s_branch KT_BACK17
KT_SLOW18:
    s_mov_b32 s67, 0
KT_SPIN18:
    s_add_u32 s69, s74, 4294961152
    buffer_load_dwordx4 v[224:227], v1, s[4:7], s69 offen offset:0 sc0 sc1
    buffer_load_dwordx4 v[228:231], v1, s[4:7], s69 offen offset:1024 sc0 sc1
    s_waitcnt vmcnt(0)
    v_cmp_u_f32 vcc, v224, v228
    s_cbranch_vccz KT_BACK18
    s_add_u32 s67, s67, 1
    s_cmp_lt_u32 s67, 0x4000
    s_cbranch_scc1 KT_SPIN18
    s_branch KT_BACK18
KT_SLOW19:
    s_mov_b32 s67, 0
KT_SPIN19:
    s_add_u32 s69, s74, 4294963200
    buffer_load_dwordx4 v[232:235], v1, s[4:7], s69 offen offset:0 sc0 sc1
    buffer_load_dwordx4 v[236:239], v1, s[4:7], s69 offen offset:1024 sc0 sc1
    s_waitcnt vmcnt(0)
    v_fma_f32 v250, v232, v234, v236
    v_cmp_u_f32 vcc, v250, v238
    s_cbranch_vccz KT_BACK19
    s_add_u32 s67, s67, 1
    s_cmp_lt_u32 s67, 0x4000
    s_cbranch_scc1 KT_SPIN19
    s_branch KT_BACK19
KT_SLOW20:
    s_mov_b32 s67, 0
KT_SPIN20:
    s_add_u32 s69, s74, 4294965248
    buffer_load_dwordx4 v[240:243], v1, s[4:7], s69 offen offset:0 sc0 sc1
    buffer_load_dwordx4 v[244:247], v1, s[4:7], s69 offen offset:1024 sc0 sc1
    s_waitcnt vmcnt(0)
    v_fma_f32 v250, v240, v242, v244
    v_cmp_u_f32 vcc, v250, v246
    s_cbranch_vccz KT_BACK20
    s_add_u32 s67, s67, 1
    s_cmp_lt_u32 s67, 0x4000
    s_cbranch_scc1 KT_SPIN20
    s_branch KT_BACK20
KT_SLOW21:
    s_mov_b32 s67, 0
KT_SPIN21:
    buffer_load_dword v13, v12, s[4:7], s78 offen sc0 sc1
    s_waitcnt vmcnt(0)
    v_cmp_gt_u32 vcc, 2, v13
    s_and_b32 vcc_lo, vcc_lo, 15
    s_cbranch_scc0 KT_BACK21
    s_add_u32 s67, s67, 1
    s_cmp_lt_u32 s67, 0x4000
    s_cbranch_scc1 KT_SPIN21
    s_branch KT_BACK21
KT_SLOW22:
    s_mov_b32 s67, 0
KT_SPIN22:
    buffer_load_dword v13, v12, s[4:7], s78 offen sc0 sc1
    s_waitcnt vmcnt(0)
    v_cmp_gt_u32 vcc, 3, v13
    s_and_b32 vcc_lo, vcc_lo, 15
    s_cbranch_scc0 KT_BACK22
    s_add_u32 s67, s67, 1
    s_cmp_lt_u32 s67, 0x4000
    s_cbranch_scc1 KT_SPIN22
    s_branch KT_BACK22
KT_SLOW23:
    s_mov_b32 s67, 0
KT_SPIN23:
    buffer_load_dwordx2 v[72:73], v252, s[4:7], s76 offen offset:0 sc0 sc1
    buffer_load_dwordx2 v[74:75], v252, s[4:7], s76 offen offset:512 sc0 sc1
    buffer_load_dwordx2 v[76:77], v252, s[4:7], s76 offen offset:1024 sc0 sc1
    buffer_load_dwordx2 v[78:79], v252, s[4:7], s76 offen offset:1536 sc0 sc1
    buffer_load_dwordx2 v[80:81], v252, s[4:7], s76 offen offset:2048 sc0 sc1
    buffer_load_dwordx2 v[82:83], v252, s[4:7], s76 offen offset:2560 sc0 sc1
    buffer_load_dwordx2 v[84:85], v252, s[4:7], s76 offen offset:3072 sc0 sc1
    buffer_load_dwordx2 v[86:87], v252, s[4:7], s76 offen offset:3584 sc0 sc1
    s_waitcnt vmcnt(0)
    v_add_f32 v72, v72, v74
    v_add_f32 v73, v73, v75
    v_add_f32 v76, v76, v78
    v_add_f32 v77, v77, v79
    v_add_f32 v80, v80, v82
    v_add_f32 v81, v81, v83
    v_add_f32 v84, v84, v86
    v_add_f32 v85, v85, v87
    v_add_f32 v72, v72, v76
    v_add_f32 v73, v73, v77
    v_add_f32 v80, v80, v84
    v_add_f32 v81, v81, v85
    v_add_f32 v72, v72, v80
    v_add_f32 v73, v73, v81
    v_mov_b32 v74, v72
    v_mov_b32 v75, v73
    s_nop 0
    v_permlane32_swap_b32 v72, v74
    v_permlane32_swap_b32 v73, v75
    v_add_f32 v72, v72, v74
    v_add_f32 v73, v73, v75
    v_cmp_u_f32 vcc, v72, v73
    s_cbranch_vccz KT_BACK23
    s_add_u32 s67, s67, 1
    s_cmp_lt_u32 s67, 0x4000
    s_cbranch_scc1 KT_SPIN23
    s_branch KT_BACK23
KT_SLOW24:
    s_mov_b32 s67, 0
KT_SPIN24:
    buffer_load_dword v13, v12, s[4:7], s78 offen sc0 sc1
    s_waitcnt vmcnt(0)
    v_cmp_gt_u32 vcc, 4, v13
    s_and_b32 vcc_lo, vcc_lo, 15
    s_cbranch_scc0 KT_BACK24
    s_add_u32 s67, s67, 1
    s_cmp_lt_u32 s67, 0x4000
    s_cbranch_scc1 KT_SPIN24
    s_branch KT_BACK24
KT_SLOW25:
    s_mov_b32 s67, 0
KT_SPIN25:
    buffer_load_dword v13, v12, s[4:7], s78 offen sc0 sc1
    s_waitcnt vmcnt(0)
    v_cmp_gt_u32 vcc, 5, v13
    s_and_b32 vcc_lo, vcc_lo, 15
    s_cbranch_scc0 KT_BACK25
    s_add_u32 s67, s67, 1
    s_cmp_lt_u32 s67, 0x4000
    s_cbranch_scc1 KT_SPIN25
    s_branch KT_BACK25
KT_SLOW26:
    s_mov_b32 s67, 0
KT_SPIN26:
    buffer_load_dwordx4 v[40:43], v1, s[4:7], s48 offen offset:0 sc0 sc1
    buffer_load_dwordx4 v[44:47], v1, s[4:7], s48 offen offset:1024 sc0 sc1
    buffer_load_dwordx2 v[48:49], v239, s[4:7], s48 offen offset:0 sc0 sc1
    s_add_u32 s75, s48, 9216
    buffer_load_dwordx4 v[50:53], v1, s[4:7], s75 offen offset:0 sc0 sc1
    buffer_load_dwordx4 v[54:57], v1, s[4:7], s75 offen offset:1024 sc0 sc1
    buffer_load_dwordx2 v[58:59], v239, s[4:7], s75 offen offset:0 sc0 sc1
    s_add_u32 s75, s48, 18432
    buffer_load_dwordx4 v[60:63], v1, s[4:7], s75 offen offset:0 sc0 sc1
    buffer_load_dwordx4 v[64:67], v1, s[4:7], s75 offen offset:1024 sc0 sc1
    buffer_load_dwordx2 v[68:69], v239, s[4:7], s75 offen offset:0 sc0 sc1
    s_waitcnt vmcnt(0)
    v_fma_mix_f32 v70, v50, 1.0, v60 op_sel:[0,0,0] op_sel_hi:[1,0,1]
    v_fma_mix_f32 v71, v50, 1.0, v60 op_sel:[1,0,1] op_sel_hi:[1,0,1]
    v_fma_mix_f32 v72, v51, 1.0, v61 op_sel:[0,0,0] op_sel_hi:[1,0,1]
    v_fma_mix_f32 v73, v51, 1.0, v61 op_sel:[1,0,1] op_sel_hi:[1,0,1]
    v_fma_mix_f32 v74, v52, 1.0, v62 op_sel:[0,0,0] op_sel_hi:[1,0,1]
    v_fma_mix_f32 v75, v52, 1.0, v62 op_sel:[1,0,1] op_sel_hi:[1,0,1]
    v_fma_mix_f32 v76, v53, 1.0, v63 op_sel:[0,0,0] op_sel_hi:[1,0,1]
    v_fma_mix_f32 v77, v53, 1.0, v63 op_sel:[1,0,1] op_sel_hi:[1,0,1]
    v_fma_mix_f32 v78, v54, 1.0, v64 op_sel:[0,0,0] op_sel_hi:[1,0,1]
    v_fma_mix_f32 v79, v54, 1.0, v64 op_sel:[1,0,1] op_sel_hi:[1,0,1]
    v_fma_mix_f32 v80, v55, 1.0, v65 op_sel:[0,0,0] op_sel_hi:[1,0,1]
    v_fma_mix_f32 v81, v55, 1.0, v65 op_sel:[1,0,1] op_sel_hi:[1,0,1]
    v_fma_mix_f32 v82, v56, 1.0, v66 op_sel:[0,0,0] op_sel_hi:[1,0,1]
    v_fma_mix_f32 v83, v56, 1.0, v66 op_sel:[1,0,1] op_sel_hi:[1,0,1]
    v_fma_mix_f32 v84, v57, 1.0, v67 op_sel:[0,0,0] op_sel_hi:[1,0,1]
    v_fma_mix_f32 v85, v57, 1.0, v67 op_sel:[1,0,1] op_sel_hi:[1,0,1]
    v_fma_mix_f32 v86, v58, 1.0, v68 op_sel:[0,0,0] op_sel_hi:[1,0,1]
    v_fma_mix_f32 v87, v58, 1.0, v68 op_sel:[1,0,1] op_sel_hi:[1,0,1]
    v_fma_mix_f32 v88, v59, 1.0, v69 op_sel:[0,0,0] op_sel_hi:[1,0,1]
    v_fma_mix_f32 v89, v59, 1.0, v69 op_sel:[1,0,1] op_sel_hi:[1,0,1]
    v_fma_mix_f32 v70, v40, 1.0, v70 op_sel:[0,0,0] op_sel_hi:[1,0,0]
    v_fma_mix_f32 v71, v40, 1.0, v71 op_sel:[1,0,0] op_sel_hi:[1,0,0]
    v_fma_mix_f32 v72, v41, 1.0, v72 op_sel:[0,0,0] op_sel_hi:[1,0,0]
    v_fma_mix_f32 v73, v41, 1.0, v73 op_sel:[1,0,0] op_sel_hi:[1,0,0]
    v_fma_mix_f32 v74, v42, 1.0, v74 op_sel:[0,0,0] op_sel_hi:[1,0,0]
    v_fma_mix_f32 v75, v42, 1.0, v75 op_sel:[1,0,0] op_sel_hi:[1,0,0]
    v_fma_mix_f32 v76, v43, 1.0, v76 op_sel:[0,0,0] op_sel_hi:[1,0,0]
    v_fma_mix_f32 v77, v43, 1.0, v77 op_sel:[1,0,0] op_sel_hi:[1,0,0]
    v_fma_mix_f32 v78, v44, 1.0, v78 op_sel:[0,0,0] op_sel_hi:[1,0,0]
    v_fma_mix_f32 v79, v44, 1.0, v79 op_sel:[1,0,0] op_sel_hi:[1,0,0]
    v_fma_mix_f32 v80, v45, 1.0, v80 op_sel:[0,0,0] op_sel_hi:[1,0,0]
    v_fma_mix_f32 v81, v45, 1.0, v81 op_sel:[1,0,0] op_sel_hi:[1,0,0]
    v_fma_mix_f32 v82, v46, 1.0, v82 op_sel:[0,0,0] op_sel_hi:[1,0,0]
    v_fma_mix_f32 v83, v46, 1.0, v83 op_sel:[1,0,0] op_sel_hi:[1,0,0]
    v_fma_mix_f32 v84, v47, 1.0, v84 op_sel:[0,0,0] op_sel_hi:[1,0,0]
    v_fma_mix_f32 v85, v47, 1.0, v85 op_sel:[1,0,0] op_sel_hi:[1,0,0]
    v_fma_mix_f32 v86, v48, 1.0, v86 op_sel:[0,0,0] op_sel_hi:[1,0,0]
    v_fma_mix_f32 v87, v48, 1.0, v87 op_sel:[1,0,0] op_sel_hi:[1,0,0]
    v_fma_mix_f32 v88, v49, 1.0, v88 op_sel:[0,0,0] op_sel_hi:[1,0,0]
    v_fma_mix_f32 v89, v49, 1.0, v89 op_sel:[1,0,0] op_sel_hi:[1,0,0]
    v_fma_f32 v242, v70, v78, v86
    v_cmp_u_f32 vcc, v242, v242
    s_cbranch_vccz KT_BACK26
    s_add_u32 s67, s67, 1
    s_cmp_lt_u32 s67, 0x4000
    s_cbranch_scc1 KT_SPIN26
    s_branch KT_BACK26
KT_END:
    s_endpgm
CODE_END:
.section .rodata,"a"
.p2align 6
.amdhsa_kernel attn_kernel
  .amdhsa_next_free_vgpr 512
  .amdhsa_next_free_sgpr 102
  .amdhsa_accum_offset 256
  .amdhsa_group_segment_fixed_size 0
  .amdhsa_kernarg_size 96
  .amdhsa_user_sgpr_count 2
  .amdhsa_user_sgpr_kernarg_segment_ptr 1
  .amdhsa_system_sgpr_workgroup_id_x 1
.end_amdhsa_kernel
```
